```python
import torch

def _softmax(x, axis=-1):
    return torch.softmax(x, dim=axis)
def _gelu(x):
    return torch.nn.functional.gelu(x, approximate="tanh")
def _silu(x):
    return torch.nn.functional.silu(x)
def _sigmoid(x):
    return torch.sigmoid(x)
def _layernorm(x, axis=-1, eps=1e-5):
    m = x.mean(dim=axis, keepdim=True)
    v = x.var(dim=axis, keepdim=True, unbiased=False)
    return (x - m) / torch.sqrt(v + eps)
def _scatter_add(tgt, idx, src, axis=0):
    return tgt.clone().index_add_(axis, idx, src)
def _segment_sum(src, seg, n):
    out = torch.zeros((n,) + src.shape[1:], dtype=src.dtype)
    return out.index_add_(0, seg, src)
def _pad(x, pw):
    flat = tuple(v for pair in reversed(pw) for v in pair)
    return torch.nn.functional.pad(x, flat)

kernel_name = 'gated_mix__linear_kernel_hedgehog__compressed_kv_cla__prompt'

def setup_inputs():

    _w = (lambda a: (lambda t: t.to(torch.bfloat16) if t.is_floating_point() else t)(torch.as_tensor(a)))
    def _A_setup():
        B, S, D, H = 1, 2048, 1024, 32
        Dh = D // H
        return {
            "x": _w((lambda *s: torch.randn(*s, dtype=torch.bfloat16) * 0.05)(B, S, D)),
            "wqkv": _w((lambda *s: torch.randn(*s, dtype=torch.bfloat16) * 1.6)(D, 3 * D)),
            "w_phi": _w((lambda *s: torch.randn(*s, dtype=torch.bfloat16) * 1.6)(H, Dh, Dh) * (Dh ** -0.5)),
            "wo": _w((lambda *s: torch.randn(*s, dtype=torch.bfloat16) * 0.05)(D, D)),
        }
    _A_in = _A_setup()

    def _B_setup():
        B, H, Sq, Sk, D, M = 1, 32, 2048, 2048, 128, 1024
        Dc = 4 * D
        return {
            "x": _w((lambda *s: torch.randn(*s, dtype=torch.bfloat16) * 0.05)(B, Sq, M)),
            "c_kv": _w((lambda *s: torch.randn(*s, dtype=torch.bfloat16) * 0.8)(B, Sk, Dc)),
            "w_q": _w((lambda *s: torch.randn(*s, dtype=torch.bfloat16) * 6.4)(M, H, D) * (M ** -0.5)),
            "w_uk": _w((lambda *s: torch.randn(*s, dtype=torch.bfloat16) * 6.4)(Dc, H, D) * (Dc ** -0.5)),
            "w_uv": _w((lambda *s: torch.randn(*s, dtype=torch.bfloat16) * 0.8)(Dc, H, D) * (Dc ** -0.5)),
            "w_o": _w((lambda *s: torch.randn(*s, dtype=torch.bfloat16) * 0.8)(H, D, M) * ((H * D) ** -0.5)),
        }
    _B_in = _B_setup()

    return {
        "A_x": _A_in["x"],
        "A_wqkv": _A_in["wqkv"],
        "A_w_phi": _A_in["w_phi"],
        "A_wo": _A_in["wo"],
        "B_x": _B_in["x"],
        "B_c_kv": _B_in["c_kv"],
        "B_w_q": _B_in["w_q"],
        "B_w_uk": _B_in["w_uk"],
        "B_w_uv": _B_in["w_uv"],
        "B_w_o": _B_in["w_o"],
        "gate_w": _w((lambda *s: torch.randn(*s, dtype=torch.bfloat16) * 0.05)(1024) * 16.0),
    }

def reference(A_x, A_wqkv, A_w_phi, A_wo, B_x, B_c_kv, B_w_q, B_w_uk, B_w_uv, B_w_o, gate_w):
    def _A_ref(x, wqkv, w_phi, wo):
        B, S, D = x.shape
        H = 32; Dh = D // H
        qkv = (lambda x, *d: x.permute(*d))((x @ wqkv).reshape(B, S, 3, H, Dh), 2, 0, 3, 1, 4)
        q, k, v = qkv[0], qkv[1], qkv[2]
        pq = torch.einsum("bhsd,hdf->bhsf", q, w_phi)
        pk = torch.einsum("bhsd,hdf->bhsf", k, w_phi)
        phi_q = torch.concatenate([_softmax(pq, axis=-1), _softmax(-pq, axis=-1)], axis=-1)
        phi_k = torch.concatenate([_softmax(pk, axis=-1), _softmax(-pk, axis=-1)], axis=-1)
        kv = torch.einsum("bhsf,bhsd->bhfd", phi_k, v)
        z  = torch.einsum("bhsf->bhf", phi_k)
        num = torch.einsum("bhqf,bhfd->bhqd", phi_q, kv)
        den = torch.einsum("bhqf,bhf->bhq", phi_q, z)[..., None] + 1e-6
        o = num / den
        return (lambda x, *d: x.permute(*d))(o, 0, 2, 1, 3).reshape(B, S, D) @ wo

    def _B_ref(x, c_kv, w_q, w_uk, w_uv, w_o):
        B, Sq, M = x.shape[0], x.shape[1], x.shape[2]
        Sk = c_kv.shape[1]
        H, D = w_q.shape[1], w_q.shape[2]
        q = torch.einsum("bqm,mhd->bhqd", x, w_q)
        k = torch.einsum("bkc,chd->bhkd", c_kv, w_uk)
        v = torch.einsum("bkc,chd->bhkd", c_kv, w_uv)
        scores = torch.einsum("bhqd,bhkd->bhqk", q, k) * (D ** -0.5)
        off = Sk - Sq
        qi = torch.arange(Sq)[:, None]
        kj = torch.arange(Sk)[None, :]
        cmask = kj <= (qi + off)
        scores = torch.where(cmask[None, None], scores, -1e9)
        p = _softmax(scores, axis=-1)
        ctx = torch.einsum("bhqk,bhkd->bhqd", p, v)
        return torch.einsum("bhqd,hdm->bqm", ctx, w_o)

    x = A_x
    g = _sigmoid((x * gate_w).sum(-1, keepdims=True))
    a = _A_ref(x, A_wqkv, A_w_phi, A_wo)
    b = _B_ref(x, B_c_kv, B_w_q, B_w_uk, B_w_uv, B_w_o)
    return g * a + (1 - g) * b
```

```asm
; @launch grid=(256,1,1) block=(256,1,1) lds=163840
.amdgcn_target "amdgcn-amd-amdhsa--gfx950"

.text
.globl gated_mix__linear_kernel_hedgehog__compressed_kv_cla__prompt_kernel
.p2align 8
.type gated_mix__linear_kernel_hedgehog__compressed_kv_cla__prompt_kernel,@function
gated_mix__linear_kernel_hedgehog__compressed_kv_cla__prompt_kernel:
 s_cmp_ge_u32 s2, 256
 s_cbranch_scc1 F_end
 s_load_dwordx4 s[4:7], s[0:1], 40
 s_load_dwordx4 s[60:63], s[0:1], 56
 s_load_dwordx2 s[72:73], s[0:1], 0
 s_load_dwordx4 s[76:79], s[0:1], 8
 s_load_dwordx2 s[64:65], s[0:1], 80
 s_load_dwordx4 s[68:71], s[0:1], 96
 s_load_dwordx2 s[96:97], s[0:1], 88
 s_load_dwordx2 s[80:81], s[0:1], 24
 s_load_dwordx2 s[82:83], s[0:1], 72
 s_getpc_b64 s[90:91]
F_pc:
 s_lshr_b32 s45, s2, 3
 v_min_u32 v61, 3, v0
 v_mad_u32_u24 v61, s45, 4, v61
 v_lshlrev_b32 v61, 7, v61
 global_load_dword v118, v61, s[90:91]
 v_lshrrev_b32 v1, 6, v0
 v_and_b32 v2, 63, v0
 v_readfirstlane_b32 s52, v1
 s_and_b32 s53, s2, 7
 s_lshl_b32 s53, s53, 2
 s_bfe_u32 s54, s2, 0x20003
 s_or_b32 s53, s53, s54
 s_lshr_b32 s54, s2, 5
 s_sub_u32 s55, 15, s54
 v_lshrrev_b32 v3, 3, v2
 v_and_b32 v4, 7, v2
 s_lshl_b32 s56, s54, 2
 s_add_u32 s56, s56, s52
 s_lshl_b32 s57, s55, 2
 s_add_u32 s57, s57, s52
 v_lshrrev_b32 v60, 1, v3
 v_xor_b32 v60, v60, v4
 v_xor_b32 v117, 4, v60
 v_lshlrev_b32 v60, 4, v60
 v_lshlrev_b32 v117, 4, v117
 v_and_b32 v62, 2, v3
 v_xor_b32 v62, v62, v4
 v_xor_b32 v63, 4, v62
 v_lshlrev_b32 v62, 4, v62
 v_lshlrev_b32 v63, 4, v63
 v_lshl_add_u32 v62, v3, 13, v62
 v_lshl_add_u32 v63, v3, 13, v63
 v_lshl_add_u32 v4, v3, 10, v60
 v_lshl_add_u32 v5, v3, 10, v117
 s_lshl_b32 s58, s56, 15
 s_lshl_b32 s59, s57, 15
 s_add_u32 s66, s58, 0
 v_add_u32 v8, s66, v4
 s_add_u32 s66, s58, 15360
 v_add_u32 v9, s66, v5
 s_add_u32 s66, s58, 6144
 v_add_u32 v10, s66, v4
 s_add_u32 s66, s58, 21504
 v_add_u32 v11, s66, v5
 s_add_u32 s66, s59, 0
 v_add_u32 v12, s66, v4
 s_add_u32 s66, s59, 15360
 v_add_u32 v13, s66, v5
 s_add_u32 s66, s59, 6144
 v_add_u32 v14, s66, v4
 s_add_u32 s66, s59, 21504
 v_add_u32 v15, s66, v5
 s_add_u32 s58, s53, s52
 s_and_b32 s58, s58, 3
 s_and_b32 s59, s53, 28
 s_or_b32 s58, s58, s59
 s_lshl_b32 s58, s58, 8
 s_and_b32 s59, s52, 1
 s_lshl_b32 s66, s59, 7
 s_add_u32 s66, s66, s58
 s_add_u32 s67, s66, 0
 v_add_u32 v16, s67, v62
 s_add_u32 s67, s66, 64512
 v_add_u32 v17, s67, v63
 s_add_u32 s67, s66, 129024
 v_add_u32 v18, s67, v62
 s_add_u32 s67, s66, 193536
 v_add_u32 v19, s67, v63
 s_add_u32 s67, s66, 262144
 v_add_u32 v20, s67, v62
 s_add_u32 s67, s66, 326656
 v_add_u32 v21, s67, v63
 s_add_u32 s67, s66, 391168
 v_add_u32 v22, s67, v62
 s_add_u32 s67, s66, 455680
 v_add_u32 v23, s67, v63
 s_lshl_b32 s46, s52, 14
 s_lshl_b32 s41, s52, 13
 s_add_u32 s42, s41, 4096
 s_lshl_b32 s43, s52, 12
 s_add_u32 s44, s43, 16384
 s_lshr_b32 s99, s2, 3
 s_xor_b32 s99, s99, s54
 s_and_b32 s98, s99, 0
 s_and_b32 s99, s99, 0
 s_and_b32 s94, s2, 1
 s_lshl_b32 s94, s94, 2
 s_or_b32 s94, s94, s98
 s_lshl_b32 s3, s94, 19
 s_lshl_b32 s94, s94, 7
 s_lshl_b32 s98, s99, 19
 s_lshl_b32 s99, s99, 7
 s_waitcnt lgkmcnt(0)
 s_mov_b32 s8, s4
 s_and_b32 s9, s5, 0xffff
 s_mov_b32 s10, 0x200000
 s_mov_b32 s11, 0x20000
 s_cmp_lt_u32 s52, 2
 s_cselect_b32 s12, s60, s62
 s_cselect_b32 s13, s61, s63
 s_and_b32 s13, s13, 0xffff
 s_mov_b32 s14, 0x400000
 s_mov_b32 s15, 0x20000
 s_add_u32 m0, s41, 0x10000
 s_xor_b32 s34, s3, 0x0
 buffer_load_dwordx4 v16, s[12:15], s34 offen offset:0 nt lds
 buffer_load_dwordx4 v17, s[12:15], s34 offen offset:1024 nt lds
 buffer_load_dwordx4 v18, s[12:15], s34 offen offset:2048 nt lds
 buffer_load_dwordx4 v19, s[12:15], s34 offen offset:3072 nt lds
 s_add_u32 m0, s42, 0x10000
 s_nop 0
 buffer_load_dwordx4 v20, s[12:15], s34 offen offset:0 nt lds
 buffer_load_dwordx4 v21, s[12:15], s34 offen offset:1024 nt lds
 buffer_load_dwordx4 v22, s[12:15], s34 offen offset:2048 nt lds
 buffer_load_dwordx4 v23, s[12:15], s34 offen offset:3072 nt lds
 s_add_u32 m0, s46, 0
 s_xor_b32 s33, s94, 0
 buffer_load_dwordx4 v8, s[8:11], s33 offen offset:0 lds
 buffer_load_dwordx4 v9, s[8:11], s33 offen offset:1024 lds
 buffer_load_dwordx4 v10, s[8:11], s33 offen offset:2048 lds
 buffer_load_dwordx4 v11, s[8:11], s33 offen offset:3072 lds
 s_add_u32 m0, s46, 4096
 s_nop 0
 buffer_load_dwordx4 v12, s[8:11], s33 offen offset:0 lds
 buffer_load_dwordx4 v13, s[8:11], s33 offen offset:1024 lds
 buffer_load_dwordx4 v14, s[8:11], s33 offen offset:2048 lds
 buffer_load_dwordx4 v15, s[8:11], s33 offen offset:3072 lds
 s_mov_b32 s16, s6
 s_and_b32 s17, s7, 0xffff
 s_mov_b32 s18, 0x800000
 s_mov_b32 s19, 0x20000
 s_mov_b32 s24, s76
 s_and_b32 s25, s77, 0xffff
 s_mov_b32 s26, 0x600000
 s_mov_b32 s27, 0x20000
 s_mov_b32 s28, s72
 s_and_b32 s29, s73, 0xffff
 s_mov_b32 s30, 0x400000
 s_mov_b32 s31, 0x20000
 s_mov_b32 s20, s70
 s_and_b32 s21, s71, 0xffff
 s_mov_b32 s22, 0x10000000
 s_mov_b32 s23, 0x20000
 s_mov_b32 s36, s68
 s_and_b32 s37, s69, 0xffff
 s_mov_b32 s38, 0x100
 s_mov_b32 s39, 0x20000
 s_mov_b32 s60, s64
 s_and_b32 s61, s65, 0xffff
 s_mov_b32 s62, 0x800
 s_mov_b32 s63, 0x20000
 s_mov_b32 s72, s78
 s_and_b32 s73, s79, 0xffff
 s_mov_b32 s74, 0x10000
 s_mov_b32 s75, 0x20000
 s_lshl_b32 s58, s53, 3
 s_lshl_b32 s59, s52, 1
 s_add_u32 s58, s58, s59
 s_cmp_lt_u32 s58, 128
 s_cselect_b32 s59, s54, s55
 s_lshl_b32 s59, s59, 7
 s_and_b32 s58, s58, 127
 s_add_u32 s58, s58, s59
 s_lshl_b32 s76, s58, 2
 s_add_u32 s76, s76, 0x3b00000
 s_lshl_b32 s58, s58, 11
 s_add_u32 s59, s58, 2048
 s_mov_b32 s77, s58
 s_mov_b32 s78, s59
 v_and_b32 v104, 15, v2
 v_lshrrev_b32 v105, 4, v2
 v_bfe_u32 v106, v2, 2, 2
 v_and_b32 v107, 3, v2
 v_lshrrev_b32 v108, 1, v105
 v_and_b32 v109, 1, v105
 v_lshlrev_b32 v110, 10, v108
 v_lshl_add_u32 v110, v109, 8, v110
 v_lshl_add_u32 v110, v104, 1, v110
 s_lshl_b32 s79, s53, 11
 v_lshl_add_u32 v4, v3, 11, v60
 v_lshl_add_u32 v5, v3, 11, v117
 s_lshl_b32 s58, s56, 16
 s_lshl_b32 s59, s57, 16
 s_add_u32 s66, s58, 0
 v_add_u32 v24, s66, v4
 s_add_u32 s66, s58, 15360
 v_add_u32 v25, s66, v5
 s_add_u32 s66, s58, 30720
 v_add_u32 v26, s66, v4
 s_add_u32 s66, s58, 46080
 v_add_u32 v27, s66, v5
 s_add_u32 s66, s59, 0
 v_add_u32 v28, s66, v4
 s_add_u32 s66, s59, 15360
 v_add_u32 v29, s66, v5
 s_add_u32 s66, s59, 30720
 v_add_u32 v30, s66, v4
 s_add_u32 s66, s59, 46080
 v_add_u32 v31, s66, v5
 s_lshl_b32 s58, s53, 8
 s_and_b32 s59, s52, 1
 s_lshr_b32 s66, s52, 1
 s_lshl_b32 s66, s66, 7
 s_add_u32 s66, s66, s58
 s_lshl_b32 s59, s59, 18
 s_add_u32 s66, s66, s59
 s_add_u32 s67, s66, 0
 v_add_u32 v32, s67, v62
 s_add_u32 s67, s66, 64512
 v_add_u32 v33, s67, v63
 s_add_u32 s67, s66, 129024
 v_add_u32 v34, s67, v62
 s_add_u32 s67, s66, 193536
 v_add_u32 v35, s67, v63
 v_lshrrev_b32 v111, 2, v2
 v_lshrrev_b32 v112, 5, v2
 v_xor_b32 v112, v112, v107
 v_lshlrev_b32 v112, 4, v112
 s_movk_i32 s67, 6144
 v_mad_u32_u24 v111, v111, s67, v112
 s_mul_i32 s66, s52, 98304
 s_lshl_b32 s67, s53, 6
 s_add_u32 s66, s66, s67
 s_add_u32 s67, s66, 0
 v_add_u32 v36, s67, v111
 s_add_u32 s67, s66, 1024
 v_add_u32 v37, s67, v111
 s_add_u32 s67, s66, 2048
 v_add_u32 v38, s67, v111
 v_lshrrev_b32 v111, 1, v104
 v_xor_b32 v111, v111, v105
 v_xor_b32 v112, 4, v111
 v_lshlrev_b32 v113, 7, v104
 v_add_u32 v113, s46, v113
 v_lshl_add_u32 v40, v111, 4, v113
 v_lshl_add_u32 v41, v112, 4, v113
 v_lshrrev_b32 v111, 1, v106
 v_lshl_or_b32 v111, v109, 1, v111
 v_lshlrev_b32 v113, 10, v105
 v_lshl_add_u32 v113, v106, 7, v113
 v_lshl_add_u32 v113, v107, 3, v113
 v_add_u32 v113, 0x10000, v113
 v_xor_b32 v112, 0, v111
 v_lshl_add_u32 v42, v112, 5, v113
 v_add_u32 v48, 0x10000, v42
 v_xor_b32 v112, 1, v111
 v_lshl_add_u32 v43, v112, 5, v113
 v_add_u32 v49, 0x10000, v43
 v_xor_b32 v112, 2, v111
 v_lshl_add_u32 v44, v112, 5, v113
 v_add_u32 v50, 0x10000, v44
 v_xor_b32 v112, 3, v111
 v_lshl_add_u32 v45, v112, 5, v113
 v_add_u32 v51, 0x10000, v45
 v_lshlrev_b32 v113, 12, v108
 v_lshl_add_u32 v113, v109, 9, v113
 v_lshl_add_u32 v113, v106, 6, v113
 v_and_b32 v111, 1, v107
 v_lshl_add_u32 v113, v111, 3, v113
 v_add_u32 v113, 0x14000, v113
 v_and_b32 v111, 2, v107
 v_xor_b32 v111, v111, v109
 v_lshl_add_u32 v46, v111, 4, v113
 v_xor_b32 v111, 1, v111
 v_lshl_add_u32 v47, v111, 4, v113
 v_add_u32 v52, 0x10000, v46
 v_add_u32 v53, 0x10000, v47
 s_lshl_b32 s58, s2, 2
 s_add_u32 s58, s58, s52
 s_lshl_b32 s59, s58, 10
 s_mul_i32 s58, s58, 768
 v_lshlrev_b32 v111, 7, v2
 v_mov_b32 v112, 0x40000000
 v_add_u32 v54, s59, v111
 v_add_u32 v55, s58, v111
 v_cmp_gt_u32 vcc, 8, v2
 v_cmp_gt_u32 s[66:67], 6, v2
 s_nop 0
 v_cndmask_b32 v54, v112, v54, vcc
 v_cndmask_b32 v55, v112, v55, s[66:67]
 v_lshlrev_b32 v111, 7, v2
 s_lshl_b32 s58, s53, 10
 v_add_u32 v1, s58, v111
 v_subrev_u32 v111, 8, v2
 v_lshlrev_b32 v111, 10, v111
 s_lshl_b32 s59, s54, 7
 v_add_u32 v111, s59, v111
 v_add_u32 v111, 0x20000, v111
 v_cmp_gt_u32 vcc, 8, v2
 s_add_u32 s58, s58, s59
 s_cmp_eq_u32 s52, 0
 v_cndmask_b32 v1, v111, v1, vcc
 s_cselect_b32 s58, s58, 0x40000000
 s_or_b32 s66, s52, s2
 s_cselect_b32 s66, 0x40000000, 0
 v_cmp_gt_u32 vcc, 40, v2
 v_mov_b32 v58, v112
 v_mov_b32 v113, v112
 v_cndmask_b32 v1, v112, v1, vcc
 v_writelane_b32 v58, s58, 0
 v_writelane_b32 v113, s66, 0
 s_and_b32 s58, s53, 28
 s_lshl_b32 s58, s58, 10
 v_lshlrev_b32 v39, 7, v2
 v_add_u32 v39, s58, v39
 v_subrev_u32 v111, 32, v2
 v_lshlrev_b32 v111, 10, v111
 s_lshl_b32 s59, s54, 7
 s_add_u32 s59, s59, 0x20000
 v_add_u32 v111, s59, v111
 v_cmp_gt_u32 vcc, 32, v2
 s_nop 1
 v_cndmask_b32 v39, v111, v39, vcc
 s_memrealtime s[58:59]
 v_mov_b32 v61, v113
 v_mov_b32 v63, 0
 s_waitcnt lgkmcnt(0)
 s_or_b32 s89, s58, 1
 v_mov_b32 v62, s89
 s_mov_b32 s50, 0x3fb8aa3b
 s_mov_b32 s51, s50
 v_and_b32 v111, 7, v104
 v_lshlrev_b32 v56, 4, v111
 v_lshrrev_b32 v111, 3, v104
 v_lshl_add_u32 v56, v111, 8, v56
 v_lshl_add_u32 v56, v108, 9, v56
 v_lshl_add_u32 v56, v109, 10, v56
 v_lshlrev_b32 v57, 4, v104
 v_lshl_add_u32 v57, v109, 9, v57
 v_lshl_add_u32 v57, v108, 12, v57
 s_lshl_b32 s40, s53, 20
 s_lshl_b32 s58, s56, 14
 s_lshl_b32 s59, s57, 14
 s_add_u32 s66, s53, 0
 s_and_b32 s66, s66, 3
 s_and_b32 s67, s53, 28
 s_or_b32 s66, s66, s67
 s_lshl_b32 s66, s66, 20
 s_add_u32 s66, s66, 0
 s_add_u32 s84, s66, s58
 s_add_u32 s85, s66, s59
 s_add_u32 s66, s53, 1
 s_and_b32 s66, s66, 3
 s_and_b32 s67, s53, 28
 s_or_b32 s66, s66, s67
 s_lshl_b32 s66, s66, 20
 s_add_u32 s66, s66, 4096
 s_add_u32 s86, s66, s58
 s_add_u32 s87, s66, s59
 s_add_u32 s66, s53, 2
 s_and_b32 s66, s66, 3
 s_and_b32 s67, s53, 28
 s_or_b32 s66, s66, s67
 s_lshl_b32 s66, s66, 20
 s_add_u32 s66, s66, 8192
 s_add_u32 s47, s66, s58
 s_add_u32 s48, s66, s59
 s_add_u32 s66, s53, 3
 s_and_b32 s66, s66, 3
 s_and_b32 s67, s53, 28
 s_or_b32 s66, s66, s67
 s_lshl_b32 s66, s66, 20
 s_add_u32 s66, s66, 8192
 s_add_u32 s92, s66, s58
 s_add_u32 s93, s66, s59
 v_cmp_eq_u32 vcc, 63, v2
 v_mov_b32 v3, 0
 s_nop 0
 v_cndmask_b32 v3, v112, v3, vcc
 s_lshl_b32 s58, s2, 1
 s_and_b32 s59, s52, 1
 s_add_u32 s58, s58, s59
 s_mul_i32 s58, s58, 6144
 s_add_u32 s58, s58, 0x100000
 v_lshlrev_b32 v111, 7, v2
 v_add_u32 v4, s58, v111
 v_cmp_gt_u32 vcc, 48, v2
 s_lshl_b32 s58, s2, 13
 v_lshlrev_b32 v5, 5, v0
 v_cndmask_b32 v4, v112, v4, vcc
 v_add_u32 v5, s58, v5
 v_mov_b32 v59, v110
 s_mov_b32 s32, 0x3b10000
 s_mov_b32 s49, 0x3b18000
 s_add_u32 m0, s41, 0x18000
 s_xor_b32 s34, s3, 0x80000
 buffer_load_dwordx4 v16, s[12:15], s34 offen offset:0 nt lds
 buffer_load_dwordx4 v17, s[12:15], s34 offen offset:1024 nt lds
 buffer_load_dwordx4 v18, s[12:15], s34 offen offset:2048 nt lds
 buffer_load_dwordx4 v19, s[12:15], s34 offen offset:3072 nt lds
 s_add_u32 m0, s42, 0x18000
 s_nop 0
 buffer_load_dwordx4 v20, s[12:15], s34 offen offset:0 nt lds
 buffer_load_dwordx4 v21, s[12:15], s34 offen offset:1024 nt lds
 buffer_load_dwordx4 v22, s[12:15], s34 offen offset:2048 nt lds
 buffer_load_dwordx4 v23, s[12:15], s34 offen offset:3072 nt lds
 s_add_u32 m0, s46, 8192
 s_xor_b32 s33, s94, 128
 buffer_load_dwordx4 v8, s[8:11], s33 offen offset:0 lds
 buffer_load_dwordx4 v9, s[8:11], s33 offen offset:1024 lds
 buffer_load_dwordx4 v10, s[8:11], s33 offen offset:2048 lds
 buffer_load_dwordx4 v11, s[8:11], s33 offen offset:3072 lds
 s_add_u32 m0, s46, 12288
 s_nop 0
 buffer_load_dwordx4 v12, s[8:11], s33 offen offset:0 lds
 buffer_load_dwordx4 v13, s[8:11], s33 offen offset:1024 lds
 buffer_load_dwordx4 v14, s[8:11], s33 offen offset:2048 lds
 buffer_load_dwordx4 v15, s[8:11], s33 offen offset:3072 lds
 s_waitcnt vmcnt(16)
 s_barrier
 ds_read_b64_tr_b16 a[96:97], v42 offset:0
 ds_read_b64_tr_b16 a[98:99], v42 offset:512
 ds_read_b64_tr_b16 a[100:101], v42 offset:4096
 ds_read_b64_tr_b16 a[102:103], v42 offset:4608
 ds_read_b128 a[64:67], v40 offset:0
 ds_read_b128 a[80:83], v41 offset:0
 ds_read_b128 a[68:71], v40 offset:2048
 ds_read_b128 a[84:87], v41 offset:2048
 ds_read_b128 a[72:75], v40 offset:4096
 ds_read_b128 a[88:91], v41 offset:4096
 ds_read_b128 a[76:79], v40 offset:6144
 ds_read_b128 a[92:95], v41 offset:6144
 ds_read_b64_tr_b16 a[104:105], v43 offset:0
 ds_read_b64_tr_b16 a[106:107], v43 offset:512
 ds_read_b64_tr_b16 a[108:109], v43 offset:4096
 ds_read_b64_tr_b16 a[110:111], v43 offset:4608
 ds_read_b64_tr_b16 a[112:113], v44 offset:0
 ds_read_b64_tr_b16 a[114:115], v44 offset:512
 ds_read_b64_tr_b16 a[116:117], v44 offset:4096
 ds_read_b64_tr_b16 a[118:119], v44 offset:4608
F_step0:
 s_waitcnt lgkmcnt(8)
 v_mfma_f32_16x16x32_bf16 v[64:67], a[96:99], a[64:67], 0
 ds_read_b64_tr_b16 a[120:121], v45 offset:0
 v_mfma_f32_16x16x32_bf16 v[64:67], a[100:103], a[80:83], v[64:67]
 buffer_store_dword v62, v61, s[36:39], 0 offen sc1
 v_mfma_f32_16x16x32_bf16 v[68:71], a[96:99], a[68:71], 0
 ds_read_b64_tr_b16 a[122:123], v45 offset:512
 v_mfma_f32_16x16x32_bf16 v[68:71], a[100:103], a[84:87], v[68:71]
 v_mfma_f32_16x16x32_bf16 v[72:75], a[96:99], a[72:75], 0
 ds_read_b64_tr_b16 a[124:125], v45 offset:4096
 v_mfma_f32_16x16x32_bf16 v[72:75], a[100:103], a[88:91], v[72:75]
 s_add_u32 m0, s46, 0
 v_lshlrev_b32 v61, 5, v2
 v_mfma_f32_16x16x32_bf16 v[76:79], a[96:99], a[76:79], 0
 ds_read_b64_tr_b16 a[126:127], v45 offset:4608
 s_xor_b32 s33, s94, 256
 v_mfma_f32_16x16x32_bf16 v[76:79], a[100:103], a[92:95], v[76:79]
 s_waitcnt lgkmcnt(8)
 v_mfma_f32_16x16x32_bf16 v[92:95], a[104:107], a[76:79], 0
 ds_read_b64_tr_b16 a[96:97], v42 offset:8192
 v_mfma_f32_16x16x32_bf16 v[92:95], a[108:111], a[92:95], v[92:95]
 buffer_load_dwordx4 v8, s[8:11], s33 offen offset:0 lds
 v_mfma_f32_16x16x32_bf16 v[88:91], a[104:107], a[72:75], 0
 ds_read_b64_tr_b16 a[98:99], v42 offset:8704
 v_mfma_f32_16x16x32_bf16 v[88:91], a[108:111], a[88:91], v[88:91]
 buffer_load_dwordx4 v9, s[8:11], s33 offen offset:1024 lds
 v_mfma_f32_16x16x32_bf16 v[84:87], a[104:107], a[68:71], 0
 ds_read_b64_tr_b16 a[100:101], v42 offset:12288
 v_mfma_f32_16x16x32_bf16 v[84:87], a[108:111], a[84:87], v[84:87]
 v_mfma_f32_16x16x32_bf16 v[80:83], a[104:107], a[64:67], 0
 ds_read_b64_tr_b16 a[102:103], v42 offset:12800
 v_mfma_f32_16x16x32_bf16 v[80:83], a[108:111], a[80:83], v[80:83]
 s_waitcnt lgkmcnt(8)
 v_mfma_f32_16x16x32_bf16 v[96:99], a[112:115], a[64:67], 0
 ds_read_b64_tr_b16 a[104:105], v43 offset:8192
 v_mfma_f32_16x16x32_bf16 v[96:99], a[116:119], a[80:83], v[96:99]
 buffer_load_dwordx4 v10, s[8:11], s33 offen offset:2048 lds
 v_mfma_f32_16x16x32_bf16 v[100:103], a[112:115], a[68:71], 0
 ds_read_b64_tr_b16 a[106:107], v43 offset:8704
 v_mfma_f32_16x16x32_bf16 v[100:103], a[116:119], a[84:87], v[100:103]
 buffer_load_dwordx4 a[128:131], v61, s[28:31], s77 offen
 v_mfma_f32_16x16x32_bf16 v[104:107], a[112:115], a[72:75], 0
 ds_read_b64_tr_b16 a[108:109], v43 offset:12288
 v_mfma_f32_16x16x32_bf16 v[104:107], a[116:119], a[88:91], v[104:107]
 v_mfma_f32_16x16x32_bf16 v[108:111], a[112:115], a[76:79], 0
 ds_read_b64_tr_b16 a[110:111], v43 offset:12800
 v_mfma_f32_16x16x32_bf16 v[108:111], a[116:119], a[92:95], v[108:111]
 s_waitcnt lgkmcnt(8)
 v_mfma_f32_16x16x32_bf16 v[124:127], a[120:123], a[76:79], 0
 ds_read_b64_tr_b16 a[112:113], v44 offset:8192
 v_mfma_f32_16x16x32_bf16 v[124:127], a[124:127], a[92:95], v[124:127]
 buffer_load_dwordx4 v11, s[8:11], s33 offen offset:3072 lds
 v_mfma_f32_16x16x32_bf16 v[120:123], a[120:123], a[72:75], 0
 ds_read_b64_tr_b16 a[114:115], v44 offset:8704
 v_mfma_f32_16x16x32_bf16 v[120:123], a[124:127], a[88:91], v[120:123]
 v_mfma_f32_16x16x32_bf16 v[116:119], a[120:123], a[68:71], 0
 ds_read_b64_tr_b16 a[116:117], v44 offset:12288
 v_mfma_f32_16x16x32_bf16 v[116:119], a[124:127], a[84:87], v[116:119]
 s_add_u32 m0, s46, 4096
 v_mfma_f32_16x16x32_bf16 v[112:115], a[120:123], a[64:67], 0
 ds_read_b64_tr_b16 a[118:119], v44 offset:12800
 v_mfma_f32_16x16x32_bf16 v[112:115], a[124:127], a[80:83], v[112:115]
 s_waitcnt lgkmcnt(8)
 v_mfma_f32_16x16x32_bf16 v[128:131], a[96:99], a[64:67], 0
 ds_read_b64_tr_b16 a[120:121], v45 offset:8192
 v_mfma_f32_16x16x32_bf16 v[128:131], a[100:103], a[80:83], v[128:131]
 buffer_load_dwordx4 v12, s[8:11], s33 offen offset:0 lds
 v_mfma_f32_16x16x32_bf16 v[132:135], a[96:99], a[68:71], 0
 ds_read_b64_tr_b16 a[122:123], v45 offset:8704
 v_mfma_f32_16x16x32_bf16 v[132:135], a[100:103], a[84:87], v[132:135]
 buffer_load_dwordx4 v13, s[8:11], s33 offen offset:1024 lds
 v_mfma_f32_16x16x32_bf16 v[136:139], a[96:99], a[72:75], 0
 ds_read_b64_tr_b16 a[124:125], v45 offset:12288
 v_mfma_f32_16x16x32_bf16 v[136:139], a[100:103], a[88:91], v[136:139]
 buffer_load_dwordx4 a[132:135], v61, s[28:31], s77 offen offset:16
 v_mfma_f32_16x16x32_bf16 v[140:143], a[96:99], a[76:79], 0
 ds_read_b64_tr_b16 a[126:127], v45 offset:12800
 v_mfma_f32_16x16x32_bf16 v[140:143], a[100:103], a[92:95], v[140:143]
 s_waitcnt lgkmcnt(8)
 v_mfma_f32_16x16x32_bf16 v[156:159], a[104:107], a[76:79], 0
 ds_read_b64_tr_b16 a[96:97], v42 offset:16384
 v_mfma_f32_16x16x32_bf16 v[156:159], a[108:111], a[92:95], v[156:159]
 v_mfma_f32_16x16x32_bf16 v[152:155], a[104:107], a[72:75], 0
 ds_read_b64_tr_b16 a[98:99], v42 offset:16896
 v_mfma_f32_16x16x32_bf16 v[152:155], a[108:111], a[88:91], v[152:155]
 buffer_load_dwordx4 v14, s[8:11], s33 offen offset:2048 lds
 v_mfma_f32_16x16x32_bf16 v[148:151], a[104:107], a[68:71], 0
 ds_read_b64_tr_b16 a[100:101], v42 offset:20480
 v_mfma_f32_16x16x32_bf16 v[148:151], a[108:111], a[84:87], v[148:151]
 v_mfma_f32_16x16x32_bf16 v[144:147], a[104:107], a[64:67], 0
 ds_read_b64_tr_b16 a[102:103], v42 offset:20992
 v_mfma_f32_16x16x32_bf16 v[144:147], a[108:111], a[80:83], v[144:147]
 s_waitcnt lgkmcnt(8)
 v_mfma_f32_16x16x32_bf16 v[160:163], a[112:115], a[64:67], 0
 ds_read_b64_tr_b16 a[104:105], v43 offset:16384
 v_mfma_f32_16x16x32_bf16 v[160:163], a[116:119], a[80:83], v[160:163]
 buffer_load_dwordx4 v15, s[8:11], s33 offen offset:3072 lds
 v_mfma_f32_16x16x32_bf16 v[164:167], a[112:115], a[68:71], 0
 ds_read_b64_tr_b16 a[106:107], v43 offset:16896
 v_mfma_f32_16x16x32_bf16 v[164:167], a[116:119], a[84:87], v[164:167]
 buffer_load_dwordx4 a[136:139], v61, s[28:31], s78 offen
 v_mfma_f32_16x16x32_bf16 v[168:171], a[112:115], a[72:75], 0
 ds_read_b64_tr_b16 a[108:109], v43 offset:20480
 v_mfma_f32_16x16x32_bf16 v[168:171], a[116:119], a[88:91], v[168:171]
 v_mfma_f32_16x16x32_bf16 v[172:175], a[112:115], a[76:79], 0
 ds_read_b64_tr_b16 a[110:111], v43 offset:20992
 s_add_u32 m0, s41, 0x20000
 v_mfma_f32_16x16x32_bf16 v[172:175], a[116:119], a[92:95], v[172:175]
 s_xor_b32 s34, s3, 0x100000
 s_waitcnt lgkmcnt(8)
 v_mfma_f32_16x16x32_bf16 v[188:191], a[120:123], a[76:79], 0
 ds_read_b64_tr_b16 a[112:113], v44 offset:16384
 v_mfma_f32_16x16x32_bf16 v[188:191], a[124:127], a[92:95], v[188:191]
 buffer_load_dwordx4 v16, s[12:15], s34 offen offset:0 nt lds
 v_mfma_f32_16x16x32_bf16 v[184:187], a[120:123], a[72:75], 0
 ds_read_b64_tr_b16 a[114:115], v44 offset:16896
 v_mfma_f32_16x16x32_bf16 v[184:187], a[124:127], a[88:91], v[184:187]
 v_mfma_f32_16x16x32_bf16 v[180:183], a[120:123], a[68:71], 0
 ds_read_b64_tr_b16 a[116:117], v44 offset:20480
 v_mfma_f32_16x16x32_bf16 v[180:183], a[124:127], a[84:87], v[180:183]
 buffer_load_dwordx4 v17, s[12:15], s34 offen offset:1024 nt lds
 v_mfma_f32_16x16x32_bf16 v[176:179], a[120:123], a[64:67], 0
 ds_read_b64_tr_b16 a[118:119], v44 offset:20992
 v_mfma_f32_16x16x32_bf16 v[176:179], a[124:127], a[80:83], v[176:179]
 s_waitcnt lgkmcnt(8)
 v_mfma_f32_16x16x32_bf16 v[192:195], a[64:67], a[96:99], 0
 ds_read_b64_tr_b16 a[120:121], v45 offset:16384
 v_mfma_f32_16x16x32_bf16 v[192:195], a[80:83], a[100:103], v[192:195]
 buffer_load_dwordx4 a[140:143], v61, s[28:31], s78 offen offset:16
 v_mfma_f32_16x16x32_bf16 v[196:199], a[68:71], a[96:99], 0
 ds_read_b64_tr_b16 a[122:123], v45 offset:16896
 v_mfma_f32_16x16x32_bf16 v[196:199], a[84:87], a[100:103], v[196:199]
 buffer_load_dwordx4 v18, s[12:15], s34 offen offset:2048 nt lds
 v_mfma_f32_16x16x32_bf16 v[200:203], a[72:75], a[96:99], 0
 ds_read_b64_tr_b16 a[124:125], v45 offset:20480
 v_mfma_f32_16x16x32_bf16 v[200:203], a[88:91], a[100:103], v[200:203]
 v_mfma_f32_16x16x32_bf16 v[204:207], a[76:79], a[96:99], 0
 ds_read_b64_tr_b16 a[126:127], v45 offset:20992
 v_mfma_f32_16x16x32_bf16 v[204:207], a[92:95], a[100:103], v[204:207]
 s_waitcnt lgkmcnt(8)
 v_mfma_f32_16x16x32_bf16 v[220:223], a[76:79], a[104:107], 0
 ds_read_b64_tr_b16 a[96:97], v42 offset:24576
 v_mfma_f32_16x16x32_bf16 v[220:223], a[92:95], a[108:111], v[220:223]
 buffer_load_dwordx4 v19, s[12:15], s34 offen offset:3072 nt lds
 v_mfma_f32_16x16x32_bf16 v[216:219], a[72:75], a[104:107], 0
 ds_read_b64_tr_b16 a[98:99], v42 offset:25088
 v_mfma_f32_16x16x32_bf16 v[216:219], a[88:91], a[108:111], v[216:219]
 v_mfma_f32_16x16x32_bf16 v[212:215], a[68:71], a[104:107], 0
 ds_read_b64_tr_b16 a[100:101], v42 offset:28672
 v_mfma_f32_16x16x32_bf16 v[212:215], a[84:87], a[108:111], v[212:215]
 buffer_load_dwordx4 a[144:147], v61, s[60:63], 0 offen
 v_mfma_f32_16x16x32_bf16 v[208:211], a[64:67], a[104:107], 0
 ds_read_b64_tr_b16 a[102:103], v42 offset:29184
 v_mfma_f32_16x16x32_bf16 v[208:211], a[80:83], a[108:111], v[208:211]
 s_add_u32 m0, s42, 0x20000
 s_waitcnt lgkmcnt(8)
 v_mfma_f32_16x16x32_bf16 v[224:227], a[64:67], a[112:115], 0
 ds_read_b64_tr_b16 a[104:105], v43 offset:24576
 v_mfma_f32_16x16x32_bf16 v[224:227], a[80:83], a[116:119], v[224:227]
 buffer_load_dwordx4 v20, s[12:15], s34 offen offset:0 nt lds
 v_mfma_f32_16x16x32_bf16 v[228:231], a[68:71], a[112:115], 0
 ds_read_b64_tr_b16 a[106:107], v43 offset:25088
 v_mfma_f32_16x16x32_bf16 v[228:231], a[84:87], a[116:119], v[228:231]
 v_mfma_f32_16x16x32_bf16 v[232:235], a[72:75], a[112:115], 0
 ds_read_b64_tr_b16 a[108:109], v43 offset:28672
 v_mfma_f32_16x16x32_bf16 v[232:235], a[88:91], a[116:119], v[232:235]
 buffer_load_dwordx4 v21, s[12:15], s34 offen offset:1024 nt lds
 v_mfma_f32_16x16x32_bf16 v[236:239], a[76:79], a[112:115], 0
 ds_read_b64_tr_b16 a[110:111], v43 offset:29184
 v_mfma_f32_16x16x32_bf16 v[236:239], a[92:95], a[116:119], v[236:239]
 s_waitcnt lgkmcnt(8)
 v_mfma_f32_16x16x32_bf16 v[252:255], a[76:79], a[120:123], 0
 ds_read_b64_tr_b16 a[112:113], v44 offset:24576
 v_mfma_f32_16x16x32_bf16 v[252:255], a[92:95], a[124:127], v[252:255]
 v_mfma_f32_16x16x32_bf16 v[248:251], a[72:75], a[120:123], 0
 ds_read_b64_tr_b16 a[114:115], v44 offset:25088
 v_mfma_f32_16x16x32_bf16 v[248:251], a[88:91], a[124:127], v[248:251]
 buffer_load_dwordx4 v22, s[12:15], s34 offen offset:2048 nt lds
 v_mfma_f32_16x16x32_bf16 v[244:247], a[68:71], a[120:123], 0
 ds_read_b64_tr_b16 a[116:117], v44 offset:28672
 v_mfma_f32_16x16x32_bf16 v[244:247], a[84:87], a[124:127], v[244:247]
 buffer_load_dwordx4 a[148:151], v61, s[60:63], 0 offen offset:16
 v_mfma_f32_16x16x32_bf16 v[240:243], a[64:67], a[120:123], 0
 ds_read_b64_tr_b16 a[118:119], v44 offset:29184
 v_mfma_f32_16x16x32_bf16 v[240:243], a[80:83], a[124:127], v[240:243]
 s_waitcnt lgkmcnt(8)
 v_mfma_f32_16x16x32_bf16 a[0:3], a[64:67], a[96:99], 0
 ds_read_b64_tr_b16 a[120:121], v45 offset:24576
 v_mfma_f32_16x16x32_bf16 a[0:3], a[80:83], a[100:103], a[0:3]
 buffer_load_dwordx4 v23, s[12:15], s34 offen offset:3072 nt lds
 v_mfma_f32_16x16x32_bf16 a[4:7], a[68:71], a[96:99], 0
 ds_read_b64_tr_b16 a[122:123], v45 offset:25088
 v_mfma_f32_16x16x32_bf16 a[4:7], a[84:87], a[100:103], a[4:7]
 v_mfma_f32_16x16x32_bf16 a[8:11], a[72:75], a[96:99], 0
 ds_read_b64_tr_b16 a[124:125], v45 offset:28672
 v_mfma_f32_16x16x32_bf16 a[8:11], a[88:91], a[100:103], a[8:11]
 v_mfma_f32_16x16x32_bf16 a[12:15], a[76:79], a[96:99], 0
 ds_read_b64_tr_b16 a[126:127], v45 offset:29184
 v_mfma_f32_16x16x32_bf16 a[12:15], a[92:95], a[100:103], a[12:15]
 s_waitcnt lgkmcnt(8)
 v_mfma_f32_16x16x32_bf16 a[28:31], a[76:79], a[104:107], 0
 v_mfma_f32_16x16x32_bf16 a[28:31], a[92:95], a[108:111], a[28:31]
 v_mfma_f32_16x16x32_bf16 a[24:27], a[72:75], a[104:107], 0
 v_mfma_f32_16x16x32_bf16 a[24:27], a[88:91], a[108:111], a[24:27]
 s_waitcnt lgkmcnt(0) vmcnt(23)
 s_barrier
 v_mfma_f32_16x16x32_bf16 a[20:23], a[68:71], a[104:107], 0
 ds_read_b64_tr_b16 a[96:97], v42 offset:32768
 v_mfma_f32_16x16x32_bf16 a[20:23], a[84:87], a[108:111], a[20:23]
 ds_read_b64_tr_b16 a[98:99], v42 offset:33280
 v_mfma_f32_16x16x32_bf16 a[16:19], a[64:67], a[104:107], 0
 ds_read_b64_tr_b16 a[100:101], v42 offset:36864
 v_mfma_f32_16x16x32_bf16 a[16:19], a[80:83], a[108:111], a[16:19]
 ds_read_b64_tr_b16 a[102:103], v42 offset:37376
 v_mfma_f32_16x16x32_bf16 a[32:35], a[64:67], a[112:115], 0
 ds_read_b128 a[224:227], v40 offset:8192
 v_mfma_f32_16x16x32_bf16 a[32:35], a[80:83], a[116:119], a[32:35]
 ds_read_b128 a[240:243], v41 offset:8192
 v_mfma_f32_16x16x32_bf16 a[36:39], a[68:71], a[112:115], 0
 ds_read_b128 a[228:231], v40 offset:10240
 v_mfma_f32_16x16x32_bf16 a[36:39], a[84:87], a[116:119], a[36:39]
 ds_read_b128 a[244:247], v41 offset:10240
 v_mfma_f32_16x16x32_bf16 a[40:43], a[72:75], a[112:115], 0
 ds_read_b128 a[232:235], v40 offset:12288
 v_mfma_f32_16x16x32_bf16 a[40:43], a[88:91], a[116:119], a[40:43]
 ds_read_b128 a[248:251], v41 offset:12288
 v_mfma_f32_16x16x32_bf16 a[44:47], a[76:79], a[112:115], 0
 ds_read_b128 a[236:239], v40 offset:14336
 v_mfma_f32_16x16x32_bf16 a[44:47], a[92:95], a[116:119], a[44:47]
 ds_read_b128 a[252:255], v41 offset:14336
 v_mfma_f32_16x16x32_bf16 a[60:63], a[76:79], a[120:123], 0
 ds_read_b64_tr_b16 a[104:105], v43 offset:32768
 v_mfma_f32_16x16x32_bf16 a[60:63], a[92:95], a[124:127], a[60:63]
 ds_read_b64_tr_b16 a[106:107], v43 offset:33280
 v_mfma_f32_16x16x32_bf16 a[56:59], a[72:75], a[120:123], 0
 ds_read_b64_tr_b16 a[108:109], v43 offset:36864
 v_mfma_f32_16x16x32_bf16 a[56:59], a[88:91], a[124:127], a[56:59]
 ds_read_b64_tr_b16 a[110:111], v43 offset:37376
 v_mfma_f32_16x16x32_bf16 a[52:55], a[68:71], a[120:123], 0
 ds_read_b64_tr_b16 a[112:113], v44 offset:32768
 v_mfma_f32_16x16x32_bf16 a[52:55], a[84:87], a[124:127], a[52:55]
 ds_read_b64_tr_b16 a[114:115], v44 offset:33280
 v_mfma_f32_16x16x32_bf16 a[48:51], a[64:67], a[120:123], 0
 ds_read_b64_tr_b16 a[116:117], v44 offset:36864
 v_mfma_f32_16x16x32_bf16 a[48:51], a[80:83], a[124:127], a[48:51]
 ds_read_b64_tr_b16 a[118:119], v44 offset:37376
F_step1:
 s_waitcnt lgkmcnt(8)
 v_mfma_f32_16x16x32_bf16 v[64:67], a[96:99], a[224:227], v[64:67]
 ds_read_b64_tr_b16 a[120:121], v45 offset:32768
 v_mfma_f32_16x16x32_bf16 v[64:67], a[100:103], a[240:243], v[64:67]
 v_mfma_f32_16x16x32_bf16 v[68:71], a[96:99], a[228:231], v[68:71]
 ds_read_b64_tr_b16 a[122:123], v45 offset:33280
 v_mfma_f32_16x16x32_bf16 v[68:71], a[100:103], a[244:247], v[68:71]
 s_add_u32 m0, s46, 8192
 s_xor_b32 s33, s94, 384
 v_mfma_f32_16x16x32_bf16 v[72:75], a[96:99], a[232:235], v[72:75]
 ds_read_b64_tr_b16 a[124:125], v45 offset:36864
 v_mfma_f32_16x16x32_bf16 v[72:75], a[100:103], a[248:251], v[72:75]
 buffer_load_dwordx4 v8, s[8:11], s33 offen offset:0 lds
 v_mfma_f32_16x16x32_bf16 v[76:79], a[96:99], a[236:239], v[76:79]
 ds_read_b64_tr_b16 a[126:127], v45 offset:37376
 v_mfma_f32_16x16x32_bf16 v[76:79], a[100:103], a[252:255], v[76:79]
 s_waitcnt lgkmcnt(8)
 v_mfma_f32_16x16x32_bf16 v[92:95], a[104:107], a[236:239], v[92:95]
 ds_read_b64_tr_b16 a[96:97], v42 offset:40960
 v_mfma_f32_16x16x32_bf16 v[92:95], a[108:111], a[252:255], v[92:95]
 buffer_load_dwordx4 v9, s[8:11], s33 offen offset:1024 lds
 v_mfma_f32_16x16x32_bf16 v[88:91], a[104:107], a[232:235], v[88:91]
 ds_read_b64_tr_b16 a[98:99], v42 offset:41472
 v_mfma_f32_16x16x32_bf16 v[88:91], a[108:111], a[248:251], v[88:91]
 v_mfma_f32_16x16x32_bf16 v[84:87], a[104:107], a[228:231], v[84:87]
 ds_read_b64_tr_b16 a[100:101], v42 offset:45056
 v_mfma_f32_16x16x32_bf16 v[84:87], a[108:111], a[244:247], v[84:87]
 v_mfma_f32_16x16x32_bf16 v[80:83], a[104:107], a[224:227], v[80:83]
 ds_read_b64_tr_b16 a[102:103], v42 offset:45568
 v_mfma_f32_16x16x32_bf16 v[80:83], a[108:111], a[240:243], v[80:83]
 s_waitcnt lgkmcnt(8)
 v_mfma_f32_16x16x32_bf16 v[96:99], a[112:115], a[224:227], v[96:99]
 ds_read_b64_tr_b16 a[104:105], v43 offset:40960
 v_mfma_f32_16x16x32_bf16 v[96:99], a[116:119], a[240:243], v[96:99]
 buffer_load_dwordx4 v10, s[8:11], s33 offen offset:2048 lds
 v_mfma_f32_16x16x32_bf16 v[100:103], a[112:115], a[228:231], v[100:103]
 ds_read_b64_tr_b16 a[106:107], v43 offset:41472
 v_mfma_f32_16x16x32_bf16 v[100:103], a[116:119], a[244:247], v[100:103]
 v_mfma_f32_16x16x32_bf16 v[104:107], a[112:115], a[232:235], v[104:107]
 ds_read_b64_tr_b16 a[108:109], v43 offset:45056
 v_mfma_f32_16x16x32_bf16 v[104:107], a[116:119], a[248:251], v[104:107]
 buffer_load_dwordx4 v11, s[8:11], s33 offen offset:3072 lds
 v_mfma_f32_16x16x32_bf16 v[108:111], a[112:115], a[236:239], v[108:111]
 ds_read_b64_tr_b16 a[110:111], v43 offset:45568
 v_mfma_f32_16x16x32_bf16 v[108:111], a[116:119], a[252:255], v[108:111]
 s_waitcnt lgkmcnt(8)
 v_mfma_f32_16x16x32_bf16 v[124:127], a[120:123], a[236:239], v[124:127]
 ds_read_b64_tr_b16 a[112:113], v44 offset:40960
 v_mfma_f32_16x16x32_bf16 v[124:127], a[124:127], a[252:255], v[124:127]
 v_mfma_f32_16x16x32_bf16 v[120:123], a[120:123], a[232:235], v[120:123]
 ds_read_b64_tr_b16 a[114:115], v44 offset:41472
 v_mfma_f32_16x16x32_bf16 v[120:123], a[124:127], a[248:251], v[120:123]
 s_add_u32 m0, s46, 12288
 v_mfma_f32_16x16x32_bf16 v[116:119], a[120:123], a[228:231], v[116:119]
 ds_read_b64_tr_b16 a[116:117], v44 offset:45056
 v_mfma_f32_16x16x32_bf16 v[116:119], a[124:127], a[244:247], v[116:119]
 buffer_load_dwordx4 v12, s[8:11], s33 offen offset:0 lds
 v_mfma_f32_16x16x32_bf16 v[112:115], a[120:123], a[224:227], v[112:115]
 ds_read_b64_tr_b16 a[118:119], v44 offset:45568
 v_mfma_f32_16x16x32_bf16 v[112:115], a[124:127], a[240:243], v[112:115]
 s_waitcnt lgkmcnt(8)
 v_mfma_f32_16x16x32_bf16 v[128:131], a[96:99], a[224:227], v[128:131]
 ds_read_b64_tr_b16 a[120:121], v45 offset:40960
 v_mfma_f32_16x16x32_bf16 v[128:131], a[100:103], a[240:243], v[128:131]
 buffer_load_dwordx4 v13, s[8:11], s33 offen offset:1024 lds
 v_mfma_f32_16x16x32_bf16 v[132:135], a[96:99], a[228:231], v[132:135]
 ds_read_b64_tr_b16 a[122:123], v45 offset:41472
 v_mfma_f32_16x16x32_bf16 v[132:135], a[100:103], a[244:247], v[132:135]
 v_mfma_f32_16x16x32_bf16 v[136:139], a[96:99], a[232:235], v[136:139]
 ds_read_b64_tr_b16 a[124:125], v45 offset:45056
 v_mfma_f32_16x16x32_bf16 v[136:139], a[100:103], a[248:251], v[136:139]
 v_mfma_f32_16x16x32_bf16 v[140:143], a[96:99], a[236:239], v[140:143]
 ds_read_b64_tr_b16 a[126:127], v45 offset:45568
 v_mfma_f32_16x16x32_bf16 v[140:143], a[100:103], a[252:255], v[140:143]
 s_waitcnt lgkmcnt(8)
 v_mfma_f32_16x16x32_bf16 v[156:159], a[104:107], a[236:239], v[156:159]
 ds_read_b64_tr_b16 a[96:97], v42 offset:49152
 v_mfma_f32_16x16x32_bf16 v[156:159], a[108:111], a[252:255], v[156:159]
 buffer_load_dwordx4 v14, s[8:11], s33 offen offset:2048 lds
 v_mfma_f32_16x16x32_bf16 v[152:155], a[104:107], a[232:235], v[152:155]
 ds_read_b64_tr_b16 a[98:99], v42 offset:49664
 v_mfma_f32_16x16x32_bf16 v[152:155], a[108:111], a[248:251], v[152:155]
 v_mfma_f32_16x16x32_bf16 v[148:151], a[104:107], a[228:231], v[148:151]
 ds_read_b64_tr_b16 a[100:101], v42 offset:53248
 v_mfma_f32_16x16x32_bf16 v[148:151], a[108:111], a[244:247], v[148:151]
 buffer_load_dwordx4 v15, s[8:11], s33 offen offset:3072 lds
 v_mfma_f32_16x16x32_bf16 v[144:147], a[104:107], a[224:227], v[144:147]
 ds_read_b64_tr_b16 a[102:103], v42 offset:53760
 v_mfma_f32_16x16x32_bf16 v[144:147], a[108:111], a[240:243], v[144:147]
 s_waitcnt lgkmcnt(8)
 v_mfma_f32_16x16x32_bf16 v[160:163], a[112:115], a[224:227], v[160:163]
 ds_read_b64_tr_b16 a[104:105], v43 offset:49152
 v_mfma_f32_16x16x32_bf16 v[160:163], a[116:119], a[240:243], v[160:163]
 v_mfma_f32_16x16x32_bf16 v[164:167], a[112:115], a[228:231], v[164:167]
 ds_read_b64_tr_b16 a[106:107], v43 offset:49664
 v_mfma_f32_16x16x32_bf16 v[164:167], a[116:119], a[244:247], v[164:167]
 s_add_u32 m0, s41, 0x10000
 s_xor_b32 s34, s3, 0x180000
 v_mfma_f32_16x16x32_bf16 v[168:171], a[112:115], a[232:235], v[168:171]
 ds_read_b64_tr_b16 a[108:109], v43 offset:53248
 v_mfma_f32_16x16x32_bf16 v[168:171], a[116:119], a[248:251], v[168:171]
 buffer_load_dwordx4 v16, s[12:15], s34 offen offset:0 nt lds
 v_mfma_f32_16x16x32_bf16 v[172:175], a[112:115], a[236:239], v[172:175]
 ds_read_b64_tr_b16 a[110:111], v43 offset:53760
 v_mfma_f32_16x16x32_bf16 v[172:175], a[116:119], a[252:255], v[172:175]
 s_waitcnt lgkmcnt(8)
 v_mfma_f32_16x16x32_bf16 v[188:191], a[120:123], a[236:239], v[188:191]
 ds_read_b64_tr_b16 a[112:113], v44 offset:49152
 v_mfma_f32_16x16x32_bf16 v[188:191], a[124:127], a[252:255], v[188:191]
 buffer_load_dwordx4 v17, s[12:15], s34 offen offset:1024 nt lds
 v_mfma_f32_16x16x32_bf16 v[184:187], a[120:123], a[232:235], v[184:187]
 ds_read_b64_tr_b16 a[114:115], v44 offset:49664
 v_mfma_f32_16x16x32_bf16 v[184:187], a[124:127], a[248:251], v[184:187]
 v_mfma_f32_16x16x32_bf16 v[180:183], a[120:123], a[228:231], v[180:183]
 ds_read_b64_tr_b16 a[116:117], v44 offset:53248
 v_mfma_f32_16x16x32_bf16 v[180:183], a[124:127], a[244:247], v[180:183]
 v_mfma_f32_16x16x32_bf16 v[176:179], a[120:123], a[224:227], v[176:179]
 ds_read_b64_tr_b16 a[118:119], v44 offset:53760
 v_mfma_f32_16x16x32_bf16 v[176:179], a[124:127], a[240:243], v[176:179]
 s_waitcnt lgkmcnt(8)
 v_mfma_f32_16x16x32_bf16 v[192:195], a[224:227], a[96:99], v[192:195]
 ds_read_b64_tr_b16 a[120:121], v45 offset:49152
 v_mfma_f32_16x16x32_bf16 v[192:195], a[240:243], a[100:103], v[192:195]
 buffer_load_dwordx4 v18, s[12:15], s34 offen offset:2048 nt lds
 v_mfma_f32_16x16x32_bf16 v[196:199], a[228:231], a[96:99], v[196:199]
 ds_read_b64_tr_b16 a[122:123], v45 offset:49664
 v_mfma_f32_16x16x32_bf16 v[196:199], a[244:247], a[100:103], v[196:199]
 v_mfma_f32_16x16x32_bf16 v[200:203], a[232:235], a[96:99], v[200:203]
 ds_read_b64_tr_b16 a[124:125], v45 offset:53248
 v_mfma_f32_16x16x32_bf16 v[200:203], a[248:251], a[100:103], v[200:203]
 buffer_load_dwordx4 v19, s[12:15], s34 offen offset:3072 nt lds
 v_mfma_f32_16x16x32_bf16 v[204:207], a[236:239], a[96:99], v[204:207]
 ds_read_b64_tr_b16 a[126:127], v45 offset:53760
 v_mfma_f32_16x16x32_bf16 v[204:207], a[252:255], a[100:103], v[204:207]
 s_waitcnt lgkmcnt(8)
 v_mfma_f32_16x16x32_bf16 v[220:223], a[236:239], a[104:107], v[220:223]
 ds_read_b64_tr_b16 a[96:97], v42 offset:57344
 v_mfma_f32_16x16x32_bf16 v[220:223], a[252:255], a[108:111], v[220:223]
 v_mfma_f32_16x16x32_bf16 v[216:219], a[232:235], a[104:107], v[216:219]
 ds_read_b64_tr_b16 a[98:99], v42 offset:57856
 v_mfma_f32_16x16x32_bf16 v[216:219], a[248:251], a[108:111], v[216:219]
 s_add_u32 m0, s42, 0x10000
 v_mfma_f32_16x16x32_bf16 v[212:215], a[228:231], a[104:107], v[212:215]
 ds_read_b64_tr_b16 a[100:101], v42 offset:61440
 v_mfma_f32_16x16x32_bf16 v[212:215], a[244:247], a[108:111], v[212:215]
 buffer_load_dwordx4 v20, s[12:15], s34 offen offset:0 nt lds
 v_mfma_f32_16x16x32_bf16 v[208:211], a[224:227], a[104:107], v[208:211]
 ds_read_b64_tr_b16 a[102:103], v42 offset:61952
 v_mfma_f32_16x16x32_bf16 v[208:211], a[240:243], a[108:111], v[208:211]
 s_waitcnt lgkmcnt(8)
 v_mfma_f32_16x16x32_bf16 v[224:227], a[224:227], a[112:115], v[224:227]
 ds_read_b64_tr_b16 a[104:105], v43 offset:57344
 v_mfma_f32_16x16x32_bf16 v[224:227], a[240:243], a[116:119], v[224:227]
 buffer_load_dwordx4 v21, s[12:15], s34 offen offset:1024 nt lds
 v_mfma_f32_16x16x32_bf16 v[228:231], a[228:231], a[112:115], v[228:231]
 ds_read_b64_tr_b16 a[106:107], v43 offset:57856
 v_mfma_f32_16x16x32_bf16 v[228:231], a[244:247], a[116:119], v[228:231]
 v_mfma_f32_16x16x32_bf16 v[232:235], a[232:235], a[112:115], v[232:235]
 ds_read_b64_tr_b16 a[108:109], v43 offset:61440
 v_mfma_f32_16x16x32_bf16 v[232:235], a[248:251], a[116:119], v[232:235]
 v_mfma_f32_16x16x32_bf16 v[236:239], a[236:239], a[112:115], v[236:239]
 ds_read_b64_tr_b16 a[110:111], v43 offset:61952
 v_mfma_f32_16x16x32_bf16 v[236:239], a[252:255], a[116:119], v[236:239]
 s_waitcnt lgkmcnt(8)
 v_mfma_f32_16x16x32_bf16 v[252:255], a[236:239], a[120:123], v[252:255]
 ds_read_b64_tr_b16 a[112:113], v44 offset:57344
 v_mfma_f32_16x16x32_bf16 v[252:255], a[252:255], a[124:127], v[252:255]
 buffer_load_dwordx4 v22, s[12:15], s34 offen offset:2048 nt lds
 v_mfma_f32_16x16x32_bf16 v[248:251], a[232:235], a[120:123], v[248:251]
 ds_read_b64_tr_b16 a[114:115], v44 offset:57856
 v_mfma_f32_16x16x32_bf16 v[248:251], a[248:251], a[124:127], v[248:251]
 v_mfma_f32_16x16x32_bf16 v[244:247], a[228:231], a[120:123], v[244:247]
 ds_read_b64_tr_b16 a[116:117], v44 offset:61440
 v_mfma_f32_16x16x32_bf16 v[244:247], a[244:247], a[124:127], v[244:247]
 buffer_load_dwordx4 v23, s[12:15], s34 offen offset:3072 nt lds
 v_mfma_f32_16x16x32_bf16 v[240:243], a[224:227], a[120:123], v[240:243]
 ds_read_b64_tr_b16 a[118:119], v44 offset:61952
 v_mfma_f32_16x16x32_bf16 v[240:243], a[240:243], a[124:127], v[240:243]
 s_waitcnt lgkmcnt(8)
 v_mfma_f32_16x16x32_bf16 a[0:3], a[224:227], a[96:99], a[0:3]
 ds_read_b64_tr_b16 a[120:121], v45 offset:57344
 v_mfma_f32_16x16x32_bf16 a[0:3], a[240:243], a[100:103], a[0:3]
 v_mfma_f32_16x16x32_bf16 a[4:7], a[228:231], a[96:99], a[4:7]
 ds_read_b64_tr_b16 a[122:123], v45 offset:57856
 v_mfma_f32_16x16x32_bf16 a[4:7], a[244:247], a[100:103], a[4:7]
 v_mfma_f32_16x16x32_bf16 a[8:11], a[232:235], a[96:99], a[8:11]
 ds_read_b64_tr_b16 a[124:125], v45 offset:61440
 v_mfma_f32_16x16x32_bf16 a[8:11], a[248:251], a[100:103], a[8:11]
 v_mfma_f32_16x16x32_bf16 a[12:15], a[236:239], a[96:99], a[12:15]
 ds_read_b64_tr_b16 a[126:127], v45 offset:61952
 v_mfma_f32_16x16x32_bf16 a[12:15], a[252:255], a[100:103], a[12:15]
 s_waitcnt lgkmcnt(8)
 v_mfma_f32_16x16x32_bf16 a[28:31], a[236:239], a[104:107], a[28:31]
 buffer_load_dword v62, off, s[36:39], 0 sc1
 v_mfma_f32_16x16x32_bf16 a[28:31], a[252:255], a[108:111], a[28:31]
 v_mfma_f32_16x16x32_bf16 a[24:27], a[232:235], a[104:107], a[24:27]
 v_mfma_f32_16x16x32_bf16 a[24:27], a[248:251], a[108:111], a[24:27]
 s_waitcnt lgkmcnt(0) vmcnt(17)
 s_barrier
 v_mfma_f32_16x16x32_bf16 a[20:23], a[228:231], a[104:107], a[20:23]
 ds_read_b64_tr_b16 a[96:97], v48 offset:0
 v_mfma_f32_16x16x32_bf16 a[20:23], a[244:247], a[108:111], a[20:23]
 ds_read_b64_tr_b16 a[98:99], v48 offset:512
 v_mfma_f32_16x16x32_bf16 a[16:19], a[224:227], a[104:107], a[16:19]
 ds_read_b64_tr_b16 a[100:101], v48 offset:4096
 v_mfma_f32_16x16x32_bf16 a[16:19], a[240:243], a[108:111], a[16:19]
 ds_read_b64_tr_b16 a[102:103], v48 offset:4608
 v_mfma_f32_16x16x32_bf16 a[32:35], a[224:227], a[112:115], a[32:35]
 ds_read_b128 a[64:67], v40 offset:0
 v_mfma_f32_16x16x32_bf16 a[32:35], a[240:243], a[116:119], a[32:35]
 ds_read_b128 a[80:83], v41 offset:0
 v_mfma_f32_16x16x32_bf16 a[36:39], a[228:231], a[112:115], a[36:39]
 ds_read_b128 a[68:71], v40 offset:2048
 v_mfma_f32_16x16x32_bf16 a[36:39], a[244:247], a[116:119], a[36:39]
 ds_read_b128 a[84:87], v41 offset:2048
 v_mfma_f32_16x16x32_bf16 a[40:43], a[232:235], a[112:115], a[40:43]
 ds_read_b128 a[72:75], v40 offset:4096
 v_mfma_f32_16x16x32_bf16 a[40:43], a[248:251], a[116:119], a[40:43]
 ds_read_b128 a[88:91], v41 offset:4096
 v_mfma_f32_16x16x32_bf16 a[44:47], a[236:239], a[112:115], a[44:47]
 ds_read_b128 a[76:79], v40 offset:6144
 v_mfma_f32_16x16x32_bf16 a[44:47], a[252:255], a[116:119], a[44:47]
 ds_read_b128 a[92:95], v41 offset:6144
 v_mfma_f32_16x16x32_bf16 a[60:63], a[236:239], a[120:123], a[60:63]
 ds_read_b64_tr_b16 a[104:105], v49 offset:0
 v_mfma_f32_16x16x32_bf16 a[60:63], a[252:255], a[124:127], a[60:63]
 ds_read_b64_tr_b16 a[106:107], v49 offset:512
 v_mfma_f32_16x16x32_bf16 a[56:59], a[232:235], a[120:123], a[56:59]
 ds_read_b64_tr_b16 a[108:109], v49 offset:4096
 v_mfma_f32_16x16x32_bf16 a[56:59], a[248:251], a[124:127], a[56:59]
 ds_read_b64_tr_b16 a[110:111], v49 offset:4608
 v_mfma_f32_16x16x32_bf16 a[52:55], a[228:231], a[120:123], a[52:55]
 ds_read_b64_tr_b16 a[112:113], v50 offset:0
 v_mfma_f32_16x16x32_bf16 a[52:55], a[244:247], a[124:127], a[52:55]
 ds_read_b64_tr_b16 a[114:115], v50 offset:512
 v_mfma_f32_16x16x32_bf16 a[48:51], a[224:227], a[120:123], a[48:51]
 ds_read_b64_tr_b16 a[116:117], v50 offset:4096
 v_mfma_f32_16x16x32_bf16 a[48:51], a[240:243], a[124:127], a[48:51]
 ds_read_b64_tr_b16 a[118:119], v50 offset:4608
F_step2:
 s_waitcnt lgkmcnt(8)
 v_mfma_f32_16x16x32_bf16 v[64:67], a[96:99], a[64:67], v[64:67]
 ds_read_b64_tr_b16 a[120:121], v51 offset:0
 v_mfma_f32_16x16x32_bf16 v[64:67], a[100:103], a[80:83], v[64:67]
 v_mfma_f32_16x16x32_bf16 v[68:71], a[96:99], a[68:71], v[68:71]
 ds_read_b64_tr_b16 a[122:123], v51 offset:512
 v_mfma_f32_16x16x32_bf16 v[68:71], a[100:103], a[84:87], v[68:71]
 s_add_u32 m0, s46, 0
 s_xor_b32 s33, s94, 512
 v_mfma_f32_16x16x32_bf16 v[72:75], a[96:99], a[72:75], v[72:75]
 ds_read_b64_tr_b16 a[124:125], v51 offset:4096
 v_mfma_f32_16x16x32_bf16 v[72:75], a[100:103], a[88:91], v[72:75]
 buffer_load_dwordx4 v8, s[8:11], s33 offen offset:0 lds
 v_mfma_f32_16x16x32_bf16 v[76:79], a[96:99], a[76:79], v[76:79]
 ds_read_b64_tr_b16 a[126:127], v51 offset:4608
 v_mfma_f32_16x16x32_bf16 v[76:79], a[100:103], a[92:95], v[76:79]
 s_waitcnt lgkmcnt(8)
 v_mfma_f32_16x16x32_bf16 v[92:95], a[104:107], a[76:79], v[92:95]
 ds_read_b64_tr_b16 a[96:97], v48 offset:8192
 v_mfma_f32_16x16x32_bf16 v[92:95], a[108:111], a[92:95], v[92:95]
 buffer_load_dwordx4 v9, s[8:11], s33 offen offset:1024 lds
 v_mfma_f32_16x16x32_bf16 v[88:91], a[104:107], a[72:75], v[88:91]
 ds_read_b64_tr_b16 a[98:99], v48 offset:8704
 v_mfma_f32_16x16x32_bf16 v[88:91], a[108:111], a[88:91], v[88:91]
 buffer_load_ushort a152, v59, s[72:75], s79 offen offset:0
 v_mfma_f32_16x16x32_bf16 v[84:87], a[104:107], a[68:71], v[84:87]
 ds_read_b64_tr_b16 a[100:101], v48 offset:12288
 v_mfma_f32_16x16x32_bf16 v[84:87], a[108:111], a[84:87], v[84:87]
 buffer_load_ushort a153, v59, s[72:75], s79 offen offset:64
 v_mfma_f32_16x16x32_bf16 v[80:83], a[104:107], a[64:67], v[80:83]
 ds_read_b64_tr_b16 a[102:103], v48 offset:12800
 v_mfma_f32_16x16x32_bf16 v[80:83], a[108:111], a[80:83], v[80:83]
 s_waitcnt lgkmcnt(8)
 v_mfma_f32_16x16x32_bf16 v[96:99], a[112:115], a[64:67], v[96:99]
 ds_read_b64_tr_b16 a[104:105], v49 offset:8192
 v_mfma_f32_16x16x32_bf16 v[96:99], a[116:119], a[80:83], v[96:99]
 buffer_load_dwordx4 v10, s[8:11], s33 offen offset:2048 lds
 v_mfma_f32_16x16x32_bf16 v[100:103], a[112:115], a[68:71], v[100:103]
 ds_read_b64_tr_b16 a[106:107], v49 offset:8704
 v_mfma_f32_16x16x32_bf16 v[100:103], a[116:119], a[84:87], v[100:103]
 buffer_load_ushort a154, v59, s[72:75], s79 offen offset:128
 v_mfma_f32_16x16x32_bf16 v[104:107], a[112:115], a[72:75], v[104:107]
 ds_read_b64_tr_b16 a[108:109], v49 offset:12288
 v_mfma_f32_16x16x32_bf16 v[104:107], a[116:119], a[88:91], v[104:107]
 buffer_load_dwordx4 v11, s[8:11], s33 offen offset:3072 lds
 v_mfma_f32_16x16x32_bf16 v[108:111], a[112:115], a[76:79], v[108:111]
 ds_read_b64_tr_b16 a[110:111], v49 offset:12800
 v_mfma_f32_16x16x32_bf16 v[108:111], a[116:119], a[92:95], v[108:111]
 s_waitcnt lgkmcnt(8)
 v_mfma_f32_16x16x32_bf16 v[124:127], a[120:123], a[76:79], v[124:127]
 ds_read_b64_tr_b16 a[112:113], v50 offset:8192
 v_mfma_f32_16x16x32_bf16 v[124:127], a[124:127], a[92:95], v[124:127]
 buffer_load_ushort a155, v59, s[72:75], s79 offen offset:192
 v_mfma_f32_16x16x32_bf16 v[120:123], a[120:123], a[72:75], v[120:123]
 ds_read_b64_tr_b16 a[114:115], v50 offset:8704
 s_add_u32 m0, s46, 4096
 v_mfma_f32_16x16x32_bf16 v[120:123], a[124:127], a[88:91], v[120:123]
 buffer_load_dwordx4 v12, s[8:11], s33 offen offset:0 lds
 v_mfma_f32_16x16x32_bf16 v[116:119], a[120:123], a[68:71], v[116:119]
 ds_read_b64_tr_b16 a[116:117], v50 offset:12288
 v_mfma_f32_16x16x32_bf16 v[116:119], a[124:127], a[84:87], v[116:119]
 v_mfma_f32_16x16x32_bf16 v[112:115], a[120:123], a[64:67], v[112:115]
 ds_read_b64_tr_b16 a[118:119], v50 offset:12800
 v_mfma_f32_16x16x32_bf16 v[112:115], a[124:127], a[80:83], v[112:115]
 s_waitcnt lgkmcnt(8)
 v_mfma_f32_16x16x32_bf16 v[128:131], a[96:99], a[64:67], v[128:131]
 ds_read_b64_tr_b16 a[120:121], v51 offset:8192
 v_mfma_f32_16x16x32_bf16 v[128:131], a[100:103], a[80:83], v[128:131]
 buffer_load_dwordx4 v13, s[8:11], s33 offen offset:1024 lds
 v_mfma_f32_16x16x32_bf16 v[132:135], a[96:99], a[68:71], v[132:135]
 ds_read_b64_tr_b16 a[122:123], v51 offset:8704
 v_mfma_f32_16x16x32_bf16 v[132:135], a[100:103], a[84:87], v[132:135]
 buffer_load_ushort a156, v59, s[72:75], s79 offen offset:512
 v_mfma_f32_16x16x32_bf16 v[136:139], a[96:99], a[72:75], v[136:139]
 ds_read_b64_tr_b16 a[124:125], v51 offset:12288
 v_mfma_f32_16x16x32_bf16 v[136:139], a[100:103], a[88:91], v[136:139]
 buffer_load_dwordx4 v14, s[8:11], s33 offen offset:2048 lds
 v_mfma_f32_16x16x32_bf16 v[140:143], a[96:99], a[76:79], v[140:143]
 ds_read_b64_tr_b16 a[126:127], v51 offset:12800
 v_mfma_f32_16x16x32_bf16 v[140:143], a[100:103], a[92:95], v[140:143]
 s_waitcnt lgkmcnt(8)
 v_mfma_f32_16x16x32_bf16 v[156:159], a[104:107], a[76:79], v[156:159]
 ds_read_b64_tr_b16 a[96:97], v48 offset:16384
 v_mfma_f32_16x16x32_bf16 v[156:159], a[108:111], a[92:95], v[156:159]
 buffer_load_ushort a157, v59, s[72:75], s79 offen offset:576
 v_mfma_f32_16x16x32_bf16 v[152:155], a[104:107], a[72:75], v[152:155]
 ds_read_b64_tr_b16 a[98:99], v48 offset:16896
 v_mfma_f32_16x16x32_bf16 v[152:155], a[108:111], a[88:91], v[152:155]
 buffer_load_dwordx4 v15, s[8:11], s33 offen offset:3072 lds
 v_mfma_f32_16x16x32_bf16 v[148:151], a[104:107], a[68:71], v[148:151]
 ds_read_b64_tr_b16 a[100:101], v48 offset:20480
 v_mfma_f32_16x16x32_bf16 v[148:151], a[108:111], a[84:87], v[148:151]
 buffer_load_ushort a158, v59, s[72:75], s79 offen offset:640
 v_mfma_f32_16x16x32_bf16 v[144:147], a[104:107], a[64:67], v[144:147]
 ds_read_b64_tr_b16 a[102:103], v48 offset:20992
 v_mfma_f32_16x16x32_bf16 v[144:147], a[108:111], a[80:83], v[144:147]
 s_waitcnt lgkmcnt(8)
 v_mfma_f32_16x16x32_bf16 v[160:163], a[112:115], a[64:67], v[160:163]
 ds_read_b64_tr_b16 a[104:105], v49 offset:16384
 v_mfma_f32_16x16x32_bf16 v[160:163], a[116:119], a[80:83], v[160:163]
 s_add_u32 m0, s41, 0x18000
 s_xor_b32 s34, s3, 0x200000
 v_mfma_f32_16x16x32_bf16 v[164:167], a[112:115], a[68:71], v[164:167]
 ds_read_b64_tr_b16 a[106:107], v49 offset:16896
 v_mfma_f32_16x16x32_bf16 v[164:167], a[116:119], a[84:87], v[164:167]
 buffer_load_dwordx4 v16, s[12:15], s34 offen offset:0 nt lds
 v_mfma_f32_16x16x32_bf16 v[168:171], a[112:115], a[72:75], v[168:171]
 ds_read_b64_tr_b16 a[108:109], v49 offset:20480
 v_mfma_f32_16x16x32_bf16 v[168:171], a[116:119], a[88:91], v[168:171]
 buffer_load_ushort a159, v59, s[72:75], s79 offen offset:704
 v_mfma_f32_16x16x32_bf16 v[172:175], a[112:115], a[76:79], v[172:175]
 ds_read_b64_tr_b16 a[110:111], v49 offset:20992
 v_mfma_f32_16x16x32_bf16 v[172:175], a[116:119], a[92:95], v[172:175]
 s_waitcnt lgkmcnt(8)
 v_mfma_f32_16x16x32_bf16 v[188:191], a[120:123], a[76:79], v[188:191]
 ds_read_b64_tr_b16 a[112:113], v50 offset:16384
 v_mfma_f32_16x16x32_bf16 v[188:191], a[124:127], a[92:95], v[188:191]
 buffer_load_dwordx4 v17, s[12:15], s34 offen offset:1024 nt lds
 v_mfma_f32_16x16x32_bf16 v[184:187], a[120:123], a[72:75], v[184:187]
 ds_read_b64_tr_b16 a[114:115], v50 offset:16896
 v_mfma_f32_16x16x32_bf16 v[184:187], a[124:127], a[88:91], v[184:187]
 buffer_load_ushort a160, v59, s[72:75], s79 offen offset:32
 v_mfma_f32_16x16x32_bf16 v[180:183], a[120:123], a[68:71], v[180:183]
 ds_read_b64_tr_b16 a[116:117], v50 offset:20480
 v_mfma_f32_16x16x32_bf16 v[180:183], a[124:127], a[84:87], v[180:183]
 buffer_load_dwordx4 v18, s[12:15], s34 offen offset:2048 nt lds
 v_mfma_f32_16x16x32_bf16 v[176:179], a[120:123], a[64:67], v[176:179]
 ds_read_b64_tr_b16 a[118:119], v50 offset:20992
 v_mfma_f32_16x16x32_bf16 v[176:179], a[124:127], a[80:83], v[176:179]
 s_waitcnt lgkmcnt(8)
 v_mfma_f32_16x16x32_bf16 v[192:195], a[64:67], a[96:99], v[192:195]
 ds_read_b64_tr_b16 a[120:121], v51 offset:16384
 v_mfma_f32_16x16x32_bf16 v[192:195], a[80:83], a[100:103], v[192:195]
 buffer_load_ushort a161, v59, s[72:75], s79 offen offset:96
 v_mfma_f32_16x16x32_bf16 v[196:199], a[68:71], a[96:99], v[196:199]
 ds_read_b64_tr_b16 a[122:123], v51 offset:16896
 v_mfma_f32_16x16x32_bf16 v[196:199], a[84:87], a[100:103], v[196:199]
 buffer_load_dwordx4 v19, s[12:15], s34 offen offset:3072 nt lds
 v_mfma_f32_16x16x32_bf16 v[200:203], a[72:75], a[96:99], v[200:203]
 ds_read_b64_tr_b16 a[124:125], v51 offset:20480
 v_mfma_f32_16x16x32_bf16 v[200:203], a[88:91], a[100:103], v[200:203]
 buffer_load_ushort a162, v59, s[72:75], s79 offen offset:160
 v_mfma_f32_16x16x32_bf16 v[204:207], a[76:79], a[96:99], v[204:207]
 ds_read_b64_tr_b16 a[126:127], v51 offset:20992
 v_mfma_f32_16x16x32_bf16 v[204:207], a[92:95], a[100:103], v[204:207]
 s_waitcnt lgkmcnt(8)
 v_mfma_f32_16x16x32_bf16 v[220:223], a[76:79], a[104:107], v[220:223]
 ds_read_b64_tr_b16 a[96:97], v48 offset:24576
 s_add_u32 m0, s42, 0x18000
 v_mfma_f32_16x16x32_bf16 v[220:223], a[92:95], a[108:111], v[220:223]
 buffer_load_dwordx4 v20, s[12:15], s34 offen offset:0 nt lds
 v_mfma_f32_16x16x32_bf16 v[216:219], a[72:75], a[104:107], v[216:219]
 ds_read_b64_tr_b16 a[98:99], v48 offset:25088
 v_mfma_f32_16x16x32_bf16 v[216:219], a[88:91], a[108:111], v[216:219]
 buffer_load_ushort a163, v59, s[72:75], s79 offen offset:224
 v_mfma_f32_16x16x32_bf16 v[212:215], a[68:71], a[104:107], v[212:215]
 ds_read_b64_tr_b16 a[100:101], v48 offset:28672
 v_mfma_f32_16x16x32_bf16 v[212:215], a[84:87], a[108:111], v[212:215]
 v_mfma_f32_16x16x32_bf16 v[208:211], a[64:67], a[104:107], v[208:211]
 ds_read_b64_tr_b16 a[102:103], v48 offset:29184
 v_mfma_f32_16x16x32_bf16 v[208:211], a[80:83], a[108:111], v[208:211]
 s_waitcnt lgkmcnt(8)
 v_mfma_f32_16x16x32_bf16 v[224:227], a[64:67], a[112:115], v[224:227]
 ds_read_b64_tr_b16 a[104:105], v49 offset:24576
 v_mfma_f32_16x16x32_bf16 v[224:227], a[80:83], a[116:119], v[224:227]
 buffer_load_dwordx4 v21, s[12:15], s34 offen offset:1024 nt lds
 v_mfma_f32_16x16x32_bf16 v[228:231], a[68:71], a[112:115], v[228:231]
 ds_read_b64_tr_b16 a[106:107], v49 offset:25088
 v_mfma_f32_16x16x32_bf16 v[228:231], a[84:87], a[116:119], v[228:231]
 buffer_load_ushort a164, v59, s[72:75], s79 offen offset:544
 v_mfma_f32_16x16x32_bf16 v[232:235], a[72:75], a[112:115], v[232:235]
 ds_read_b64_tr_b16 a[108:109], v49 offset:28672
 v_mfma_f32_16x16x32_bf16 v[232:235], a[88:91], a[116:119], v[232:235]
 buffer_load_dwordx4 v22, s[12:15], s34 offen offset:2048 nt lds
 v_mfma_f32_16x16x32_bf16 v[236:239], a[76:79], a[112:115], v[236:239]
 ds_read_b64_tr_b16 a[110:111], v49 offset:29184
 v_mfma_f32_16x16x32_bf16 v[236:239], a[92:95], a[116:119], v[236:239]
 s_waitcnt lgkmcnt(8)
 v_mfma_f32_16x16x32_bf16 v[252:255], a[76:79], a[120:123], v[252:255]
 ds_read_b64_tr_b16 a[112:113], v50 offset:24576
 v_mfma_f32_16x16x32_bf16 v[252:255], a[92:95], a[124:127], v[252:255]
 buffer_load_ushort a165, v59, s[72:75], s79 offen offset:608
 v_mfma_f32_16x16x32_bf16 v[248:251], a[72:75], a[120:123], v[248:251]
 ds_read_b64_tr_b16 a[114:115], v50 offset:25088
 v_mfma_f32_16x16x32_bf16 v[248:251], a[88:91], a[124:127], v[248:251]
 buffer_load_dwordx4 v23, s[12:15], s34 offen offset:3072 nt lds
 v_mfma_f32_16x16x32_bf16 v[244:247], a[68:71], a[120:123], v[244:247]
 ds_read_b64_tr_b16 a[116:117], v50 offset:28672
 v_mfma_f32_16x16x32_bf16 v[244:247], a[84:87], a[124:127], v[244:247]
 buffer_load_ushort a166, v59, s[72:75], s79 offen offset:672
 v_mfma_f32_16x16x32_bf16 v[240:243], a[64:67], a[120:123], v[240:243]
 ds_read_b64_tr_b16 a[118:119], v50 offset:29184
 v_mfma_f32_16x16x32_bf16 v[240:243], a[80:83], a[124:127], v[240:243]
 s_waitcnt lgkmcnt(8)
 v_mfma_f32_16x16x32_bf16 a[0:3], a[64:67], a[96:99], a[0:3]
 ds_read_b64_tr_b16 a[120:121], v51 offset:24576
 v_mfma_f32_16x16x32_bf16 a[0:3], a[80:83], a[100:103], a[0:3]
 v_mfma_f32_16x16x32_bf16 a[4:7], a[68:71], a[96:99], a[4:7]
 ds_read_b64_tr_b16 a[122:123], v51 offset:25088
 s_mov_b32 s66, 0x0
 v_mfma_f32_16x16x32_bf16 a[4:7], a[84:87], a[100:103], a[4:7]
 buffer_load_dword v60, v54, s[16:19], s66 offen
 v_mfma_f32_16x16x32_bf16 a[8:11], a[72:75], a[96:99], a[8:11]
 ds_read_b64_tr_b16 a[124:125], v51 offset:28672
 v_mfma_f32_16x16x32_bf16 a[8:11], a[88:91], a[100:103], a[8:11]
 buffer_load_ushort a167, v59, s[72:75], s79 offen offset:736
 v_mfma_f32_16x16x32_bf16 a[12:15], a[76:79], a[96:99], a[12:15]
 ds_read_b64_tr_b16 a[126:127], v51 offset:29184
 s_mov_b32 s67, 0x0
 v_mfma_f32_16x16x32_bf16 a[12:15], a[92:95], a[100:103], a[12:15]
 s_waitcnt lgkmcnt(8)
 v_mfma_f32_16x16x32_bf16 a[28:31], a[76:79], a[104:107], a[28:31]
 buffer_load_dword v60, v55, s[24:27], s67 offen
 v_mfma_f32_16x16x32_bf16 a[28:31], a[92:95], a[108:111], a[28:31]
 v_mfma_f32_16x16x32_bf16 a[24:27], a[72:75], a[104:107], a[24:27]
 v_mfma_f32_16x16x32_bf16 a[24:27], a[88:91], a[108:111], a[24:27]
 s_waitcnt lgkmcnt(0) vmcnt(35)
 s_barrier
 v_mfma_f32_16x16x32_bf16 a[20:23], a[68:71], a[104:107], a[20:23]
 ds_read_b64_tr_b16 a[96:97], v42 offset:0
 v_mfma_f32_16x16x32_bf16 a[20:23], a[84:87], a[108:111], a[20:23]
 ds_read_b64_tr_b16 a[98:99], v42 offset:512
 v_mfma_f32_16x16x32_bf16 a[16:19], a[64:67], a[104:107], a[16:19]
 ds_read_b64_tr_b16 a[100:101], v42 offset:4096
 v_mfma_f32_16x16x32_bf16 a[16:19], a[80:83], a[108:111], a[16:19]
 ds_read_b64_tr_b16 a[102:103], v42 offset:4608
 v_mfma_f32_16x16x32_bf16 a[32:35], a[64:67], a[112:115], a[32:35]
 ds_read_b128 a[224:227], v40 offset:8192
 v_mfma_f32_16x16x32_bf16 a[32:35], a[80:83], a[116:119], a[32:35]
 ds_read_b128 a[240:243], v41 offset:8192
 v_mfma_f32_16x16x32_bf16 a[36:39], a[68:71], a[112:115], a[36:39]
 ds_read_b128 a[228:231], v40 offset:10240
 v_mfma_f32_16x16x32_bf16 a[36:39], a[84:87], a[116:119], a[36:39]
 ds_read_b128 a[244:247], v41 offset:10240
 v_mfma_f32_16x16x32_bf16 a[40:43], a[72:75], a[112:115], a[40:43]
 ds_read_b128 a[232:235], v40 offset:12288
 v_mfma_f32_16x16x32_bf16 a[40:43], a[88:91], a[116:119], a[40:43]
 ds_read_b128 a[248:251], v41 offset:12288
 v_mfma_f32_16x16x32_bf16 a[44:47], a[76:79], a[112:115], a[44:47]
 ds_read_b128 a[236:239], v40 offset:14336
 v_mfma_f32_16x16x32_bf16 a[44:47], a[92:95], a[116:119], a[44:47]
 ds_read_b128 a[252:255], v41 offset:14336
 v_mfma_f32_16x16x32_bf16 a[60:63], a[76:79], a[120:123], a[60:63]
 ds_read_b64_tr_b16 a[104:105], v43 offset:0
 v_mfma_f32_16x16x32_bf16 a[60:63], a[92:95], a[124:127], a[60:63]
 ds_read_b64_tr_b16 a[106:107], v43 offset:512
 v_mfma_f32_16x16x32_bf16 a[56:59], a[72:75], a[120:123], a[56:59]
 ds_read_b64_tr_b16 a[108:109], v43 offset:4096
 v_mfma_f32_16x16x32_bf16 a[56:59], a[88:91], a[124:127], a[56:59]
 ds_read_b64_tr_b16 a[110:111], v43 offset:4608
 v_mfma_f32_16x16x32_bf16 a[52:55], a[68:71], a[120:123], a[52:55]
 ds_read_b64_tr_b16 a[112:113], v44 offset:0
 v_mfma_f32_16x16x32_bf16 a[52:55], a[84:87], a[124:127], a[52:55]
 ds_read_b64_tr_b16 a[114:115], v44 offset:512
 v_mfma_f32_16x16x32_bf16 a[48:51], a[64:67], a[120:123], a[48:51]
 ds_read_b64_tr_b16 a[116:117], v44 offset:4096
 v_mfma_f32_16x16x32_bf16 a[48:51], a[80:83], a[124:127], a[48:51]
 ds_read_b64_tr_b16 a[118:119], v44 offset:4608
F_step3:
 s_waitcnt lgkmcnt(8)
 v_mfma_f32_16x16x32_bf16 v[64:67], a[96:99], a[224:227], v[64:67]
 ds_read_b64_tr_b16 a[120:121], v45 offset:0
 v_mfma_f32_16x16x32_bf16 v[64:67], a[100:103], a[240:243], v[64:67]
 v_mfma_f32_16x16x32_bf16 v[68:71], a[96:99], a[228:231], v[68:71]
 ds_read_b64_tr_b16 a[122:123], v45 offset:512
 v_mfma_f32_16x16x32_bf16 v[68:71], a[100:103], a[244:247], v[68:71]
 s_add_u32 m0, s46, 8192
 s_xor_b32 s33, s94, 640
 v_mfma_f32_16x16x32_bf16 v[72:75], a[96:99], a[232:235], v[72:75]
 ds_read_b64_tr_b16 a[124:125], v45 offset:4096
 v_mfma_f32_16x16x32_bf16 v[72:75], a[100:103], a[248:251], v[72:75]
 buffer_load_dwordx4 v8, s[8:11], s33 offen offset:0 lds
 v_mfma_f32_16x16x32_bf16 v[76:79], a[96:99], a[236:239], v[76:79]
 ds_read_b64_tr_b16 a[126:127], v45 offset:4608
 v_mfma_f32_16x16x32_bf16 v[76:79], a[100:103], a[252:255], v[76:79]
 s_waitcnt lgkmcnt(8)
 v_mfma_f32_16x16x32_bf16 v[92:95], a[104:107], a[236:239], v[92:95]
 ds_read_b64_tr_b16 a[96:97], v42 offset:8192
 v_mfma_f32_16x16x32_bf16 v[92:95], a[108:111], a[252:255], v[92:95]
 buffer_load_dwordx4 v9, s[8:11], s33 offen offset:1024 lds
 v_mfma_f32_16x16x32_bf16 v[88:91], a[104:107], a[232:235], v[88:91]
 ds_read_b64_tr_b16 a[98:99], v42 offset:8704
 v_mfma_f32_16x16x32_bf16 v[88:91], a[108:111], a[248:251], v[88:91]
 v_mfma_f32_16x16x32_bf16 v[84:87], a[104:107], a[228:231], v[84:87]
 ds_read_b64_tr_b16 a[100:101], v42 offset:12288
 v_mfma_f32_16x16x32_bf16 v[84:87], a[108:111], a[244:247], v[84:87]
 v_mfma_f32_16x16x32_bf16 v[80:83], a[104:107], a[224:227], v[80:83]
 ds_read_b64_tr_b16 a[102:103], v42 offset:12800
 v_mfma_f32_16x16x32_bf16 v[80:83], a[108:111], a[240:243], v[80:83]
 s_waitcnt lgkmcnt(8)
 v_mfma_f32_16x16x32_bf16 v[96:99], a[112:115], a[224:227], v[96:99]
 ds_read_b64_tr_b16 a[104:105], v43 offset:8192
 v_mfma_f32_16x16x32_bf16 v[96:99], a[116:119], a[240:243], v[96:99]
 buffer_load_dwordx4 v10, s[8:11], s33 offen offset:2048 lds
 v_mfma_f32_16x16x32_bf16 v[100:103], a[112:115], a[228:231], v[100:103]
 ds_read_b64_tr_b16 a[106:107], v43 offset:8704
 v_mfma_f32_16x16x32_bf16 v[100:103], a[116:119], a[244:247], v[100:103]
 buffer_load_dwordx4 v11, s[8:11], s33 offen offset:3072 lds
 v_mfma_f32_16x16x32_bf16 v[104:107], a[112:115], a[232:235], v[104:107]
 ds_read_b64_tr_b16 a[108:109], v43 offset:12288
 v_mfma_f32_16x16x32_bf16 v[104:107], a[116:119], a[248:251], v[104:107]
 v_mfma_f32_16x16x32_bf16 v[108:111], a[112:115], a[236:239], v[108:111]
 ds_read_b64_tr_b16 a[110:111], v43 offset:12800
 v_mfma_f32_16x16x32_bf16 v[108:111], a[116:119], a[252:255], v[108:111]
 s_waitcnt lgkmcnt(8)
 v_mfma_f32_16x16x32_bf16 v[124:127], a[120:123], a[236:239], v[124:127]
 ds_read_b64_tr_b16 a[112:113], v44 offset:8192
 v_mfma_f32_16x16x32_bf16 v[124:127], a[124:127], a[252:255], v[124:127]
 s_add_u32 m0, s46, 12288
 v_mfma_f32_16x16x32_bf16 v[120:123], a[120:123], a[232:235], v[120:123]
 ds_read_b64_tr_b16 a[114:115], v44 offset:8704
 v_mfma_f32_16x16x32_bf16 v[120:123], a[124:127], a[248:251], v[120:123]
 buffer_load_dwordx4 v12, s[8:11], s33 offen offset:0 lds
 v_mfma_f32_16x16x32_bf16 v[116:119], a[120:123], a[228:231], v[116:119]
 ds_read_b64_tr_b16 a[116:117], v44 offset:12288
 v_mfma_f32_16x16x32_bf16 v[116:119], a[124:127], a[244:247], v[116:119]
 v_mfma_f32_16x16x32_bf16 v[112:115], a[120:123], a[224:227], v[112:115]
 ds_read_b64_tr_b16 a[118:119], v44 offset:12800
 v_mfma_f32_16x16x32_bf16 v[112:115], a[124:127], a[240:243], v[112:115]
 s_waitcnt lgkmcnt(8)
 v_mfma_f32_16x16x32_bf16 v[128:131], a[96:99], a[224:227], v[128:131]
 ds_read_b64_tr_b16 a[120:121], v45 offset:8192
 v_mfma_f32_16x16x32_bf16 v[128:131], a[100:103], a[240:243], v[128:131]
 buffer_load_dwordx4 v13, s[8:11], s33 offen offset:1024 lds
 v_mfma_f32_16x16x32_bf16 v[132:135], a[96:99], a[228:231], v[132:135]
 ds_read_b64_tr_b16 a[122:123], v45 offset:8704
 v_mfma_f32_16x16x32_bf16 v[132:135], a[100:103], a[244:247], v[132:135]
 v_mfma_f32_16x16x32_bf16 v[136:139], a[96:99], a[232:235], v[136:139]
 ds_read_b64_tr_b16 a[124:125], v45 offset:12288
 v_mfma_f32_16x16x32_bf16 v[136:139], a[100:103], a[248:251], v[136:139]
 buffer_load_dwordx4 v14, s[8:11], s33 offen offset:2048 lds
 v_mfma_f32_16x16x32_bf16 v[140:143], a[96:99], a[236:239], v[140:143]
 ds_read_b64_tr_b16 a[126:127], v45 offset:12800
 v_mfma_f32_16x16x32_bf16 v[140:143], a[100:103], a[252:255], v[140:143]
 s_waitcnt lgkmcnt(8)
 v_mfma_f32_16x16x32_bf16 v[156:159], a[104:107], a[236:239], v[156:159]
 ds_read_b64_tr_b16 a[96:97], v42 offset:16384
 v_mfma_f32_16x16x32_bf16 v[156:159], a[108:111], a[252:255], v[156:159]
 buffer_load_dwordx4 v15, s[8:11], s33 offen offset:3072 lds
 v_mfma_f32_16x16x32_bf16 v[152:155], a[104:107], a[232:235], v[152:155]
 ds_read_b64_tr_b16 a[98:99], v42 offset:16896
 v_mfma_f32_16x16x32_bf16 v[152:155], a[108:111], a[248:251], v[152:155]
 v_mfma_f32_16x16x32_bf16 v[148:151], a[104:107], a[228:231], v[148:151]
 ds_read_b64_tr_b16 a[100:101], v42 offset:20480
 v_mfma_f32_16x16x32_bf16 v[148:151], a[108:111], a[244:247], v[148:151]
 v_mfma_f32_16x16x32_bf16 v[144:147], a[104:107], a[224:227], v[144:147]
 ds_read_b64_tr_b16 a[102:103], v42 offset:20992
 v_mfma_f32_16x16x32_bf16 v[144:147], a[108:111], a[240:243], v[144:147]
 s_add_u32 m0, s41, 0x20000
 s_waitcnt lgkmcnt(8)
 v_mfma_f32_16x16x32_bf16 v[160:163], a[112:115], a[224:227], v[160:163]
 ds_read_b64_tr_b16 a[104:105], v43 offset:16384
 s_xor_b32 s34, s3, 0x280000
 v_mfma_f32_16x16x32_bf16 v[160:163], a[116:119], a[240:243], v[160:163]
 buffer_load_dwordx4 v16, s[12:15], s34 offen offset:0 nt lds
 v_mfma_f32_16x16x32_bf16 v[164:167], a[112:115], a[228:231], v[164:167]
 ds_read_b64_tr_b16 a[106:107], v43 offset:16896
 v_mfma_f32_16x16x32_bf16 v[164:167], a[116:119], a[244:247], v[164:167]
 v_mfma_f32_16x16x32_bf16 v[168:171], a[112:115], a[232:235], v[168:171]
 ds_read_b64_tr_b16 a[108:109], v43 offset:20480
 v_mfma_f32_16x16x32_bf16 v[168:171], a[116:119], a[248:251], v[168:171]
 buffer_load_dwordx4 v17, s[12:15], s34 offen offset:1024 nt lds
 v_mfma_f32_16x16x32_bf16 v[172:175], a[112:115], a[236:239], v[172:175]
 ds_read_b64_tr_b16 a[110:111], v43 offset:20992
 v_mfma_f32_16x16x32_bf16 v[172:175], a[116:119], a[252:255], v[172:175]
 s_waitcnt lgkmcnt(8)
 v_mfma_f32_16x16x32_bf16 v[188:191], a[120:123], a[236:239], v[188:191]
 ds_read_b64_tr_b16 a[112:113], v44 offset:16384
 v_mfma_f32_16x16x32_bf16 v[188:191], a[124:127], a[252:255], v[188:191]
 v_mfma_f32_16x16x32_bf16 v[184:187], a[120:123], a[232:235], v[184:187]
 ds_read_b64_tr_b16 a[114:115], v44 offset:16896
 v_mfma_f32_16x16x32_bf16 v[184:187], a[124:127], a[248:251], v[184:187]
 buffer_load_dwordx4 v18, s[12:15], s34 offen offset:2048 nt lds
 v_mfma_f32_16x16x32_bf16 v[180:183], a[120:123], a[228:231], v[180:183]
 ds_read_b64_tr_b16 a[116:117], v44 offset:20480
 v_mfma_f32_16x16x32_bf16 v[180:183], a[124:127], a[244:247], v[180:183]
 v_mfma_f32_16x16x32_bf16 v[176:179], a[120:123], a[224:227], v[176:179]
 ds_read_b64_tr_b16 a[118:119], v44 offset:20992
 v_mfma_f32_16x16x32_bf16 v[176:179], a[124:127], a[240:243], v[176:179]
 s_waitcnt lgkmcnt(8)
 v_mfma_f32_16x16x32_bf16 v[192:195], a[224:227], a[96:99], v[192:195]
 ds_read_b64_tr_b16 a[120:121], v45 offset:16384
 v_mfma_f32_16x16x32_bf16 v[192:195], a[240:243], a[100:103], v[192:195]
 buffer_load_dwordx4 v19, s[12:15], s34 offen offset:3072 nt lds
 v_mfma_f32_16x16x32_bf16 v[196:199], a[228:231], a[96:99], v[196:199]
 ds_read_b64_tr_b16 a[122:123], v45 offset:16896
 v_mfma_f32_16x16x32_bf16 v[196:199], a[244:247], a[100:103], v[196:199]
 v_mfma_f32_16x16x32_bf16 v[200:203], a[232:235], a[96:99], v[200:203]
 ds_read_b64_tr_b16 a[124:125], v45 offset:20480
 v_mfma_f32_16x16x32_bf16 v[200:203], a[248:251], a[100:103], v[200:203]
 s_add_u32 m0, s42, 0x20000
 v_mfma_f32_16x16x32_bf16 v[204:207], a[236:239], a[96:99], v[204:207]
 ds_read_b64_tr_b16 a[126:127], v45 offset:20992
 v_mfma_f32_16x16x32_bf16 v[204:207], a[252:255], a[100:103], v[204:207]
 s_waitcnt lgkmcnt(8)
 v_mfma_f32_16x16x32_bf16 v[220:223], a[236:239], a[104:107], v[220:223]
 ds_read_b64_tr_b16 a[96:97], v42 offset:24576
 v_mfma_f32_16x16x32_bf16 v[220:223], a[252:255], a[108:111], v[220:223]
 buffer_load_dwordx4 v20, s[12:15], s34 offen offset:0 nt lds
 v_mfma_f32_16x16x32_bf16 v[216:219], a[232:235], a[104:107], v[216:219]
 ds_read_b64_tr_b16 a[98:99], v42 offset:25088
 v_mfma_f32_16x16x32_bf16 v[216:219], a[248:251], a[108:111], v[216:219]
 buffer_load_dwordx4 v21, s[12:15], s34 offen offset:1024 nt lds
 v_mfma_f32_16x16x32_bf16 v[212:215], a[228:231], a[104:107], v[212:215]
 ds_read_b64_tr_b16 a[100:101], v42 offset:28672
 v_mfma_f32_16x16x32_bf16 v[212:215], a[244:247], a[108:111], v[212:215]
 v_mfma_f32_16x16x32_bf16 v[208:211], a[224:227], a[104:107], v[208:211]
 ds_read_b64_tr_b16 a[102:103], v42 offset:29184
 v_mfma_f32_16x16x32_bf16 v[208:211], a[240:243], a[108:111], v[208:211]
 s_waitcnt lgkmcnt(8)
 v_mfma_f32_16x16x32_bf16 v[224:227], a[224:227], a[112:115], v[224:227]
 ds_read_b64_tr_b16 a[104:105], v43 offset:24576
 v_mfma_f32_16x16x32_bf16 v[224:227], a[240:243], a[116:119], v[224:227]
 buffer_load_dwordx4 v22, s[12:15], s34 offen offset:2048 nt lds
 v_mfma_f32_16x16x32_bf16 v[228:231], a[228:231], a[112:115], v[228:231]
 ds_read_b64_tr_b16 a[106:107], v43 offset:25088
 v_mfma_f32_16x16x32_bf16 v[228:231], a[244:247], a[116:119], v[228:231]
 v_mfma_f32_16x16x32_bf16 v[232:235], a[232:235], a[112:115], v[232:235]
 ds_read_b64_tr_b16 a[108:109], v43 offset:28672
 v_mfma_f32_16x16x32_bf16 v[232:235], a[248:251], a[116:119], v[232:235]
 v_mfma_f32_16x16x32_bf16 v[236:239], a[236:239], a[112:115], v[236:239]
 ds_read_b64_tr_b16 a[110:111], v43 offset:29184
 v_mfma_f32_16x16x32_bf16 v[236:239], a[252:255], a[116:119], v[236:239]
 s_waitcnt lgkmcnt(8)
 v_mfma_f32_16x16x32_bf16 v[252:255], a[236:239], a[120:123], v[252:255]
 ds_read_b64_tr_b16 a[112:113], v44 offset:24576
 v_mfma_f32_16x16x32_bf16 v[252:255], a[252:255], a[124:127], v[252:255]
 buffer_load_dwordx4 v23, s[12:15], s34 offen offset:3072 nt lds
 v_mfma_f32_16x16x32_bf16 v[248:251], a[232:235], a[120:123], v[248:251]
 ds_read_b64_tr_b16 a[114:115], v44 offset:25088
 v_mfma_f32_16x16x32_bf16 v[248:251], a[248:251], a[124:127], v[248:251]
 v_mfma_f32_16x16x32_bf16 v[244:247], a[228:231], a[120:123], v[244:247]
 ds_read_b64_tr_b16 a[116:117], v44 offset:28672
 v_mfma_f32_16x16x32_bf16 v[244:247], a[244:247], a[124:127], v[244:247]
 v_mfma_f32_16x16x32_bf16 v[240:243], a[224:227], a[120:123], v[240:243]
 ds_read_b64_tr_b16 a[118:119], v44 offset:29184
 s_mov_b32 s66, 0x100000
 v_mfma_f32_16x16x32_bf16 v[240:243], a[240:243], a[124:127], v[240:243]
 s_waitcnt lgkmcnt(8)
 v_mfma_f32_16x16x32_bf16 a[0:3], a[224:227], a[96:99], a[0:3]
 ds_read_b64_tr_b16 a[120:121], v45 offset:24576
 v_mfma_f32_16x16x32_bf16 a[0:3], a[240:243], a[100:103], a[0:3]
 buffer_load_dword v60, v54, s[16:19], s66 offen
 v_mfma_f32_16x16x32_bf16 a[4:7], a[228:231], a[96:99], a[4:7]
 ds_read_b64_tr_b16 a[122:123], v45 offset:25088
 s_mov_b32 s67, 0xc0000
 v_mfma_f32_16x16x32_bf16 a[4:7], a[244:247], a[100:103], a[4:7]
 buffer_load_dword v60, v55, s[24:27], s67 offen
 v_mfma_f32_16x16x32_bf16 a[8:11], a[232:235], a[96:99], a[8:11]
 ds_read_b64_tr_b16 a[124:125], v45 offset:28672
 v_mfma_f32_16x16x32_bf16 a[8:11], a[248:251], a[100:103], a[8:11]
 v_mfma_f32_16x16x32_bf16 a[12:15], a[236:239], a[96:99], a[12:15]
 ds_read_b64_tr_b16 a[126:127], v45 offset:29184
 v_min_u32 v63, 1, v2
 v_mfma_f32_16x16x32_bf16 a[12:15], a[252:255], a[100:103], a[12:15]
 v_mad_u32_u24 v63, s45, 2, v63
 s_waitcnt lgkmcnt(8)
 v_mfma_f32_16x16x32_bf16 a[28:31], a[236:239], a[104:107], a[28:31]
 v_lshlrev_b32 v63, 7, v63
 v_mfma_f32_16x16x32_bf16 a[28:31], a[252:255], a[108:111], a[28:31]
 v_add_u32 v63, F_step7-F_pc, v63
 v_mfma_f32_16x16x32_bf16 a[24:27], a[232:235], a[104:107], a[24:27]
 global_load_dword v60, v63, s[90:91]
 v_mfma_f32_16x16x32_bf16 a[24:27], a[248:251], a[108:111], a[24:27]
 s_waitcnt lgkmcnt(0) vmcnt(21)
 s_barrier
 v_readfirstlane_b32 s89, v62
 s_nop 0
 s_cmp_eq_u32 s89, 0
 s_cbranch_scc1 F_spin0
F_spin0_b:
 v_mfma_f32_16x16x32_bf16 a[20:23], a[228:231], a[104:107], a[20:23]
 ds_read_b64_tr_b16 a[96:97], v42 offset:32768
 v_mfma_f32_16x16x32_bf16 a[20:23], a[244:247], a[108:111], a[20:23]
 ds_read_b64_tr_b16 a[98:99], v42 offset:33280
 v_mfma_f32_16x16x32_bf16 a[16:19], a[224:227], a[104:107], a[16:19]
 ds_read_b64_tr_b16 a[100:101], v42 offset:36864
 v_mfma_f32_16x16x32_bf16 a[16:19], a[240:243], a[108:111], a[16:19]
 ds_read_b64_tr_b16 a[102:103], v42 offset:37376
 v_mfma_f32_16x16x32_bf16 a[32:35], a[224:227], a[112:115], a[32:35]
 ds_read_b128 a[64:67], v40 offset:0
 v_mfma_f32_16x16x32_bf16 a[32:35], a[240:243], a[116:119], a[32:35]
 ds_read_b128 a[80:83], v41 offset:0
 v_mfma_f32_16x16x32_bf16 a[36:39], a[228:231], a[112:115], a[36:39]
 ds_read_b128 a[68:71], v40 offset:2048
 v_mfma_f32_16x16x32_bf16 a[36:39], a[244:247], a[116:119], a[36:39]
 ds_read_b128 a[84:87], v41 offset:2048
 v_mfma_f32_16x16x32_bf16 a[40:43], a[232:235], a[112:115], a[40:43]
 ds_read_b128 a[72:75], v40 offset:4096
 v_mfma_f32_16x16x32_bf16 a[40:43], a[248:251], a[116:119], a[40:43]
 ds_read_b128 a[88:91], v41 offset:4096
 v_mfma_f32_16x16x32_bf16 a[44:47], a[236:239], a[112:115], a[44:47]
 ds_read_b128 a[76:79], v40 offset:6144
 v_mfma_f32_16x16x32_bf16 a[44:47], a[252:255], a[116:119], a[44:47]
 ds_read_b128 a[92:95], v41 offset:6144
 v_mfma_f32_16x16x32_bf16 a[60:63], a[236:239], a[120:123], a[60:63]
 ds_read_b64_tr_b16 a[104:105], v43 offset:32768
 v_mfma_f32_16x16x32_bf16 a[60:63], a[252:255], a[124:127], a[60:63]
 ds_read_b64_tr_b16 a[106:107], v43 offset:33280
 v_mfma_f32_16x16x32_bf16 a[56:59], a[232:235], a[120:123], a[56:59]
 ds_read_b64_tr_b16 a[108:109], v43 offset:36864
 v_mfma_f32_16x16x32_bf16 a[56:59], a[248:251], a[124:127], a[56:59]
 ds_read_b64_tr_b16 a[110:111], v43 offset:37376
 v_mfma_f32_16x16x32_bf16 a[52:55], a[228:231], a[120:123], a[52:55]
 ds_read_b64_tr_b16 a[112:113], v44 offset:32768
 v_mfma_f32_16x16x32_bf16 a[52:55], a[244:247], a[124:127], a[52:55]
 ds_read_b64_tr_b16 a[114:115], v44 offset:33280
 v_mfma_f32_16x16x32_bf16 a[48:51], a[224:227], a[120:123], a[48:51]
 ds_read_b64_tr_b16 a[116:117], v44 offset:36864
 v_mfma_f32_16x16x32_bf16 a[48:51], a[240:243], a[124:127], a[48:51]
 ds_read_b64_tr_b16 a[118:119], v44 offset:37376
F_step4:
 s_waitcnt lgkmcnt(8)
 v_mfma_f32_16x16x32_bf16 v[64:67], a[96:99], a[64:67], v[64:67]
 ds_read_b64_tr_b16 a[120:121], v45 offset:32768
 v_mfma_f32_16x16x32_bf16 v[64:67], a[100:103], a[80:83], v[64:67]
 v_mfma_f32_16x16x32_bf16 v[68:71], a[96:99], a[68:71], v[68:71]
 ds_read_b64_tr_b16 a[122:123], v45 offset:33280
 v_mov_b32 v4, 0
 v_mfma_f32_16x16x32_bf16 v[68:71], a[100:103], a[84:87], v[68:71]
 s_add_u32 m0, s46, 0
 s_xor_b32 s33, s94, 768
 v_mfma_f32_16x16x32_bf16 v[72:75], a[96:99], a[72:75], v[72:75]
 ds_read_b64_tr_b16 a[124:125], v45 offset:36864
 v_mov_b32 v5, 0
 v_mfma_f32_16x16x32_bf16 v[72:75], a[100:103], a[88:91], v[72:75]
 buffer_load_dwordx4 v8, s[8:11], s33 offen offset:0 lds
 v_mfma_f32_16x16x32_bf16 v[76:79], a[96:99], a[76:79], v[76:79]
 ds_read_b64_tr_b16 a[126:127], v45 offset:37376
 v_mfma_f32_16x16x32_bf16 v[76:79], a[100:103], a[92:95], v[76:79]
 v_accvgpr_read_b32 v61, a144
 s_waitcnt lgkmcnt(8)
 v_mfma_f32_16x16x32_bf16 v[92:95], a[104:107], a[76:79], v[92:95]
 ds_read_b64_tr_b16 a[96:97], v42 offset:40960
 v_mfma_f32_16x16x32_bf16 v[92:95], a[108:111], a[92:95], v[92:95]
 buffer_load_dwordx4 v9, s[8:11], s33 offen offset:1024 lds
 v_mfma_f32_16x16x32_bf16 v[88:91], a[104:107], a[72:75], v[88:91]
 ds_read_b64_tr_b16 a[98:99], v42 offset:41472
 v_accvgpr_read_b32 v62, a128
 v_mfma_f32_16x16x32_bf16 v[88:91], a[108:111], a[88:91], v[88:91]
 v_mfma_f32_16x16x32_bf16 v[84:87], a[104:107], a[68:71], v[84:87]
 ds_read_b64_tr_b16 a[100:101], v42 offset:45056
 v_mfma_f32_16x16x32_bf16 v[84:87], a[108:111], a[84:87], v[84:87]
 buffer_load_dwordx4 v10, s[8:11], s33 offen offset:2048 lds
 v_mfma_f32_16x16x32_bf16 v[80:83], a[104:107], a[64:67], v[80:83]
 ds_read_b64_tr_b16 a[102:103], v42 offset:45568
 v_accvgpr_read_b32 v63, a136
 v_mfma_f32_16x16x32_bf16 v[80:83], a[108:111], a[80:83], v[80:83]
 s_waitcnt lgkmcnt(8)
 v_mfma_f32_16x16x32_bf16 v[96:99], a[112:115], a[64:67], v[96:99]
 ds_read_b64_tr_b16 a[104:105], v43 offset:40960
 v_dot2_f32_bf16 v4, v62, v61, v4
 v_mfma_f32_16x16x32_bf16 v[96:99], a[116:119], a[80:83], v[96:99]
 v_mfma_f32_16x16x32_bf16 v[100:103], a[112:115], a[68:71], v[100:103]
 ds_read_b64_tr_b16 a[106:107], v43 offset:41472
 v_mfma_f32_16x16x32_bf16 v[100:103], a[116:119], a[84:87], v[100:103]
 buffer_load_dwordx4 v11, s[8:11], s33 offen offset:3072 lds
 v_mfma_f32_16x16x32_bf16 v[104:107], a[112:115], a[72:75], v[104:107]
 ds_read_b64_tr_b16 a[108:109], v43 offset:45056
 v_dot2_f32_bf16 v5, v63, v61, v5
 v_mfma_f32_16x16x32_bf16 v[104:107], a[116:119], a[88:91], v[104:107]
 v_mfma_f32_16x16x32_bf16 v[108:111], a[112:115], a[76:79], v[108:111]
 ds_read_b64_tr_b16 a[110:111], v43 offset:45568
 v_accvgpr_read_b32 v61, a145
 v_mfma_f32_16x16x32_bf16 v[108:111], a[116:119], a[92:95], v[108:111]
 s_waitcnt lgkmcnt(8)
 v_mfma_f32_16x16x32_bf16 v[124:127], a[120:123], a[76:79], v[124:127]
 ds_read_b64_tr_b16 a[112:113], v44 offset:40960
 s_add_u32 m0, s46, 4096
 v_mfma_f32_16x16x32_bf16 v[124:127], a[124:127], a[92:95], v[124:127]
 buffer_load_dwordx4 v12, s[8:11], s33 offen offset:0 lds
 v_mfma_f32_16x16x32_bf16 v[120:123], a[120:123], a[72:75], v[120:123]
 ds_read_b64_tr_b16 a[114:115], v44 offset:41472
 v_accvgpr_read_b32 v62, a129
 v_mfma_f32_16x16x32_bf16 v[120:123], a[124:127], a[88:91], v[120:123]
 v_mfma_f32_16x16x32_bf16 v[116:119], a[120:123], a[68:71], v[116:119]
 ds_read_b64_tr_b16 a[116:117], v44 offset:45056
 v_accvgpr_read_b32 v63, a137
 v_mfma_f32_16x16x32_bf16 v[116:119], a[124:127], a[84:87], v[116:119]
 buffer_load_dwordx4 v13, s[8:11], s33 offen offset:1024 lds
 v_mfma_f32_16x16x32_bf16 v[112:115], a[120:123], a[64:67], v[112:115]
 ds_read_b64_tr_b16 a[118:119], v44 offset:45568
 v_mfma_f32_16x16x32_bf16 v[112:115], a[124:127], a[80:83], v[112:115]
 v_dot2_f32_bf16 v4, v62, v61, v4
 s_waitcnt lgkmcnt(8)
 v_mfma_f32_16x16x32_bf16 v[128:131], a[96:99], a[64:67], v[128:131]
 ds_read_b64_tr_b16 a[120:121], v45 offset:40960
 v_mfma_f32_16x16x32_bf16 v[128:131], a[100:103], a[80:83], v[128:131]
 v_mfma_f32_16x16x32_bf16 v[132:135], a[96:99], a[68:71], v[132:135]
 ds_read_b64_tr_b16 a[122:123], v45 offset:41472
 v_dot2_f32_bf16 v5, v63, v61, v5
 v_mfma_f32_16x16x32_bf16 v[132:135], a[100:103], a[84:87], v[132:135]
 buffer_load_dwordx4 v14, s[8:11], s33 offen offset:2048 lds
 v_mfma_f32_16x16x32_bf16 v[136:139], a[96:99], a[72:75], v[136:139]
 ds_read_b64_tr_b16 a[124:125], v45 offset:45056
 v_mfma_f32_16x16x32_bf16 v[136:139], a[100:103], a[88:91], v[136:139]
 v_accvgpr_read_b32 v61, a146
 v_mfma_f32_16x16x32_bf16 v[140:143], a[96:99], a[76:79], v[140:143]
 ds_read_b64_tr_b16 a[126:127], v45 offset:45568
 v_mfma_f32_16x16x32_bf16 v[140:143], a[100:103], a[92:95], v[140:143]
 s_waitcnt lgkmcnt(8)
 v_mfma_f32_16x16x32_bf16 v[156:159], a[104:107], a[76:79], v[156:159]
 ds_read_b64_tr_b16 a[96:97], v42 offset:49152
 v_accvgpr_read_b32 v62, a130
 v_mfma_f32_16x16x32_bf16 v[156:159], a[108:111], a[92:95], v[156:159]
 buffer_load_dwordx4 v15, s[8:11], s33 offen offset:3072 lds
 v_mfma_f32_16x16x32_bf16 v[152:155], a[104:107], a[72:75], v[152:155]
 ds_read_b64_tr_b16 a[98:99], v42 offset:49664
 v_mfma_f32_16x16x32_bf16 v[152:155], a[108:111], a[88:91], v[152:155]
 v_accvgpr_read_b32 v63, a138
 v_mfma_f32_16x16x32_bf16 v[148:151], a[104:107], a[68:71], v[148:151]
 ds_read_b64_tr_b16 a[100:101], v42 offset:53248
 v_mfma_f32_16x16x32_bf16 v[148:151], a[108:111], a[84:87], v[148:151]
 s_add_u32 m0, s41, 0x10000
 s_xor_b32 s34, s3, 0x300000
 v_mfma_f32_16x16x32_bf16 v[144:147], a[104:107], a[64:67], v[144:147]
 ds_read_b64_tr_b16 a[102:103], v42 offset:53760
 v_dot2_f32_bf16 v4, v62, v61, v4
 v_mfma_f32_16x16x32_bf16 v[144:147], a[108:111], a[80:83], v[144:147]
 s_waitcnt lgkmcnt(8)
 v_mfma_f32_16x16x32_bf16 v[160:163], a[112:115], a[64:67], v[160:163]
 ds_read_b64_tr_b16 a[104:105], v43 offset:49152
 v_mfma_f32_16x16x32_bf16 v[160:163], a[116:119], a[80:83], v[160:163]
 buffer_load_dwordx4 v16, s[12:15], s34 offen offset:0 nt lds
 v_mfma_f32_16x16x32_bf16 v[164:167], a[112:115], a[68:71], v[164:167]
 ds_read_b64_tr_b16 a[106:107], v43 offset:49664
 v_dot2_f32_bf16 v5, v63, v61, v5
 v_mfma_f32_16x16x32_bf16 v[164:167], a[116:119], a[84:87], v[164:167]
 buffer_load_dwordx4 v17, s[12:15], s34 offen offset:1024 nt lds
 v_mfma_f32_16x16x32_bf16 v[168:171], a[112:115], a[72:75], v[168:171]
 ds_read_b64_tr_b16 a[108:109], v43 offset:53248
 v_accvgpr_read_b32 v61, a147
 v_mfma_f32_16x16x32_bf16 v[168:171], a[116:119], a[88:91], v[168:171]
 v_mfma_f32_16x16x32_bf16 v[172:175], a[112:115], a[76:79], v[172:175]
 ds_read_b64_tr_b16 a[110:111], v43 offset:53760
 v_mfma_f32_16x16x32_bf16 v[172:175], a[116:119], a[92:95], v[172:175]
 v_accvgpr_read_b32 v62, a131
 s_waitcnt lgkmcnt(8)
 v_mfma_f32_16x16x32_bf16 v[188:191], a[120:123], a[76:79], v[188:191]
 ds_read_b64_tr_b16 a[112:113], v44 offset:49152
 v_mfma_f32_16x16x32_bf16 v[188:191], a[124:127], a[92:95], v[188:191]
 buffer_load_dwordx4 v18, s[12:15], s34 offen offset:2048 nt lds
 v_mfma_f32_16x16x32_bf16 v[184:187], a[120:123], a[72:75], v[184:187]
 ds_read_b64_tr_b16 a[114:115], v44 offset:49664
 v_accvgpr_read_b32 v63, a139
 v_mfma_f32_16x16x32_bf16 v[184:187], a[124:127], a[88:91], v[184:187]
 v_mfma_f32_16x16x32_bf16 v[180:183], a[120:123], a[68:71], v[180:183]
 ds_read_b64_tr_b16 a[116:117], v44 offset:53248
 v_mfma_f32_16x16x32_bf16 v[180:183], a[124:127], a[84:87], v[180:183]
 buffer_load_dwordx4 v19, s[12:15], s34 offen offset:3072 nt lds
 v_mfma_f32_16x16x32_bf16 v[176:179], a[120:123], a[64:67], v[176:179]
 ds_read_b64_tr_b16 a[118:119], v44 offset:53760
 v_dot2_f32_bf16 v4, v62, v61, v4
 v_mfma_f32_16x16x32_bf16 v[176:179], a[124:127], a[80:83], v[176:179]
 s_waitcnt lgkmcnt(8)
 v_mfma_f32_16x16x32_bf16 v[192:195], a[64:67], a[96:99], v[192:195]
 ds_read_b64_tr_b16 a[120:121], v45 offset:49152
 v_dot2_f32_bf16 v5, v63, v61, v5
 v_mfma_f32_16x16x32_bf16 v[192:195], a[80:83], a[100:103], v[192:195]
 v_mfma_f32_16x16x32_bf16 v[196:199], a[68:71], a[96:99], v[196:199]
 ds_read_b64_tr_b16 a[122:123], v45 offset:49664
 s_add_u32 m0, s42, 0x10000
 v_mfma_f32_16x16x32_bf16 v[196:199], a[84:87], a[100:103], v[196:199]
 buffer_load_dwordx4 v20, s[12:15], s34 offen offset:0 nt lds
 v_mfma_f32_16x16x32_bf16 v[200:203], a[72:75], a[96:99], v[200:203]
 ds_read_b64_tr_b16 a[124:125], v45 offset:53248
 v_accvgpr_read_b32 v61, a148
 v_mfma_f32_16x16x32_bf16 v[200:203], a[88:91], a[100:103], v[200:203]
 v_accvgpr_read_b32 v62, a132
 v_mfma_f32_16x16x32_bf16 v[204:207], a[76:79], a[96:99], v[204:207]
 ds_read_b64_tr_b16 a[126:127], v45 offset:53760
 v_mfma_f32_16x16x32_bf16 v[204:207], a[92:95], a[100:103], v[204:207]
 s_waitcnt lgkmcnt(8)
 v_mfma_f32_16x16x32_bf16 v[220:223], a[76:79], a[104:107], v[220:223]
 ds_read_b64_tr_b16 a[96:97], v42 offset:57344
 v_accvgpr_read_b32 v63, a140
 v_mfma_f32_16x16x32_bf16 v[220:223], a[92:95], a[108:111], v[220:223]
 buffer_load_dwordx4 v21, s[12:15], s34 offen offset:1024 nt lds
 v_mfma_f32_16x16x32_bf16 v[216:219], a[72:75], a[104:107], v[216:219]
 ds_read_b64_tr_b16 a[98:99], v42 offset:57856
 v_mfma_f32_16x16x32_bf16 v[216:219], a[88:91], a[108:111], v[216:219]
 v_dot2_f32_bf16 v4, v62, v61, v4
 v_mfma_f32_16x16x32_bf16 v[212:215], a[68:71], a[104:107], v[212:215]
 ds_read_b64_tr_b16 a[100:101], v42 offset:61440
 v_mfma_f32_16x16x32_bf16 v[212:215], a[84:87], a[108:111], v[212:215]
 buffer_load_dwordx4 v22, s[12:15], s34 offen offset:2048 nt lds
 v_mfma_f32_16x16x32_bf16 v[208:211], a[64:67], a[104:107], v[208:211]
 ds_read_b64_tr_b16 a[102:103], v42 offset:61952
 v_dot2_f32_bf16 v5, v63, v61, v5
 v_mfma_f32_16x16x32_bf16 v[208:211], a[80:83], a[108:111], v[208:211]
 s_waitcnt lgkmcnt(8)
 v_mfma_f32_16x16x32_bf16 v[224:227], a[64:67], a[112:115], v[224:227]
 ds_read_b64_tr_b16 a[104:105], v43 offset:57344
 v_mfma_f32_16x16x32_bf16 v[224:227], a[80:83], a[116:119], v[224:227]
 v_accvgpr_read_b32 v61, a149
 v_mfma_f32_16x16x32_bf16 v[228:231], a[68:71], a[112:115], v[228:231]
 ds_read_b64_tr_b16 a[106:107], v43 offset:57856
 v_mfma_f32_16x16x32_bf16 v[228:231], a[84:87], a[116:119], v[228:231]
 buffer_load_dwordx4 v23, s[12:15], s34 offen offset:3072 nt lds
 v_mfma_f32_16x16x32_bf16 v[232:235], a[72:75], a[112:115], v[232:235]
 ds_read_b64_tr_b16 a[108:109], v43 offset:61440
 v_accvgpr_read_b32 v62, a133
 v_mfma_f32_16x16x32_bf16 v[232:235], a[88:91], a[116:119], v[232:235]
 v_mfma_f32_16x16x32_bf16 v[236:239], a[76:79], a[112:115], v[236:239]
 ds_read_b64_tr_b16 a[110:111], v43 offset:61952
 v_mfma_f32_16x16x32_bf16 v[236:239], a[92:95], a[116:119], v[236:239]
 v_accvgpr_read_b32 v63, a141
 s_waitcnt lgkmcnt(8)
 v_mfma_f32_16x16x32_bf16 v[252:255], a[76:79], a[120:123], v[252:255]
 ds_read_b64_tr_b16 a[112:113], v44 offset:57344
 v_mfma_f32_16x16x32_bf16 v[252:255], a[92:95], a[124:127], v[252:255]
 v_mfma_f32_16x16x32_bf16 v[248:251], a[72:75], a[120:123], v[248:251]
 ds_read_b64_tr_b16 a[114:115], v44 offset:57856
 s_mov_b32 s66, 0x200000
 v_mfma_f32_16x16x32_bf16 v[248:251], a[88:91], a[124:127], v[248:251]
 buffer_load_dword v60, v54, s[16:19], s66 offen
 v_mfma_f32_16x16x32_bf16 v[244:247], a[68:71], a[120:123], v[244:247]
 ds_read_b64_tr_b16 a[116:117], v44 offset:61440
 v_dot2_f32_bf16 v4, v62, v61, v4
 v_mfma_f32_16x16x32_bf16 v[244:247], a[84:87], a[124:127], v[244:247]
 v_dot2_f32_bf16 v5, v63, v61, v5
 v_mfma_f32_16x16x32_bf16 v[240:243], a[64:67], a[120:123], v[240:243]
 ds_read_b64_tr_b16 a[118:119], v44 offset:61952
 s_mov_b32 s67, 0x180000
 v_mfma_f32_16x16x32_bf16 v[240:243], a[80:83], a[124:127], v[240:243]
 s_waitcnt lgkmcnt(8)
 v_mfma_f32_16x16x32_bf16 a[0:3], a[64:67], a[96:99], a[0:3]
 ds_read_b64_tr_b16 a[120:121], v45 offset:57344
 v_accvgpr_read_b32 v61, a150
 v_mfma_f32_16x16x32_bf16 a[0:3], a[80:83], a[100:103], a[0:3]
 buffer_load_dword v60, v55, s[24:27], s67 offen
 v_mfma_f32_16x16x32_bf16 a[4:7], a[68:71], a[96:99], a[4:7]
 ds_read_b64_tr_b16 a[122:123], v45 offset:57856
 s_mov_b32 s66, 0x300000
 v_mfma_f32_16x16x32_bf16 a[4:7], a[84:87], a[100:103], a[4:7]
 buffer_load_dword v60, v54, s[16:19], s66 offen
 v_mfma_f32_16x16x32_bf16 a[8:11], a[72:75], a[96:99], a[8:11]
 ds_read_b64_tr_b16 a[124:125], v45 offset:61440
 v_accvgpr_read_b32 v62, a134
 v_mfma_f32_16x16x32_bf16 a[8:11], a[88:91], a[100:103], a[8:11]
 v_mfma_f32_16x16x32_bf16 a[12:15], a[76:79], a[96:99], a[12:15]
 ds_read_b64_tr_b16 a[126:127], v45 offset:61952
 s_mov_b32 s67, 0x240000
 v_mfma_f32_16x16x32_bf16 a[12:15], a[92:95], a[100:103], a[12:15]
 v_accvgpr_read_b32 v63, a142
 s_waitcnt lgkmcnt(8)
 v_mfma_f32_16x16x32_bf16 a[28:31], a[76:79], a[104:107], a[28:31]
 buffer_load_dword v60, v55, s[24:27], s67 offen
 v_mfma_f32_16x16x32_bf16 a[28:31], a[92:95], a[108:111], a[28:31]
 v_dot2_f32_bf16 v4, v62, v61, v4
 v_mfma_f32_16x16x32_bf16 a[24:27], a[72:75], a[104:107], a[24:27]
 v_mfma_f32_16x16x32_bf16 a[24:27], a[88:91], a[108:111], a[24:27]
 s_waitcnt lgkmcnt(0) vmcnt(23)
 s_barrier
 v_mfma_f32_16x16x32_bf16 a[20:23], a[68:71], a[104:107], a[20:23]
 ds_read_b64_tr_b16 a[96:97], v48 offset:0
 v_dot2_f32_bf16 v5, v63, v61, v5
 v_mfma_f32_16x16x32_bf16 a[20:23], a[84:87], a[108:111], a[20:23]
 ds_read_b64_tr_b16 a[98:99], v48 offset:512
 v_mfma_f32_16x16x32_bf16 a[16:19], a[64:67], a[104:107], a[16:19]
 ds_read_b64_tr_b16 a[100:101], v48 offset:4096
 v_mfma_f32_16x16x32_bf16 a[16:19], a[80:83], a[108:111], a[16:19]
 ds_read_b64_tr_b16 a[102:103], v48 offset:4608
 v_mfma_f32_16x16x32_bf16 a[32:35], a[64:67], a[112:115], a[32:35]
 ds_read_b128 a[224:227], v40 offset:8192
 v_accvgpr_read_b32 v61, a151
 v_mfma_f32_16x16x32_bf16 a[32:35], a[80:83], a[116:119], a[32:35]
 ds_read_b128 a[240:243], v41 offset:8192
 v_mfma_f32_16x16x32_bf16 a[36:39], a[68:71], a[112:115], a[36:39]
 ds_read_b128 a[228:231], v40 offset:10240
 v_accvgpr_read_b32 v62, a135
 v_mfma_f32_16x16x32_bf16 a[36:39], a[84:87], a[116:119], a[36:39]
 ds_read_b128 a[244:247], v41 offset:10240
 v_mfma_f32_16x16x32_bf16 a[40:43], a[72:75], a[112:115], a[40:43]
 ds_read_b128 a[232:235], v40 offset:12288
 v_mfma_f32_16x16x32_bf16 a[40:43], a[88:91], a[116:119], a[40:43]
 ds_read_b128 a[248:251], v41 offset:12288
 v_accvgpr_read_b32 v63, a143
 v_mfma_f32_16x16x32_bf16 a[44:47], a[76:79], a[112:115], a[44:47]
 ds_read_b128 a[236:239], v40 offset:14336
 v_mfma_f32_16x16x32_bf16 a[44:47], a[92:95], a[116:119], a[44:47]
 ds_read_b128 a[252:255], v41 offset:14336
 v_mfma_f32_16x16x32_bf16 a[60:63], a[76:79], a[120:123], a[60:63]
 ds_read_b64_tr_b16 a[104:105], v49 offset:0
 v_dot2_f32_bf16 v4, v62, v61, v4
 v_mfma_f32_16x16x32_bf16 a[60:63], a[92:95], a[124:127], a[60:63]
 ds_read_b64_tr_b16 a[106:107], v49 offset:512
 v_mfma_f32_16x16x32_bf16 a[56:59], a[72:75], a[120:123], a[56:59]
 ds_read_b64_tr_b16 a[108:109], v49 offset:4096
 v_mfma_f32_16x16x32_bf16 a[56:59], a[88:91], a[124:127], a[56:59]
 ds_read_b64_tr_b16 a[110:111], v49 offset:4608
 v_dot2_f32_bf16 v5, v63, v61, v5
 v_mfma_f32_16x16x32_bf16 a[52:55], a[68:71], a[120:123], a[52:55]
 ds_read_b64_tr_b16 a[112:113], v50 offset:0
 v_mfma_f32_16x16x32_bf16 a[52:55], a[84:87], a[124:127], a[52:55]
 ds_read_b64_tr_b16 a[114:115], v50 offset:512
 v_mfma_f32_16x16x32_bf16 a[48:51], a[64:67], a[120:123], a[48:51]
 ds_read_b64_tr_b16 a[116:117], v50 offset:4096
 v_mfma_f32_16x16x32_bf16 a[48:51], a[80:83], a[124:127], a[48:51]
 ds_read_b64_tr_b16 a[118:119], v50 offset:4608
F_step5:
 s_waitcnt lgkmcnt(8)
 v_mfma_f32_16x16x32_bf16 v[64:67], a[96:99], a[224:227], v[64:67]
 ds_read_b64_tr_b16 a[120:121], v51 offset:0
 v_mfma_f32_16x16x32_bf16 v[64:67], a[100:103], a[240:243], v[64:67]
 v_mfma_f32_16x16x32_bf16 v[68:71], a[96:99], a[228:231], v[68:71]
 ds_read_b64_tr_b16 a[122:123], v51 offset:512
 v_add_f32_dpp v4, v4, v4 row_shr:1 row_mask:0xf bank_mask:0xf bound_ctrl:0
 v_mfma_f32_16x16x32_bf16 v[68:71], a[100:103], a[244:247], v[68:71]
 s_add_u32 m0, s46, 8192
 s_xor_b32 s33, s94, 896
 v_mfma_f32_16x16x32_bf16 v[72:75], a[96:99], a[232:235], v[72:75]
 ds_read_b64_tr_b16 a[124:125], v51 offset:4096
 v_mfma_f32_16x16x32_bf16 v[72:75], a[100:103], a[248:251], v[72:75]
 buffer_load_dwordx4 v8, s[8:11], s33 offen offset:0 lds
 v_mfma_f32_16x16x32_bf16 v[76:79], a[96:99], a[236:239], v[76:79]
 ds_read_b64_tr_b16 a[126:127], v51 offset:4608
 v_mfma_f32_16x16x32_bf16 v[76:79], a[100:103], a[252:255], v[76:79]
 s_waitcnt lgkmcnt(8)
 v_mfma_f32_16x16x32_bf16 v[92:95], a[104:107], a[236:239], v[92:95]
 ds_read_b64_tr_b16 a[96:97], v48 offset:8192
 v_add_f32_dpp v5, v5, v5 row_shr:1 row_mask:0xf bank_mask:0xf bound_ctrl:0
 v_mfma_f32_16x16x32_bf16 v[92:95], a[108:111], a[252:255], v[92:95]
 buffer_load_dwordx4 v9, s[8:11], s33 offen offset:1024 lds
 v_mfma_f32_16x16x32_bf16 v[88:91], a[104:107], a[232:235], v[88:91]
 ds_read_b64_tr_b16 a[98:99], v48 offset:8704
 v_mfma_f32_16x16x32_bf16 v[88:91], a[108:111], a[248:251], v[88:91]
 v_mfma_f32_16x16x32_bf16 v[84:87], a[104:107], a[228:231], v[84:87]
 ds_read_b64_tr_b16 a[100:101], v48 offset:12288
 v_mfma_f32_16x16x32_bf16 v[84:87], a[108:111], a[244:247], v[84:87]
 v_mfma_f32_16x16x32_bf16 v[80:83], a[104:107], a[224:227], v[80:83]
 ds_read_b64_tr_b16 a[102:103], v48 offset:12800
 v_add_f32_dpp v4, v4, v4 row_shr:2 row_mask:0xf bank_mask:0xf bound_ctrl:0
 v_mfma_f32_16x16x32_bf16 v[80:83], a[108:111], a[240:243], v[80:83]
 s_waitcnt lgkmcnt(8)
 v_mfma_f32_16x16x32_bf16 v[96:99], a[112:115], a[224:227], v[96:99]
 ds_read_b64_tr_b16 a[104:105], v49 offset:8192
 v_mfma_f32_16x16x32_bf16 v[96:99], a[116:119], a[240:243], v[96:99]
 buffer_load_dwordx4 v10, s[8:11], s33 offen offset:2048 lds
 v_mfma_f32_16x16x32_bf16 v[100:103], a[112:115], a[228:231], v[100:103]
 ds_read_b64_tr_b16 a[106:107], v49 offset:8704
 v_mfma_f32_16x16x32_bf16 v[100:103], a[116:119], a[244:247], v[100:103]
 v_mfma_f32_16x16x32_bf16 v[104:107], a[112:115], a[232:235], v[104:107]
 ds_read_b64_tr_b16 a[108:109], v49 offset:12288
 v_add_f32_dpp v5, v5, v5 row_shr:2 row_mask:0xf bank_mask:0xf bound_ctrl:0
 v_mfma_f32_16x16x32_bf16 v[104:107], a[116:119], a[248:251], v[104:107]
 buffer_load_dwordx4 v11, s[8:11], s33 offen offset:3072 lds
 v_mfma_f32_16x16x32_bf16 v[108:111], a[112:115], a[236:239], v[108:111]
 ds_read_b64_tr_b16 a[110:111], v49 offset:12800
 v_mfma_f32_16x16x32_bf16 v[108:111], a[116:119], a[252:255], v[108:111]
 s_waitcnt lgkmcnt(8)
 v_mfma_f32_16x16x32_bf16 v[124:127], a[120:123], a[236:239], v[124:127]
 ds_read_b64_tr_b16 a[112:113], v50 offset:8192
 v_mfma_f32_16x16x32_bf16 v[124:127], a[124:127], a[252:255], v[124:127]
 v_mfma_f32_16x16x32_bf16 v[120:123], a[120:123], a[232:235], v[120:123]
 ds_read_b64_tr_b16 a[114:115], v50 offset:8704
 s_add_u32 m0, s46, 12288
 v_mfma_f32_16x16x32_bf16 v[120:123], a[124:127], a[248:251], v[120:123]
 buffer_load_dwordx4 v12, s[8:11], s33 offen offset:0 lds
 v_mfma_f32_16x16x32_bf16 v[116:119], a[120:123], a[228:231], v[116:119]
 ds_read_b64_tr_b16 a[116:117], v50 offset:12288
 v_add_f32_dpp v4, v4, v4 row_shr:4 row_mask:0xf bank_mask:0xf bound_ctrl:0
 v_mfma_f32_16x16x32_bf16 v[116:119], a[124:127], a[244:247], v[116:119]
 v_mfma_f32_16x16x32_bf16 v[112:115], a[120:123], a[224:227], v[112:115]
 ds_read_b64_tr_b16 a[118:119], v50 offset:12800
 v_mfma_f32_16x16x32_bf16 v[112:115], a[124:127], a[240:243], v[112:115]
 s_waitcnt lgkmcnt(8)
 v_mfma_f32_16x16x32_bf16 v[128:131], a[96:99], a[224:227], v[128:131]
 ds_read_b64_tr_b16 a[120:121], v51 offset:8192
 v_mfma_f32_16x16x32_bf16 v[128:131], a[100:103], a[240:243], v[128:131]
 buffer_load_dwordx4 v13, s[8:11], s33 offen offset:1024 lds
 v_mfma_f32_16x16x32_bf16 v[132:135], a[96:99], a[228:231], v[132:135]
 ds_read_b64_tr_b16 a[122:123], v51 offset:8704
 v_add_f32_dpp v5, v5, v5 row_shr:4 row_mask:0xf bank_mask:0xf bound_ctrl:0
 v_mfma_f32_16x16x32_bf16 v[132:135], a[100:103], a[244:247], v[132:135]
 v_mfma_f32_16x16x32_bf16 v[136:139], a[96:99], a[232:235], v[136:139]
 ds_read_b64_tr_b16 a[124:125], v51 offset:12288
 v_mfma_f32_16x16x32_bf16 v[136:139], a[100:103], a[248:251], v[136:139]
 buffer_load_dwordx4 v14, s[8:11], s33 offen offset:2048 lds
 v_mfma_f32_16x16x32_bf16 v[140:143], a[96:99], a[236:239], v[140:143]
 ds_read_b64_tr_b16 a[126:127], v51 offset:12800
 v_mfma_f32_16x16x32_bf16 v[140:143], a[100:103], a[252:255], v[140:143]
 v_add_f32_dpp v4, v4, v4 row_shr:8 row_mask:0xf bank_mask:0xf bound_ctrl:0
 s_waitcnt lgkmcnt(8)
 v_mfma_f32_16x16x32_bf16 v[156:159], a[104:107], a[236:239], v[156:159]
 ds_read_b64_tr_b16 a[96:97], v48 offset:16384
 v_mfma_f32_16x16x32_bf16 v[156:159], a[108:111], a[252:255], v[156:159]
 v_mfma_f32_16x16x32_bf16 v[152:155], a[104:107], a[232:235], v[152:155]
 ds_read_b64_tr_b16 a[98:99], v48 offset:16896
 v_mfma_f32_16x16x32_bf16 v[152:155], a[108:111], a[248:251], v[152:155]
 buffer_load_dwordx4 v15, s[8:11], s33 offen offset:3072 lds
 v_mfma_f32_16x16x32_bf16 v[148:151], a[104:107], a[228:231], v[148:151]
 ds_read_b64_tr_b16 a[100:101], v48 offset:20480
 v_mfma_f32_16x16x32_bf16 v[148:151], a[108:111], a[244:247], v[148:151]
 v_add_f32_dpp v5, v5, v5 row_shr:8 row_mask:0xf bank_mask:0xf bound_ctrl:0
 v_mfma_f32_16x16x32_bf16 v[144:147], a[104:107], a[224:227], v[144:147]
 ds_read_b64_tr_b16 a[102:103], v48 offset:20992
 v_mfma_f32_16x16x32_bf16 v[144:147], a[108:111], a[240:243], v[144:147]
 s_waitcnt lgkmcnt(8)
 v_mfma_f32_16x16x32_bf16 v[160:163], a[112:115], a[224:227], v[160:163]
 ds_read_b64_tr_b16 a[104:105], v49 offset:16384
 v_mfma_f32_16x16x32_bf16 v[160:163], a[116:119], a[240:243], v[160:163]
 s_add_u32 m0, s41, 0x18000
 s_xor_b32 s34, s3, 0x380000
 v_mfma_f32_16x16x32_bf16 v[164:167], a[112:115], a[228:231], v[164:167]
 ds_read_b64_tr_b16 a[106:107], v49 offset:16896
 v_mfma_f32_16x16x32_bf16 v[164:167], a[116:119], a[244:247], v[164:167]
 buffer_load_dwordx4 v16, s[12:15], s34 offen offset:0 nt lds
 v_mfma_f32_16x16x32_bf16 v[168:171], a[112:115], a[232:235], v[168:171]
 ds_read_b64_tr_b16 a[108:109], v49 offset:20480
 v_add_f32_dpp v4, v4, v4 row_bcast:15 row_mask:0xa bank_mask:0xf
 v_mfma_f32_16x16x32_bf16 v[168:171], a[116:119], a[248:251], v[168:171]
 v_mfma_f32_16x16x32_bf16 v[172:175], a[112:115], a[236:239], v[172:175]
 ds_read_b64_tr_b16 a[110:111], v49 offset:20992
 v_mfma_f32_16x16x32_bf16 v[172:175], a[116:119], a[252:255], v[172:175]
 s_waitcnt lgkmcnt(8)
 v_mfma_f32_16x16x32_bf16 v[188:191], a[120:123], a[236:239], v[188:191]
 ds_read_b64_tr_b16 a[112:113], v50 offset:16384
 v_mfma_f32_16x16x32_bf16 v[188:191], a[124:127], a[252:255], v[188:191]
 buffer_load_dwordx4 v17, s[12:15], s34 offen offset:1024 nt lds
 v_mfma_f32_16x16x32_bf16 v[184:187], a[120:123], a[232:235], v[184:187]
 ds_read_b64_tr_b16 a[114:115], v50 offset:16896
 v_add_f32_dpp v5, v5, v5 row_bcast:15 row_mask:0xa bank_mask:0xf
 v_mfma_f32_16x16x32_bf16 v[184:187], a[124:127], a[248:251], v[184:187]
 v_mfma_f32_16x16x32_bf16 v[180:183], a[120:123], a[228:231], v[180:183]
 ds_read_b64_tr_b16 a[116:117], v50 offset:20480
 v_mfma_f32_16x16x32_bf16 v[180:183], a[124:127], a[244:247], v[180:183]
 buffer_load_dwordx4 v18, s[12:15], s34 offen offset:2048 nt lds
 v_mfma_f32_16x16x32_bf16 v[176:179], a[120:123], a[224:227], v[176:179]
 ds_read_b64_tr_b16 a[118:119], v50 offset:20992
 v_mfma_f32_16x16x32_bf16 v[176:179], a[124:127], a[240:243], v[176:179]
 s_waitcnt lgkmcnt(8)
 v_mfma_f32_16x16x32_bf16 v[192:195], a[224:227], a[96:99], v[192:195]
 ds_read_b64_tr_b16 a[120:121], v51 offset:16384
 v_add_f32_dpp v4, v4, v4 row_bcast:31 row_mask:0xc bank_mask:0xf
 v_mfma_f32_16x16x32_bf16 v[192:195], a[240:243], a[100:103], v[192:195]
 v_mfma_f32_16x16x32_bf16 v[196:199], a[228:231], a[96:99], v[196:199]
 ds_read_b64_tr_b16 a[122:123], v51 offset:16896
 v_mfma_f32_16x16x32_bf16 v[196:199], a[244:247], a[100:103], v[196:199]
 buffer_load_dwordx4 v19, s[12:15], s34 offen offset:3072 nt lds
 v_mfma_f32_16x16x32_bf16 v[200:203], a[232:235], a[96:99], v[200:203]
 ds_read_b64_tr_b16 a[124:125], v51 offset:20480
 v_mfma_f32_16x16x32_bf16 v[200:203], a[248:251], a[100:103], v[200:203]
 v_mfma_f32_16x16x32_bf16 v[204:207], a[236:239], a[96:99], v[204:207]
 ds_read_b64_tr_b16 a[126:127], v51 offset:20992
 v_add_f32_dpp v5, v5, v5 row_bcast:31 row_mask:0xc bank_mask:0xf
 v_mfma_f32_16x16x32_bf16 v[204:207], a[252:255], a[100:103], v[204:207]
 s_waitcnt lgkmcnt(8)
 v_mfma_f32_16x16x32_bf16 v[220:223], a[236:239], a[104:107], v[220:223]
 ds_read_b64_tr_b16 a[96:97], v48 offset:24576
 s_add_u32 m0, s42, 0x18000
 v_mfma_f32_16x16x32_bf16 v[220:223], a[252:255], a[108:111], v[220:223]
 buffer_load_dwordx4 v20, s[12:15], s34 offen offset:0 nt lds
 v_mfma_f32_16x16x32_bf16 v[216:219], a[232:235], a[104:107], v[216:219]
 ds_read_b64_tr_b16 a[98:99], v48 offset:25088
 v_mfma_f32_16x16x32_bf16 v[216:219], a[248:251], a[108:111], v[216:219]
 v_mfma_f32_16x16x32_bf16 v[212:215], a[228:231], a[104:107], v[212:215]
 ds_read_b64_tr_b16 a[100:101], v48 offset:28672
 v_mul_f32 v4, s50, v4
 v_mfma_f32_16x16x32_bf16 v[212:215], a[244:247], a[108:111], v[212:215]
 v_mfma_f32_16x16x32_bf16 v[208:211], a[224:227], a[104:107], v[208:211]
 ds_read_b64_tr_b16 a[102:103], v48 offset:29184
 v_mfma_f32_16x16x32_bf16 v[208:211], a[240:243], a[108:111], v[208:211]
 s_waitcnt lgkmcnt(8)
 v_mfma_f32_16x16x32_bf16 v[224:227], a[224:227], a[112:115], v[224:227]
 ds_read_b64_tr_b16 a[104:105], v49 offset:24576
 v_mfma_f32_16x16x32_bf16 v[224:227], a[240:243], a[116:119], v[224:227]
 buffer_load_dwordx4 v21, s[12:15], s34 offen offset:1024 nt lds
 v_mfma_f32_16x16x32_bf16 v[228:231], a[228:231], a[112:115], v[228:231]
 ds_read_b64_tr_b16 a[106:107], v49 offset:25088
 v_mul_f32 v5, s50, v5
 v_mfma_f32_16x16x32_bf16 v[228:231], a[244:247], a[116:119], v[228:231]
 v_mfma_f32_16x16x32_bf16 v[232:235], a[232:235], a[112:115], v[232:235]
 ds_read_b64_tr_b16 a[108:109], v49 offset:28672
 v_mfma_f32_16x16x32_bf16 v[232:235], a[248:251], a[116:119], v[232:235]
 buffer_load_dwordx4 v22, s[12:15], s34 offen offset:2048 nt lds
 v_mfma_f32_16x16x32_bf16 v[236:239], a[236:239], a[112:115], v[236:239]
 ds_read_b64_tr_b16 a[110:111], v49 offset:29184
 v_mfma_f32_16x16x32_bf16 v[236:239], a[252:255], a[116:119], v[236:239]
 s_waitcnt lgkmcnt(8)
 v_mfma_f32_16x16x32_bf16 v[252:255], a[236:239], a[120:123], v[252:255]
 ds_read_b64_tr_b16 a[112:113], v50 offset:24576
 v_exp_f32 v4, -v4
 v_mfma_f32_16x16x32_bf16 v[252:255], a[252:255], a[124:127], v[252:255]
 v_mfma_f32_16x16x32_bf16 v[248:251], a[232:235], a[120:123], v[248:251]
 ds_read_b64_tr_b16 a[114:115], v50 offset:25088
 v_mfma_f32_16x16x32_bf16 v[248:251], a[248:251], a[124:127], v[248:251]
 buffer_load_dwordx4 v23, s[12:15], s34 offen offset:3072 nt lds
 v_mfma_f32_16x16x32_bf16 v[244:247], a[228:231], a[120:123], v[244:247]
 ds_read_b64_tr_b16 a[116:117], v50 offset:28672
 v_mfma_f32_16x16x32_bf16 v[244:247], a[244:247], a[124:127], v[244:247]
 v_mfma_f32_16x16x32_bf16 v[240:243], a[224:227], a[120:123], v[240:243]
 ds_read_b64_tr_b16 a[118:119], v50 offset:29184
 v_mfma_f32_16x16x32_bf16 v[240:243], a[240:243], a[124:127], v[240:243]
 v_exp_f32 v5, -v5
 s_waitcnt lgkmcnt(8)
 v_mfma_f32_16x16x32_bf16 a[0:3], a[224:227], a[96:99], a[0:3]
 ds_read_b64_tr_b16 a[120:121], v51 offset:24576
 v_mfma_f32_16x16x32_bf16 a[0:3], a[240:243], a[100:103], a[0:3]
 v_mfma_f32_16x16x32_bf16 a[4:7], a[228:231], a[96:99], a[4:7]
 ds_read_b64_tr_b16 a[122:123], v51 offset:25088
 s_mov_b32 s66, 0x400000
 v_mfma_f32_16x16x32_bf16 a[4:7], a[244:247], a[100:103], a[4:7]
 buffer_load_dword v60, v54, s[16:19], s66 offen
 v_mfma_f32_16x16x32_bf16 a[8:11], a[232:235], a[96:99], a[8:11]
 ds_read_b64_tr_b16 a[124:125], v51 offset:28672
 v_mfma_f32_16x16x32_bf16 a[8:11], a[248:251], a[100:103], a[8:11]
 v_add_f32 v4, 1.0, v4
 v_mfma_f32_16x16x32_bf16 a[12:15], a[236:239], a[96:99], a[12:15]
 ds_read_b64_tr_b16 a[126:127], v51 offset:29184
 s_mov_b32 s67, 0x300000
 v_mfma_f32_16x16x32_bf16 a[12:15], a[252:255], a[100:103], a[12:15]
 s_waitcnt lgkmcnt(8)
 v_mfma_f32_16x16x32_bf16 a[28:31], a[236:239], a[104:107], a[28:31]
 buffer_load_dword v60, v55, s[24:27], s67 offen
 v_mfma_f32_16x16x32_bf16 a[28:31], a[252:255], a[108:111], a[28:31]
 v_mfma_f32_16x16x32_bf16 a[24:27], a[232:235], a[104:107], a[24:27]
 v_mfma_f32_16x16x32_bf16 a[24:27], a[248:251], a[108:111], a[24:27]
 s_waitcnt lgkmcnt(0) vmcnt(22)
 s_barrier
 v_mfma_f32_16x16x32_bf16 a[20:23], a[228:231], a[104:107], a[20:23]
 ds_read_b64_tr_b16 a[96:97], v42 offset:0
 v_add_f32 v5, 1.0, v5
 v_mfma_f32_16x16x32_bf16 a[20:23], a[244:247], a[108:111], a[20:23]
 ds_read_b64_tr_b16 a[98:99], v42 offset:512
 v_mfma_f32_16x16x32_bf16 a[16:19], a[224:227], a[104:107], a[16:19]
 ds_read_b64_tr_b16 a[100:101], v42 offset:4096
 v_mfma_f32_16x16x32_bf16 a[16:19], a[240:243], a[108:111], a[16:19]
 ds_read_b64_tr_b16 a[102:103], v42 offset:4608
 v_mfma_f32_16x16x32_bf16 a[32:35], a[224:227], a[112:115], a[32:35]
 ds_read_b128 a[64:67], v40 offset:0
 v_mfma_f32_16x16x32_bf16 a[32:35], a[240:243], a[116:119], a[32:35]
 ds_read_b128 a[80:83], v41 offset:0
 v_rcp_f32 v4, v4
 v_mfma_f32_16x16x32_bf16 a[36:39], a[228:231], a[112:115], a[36:39]
 ds_read_b128 a[68:71], v40 offset:2048
 v_mfma_f32_16x16x32_bf16 a[36:39], a[244:247], a[116:119], a[36:39]
 ds_read_b128 a[84:87], v41 offset:2048
 v_mfma_f32_16x16x32_bf16 a[40:43], a[232:235], a[112:115], a[40:43]
 ds_read_b128 a[72:75], v40 offset:4096
 v_mfma_f32_16x16x32_bf16 a[40:43], a[248:251], a[116:119], a[40:43]
 ds_read_b128 a[88:91], v41 offset:4096
 v_mfma_f32_16x16x32_bf16 a[44:47], a[236:239], a[112:115], a[44:47]
 ds_read_b128 a[76:79], v40 offset:6144
 v_mfma_f32_16x16x32_bf16 a[44:47], a[252:255], a[116:119], a[44:47]
 ds_read_b128 a[92:95], v41 offset:6144
 v_mfma_f32_16x16x32_bf16 a[60:63], a[236:239], a[120:123], a[60:63]
 ds_read_b64_tr_b16 a[104:105], v43 offset:0
 v_rcp_f32 v5, v5
 v_mfma_f32_16x16x32_bf16 a[60:63], a[252:255], a[124:127], a[60:63]
 ds_read_b64_tr_b16 a[106:107], v43 offset:512
 v_mfma_f32_16x16x32_bf16 a[56:59], a[232:235], a[120:123], a[56:59]
 ds_read_b64_tr_b16 a[108:109], v43 offset:4096
 v_mfma_f32_16x16x32_bf16 a[56:59], a[248:251], a[124:127], a[56:59]
 ds_read_b64_tr_b16 a[110:111], v43 offset:4608
 v_mfma_f32_16x16x32_bf16 a[52:55], a[228:231], a[120:123], a[52:55]
 ds_read_b64_tr_b16 a[112:113], v44 offset:0
 v_mfma_f32_16x16x32_bf16 a[52:55], a[244:247], a[124:127], a[52:55]
 ds_read_b64_tr_b16 a[114:115], v44 offset:512
 v_mfma_f32_16x16x32_bf16 a[48:51], a[224:227], a[120:123], a[48:51]
 ds_read_b64_tr_b16 a[116:117], v44 offset:4096
 v_mfma_f32_16x16x32_bf16 a[48:51], a[240:243], a[124:127], a[48:51]
 ds_read_b64_tr_b16 a[118:119], v44 offset:4608
F_step6:
 s_waitcnt lgkmcnt(8)
 v_mfma_f32_16x16x32_bf16 v[64:67], a[96:99], a[64:67], v[64:67]
 ds_read_b64_tr_b16 a[120:121], v45 offset:0
 v_mfma_f32_16x16x32_bf16 v[64:67], a[100:103], a[80:83], v[64:67]
 v_mfma_f32_16x16x32_bf16 v[68:71], a[96:99], a[68:71], v[68:71]
 ds_read_b64_tr_b16 a[122:123], v45 offset:512
 v_accvgpr_read_b32 v61, a152
 v_mfma_f32_16x16x32_bf16 v[68:71], a[100:103], a[84:87], v[68:71]
 s_add_u32 m0, s46, 0
 s_xor_b32 s33, s99, 0
 v_mfma_f32_16x16x32_bf16 v[72:75], a[96:99], a[72:75], v[72:75]
 ds_read_b64_tr_b16 a[124:125], v45 offset:4096
 v_mfma_f32_16x16x32_bf16 v[72:75], a[100:103], a[88:91], v[72:75]
 buffer_load_dwordx4 v24, s[28:31], s33 offen offset:0 lds
 v_mfma_f32_16x16x32_bf16 v[76:79], a[96:99], a[76:79], v[76:79]
 ds_read_b64_tr_b16 a[126:127], v45 offset:4608
 v_mfma_f32_16x16x32_bf16 v[76:79], a[100:103], a[92:95], v[76:79]
 v_accvgpr_read_b32 v62, a153
 s_waitcnt lgkmcnt(8)
 v_mfma_f32_16x16x32_bf16 v[92:95], a[104:107], a[76:79], v[92:95]
 ds_read_b64_tr_b16 a[96:97], v42 offset:8192
 v_mfma_f32_16x16x32_bf16 v[92:95], a[108:111], a[92:95], v[92:95]
 buffer_load_dwordx4 v25, s[28:31], s33 offen offset:1024 lds
 v_mfma_f32_16x16x32_bf16 v[88:91], a[104:107], a[72:75], v[88:91]
 ds_read_b64_tr_b16 a[98:99], v42 offset:8704
 v_mfma_f32_16x16x32_bf16 v[88:91], a[108:111], a[88:91], v[88:91]
 buffer_store_dwordx2 v[4:5], v3, s[20:23], s76 offen sc1
 v_mfma_f32_16x16x32_bf16 v[84:87], a[104:107], a[68:71], v[84:87]
 ds_read_b64_tr_b16 a[100:101], v42 offset:12288
 v_lshl_or_b32 v16, v62, 16, v61
 v_mfma_f32_16x16x32_bf16 v[84:87], a[108:111], a[84:87], v[84:87]
 v_mfma_f32_16x16x32_bf16 v[80:83], a[104:107], a[64:67], v[80:83]
 ds_read_b64_tr_b16 a[102:103], v42 offset:12800
 v_mfma_f32_16x16x32_bf16 v[80:83], a[108:111], a[80:83], v[80:83]
 s_waitcnt lgkmcnt(8)
 v_mfma_f32_16x16x32_bf16 v[96:99], a[112:115], a[64:67], v[96:99]
 ds_read_b64_tr_b16 a[104:105], v43 offset:8192
 v_mfma_f32_16x16x32_bf16 v[96:99], a[116:119], a[80:83], v[96:99]
 buffer_load_dwordx4 v26, s[28:31], s33 offen offset:2048 lds
 v_mfma_f32_16x16x32_bf16 v[100:103], a[112:115], a[68:71], v[100:103]
 ds_read_b64_tr_b16 a[106:107], v43 offset:8704
 v_accvgpr_read_b32 v61, a154
 v_mfma_f32_16x16x32_bf16 v[100:103], a[116:119], a[84:87], v[100:103]
 v_mfma_f32_16x16x32_bf16 v[104:107], a[112:115], a[72:75], v[104:107]
 ds_read_b64_tr_b16 a[108:109], v43 offset:12288
 v_mfma_f32_16x16x32_bf16 v[104:107], a[116:119], a[88:91], v[104:107]
 buffer_load_dwordx4 v27, s[28:31], s33 offen offset:3072 lds
 v_mfma_f32_16x16x32_bf16 v[108:111], a[112:115], a[76:79], v[108:111]
 ds_read_b64_tr_b16 a[110:111], v43 offset:12800
 v_accvgpr_read_b32 v62, a155
 v_mfma_f32_16x16x32_bf16 v[108:111], a[116:119], a[92:95], v[108:111]
 s_waitcnt lgkmcnt(8)
 v_mfma_f32_16x16x32_bf16 v[124:127], a[120:123], a[76:79], v[124:127]
 ds_read_b64_tr_b16 a[112:113], v44 offset:8192
 v_mfma_f32_16x16x32_bf16 v[124:127], a[124:127], a[92:95], v[124:127]
 v_mfma_f32_16x16x32_bf16 v[120:123], a[120:123], a[72:75], v[120:123]
 ds_read_b64_tr_b16 a[114:115], v44 offset:8704
 v_mfma_f32_16x16x32_bf16 v[120:123], a[124:127], a[88:91], v[120:123]
 s_add_u32 m0, s46, 4096
 v_lshl_or_b32 v17, v62, 16, v61
 v_mfma_f32_16x16x32_bf16 v[116:119], a[120:123], a[68:71], v[116:119]
 ds_read_b64_tr_b16 a[116:117], v44 offset:12288
 v_mfma_f32_16x16x32_bf16 v[116:119], a[124:127], a[84:87], v[116:119]
 buffer_load_dwordx4 v28, s[28:31], s33 offen offset:0 lds
 v_mfma_f32_16x16x32_bf16 v[112:115], a[120:123], a[64:67], v[112:115]
 ds_read_b64_tr_b16 a[118:119], v44 offset:12800
 v_mfma_f32_16x16x32_bf16 v[112:115], a[124:127], a[80:83], v[112:115]
 s_waitcnt lgkmcnt(8)
 v_mfma_f32_16x16x32_bf16 v[128:131], a[96:99], a[64:67], v[128:131]
 ds_read_b64_tr_b16 a[120:121], v45 offset:8192
 v_mfma_f32_16x16x32_bf16 v[128:131], a[100:103], a[80:83], v[128:131]
 v_accvgpr_read_b32 v61, a156
 v_mfma_f32_16x16x32_bf16 v[132:135], a[96:99], a[68:71], v[132:135]
 ds_read_b64_tr_b16 a[122:123], v45 offset:8704
 v_mfma_f32_16x16x32_bf16 v[132:135], a[100:103], a[84:87], v[132:135]
 buffer_load_dwordx4 v29, s[28:31], s33 offen offset:1024 lds
 v_mfma_f32_16x16x32_bf16 v[136:139], a[96:99], a[72:75], v[136:139]
 ds_read_b64_tr_b16 a[124:125], v45 offset:12288
 v_mfma_f32_16x16x32_bf16 v[136:139], a[100:103], a[88:91], v[136:139]
 v_mfma_f32_16x16x32_bf16 v[140:143], a[96:99], a[76:79], v[140:143]
 ds_read_b64_tr_b16 a[126:127], v45 offset:12800
 v_accvgpr_read_b32 v62, a157
 v_mfma_f32_16x16x32_bf16 v[140:143], a[100:103], a[92:95], v[140:143]
 s_waitcnt lgkmcnt(8)
 v_mfma_f32_16x16x32_bf16 v[156:159], a[104:107], a[76:79], v[156:159]
 ds_read_b64_tr_b16 a[96:97], v42 offset:16384
 v_mfma_f32_16x16x32_bf16 v[156:159], a[108:111], a[92:95], v[156:159]
 buffer_load_dwordx4 v30, s[28:31], s33 offen offset:2048 lds
 v_mfma_f32_16x16x32_bf16 v[152:155], a[104:107], a[72:75], v[152:155]
 ds_read_b64_tr_b16 a[98:99], v42 offset:16896
 v_mfma_f32_16x16x32_bf16 v[152:155], a[108:111], a[88:91], v[152:155]
 v_lshl_or_b32 v18, v62, 16, v61
 v_mfma_f32_16x16x32_bf16 v[148:151], a[104:107], a[68:71], v[148:151]
 ds_read_b64_tr_b16 a[100:101], v42 offset:20480
 v_mfma_f32_16x16x32_bf16 v[148:151], a[108:111], a[84:87], v[148:151]
 v_mfma_f32_16x16x32_bf16 v[144:147], a[104:107], a[64:67], v[144:147]
 ds_read_b64_tr_b16 a[102:103], v42 offset:20992
 v_mfma_f32_16x16x32_bf16 v[144:147], a[108:111], a[80:83], v[144:147]
 s_waitcnt lgkmcnt(8)
 v_mfma_f32_16x16x32_bf16 v[160:163], a[112:115], a[64:67], v[160:163]
 ds_read_b64_tr_b16 a[104:105], v43 offset:16384
 v_accvgpr_read_b32 v61, a158
 v_mfma_f32_16x16x32_bf16 v[160:163], a[116:119], a[80:83], v[160:163]
 buffer_load_dwordx4 v31, s[28:31], s33 offen offset:3072 lds
 v_mfma_f32_16x16x32_bf16 v[164:167], a[112:115], a[68:71], v[164:167]
 ds_read_b64_tr_b16 a[106:107], v43 offset:16896
 v_mfma_f32_16x16x32_bf16 v[164:167], a[116:119], a[84:87], v[164:167]
 v_mfma_f32_16x16x32_bf16 v[168:171], a[112:115], a[72:75], v[168:171]
 ds_read_b64_tr_b16 a[108:109], v43 offset:20480
 s_add_u32 m0, s43, 0x20000
 v_mfma_f32_16x16x32_bf16 v[168:171], a[116:119], a[88:91], v[168:171]
 s_xor_b32 s34, s98, 0x0
 v_accvgpr_read_b32 v62, a159
 v_mfma_f32_16x16x32_bf16 v[172:175], a[112:115], a[76:79], v[172:175]
 ds_read_b64_tr_b16 a[110:111], v43 offset:20992
 v_mfma_f32_16x16x32_bf16 v[172:175], a[116:119], a[92:95], v[172:175]
 s_waitcnt lgkmcnt(8)
 v_mfma_f32_16x16x32_bf16 v[188:191], a[120:123], a[76:79], v[188:191]
 ds_read_b64_tr_b16 a[112:113], v44 offset:16384
 v_mfma_f32_16x16x32_bf16 v[188:191], a[124:127], a[92:95], v[188:191]
 buffer_load_dwordx4 v32, s[16:19], s34 offen offset:0 lds
 v_mfma_f32_16x16x32_bf16 v[184:187], a[120:123], a[72:75], v[184:187]
 ds_read_b64_tr_b16 a[114:115], v44 offset:16896
 v_lshl_or_b32 v19, v62, 16, v61
 v_mfma_f32_16x16x32_bf16 v[184:187], a[124:127], a[88:91], v[184:187]
 buffer_load_dwordx4 v33, s[16:19], s34 offen offset:1024 lds
 v_mfma_f32_16x16x32_bf16 v[180:183], a[120:123], a[68:71], v[180:183]
 ds_read_b64_tr_b16 a[116:117], v44 offset:20480
 v_mfma_f32_16x16x32_bf16 v[180:183], a[124:127], a[84:87], v[180:183]
 v_mfma_f32_16x16x32_bf16 v[176:179], a[120:123], a[64:67], v[176:179]
 ds_read_b64_tr_b16 a[118:119], v44 offset:20992
 v_mfma_f32_16x16x32_bf16 v[176:179], a[124:127], a[80:83], v[176:179]
 s_waitcnt lgkmcnt(8)
 v_mfma_f32_16x16x32_bf16 v[192:195], a[64:67], a[96:99], v[192:195]
 ds_read_b64_tr_b16 a[120:121], v45 offset:16384
 v_accvgpr_read_b32 v61, a160
 v_mfma_f32_16x16x32_bf16 v[192:195], a[80:83], a[100:103], v[192:195]
 buffer_load_dwordx4 v34, s[16:19], s34 offen offset:2048 lds
 v_mfma_f32_16x16x32_bf16 v[196:199], a[68:71], a[96:99], v[196:199]
 ds_read_b64_tr_b16 a[122:123], v45 offset:16896
 v_mfma_f32_16x16x32_bf16 v[196:199], a[84:87], a[100:103], v[196:199]
 v_mfma_f32_16x16x32_bf16 v[200:203], a[72:75], a[96:99], v[200:203]
 ds_read_b64_tr_b16 a[124:125], v45 offset:20480
 v_mfma_f32_16x16x32_bf16 v[200:203], a[88:91], a[100:103], v[200:203]
 v_accvgpr_read_b32 v62, a161
 v_mfma_f32_16x16x32_bf16 v[204:207], a[76:79], a[96:99], v[204:207]
 ds_read_b64_tr_b16 a[126:127], v45 offset:20992
 v_mfma_f32_16x16x32_bf16 v[204:207], a[92:95], a[100:103], v[204:207]
 s_waitcnt lgkmcnt(8)
 v_mfma_f32_16x16x32_bf16 v[220:223], a[76:79], a[104:107], v[220:223]
 ds_read_b64_tr_b16 a[96:97], v42 offset:24576
 v_mfma_f32_16x16x32_bf16 v[220:223], a[92:95], a[108:111], v[220:223]
 buffer_load_dwordx4 v35, s[16:19], s34 offen offset:3072 lds
 v_mfma_f32_16x16x32_bf16 v[216:219], a[72:75], a[104:107], v[216:219]
 ds_read_b64_tr_b16 a[98:99], v42 offset:25088
 v_lshl_or_b32 v20, v62, 16, v61
 v_mfma_f32_16x16x32_bf16 v[216:219], a[88:91], a[108:111], v[216:219]
 v_mfma_f32_16x16x32_bf16 v[212:215], a[68:71], a[104:107], v[212:215]
 ds_read_b64_tr_b16 a[100:101], v42 offset:28672
 v_mfma_f32_16x16x32_bf16 v[212:215], a[84:87], a[108:111], v[212:215]
 s_add_u32 m0, s44, 0x20000
 s_mov_b32 s35, 0x0
 v_mfma_f32_16x16x32_bf16 v[208:211], a[64:67], a[104:107], v[208:211]
 ds_read_b64_tr_b16 a[102:103], v42 offset:29184
 v_mfma_f32_16x16x32_bf16 v[208:211], a[80:83], a[108:111], v[208:211]
 v_accvgpr_read_b32 v61, a162
 s_waitcnt lgkmcnt(8)
 v_mfma_f32_16x16x32_bf16 v[224:227], a[64:67], a[112:115], v[224:227]
 ds_read_b64_tr_b16 a[104:105], v43 offset:24576
 v_mfma_f32_16x16x32_bf16 v[224:227], a[80:83], a[116:119], v[224:227]
 buffer_load_dwordx4 v36, s[24:27], s35 offen offset:0 lds
 v_mfma_f32_16x16x32_bf16 v[228:231], a[68:71], a[112:115], v[228:231]
 ds_read_b64_tr_b16 a[106:107], v43 offset:25088
 v_mfma_f32_16x16x32_bf16 v[228:231], a[84:87], a[116:119], v[228:231]
 buffer_load_dwordx4 v37, s[24:27], s35 offen offset:1024 lds
 v_mfma_f32_16x16x32_bf16 v[232:235], a[72:75], a[112:115], v[232:235]
 ds_read_b64_tr_b16 a[108:109], v43 offset:28672
 v_accvgpr_read_b32 v62, a163
 v_mfma_f32_16x16x32_bf16 v[232:235], a[88:91], a[116:119], v[232:235]
 v_mfma_f32_16x16x32_bf16 v[236:239], a[76:79], a[112:115], v[236:239]
 ds_read_b64_tr_b16 a[110:111], v43 offset:29184
 v_mfma_f32_16x16x32_bf16 v[236:239], a[92:95], a[116:119], v[236:239]
 s_waitcnt lgkmcnt(8)
 v_mfma_f32_16x16x32_bf16 v[252:255], a[76:79], a[120:123], v[252:255]
 ds_read_b64_tr_b16 a[112:113], v44 offset:24576
 v_mfma_f32_16x16x32_bf16 v[252:255], a[92:95], a[124:127], v[252:255]
 buffer_load_dwordx4 v38, s[24:27], s35 offen offset:2048 lds
 v_mfma_f32_16x16x32_bf16 v[248:251], a[72:75], a[120:123], v[248:251]
 ds_read_b64_tr_b16 a[114:115], v44 offset:25088
 v_lshl_or_b32 v21, v62, 16, v61
 v_mfma_f32_16x16x32_bf16 v[248:251], a[88:91], a[124:127], v[248:251]
 v_mfma_f32_16x16x32_bf16 v[244:247], a[68:71], a[120:123], v[244:247]
 ds_read_b64_tr_b16 a[116:117], v44 offset:28672
 v_mfma_f32_16x16x32_bf16 v[244:247], a[84:87], a[124:127], v[244:247]
 v_mfma_f32_16x16x32_bf16 v[240:243], a[64:67], a[120:123], v[240:243]
 ds_read_b64_tr_b16 a[118:119], v44 offset:29184
 v_mfma_f32_16x16x32_bf16 v[240:243], a[80:83], a[124:127], v[240:243]
 v_accvgpr_read_b32 v61, a164
 s_waitcnt lgkmcnt(8)
 v_mfma_f32_16x16x32_bf16 a[0:3], a[64:67], a[96:99], a[0:3]
 ds_read_b64_tr_b16 a[120:121], v45 offset:24576
 v_mfma_f32_16x16x32_bf16 a[0:3], a[80:83], a[100:103], a[0:3]
 v_mfma_f32_16x16x32_bf16 a[4:7], a[68:71], a[96:99], a[4:7]
 ds_read_b64_tr_b16 a[122:123], v45 offset:25088
 s_mov_b32 s66, 0x500000
 v_mfma_f32_16x16x32_bf16 a[4:7], a[84:87], a[100:103], a[4:7]
 buffer_load_dword v60, v54, s[16:19], s66 offen
 v_mfma_f32_16x16x32_bf16 a[8:11], a[72:75], a[96:99], a[8:11]
 ds_read_b64_tr_b16 a[124:125], v45 offset:28672
 v_accvgpr_read_b32 v62, a165
 v_mfma_f32_16x16x32_bf16 a[8:11], a[88:91], a[100:103], a[8:11]
 v_mfma_f32_16x16x32_bf16 a[12:15], a[76:79], a[96:99], a[12:15]
 ds_read_b64_tr_b16 a[126:127], v45 offset:29184
 s_mov_b32 s67, 0x3c0000
 v_mfma_f32_16x16x32_bf16 a[12:15], a[92:95], a[100:103], a[12:15]
 s_waitcnt lgkmcnt(8)
 v_mfma_f32_16x16x32_bf16 a[28:31], a[76:79], a[104:107], a[28:31]
 buffer_load_dword v60, v55, s[24:27], s67 offen
 v_mfma_f32_16x16x32_bf16 a[28:31], a[92:95], a[108:111], a[28:31]
 v_lshl_or_b32 v22, v62, 16, v61
 v_mfma_f32_16x16x32_bf16 a[24:27], a[72:75], a[104:107], a[24:27]
 v_mfma_f32_16x16x32_bf16 a[24:27], a[88:91], a[108:111], a[24:27]
 s_waitcnt lgkmcnt(0) vmcnt(20)
 s_barrier
 v_mfma_f32_16x16x32_bf16 a[20:23], a[68:71], a[104:107], a[20:23]
 ds_read_b64_tr_b16 a[96:97], v42 offset:49152
 v_mfma_f32_16x16x32_bf16 a[20:23], a[84:87], a[108:111], a[20:23]
 ds_read_b64_tr_b16 a[98:99], v42 offset:49664
 v_mfma_f32_16x16x32_bf16 a[16:19], a[64:67], a[104:107], a[16:19]
 ds_read_b64_tr_b16 a[100:101], v42 offset:53248
 v_accvgpr_read_b32 v61, a166
 v_mfma_f32_16x16x32_bf16 a[16:19], a[80:83], a[108:111], a[16:19]
 ds_read_b64_tr_b16 a[102:103], v42 offset:53760
 v_mfma_f32_16x16x32_bf16 a[32:35], a[64:67], a[112:115], a[32:35]
 ds_read_b128 a[224:227], v40 offset:8192
 v_mfma_f32_16x16x32_bf16 a[32:35], a[80:83], a[116:119], a[32:35]
 ds_read_b128 a[240:243], v41 offset:8192
 v_mfma_f32_16x16x32_bf16 a[36:39], a[68:71], a[112:115], a[36:39]
 ds_read_b128 a[228:231], v40 offset:10240
 v_mfma_f32_16x16x32_bf16 a[36:39], a[84:87], a[116:119], a[36:39]
 ds_read_b128 a[244:247], v41 offset:10240
 v_accvgpr_read_b32 v62, a167
 v_mfma_f32_16x16x32_bf16 a[40:43], a[72:75], a[112:115], a[40:43]
 ds_read_b128 a[232:235], v40 offset:12288
 v_mfma_f32_16x16x32_bf16 a[40:43], a[88:91], a[116:119], a[40:43]
 ds_read_b128 a[248:251], v41 offset:12288
 v_mfma_f32_16x16x32_bf16 a[44:47], a[76:79], a[112:115], a[44:47]
 ds_read_b128 a[236:239], v40 offset:14336
 v_mfma_f32_16x16x32_bf16 a[44:47], a[92:95], a[116:119], a[44:47]
 ds_read_b128 a[252:255], v41 offset:14336
 v_mfma_f32_16x16x32_bf16 a[60:63], a[76:79], a[120:123], a[60:63]
 ds_read_b64_tr_b16 a[104:105], v43 offset:49152
 v_lshl_or_b32 v23, v62, 16, v61
 v_mfma_f32_16x16x32_bf16 a[60:63], a[92:95], a[124:127], a[60:63]
 ds_read_b64_tr_b16 a[106:107], v43 offset:49664
 v_mfma_f32_16x16x32_bf16 a[56:59], a[72:75], a[120:123], a[56:59]
 ds_read_b64_tr_b16 a[108:109], v43 offset:53248
 v_mfma_f32_16x16x32_bf16 a[56:59], a[88:91], a[124:127], a[56:59]
 ds_read_b64_tr_b16 a[110:111], v43 offset:53760
 v_mfma_f32_16x16x32_bf16 a[52:55], a[68:71], a[120:123], a[52:55]
 ds_read_b64_tr_b16 a[112:113], v44 offset:49152
 v_mfma_f32_16x16x32_bf16 a[52:55], a[84:87], a[124:127], a[52:55]
 ds_read_b64_tr_b16 a[114:115], v44 offset:49664
 v_mfma_f32_16x16x32_bf16 a[48:51], a[64:67], a[120:123], a[48:51]
 ds_read_b64_tr_b16 a[116:117], v44 offset:53248
 v_mfma_f32_16x16x32_bf16 a[48:51], a[80:83], a[124:127], a[48:51]
 ds_read_b64_tr_b16 a[118:119], v44 offset:53760
F_step7:
 s_waitcnt lgkmcnt(8)
 v_mfma_f32_16x16x32_bf16 v[192:195], a[224:227], a[96:99], v[192:195]
 ds_read_b64_tr_b16 a[120:121], v45 offset:49152
 v_mfma_f32_16x16x32_bf16 v[192:195], a[240:243], a[100:103], v[192:195]
 v_mfma_f32_16x16x32_bf16 v[196:199], a[228:231], a[96:99], v[196:199]
 ds_read_b64_tr_b16 a[122:123], v45 offset:49664
 v_mfma_f32_16x16x32_bf16 v[196:199], a[244:247], a[100:103], v[196:199]
 s_add_u32 m0, s46, 8192
 s_xor_b32 s33, s99, 128
 v_mfma_f32_16x16x32_bf16 v[200:203], a[232:235], a[96:99], v[200:203]
 ds_read_b64_tr_b16 a[124:125], v45 offset:53248
 v_mfma_f32_16x16x32_bf16 v[200:203], a[248:251], a[100:103], v[200:203]
 buffer_load_dwordx4 v24, s[28:31], s33 offen offset:0 lds
 v_mfma_f32_16x16x32_bf16 v[204:207], a[236:239], a[96:99], v[204:207]
 ds_read_b64_tr_b16 a[126:127], v45 offset:53760
 v_mfma_f32_16x16x32_bf16 v[204:207], a[252:255], a[100:103], v[204:207]
 s_waitcnt lgkmcnt(8)
 v_mfma_f32_16x16x32_bf16 v[220:223], a[236:239], a[104:107], v[220:223]
 ds_read_b64_tr_b16 a[96:97], v42 offset:57344
 v_mfma_f32_16x16x32_bf16 v[220:223], a[252:255], a[108:111], v[220:223]
 buffer_load_dwordx4 v25, s[28:31], s33 offen offset:1024 lds
 v_mfma_f32_16x16x32_bf16 v[216:219], a[232:235], a[104:107], v[216:219]
 ds_read_b64_tr_b16 a[98:99], v42 offset:57856
 v_mfma_f32_16x16x32_bf16 v[216:219], a[248:251], a[108:111], v[216:219]
 v_mfma_f32_16x16x32_bf16 v[212:215], a[228:231], a[104:107], v[212:215]
 ds_read_b64_tr_b16 a[100:101], v42 offset:61440
 v_cvt_pk_bf16_f32 v192, v192, v193
 v_mfma_f32_16x16x32_bf16 v[212:215], a[244:247], a[108:111], v[212:215]
 buffer_load_dwordx4 v26, s[28:31], s33 offen offset:2048 lds
 v_mfma_f32_16x16x32_bf16 v[208:211], a[224:227], a[104:107], v[208:211]
 ds_read_b64_tr_b16 a[102:103], v42 offset:61952
 v_cvt_pk_bf16_f32 v193, v194, v195
 v_mfma_f32_16x16x32_bf16 v[208:211], a[240:243], a[108:111], v[208:211]
 v_cvt_pk_bf16_f32 v194, v196, v197
 s_waitcnt lgkmcnt(8)
 v_mfma_f32_16x16x32_bf16 v[224:227], a[224:227], a[112:115], v[224:227]
 ds_read_b64_tr_b16 a[104:105], v43 offset:57344
 v_cvt_pk_bf16_f32 v195, v198, v199
 v_mfma_f32_16x16x32_bf16 v[224:227], a[240:243], a[116:119], v[224:227]
 v_cvt_pk_bf16_f32 v200, v200, v201
 v_cvt_pk_bf16_f32 v201, v202, v203
 v_mfma_f32_16x16x32_bf16 v[228:231], a[228:231], a[112:115], v[228:231]
 ds_read_b64_tr_b16 a[106:107], v43 offset:57856
 v_cvt_pk_bf16_f32 v202, v204, v205
 v_mfma_f32_16x16x32_bf16 v[228:231], a[244:247], a[116:119], v[228:231]
 buffer_load_dwordx4 v27, s[28:31], s33 offen offset:3072 lds
 v_mfma_f32_16x16x32_bf16 v[232:235], a[232:235], a[112:115], v[232:235]
 ds_read_b64_tr_b16 a[108:109], v43 offset:61440
 v_cvt_pk_bf16_f32 v203, v206, v207
 v_mfma_f32_16x16x32_bf16 v[232:235], a[248:251], a[116:119], v[232:235]
 v_cvt_pk_bf16_f32 v208, v208, v209
 v_cvt_pk_bf16_f32 v209, v210, v211
 v_mfma_f32_16x16x32_bf16 v[236:239], a[236:239], a[112:115], v[236:239]
 ds_read_b64_tr_b16 a[110:111], v43 offset:61952
 v_cvt_pk_bf16_f32 v210, v212, v213
 v_mfma_f32_16x16x32_bf16 v[236:239], a[252:255], a[116:119], v[236:239]
 v_cvt_pk_bf16_f32 v211, v214, v215
 s_waitcnt lgkmcnt(8)
 v_mfma_f32_16x16x32_bf16 v[252:255], a[236:239], a[120:123], v[252:255]
 ds_read_b64_tr_b16 a[112:113], v44 offset:57344
 s_add_u32 m0, s46, 12288
 v_mfma_f32_16x16x32_bf16 v[252:255], a[252:255], a[124:127], v[252:255]
 buffer_load_dwordx4 v28, s[28:31], s33 offen offset:0 lds
 v_mfma_f32_16x16x32_bf16 v[248:251], a[232:235], a[120:123], v[248:251]
 ds_read_b64_tr_b16 a[114:115], v44 offset:57856
 v_cvt_pk_bf16_f32 v216, v216, v217
 v_mfma_f32_16x16x32_bf16 v[248:251], a[248:251], a[124:127], v[248:251]
 v_cvt_pk_bf16_f32 v217, v218, v219
 v_cvt_pk_bf16_f32 v218, v220, v221
 v_mfma_f32_16x16x32_bf16 v[244:247], a[228:231], a[120:123], v[244:247]
 ds_read_b64_tr_b16 a[116:117], v44 offset:61440
 v_cvt_pk_bf16_f32 v219, v222, v223
 v_mfma_f32_16x16x32_bf16 v[244:247], a[244:247], a[124:127], v[244:247]
 v_cvt_pk_bf16_f32 v224, v224, v225
 v_cvt_pk_bf16_f32 v225, v226, v227
 v_mfma_f32_16x16x32_bf16 v[240:243], a[224:227], a[120:123], v[240:243]
 ds_read_b64_tr_b16 a[118:119], v44 offset:61952
 v_cvt_pk_bf16_f32 v226, v228, v229
 v_mfma_f32_16x16x32_bf16 v[240:243], a[240:243], a[124:127], v[240:243]
 v_cvt_pk_bf16_f32 v227, v230, v231
 s_waitcnt lgkmcnt(8)
 v_mfma_f32_16x16x32_bf16 a[0:3], a[224:227], a[96:99], a[0:3]
 ds_read_b64_tr_b16 a[120:121], v45 offset:57344
 v_cvt_pk_bf16_f32 v232, v232, v233
 v_mfma_f32_16x16x32_bf16 a[0:3], a[240:243], a[100:103], a[0:3]
 buffer_load_dwordx4 v29, s[28:31], s33 offen offset:1024 lds
 v_mfma_f32_16x16x32_bf16 a[4:7], a[228:231], a[96:99], a[4:7]
 ds_read_b64_tr_b16 a[122:123], v45 offset:57856
 v_cvt_pk_bf16_f32 v233, v234, v235
 v_mfma_f32_16x16x32_bf16 a[4:7], a[244:247], a[100:103], a[4:7]
 buffer_load_dwordx4 v30, s[28:31], s33 offen offset:2048 lds
 v_mfma_f32_16x16x32_bf16 a[8:11], a[232:235], a[96:99], a[8:11]
 ds_read_b64_tr_b16 a[124:125], v45 offset:61440
 v_cvt_pk_bf16_f32 v234, v236, v237
 v_mfma_f32_16x16x32_bf16 a[8:11], a[248:251], a[100:103], a[8:11]
 v_cvt_pk_bf16_f32 v235, v238, v239
 v_cvt_pk_bf16_f32 v240, v240, v241
 v_mfma_f32_16x16x32_bf16 a[12:15], a[236:239], a[96:99], a[12:15]
 ds_read_b64_tr_b16 a[126:127], v45 offset:61952
 v_cvt_pk_bf16_f32 v241, v242, v243
 v_mfma_f32_16x16x32_bf16 a[12:15], a[252:255], a[100:103], a[12:15]
 v_cvt_pk_bf16_f32 v242, v244, v245
 s_waitcnt lgkmcnt(8)
 v_mfma_f32_16x16x32_bf16 a[28:31], a[236:239], a[104:107], a[28:31]
 ds_read_b64_tr_b16 a[96:97], v42 offset:32768
 v_cvt_pk_bf16_f32 v243, v246, v247
 v_mfma_f32_16x16x32_bf16 a[28:31], a[252:255], a[108:111], a[28:31]
 buffer_load_dwordx4 v31, s[28:31], s33 offen offset:3072 lds
 v_mfma_f32_16x16x32_bf16 a[24:27], a[232:235], a[104:107], a[24:27]
 ds_read_b64_tr_b16 a[98:99], v42 offset:33280
 v_cvt_pk_bf16_f32 v248, v248, v249
 v_mfma_f32_16x16x32_bf16 a[24:27], a[248:251], a[108:111], a[24:27]
 v_cvt_pk_bf16_f32 v249, v250, v251
 v_mfma_f32_16x16x32_bf16 a[20:23], a[228:231], a[104:107], a[20:23]
 ds_read_b64_tr_b16 a[100:101], v42 offset:36864
 v_cvt_pk_bf16_f32 v250, v252, v253
 v_mfma_f32_16x16x32_bf16 a[20:23], a[244:247], a[108:111], a[20:23]
 v_cvt_pk_bf16_f32 v251, v254, v255
 v_mfma_f32_16x16x32_bf16 a[16:19], a[224:227], a[104:107], a[16:19]
 ds_read_b64_tr_b16 a[102:103], v42 offset:37376
 s_add_u32 m0, s43, 0x10000
 v_mfma_f32_16x16x32_bf16 a[16:19], a[240:243], a[108:111], a[16:19]
 s_xor_b32 s34, s98, 0x80000
 s_waitcnt lgkmcnt(8)
 v_mfma_f32_16x16x32_bf16 a[32:35], a[224:227], a[112:115], a[32:35]
 ds_read_b64_tr_b16 a[104:105], v43 offset:32768
 v_accvgpr_read_b32 v8, a0
 v_mfma_f32_16x16x32_bf16 a[32:35], a[240:243], a[116:119], a[32:35]
 buffer_load_dwordx4 v32, s[16:19], s34 offen offset:0 lds
 v_mfma_f32_16x16x32_bf16 a[36:39], a[228:231], a[112:115], a[36:39]
 ds_read_b64_tr_b16 a[106:107], v43 offset:33280
 v_accvgpr_read_b32 v9, a1
 v_mfma_f32_16x16x32_bf16 a[36:39], a[244:247], a[116:119], a[36:39]
 buffer_load_dwordx4 v33, s[16:19], s34 offen offset:1024 lds
 v_mfma_f32_16x16x32_bf16 a[40:43], a[232:235], a[112:115], a[40:43]
 ds_read_b64_tr_b16 a[108:109], v43 offset:36864
 v_accvgpr_read_b32 v10, a2
 v_mfma_f32_16x16x32_bf16 a[40:43], a[248:251], a[116:119], a[40:43]
 v_accvgpr_read_b32 v11, a3
 v_accvgpr_read_b32 v12, a4
 v_mfma_f32_16x16x32_bf16 a[44:47], a[236:239], a[112:115], a[44:47]
 ds_read_b64_tr_b16 a[110:111], v43 offset:37376
 v_accvgpr_read_b32 v13, a5
 v_mfma_f32_16x16x32_bf16 a[44:47], a[252:255], a[116:119], a[44:47]
 v_accvgpr_read_b32 v14, a6
 s_waitcnt lgkmcnt(8)
 v_mfma_f32_16x16x32_bf16 a[60:63], a[236:239], a[120:123], a[60:63]
 ds_read_b64_tr_b16 a[112:113], v44 offset:32768
 v_accvgpr_read_b32 v15, a7
 v_mfma_f32_16x16x32_bf16 a[60:63], a[252:255], a[124:127], a[60:63]
 buffer_load_dwordx4 v34, s[16:19], s34 offen offset:2048 lds
 v_mfma_f32_16x16x32_bf16 a[56:59], a[232:235], a[120:123], a[56:59]
 ds_read_b64_tr_b16 a[114:115], v44 offset:33280
 v_cvt_pk_bf16_f32 v196, v8, v9
 v_mfma_f32_16x16x32_bf16 a[56:59], a[248:251], a[124:127], a[56:59]
 v_cvt_pk_bf16_f32 v197, v10, v11
 v_mfma_f32_16x16x32_bf16 a[52:55], a[228:231], a[120:123], a[52:55]
 ds_read_b64_tr_b16 a[116:117], v44 offset:36864
 v_cvt_pk_bf16_f32 v198, v12, v13
 v_mfma_f32_16x16x32_bf16 a[52:55], a[244:247], a[124:127], a[52:55]
 v_cvt_pk_bf16_f32 v199, v14, v15
 v_mfma_f32_16x16x32_bf16 a[48:51], a[224:227], a[120:123], a[48:51]
 ds_read_b64_tr_b16 a[118:119], v44 offset:37376
 v_accvgpr_read_b32 v8, a8
 v_mfma_f32_16x16x32_bf16 a[48:51], a[240:243], a[124:127], a[48:51]
 v_accvgpr_read_b32 v9, a9
 s_waitcnt lgkmcnt(8)
 v_mfma_f32_16x16x32_bf16 v[64:67], a[96:99], a[224:227], v[64:67]
 ds_read_b64_tr_b16 a[120:121], v45 offset:32768
 v_accvgpr_read_b32 v10, a10
 v_mfma_f32_16x16x32_bf16 v[64:67], a[100:103], a[240:243], v[64:67]
 buffer_load_dwordx4 v35, s[16:19], s34 offen offset:3072 lds
 v_mfma_f32_16x16x32_bf16 v[68:71], a[96:99], a[228:231], v[68:71]
 ds_read_b64_tr_b16 a[122:123], v45 offset:33280
 v_accvgpr_read_b32 v11, a11
 v_mfma_f32_16x16x32_bf16 v[68:71], a[100:103], a[244:247], v[68:71]
 s_add_u32 m0, s44, 0x10000
 v_accvgpr_read_b32 v12, a12
 v_mfma_f32_16x16x32_bf16 v[72:75], a[96:99], a[232:235], v[72:75]
 ds_read_b64_tr_b16 a[124:125], v45 offset:36864
 s_mov_b32 s35, 0x60000
 v_mfma_f32_16x16x32_bf16 v[72:75], a[100:103], a[248:251], v[72:75]
 buffer_load_dwordx4 v36, s[24:27], s35 offen offset:0 lds
 v_mfma_f32_16x16x32_bf16 v[76:79], a[96:99], a[236:239], v[76:79]
 ds_read_b64_tr_b16 a[126:127], v45 offset:37376
 v_accvgpr_read_b32 v13, a13
 v_mfma_f32_16x16x32_bf16 v[76:79], a[100:103], a[252:255], v[76:79]
 v_accvgpr_read_b32 v14, a14
 s_waitcnt lgkmcnt(8)
 v_mfma_f32_16x16x32_bf16 v[92:95], a[104:107], a[236:239], v[92:95]
 ds_read_b64_tr_b16 a[96:97], v42 offset:40960
 v_accvgpr_read_b32 v15, a15
 v_mfma_f32_16x16x32_bf16 v[92:95], a[108:111], a[252:255], v[92:95]
 buffer_load_dwordx4 v37, s[24:27], s35 offen offset:1024 lds
 v_mfma_f32_16x16x32_bf16 v[88:91], a[104:107], a[232:235], v[88:91]
 ds_read_b64_tr_b16 a[98:99], v42 offset:41472
 v_cvt_pk_bf16_f32 v204, v8, v9
 v_mfma_f32_16x16x32_bf16 v[88:91], a[108:111], a[248:251], v[88:91]
 v_cvt_pk_bf16_f32 v205, v10, v11
 v_cvt_pk_bf16_f32 v206, v12, v13
 v_mfma_f32_16x16x32_bf16 v[84:87], a[104:107], a[228:231], v[84:87]
 ds_read_b64_tr_b16 a[100:101], v42 offset:45056
 v_cvt_pk_bf16_f32 v207, v14, v15
 v_mfma_f32_16x16x32_bf16 v[84:87], a[108:111], a[244:247], v[84:87]
 v_accvgpr_read_b32 v8, a16
 v_mfma_f32_16x16x32_bf16 v[80:83], a[104:107], a[224:227], v[80:83]
 ds_read_b64_tr_b16 a[102:103], v42 offset:45568
 v_accvgpr_read_b32 v9, a17
 v_mfma_f32_16x16x32_bf16 v[80:83], a[108:111], a[240:243], v[80:83]
 v_accvgpr_read_b32 v10, a18
 s_waitcnt lgkmcnt(8)
 v_mfma_f32_16x16x32_bf16 v[96:99], a[112:115], a[224:227], v[96:99]
 ds_read_b64_tr_b16 a[104:105], v43 offset:40960
 v_accvgpr_read_b32 v11, a19
 v_mfma_f32_16x16x32_bf16 v[96:99], a[116:119], a[240:243], v[96:99]
 buffer_load_dwordx4 v38, s[24:27], s35 offen offset:2048 lds
 v_mfma_f32_16x16x32_bf16 v[100:103], a[112:115], a[228:231], v[100:103]
 ds_read_b64_tr_b16 a[106:107], v43 offset:41472
 v_accvgpr_read_b32 v12, a20
 v_mfma_f32_16x16x32_bf16 v[100:103], a[116:119], a[244:247], v[100:103]
 v_accvgpr_read_b32 v13, a21
 v_mfma_f32_16x16x32_bf16 v[104:107], a[112:115], a[232:235], v[104:107]
 ds_read_b64_tr_b16 a[108:109], v43 offset:45056
 v_accvgpr_read_b32 v14, a22
 v_mfma_f32_16x16x32_bf16 v[104:107], a[116:119], a[248:251], v[104:107]
 v_accvgpr_read_b32 v15, a23
 v_mfma_f32_16x16x32_bf16 v[108:111], a[112:115], a[236:239], v[108:111]
 ds_read_b64_tr_b16 a[110:111], v43 offset:45568
 s_mov_b32 s66, 0x600000
 v_mfma_f32_16x16x32_bf16 v[108:111], a[116:119], a[252:255], v[108:111]
 v_cvt_pk_bf16_f32 v212, v8, v9
 s_waitcnt lgkmcnt(8)
 v_mfma_f32_16x16x32_bf16 v[124:127], a[120:123], a[236:239], v[124:127]
 ds_read_b64_tr_b16 a[112:113], v44 offset:40960
 v_cvt_pk_bf16_f32 v213, v10, v11
 v_mfma_f32_16x16x32_bf16 v[124:127], a[124:127], a[252:255], v[124:127]
 buffer_load_dword v60, v54, s[16:19], s66 offen
 v_mfma_f32_16x16x32_bf16 v[120:123], a[120:123], a[232:235], v[120:123]
 ds_read_b64_tr_b16 a[114:115], v44 offset:41472
 s_mov_b32 s67, 0x480000
 v_mfma_f32_16x16x32_bf16 v[120:123], a[124:127], a[248:251], v[120:123]
 buffer_load_dword v60, v55, s[24:27], s67 offen
 v_mfma_f32_16x16x32_bf16 v[116:119], a[120:123], a[228:231], v[116:119]
 ds_read_b64_tr_b16 a[116:117], v44 offset:45056
 v_cvt_pk_bf16_f32 v214, v12, v13
 v_mfma_f32_16x16x32_bf16 v[116:119], a[124:127], a[244:247], v[116:119]
 v_cvt_pk_bf16_f32 v215, v14, v15
 v_accvgpr_read_b32 v8, a24
 v_mfma_f32_16x16x32_bf16 v[112:115], a[120:123], a[224:227], v[112:115]
 ds_read_b64_tr_b16 a[118:119], v44 offset:45568
 s_mov_b32 s66, 0x700000
 v_mfma_f32_16x16x32_bf16 v[112:115], a[124:127], a[240:243], v[112:115]
 v_accvgpr_read_b32 v9, a25
 s_waitcnt lgkmcnt(8)
 v_mfma_f32_16x16x32_bf16 v[128:131], a[96:99], a[224:227], v[128:131]
 ds_read_b64_tr_b16 a[120:121], v45 offset:40960
 v_accvgpr_read_b32 v10, a26
 v_mfma_f32_16x16x32_bf16 v[128:131], a[100:103], a[240:243], v[128:131]
 buffer_load_dword v60, v54, s[16:19], s66 offen
 v_mfma_f32_16x16x32_bf16 v[132:135], a[96:99], a[228:231], v[132:135]
 ds_read_b64_tr_b16 a[122:123], v45 offset:41472
 s_mov_b32 s67, 0x540000
 v_mfma_f32_16x16x32_bf16 v[132:135], a[100:103], a[244:247], v[132:135]
 buffer_load_dword v60, v55, s[24:27], s67 offen
 v_mfma_f32_16x16x32_bf16 v[136:139], a[96:99], a[232:235], v[136:139]
 ds_read_b64_tr_b16 a[124:125], v45 offset:45056
 v_accvgpr_read_b32 v11, a27
 v_mfma_f32_16x16x32_bf16 v[136:139], a[100:103], a[248:251], v[136:139]
 v_accvgpr_read_b32 v12, a28
 v_accvgpr_read_b32 v13, a29
 v_mfma_f32_16x16x32_bf16 v[140:143], a[96:99], a[236:239], v[140:143]
 ds_read_b64_tr_b16 a[126:127], v45 offset:45568
 v_min_u32 v63, 1, v2
 v_mfma_f32_16x16x32_bf16 v[140:143], a[100:103], a[252:255], v[140:143]
 v_mad_u32_u24 v63, s45, 2, v63
 s_waitcnt lgkmcnt(8)
 v_mfma_f32_16x16x32_bf16 v[156:159], a[104:107], a[236:239], v[156:159]
 v_lshlrev_b32 v63, 7, v63
 v_accvgpr_read_b32 v14, a30
 v_mfma_f32_16x16x32_bf16 v[156:159], a[108:111], a[252:255], v[156:159]
 v_add_u32 v63, F_step11-F_pc, v63
 v_accvgpr_read_b32 v15, a31
 v_mfma_f32_16x16x32_bf16 v[152:155], a[104:107], a[232:235], v[152:155]
 global_load_dword v60, v63, s[90:91]
 v_mfma_f32_16x16x32_bf16 v[152:155], a[108:111], a[248:251], v[152:155]
 s_waitcnt lgkmcnt(0) vmcnt(22)
 s_barrier
 v_mov_b32 v61, s89
 s_mov_b32 s66, 0x3b30000
 buffer_store_dword v61, v58, s[20:23], s66 offen sc1
 v_mfma_f32_16x16x32_bf16 v[148:151], a[104:107], a[228:231], v[148:151]
 ds_read_b64_tr_b16 a[96:97], v48 offset:0
 v_cvt_pk_bf16_f32 v220, v8, v9
 v_mfma_f32_16x16x32_bf16 v[148:151], a[108:111], a[244:247], v[148:151]
 ds_read_b64_tr_b16 a[98:99], v48 offset:512
 v_cvt_pk_bf16_f32 v221, v10, v11
 v_mfma_f32_16x16x32_bf16 v[144:147], a[104:107], a[224:227], v[144:147]
 ds_read_b64_tr_b16 a[100:101], v48 offset:4096
 v_cvt_pk_bf16_f32 v222, v12, v13
 v_mfma_f32_16x16x32_bf16 v[144:147], a[108:111], a[240:243], v[144:147]
 ds_read_b64_tr_b16 a[102:103], v48 offset:4608
 v_mfma_f32_16x16x32_bf16 v[160:163], a[112:115], a[224:227], v[160:163]
 ds_read_b128 a[64:67], v40 offset:0
 v_cvt_pk_bf16_f32 v223, v14, v15
 v_mfma_f32_16x16x32_bf16 v[160:163], a[116:119], a[240:243], v[160:163]
 ds_read_b128 a[80:83], v41 offset:0
 v_cvt_pk_bf16_f32 v64, v64, v65
 v_mfma_f32_16x16x32_bf16 v[164:167], a[112:115], a[228:231], v[164:167]
 ds_read_b128 a[68:71], v40 offset:2048
 v_cvt_pk_bf16_f32 v65, v66, v67
 v_mfma_f32_16x16x32_bf16 v[164:167], a[116:119], a[244:247], v[164:167]
 ds_read_b128 a[84:87], v41 offset:2048
 v_cvt_pk_bf16_f32 v66, v80, v81
 v_mfma_f32_16x16x32_bf16 v[168:171], a[112:115], a[232:235], v[168:171]
 ds_read_b128 a[72:75], v40 offset:4096
 v_cvt_pk_bf16_f32 v67, v82, v83
 v_mfma_f32_16x16x32_bf16 v[168:171], a[116:119], a[248:251], v[168:171]
 ds_read_b128 a[88:91], v41 offset:4096
 v_cvt_pk_bf16_f32 v68, v68, v69
 v_mfma_f32_16x16x32_bf16 v[172:175], a[112:115], a[236:239], v[172:175]
 ds_read_b128 a[76:79], v40 offset:6144
 v_cvt_pk_bf16_f32 v69, v70, v71
 v_mfma_f32_16x16x32_bf16 v[172:175], a[116:119], a[252:255], v[172:175]
 ds_read_b128 a[92:95], v41 offset:6144
 v_mfma_f32_16x16x32_bf16 v[188:191], a[120:123], a[236:239], v[188:191]
 ds_read_b64_tr_b16 a[104:105], v49 offset:0
 v_cvt_pk_bf16_f32 v70, v84, v85
 v_mfma_f32_16x16x32_bf16 v[188:191], a[124:127], a[252:255], v[188:191]
 ds_read_b64_tr_b16 a[106:107], v49 offset:512
 v_cvt_pk_bf16_f32 v71, v86, v87
 v_mfma_f32_16x16x32_bf16 v[184:187], a[120:123], a[232:235], v[184:187]
 ds_read_b64_tr_b16 a[108:109], v49 offset:4096
 v_cvt_pk_bf16_f32 v72, v72, v73
 v_mfma_f32_16x16x32_bf16 v[184:187], a[124:127], a[248:251], v[184:187]
 ds_read_b64_tr_b16 a[110:111], v49 offset:4608
 v_cvt_pk_bf16_f32 v73, v74, v75
 v_mfma_f32_16x16x32_bf16 v[180:183], a[120:123], a[228:231], v[180:183]
 ds_read_b64_tr_b16 a[112:113], v48 offset:8192
 v_cvt_pk_bf16_f32 v74, v88, v89
 v_mfma_f32_16x16x32_bf16 v[180:183], a[124:127], a[244:247], v[180:183]
 ds_read_b64_tr_b16 a[114:115], v48 offset:8704
 v_cvt_pk_bf16_f32 v75, v90, v91
 v_mfma_f32_16x16x32_bf16 v[176:179], a[120:123], a[224:227], v[176:179]
 ds_read_b64_tr_b16 a[116:117], v48 offset:12288
 v_cvt_pk_bf16_f32 v76, v76, v77
 v_mfma_f32_16x16x32_bf16 v[176:179], a[124:127], a[240:243], v[176:179]
 ds_read_b64_tr_b16 a[118:119], v48 offset:12800
 v_cvt_pk_bf16_f32 v77, v78, v79
 v_cvt_pk_bf16_f32 v78, v92, v93
 v_cvt_pk_bf16_f32 v79, v94, v95
F_step8:
 s_waitcnt lgkmcnt(8)
 v_mfma_f32_16x16x32_bf16 a[0:3], a[96:99], a[64:67], 0
 ds_read_b64_tr_b16 a[120:121], v49 offset:8192
 v_accvgpr_read_b32 v8, a32
 v_mfma_f32_16x16x32_bf16 a[0:3], a[100:103], a[80:83], a[0:3]
 v_accvgpr_read_b32 v9, a33
 v_accvgpr_read_b32 v10, a34
 v_mfma_f32_16x16x32_bf16 a[4:7], a[96:99], a[68:71], 0
 ds_read_b64_tr_b16 a[122:123], v49 offset:8704
 v_accvgpr_read_b32 v11, a35
 v_mfma_f32_16x16x32_bf16 a[4:7], a[100:103], a[84:87], a[4:7]
 s_add_u32 m0, s46, 0
 v_accvgpr_read_b32 v12, a36
 v_mfma_f32_16x16x32_bf16 a[8:11], a[96:99], a[72:75], 0
 ds_read_b64_tr_b16 a[124:125], v49 offset:12288
 s_xor_b32 s33, s99, 256
 v_mfma_f32_16x16x32_bf16 a[8:11], a[100:103], a[88:91], a[8:11]
 buffer_load_dwordx4 v24, s[28:31], s33 offen offset:0 lds
 v_mfma_f32_16x16x32_bf16 a[12:15], a[96:99], a[76:79], 0
 ds_read_b64_tr_b16 a[126:127], v49 offset:12800
 v_accvgpr_read_b32 v13, a37
 v_mfma_f32_16x16x32_bf16 a[12:15], a[100:103], a[92:95], a[12:15]
 v_accvgpr_read_b32 v14, a38
 s_waitcnt lgkmcnt(8)
 v_mfma_f32_16x16x32_bf16 a[28:31], a[104:107], a[76:79], 0
 ds_read_b64_tr_b16 a[96:97], v50 offset:8192
 v_accvgpr_read_b32 v15, a39
 v_mfma_f32_16x16x32_bf16 a[28:31], a[108:111], a[92:95], a[28:31]
 buffer_load_dwordx4 v25, s[28:31], s33 offen offset:1024 lds
 v_mfma_f32_16x16x32_bf16 a[24:27], a[104:107], a[72:75], 0
 ds_read_b64_tr_b16 a[98:99], v50 offset:8704
 v_cvt_pk_bf16_f32 v228, v8, v9
 v_mfma_f32_16x16x32_bf16 a[24:27], a[108:111], a[88:91], a[24:27]
 buffer_store_dwordx4 v[192:195], v57, s[20:23], s47 offen offset:0 sc1
 v_mfma_f32_16x16x32_bf16 a[20:23], a[104:107], a[68:71], 0
 ds_read_b64_tr_b16 a[100:101], v50 offset:12288
 v_cvt_pk_bf16_f32 v229, v10, v11
 v_mfma_f32_16x16x32_bf16 a[20:23], a[108:111], a[84:87], a[20:23]
 v_cvt_pk_bf16_f32 v230, v12, v13
 v_cvt_pk_bf16_f32 v231, v14, v15
 v_mfma_f32_16x16x32_bf16 a[16:19], a[104:107], a[64:67], 0
 ds_read_b64_tr_b16 a[102:103], v50 offset:12800
 v_accvgpr_read_b32 v8, a40
 v_mfma_f32_16x16x32_bf16 a[16:19], a[108:111], a[80:83], a[16:19]
 v_accvgpr_read_b32 v9, a41
 s_waitcnt lgkmcnt(8)
 v_mfma_f32_16x16x32_bf16 a[128:131], a[112:115], a[64:67], 0
 ds_read_b64_tr_b16 a[104:105], v51 offset:8192
 v_accvgpr_read_b32 v10, a42
 v_mfma_f32_16x16x32_bf16 a[128:131], a[116:119], a[80:83], a[128:131]
 buffer_load_dwordx4 v26, s[28:31], s33 offen offset:2048 lds
 v_mfma_f32_16x16x32_bf16 a[132:135], a[112:115], a[68:71], 0
 ds_read_b64_tr_b16 a[106:107], v51 offset:8704
 v_accvgpr_read_b32 v11, a43
 v_mfma_f32_16x16x32_bf16 a[132:135], a[116:119], a[84:87], a[132:135]
 v_accvgpr_read_b32 v12, a44
 v_accvgpr_read_b32 v13, a45
 v_mfma_f32_16x16x32_bf16 a[136:139], a[112:115], a[72:75], 0
 ds_read_b64_tr_b16 a[108:109], v51 offset:12288
 v_accvgpr_read_b32 v14, a46
 v_mfma_f32_16x16x32_bf16 a[136:139], a[116:119], a[88:91], a[136:139]
 buffer_load_dwordx4 v27, s[28:31], s33 offen offset:3072 lds
 v_mfma_f32_16x16x32_bf16 a[140:143], a[112:115], a[76:79], 0
 ds_read_b64_tr_b16 a[110:111], v51 offset:12800
 v_accvgpr_read_b32 v15, a47
 v_mfma_f32_16x16x32_bf16 a[140:143], a[116:119], a[92:95], a[140:143]
 v_cvt_pk_bf16_f32 v236, v8, v9
 s_waitcnt lgkmcnt(8)
 v_mfma_f32_16x16x32_bf16 a[156:159], a[120:123], a[76:79], 0
 ds_read_b64_tr_b16 a[112:113], v52 offset:2048
 v_cvt_pk_bf16_f32 v237, v10, v11
 v_mfma_f32_16x16x32_bf16 a[156:159], a[124:127], a[92:95], a[156:159]
 s_add_u32 m0, s46, 4096
 v_cvt_pk_bf16_f32 v238, v12, v13
 v_mfma_f32_16x16x32_bf16 a[152:155], a[120:123], a[72:75], 0
 ds_read_b64_tr_b16 a[114:115], v52 offset:2304
 v_cvt_pk_bf16_f32 v239, v14, v15
 v_mfma_f32_16x16x32_bf16 a[152:155], a[124:127], a[88:91], a[152:155]
 buffer_load_dwordx4 v28, s[28:31], s33 offen offset:0 lds
 v_mfma_f32_16x16x32_bf16 a[148:151], a[120:123], a[68:71], 0
 ds_read_b64_tr_b16 a[116:117], v52 offset:10240
 v_accvgpr_read_b32 v8, a48
 v_mfma_f32_16x16x32_bf16 a[148:151], a[124:127], a[84:87], a[148:151]
 v_accvgpr_read_b32 v9, a49
 v_accvgpr_read_b32 v10, a50
 v_mfma_f32_16x16x32_bf16 a[144:147], a[120:123], a[64:67], 0
 ds_read_b64_tr_b16 a[118:119], v52 offset:10496
 v_accvgpr_read_b32 v11, a51
 v_mfma_f32_16x16x32_bf16 a[144:147], a[124:127], a[80:83], a[144:147]
 v_accvgpr_read_b32 v12, a52
 s_waitcnt lgkmcnt(8)
 v_mfma_f32_16x16x32_bf16 a[160:163], a[96:99], a[64:67], 0
 ds_read_b64_tr_b16 a[120:121], v53 offset:2048
 v_accvgpr_read_b32 v13, a53
 v_mfma_f32_16x16x32_bf16 a[160:163], a[100:103], a[80:83], a[160:163]
 buffer_load_dwordx4 v29, s[28:31], s33 offen offset:1024 lds
 v_mfma_f32_16x16x32_bf16 a[164:167], a[96:99], a[68:71], 0
 ds_read_b64_tr_b16 a[122:123], v53 offset:2304
 v_accvgpr_read_b32 v14, a54
 v_mfma_f32_16x16x32_bf16 a[164:167], a[100:103], a[84:87], a[164:167]
 v_accvgpr_read_b32 v15, a55
 v_cvt_pk_bf16_f32 v244, v8, v9
 v_mfma_f32_16x16x32_bf16 a[168:171], a[96:99], a[72:75], 0
 ds_read_b64_tr_b16 a[124:125], v53 offset:10240
 v_cvt_pk_bf16_f32 v245, v10, v11
 v_mfma_f32_16x16x32_bf16 a[168:171], a[100:103], a[88:91], a[168:171]
 buffer_load_dwordx4 v30, s[28:31], s33 offen offset:2048 lds
 v_mfma_f32_16x16x32_bf16 a[172:175], a[96:99], a[76:79], 0
 ds_read_b64_tr_b16 a[126:127], v53 offset:10496
 v_cvt_pk_bf16_f32 v246, v12, v13
 v_mfma_f32_16x16x32_bf16 a[172:175], a[100:103], a[92:95], a[172:175]
 v_cvt_pk_bf16_f32 v247, v14, v15
 s_waitcnt lgkmcnt(8)
 v_mfma_f32_16x16x32_bf16 a[188:191], a[104:107], a[76:79], 0
 ds_read_b64_tr_b16 a[96:97], v50 offset:0
 v_accvgpr_read_b32 v8, a56
 v_mfma_f32_16x16x32_bf16 a[188:191], a[108:111], a[92:95], a[188:191]
 v_accvgpr_read_b32 v9, a57
 v_accvgpr_read_b32 v10, a58
 v_mfma_f32_16x16x32_bf16 a[184:187], a[104:107], a[72:75], 0
 ds_read_b64_tr_b16 a[98:99], v50 offset:512
 v_accvgpr_read_b32 v11, a59
 v_mfma_f32_16x16x32_bf16 a[184:187], a[108:111], a[88:91], a[184:187]
 buffer_load_dwordx4 v31, s[28:31], s33 offen offset:3072 lds
 v_mfma_f32_16x16x32_bf16 a[180:183], a[104:107], a[68:71], 0
 ds_read_b64_tr_b16 a[100:101], v50 offset:4096
 v_accvgpr_read_b32 v12, a60
 v_mfma_f32_16x16x32_bf16 a[180:183], a[108:111], a[84:87], a[180:183]
 v_accvgpr_read_b32 v13, a61
 v_accvgpr_read_b32 v14, a62
 v_mfma_f32_16x16x32_bf16 a[176:179], a[104:107], a[64:67], 0
 ds_read_b64_tr_b16 a[102:103], v50 offset:4608
 v_accvgpr_read_b32 v15, a63
 v_mfma_f32_16x16x32_bf16 a[176:179], a[108:111], a[80:83], a[176:179]
 v_cvt_pk_bf16_f32 v252, v8, v9
 s_waitcnt lgkmcnt(8)
 v_mfma_f32_16x16x32_bf16 a[192:195], a[64:67], a[112:115], 0
 ds_read_b64_tr_b16 a[104:105], v51 offset:0
 s_add_u32 m0, s43, 0x18000
 v_mfma_f32_16x16x32_bf16 a[192:195], a[80:83], a[116:119], a[192:195]
 s_xor_b32 s34, s98, 0x100000
 v_cvt_pk_bf16_f32 v253, v10, v11
 v_mfma_f32_16x16x32_bf16 a[196:199], a[68:71], a[112:115], 0
 ds_read_b64_tr_b16 a[106:107], v51 offset:512
 v_cvt_pk_bf16_f32 v254, v12, v13
 v_mfma_f32_16x16x32_bf16 a[196:199], a[84:87], a[116:119], a[196:199]
 buffer_load_dwordx4 v32, s[16:19], s34 offen offset:0 lds
 v_mfma_f32_16x16x32_bf16 a[200:203], a[72:75], a[112:115], 0
 ds_read_b64_tr_b16 a[108:109], v51 offset:4096
 v_cvt_pk_bf16_f32 v255, v14, v15
 v_mfma_f32_16x16x32_bf16 a[200:203], a[88:91], a[116:119], a[200:203]
 buffer_store_dwordx4 v[200:203], v57, s[20:23], s48 offen offset:0 sc1
 v_mfma_f32_16x16x32_bf16 a[204:207], a[76:79], a[112:115], 0
 ds_read_b64_tr_b16 a[110:111], v51 offset:4608
 v_cvt_pk_bf16_f32 v96, v96, v97
 v_mfma_f32_16x16x32_bf16 a[204:207], a[92:95], a[116:119], a[204:207]
 v_cvt_pk_bf16_f32 v97, v98, v99
 s_waitcnt lgkmcnt(8)
 v_mfma_f32_16x16x32_bf16 a[220:223], a[76:79], a[120:123], 0
 ds_read_b64_tr_b16 a[112:113], v52 offset:0
 v_cvt_pk_bf16_f32 v98, v112, v113
 v_mfma_f32_16x16x32_bf16 a[220:223], a[92:95], a[124:127], a[220:223]
 buffer_load_dwordx4 v33, s[16:19], s34 offen offset:1024 lds
 v_mfma_f32_16x16x32_bf16 a[216:219], a[72:75], a[120:123], 0
 ds_read_b64_tr_b16 a[114:115], v52 offset:256
 v_cvt_pk_bf16_f32 v99, v114, v115
 v_mfma_f32_16x16x32_bf16 a[216:219], a[88:91], a[124:127], a[216:219]
 buffer_load_dwordx4 v34, s[16:19], s34 offen offset:2048 lds
 v_mfma_f32_16x16x32_bf16 a[212:215], a[68:71], a[120:123], 0
 ds_read_b64_tr_b16 a[116:117], v52 offset:8192
 v_cvt_pk_bf16_f32 v100, v100, v101
 v_mfma_f32_16x16x32_bf16 a[212:215], a[84:87], a[124:127], a[212:215]
 v_cvt_pk_bf16_f32 v101, v102, v103
 v_cvt_pk_bf16_f32 v102, v116, v117
 v_mfma_f32_16x16x32_bf16 a[208:211], a[64:67], a[120:123], 0
 ds_read_b64_tr_b16 a[118:119], v52 offset:8448
 v_cvt_pk_bf16_f32 v103, v118, v119
 v_mfma_f32_16x16x32_bf16 a[208:211], a[80:83], a[124:127], a[208:211]
 v_cvt_pk_bf16_f32 v104, v104, v105
 s_waitcnt lgkmcnt(8)
 v_mfma_f32_16x16x32_bf16 a[32:35], a[96:99], a[64:67], 0
 ds_read_b64_tr_b16 a[120:121], v53 offset:0
 v_cvt_pk_bf16_f32 v105, v106, v107
 v_mfma_f32_16x16x32_bf16 a[32:35], a[100:103], a[80:83], a[32:35]
 buffer_load_dwordx4 v35, s[16:19], s34 offen offset:3072 lds
 v_mfma_f32_16x16x32_bf16 a[36:39], a[96:99], a[68:71], 0
 ds_read_b64_tr_b16 a[122:123], v53 offset:256
 v_cvt_pk_bf16_f32 v106, v120, v121
 v_mfma_f32_16x16x32_bf16 a[36:39], a[100:103], a[84:87], a[36:39]
 v_cvt_pk_bf16_f32 v107, v122, v123
 v_cvt_pk_bf16_f32 v108, v108, v109
 v_mfma_f32_16x16x32_bf16 a[40:43], a[96:99], a[72:75], 0
 ds_read_b64_tr_b16 a[124:125], v53 offset:8192
 v_cvt_pk_bf16_f32 v109, v110, v111
 v_mfma_f32_16x16x32_bf16 a[40:43], a[100:103], a[88:91], a[40:43]
 v_cvt_pk_bf16_f32 v110, v124, v125
 v_cvt_pk_bf16_f32 v111, v126, v127
 v_mfma_f32_16x16x32_bf16 a[44:47], a[96:99], a[76:79], 0
 ds_read_b64_tr_b16 a[126:127], v53 offset:8448
 v_cvt_pk_bf16_f32 v128, v128, v129
 v_mfma_f32_16x16x32_bf16 a[44:47], a[100:103], a[92:95], a[44:47]
 s_add_u32 m0, s44, 0x18000
 s_waitcnt lgkmcnt(8)
 v_mfma_f32_16x16x32_bf16 a[60:63], a[104:107], a[76:79], 0
 ds_read_b64_tr_b16 a[96:97], v52 offset:1024
 s_mov_b32 s35, 0xc0000
 v_mfma_f32_16x16x32_bf16 a[60:63], a[108:111], a[92:95], a[60:63]
 buffer_load_dwordx4 v36, s[24:27], s35 offen offset:0 lds
 v_mfma_f32_16x16x32_bf16 a[56:59], a[104:107], a[72:75], 0
 ds_read_b64_tr_b16 a[98:99], v52 offset:1280
 v_cvt_pk_bf16_f32 v129, v130, v131
 v_mfma_f32_16x16x32_bf16 a[56:59], a[108:111], a[88:91], a[56:59]
 v_cvt_pk_bf16_f32 v130, v144, v145
 v_cvt_pk_bf16_f32 v131, v146, v147
 v_mfma_f32_16x16x32_bf16 a[52:55], a[104:107], a[68:71], 0
 ds_read_b64_tr_b16 a[100:101], v52 offset:9216
 v_cvt_pk_bf16_f32 v132, v132, v133
 v_mfma_f32_16x16x32_bf16 a[52:55], a[108:111], a[84:87], a[52:55]
 buffer_load_dwordx4 v37, s[24:27], s35 offen offset:1024 lds
 v_mfma_f32_16x16x32_bf16 a[48:51], a[104:107], a[64:67], 0
 ds_read_b64_tr_b16 a[102:103], v52 offset:9472
 v_cvt_pk_bf16_f32 v133, v134, v135
 v_mfma_f32_16x16x32_bf16 a[48:51], a[108:111], a[80:83], a[48:51]
 v_cvt_pk_bf16_f32 v134, v148, v149
 s_waitcnt lgkmcnt(8)
 v_mfma_f32_16x16x32_bf16 v[80:83], a[112:115], a[64:67], 0
 ds_read_b64_tr_b16 a[104:105], v53 offset:1024
 v_cvt_pk_bf16_f32 v135, v150, v151
 v_mfma_f32_16x16x32_bf16 v[80:83], a[116:119], a[80:83], v[80:83]
 v_cvt_pk_bf16_f32 v136, v136, v137
 v_cvt_pk_bf16_f32 v137, v138, v139
 v_mfma_f32_16x16x32_bf16 v[84:87], a[112:115], a[68:71], 0
 ds_read_b64_tr_b16 a[106:107], v53 offset:1280
 v_cvt_pk_bf16_f32 v138, v152, v153
 v_mfma_f32_16x16x32_bf16 v[84:87], a[116:119], a[84:87], v[84:87]
 buffer_load_dwordx4 v38, s[24:27], s35 offen offset:2048 lds
 v_mfma_f32_16x16x32_bf16 v[88:91], a[112:115], a[72:75], 0
 ds_read_b64_tr_b16 a[108:109], v53 offset:9216
 v_cvt_pk_bf16_f32 v139, v154, v155
 v_mfma_f32_16x16x32_bf16 v[88:91], a[116:119], a[88:91], v[88:91]
 v_cvt_pk_bf16_f32 v140, v140, v141
 v_cvt_pk_bf16_f32 v141, v142, v143
 v_mfma_f32_16x16x32_bf16 v[92:95], a[112:115], a[76:79], 0
 ds_read_b64_tr_b16 a[110:111], v53 offset:9472
 v_cvt_pk_bf16_f32 v142, v156, v157
 v_mfma_f32_16x16x32_bf16 v[92:95], a[116:119], a[92:95], v[92:95]
 v_cvt_pk_bf16_f32 v143, v158, v159
 s_waitcnt lgkmcnt(8)
 v_mfma_f32_16x16x32_bf16 v[124:127], a[120:123], a[76:79], 0
 v_cvt_pk_bf16_f32 v160, v160, v161
 v_cvt_pk_bf16_f32 v161, v162, v163
 v_mfma_f32_16x16x32_bf16 v[124:127], a[124:127], a[92:95], v[124:127]
 v_cvt_pk_bf16_f32 v162, v176, v177
 v_cvt_pk_bf16_f32 v163, v178, v179
 v_mfma_f32_16x16x32_bf16 v[120:123], a[120:123], a[72:75], 0
 v_cvt_pk_bf16_f32 v164, v164, v165
 v_cvt_pk_bf16_f32 v165, v166, v167
 v_mfma_f32_16x16x32_bf16 v[120:123], a[124:127], a[88:91], v[120:123]
 s_waitcnt lgkmcnt(0) vmcnt(23)
 s_barrier
 v_mfma_f32_16x16x32_bf16 v[116:119], a[120:123], a[68:71], 0
 ds_read_b64_tr_b16 a[112:113], v42 offset:0
 v_cvt_pk_bf16_f32 v166, v180, v181
 v_mfma_f32_16x16x32_bf16 v[116:119], a[124:127], a[84:87], v[116:119]
 ds_read_b64_tr_b16 a[114:115], v42 offset:512
 v_cvt_pk_bf16_f32 v167, v182, v183
 v_mfma_f32_16x16x32_bf16 v[112:115], a[120:123], a[64:67], 0
 ds_read_b64_tr_b16 a[116:117], v42 offset:4096
 v_cvt_pk_bf16_f32 v168, v168, v169
 buffer_store_dwordx4 v[208:211], v57, s[20:23], s47 offen offset:256 sc1
 v_mfma_f32_16x16x32_bf16 v[112:115], a[124:127], a[80:83], v[112:115]
 ds_read_b64_tr_b16 a[118:119], v42 offset:4608
 v_mfma_f32_16x16x32_bf16 v[144:147], a[96:99], a[64:67], 0
 ds_read_b128 a[224:227], v40 offset:8192
 v_cvt_pk_bf16_f32 v169, v170, v171
 v_mfma_f32_16x16x32_bf16 v[144:147], a[100:103], a[80:83], v[144:147]
 ds_read_b128 a[240:243], v41 offset:8192
 v_cvt_pk_bf16_f32 v170, v184, v185
 v_mfma_f32_16x16x32_bf16 v[148:151], a[96:99], a[68:71], 0
 ds_read_b128 a[228:231], v40 offset:10240
 v_cvt_pk_bf16_f32 v171, v186, v187
 v_mfma_f32_16x16x32_bf16 v[148:151], a[100:103], a[84:87], v[148:151]
 ds_read_b128 a[244:247], v41 offset:10240
 v_cvt_pk_bf16_f32 v172, v172, v173
 v_mfma_f32_16x16x32_bf16 v[152:155], a[96:99], a[72:75], 0
 ds_read_b128 a[232:235], v40 offset:12288
 v_cvt_pk_bf16_f32 v173, v174, v175
 v_mfma_f32_16x16x32_bf16 v[152:155], a[100:103], a[88:91], v[152:155]
 ds_read_b128 a[248:251], v41 offset:12288
 v_cvt_pk_bf16_f32 v174, v188, v189
 v_mfma_f32_16x16x32_bf16 v[156:159], a[96:99], a[76:79], 0
 v_cvt_pk_bf16_f32 v175, v190, v191
 ds_read_b128 a[236:239], v40 offset:14336
 v_mfma_f32_16x16x32_bf16 v[156:159], a[100:103], a[92:95], v[156:159]
 ds_read_b128 a[252:255], v41 offset:14336
 v_mfma_f32_16x16x32_bf16 v[188:191], a[104:107], a[76:79], 0
 ds_read_b64_tr_b16 a[120:121], v43 offset:0
 v_mfma_f32_16x16x32_bf16 v[188:191], a[108:111], a[92:95], v[188:191]
 ds_read_b64_tr_b16 a[122:123], v43 offset:512
 v_mfma_f32_16x16x32_bf16 v[184:187], a[104:107], a[72:75], 0
 ds_read_b64_tr_b16 a[124:125], v43 offset:4096
 v_mfma_f32_16x16x32_bf16 v[184:187], a[108:111], a[88:91], v[184:187]
 ds_read_b64_tr_b16 a[126:127], v43 offset:4608
 v_mfma_f32_16x16x32_bf16 v[180:183], a[104:107], a[68:71], 0
 ds_read_b64_tr_b16 a[96:97], v44 offset:0
 v_mfma_f32_16x16x32_bf16 v[180:183], a[108:111], a[84:87], v[180:183]
 ds_read_b64_tr_b16 a[98:99], v44 offset:512
 v_mfma_f32_16x16x32_bf16 v[176:179], a[104:107], a[64:67], 0
 ds_read_b64_tr_b16 a[100:101], v44 offset:4096
 v_mfma_f32_16x16x32_bf16 v[176:179], a[108:111], a[80:83], v[176:179]
 ds_read_b64_tr_b16 a[102:103], v44 offset:4608
F_step9:
 s_waitcnt lgkmcnt(8)
 v_mfma_f32_16x16x32_bf16 a[0:3], a[112:115], a[224:227], a[0:3]
 ds_read_b64_tr_b16 a[104:105], v45 offset:0
 v_mfma_f32_16x16x32_bf16 a[0:3], a[116:119], a[240:243], a[0:3]
 v_mfma_f32_16x16x32_bf16 a[4:7], a[112:115], a[228:231], a[4:7]
 ds_read_b64_tr_b16 a[106:107], v45 offset:512
 v_mfma_f32_16x16x32_bf16 a[4:7], a[116:119], a[244:247], a[4:7]
 s_add_u32 m0, s46, 8192
 s_xor_b32 s33, s99, 384
 v_mfma_f32_16x16x32_bf16 a[8:11], a[112:115], a[232:235], a[8:11]
 ds_read_b64_tr_b16 a[108:109], v45 offset:4096
 v_mfma_f32_16x16x32_bf16 a[8:11], a[116:119], a[248:251], a[8:11]
 buffer_load_dwordx4 v24, s[28:31], s33 offen offset:0 lds
 v_mfma_f32_16x16x32_bf16 a[12:15], a[112:115], a[236:239], a[12:15]
 ds_read_b64_tr_b16 a[110:111], v45 offset:4608
 v_mfma_f32_16x16x32_bf16 a[12:15], a[116:119], a[252:255], a[12:15]
 s_waitcnt lgkmcnt(8)
 v_mfma_f32_16x16x32_bf16 a[28:31], a[120:123], a[236:239], a[28:31]
 ds_read_b64_tr_b16 a[112:113], v42 offset:8192
 v_mfma_f32_16x16x32_bf16 a[28:31], a[124:127], a[252:255], a[28:31]
 buffer_load_dwordx4 v25, s[28:31], s33 offen offset:1024 lds
 v_mfma_f32_16x16x32_bf16 a[24:27], a[120:123], a[232:235], a[24:27]
 ds_read_b64_tr_b16 a[114:115], v42 offset:8704
 v_mfma_f32_16x16x32_bf16 a[24:27], a[124:127], a[248:251], a[24:27]
 buffer_store_dwordx4 v[216:219], v57, s[20:23], s48 offen offset:256 sc1
 v_mfma_f32_16x16x32_bf16 a[20:23], a[120:123], a[228:231], a[20:23]
 ds_read_b64_tr_b16 a[116:117], v42 offset:12288
 v_mfma_f32_16x16x32_bf16 a[20:23], a[124:127], a[244:247], a[20:23]
 v_mfma_f32_16x16x32_bf16 a[16:19], a[120:123], a[224:227], a[16:19]
 ds_read_b64_tr_b16 a[118:119], v42 offset:12800
 v_mfma_f32_16x16x32_bf16 a[16:19], a[124:127], a[240:243], a[16:19]
 s_waitcnt lgkmcnt(8)
 v_mfma_f32_16x16x32_bf16 a[32:35], a[96:99], a[224:227], a[32:35]
 ds_read_b64_tr_b16 a[120:121], v43 offset:8192
 v_mfma_f32_16x16x32_bf16 a[32:35], a[100:103], a[240:243], a[32:35]
 buffer_load_dwordx4 v26, s[28:31], s33 offen offset:2048 lds
 v_mfma_f32_16x16x32_bf16 a[36:39], a[96:99], a[228:231], a[36:39]
 ds_read_b64_tr_b16 a[122:123], v43 offset:8704
 v_mfma_f32_16x16x32_bf16 a[36:39], a[100:103], a[244:247], a[36:39]
 v_mfma_f32_16x16x32_bf16 a[40:43], a[96:99], a[232:235], a[40:43]
 ds_read_b64_tr_b16 a[124:125], v43 offset:12288
 v_mfma_f32_16x16x32_bf16 a[40:43], a[100:103], a[248:251], a[40:43]
 buffer_load_dwordx4 v27, s[28:31], s33 offen offset:3072 lds
 v_mfma_f32_16x16x32_bf16 a[44:47], a[96:99], a[236:239], a[44:47]
 ds_read_b64_tr_b16 a[126:127], v43 offset:12800
 v_mfma_f32_16x16x32_bf16 a[44:47], a[100:103], a[252:255], a[44:47]
 s_waitcnt lgkmcnt(8)
 v_mfma_f32_16x16x32_bf16 a[60:63], a[104:107], a[236:239], a[60:63]
 ds_read_b64_tr_b16 a[96:97], v44 offset:8192
 v_mfma_f32_16x16x32_bf16 a[60:63], a[108:111], a[252:255], a[60:63]
 s_add_u32 m0, s46, 12288
 v_mfma_f32_16x16x32_bf16 a[56:59], a[104:107], a[232:235], a[56:59]
 ds_read_b64_tr_b16 a[98:99], v44 offset:8704
 v_mfma_f32_16x16x32_bf16 a[56:59], a[108:111], a[248:251], a[56:59]
 buffer_load_dwordx4 v28, s[28:31], s33 offen offset:0 lds
 v_mfma_f32_16x16x32_bf16 a[52:55], a[104:107], a[228:231], a[52:55]
 ds_read_b64_tr_b16 a[100:101], v44 offset:12288
 v_mfma_f32_16x16x32_bf16 a[52:55], a[108:111], a[244:247], a[52:55]
 v_mfma_f32_16x16x32_bf16 a[48:51], a[104:107], a[224:227], a[48:51]
 ds_read_b64_tr_b16 a[102:103], v44 offset:12800
 v_mfma_f32_16x16x32_bf16 a[48:51], a[108:111], a[240:243], a[48:51]
 s_waitcnt lgkmcnt(8)
 v_mfma_f32_16x16x32_bf16 a[128:131], a[112:115], a[224:227], a[128:131]
 ds_read_b64_tr_b16 a[104:105], v45 offset:8192
 v_mfma_f32_16x16x32_bf16 a[128:131], a[116:119], a[240:243], a[128:131]
 buffer_load_dwordx4 v29, s[28:31], s33 offen offset:1024 lds
 v_mfma_f32_16x16x32_bf16 a[132:135], a[112:115], a[228:231], a[132:135]
 ds_read_b64_tr_b16 a[106:107], v45 offset:8704
 v_mfma_f32_16x16x32_bf16 a[132:135], a[116:119], a[244:247], a[132:135]
 v_mfma_f32_16x16x32_bf16 a[136:139], a[112:115], a[232:235], a[136:139]
 ds_read_b64_tr_b16 a[108:109], v45 offset:12288
 v_mfma_f32_16x16x32_bf16 a[136:139], a[116:119], a[248:251], a[136:139]
 buffer_load_dwordx4 v30, s[28:31], s33 offen offset:2048 lds
 v_mfma_f32_16x16x32_bf16 a[140:143], a[112:115], a[236:239], a[140:143]
 ds_read_b64_tr_b16 a[110:111], v45 offset:12800
 v_mfma_f32_16x16x32_bf16 a[140:143], a[116:119], a[252:255], a[140:143]
 s_waitcnt lgkmcnt(8)
 v_mfma_f32_16x16x32_bf16 a[156:159], a[120:123], a[236:239], a[156:159]
 ds_read_b64_tr_b16 a[112:113], v46 offset:0
 v_mfma_f32_16x16x32_bf16 a[156:159], a[124:127], a[252:255], a[156:159]
 v_mfma_f32_16x16x32_bf16 a[152:155], a[120:123], a[232:235], a[152:155]
 ds_read_b64_tr_b16 a[114:115], v46 offset:256
 v_mfma_f32_16x16x32_bf16 a[152:155], a[124:127], a[248:251], a[152:155]
 buffer_load_dwordx4 v31, s[28:31], s33 offen offset:3072 lds
 v_mfma_f32_16x16x32_bf16 a[148:151], a[120:123], a[228:231], a[148:151]
 ds_read_b64_tr_b16 a[116:117], v46 offset:8192
 v_mfma_f32_16x16x32_bf16 a[148:151], a[124:127], a[244:247], a[148:151]
 v_mfma_f32_16x16x32_bf16 a[144:147], a[120:123], a[224:227], a[144:147]
 ds_read_b64_tr_b16 a[118:119], v46 offset:8448
 v_mfma_f32_16x16x32_bf16 a[144:147], a[124:127], a[240:243], a[144:147]
 s_waitcnt lgkmcnt(8)
 v_mfma_f32_16x16x32_bf16 a[160:163], a[96:99], a[224:227], a[160:163]
 ds_read_b64_tr_b16 a[120:121], v47 offset:0
 s_add_u32 m0, s43, 0x20000
 v_mfma_f32_16x16x32_bf16 a[160:163], a[100:103], a[240:243], a[160:163]
 s_xor_b32 s34, s98, 0x180000
 v_mfma_f32_16x16x32_bf16 a[164:167], a[96:99], a[228:231], a[164:167]
 ds_read_b64_tr_b16 a[122:123], v47 offset:256
 v_mfma_f32_16x16x32_bf16 a[164:167], a[100:103], a[244:247], a[164:167]
 buffer_load_dwordx4 v32, s[16:19], s34 offen offset:0 lds
 v_mfma_f32_16x16x32_bf16 a[168:171], a[96:99], a[232:235], a[168:171]
 ds_read_b64_tr_b16 a[124:125], v47 offset:8192
 v_mfma_f32_16x16x32_bf16 a[168:171], a[100:103], a[248:251], a[168:171]
 buffer_store_dwordx4 v[224:227], v57, s[20:23], s47 offen offset:1024 sc1
 v_mfma_f32_16x16x32_bf16 a[172:175], a[96:99], a[236:239], a[172:175]
 ds_read_b64_tr_b16 a[126:127], v47 offset:8448
 v_mfma_f32_16x16x32_bf16 a[172:175], a[100:103], a[252:255], a[172:175]
 s_waitcnt lgkmcnt(8)
 v_mfma_f32_16x16x32_bf16 a[188:191], a[104:107], a[236:239], a[188:191]
 ds_read_b64_tr_b16 a[96:97], v46 offset:1024
 v_mfma_f32_16x16x32_bf16 a[188:191], a[108:111], a[252:255], a[188:191]
 buffer_load_dwordx4 v33, s[16:19], s34 offen offset:1024 lds
 v_mfma_f32_16x16x32_bf16 a[184:187], a[104:107], a[232:235], a[184:187]
 ds_read_b64_tr_b16 a[98:99], v46 offset:1280
 v_mfma_f32_16x16x32_bf16 a[184:187], a[108:111], a[248:251], a[184:187]
 buffer_load_dwordx4 v34, s[16:19], s34 offen offset:2048 lds
 v_mfma_f32_16x16x32_bf16 a[180:183], a[104:107], a[228:231], a[180:183]
 ds_read_b64_tr_b16 a[100:101], v46 offset:9216
 v_mfma_f32_16x16x32_bf16 a[180:183], a[108:111], a[244:247], a[180:183]
 v_mfma_f32_16x16x32_bf16 a[176:179], a[104:107], a[224:227], a[176:179]
 ds_read_b64_tr_b16 a[102:103], v46 offset:9472
 v_mfma_f32_16x16x32_bf16 a[176:179], a[108:111], a[240:243], a[176:179]
 s_waitcnt lgkmcnt(8)
 v_mfma_f32_16x16x32_bf16 v[80:83], a[112:115], a[224:227], v[80:83]
 ds_read_b64_tr_b16 a[104:105], v47 offset:1024
 v_mfma_f32_16x16x32_bf16 v[80:83], a[116:119], a[240:243], v[80:83]
 buffer_load_dwordx4 v35, s[16:19], s34 offen offset:3072 lds
 v_mfma_f32_16x16x32_bf16 v[84:87], a[112:115], a[228:231], v[84:87]
 ds_read_b64_tr_b16 a[106:107], v47 offset:1280
 v_mfma_f32_16x16x32_bf16 v[84:87], a[116:119], a[244:247], v[84:87]
 v_mfma_f32_16x16x32_bf16 v[88:91], a[112:115], a[232:235], v[88:91]
 ds_read_b64_tr_b16 a[108:109], v47 offset:9216
 v_mfma_f32_16x16x32_bf16 v[88:91], a[116:119], a[248:251], v[88:91]
 v_mfma_f32_16x16x32_bf16 v[92:95], a[112:115], a[236:239], v[92:95]
 ds_read_b64_tr_b16 a[110:111], v47 offset:9472
 v_mfma_f32_16x16x32_bf16 v[92:95], a[116:119], a[252:255], v[92:95]
 s_add_u32 m0, s44, 0x20000
 s_waitcnt lgkmcnt(8)
 v_mfma_f32_16x16x32_bf16 v[124:127], a[120:123], a[236:239], v[124:127]
 ds_read_b64_tr_b16 a[112:113], v46 offset:2048
 s_mov_b32 s35, 0x120000
 v_mfma_f32_16x16x32_bf16 v[124:127], a[124:127], a[252:255], v[124:127]
 buffer_load_dwordx4 v36, s[24:27], s35 offen offset:0 lds
 v_mfma_f32_16x16x32_bf16 v[120:123], a[120:123], a[232:235], v[120:123]
 ds_read_b64_tr_b16 a[114:115], v46 offset:2304
 v_mfma_f32_16x16x32_bf16 v[120:123], a[124:127], a[248:251], v[120:123]
 v_mfma_f32_16x16x32_bf16 v[116:119], a[120:123], a[228:231], v[116:119]
 ds_read_b64_tr_b16 a[116:117], v46 offset:10240
 v_mfma_f32_16x16x32_bf16 v[116:119], a[124:127], a[244:247], v[116:119]
 buffer_load_dwordx4 v37, s[24:27], s35 offen offset:1024 lds
 v_mfma_f32_16x16x32_bf16 v[112:115], a[120:123], a[224:227], v[112:115]
 ds_read_b64_tr_b16 a[118:119], v46 offset:10496
 v_mfma_f32_16x16x32_bf16 v[112:115], a[124:127], a[240:243], v[112:115]
 s_waitcnt lgkmcnt(8)
 v_mfma_f32_16x16x32_bf16 v[144:147], a[96:99], a[224:227], v[144:147]
 ds_read_b64_tr_b16 a[120:121], v47 offset:2048
 v_mfma_f32_16x16x32_bf16 v[144:147], a[100:103], a[240:243], v[144:147]
 v_mfma_f32_16x16x32_bf16 v[148:151], a[96:99], a[228:231], v[148:151]
 ds_read_b64_tr_b16 a[122:123], v47 offset:2304
 v_mfma_f32_16x16x32_bf16 v[148:151], a[100:103], a[244:247], v[148:151]
 buffer_load_dwordx4 v38, s[24:27], s35 offen offset:2048 lds
 v_mfma_f32_16x16x32_bf16 v[152:155], a[96:99], a[232:235], v[152:155]
 ds_read_b64_tr_b16 a[124:125], v47 offset:10240
 v_mfma_f32_16x16x32_bf16 v[152:155], a[100:103], a[248:251], v[152:155]
 v_mfma_f32_16x16x32_bf16 v[156:159], a[96:99], a[236:239], v[156:159]
 ds_read_b64_tr_b16 a[126:127], v47 offset:10496
 v_mfma_f32_16x16x32_bf16 v[156:159], a[100:103], a[252:255], v[156:159]
 s_waitcnt lgkmcnt(8)
 v_mfma_f32_16x16x32_bf16 v[188:191], a[104:107], a[236:239], v[188:191]
 v_mfma_f32_16x16x32_bf16 v[188:191], a[108:111], a[252:255], v[188:191]
 v_mfma_f32_16x16x32_bf16 v[184:187], a[104:107], a[232:235], v[184:187]
 v_mfma_f32_16x16x32_bf16 v[184:187], a[108:111], a[248:251], v[184:187]
 s_waitcnt lgkmcnt(0) vmcnt(18)
 s_barrier
 v_mfma_f32_16x16x32_bf16 v[180:183], a[104:107], a[228:231], v[180:183]
 ds_read_b64_tr_b16 a[96:97], v42 offset:32768
 v_mfma_f32_16x16x32_bf16 v[180:183], a[108:111], a[244:247], v[180:183]
 ds_read_b64_tr_b16 a[98:99], v42 offset:33280
 v_mfma_f32_16x16x32_bf16 v[176:179], a[104:107], a[224:227], v[176:179]
 ds_read_b64_tr_b16 a[100:101], v42 offset:36864
 buffer_store_dwordx4 v[232:235], v57, s[20:23], s48 offen offset:1024 sc1
 v_mfma_f32_16x16x32_bf16 v[176:179], a[108:111], a[240:243], v[176:179]
 ds_read_b64_tr_b16 a[102:103], v42 offset:37376
 v_mfma_f32_16x16x32_bf16 a[192:195], a[224:227], a[112:115], a[192:195]
 ds_read_b128 a[64:67], v40 offset:0
 v_mfma_f32_16x16x32_bf16 a[192:195], a[240:243], a[116:119], a[192:195]
 ds_read_b128 a[80:83], v41 offset:0
 v_mfma_f32_16x16x32_bf16 a[196:199], a[228:231], a[112:115], a[196:199]
 ds_read_b128 a[68:71], v40 offset:2048
 v_mfma_f32_16x16x32_bf16 a[196:199], a[244:247], a[116:119], a[196:199]
 ds_read_b128 a[84:87], v41 offset:2048
 v_mfma_f32_16x16x32_bf16 a[200:203], a[232:235], a[112:115], a[200:203]
 ds_read_b128 a[72:75], v40 offset:4096
 v_mfma_f32_16x16x32_bf16 a[200:203], a[248:251], a[116:119], a[200:203]
 ds_read_b128 a[88:91], v41 offset:4096
 v_mfma_f32_16x16x32_bf16 a[204:207], a[236:239], a[112:115], a[204:207]
 ds_read_b128 a[76:79], v40 offset:6144
 v_mfma_f32_16x16x32_bf16 a[204:207], a[252:255], a[116:119], a[204:207]
 ds_read_b128 a[92:95], v41 offset:6144
 v_mfma_f32_16x16x32_bf16 a[220:223], a[236:239], a[120:123], a[220:223]
 ds_read_b64_tr_b16 a[104:105], v43 offset:32768
 v_mfma_f32_16x16x32_bf16 a[220:223], a[252:255], a[124:127], a[220:223]
 ds_read_b64_tr_b16 a[106:107], v43 offset:33280
 v_mfma_f32_16x16x32_bf16 a[216:219], a[232:235], a[120:123], a[216:219]
 ds_read_b64_tr_b16 a[108:109], v43 offset:36864
 v_mfma_f32_16x16x32_bf16 a[216:219], a[248:251], a[124:127], a[216:219]
 ds_read_b64_tr_b16 a[110:111], v43 offset:37376
 v_mfma_f32_16x16x32_bf16 a[212:215], a[228:231], a[120:123], a[212:215]
 ds_read_b64_tr_b16 a[112:113], v44 offset:32768
 v_mfma_f32_16x16x32_bf16 a[212:215], a[244:247], a[124:127], a[212:215]
 ds_read_b64_tr_b16 a[114:115], v44 offset:33280
 v_mfma_f32_16x16x32_bf16 a[208:211], a[224:227], a[120:123], a[208:211]
 ds_read_b64_tr_b16 a[116:117], v44 offset:36864
 v_mfma_f32_16x16x32_bf16 a[208:211], a[240:243], a[124:127], a[208:211]
 ds_read_b64_tr_b16 a[118:119], v44 offset:37376
F_step10:
 s_waitcnt lgkmcnt(8)
 v_mfma_f32_16x16x32_bf16 a[0:3], a[96:99], a[64:67], a[0:3]
 ds_read_b64_tr_b16 a[120:121], v45 offset:32768
 v_mfma_f32_16x16x32_bf16 a[0:3], a[100:103], a[80:83], a[0:3]
 v_mfma_f32_16x16x32_bf16 a[4:7], a[96:99], a[68:71], a[4:7]
 ds_read_b64_tr_b16 a[122:123], v45 offset:33280
 v_mfma_f32_16x16x32_bf16 a[4:7], a[100:103], a[84:87], a[4:7]
 s_add_u32 m0, s46, 0
 s_xor_b32 s33, s99, 512
 v_mfma_f32_16x16x32_bf16 a[8:11], a[96:99], a[72:75], a[8:11]
 ds_read_b64_tr_b16 a[124:125], v45 offset:36864
 v_mfma_f32_16x16x32_bf16 a[8:11], a[100:103], a[88:91], a[8:11]
 buffer_load_dwordx4 v24, s[28:31], s33 offen offset:0 lds
 v_mfma_f32_16x16x32_bf16 a[12:15], a[96:99], a[76:79], a[12:15]
 ds_read_b64_tr_b16 a[126:127], v45 offset:37376
 v_mfma_f32_16x16x32_bf16 a[12:15], a[100:103], a[92:95], a[12:15]
 s_waitcnt lgkmcnt(8)
 v_mfma_f32_16x16x32_bf16 a[28:31], a[104:107], a[76:79], a[28:31]
 ds_read_b64_tr_b16 a[96:97], v42 offset:40960
 v_mfma_f32_16x16x32_bf16 a[28:31], a[108:111], a[92:95], a[28:31]
 buffer_load_dwordx4 v25, s[28:31], s33 offen offset:1024 lds
 v_mfma_f32_16x16x32_bf16 a[24:27], a[104:107], a[72:75], a[24:27]
 ds_read_b64_tr_b16 a[98:99], v42 offset:41472
 v_mfma_f32_16x16x32_bf16 a[24:27], a[108:111], a[88:91], a[24:27]
 buffer_store_dwordx4 v[240:243], v57, s[20:23], s47 offen offset:1280 sc1
 v_mfma_f32_16x16x32_bf16 a[20:23], a[104:107], a[68:71], a[20:23]
 ds_read_b64_tr_b16 a[100:101], v42 offset:45056
 v_mfma_f32_16x16x32_bf16 a[20:23], a[108:111], a[84:87], a[20:23]
 v_mfma_f32_16x16x32_bf16 a[16:19], a[104:107], a[64:67], a[16:19]
 ds_read_b64_tr_b16 a[102:103], v42 offset:45568
 v_mfma_f32_16x16x32_bf16 a[16:19], a[108:111], a[80:83], a[16:19]
 s_waitcnt lgkmcnt(8)
 v_mfma_f32_16x16x32_bf16 a[32:35], a[112:115], a[64:67], a[32:35]
 ds_read_b64_tr_b16 a[104:105], v43 offset:40960
 v_mfma_f32_16x16x32_bf16 a[32:35], a[116:119], a[80:83], a[32:35]
 buffer_load_dwordx4 v26, s[28:31], s33 offen offset:2048 lds
 v_mfma_f32_16x16x32_bf16 a[36:39], a[112:115], a[68:71], a[36:39]
 ds_read_b64_tr_b16 a[106:107], v43 offset:41472
 v_mfma_f32_16x16x32_bf16 a[36:39], a[116:119], a[84:87], a[36:39]
 v_mfma_f32_16x16x32_bf16 a[40:43], a[112:115], a[72:75], a[40:43]
 ds_read_b64_tr_b16 a[108:109], v43 offset:45056
 v_mfma_f32_16x16x32_bf16 a[40:43], a[116:119], a[88:91], a[40:43]
 buffer_load_dwordx4 v27, s[28:31], s33 offen offset:3072 lds
 v_mfma_f32_16x16x32_bf16 a[44:47], a[112:115], a[76:79], a[44:47]
 ds_read_b64_tr_b16 a[110:111], v43 offset:45568
 v_mfma_f32_16x16x32_bf16 a[44:47], a[116:119], a[92:95], a[44:47]
 s_waitcnt lgkmcnt(8)
 v_mfma_f32_16x16x32_bf16 a[60:63], a[120:123], a[76:79], a[60:63]
 ds_read_b64_tr_b16 a[112:113], v44 offset:40960
 v_mfma_f32_16x16x32_bf16 a[60:63], a[124:127], a[92:95], a[60:63]
 s_add_u32 m0, s46, 4096
 v_mfma_f32_16x16x32_bf16 a[56:59], a[120:123], a[72:75], a[56:59]
 ds_read_b64_tr_b16 a[114:115], v44 offset:41472
 v_mfma_f32_16x16x32_bf16 a[56:59], a[124:127], a[88:91], a[56:59]
 buffer_load_dwordx4 v28, s[28:31], s33 offen offset:0 lds
 v_mfma_f32_16x16x32_bf16 a[52:55], a[120:123], a[68:71], a[52:55]
 ds_read_b64_tr_b16 a[116:117], v44 offset:45056
 v_mfma_f32_16x16x32_bf16 a[52:55], a[124:127], a[84:87], a[52:55]
 v_mfma_f32_16x16x32_bf16 a[48:51], a[120:123], a[64:67], a[48:51]
 ds_read_b64_tr_b16 a[118:119], v44 offset:45568
 v_mfma_f32_16x16x32_bf16 a[48:51], a[124:127], a[80:83], a[48:51]
 s_waitcnt lgkmcnt(8)
 v_mfma_f32_16x16x32_bf16 a[128:131], a[96:99], a[64:67], a[128:131]
 ds_read_b64_tr_b16 a[120:121], v45 offset:40960
 v_mfma_f32_16x16x32_bf16 a[128:131], a[100:103], a[80:83], a[128:131]
 buffer_load_dwordx4 v29, s[28:31], s33 offen offset:1024 lds
 v_mfma_f32_16x16x32_bf16 a[132:135], a[96:99], a[68:71], a[132:135]
 ds_read_b64_tr_b16 a[122:123], v45 offset:41472
 v_mfma_f32_16x16x32_bf16 a[132:135], a[100:103], a[84:87], a[132:135]
 v_mfma_f32_16x16x32_bf16 a[136:139], a[96:99], a[72:75], a[136:139]
 ds_read_b64_tr_b16 a[124:125], v45 offset:45056
 v_mfma_f32_16x16x32_bf16 a[136:139], a[100:103], a[88:91], a[136:139]
 buffer_load_dwordx4 v30, s[28:31], s33 offen offset:2048 lds
 v_mfma_f32_16x16x32_bf16 a[140:143], a[96:99], a[76:79], a[140:143]
 ds_read_b64_tr_b16 a[126:127], v45 offset:45568
 v_mfma_f32_16x16x32_bf16 a[140:143], a[100:103], a[92:95], a[140:143]
 s_waitcnt lgkmcnt(8)
 v_mfma_f32_16x16x32_bf16 a[156:159], a[104:107], a[76:79], a[156:159]
 ds_read_b64_tr_b16 a[96:97], v46 offset:32768
 v_mfma_f32_16x16x32_bf16 a[156:159], a[108:111], a[92:95], a[156:159]
 v_mfma_f32_16x16x32_bf16 a[152:155], a[104:107], a[72:75], a[152:155]
 ds_read_b64_tr_b16 a[98:99], v46 offset:33024
 v_mfma_f32_16x16x32_bf16 a[152:155], a[108:111], a[88:91], a[152:155]
 buffer_load_dwordx4 v31, s[28:31], s33 offen offset:3072 lds
 v_mfma_f32_16x16x32_bf16 a[148:151], a[104:107], a[68:71], a[148:151]
 ds_read_b64_tr_b16 a[100:101], v46 offset:40960
 v_mfma_f32_16x16x32_bf16 a[148:151], a[108:111], a[84:87], a[148:151]
 v_mfma_f32_16x16x32_bf16 a[144:147], a[104:107], a[64:67], a[144:147]
 ds_read_b64_tr_b16 a[102:103], v46 offset:41216
 v_mfma_f32_16x16x32_bf16 a[144:147], a[108:111], a[80:83], a[144:147]
 s_waitcnt lgkmcnt(8)
 v_mfma_f32_16x16x32_bf16 a[160:163], a[112:115], a[64:67], a[160:163]
 ds_read_b64_tr_b16 a[104:105], v47 offset:32768
 s_add_u32 m0, s43, 0x10000
 v_mfma_f32_16x16x32_bf16 a[160:163], a[116:119], a[80:83], a[160:163]
 s_xor_b32 s34, s98, 0x200000
 v_mfma_f32_16x16x32_bf16 a[164:167], a[112:115], a[68:71], a[164:167]
 ds_read_b64_tr_b16 a[106:107], v47 offset:33024
 v_mfma_f32_16x16x32_bf16 a[164:167], a[116:119], a[84:87], a[164:167]
 buffer_load_dwordx4 v32, s[16:19], s34 offen offset:0 lds
 v_mfma_f32_16x16x32_bf16 a[168:171], a[112:115], a[72:75], a[168:171]
 ds_read_b64_tr_b16 a[108:109], v47 offset:40960
 v_mfma_f32_16x16x32_bf16 a[168:171], a[116:119], a[88:91], a[168:171]
 buffer_store_dwordx4 v[248:251], v57, s[20:23], s48 offen offset:1280 sc1
 v_mfma_f32_16x16x32_bf16 a[172:175], a[112:115], a[76:79], a[172:175]
 ds_read_b64_tr_b16 a[110:111], v47 offset:41216
 v_mfma_f32_16x16x32_bf16 a[172:175], a[116:119], a[92:95], a[172:175]
 s_waitcnt lgkmcnt(8)
 v_mfma_f32_16x16x32_bf16 a[188:191], a[120:123], a[76:79], a[188:191]
 ds_read_b64_tr_b16 a[112:113], v46 offset:33792
 v_mfma_f32_16x16x32_bf16 a[188:191], a[124:127], a[92:95], a[188:191]
 buffer_load_dwordx4 v33, s[16:19], s34 offen offset:1024 lds
 v_mfma_f32_16x16x32_bf16 a[184:187], a[120:123], a[72:75], a[184:187]
 ds_read_b64_tr_b16 a[114:115], v46 offset:34048
 v_mfma_f32_16x16x32_bf16 a[184:187], a[124:127], a[88:91], a[184:187]
 buffer_load_dwordx4 v34, s[16:19], s34 offen offset:2048 lds
 v_mfma_f32_16x16x32_bf16 a[180:183], a[120:123], a[68:71], a[180:183]
 ds_read_b64_tr_b16 a[116:117], v46 offset:41984
 v_mfma_f32_16x16x32_bf16 a[180:183], a[124:127], a[84:87], a[180:183]
 v_mfma_f32_16x16x32_bf16 a[176:179], a[120:123], a[64:67], a[176:179]
 ds_read_b64_tr_b16 a[118:119], v46 offset:42240
 v_mfma_f32_16x16x32_bf16 a[176:179], a[124:127], a[80:83], a[176:179]
 s_waitcnt lgkmcnt(8)
 v_mfma_f32_16x16x32_bf16 v[80:83], a[96:99], a[64:67], v[80:83]
 ds_read_b64_tr_b16 a[120:121], v47 offset:33792
 v_mfma_f32_16x16x32_bf16 v[80:83], a[100:103], a[80:83], v[80:83]
 buffer_load_dwordx4 v35, s[16:19], s34 offen offset:3072 lds
 v_mfma_f32_16x16x32_bf16 v[84:87], a[96:99], a[68:71], v[84:87]
 ds_read_b64_tr_b16 a[122:123], v47 offset:34048
 v_mfma_f32_16x16x32_bf16 v[84:87], a[100:103], a[84:87], v[84:87]
 v_mfma_f32_16x16x32_bf16 v[88:91], a[96:99], a[72:75], v[88:91]
 ds_read_b64_tr_b16 a[124:125], v47 offset:41984
 v_mfma_f32_16x16x32_bf16 v[88:91], a[100:103], a[88:91], v[88:91]
 v_mfma_f32_16x16x32_bf16 v[92:95], a[96:99], a[76:79], v[92:95]
 ds_read_b64_tr_b16 a[126:127], v47 offset:42240
 v_mfma_f32_16x16x32_bf16 v[92:95], a[100:103], a[92:95], v[92:95]
 s_add_u32 m0, s44, 0x10000
 s_waitcnt lgkmcnt(8)
 v_mfma_f32_16x16x32_bf16 v[124:127], a[104:107], a[76:79], v[124:127]
 ds_read_b64_tr_b16 a[96:97], v46 offset:34816
 s_mov_b32 s35, 0x180000
 v_mfma_f32_16x16x32_bf16 v[124:127], a[108:111], a[92:95], v[124:127]
 buffer_load_dwordx4 v36, s[24:27], s35 offen offset:0 lds
 v_mfma_f32_16x16x32_bf16 v[120:123], a[104:107], a[72:75], v[120:123]
 ds_read_b64_tr_b16 a[98:99], v46 offset:35072
 v_mfma_f32_16x16x32_bf16 v[120:123], a[108:111], a[88:91], v[120:123]
 v_mfma_f32_16x16x32_bf16 v[116:119], a[104:107], a[68:71], v[116:119]
 ds_read_b64_tr_b16 a[100:101], v46 offset:43008
 v_mfma_f32_16x16x32_bf16 v[116:119], a[108:111], a[84:87], v[116:119]
 buffer_load_dwordx4 v37, s[24:27], s35 offen offset:1024 lds
 v_mfma_f32_16x16x32_bf16 v[112:115], a[104:107], a[64:67], v[112:115]
 ds_read_b64_tr_b16 a[102:103], v46 offset:43264
 v_mfma_f32_16x16x32_bf16 v[112:115], a[108:111], a[80:83], v[112:115]
 s_waitcnt lgkmcnt(8)
 v_mfma_f32_16x16x32_bf16 v[144:147], a[112:115], a[64:67], v[144:147]
 ds_read_b64_tr_b16 a[104:105], v47 offset:34816
 v_mfma_f32_16x16x32_bf16 v[144:147], a[116:119], a[80:83], v[144:147]
 v_mfma_f32_16x16x32_bf16 v[148:151], a[112:115], a[68:71], v[148:151]
 ds_read_b64_tr_b16 a[106:107], v47 offset:35072
 v_mfma_f32_16x16x32_bf16 v[148:151], a[116:119], a[84:87], v[148:151]
 buffer_load_dwordx4 v38, s[24:27], s35 offen offset:2048 lds
 v_mfma_f32_16x16x32_bf16 v[152:155], a[112:115], a[72:75], v[152:155]
 ds_read_b64_tr_b16 a[108:109], v47 offset:43008
 v_mfma_f32_16x16x32_bf16 v[152:155], a[116:119], a[88:91], v[152:155]
 v_mfma_f32_16x16x32_bf16 v[156:159], a[112:115], a[76:79], v[156:159]
 ds_read_b64_tr_b16 a[110:111], v47 offset:43264
 v_mfma_f32_16x16x32_bf16 v[156:159], a[116:119], a[92:95], v[156:159]
 s_waitcnt lgkmcnt(8)
 v_mfma_f32_16x16x32_bf16 v[188:191], a[120:123], a[76:79], v[188:191]
 v_mfma_f32_16x16x32_bf16 v[188:191], a[124:127], a[92:95], v[188:191]
 v_mfma_f32_16x16x32_bf16 v[184:187], a[120:123], a[72:75], v[184:187]
 v_mfma_f32_16x16x32_bf16 v[184:187], a[124:127], a[88:91], v[184:187]
 s_waitcnt lgkmcnt(0) vmcnt(18)
 s_barrier
 v_mfma_f32_16x16x32_bf16 v[180:183], a[120:123], a[68:71], v[180:183]
 ds_read_b64_tr_b16 a[112:113], v48 offset:0
 v_mfma_f32_16x16x32_bf16 v[180:183], a[124:127], a[84:87], v[180:183]
 ds_read_b64_tr_b16 a[114:115], v48 offset:512
 v_mfma_f32_16x16x32_bf16 v[176:179], a[120:123], a[64:67], v[176:179]
 ds_read_b64_tr_b16 a[116:117], v48 offset:4096
 buffer_store_dwordx4 v[196:199], v57, s[20:23], s92 offen offset:2048 sc1
 v_mfma_f32_16x16x32_bf16 v[176:179], a[124:127], a[80:83], v[176:179]
 ds_read_b64_tr_b16 a[118:119], v48 offset:4608
 v_mfma_f32_16x16x32_bf16 a[192:195], a[64:67], a[96:99], a[192:195]
 ds_read_b128 a[224:227], v40 offset:8192
 v_mfma_f32_16x16x32_bf16 a[192:195], a[80:83], a[100:103], a[192:195]
 ds_read_b128 a[240:243], v41 offset:8192
 v_mfma_f32_16x16x32_bf16 a[196:199], a[68:71], a[96:99], a[196:199]
 ds_read_b128 a[228:231], v40 offset:10240
 v_mfma_f32_16x16x32_bf16 a[196:199], a[84:87], a[100:103], a[196:199]
 ds_read_b128 a[244:247], v41 offset:10240
 v_mfma_f32_16x16x32_bf16 a[200:203], a[72:75], a[96:99], a[200:203]
 ds_read_b128 a[232:235], v40 offset:12288
 v_mfma_f32_16x16x32_bf16 a[200:203], a[88:91], a[100:103], a[200:203]
 ds_read_b128 a[248:251], v41 offset:12288
 v_mfma_f32_16x16x32_bf16 a[204:207], a[76:79], a[96:99], a[204:207]
 ds_read_b128 a[236:239], v40 offset:14336
 v_mfma_f32_16x16x32_bf16 a[204:207], a[92:95], a[100:103], a[204:207]
 ds_read_b128 a[252:255], v41 offset:14336
 v_mfma_f32_16x16x32_bf16 a[220:223], a[76:79], a[104:107], a[220:223]
 ds_read_b64_tr_b16 a[120:121], v49 offset:0
 v_mfma_f32_16x16x32_bf16 a[220:223], a[92:95], a[108:111], a[220:223]
 ds_read_b64_tr_b16 a[122:123], v49 offset:512
 v_mfma_f32_16x16x32_bf16 a[216:219], a[72:75], a[104:107], a[216:219]
 ds_read_b64_tr_b16 a[124:125], v49 offset:4096
 v_mfma_f32_16x16x32_bf16 a[216:219], a[88:91], a[108:111], a[216:219]
 ds_read_b64_tr_b16 a[126:127], v49 offset:4608
 v_mfma_f32_16x16x32_bf16 a[212:215], a[68:71], a[104:107], a[212:215]
 ds_read_b64_tr_b16 a[96:97], v50 offset:0
 v_mfma_f32_16x16x32_bf16 a[212:215], a[84:87], a[108:111], a[212:215]
 ds_read_b64_tr_b16 a[98:99], v50 offset:512
 v_mfma_f32_16x16x32_bf16 a[208:211], a[64:67], a[104:107], a[208:211]
 ds_read_b64_tr_b16 a[100:101], v50 offset:4096
 v_mfma_f32_16x16x32_bf16 a[208:211], a[80:83], a[108:111], a[208:211]
 ds_read_b64_tr_b16 a[102:103], v50 offset:4608
F_step11:
 s_waitcnt lgkmcnt(8)
 v_mfma_f32_16x16x32_bf16 a[0:3], a[112:115], a[224:227], a[0:3]
 ds_read_b64_tr_b16 a[104:105], v51 offset:0
 v_mfma_f32_16x16x32_bf16 a[0:3], a[116:119], a[240:243], a[0:3]
 v_mfma_f32_16x16x32_bf16 a[4:7], a[112:115], a[228:231], a[4:7]
 ds_read_b64_tr_b16 a[106:107], v51 offset:512
 v_mfma_f32_16x16x32_bf16 a[4:7], a[116:119], a[244:247], a[4:7]
 s_add_u32 m0, s46, 8192
 s_xor_b32 s33, s99, 640
 v_mfma_f32_16x16x32_bf16 a[8:11], a[112:115], a[232:235], a[8:11]
 ds_read_b64_tr_b16 a[108:109], v51 offset:4096
 v_mfma_f32_16x16x32_bf16 a[8:11], a[116:119], a[248:251], a[8:11]
 buffer_load_dwordx4 v24, s[28:31], s33 offen offset:0 lds
 v_mfma_f32_16x16x32_bf16 a[12:15], a[112:115], a[236:239], a[12:15]
 ds_read_b64_tr_b16 a[110:111], v51 offset:4608
 v_mfma_f32_16x16x32_bf16 a[12:15], a[116:119], a[252:255], a[12:15]
 s_waitcnt lgkmcnt(8)
 v_mfma_f32_16x16x32_bf16 a[28:31], a[120:123], a[236:239], a[28:31]
 ds_read_b64_tr_b16 a[112:113], v48 offset:8192
 v_mfma_f32_16x16x32_bf16 a[28:31], a[124:127], a[252:255], a[28:31]
 buffer_load_dwordx4 v25, s[28:31], s33 offen offset:1024 lds
 v_mfma_f32_16x16x32_bf16 a[24:27], a[120:123], a[232:235], a[24:27]
 ds_read_b64_tr_b16 a[114:115], v48 offset:8704
 v_mfma_f32_16x16x32_bf16 a[24:27], a[124:127], a[248:251], a[24:27]
 buffer_store_dwordx4 v[204:207], v57, s[20:23], s93 offen offset:2048 sc1
 v_mfma_f32_16x16x32_bf16 a[20:23], a[120:123], a[228:231], a[20:23]
 ds_read_b64_tr_b16 a[116:117], v48 offset:12288
 v_mfma_f32_16x16x32_bf16 a[20:23], a[124:127], a[244:247], a[20:23]
 buffer_load_dwordx4 v26, s[28:31], s33 offen offset:2048 lds
 v_mfma_f32_16x16x32_bf16 a[16:19], a[120:123], a[224:227], a[16:19]
 ds_read_b64_tr_b16 a[118:119], v48 offset:12800
 v_mfma_f32_16x16x32_bf16 a[16:19], a[124:127], a[240:243], a[16:19]
 s_waitcnt lgkmcnt(8)
 v_mfma_f32_16x16x32_bf16 a[32:35], a[96:99], a[224:227], a[32:35]
 ds_read_b64_tr_b16 a[120:121], v49 offset:8192
 v_mfma_f32_16x16x32_bf16 a[32:35], a[100:103], a[240:243], a[32:35]
 v_mfma_f32_16x16x32_bf16 a[36:39], a[96:99], a[228:231], a[36:39]
 ds_read_b64_tr_b16 a[122:123], v49 offset:8704
 v_mfma_f32_16x16x32_bf16 a[36:39], a[100:103], a[244:247], a[36:39]
 buffer_load_dwordx4 v27, s[28:31], s33 offen offset:3072 lds
 v_mfma_f32_16x16x32_bf16 a[40:43], a[96:99], a[232:235], a[40:43]
 ds_read_b64_tr_b16 a[124:125], v49 offset:12288
 v_mfma_f32_16x16x32_bf16 a[40:43], a[100:103], a[248:251], a[40:43]
 v_mfma_f32_16x16x32_bf16 a[44:47], a[96:99], a[236:239], a[44:47]
 ds_read_b64_tr_b16 a[126:127], v49 offset:12800
 v_mfma_f32_16x16x32_bf16 a[44:47], a[100:103], a[252:255], a[44:47]
 s_waitcnt lgkmcnt(8)
 v_mfma_f32_16x16x32_bf16 a[60:63], a[104:107], a[236:239], a[60:63]
 ds_read_b64_tr_b16 a[96:97], v50 offset:8192
 s_add_u32 m0, s46, 12288
 v_mfma_f32_16x16x32_bf16 a[60:63], a[108:111], a[252:255], a[60:63]
 buffer_load_dwordx4 v28, s[28:31], s33 offen offset:0 lds
 v_mfma_f32_16x16x32_bf16 a[56:59], a[104:107], a[232:235], a[56:59]
 ds_read_b64_tr_b16 a[98:99], v50 offset:8704
 v_mfma_f32_16x16x32_bf16 a[56:59], a[108:111], a[248:251], a[56:59]
 v_mfma_f32_16x16x32_bf16 a[52:55], a[104:107], a[228:231], a[52:55]
 ds_read_b64_tr_b16 a[100:101], v50 offset:12288
 v_mfma_f32_16x16x32_bf16 a[52:55], a[108:111], a[244:247], a[52:55]
 v_mfma_f32_16x16x32_bf16 a[48:51], a[104:107], a[224:227], a[48:51]
 ds_read_b64_tr_b16 a[102:103], v50 offset:12800
 v_mfma_f32_16x16x32_bf16 a[48:51], a[108:111], a[240:243], a[48:51]
 s_waitcnt lgkmcnt(8)
 v_mfma_f32_16x16x32_bf16 a[128:131], a[112:115], a[224:227], a[128:131]
 ds_read_b64_tr_b16 a[104:105], v51 offset:8192
 v_mfma_f32_16x16x32_bf16 a[128:131], a[116:119], a[240:243], a[128:131]
 buffer_load_dwordx4 v29, s[28:31], s33 offen offset:1024 lds
 v_mfma_f32_16x16x32_bf16 a[132:135], a[112:115], a[228:231], a[132:135]
 ds_read_b64_tr_b16 a[106:107], v51 offset:8704
 v_mfma_f32_16x16x32_bf16 a[132:135], a[116:119], a[244:247], a[132:135]
 buffer_load_dwordx4 v30, s[28:31], s33 offen offset:2048 lds
 v_mfma_f32_16x16x32_bf16 a[136:139], a[112:115], a[232:235], a[136:139]
 ds_read_b64_tr_b16 a[108:109], v51 offset:12288
 v_mfma_f32_16x16x32_bf16 a[136:139], a[116:119], a[248:251], a[136:139]
 v_mfma_f32_16x16x32_bf16 a[140:143], a[112:115], a[236:239], a[140:143]
 ds_read_b64_tr_b16 a[110:111], v51 offset:12800
 v_mfma_f32_16x16x32_bf16 a[140:143], a[116:119], a[252:255], a[140:143]
 s_waitcnt lgkmcnt(8)
 v_mfma_f32_16x16x32_bf16 a[156:159], a[120:123], a[236:239], a[156:159]
 ds_read_b64_tr_b16 a[112:113], v52 offset:0
 v_mfma_f32_16x16x32_bf16 a[156:159], a[124:127], a[252:255], a[156:159]
 buffer_load_dwordx4 v31, s[28:31], s33 offen offset:3072 lds
 v_mfma_f32_16x16x32_bf16 a[152:155], a[120:123], a[232:235], a[152:155]
 ds_read_b64_tr_b16 a[114:115], v52 offset:256
 v_mfma_f32_16x16x32_bf16 a[152:155], a[124:127], a[248:251], a[152:155]
 v_mfma_f32_16x16x32_bf16 a[148:151], a[120:123], a[228:231], a[148:151]
 ds_read_b64_tr_b16 a[116:117], v52 offset:8192
 v_mfma_f32_16x16x32_bf16 a[148:151], a[124:127], a[244:247], a[148:151]
 v_mfma_f32_16x16x32_bf16 a[144:147], a[120:123], a[224:227], a[144:147]
 ds_read_b64_tr_b16 a[118:119], v52 offset:8448
 s_add_u32 m0, s43, 0x18000
 v_mfma_f32_16x16x32_bf16 a[144:147], a[124:127], a[240:243], a[144:147]
 s_xor_b32 s34, s98, 0x280000
 s_waitcnt lgkmcnt(8)
 v_mfma_f32_16x16x32_bf16 a[160:163], a[96:99], a[224:227], a[160:163]
 ds_read_b64_tr_b16 a[120:121], v53 offset:0
 v_mfma_f32_16x16x32_bf16 a[160:163], a[100:103], a[240:243], a[160:163]
 buffer_load_dwordx4 v32, s[16:19], s34 offen offset:0 lds
 v_mfma_f32_16x16x32_bf16 a[164:167], a[96:99], a[228:231], a[164:167]
 ds_read_b64_tr_b16 a[122:123], v53 offset:256
 v_mfma_f32_16x16x32_bf16 a[164:167], a[100:103], a[244:247], a[164:167]
 buffer_load_dwordx4 v33, s[16:19], s34 offen offset:1024 lds
 v_mfma_f32_16x16x32_bf16 a[168:171], a[96:99], a[232:235], a[168:171]
 ds_read_b64_tr_b16 a[124:125], v53 offset:8192
 v_mfma_f32_16x16x32_bf16 a[168:171], a[100:103], a[248:251], a[168:171]
 buffer_store_dwordx4 v[212:215], v57, s[20:23], s92 offen offset:2304 sc1
 v_mfma_f32_16x16x32_bf16 a[172:175], a[96:99], a[236:239], a[172:175]
 ds_read_b64_tr_b16 a[126:127], v53 offset:8448
 v_mfma_f32_16x16x32_bf16 a[172:175], a[100:103], a[252:255], a[172:175]
 s_waitcnt lgkmcnt(8)
 v_mfma_f32_16x16x32_bf16 a[188:191], a[104:107], a[236:239], a[188:191]
 ds_read_b64_tr_b16 a[96:97], v52 offset:1024
 v_mfma_f32_16x16x32_bf16 a[188:191], a[108:111], a[252:255], a[188:191]
 buffer_load_dwordx4 v34, s[16:19], s34 offen offset:2048 lds
 v_mfma_f32_16x16x32_bf16 a[184:187], a[104:107], a[232:235], a[184:187]
 ds_read_b64_tr_b16 a[98:99], v52 offset:1280
 v_mfma_f32_16x16x32_bf16 a[184:187], a[108:111], a[248:251], a[184:187]
 v_mfma_f32_16x16x32_bf16 a[180:183], a[104:107], a[228:231], a[180:183]
 ds_read_b64_tr_b16 a[100:101], v52 offset:9216
 v_mfma_f32_16x16x32_bf16 a[180:183], a[108:111], a[244:247], a[180:183]
 v_mfma_f32_16x16x32_bf16 a[176:179], a[104:107], a[224:227], a[176:179]
 ds_read_b64_tr_b16 a[102:103], v52 offset:9472
 v_mfma_f32_16x16x32_bf16 a[176:179], a[108:111], a[240:243], a[176:179]
 s_waitcnt lgkmcnt(8)
 v_mfma_f32_16x16x32_bf16 v[80:83], a[112:115], a[224:227], v[80:83]
 ds_read_b64_tr_b16 a[104:105], v53 offset:1024
 v_mfma_f32_16x16x32_bf16 v[80:83], a[116:119], a[240:243], v[80:83]
 buffer_load_dwordx4 v35, s[16:19], s34 offen offset:3072 lds
 v_mfma_f32_16x16x32_bf16 v[84:87], a[112:115], a[228:231], v[84:87]
 ds_read_b64_tr_b16 a[106:107], v53 offset:1280
 v_mfma_f32_16x16x32_bf16 v[84:87], a[116:119], a[244:247], v[84:87]
 s_add_u32 m0, s44, 0x18000
 s_mov_b32 s35, 0x1e0000
 v_mfma_f32_16x16x32_bf16 v[88:91], a[112:115], a[232:235], v[88:91]
 ds_read_b64_tr_b16 a[108:109], v53 offset:9216
 v_mfma_f32_16x16x32_bf16 v[88:91], a[116:119], a[248:251], v[88:91]
 buffer_load_dwordx4 v36, s[24:27], s35 offen offset:0 lds
 v_mfma_f32_16x16x32_bf16 v[92:95], a[112:115], a[236:239], v[92:95]
 ds_read_b64_tr_b16 a[110:111], v53 offset:9472
 v_mfma_f32_16x16x32_bf16 v[92:95], a[116:119], a[252:255], v[92:95]
 s_waitcnt lgkmcnt(8)
 v_mfma_f32_16x16x32_bf16 v[124:127], a[120:123], a[236:239], v[124:127]
 ds_read_b64_tr_b16 a[112:113], v52 offset:2048
 v_mfma_f32_16x16x32_bf16 v[124:127], a[124:127], a[252:255], v[124:127]
 buffer_load_dwordx4 v37, s[24:27], s35 offen offset:1024 lds
 v_mfma_f32_16x16x32_bf16 v[120:123], a[120:123], a[232:235], v[120:123]
 ds_read_b64_tr_b16 a[114:115], v52 offset:2304
 v_mfma_f32_16x16x32_bf16 v[120:123], a[124:127], a[248:251], v[120:123]
 v_mfma_f32_16x16x32_bf16 v[116:119], a[120:123], a[228:231], v[116:119]
 ds_read_b64_tr_b16 a[116:117], v52 offset:10240
 v_mfma_f32_16x16x32_bf16 v[116:119], a[124:127], a[244:247], v[116:119]
 v_mfma_f32_16x16x32_bf16 v[112:115], a[120:123], a[224:227], v[112:115]
 ds_read_b64_tr_b16 a[118:119], v52 offset:10496
 v_mfma_f32_16x16x32_bf16 v[112:115], a[124:127], a[240:243], v[112:115]
 s_waitcnt lgkmcnt(8)
 v_mfma_f32_16x16x32_bf16 v[144:147], a[96:99], a[224:227], v[144:147]
 ds_read_b64_tr_b16 a[120:121], v53 offset:2048
 v_mfma_f32_16x16x32_bf16 v[144:147], a[100:103], a[240:243], v[144:147]
 buffer_load_dwordx4 v38, s[24:27], s35 offen offset:2048 lds
 v_mfma_f32_16x16x32_bf16 v[148:151], a[96:99], a[228:231], v[148:151]
 ds_read_b64_tr_b16 a[122:123], v53 offset:2304
 v_mfma_f32_16x16x32_bf16 v[148:151], a[100:103], a[244:247], v[148:151]
 v_mfma_f32_16x16x32_bf16 v[152:155], a[96:99], a[232:235], v[152:155]
 ds_read_b64_tr_b16 a[124:125], v53 offset:10240
 v_mfma_f32_16x16x32_bf16 v[152:155], a[100:103], a[248:251], v[152:155]
 v_mfma_f32_16x16x32_bf16 v[156:159], a[96:99], a[236:239], v[156:159]
 ds_read_b64_tr_b16 a[126:127], v53 offset:10496
 v_min_u32 v5, 1, v2
 v_mfma_f32_16x16x32_bf16 v[156:159], a[100:103], a[252:255], v[156:159]
 v_mad_u32_u24 v5, s45, 2, v5
 s_waitcnt lgkmcnt(8)
 v_mfma_f32_16x16x32_bf16 v[188:191], a[104:107], a[236:239], v[188:191]
 v_lshlrev_b32 v5, 7, v5
 v_mfma_f32_16x16x32_bf16 v[188:191], a[108:111], a[252:255], v[188:191]
 v_add_u32 v5, F_step15-F_pc, v5
 v_mfma_f32_16x16x32_bf16 v[184:187], a[104:107], a[232:235], v[184:187]
 global_load_dword v60, v5, s[90:91]
 v_mfma_f32_16x16x32_bf16 v[184:187], a[108:111], a[248:251], v[184:187]
 s_waitcnt lgkmcnt(0) vmcnt(19)
 s_barrier
 v_mfma_f32_16x16x32_bf16 v[180:183], a[104:107], a[228:231], v[180:183]
 ds_read_b64_tr_b16 a[96:97], v42 offset:0
 v_mfma_f32_16x16x32_bf16 v[180:183], a[108:111], a[244:247], v[180:183]
 ds_read_b64_tr_b16 a[98:99], v42 offset:512
 v_mfma_f32_16x16x32_bf16 v[176:179], a[104:107], a[224:227], v[176:179]
 ds_read_b64_tr_b16 a[100:101], v42 offset:4096
 buffer_store_dwordx4 v[220:223], v57, s[20:23], s93 offen offset:2304 sc1
 v_mfma_f32_16x16x32_bf16 v[176:179], a[108:111], a[240:243], v[176:179]
 ds_read_b64_tr_b16 a[102:103], v42 offset:4608
 v_mfma_f32_16x16x32_bf16 a[192:195], a[224:227], a[112:115], a[192:195]
 ds_read_b128 a[64:67], v40 offset:0
 v_mfma_f32_16x16x32_bf16 a[192:195], a[240:243], a[116:119], a[192:195]
 ds_read_b128 a[80:83], v41 offset:0
 v_mfma_f32_16x16x32_bf16 a[196:199], a[228:231], a[112:115], a[196:199]
 ds_read_b128 a[68:71], v40 offset:2048
 v_mfma_f32_16x16x32_bf16 a[196:199], a[244:247], a[116:119], a[196:199]
 ds_read_b128 a[84:87], v41 offset:2048
 v_mfma_f32_16x16x32_bf16 a[200:203], a[232:235], a[112:115], a[200:203]
 ds_read_b128 a[72:75], v40 offset:4096
 v_mfma_f32_16x16x32_bf16 a[200:203], a[248:251], a[116:119], a[200:203]
 ds_read_b128 a[88:91], v41 offset:4096
 v_mfma_f32_16x16x32_bf16 a[204:207], a[236:239], a[112:115], a[204:207]
 ds_read_b128 a[76:79], v40 offset:6144
 v_mfma_f32_16x16x32_bf16 a[204:207], a[252:255], a[116:119], a[204:207]
 ds_read_b128 a[92:95], v41 offset:6144
 v_mfma_f32_16x16x32_bf16 a[220:223], a[236:239], a[120:123], a[220:223]
 ds_read_b64_tr_b16 a[104:105], v43 offset:0
 v_mfma_f32_16x16x32_bf16 a[220:223], a[252:255], a[124:127], a[220:223]
 ds_read_b64_tr_b16 a[106:107], v43 offset:512
 v_mfma_f32_16x16x32_bf16 a[216:219], a[232:235], a[120:123], a[216:219]
 ds_read_b64_tr_b16 a[108:109], v43 offset:4096
 v_mfma_f32_16x16x32_bf16 a[216:219], a[248:251], a[124:127], a[216:219]
 ds_read_b64_tr_b16 a[110:111], v43 offset:4608
 v_mfma_f32_16x16x32_bf16 a[212:215], a[228:231], a[120:123], a[212:215]
 ds_read_b64_tr_b16 a[112:113], v44 offset:0
 v_mfma_f32_16x16x32_bf16 a[212:215], a[244:247], a[124:127], a[212:215]
 ds_read_b64_tr_b16 a[114:115], v44 offset:512
 v_mfma_f32_16x16x32_bf16 a[208:211], a[224:227], a[120:123], a[208:211]
 ds_read_b64_tr_b16 a[116:117], v44 offset:4096
 v_mfma_f32_16x16x32_bf16 a[208:211], a[240:243], a[124:127], a[208:211]
 ds_read_b64_tr_b16 a[118:119], v44 offset:4608
F_step12:
 s_waitcnt lgkmcnt(8)
 v_mfma_f32_16x16x32_bf16 a[0:3], a[96:99], a[64:67], a[0:3]
 ds_read_b64_tr_b16 a[120:121], v45 offset:0
 v_mfma_f32_16x16x32_bf16 a[0:3], a[100:103], a[80:83], a[0:3]
 v_mfma_f32_16x16x32_bf16 a[4:7], a[96:99], a[68:71], a[4:7]
 ds_read_b64_tr_b16 a[122:123], v45 offset:512
 v_mfma_f32_16x16x32_bf16 a[4:7], a[100:103], a[84:87], a[4:7]
 s_add_u32 m0, s46, 0
 s_xor_b32 s33, s99, 768
 v_mfma_f32_16x16x32_bf16 a[8:11], a[96:99], a[72:75], a[8:11]
 ds_read_b64_tr_b16 a[124:125], v45 offset:4096
 v_mfma_f32_16x16x32_bf16 a[8:11], a[100:103], a[88:91], a[8:11]
 buffer_load_dwordx4 v24, s[28:31], s33 offen offset:0 lds
 v_mfma_f32_16x16x32_bf16 a[12:15], a[96:99], a[76:79], a[12:15]
 ds_read_b64_tr_b16 a[126:127], v45 offset:4608
 v_mfma_f32_16x16x32_bf16 a[12:15], a[100:103], a[92:95], a[12:15]
 s_waitcnt lgkmcnt(8)
 v_mfma_f32_16x16x32_bf16 a[28:31], a[104:107], a[76:79], a[28:31]
 ds_read_b64_tr_b16 a[96:97], v42 offset:8192
 v_mfma_f32_16x16x32_bf16 a[28:31], a[108:111], a[92:95], a[28:31]
 buffer_load_dwordx4 v25, s[28:31], s33 offen offset:1024 lds
 v_mfma_f32_16x16x32_bf16 a[24:27], a[104:107], a[72:75], a[24:27]
 ds_read_b64_tr_b16 a[98:99], v42 offset:8704
 v_mfma_f32_16x16x32_bf16 a[24:27], a[108:111], a[88:91], a[24:27]
 buffer_store_dwordx4 v[64:67], v56, s[20:23], s84 offen offset:0 sc1
 v_mfma_f32_16x16x32_bf16 a[20:23], a[104:107], a[68:71], a[20:23]
 ds_read_b64_tr_b16 a[100:101], v42 offset:12288
 v_mfma_f32_16x16x32_bf16 a[20:23], a[108:111], a[84:87], a[20:23]
 v_mfma_f32_16x16x32_bf16 a[16:19], a[104:107], a[64:67], a[16:19]
 ds_read_b64_tr_b16 a[102:103], v42 offset:12800
 v_mfma_f32_16x16x32_bf16 a[16:19], a[108:111], a[80:83], a[16:19]
 s_waitcnt lgkmcnt(8)
 v_mfma_f32_16x16x32_bf16 a[32:35], a[112:115], a[64:67], a[32:35]
 ds_read_b64_tr_b16 a[104:105], v43 offset:8192
 v_mfma_f32_16x16x32_bf16 a[32:35], a[116:119], a[80:83], a[32:35]
 buffer_load_dwordx4 v26, s[28:31], s33 offen offset:2048 lds
 v_mfma_f32_16x16x32_bf16 a[36:39], a[112:115], a[68:71], a[36:39]
 ds_read_b64_tr_b16 a[106:107], v43 offset:8704
 v_mfma_f32_16x16x32_bf16 a[36:39], a[116:119], a[84:87], a[36:39]
 v_mfma_f32_16x16x32_bf16 a[40:43], a[112:115], a[72:75], a[40:43]
 ds_read_b64_tr_b16 a[108:109], v43 offset:12288
 v_mfma_f32_16x16x32_bf16 a[40:43], a[116:119], a[88:91], a[40:43]
 buffer_load_dwordx4 v27, s[28:31], s33 offen offset:3072 lds
 v_mfma_f32_16x16x32_bf16 a[44:47], a[112:115], a[76:79], a[44:47]
 ds_read_b64_tr_b16 a[110:111], v43 offset:12800
 v_mfma_f32_16x16x32_bf16 a[44:47], a[116:119], a[92:95], a[44:47]
 s_waitcnt lgkmcnt(8)
 v_mfma_f32_16x16x32_bf16 a[60:63], a[120:123], a[76:79], a[60:63]
 ds_read_b64_tr_b16 a[112:113], v44 offset:8192
 v_mfma_f32_16x16x32_bf16 a[60:63], a[124:127], a[92:95], a[60:63]
 s_add_u32 m0, s46, 4096
 v_mfma_f32_16x16x32_bf16 a[56:59], a[120:123], a[72:75], a[56:59]
 ds_read_b64_tr_b16 a[114:115], v44 offset:8704
 v_mfma_f32_16x16x32_bf16 a[56:59], a[124:127], a[88:91], a[56:59]
 buffer_load_dwordx4 v28, s[28:31], s33 offen offset:0 lds
 v_mfma_f32_16x16x32_bf16 a[52:55], a[120:123], a[68:71], a[52:55]
 ds_read_b64_tr_b16 a[116:117], v44 offset:12288
 v_mfma_f32_16x16x32_bf16 a[52:55], a[124:127], a[84:87], a[52:55]
 v_mfma_f32_16x16x32_bf16 a[48:51], a[120:123], a[64:67], a[48:51]
 ds_read_b64_tr_b16 a[118:119], v44 offset:12800
 v_mfma_f32_16x16x32_bf16 a[48:51], a[124:127], a[80:83], a[48:51]
 s_waitcnt lgkmcnt(8)
 v_mfma_f32_16x16x32_bf16 a[128:131], a[96:99], a[64:67], a[128:131]
 ds_read_b64_tr_b16 a[120:121], v45 offset:8192
 v_mfma_f32_16x16x32_bf16 a[128:131], a[100:103], a[80:83], a[128:131]
 buffer_load_dwordx4 v29, s[28:31], s33 offen offset:1024 lds
 v_mfma_f32_16x16x32_bf16 a[132:135], a[96:99], a[68:71], a[132:135]
 ds_read_b64_tr_b16 a[122:123], v45 offset:8704
 v_mfma_f32_16x16x32_bf16 a[132:135], a[100:103], a[84:87], a[132:135]
 v_mfma_f32_16x16x32_bf16 a[136:139], a[96:99], a[72:75], a[136:139]
 ds_read_b64_tr_b16 a[124:125], v45 offset:12288
 v_mfma_f32_16x16x32_bf16 a[136:139], a[100:103], a[88:91], a[136:139]
 buffer_load_dwordx4 v30, s[28:31], s33 offen offset:2048 lds
 v_mfma_f32_16x16x32_bf16 a[140:143], a[96:99], a[76:79], a[140:143]
 ds_read_b64_tr_b16 a[126:127], v45 offset:12800
 v_mfma_f32_16x16x32_bf16 a[140:143], a[100:103], a[92:95], a[140:143]
 s_waitcnt lgkmcnt(8)
 v_mfma_f32_16x16x32_bf16 a[156:159], a[104:107], a[76:79], a[156:159]
 ds_read_b64_tr_b16 a[96:97], v46 offset:0
 v_mfma_f32_16x16x32_bf16 a[156:159], a[108:111], a[92:95], a[156:159]
 v_mfma_f32_16x16x32_bf16 a[152:155], a[104:107], a[72:75], a[152:155]
 ds_read_b64_tr_b16 a[98:99], v46 offset:256
 v_mfma_f32_16x16x32_bf16 a[152:155], a[108:111], a[88:91], a[152:155]
 buffer_load_dwordx4 v31, s[28:31], s33 offen offset:3072 lds
 v_mfma_f32_16x16x32_bf16 a[148:151], a[104:107], a[68:71], a[148:151]
 ds_read_b64_tr_b16 a[100:101], v46 offset:8192
 v_mfma_f32_16x16x32_bf16 a[148:151], a[108:111], a[84:87], a[148:151]
 v_mfma_f32_16x16x32_bf16 a[144:147], a[104:107], a[64:67], a[144:147]
 ds_read_b64_tr_b16 a[102:103], v46 offset:8448
 v_mfma_f32_16x16x32_bf16 a[144:147], a[108:111], a[80:83], a[144:147]
 s_waitcnt lgkmcnt(8)
 v_mfma_f32_16x16x32_bf16 a[160:163], a[112:115], a[64:67], a[160:163]
 ds_read_b64_tr_b16 a[104:105], v47 offset:0
 s_add_u32 m0, s43, 0x20000
 v_mfma_f32_16x16x32_bf16 a[160:163], a[116:119], a[80:83], a[160:163]
 s_xor_b32 s34, s98, 0x300000
 v_mfma_f32_16x16x32_bf16 a[164:167], a[112:115], a[68:71], a[164:167]
 ds_read_b64_tr_b16 a[106:107], v47 offset:256
 v_mfma_f32_16x16x32_bf16 a[164:167], a[116:119], a[84:87], a[164:167]
 buffer_load_dwordx4 v32, s[16:19], s34 offen offset:0 lds
 v_mfma_f32_16x16x32_bf16 a[168:171], a[112:115], a[72:75], a[168:171]
 ds_read_b64_tr_b16 a[108:109], v47 offset:8192
 v_mfma_f32_16x16x32_bf16 a[168:171], a[116:119], a[88:91], a[168:171]
 buffer_store_dwordx4 v[68:71], v56, s[20:23], s84 offen offset:128 sc1
 v_mfma_f32_16x16x32_bf16 a[172:175], a[112:115], a[76:79], a[172:175]
 ds_read_b64_tr_b16 a[110:111], v47 offset:8448
 v_mfma_f32_16x16x32_bf16 a[172:175], a[116:119], a[92:95], a[172:175]
 s_waitcnt lgkmcnt(8)
 v_mfma_f32_16x16x32_bf16 a[188:191], a[120:123], a[76:79], a[188:191]
 ds_read_b64_tr_b16 a[112:113], v46 offset:1024
 v_mfma_f32_16x16x32_bf16 a[188:191], a[124:127], a[92:95], a[188:191]
 buffer_load_dwordx4 v33, s[16:19], s34 offen offset:1024 lds
 v_mfma_f32_16x16x32_bf16 a[184:187], a[120:123], a[72:75], a[184:187]
 ds_read_b64_tr_b16 a[114:115], v46 offset:1280
 v_mfma_f32_16x16x32_bf16 a[184:187], a[124:127], a[88:91], a[184:187]
 buffer_load_dwordx4 v34, s[16:19], s34 offen offset:2048 lds
 v_mfma_f32_16x16x32_bf16 a[180:183], a[120:123], a[68:71], a[180:183]
 ds_read_b64_tr_b16 a[116:117], v46 offset:9216
 v_mfma_f32_16x16x32_bf16 a[180:183], a[124:127], a[84:87], a[180:183]
 v_mfma_f32_16x16x32_bf16 a[176:179], a[120:123], a[64:67], a[176:179]
 ds_read_b64_tr_b16 a[118:119], v46 offset:9472
 v_mfma_f32_16x16x32_bf16 a[176:179], a[124:127], a[80:83], a[176:179]
 s_waitcnt lgkmcnt(8)
 v_mfma_f32_16x16x32_bf16 v[80:83], a[96:99], a[64:67], v[80:83]
 ds_read_b64_tr_b16 a[120:121], v47 offset:1024
 v_mfma_f32_16x16x32_bf16 v[80:83], a[100:103], a[80:83], v[80:83]
 buffer_load_dwordx4 v35, s[16:19], s34 offen offset:3072 lds
 v_mfma_f32_16x16x32_bf16 v[84:87], a[96:99], a[68:71], v[84:87]
 ds_read_b64_tr_b16 a[122:123], v47 offset:1280
 v_mfma_f32_16x16x32_bf16 v[84:87], a[100:103], a[84:87], v[84:87]
 v_mfma_f32_16x16x32_bf16 v[88:91], a[96:99], a[72:75], v[88:91]
 ds_read_b64_tr_b16 a[124:125], v47 offset:9216
 v_mfma_f32_16x16x32_bf16 v[88:91], a[100:103], a[88:91], v[88:91]
 v_mfma_f32_16x16x32_bf16 v[92:95], a[96:99], a[76:79], v[92:95]
 ds_read_b64_tr_b16 a[126:127], v47 offset:9472
 v_mfma_f32_16x16x32_bf16 v[92:95], a[100:103], a[92:95], v[92:95]
 s_add_u32 m0, s44, 0x20000
 s_waitcnt lgkmcnt(8)
 v_mfma_f32_16x16x32_bf16 v[124:127], a[104:107], a[76:79], v[124:127]
 ds_read_b64_tr_b16 a[96:97], v46 offset:2048
 s_mov_b32 s35, 0x240000
 v_mfma_f32_16x16x32_bf16 v[124:127], a[108:111], a[92:95], v[124:127]
 buffer_load_dwordx4 v36, s[24:27], s35 offen offset:0 lds
 v_mfma_f32_16x16x32_bf16 v[120:123], a[104:107], a[72:75], v[120:123]
 ds_read_b64_tr_b16 a[98:99], v46 offset:2304
 v_mfma_f32_16x16x32_bf16 v[120:123], a[108:111], a[88:91], v[120:123]
 v_mfma_f32_16x16x32_bf16 v[116:119], a[104:107], a[68:71], v[116:119]
 ds_read_b64_tr_b16 a[100:101], v46 offset:10240
 v_mfma_f32_16x16x32_bf16 v[116:119], a[108:111], a[84:87], v[116:119]
 buffer_load_dwordx4 v37, s[24:27], s35 offen offset:1024 lds
 v_mfma_f32_16x16x32_bf16 v[112:115], a[104:107], a[64:67], v[112:115]
 ds_read_b64_tr_b16 a[102:103], v46 offset:10496
 v_mfma_f32_16x16x32_bf16 v[112:115], a[108:111], a[80:83], v[112:115]
 s_waitcnt lgkmcnt(8)
 v_mfma_f32_16x16x32_bf16 v[144:147], a[112:115], a[64:67], v[144:147]
 ds_read_b64_tr_b16 a[104:105], v47 offset:2048
 v_mfma_f32_16x16x32_bf16 v[144:147], a[116:119], a[80:83], v[144:147]
 v_mfma_f32_16x16x32_bf16 v[148:151], a[112:115], a[68:71], v[148:151]
 ds_read_b64_tr_b16 a[106:107], v47 offset:2304
 v_mfma_f32_16x16x32_bf16 v[148:151], a[116:119], a[84:87], v[148:151]
 buffer_load_dwordx4 v38, s[24:27], s35 offen offset:2048 lds
 v_mfma_f32_16x16x32_bf16 v[152:155], a[112:115], a[72:75], v[152:155]
 ds_read_b64_tr_b16 a[108:109], v47 offset:10240
 v_mfma_f32_16x16x32_bf16 v[152:155], a[116:119], a[88:91], v[152:155]
 v_mfma_f32_16x16x32_bf16 v[156:159], a[112:115], a[76:79], v[156:159]
 ds_read_b64_tr_b16 a[110:111], v47 offset:10496
 v_mfma_f32_16x16x32_bf16 v[156:159], a[116:119], a[92:95], v[156:159]
 s_waitcnt lgkmcnt(8)
 v_mfma_f32_16x16x32_bf16 v[188:191], a[120:123], a[76:79], v[188:191]
 v_mfma_f32_16x16x32_bf16 v[188:191], a[124:127], a[92:95], v[188:191]
 v_mfma_f32_16x16x32_bf16 v[184:187], a[120:123], a[72:75], v[184:187]
 v_mfma_f32_16x16x32_bf16 v[184:187], a[124:127], a[88:91], v[184:187]
 s_waitcnt lgkmcnt(0) vmcnt(19)
 s_barrier
 v_mfma_f32_16x16x32_bf16 v[180:183], a[120:123], a[68:71], v[180:183]
 ds_read_b64_tr_b16 a[112:113], v42 offset:32768
 v_mfma_f32_16x16x32_bf16 v[180:183], a[124:127], a[84:87], v[180:183]
 ds_read_b64_tr_b16 a[114:115], v42 offset:33280
 v_mfma_f32_16x16x32_bf16 v[176:179], a[120:123], a[64:67], v[176:179]
 ds_read_b64_tr_b16 a[116:117], v42 offset:36864
 buffer_store_dwordx4 v[72:75], v56, s[20:23], s85 offen offset:0 sc1
 v_mfma_f32_16x16x32_bf16 v[176:179], a[124:127], a[80:83], v[176:179]
 ds_read_b64_tr_b16 a[118:119], v42 offset:37376
 v_mfma_f32_16x16x32_bf16 a[192:195], a[64:67], a[96:99], a[192:195]
 ds_read_b128 a[224:227], v40 offset:8192
 v_mfma_f32_16x16x32_bf16 a[192:195], a[80:83], a[100:103], a[192:195]
 ds_read_b128 a[240:243], v41 offset:8192
 v_mfma_f32_16x16x32_bf16 a[196:199], a[68:71], a[96:99], a[196:199]
 ds_read_b128 a[228:231], v40 offset:10240
 v_mfma_f32_16x16x32_bf16 a[196:199], a[84:87], a[100:103], a[196:199]
 ds_read_b128 a[244:247], v41 offset:10240
 v_mfma_f32_16x16x32_bf16 a[200:203], a[72:75], a[96:99], a[200:203]
 ds_read_b128 a[232:235], v40 offset:12288
 v_mfma_f32_16x16x32_bf16 a[200:203], a[88:91], a[100:103], a[200:203]
 ds_read_b128 a[248:251], v41 offset:12288
 v_mfma_f32_16x16x32_bf16 a[204:207], a[76:79], a[96:99], a[204:207]
 ds_read_b128 a[236:239], v40 offset:14336
 v_mfma_f32_16x16x32_bf16 a[204:207], a[92:95], a[100:103], a[204:207]
 ds_read_b128 a[252:255], v41 offset:14336
 v_mfma_f32_16x16x32_bf16 a[220:223], a[76:79], a[104:107], a[220:223]
 ds_read_b64_tr_b16 a[120:121], v43 offset:32768
 v_mfma_f32_16x16x32_bf16 a[220:223], a[92:95], a[108:111], a[220:223]
 ds_read_b64_tr_b16 a[122:123], v43 offset:33280
 v_mfma_f32_16x16x32_bf16 a[216:219], a[72:75], a[104:107], a[216:219]
 ds_read_b64_tr_b16 a[124:125], v43 offset:36864
 v_mfma_f32_16x16x32_bf16 a[216:219], a[88:91], a[108:111], a[216:219]
 ds_read_b64_tr_b16 a[126:127], v43 offset:37376
 v_mfma_f32_16x16x32_bf16 a[212:215], a[68:71], a[104:107], a[212:215]
 ds_read_b64_tr_b16 a[96:97], v44 offset:32768
 v_mfma_f32_16x16x32_bf16 a[212:215], a[84:87], a[108:111], a[212:215]
 ds_read_b64_tr_b16 a[98:99], v44 offset:33280
 v_mfma_f32_16x16x32_bf16 a[208:211], a[64:67], a[104:107], a[208:211]
 ds_read_b64_tr_b16 a[100:101], v44 offset:36864
 v_mfma_f32_16x16x32_bf16 a[208:211], a[80:83], a[108:111], a[208:211]
 ds_read_b64_tr_b16 a[102:103], v44 offset:37376
F_step13:
 s_waitcnt lgkmcnt(8)
 v_mfma_f32_16x16x32_bf16 a[0:3], a[112:115], a[224:227], a[0:3]
 ds_read_b64_tr_b16 a[104:105], v45 offset:32768
 v_mfma_f32_16x16x32_bf16 a[0:3], a[116:119], a[240:243], a[0:3]
 v_mfma_f32_16x16x32_bf16 a[4:7], a[112:115], a[228:231], a[4:7]
 ds_read_b64_tr_b16 a[106:107], v45 offset:33280
 v_mfma_f32_16x16x32_bf16 a[4:7], a[116:119], a[244:247], a[4:7]
 s_add_u32 m0, s46, 8192
 s_xor_b32 s33, s99, 896
 v_mfma_f32_16x16x32_bf16 a[8:11], a[112:115], a[232:235], a[8:11]
 ds_read_b64_tr_b16 a[108:109], v45 offset:36864
 v_mfma_f32_16x16x32_bf16 a[8:11], a[116:119], a[248:251], a[8:11]
 buffer_load_dwordx4 v24, s[28:31], s33 offen offset:0 lds
 v_mfma_f32_16x16x32_bf16 a[12:15], a[112:115], a[236:239], a[12:15]
 ds_read_b64_tr_b16 a[110:111], v45 offset:37376
 v_mfma_f32_16x16x32_bf16 a[12:15], a[116:119], a[252:255], a[12:15]
 s_waitcnt lgkmcnt(8)
 v_mfma_f32_16x16x32_bf16 a[28:31], a[120:123], a[236:239], a[28:31]
 ds_read_b64_tr_b16 a[112:113], v42 offset:40960
 v_mfma_f32_16x16x32_bf16 a[28:31], a[124:127], a[252:255], a[28:31]
 buffer_load_dwordx4 v25, s[28:31], s33 offen offset:1024 lds
 v_mfma_f32_16x16x32_bf16 a[24:27], a[120:123], a[232:235], a[24:27]
 ds_read_b64_tr_b16 a[114:115], v42 offset:41472
 v_mfma_f32_16x16x32_bf16 a[24:27], a[124:127], a[248:251], a[24:27]
 buffer_store_dwordx4 v[76:79], v56, s[20:23], s85 offen offset:128 sc1
 v_mfma_f32_16x16x32_bf16 a[20:23], a[120:123], a[228:231], a[20:23]
 ds_read_b64_tr_b16 a[116:117], v42 offset:45056
 v_mfma_f32_16x16x32_bf16 a[20:23], a[124:127], a[244:247], a[20:23]
 v_mfma_f32_16x16x32_bf16 a[16:19], a[120:123], a[224:227], a[16:19]
 ds_read_b64_tr_b16 a[118:119], v42 offset:45568
 v_mfma_f32_16x16x32_bf16 a[16:19], a[124:127], a[240:243], a[16:19]
 s_waitcnt lgkmcnt(8)
 v_mfma_f32_16x16x32_bf16 a[32:35], a[96:99], a[224:227], a[32:35]
 ds_read_b64_tr_b16 a[120:121], v43 offset:40960
 v_mfma_f32_16x16x32_bf16 a[32:35], a[100:103], a[240:243], a[32:35]
 buffer_load_dwordx4 v26, s[28:31], s33 offen offset:2048 lds
 v_mfma_f32_16x16x32_bf16 a[36:39], a[96:99], a[228:231], a[36:39]
 ds_read_b64_tr_b16 a[122:123], v43 offset:41472
 v_mfma_f32_16x16x32_bf16 a[36:39], a[100:103], a[244:247], a[36:39]
 v_mfma_f32_16x16x32_bf16 a[40:43], a[96:99], a[232:235], a[40:43]
 ds_read_b64_tr_b16 a[124:125], v43 offset:45056
 v_mfma_f32_16x16x32_bf16 a[40:43], a[100:103], a[248:251], a[40:43]
 buffer_load_dwordx4 v27, s[28:31], s33 offen offset:3072 lds
 v_mfma_f32_16x16x32_bf16 a[44:47], a[96:99], a[236:239], a[44:47]
 ds_read_b64_tr_b16 a[126:127], v43 offset:45568
 v_mfma_f32_16x16x32_bf16 a[44:47], a[100:103], a[252:255], a[44:47]
 s_waitcnt lgkmcnt(8)
 v_mfma_f32_16x16x32_bf16 a[60:63], a[104:107], a[236:239], a[60:63]
 ds_read_b64_tr_b16 a[96:97], v44 offset:40960
 v_mfma_f32_16x16x32_bf16 a[60:63], a[108:111], a[252:255], a[60:63]
 s_add_u32 m0, s46, 12288
 v_mfma_f32_16x16x32_bf16 a[56:59], a[104:107], a[232:235], a[56:59]
 ds_read_b64_tr_b16 a[98:99], v44 offset:41472
 v_mfma_f32_16x16x32_bf16 a[56:59], a[108:111], a[248:251], a[56:59]
 buffer_load_dwordx4 v28, s[28:31], s33 offen offset:0 lds
 v_mfma_f32_16x16x32_bf16 a[52:55], a[104:107], a[228:231], a[52:55]
 ds_read_b64_tr_b16 a[100:101], v44 offset:45056
 v_mfma_f32_16x16x32_bf16 a[52:55], a[108:111], a[244:247], a[52:55]
 v_mfma_f32_16x16x32_bf16 a[48:51], a[104:107], a[224:227], a[48:51]
 ds_read_b64_tr_b16 a[102:103], v44 offset:45568
 v_mfma_f32_16x16x32_bf16 a[48:51], a[108:111], a[240:243], a[48:51]
 s_waitcnt lgkmcnt(8)
 v_mfma_f32_16x16x32_bf16 a[128:131], a[112:115], a[224:227], a[128:131]
 ds_read_b64_tr_b16 a[104:105], v45 offset:40960
 v_mfma_f32_16x16x32_bf16 a[128:131], a[116:119], a[240:243], a[128:131]
 buffer_load_dwordx4 v29, s[28:31], s33 offen offset:1024 lds
 v_mfma_f32_16x16x32_bf16 a[132:135], a[112:115], a[228:231], a[132:135]
 ds_read_b64_tr_b16 a[106:107], v45 offset:41472
 v_mfma_f32_16x16x32_bf16 a[132:135], a[116:119], a[244:247], a[132:135]
 v_mfma_f32_16x16x32_bf16 a[136:139], a[112:115], a[232:235], a[136:139]
 ds_read_b64_tr_b16 a[108:109], v45 offset:45056
 v_mfma_f32_16x16x32_bf16 a[136:139], a[116:119], a[248:251], a[136:139]
 buffer_load_dwordx4 v30, s[28:31], s33 offen offset:2048 lds
 v_mfma_f32_16x16x32_bf16 a[140:143], a[112:115], a[236:239], a[140:143]
 ds_read_b64_tr_b16 a[110:111], v45 offset:45568
 v_mfma_f32_16x16x32_bf16 a[140:143], a[116:119], a[252:255], a[140:143]
 s_waitcnt lgkmcnt(8)
 v_mfma_f32_16x16x32_bf16 a[156:159], a[120:123], a[236:239], a[156:159]
 ds_read_b64_tr_b16 a[112:113], v46 offset:32768
 v_mfma_f32_16x16x32_bf16 a[156:159], a[124:127], a[252:255], a[156:159]
 v_mfma_f32_16x16x32_bf16 a[152:155], a[120:123], a[232:235], a[152:155]
 ds_read_b64_tr_b16 a[114:115], v46 offset:33024
 v_mfma_f32_16x16x32_bf16 a[152:155], a[124:127], a[248:251], a[152:155]
 buffer_load_dwordx4 v31, s[28:31], s33 offen offset:3072 lds
 v_mfma_f32_16x16x32_bf16 a[148:151], a[120:123], a[228:231], a[148:151]
 ds_read_b64_tr_b16 a[116:117], v46 offset:40960
 v_mfma_f32_16x16x32_bf16 a[148:151], a[124:127], a[244:247], a[148:151]
 v_mfma_f32_16x16x32_bf16 a[144:147], a[120:123], a[224:227], a[144:147]
 ds_read_b64_tr_b16 a[118:119], v46 offset:41216
 v_mfma_f32_16x16x32_bf16 a[144:147], a[124:127], a[240:243], a[144:147]
 s_waitcnt lgkmcnt(8)
 v_mfma_f32_16x16x32_bf16 a[160:163], a[96:99], a[224:227], a[160:163]
 ds_read_b64_tr_b16 a[120:121], v47 offset:32768
 s_add_u32 m0, s43, 0x10000
 v_mfma_f32_16x16x32_bf16 a[160:163], a[100:103], a[240:243], a[160:163]
 s_xor_b32 s34, s98, 0x380000
 v_mfma_f32_16x16x32_bf16 a[164:167], a[96:99], a[228:231], a[164:167]
 ds_read_b64_tr_b16 a[122:123], v47 offset:33024
 v_mfma_f32_16x16x32_bf16 a[164:167], a[100:103], a[244:247], a[164:167]
 buffer_load_dwordx4 v32, s[16:19], s34 offen offset:0 lds
 v_mfma_f32_16x16x32_bf16 a[168:171], a[96:99], a[232:235], a[168:171]
 ds_read_b64_tr_b16 a[124:125], v47 offset:40960
 v_mfma_f32_16x16x32_bf16 a[168:171], a[100:103], a[248:251], a[168:171]
 buffer_store_dwordx4 v[228:231], v57, s[20:23], s92 offen offset:3072 sc1
 v_mfma_f32_16x16x32_bf16 a[172:175], a[96:99], a[236:239], a[172:175]
 ds_read_b64_tr_b16 a[126:127], v47 offset:41216
 v_mfma_f32_16x16x32_bf16 a[172:175], a[100:103], a[252:255], a[172:175]
 s_waitcnt lgkmcnt(8)
 v_mfma_f32_16x16x32_bf16 a[188:191], a[104:107], a[236:239], a[188:191]
 ds_read_b64_tr_b16 a[96:97], v46 offset:33792
 v_mfma_f32_16x16x32_bf16 a[188:191], a[108:111], a[252:255], a[188:191]
 buffer_load_dwordx4 v33, s[16:19], s34 offen offset:1024 lds
 v_mfma_f32_16x16x32_bf16 a[184:187], a[104:107], a[232:235], a[184:187]
 ds_read_b64_tr_b16 a[98:99], v46 offset:34048
 v_mfma_f32_16x16x32_bf16 a[184:187], a[108:111], a[248:251], a[184:187]
 buffer_load_dwordx4 v34, s[16:19], s34 offen offset:2048 lds
 v_mfma_f32_16x16x32_bf16 a[180:183], a[104:107], a[228:231], a[180:183]
 ds_read_b64_tr_b16 a[100:101], v46 offset:41984
 v_mfma_f32_16x16x32_bf16 a[180:183], a[108:111], a[244:247], a[180:183]
 v_mfma_f32_16x16x32_bf16 a[176:179], a[104:107], a[224:227], a[176:179]
 ds_read_b64_tr_b16 a[102:103], v46 offset:42240
 v_mfma_f32_16x16x32_bf16 a[176:179], a[108:111], a[240:243], a[176:179]
 s_waitcnt lgkmcnt(8)
 v_mfma_f32_16x16x32_bf16 v[80:83], a[112:115], a[224:227], v[80:83]
 ds_read_b64_tr_b16 a[104:105], v47 offset:33792
 v_mfma_f32_16x16x32_bf16 v[80:83], a[116:119], a[240:243], v[80:83]
 buffer_load_dwordx4 v35, s[16:19], s34 offen offset:3072 lds
 v_mfma_f32_16x16x32_bf16 v[84:87], a[112:115], a[228:231], v[84:87]
 ds_read_b64_tr_b16 a[106:107], v47 offset:34048
 v_mfma_f32_16x16x32_bf16 v[84:87], a[116:119], a[244:247], v[84:87]
 v_mfma_f32_16x16x32_bf16 v[88:91], a[112:115], a[232:235], v[88:91]
 ds_read_b64_tr_b16 a[108:109], v47 offset:41984
 v_mfma_f32_16x16x32_bf16 v[88:91], a[116:119], a[248:251], v[88:91]
 v_mfma_f32_16x16x32_bf16 v[92:95], a[112:115], a[236:239], v[92:95]
 ds_read_b64_tr_b16 a[110:111], v47 offset:42240
 v_mfma_f32_16x16x32_bf16 v[92:95], a[116:119], a[252:255], v[92:95]
 s_add_u32 m0, s44, 0x10000
 s_waitcnt lgkmcnt(8)
 v_mfma_f32_16x16x32_bf16 v[124:127], a[120:123], a[236:239], v[124:127]
 ds_read_b64_tr_b16 a[112:113], v46 offset:34816
 s_mov_b32 s35, 0x2a0000
 v_mfma_f32_16x16x32_bf16 v[124:127], a[124:127], a[252:255], v[124:127]
 buffer_load_dwordx4 v36, s[24:27], s35 offen offset:0 lds
 v_mfma_f32_16x16x32_bf16 v[120:123], a[120:123], a[232:235], v[120:123]
 ds_read_b64_tr_b16 a[114:115], v46 offset:35072
 v_mfma_f32_16x16x32_bf16 v[120:123], a[124:127], a[248:251], v[120:123]
 v_mfma_f32_16x16x32_bf16 v[116:119], a[120:123], a[228:231], v[116:119]
 ds_read_b64_tr_b16 a[116:117], v46 offset:43008
 v_mfma_f32_16x16x32_bf16 v[116:119], a[124:127], a[244:247], v[116:119]
 buffer_load_dwordx4 v37, s[24:27], s35 offen offset:1024 lds
 v_mfma_f32_16x16x32_bf16 v[112:115], a[120:123], a[224:227], v[112:115]
 ds_read_b64_tr_b16 a[118:119], v46 offset:43264
 v_mfma_f32_16x16x32_bf16 v[112:115], a[124:127], a[240:243], v[112:115]
 s_waitcnt lgkmcnt(8)
 v_mfma_f32_16x16x32_bf16 v[144:147], a[96:99], a[224:227], v[144:147]
 ds_read_b64_tr_b16 a[120:121], v47 offset:34816
 v_mfma_f32_16x16x32_bf16 v[144:147], a[100:103], a[240:243], v[144:147]
 v_mfma_f32_16x16x32_bf16 v[148:151], a[96:99], a[228:231], v[148:151]
 ds_read_b64_tr_b16 a[122:123], v47 offset:35072
 v_mfma_f32_16x16x32_bf16 v[148:151], a[100:103], a[244:247], v[148:151]
 buffer_load_dwordx4 v38, s[24:27], s35 offen offset:2048 lds
 v_mfma_f32_16x16x32_bf16 v[152:155], a[96:99], a[232:235], v[152:155]
 ds_read_b64_tr_b16 a[124:125], v47 offset:43008
 v_mfma_f32_16x16x32_bf16 v[152:155], a[100:103], a[248:251], v[152:155]
 v_mfma_f32_16x16x32_bf16 v[156:159], a[96:99], a[236:239], v[156:159]
 ds_read_b64_tr_b16 a[126:127], v47 offset:43264
 v_mfma_f32_16x16x32_bf16 v[156:159], a[100:103], a[252:255], v[156:159]
 s_waitcnt lgkmcnt(8)
 v_mfma_f32_16x16x32_bf16 v[188:191], a[104:107], a[236:239], v[188:191]
 v_mfma_f32_16x16x32_bf16 v[188:191], a[108:111], a[252:255], v[188:191]
 v_mfma_f32_16x16x32_bf16 v[184:187], a[104:107], a[232:235], v[184:187]
 v_mfma_f32_16x16x32_bf16 v[184:187], a[108:111], a[248:251], v[184:187]
 s_waitcnt lgkmcnt(0) vmcnt(18)
 s_barrier
 v_mfma_f32_16x16x32_bf16 v[180:183], a[104:107], a[228:231], v[180:183]
 ds_read_b64_tr_b16 a[96:97], v48 offset:0
 v_mfma_f32_16x16x32_bf16 v[180:183], a[108:111], a[244:247], v[180:183]
 ds_read_b64_tr_b16 a[98:99], v48 offset:512
 v_mfma_f32_16x16x32_bf16 v[176:179], a[104:107], a[224:227], v[176:179]
 ds_read_b64_tr_b16 a[100:101], v48 offset:4096
 buffer_store_dwordx4 v[236:239], v57, s[20:23], s93 offen offset:3072 sc1
 v_mfma_f32_16x16x32_bf16 v[176:179], a[108:111], a[240:243], v[176:179]
 ds_read_b64_tr_b16 a[102:103], v48 offset:4608
 v_mfma_f32_16x16x32_bf16 a[192:195], a[224:227], a[112:115], a[192:195]
 ds_read_b128 a[64:67], v40 offset:0
 v_mfma_f32_16x16x32_bf16 a[192:195], a[240:243], a[116:119], a[192:195]
 ds_read_b128 a[80:83], v41 offset:0
 v_mfma_f32_16x16x32_bf16 a[196:199], a[228:231], a[112:115], a[196:199]
 ds_read_b128 a[68:71], v40 offset:2048
 v_mfma_f32_16x16x32_bf16 a[196:199], a[244:247], a[116:119], a[196:199]
 ds_read_b128 a[84:87], v41 offset:2048
 v_mfma_f32_16x16x32_bf16 a[200:203], a[232:235], a[112:115], a[200:203]
 ds_read_b128 a[72:75], v40 offset:4096
 v_mfma_f32_16x16x32_bf16 a[200:203], a[248:251], a[116:119], a[200:203]
 ds_read_b128 a[88:91], v41 offset:4096
 v_mfma_f32_16x16x32_bf16 a[204:207], a[236:239], a[112:115], a[204:207]
 ds_read_b128 a[76:79], v40 offset:6144
 v_mfma_f32_16x16x32_bf16 a[204:207], a[252:255], a[116:119], a[204:207]
 ds_read_b128 a[92:95], v41 offset:6144
 v_mfma_f32_16x16x32_bf16 a[220:223], a[236:239], a[120:123], a[220:223]
 ds_read_b64_tr_b16 a[104:105], v49 offset:0
 v_mfma_f32_16x16x32_bf16 a[220:223], a[252:255], a[124:127], a[220:223]
 ds_read_b64_tr_b16 a[106:107], v49 offset:512
 v_mfma_f32_16x16x32_bf16 a[216:219], a[232:235], a[120:123], a[216:219]
 ds_read_b64_tr_b16 a[108:109], v49 offset:4096
 v_mfma_f32_16x16x32_bf16 a[216:219], a[248:251], a[124:127], a[216:219]
 ds_read_b64_tr_b16 a[110:111], v49 offset:4608
 v_mfma_f32_16x16x32_bf16 a[212:215], a[228:231], a[120:123], a[212:215]
 ds_read_b64_tr_b16 a[112:113], v50 offset:0
 v_mfma_f32_16x16x32_bf16 a[212:215], a[244:247], a[124:127], a[212:215]
 ds_read_b64_tr_b16 a[114:115], v50 offset:512
 v_mfma_f32_16x16x32_bf16 a[208:211], a[224:227], a[120:123], a[208:211]
 ds_read_b64_tr_b16 a[116:117], v50 offset:4096
 v_mfma_f32_16x16x32_bf16 a[208:211], a[240:243], a[124:127], a[208:211]
 ds_read_b64_tr_b16 a[118:119], v50 offset:4608
F_step14:
 s_waitcnt lgkmcnt(8)
 v_mfma_f32_16x16x32_bf16 a[0:3], a[96:99], a[64:67], a[0:3]
 ds_read_b64_tr_b16 a[120:121], v51 offset:0
 v_mfma_f32_16x16x32_bf16 a[0:3], a[100:103], a[80:83], a[0:3]
 v_mfma_f32_16x16x32_bf16 a[4:7], a[96:99], a[68:71], a[4:7]
 ds_read_b64_tr_b16 a[122:123], v51 offset:512
 v_mfma_f32_16x16x32_bf16 a[4:7], a[100:103], a[84:87], a[4:7]
 s_add_u32 m0, s46, 0
 s_xor_b32 s33, s99, 1024
 v_mfma_f32_16x16x32_bf16 a[8:11], a[96:99], a[72:75], a[8:11]
 ds_read_b64_tr_b16 a[124:125], v51 offset:4096
 v_mfma_f32_16x16x32_bf16 a[8:11], a[100:103], a[88:91], a[8:11]
 buffer_load_dwordx4 v24, s[28:31], s33 offen offset:0 lds
 v_mfma_f32_16x16x32_bf16 a[12:15], a[96:99], a[76:79], a[12:15]
 ds_read_b64_tr_b16 a[126:127], v51 offset:4608
 v_mfma_f32_16x16x32_bf16 a[12:15], a[100:103], a[92:95], a[12:15]
 s_waitcnt lgkmcnt(8)
 v_mfma_f32_16x16x32_bf16 a[28:31], a[104:107], a[76:79], a[28:31]
 ds_read_b64_tr_b16 a[96:97], v48 offset:8192
 v_mfma_f32_16x16x32_bf16 a[28:31], a[108:111], a[92:95], a[28:31]
 buffer_load_dwordx4 v25, s[28:31], s33 offen offset:1024 lds
 v_mfma_f32_16x16x32_bf16 a[24:27], a[104:107], a[72:75], a[24:27]
 ds_read_b64_tr_b16 a[98:99], v48 offset:8704
 v_mfma_f32_16x16x32_bf16 a[24:27], a[108:111], a[88:91], a[24:27]
 buffer_store_dwordx4 v[244:247], v57, s[20:23], s92 offen offset:3328 sc1
 v_mfma_f32_16x16x32_bf16 a[20:23], a[104:107], a[68:71], a[20:23]
 ds_read_b64_tr_b16 a[100:101], v48 offset:12288
 v_mfma_f32_16x16x32_bf16 a[20:23], a[108:111], a[84:87], a[20:23]
 v_mfma_f32_16x16x32_bf16 a[16:19], a[104:107], a[64:67], a[16:19]
 ds_read_b64_tr_b16 a[102:103], v48 offset:12800
 v_mfma_f32_16x16x32_bf16 a[16:19], a[108:111], a[80:83], a[16:19]
 s_waitcnt lgkmcnt(8)
 v_mfma_f32_16x16x32_bf16 a[32:35], a[112:115], a[64:67], a[32:35]
 ds_read_b64_tr_b16 a[104:105], v49 offset:8192
 v_mfma_f32_16x16x32_bf16 a[32:35], a[116:119], a[80:83], a[32:35]
 buffer_load_dwordx4 v26, s[28:31], s33 offen offset:2048 lds
 v_mfma_f32_16x16x32_bf16 a[36:39], a[112:115], a[68:71], a[36:39]
 ds_read_b64_tr_b16 a[106:107], v49 offset:8704
 v_mfma_f32_16x16x32_bf16 a[36:39], a[116:119], a[84:87], a[36:39]
 v_mfma_f32_16x16x32_bf16 a[40:43], a[112:115], a[72:75], a[40:43]
 ds_read_b64_tr_b16 a[108:109], v49 offset:12288
 v_mfma_f32_16x16x32_bf16 a[40:43], a[116:119], a[88:91], a[40:43]
 buffer_load_dwordx4 v27, s[28:31], s33 offen offset:3072 lds
 v_mfma_f32_16x16x32_bf16 a[44:47], a[112:115], a[76:79], a[44:47]
 ds_read_b64_tr_b16 a[110:111], v49 offset:12800
 v_mfma_f32_16x16x32_bf16 a[44:47], a[116:119], a[92:95], a[44:47]
 s_waitcnt lgkmcnt(8)
 v_mfma_f32_16x16x32_bf16 a[60:63], a[120:123], a[76:79], a[60:63]
 ds_read_b64_tr_b16 a[112:113], v50 offset:8192
 v_mfma_f32_16x16x32_bf16 a[60:63], a[124:127], a[92:95], a[60:63]
 s_add_u32 m0, s46, 4096
 v_mfma_f32_16x16x32_bf16 a[56:59], a[120:123], a[72:75], a[56:59]
 ds_read_b64_tr_b16 a[114:115], v50 offset:8704
 v_mfma_f32_16x16x32_bf16 a[56:59], a[124:127], a[88:91], a[56:59]
 buffer_load_dwordx4 v28, s[28:31], s33 offen offset:0 lds
 v_mfma_f32_16x16x32_bf16 a[52:55], a[120:123], a[68:71], a[52:55]
 ds_read_b64_tr_b16 a[116:117], v50 offset:12288
 v_mfma_f32_16x16x32_bf16 a[52:55], a[124:127], a[84:87], a[52:55]
 v_mfma_f32_16x16x32_bf16 a[48:51], a[120:123], a[64:67], a[48:51]
 ds_read_b64_tr_b16 a[118:119], v50 offset:12800
 v_mfma_f32_16x16x32_bf16 a[48:51], a[124:127], a[80:83], a[48:51]
 s_waitcnt lgkmcnt(8)
 v_mfma_f32_16x16x32_bf16 a[128:131], a[96:99], a[64:67], a[128:131]
 ds_read_b64_tr_b16 a[120:121], v51 offset:8192
 v_mfma_f32_16x16x32_bf16 a[128:131], a[100:103], a[80:83], a[128:131]
 buffer_load_dwordx4 v29, s[28:31], s33 offen offset:1024 lds
 v_mfma_f32_16x16x32_bf16 a[132:135], a[96:99], a[68:71], a[132:135]
 ds_read_b64_tr_b16 a[122:123], v51 offset:8704
 v_mfma_f32_16x16x32_bf16 a[132:135], a[100:103], a[84:87], a[132:135]
 v_mfma_f32_16x16x32_bf16 a[136:139], a[96:99], a[72:75], a[136:139]
 ds_read_b64_tr_b16 a[124:125], v51 offset:12288
 v_mfma_f32_16x16x32_bf16 a[136:139], a[100:103], a[88:91], a[136:139]
 buffer_load_dwordx4 v30, s[28:31], s33 offen offset:2048 lds
 v_mfma_f32_16x16x32_bf16 a[140:143], a[96:99], a[76:79], a[140:143]
 ds_read_b64_tr_b16 a[126:127], v51 offset:12800
 v_mfma_f32_16x16x32_bf16 a[140:143], a[100:103], a[92:95], a[140:143]
 s_waitcnt lgkmcnt(8)
 v_mfma_f32_16x16x32_bf16 a[156:159], a[104:107], a[76:79], a[156:159]
 ds_read_b64_tr_b16 a[96:97], v52 offset:0
 v_mfma_f32_16x16x32_bf16 a[156:159], a[108:111], a[92:95], a[156:159]
 v_mfma_f32_16x16x32_bf16 a[152:155], a[104:107], a[72:75], a[152:155]
 ds_read_b64_tr_b16 a[98:99], v52 offset:256
 v_mfma_f32_16x16x32_bf16 a[152:155], a[108:111], a[88:91], a[152:155]
 buffer_load_dwordx4 v31, s[28:31], s33 offen offset:3072 lds
 v_mfma_f32_16x16x32_bf16 a[148:151], a[104:107], a[68:71], a[148:151]
 ds_read_b64_tr_b16 a[100:101], v52 offset:8192
 v_mfma_f32_16x16x32_bf16 a[148:151], a[108:111], a[84:87], a[148:151]
 v_mfma_f32_16x16x32_bf16 a[144:147], a[104:107], a[64:67], a[144:147]
 ds_read_b64_tr_b16 a[102:103], v52 offset:8448
 v_mfma_f32_16x16x32_bf16 a[144:147], a[108:111], a[80:83], a[144:147]
 s_waitcnt lgkmcnt(8)
 v_mfma_f32_16x16x32_bf16 a[160:163], a[112:115], a[64:67], a[160:163]
 ds_read_b64_tr_b16 a[104:105], v53 offset:0
 s_add_u32 m0, s43, 0x18000
 v_mfma_f32_16x16x32_bf16 a[160:163], a[116:119], a[80:83], a[160:163]
 s_xor_b32 s34, s98, 0x400000
 v_mfma_f32_16x16x32_bf16 a[164:167], a[112:115], a[68:71], a[164:167]
 ds_read_b64_tr_b16 a[106:107], v53 offset:256
 v_mfma_f32_16x16x32_bf16 a[164:167], a[116:119], a[84:87], a[164:167]
 buffer_load_dwordx4 v32, s[16:19], s34 offen offset:0 lds
 v_mfma_f32_16x16x32_bf16 a[168:171], a[112:115], a[72:75], a[168:171]
 ds_read_b64_tr_b16 a[108:109], v53 offset:8192
 v_mfma_f32_16x16x32_bf16 a[168:171], a[116:119], a[88:91], a[168:171]
 buffer_store_dwordx4 v[252:255], v57, s[20:23], s93 offen offset:3328 sc1
 v_mfma_f32_16x16x32_bf16 a[172:175], a[112:115], a[76:79], a[172:175]
 ds_read_b64_tr_b16 a[110:111], v53 offset:8448
 v_mfma_f32_16x16x32_bf16 a[172:175], a[116:119], a[92:95], a[172:175]
 s_waitcnt lgkmcnt(8)
 v_mfma_f32_16x16x32_bf16 a[188:191], a[120:123], a[76:79], a[188:191]
 ds_read_b64_tr_b16 a[112:113], v52 offset:1024
 v_mfma_f32_16x16x32_bf16 a[188:191], a[124:127], a[92:95], a[188:191]
 buffer_load_dwordx4 v33, s[16:19], s34 offen offset:1024 lds
 v_mfma_f32_16x16x32_bf16 a[184:187], a[120:123], a[72:75], a[184:187]
 ds_read_b64_tr_b16 a[114:115], v52 offset:1280
 v_mfma_f32_16x16x32_bf16 a[184:187], a[124:127], a[88:91], a[184:187]
 buffer_load_dwordx4 v34, s[16:19], s34 offen offset:2048 lds
 v_mfma_f32_16x16x32_bf16 a[180:183], a[120:123], a[68:71], a[180:183]
 ds_read_b64_tr_b16 a[116:117], v52 offset:9216
 v_mfma_f32_16x16x32_bf16 a[180:183], a[124:127], a[84:87], a[180:183]
 v_mfma_f32_16x16x32_bf16 a[176:179], a[120:123], a[64:67], a[176:179]
 ds_read_b64_tr_b16 a[118:119], v52 offset:9472
 v_mfma_f32_16x16x32_bf16 a[176:179], a[124:127], a[80:83], a[176:179]
 s_waitcnt lgkmcnt(8)
 v_mfma_f32_16x16x32_bf16 v[80:83], a[96:99], a[64:67], v[80:83]
 ds_read_b64_tr_b16 a[120:121], v53 offset:1024
 v_mfma_f32_16x16x32_bf16 v[80:83], a[100:103], a[80:83], v[80:83]
 buffer_load_dwordx4 v35, s[16:19], s34 offen offset:3072 lds
 v_mfma_f32_16x16x32_bf16 v[84:87], a[96:99], a[68:71], v[84:87]
 ds_read_b64_tr_b16 a[122:123], v53 offset:1280
 v_mfma_f32_16x16x32_bf16 v[84:87], a[100:103], a[84:87], v[84:87]
 v_mfma_f32_16x16x32_bf16 v[88:91], a[96:99], a[72:75], v[88:91]
 ds_read_b64_tr_b16 a[124:125], v53 offset:9216
 v_mfma_f32_16x16x32_bf16 v[88:91], a[100:103], a[88:91], v[88:91]
 v_mfma_f32_16x16x32_bf16 v[92:95], a[96:99], a[76:79], v[92:95]
 ds_read_b64_tr_b16 a[126:127], v53 offset:9472
 v_mfma_f32_16x16x32_bf16 v[92:95], a[100:103], a[92:95], v[92:95]
 s_add_u32 m0, s44, 0x18000
 s_waitcnt lgkmcnt(8)
 v_mfma_f32_16x16x32_bf16 v[124:127], a[104:107], a[76:79], v[124:127]
 ds_read_b64_tr_b16 a[96:97], v52 offset:2048
 s_mov_b32 s35, 0x300000
 v_mfma_f32_16x16x32_bf16 v[124:127], a[108:111], a[92:95], v[124:127]
 buffer_load_dwordx4 v36, s[24:27], s35 offen offset:0 lds
 v_mfma_f32_16x16x32_bf16 v[120:123], a[104:107], a[72:75], v[120:123]
 ds_read_b64_tr_b16 a[98:99], v52 offset:2304
 v_mfma_f32_16x16x32_bf16 v[120:123], a[108:111], a[88:91], v[120:123]
 v_mfma_f32_16x16x32_bf16 v[116:119], a[104:107], a[68:71], v[116:119]
 ds_read_b64_tr_b16 a[100:101], v52 offset:10240
 v_mfma_f32_16x16x32_bf16 v[116:119], a[108:111], a[84:87], v[116:119]
 buffer_load_dwordx4 v37, s[24:27], s35 offen offset:1024 lds
 v_mfma_f32_16x16x32_bf16 v[112:115], a[104:107], a[64:67], v[112:115]
 ds_read_b64_tr_b16 a[102:103], v52 offset:10496
 v_mfma_f32_16x16x32_bf16 v[112:115], a[108:111], a[80:83], v[112:115]
 s_waitcnt lgkmcnt(8)
 v_mfma_f32_16x16x32_bf16 v[144:147], a[112:115], a[64:67], v[144:147]
 ds_read_b64_tr_b16 a[104:105], v53 offset:2048
 v_mfma_f32_16x16x32_bf16 v[144:147], a[116:119], a[80:83], v[144:147]
 v_mfma_f32_16x16x32_bf16 v[148:151], a[112:115], a[68:71], v[148:151]
 ds_read_b64_tr_b16 a[106:107], v53 offset:2304
 v_mfma_f32_16x16x32_bf16 v[148:151], a[116:119], a[84:87], v[148:151]
 buffer_load_dwordx4 v38, s[24:27], s35 offen offset:2048 lds
 v_mfma_f32_16x16x32_bf16 v[152:155], a[112:115], a[72:75], v[152:155]
 ds_read_b64_tr_b16 a[108:109], v53 offset:10240
 v_mfma_f32_16x16x32_bf16 v[152:155], a[116:119], a[88:91], v[152:155]
 v_mfma_f32_16x16x32_bf16 v[156:159], a[112:115], a[76:79], v[156:159]
 ds_read_b64_tr_b16 a[110:111], v53 offset:10496
 v_mfma_f32_16x16x32_bf16 v[156:159], a[116:119], a[92:95], v[156:159]
 s_waitcnt lgkmcnt(8)
 v_mfma_f32_16x16x32_bf16 v[188:191], a[120:123], a[76:79], v[188:191]
 v_mfma_f32_16x16x32_bf16 v[188:191], a[124:127], a[92:95], v[188:191]
 v_mfma_f32_16x16x32_bf16 v[184:187], a[120:123], a[72:75], v[184:187]
 v_mfma_f32_16x16x32_bf16 v[184:187], a[124:127], a[88:91], v[184:187]
 s_waitcnt lgkmcnt(0) vmcnt(18)
 s_barrier
 v_mfma_f32_16x16x32_bf16 v[180:183], a[120:123], a[68:71], v[180:183]
 ds_read_b64_tr_b16 a[112:113], v42 offset:0
 v_mfma_f32_16x16x32_bf16 v[180:183], a[124:127], a[84:87], v[180:183]
 ds_read_b64_tr_b16 a[114:115], v42 offset:512
 v_mfma_f32_16x16x32_bf16 v[176:179], a[120:123], a[64:67], v[176:179]
 ds_read_b64_tr_b16 a[116:117], v42 offset:4096
 buffer_store_dwordx4 v[96:99], v56, s[20:23], s84 offen offset:2048 sc1
 v_mfma_f32_16x16x32_bf16 v[176:179], a[124:127], a[80:83], v[176:179]
 ds_read_b64_tr_b16 a[118:119], v42 offset:4608
 v_mfma_f32_16x16x32_bf16 a[192:195], a[64:67], a[96:99], a[192:195]
 ds_read_b128 a[224:227], v40 offset:8192
 v_mfma_f32_16x16x32_bf16 a[192:195], a[80:83], a[100:103], a[192:195]
 ds_read_b128 a[240:243], v41 offset:8192
 v_mfma_f32_16x16x32_bf16 a[196:199], a[68:71], a[96:99], a[196:199]
 ds_read_b128 a[228:231], v40 offset:10240
 v_mfma_f32_16x16x32_bf16 a[196:199], a[84:87], a[100:103], a[196:199]
 ds_read_b128 a[244:247], v41 offset:10240
 v_mfma_f32_16x16x32_bf16 a[200:203], a[72:75], a[96:99], a[200:203]
 ds_read_b128 a[232:235], v40 offset:12288
 v_mfma_f32_16x16x32_bf16 a[200:203], a[88:91], a[100:103], a[200:203]
 ds_read_b128 a[248:251], v41 offset:12288
 v_mfma_f32_16x16x32_bf16 a[204:207], a[76:79], a[96:99], a[204:207]
 ds_read_b128 a[236:239], v40 offset:14336
 v_mfma_f32_16x16x32_bf16 a[204:207], a[92:95], a[100:103], a[204:207]
 ds_read_b128 a[252:255], v41 offset:14336
 v_mfma_f32_16x16x32_bf16 a[220:223], a[76:79], a[104:107], a[220:223]
 ds_read_b64_tr_b16 a[120:121], v43 offset:0
 v_mfma_f32_16x16x32_bf16 a[220:223], a[92:95], a[108:111], a[220:223]
 ds_read_b64_tr_b16 a[122:123], v43 offset:512
 v_mfma_f32_16x16x32_bf16 a[216:219], a[72:75], a[104:107], a[216:219]
 ds_read_b64_tr_b16 a[124:125], v43 offset:4096
 v_mfma_f32_16x16x32_bf16 a[216:219], a[88:91], a[108:111], a[216:219]
 ds_read_b64_tr_b16 a[126:127], v43 offset:4608
 v_mfma_f32_16x16x32_bf16 a[212:215], a[68:71], a[104:107], a[212:215]
 ds_read_b64_tr_b16 a[96:97], v44 offset:0
 v_mfma_f32_16x16x32_bf16 a[212:215], a[84:87], a[108:111], a[212:215]
 ds_read_b64_tr_b16 a[98:99], v44 offset:512
 v_mfma_f32_16x16x32_bf16 a[208:211], a[64:67], a[104:107], a[208:211]
 ds_read_b64_tr_b16 a[100:101], v44 offset:4096
 v_mfma_f32_16x16x32_bf16 a[208:211], a[80:83], a[108:111], a[208:211]
 ds_read_b64_tr_b16 a[102:103], v44 offset:4608
F_step15:
 s_waitcnt lgkmcnt(8)
 v_mfma_f32_16x16x32_bf16 a[0:3], a[112:115], a[224:227], a[0:3]
 ds_read_b64_tr_b16 a[104:105], v45 offset:0
 v_mfma_f32_16x16x32_bf16 a[0:3], a[116:119], a[240:243], a[0:3]
 v_mfma_f32_16x16x32_bf16 a[4:7], a[112:115], a[228:231], a[4:7]
 ds_read_b64_tr_b16 a[106:107], v45 offset:512
 v_mfma_f32_16x16x32_bf16 a[4:7], a[116:119], a[244:247], a[4:7]
 s_add_u32 m0, s46, 8192
 s_xor_b32 s33, s99, 1152
 v_mfma_f32_16x16x32_bf16 a[8:11], a[112:115], a[232:235], a[8:11]
 ds_read_b64_tr_b16 a[108:109], v45 offset:4096
 v_mfma_f32_16x16x32_bf16 a[8:11], a[116:119], a[248:251], a[8:11]
 buffer_load_dwordx4 v24, s[28:31], s33 offen offset:0 lds
 v_mfma_f32_16x16x32_bf16 a[12:15], a[112:115], a[236:239], a[12:15]
 ds_read_b64_tr_b16 a[110:111], v45 offset:4608
 v_mfma_f32_16x16x32_bf16 a[12:15], a[116:119], a[252:255], a[12:15]
 s_waitcnt lgkmcnt(8)
 v_mfma_f32_16x16x32_bf16 a[28:31], a[120:123], a[236:239], a[28:31]
 ds_read_b64_tr_b16 a[112:113], v42 offset:8192
 v_mfma_f32_16x16x32_bf16 a[28:31], a[124:127], a[252:255], a[28:31]
 buffer_load_dwordx4 v25, s[28:31], s33 offen offset:1024 lds
 v_mfma_f32_16x16x32_bf16 a[24:27], a[120:123], a[232:235], a[24:27]
 ds_read_b64_tr_b16 a[114:115], v42 offset:8704
 v_mfma_f32_16x16x32_bf16 a[24:27], a[124:127], a[248:251], a[24:27]
 buffer_store_dwordx4 v[100:103], v56, s[20:23], s84 offen offset:2176 sc1
 v_mfma_f32_16x16x32_bf16 a[20:23], a[120:123], a[228:231], a[20:23]
 ds_read_b64_tr_b16 a[116:117], v42 offset:12288
 v_mfma_f32_16x16x32_bf16 a[20:23], a[124:127], a[244:247], a[20:23]
 buffer_load_dwordx4 v26, s[28:31], s33 offen offset:2048 lds
 v_mfma_f32_16x16x32_bf16 a[16:19], a[120:123], a[224:227], a[16:19]
 ds_read_b64_tr_b16 a[118:119], v42 offset:12800
 v_mfma_f32_16x16x32_bf16 a[16:19], a[124:127], a[240:243], a[16:19]
 s_waitcnt lgkmcnt(8)
 v_mfma_f32_16x16x32_bf16 a[32:35], a[96:99], a[224:227], a[32:35]
 ds_read_b64_tr_b16 a[120:121], v43 offset:8192
 v_mfma_f32_16x16x32_bf16 a[32:35], a[100:103], a[240:243], a[32:35]
 v_mfma_f32_16x16x32_bf16 a[36:39], a[96:99], a[228:231], a[36:39]
 ds_read_b64_tr_b16 a[122:123], v43 offset:8704
 v_mfma_f32_16x16x32_bf16 a[36:39], a[100:103], a[244:247], a[36:39]
 buffer_load_dwordx4 v27, s[28:31], s33 offen offset:3072 lds
 v_mfma_f32_16x16x32_bf16 a[40:43], a[96:99], a[232:235], a[40:43]
 ds_read_b64_tr_b16 a[124:125], v43 offset:12288
 v_mfma_f32_16x16x32_bf16 a[40:43], a[100:103], a[248:251], a[40:43]
 v_mfma_f32_16x16x32_bf16 a[44:47], a[96:99], a[236:239], a[44:47]
 ds_read_b64_tr_b16 a[126:127], v43 offset:12800
 v_mfma_f32_16x16x32_bf16 a[44:47], a[100:103], a[252:255], a[44:47]
 s_waitcnt lgkmcnt(8)
 v_mfma_f32_16x16x32_bf16 a[60:63], a[104:107], a[236:239], a[60:63]
 ds_read_b64_tr_b16 a[96:97], v44 offset:8192
 s_add_u32 m0, s46, 12288
 v_mfma_f32_16x16x32_bf16 a[60:63], a[108:111], a[252:255], a[60:63]
 buffer_load_dwordx4 v28, s[28:31], s33 offen offset:0 lds
 v_mfma_f32_16x16x32_bf16 a[56:59], a[104:107], a[232:235], a[56:59]
 ds_read_b64_tr_b16 a[98:99], v44 offset:8704
 v_mfma_f32_16x16x32_bf16 a[56:59], a[108:111], a[248:251], a[56:59]
 v_mfma_f32_16x16x32_bf16 a[52:55], a[104:107], a[228:231], a[52:55]
 ds_read_b64_tr_b16 a[100:101], v44 offset:12288
 v_mfma_f32_16x16x32_bf16 a[52:55], a[108:111], a[244:247], a[52:55]
 v_mfma_f32_16x16x32_bf16 a[48:51], a[104:107], a[224:227], a[48:51]
 ds_read_b64_tr_b16 a[102:103], v44 offset:12800
 v_mfma_f32_16x16x32_bf16 a[48:51], a[108:111], a[240:243], a[48:51]
 s_waitcnt lgkmcnt(8)
 v_mfma_f32_16x16x32_bf16 a[128:131], a[112:115], a[224:227], a[128:131]
 ds_read_b64_tr_b16 a[104:105], v45 offset:8192
 v_mfma_f32_16x16x32_bf16 a[128:131], a[116:119], a[240:243], a[128:131]
 buffer_load_dwordx4 v29, s[28:31], s33 offen offset:1024 lds
 v_mfma_f32_16x16x32_bf16 a[132:135], a[112:115], a[228:231], a[132:135]
 ds_read_b64_tr_b16 a[106:107], v45 offset:8704
 v_mfma_f32_16x16x32_bf16 a[132:135], a[116:119], a[244:247], a[132:135]
 buffer_load_dwordx4 v30, s[28:31], s33 offen offset:2048 lds
 v_mfma_f32_16x16x32_bf16 a[136:139], a[112:115], a[232:235], a[136:139]
 ds_read_b64_tr_b16 a[108:109], v45 offset:12288
 v_mfma_f32_16x16x32_bf16 a[136:139], a[116:119], a[248:251], a[136:139]
 v_mfma_f32_16x16x32_bf16 a[140:143], a[112:115], a[236:239], a[140:143]
 ds_read_b64_tr_b16 a[110:111], v45 offset:12800
 v_mfma_f32_16x16x32_bf16 a[140:143], a[116:119], a[252:255], a[140:143]
 s_waitcnt lgkmcnt(8)
 v_mfma_f32_16x16x32_bf16 a[156:159], a[120:123], a[236:239], a[156:159]
 ds_read_b64_tr_b16 a[112:113], v46 offset:0
 v_mfma_f32_16x16x32_bf16 a[156:159], a[124:127], a[252:255], a[156:159]
 buffer_load_dwordx4 v31, s[28:31], s33 offen offset:3072 lds
 v_mfma_f32_16x16x32_bf16 a[152:155], a[120:123], a[232:235], a[152:155]
 ds_read_b64_tr_b16 a[114:115], v46 offset:256
 v_mfma_f32_16x16x32_bf16 a[152:155], a[124:127], a[248:251], a[152:155]
 v_mfma_f32_16x16x32_bf16 a[148:151], a[120:123], a[228:231], a[148:151]
 ds_read_b64_tr_b16 a[116:117], v46 offset:8192
 v_mfma_f32_16x16x32_bf16 a[148:151], a[124:127], a[244:247], a[148:151]
 v_mfma_f32_16x16x32_bf16 a[144:147], a[120:123], a[224:227], a[144:147]
 ds_read_b64_tr_b16 a[118:119], v46 offset:8448
 s_add_u32 m0, s43, 0x20000
 v_mfma_f32_16x16x32_bf16 a[144:147], a[124:127], a[240:243], a[144:147]
 s_xor_b32 s34, s98, 0x480000
 s_waitcnt lgkmcnt(8)
 v_mfma_f32_16x16x32_bf16 a[160:163], a[96:99], a[224:227], a[160:163]
 ds_read_b64_tr_b16 a[120:121], v47 offset:0
 v_mfma_f32_16x16x32_bf16 a[160:163], a[100:103], a[240:243], a[160:163]
 buffer_load_dwordx4 v32, s[16:19], s34 offen offset:0 lds
 v_mfma_f32_16x16x32_bf16 a[164:167], a[96:99], a[228:231], a[164:167]
 ds_read_b64_tr_b16 a[122:123], v47 offset:256
 v_mfma_f32_16x16x32_bf16 a[164:167], a[100:103], a[244:247], a[164:167]
 buffer_load_dwordx4 v33, s[16:19], s34 offen offset:1024 lds
 v_mfma_f32_16x16x32_bf16 a[168:171], a[96:99], a[232:235], a[168:171]
 ds_read_b64_tr_b16 a[124:125], v47 offset:8192
 v_mfma_f32_16x16x32_bf16 a[168:171], a[100:103], a[248:251], a[168:171]
 buffer_store_dwordx4 v[104:107], v56, s[20:23], s85 offen offset:2048 sc1
 v_mfma_f32_16x16x32_bf16 a[172:175], a[96:99], a[236:239], a[172:175]
 ds_read_b64_tr_b16 a[126:127], v47 offset:8448
 v_mfma_f32_16x16x32_bf16 a[172:175], a[100:103], a[252:255], a[172:175]
 s_waitcnt lgkmcnt(8)
 v_mfma_f32_16x16x32_bf16 a[188:191], a[104:107], a[236:239], a[188:191]
 ds_read_b64_tr_b16 a[96:97], v46 offset:1024
 v_mfma_f32_16x16x32_bf16 a[188:191], a[108:111], a[252:255], a[188:191]
 buffer_load_dwordx4 v34, s[16:19], s34 offen offset:2048 lds
 v_mfma_f32_16x16x32_bf16 a[184:187], a[104:107], a[232:235], a[184:187]
 ds_read_b64_tr_b16 a[98:99], v46 offset:1280
 v_mfma_f32_16x16x32_bf16 a[184:187], a[108:111], a[248:251], a[184:187]
 v_mfma_f32_16x16x32_bf16 a[180:183], a[104:107], a[228:231], a[180:183]
 ds_read_b64_tr_b16 a[100:101], v46 offset:9216
 v_mfma_f32_16x16x32_bf16 a[180:183], a[108:111], a[244:247], a[180:183]
 v_mfma_f32_16x16x32_bf16 a[176:179], a[104:107], a[224:227], a[176:179]
 ds_read_b64_tr_b16 a[102:103], v46 offset:9472
 v_mfma_f32_16x16x32_bf16 a[176:179], a[108:111], a[240:243], a[176:179]
 s_waitcnt lgkmcnt(8)
 v_mfma_f32_16x16x32_bf16 v[80:83], a[112:115], a[224:227], v[80:83]
 ds_read_b64_tr_b16 a[104:105], v47 offset:1024
 v_mfma_f32_16x16x32_bf16 v[80:83], a[116:119], a[240:243], v[80:83]
 buffer_load_dwordx4 v35, s[16:19], s34 offen offset:3072 lds
 v_mfma_f32_16x16x32_bf16 v[84:87], a[112:115], a[228:231], v[84:87]
 ds_read_b64_tr_b16 a[106:107], v47 offset:1280
 v_mfma_f32_16x16x32_bf16 v[84:87], a[116:119], a[244:247], v[84:87]
 s_add_u32 m0, s44, 0x20000
 s_mov_b32 s35, 0x360000
 v_mfma_f32_16x16x32_bf16 v[88:91], a[112:115], a[232:235], v[88:91]
 ds_read_b64_tr_b16 a[108:109], v47 offset:9216
 v_mfma_f32_16x16x32_bf16 v[88:91], a[116:119], a[248:251], v[88:91]
 buffer_load_dwordx4 v36, s[24:27], s35 offen offset:0 lds
 v_mfma_f32_16x16x32_bf16 v[92:95], a[112:115], a[236:239], v[92:95]
 ds_read_b64_tr_b16 a[110:111], v47 offset:9472
 v_mfma_f32_16x16x32_bf16 v[92:95], a[116:119], a[252:255], v[92:95]
 s_waitcnt lgkmcnt(8)
 v_mfma_f32_16x16x32_bf16 v[124:127], a[120:123], a[236:239], v[124:127]
 ds_read_b64_tr_b16 a[112:113], v46 offset:2048
 v_mfma_f32_16x16x32_bf16 v[124:127], a[124:127], a[252:255], v[124:127]
 buffer_load_dwordx4 v37, s[24:27], s35 offen offset:1024 lds
 v_mfma_f32_16x16x32_bf16 v[120:123], a[120:123], a[232:235], v[120:123]
 ds_read_b64_tr_b16 a[114:115], v46 offset:2304
 v_mfma_f32_16x16x32_bf16 v[120:123], a[124:127], a[248:251], v[120:123]
 v_mfma_f32_16x16x32_bf16 v[116:119], a[120:123], a[228:231], v[116:119]
 ds_read_b64_tr_b16 a[116:117], v46 offset:10240
 v_mfma_f32_16x16x32_bf16 v[116:119], a[124:127], a[244:247], v[116:119]
 v_mfma_f32_16x16x32_bf16 v[112:115], a[120:123], a[224:227], v[112:115]
 ds_read_b64_tr_b16 a[118:119], v46 offset:10496
 v_mfma_f32_16x16x32_bf16 v[112:115], a[124:127], a[240:243], v[112:115]
 s_waitcnt lgkmcnt(8)
 v_mfma_f32_16x16x32_bf16 v[144:147], a[96:99], a[224:227], v[144:147]
 ds_read_b64_tr_b16 a[120:121], v47 offset:2048
 v_mfma_f32_16x16x32_bf16 v[144:147], a[100:103], a[240:243], v[144:147]
 buffer_load_dwordx4 v38, s[24:27], s35 offen offset:2048 lds
 v_mfma_f32_16x16x32_bf16 v[148:151], a[96:99], a[228:231], v[148:151]
 ds_read_b64_tr_b16 a[122:123], v47 offset:2304
 v_mfma_f32_16x16x32_bf16 v[148:151], a[100:103], a[244:247], v[148:151]
 v_mfma_f32_16x16x32_bf16 v[152:155], a[96:99], a[232:235], v[152:155]
 ds_read_b64_tr_b16 a[124:125], v47 offset:10240
 v_mfma_f32_16x16x32_bf16 v[152:155], a[100:103], a[248:251], v[152:155]
 v_mfma_f32_16x16x32_bf16 v[156:159], a[96:99], a[236:239], v[156:159]
 ds_read_b64_tr_b16 a[126:127], v47 offset:10496
 v_min_u32 v5, 1, v2
 v_mfma_f32_16x16x32_bf16 v[156:159], a[100:103], a[252:255], v[156:159]
 v_mad_u32_u24 v5, s45, 2, v5
 s_waitcnt lgkmcnt(8)
 v_mfma_f32_16x16x32_bf16 v[188:191], a[104:107], a[236:239], v[188:191]
 v_lshlrev_b32 v5, 7, v5
 v_mfma_f32_16x16x32_bf16 v[188:191], a[108:111], a[252:255], v[188:191]
 v_add_u32 v5, F_step19-F_pc, v5
 v_mfma_f32_16x16x32_bf16 v[184:187], a[104:107], a[232:235], v[184:187]
 global_load_dword v60, v5, s[90:91]
 v_mfma_f32_16x16x32_bf16 v[184:187], a[108:111], a[248:251], v[184:187]
 s_waitcnt lgkmcnt(0) vmcnt(19)
 s_barrier
 v_mfma_f32_16x16x32_bf16 v[180:183], a[104:107], a[228:231], v[180:183]
 ds_read_b64_tr_b16 a[96:97], v42 offset:32768
 v_mfma_f32_16x16x32_bf16 v[180:183], a[108:111], a[244:247], v[180:183]
 ds_read_b64_tr_b16 a[98:99], v42 offset:33280
 v_mfma_f32_16x16x32_bf16 v[176:179], a[104:107], a[224:227], v[176:179]
 ds_read_b64_tr_b16 a[100:101], v42 offset:36864
 buffer_store_dwordx4 v[108:111], v56, s[20:23], s85 offen offset:2176 sc1
 v_mfma_f32_16x16x32_bf16 v[176:179], a[108:111], a[240:243], v[176:179]
 ds_read_b64_tr_b16 a[102:103], v42 offset:37376
 v_mfma_f32_16x16x32_bf16 a[192:195], a[224:227], a[112:115], a[192:195]
 ds_read_b128 a[64:67], v40 offset:0
 v_mfma_f32_16x16x32_bf16 a[192:195], a[240:243], a[116:119], a[192:195]
 ds_read_b128 a[80:83], v41 offset:0
 v_mfma_f32_16x16x32_bf16 a[196:199], a[228:231], a[112:115], a[196:199]
 ds_read_b128 a[68:71], v40 offset:2048
 v_mfma_f32_16x16x32_bf16 a[196:199], a[244:247], a[116:119], a[196:199]
 ds_read_b128 a[84:87], v41 offset:2048
 v_mfma_f32_16x16x32_bf16 a[200:203], a[232:235], a[112:115], a[200:203]
 ds_read_b128 a[72:75], v40 offset:4096
 v_mfma_f32_16x16x32_bf16 a[200:203], a[248:251], a[116:119], a[200:203]
 ds_read_b128 a[88:91], v41 offset:4096
 v_mfma_f32_16x16x32_bf16 a[204:207], a[236:239], a[112:115], a[204:207]
 ds_read_b128 a[76:79], v40 offset:6144
 v_mfma_f32_16x16x32_bf16 a[204:207], a[252:255], a[116:119], a[204:207]
 ds_read_b128 a[92:95], v41 offset:6144
 v_mfma_f32_16x16x32_bf16 a[220:223], a[236:239], a[120:123], a[220:223]
 ds_read_b64_tr_b16 a[104:105], v43 offset:32768
 v_mfma_f32_16x16x32_bf16 a[220:223], a[252:255], a[124:127], a[220:223]
 ds_read_b64_tr_b16 a[106:107], v43 offset:33280
 v_mfma_f32_16x16x32_bf16 a[216:219], a[232:235], a[120:123], a[216:219]
 ds_read_b64_tr_b16 a[108:109], v43 offset:36864
 v_mfma_f32_16x16x32_bf16 a[216:219], a[248:251], a[124:127], a[216:219]
 ds_read_b64_tr_b16 a[110:111], v43 offset:37376
 v_mfma_f32_16x16x32_bf16 a[212:215], a[228:231], a[120:123], a[212:215]
 ds_read_b64_tr_b16 a[112:113], v44 offset:32768
 v_mfma_f32_16x16x32_bf16 a[212:215], a[244:247], a[124:127], a[212:215]
 ds_read_b64_tr_b16 a[114:115], v44 offset:33280
 v_mfma_f32_16x16x32_bf16 a[208:211], a[224:227], a[120:123], a[208:211]
 ds_read_b64_tr_b16 a[116:117], v44 offset:36864
 v_mfma_f32_16x16x32_bf16 a[208:211], a[240:243], a[124:127], a[208:211]
 ds_read_b64_tr_b16 a[118:119], v44 offset:37376
F_step16:
 s_waitcnt lgkmcnt(8)
 v_mfma_f32_16x16x32_bf16 a[0:3], a[96:99], a[64:67], a[0:3]
 ds_read_b64_tr_b16 a[120:121], v45 offset:32768
 v_mfma_f32_16x16x32_bf16 a[0:3], a[100:103], a[80:83], a[0:3]
 v_mfma_f32_16x16x32_bf16 a[4:7], a[96:99], a[68:71], a[4:7]
 ds_read_b64_tr_b16 a[122:123], v45 offset:33280
 v_mfma_f32_16x16x32_bf16 a[4:7], a[100:103], a[84:87], a[4:7]
 s_add_u32 m0, s46, 0
 s_xor_b32 s33, s99, 1280
 v_mfma_f32_16x16x32_bf16 a[8:11], a[96:99], a[72:75], a[8:11]
 ds_read_b64_tr_b16 a[124:125], v45 offset:36864
 v_mfma_f32_16x16x32_bf16 a[8:11], a[100:103], a[88:91], a[8:11]
 buffer_load_dwordx4 v24, s[28:31], s33 offen offset:0 lds
 v_mfma_f32_16x16x32_bf16 a[12:15], a[96:99], a[76:79], a[12:15]
 ds_read_b64_tr_b16 a[126:127], v45 offset:37376
 v_mfma_f32_16x16x32_bf16 a[12:15], a[100:103], a[92:95], a[12:15]
 s_waitcnt lgkmcnt(8)
 v_mfma_f32_16x16x32_bf16 a[28:31], a[104:107], a[76:79], a[28:31]
 ds_read_b64_tr_b16 a[96:97], v42 offset:40960
 v_mfma_f32_16x16x32_bf16 a[28:31], a[108:111], a[92:95], a[28:31]
 buffer_load_dwordx4 v25, s[28:31], s33 offen offset:1024 lds
 v_mfma_f32_16x16x32_bf16 a[24:27], a[104:107], a[72:75], a[24:27]
 ds_read_b64_tr_b16 a[98:99], v42 offset:41472
 v_mfma_f32_16x16x32_bf16 a[24:27], a[108:111], a[88:91], a[24:27]
 buffer_store_dwordx4 v[128:131], v56, s[20:23], s86 offen offset:0 sc1
 v_mfma_f32_16x16x32_bf16 a[20:23], a[104:107], a[68:71], a[20:23]
 ds_read_b64_tr_b16 a[100:101], v42 offset:45056
 v_mfma_f32_16x16x32_bf16 a[20:23], a[108:111], a[84:87], a[20:23]
 v_mfma_f32_16x16x32_bf16 a[16:19], a[104:107], a[64:67], a[16:19]
 ds_read_b64_tr_b16 a[102:103], v42 offset:45568
 v_mfma_f32_16x16x32_bf16 a[16:19], a[108:111], a[80:83], a[16:19]
 s_waitcnt lgkmcnt(8)
 v_mfma_f32_16x16x32_bf16 a[32:35], a[112:115], a[64:67], a[32:35]
 ds_read_b64_tr_b16 a[104:105], v43 offset:40960
 v_mfma_f32_16x16x32_bf16 a[32:35], a[116:119], a[80:83], a[32:35]
 buffer_load_dwordx4 v26, s[28:31], s33 offen offset:2048 lds
 v_mfma_f32_16x16x32_bf16 a[36:39], a[112:115], a[68:71], a[36:39]
 ds_read_b64_tr_b16 a[106:107], v43 offset:41472
 v_mfma_f32_16x16x32_bf16 a[36:39], a[116:119], a[84:87], a[36:39]
 v_mfma_f32_16x16x32_bf16 a[40:43], a[112:115], a[72:75], a[40:43]
 ds_read_b64_tr_b16 a[108:109], v43 offset:45056
 v_mfma_f32_16x16x32_bf16 a[40:43], a[116:119], a[88:91], a[40:43]
 buffer_load_dwordx4 v27, s[28:31], s33 offen offset:3072 lds
 v_mfma_f32_16x16x32_bf16 a[44:47], a[112:115], a[76:79], a[44:47]
 ds_read_b64_tr_b16 a[110:111], v43 offset:45568
 v_mfma_f32_16x16x32_bf16 a[44:47], a[116:119], a[92:95], a[44:47]
 s_waitcnt lgkmcnt(8)
 v_mfma_f32_16x16x32_bf16 a[60:63], a[120:123], a[76:79], a[60:63]
 ds_read_b64_tr_b16 a[112:113], v44 offset:40960
 v_mfma_f32_16x16x32_bf16 a[60:63], a[124:127], a[92:95], a[60:63]
 s_add_u32 m0, s46, 4096
 v_mfma_f32_16x16x32_bf16 a[56:59], a[120:123], a[72:75], a[56:59]
 ds_read_b64_tr_b16 a[114:115], v44 offset:41472
 v_mfma_f32_16x16x32_bf16 a[56:59], a[124:127], a[88:91], a[56:59]
 buffer_load_dwordx4 v28, s[28:31], s33 offen offset:0 lds
 v_mfma_f32_16x16x32_bf16 a[52:55], a[120:123], a[68:71], a[52:55]
 ds_read_b64_tr_b16 a[116:117], v44 offset:45056
 v_mfma_f32_16x16x32_bf16 a[52:55], a[124:127], a[84:87], a[52:55]
 v_mfma_f32_16x16x32_bf16 a[48:51], a[120:123], a[64:67], a[48:51]
 ds_read_b64_tr_b16 a[118:119], v44 offset:45568
 v_mfma_f32_16x16x32_bf16 a[48:51], a[124:127], a[80:83], a[48:51]
 s_waitcnt lgkmcnt(8)
 v_mfma_f32_16x16x32_bf16 a[128:131], a[96:99], a[64:67], a[128:131]
 ds_read_b64_tr_b16 a[120:121], v45 offset:40960
 v_mfma_f32_16x16x32_bf16 a[128:131], a[100:103], a[80:83], a[128:131]
 buffer_load_dwordx4 v29, s[28:31], s33 offen offset:1024 lds
 v_mfma_f32_16x16x32_bf16 a[132:135], a[96:99], a[68:71], a[132:135]
 ds_read_b64_tr_b16 a[122:123], v45 offset:41472
 v_mfma_f32_16x16x32_bf16 a[132:135], a[100:103], a[84:87], a[132:135]
 v_mfma_f32_16x16x32_bf16 a[136:139], a[96:99], a[72:75], a[136:139]
 ds_read_b64_tr_b16 a[124:125], v45 offset:45056
 v_mfma_f32_16x16x32_bf16 a[136:139], a[100:103], a[88:91], a[136:139]
 buffer_load_dwordx4 v30, s[28:31], s33 offen offset:2048 lds
 v_mfma_f32_16x16x32_bf16 a[140:143], a[96:99], a[76:79], a[140:143]
 ds_read_b64_tr_b16 a[126:127], v45 offset:45568
 v_mfma_f32_16x16x32_bf16 a[140:143], a[100:103], a[92:95], a[140:143]
 s_waitcnt lgkmcnt(8)
 v_mfma_f32_16x16x32_bf16 a[156:159], a[104:107], a[76:79], a[156:159]
 ds_read_b64_tr_b16 a[96:97], v46 offset:32768
 v_mfma_f32_16x16x32_bf16 a[156:159], a[108:111], a[92:95], a[156:159]
 v_mfma_f32_16x16x32_bf16 a[152:155], a[104:107], a[72:75], a[152:155]
 ds_read_b64_tr_b16 a[98:99], v46 offset:33024
 v_mfma_f32_16x16x32_bf16 a[152:155], a[108:111], a[88:91], a[152:155]
 buffer_load_dwordx4 v31, s[28:31], s33 offen offset:3072 lds
 v_mfma_f32_16x16x32_bf16 a[148:151], a[104:107], a[68:71], a[148:151]
 ds_read_b64_tr_b16 a[100:101], v46 offset:40960
 v_mfma_f32_16x16x32_bf16 a[148:151], a[108:111], a[84:87], a[148:151]
 v_mfma_f32_16x16x32_bf16 a[144:147], a[104:107], a[64:67], a[144:147]
 ds_read_b64_tr_b16 a[102:103], v46 offset:41216
 v_mfma_f32_16x16x32_bf16 a[144:147], a[108:111], a[80:83], a[144:147]
 s_waitcnt lgkmcnt(8)
 v_mfma_f32_16x16x32_bf16 a[160:163], a[112:115], a[64:67], a[160:163]
 ds_read_b64_tr_b16 a[104:105], v47 offset:32768
 s_add_u32 m0, s43, 0x10000
 v_mfma_f32_16x16x32_bf16 a[160:163], a[116:119], a[80:83], a[160:163]
 s_xor_b32 s34, s98, 0x500000
 v_mfma_f32_16x16x32_bf16 a[164:167], a[112:115], a[68:71], a[164:167]
 ds_read_b64_tr_b16 a[106:107], v47 offset:33024
 v_mfma_f32_16x16x32_bf16 a[164:167], a[116:119], a[84:87], a[164:167]
 buffer_load_dwordx4 v32, s[16:19], s34 offen offset:0 lds
 v_mfma_f32_16x16x32_bf16 a[168:171], a[112:115], a[72:75], a[168:171]
 ds_read_b64_tr_b16 a[108:109], v47 offset:40960
 v_mfma_f32_16x16x32_bf16 a[168:171], a[116:119], a[88:91], a[168:171]
 buffer_store_dwordx4 v[132:135], v56, s[20:23], s86 offen offset:128 sc1
 v_mfma_f32_16x16x32_bf16 a[172:175], a[112:115], a[76:79], a[172:175]
 ds_read_b64_tr_b16 a[110:111], v47 offset:41216
 v_mfma_f32_16x16x32_bf16 a[172:175], a[116:119], a[92:95], a[172:175]
 s_waitcnt lgkmcnt(8)
 v_mfma_f32_16x16x32_bf16 a[188:191], a[120:123], a[76:79], a[188:191]
 ds_read_b64_tr_b16 a[112:113], v46 offset:33792
 v_mfma_f32_16x16x32_bf16 a[188:191], a[124:127], a[92:95], a[188:191]
 buffer_load_dwordx4 v33, s[16:19], s34 offen offset:1024 lds
 v_mfma_f32_16x16x32_bf16 a[184:187], a[120:123], a[72:75], a[184:187]
 ds_read_b64_tr_b16 a[114:115], v46 offset:34048
 v_mfma_f32_16x16x32_bf16 a[184:187], a[124:127], a[88:91], a[184:187]
 buffer_load_dwordx4 v34, s[16:19], s34 offen offset:2048 lds
 v_mfma_f32_16x16x32_bf16 a[180:183], a[120:123], a[68:71], a[180:183]
 ds_read_b64_tr_b16 a[116:117], v46 offset:41984
 v_mfma_f32_16x16x32_bf16 a[180:183], a[124:127], a[84:87], a[180:183]
 v_mfma_f32_16x16x32_bf16 a[176:179], a[120:123], a[64:67], a[176:179]
 ds_read_b64_tr_b16 a[118:119], v46 offset:42240
 v_mfma_f32_16x16x32_bf16 a[176:179], a[124:127], a[80:83], a[176:179]
 s_waitcnt lgkmcnt(8)
 v_mfma_f32_16x16x32_bf16 v[80:83], a[96:99], a[64:67], v[80:83]
 ds_read_b64_tr_b16 a[120:121], v47 offset:33792
 v_mfma_f32_16x16x32_bf16 v[80:83], a[100:103], a[80:83], v[80:83]
 buffer_load_dwordx4 v35, s[16:19], s34 offen offset:3072 lds
 v_mfma_f32_16x16x32_bf16 v[84:87], a[96:99], a[68:71], v[84:87]
 ds_read_b64_tr_b16 a[122:123], v47 offset:34048
 v_mfma_f32_16x16x32_bf16 v[84:87], a[100:103], a[84:87], v[84:87]
 v_mfma_f32_16x16x32_bf16 v[88:91], a[96:99], a[72:75], v[88:91]
 ds_read_b64_tr_b16 a[124:125], v47 offset:41984
 v_mfma_f32_16x16x32_bf16 v[88:91], a[100:103], a[88:91], v[88:91]
 v_mfma_f32_16x16x32_bf16 v[92:95], a[96:99], a[76:79], v[92:95]
 ds_read_b64_tr_b16 a[126:127], v47 offset:42240
 v_mfma_f32_16x16x32_bf16 v[92:95], a[100:103], a[92:95], v[92:95]
 s_add_u32 m0, s44, 0x10000
 s_waitcnt lgkmcnt(8)
 v_mfma_f32_16x16x32_bf16 v[124:127], a[104:107], a[76:79], v[124:127]
 ds_read_b64_tr_b16 a[96:97], v46 offset:34816
 s_mov_b32 s35, 0x3c0000
 v_mfma_f32_16x16x32_bf16 v[124:127], a[108:111], a[92:95], v[124:127]
 buffer_load_dwordx4 v36, s[24:27], s35 offen offset:0 lds
 v_mfma_f32_16x16x32_bf16 v[120:123], a[104:107], a[72:75], v[120:123]
 ds_read_b64_tr_b16 a[98:99], v46 offset:35072
 v_mfma_f32_16x16x32_bf16 v[120:123], a[108:111], a[88:91], v[120:123]
 v_mfma_f32_16x16x32_bf16 v[116:119], a[104:107], a[68:71], v[116:119]
 ds_read_b64_tr_b16 a[100:101], v46 offset:43008
 v_mfma_f32_16x16x32_bf16 v[116:119], a[108:111], a[84:87], v[116:119]
 buffer_load_dwordx4 v37, s[24:27], s35 offen offset:1024 lds
 v_mfma_f32_16x16x32_bf16 v[112:115], a[104:107], a[64:67], v[112:115]
 ds_read_b64_tr_b16 a[102:103], v46 offset:43264
 v_mfma_f32_16x16x32_bf16 v[112:115], a[108:111], a[80:83], v[112:115]
 s_waitcnt lgkmcnt(8)
 v_mfma_f32_16x16x32_bf16 v[144:147], a[112:115], a[64:67], v[144:147]
 ds_read_b64_tr_b16 a[104:105], v47 offset:34816
 v_mfma_f32_16x16x32_bf16 v[144:147], a[116:119], a[80:83], v[144:147]
 v_mfma_f32_16x16x32_bf16 v[148:151], a[112:115], a[68:71], v[148:151]
 ds_read_b64_tr_b16 a[106:107], v47 offset:35072
 v_mfma_f32_16x16x32_bf16 v[148:151], a[116:119], a[84:87], v[148:151]
 buffer_load_dwordx4 v38, s[24:27], s35 offen offset:2048 lds
 v_mfma_f32_16x16x32_bf16 v[152:155], a[112:115], a[72:75], v[152:155]
 ds_read_b64_tr_b16 a[108:109], v47 offset:43008
 v_mfma_f32_16x16x32_bf16 v[152:155], a[116:119], a[88:91], v[152:155]
 v_mfma_f32_16x16x32_bf16 v[156:159], a[112:115], a[76:79], v[156:159]
 ds_read_b64_tr_b16 a[110:111], v47 offset:43264
 v_mfma_f32_16x16x32_bf16 v[156:159], a[116:119], a[92:95], v[156:159]
 s_waitcnt lgkmcnt(8)
 v_mfma_f32_16x16x32_bf16 v[188:191], a[120:123], a[76:79], v[188:191]
 v_mfma_f32_16x16x32_bf16 v[188:191], a[124:127], a[92:95], v[188:191]
 v_mfma_f32_16x16x32_bf16 v[184:187], a[120:123], a[72:75], v[184:187]
 v_mfma_f32_16x16x32_bf16 v[184:187], a[124:127], a[88:91], v[184:187]
 s_waitcnt lgkmcnt(0) vmcnt(19)
 s_barrier
 v_mfma_f32_16x16x32_bf16 v[180:183], a[120:123], a[68:71], v[180:183]
 ds_read_b64_tr_b16 a[112:113], v48 offset:0
 v_mfma_f32_16x16x32_bf16 v[180:183], a[124:127], a[84:87], v[180:183]
 ds_read_b64_tr_b16 a[114:115], v48 offset:512
 v_mfma_f32_16x16x32_bf16 v[176:179], a[120:123], a[64:67], v[176:179]
 ds_read_b64_tr_b16 a[116:117], v48 offset:4096
 buffer_store_dwordx4 v[136:139], v56, s[20:23], s87 offen offset:0 sc1
 v_mfma_f32_16x16x32_bf16 v[176:179], a[124:127], a[80:83], v[176:179]
 ds_read_b64_tr_b16 a[118:119], v48 offset:4608
 v_mfma_f32_16x16x32_bf16 a[192:195], a[64:67], a[96:99], a[192:195]
 ds_read_b128 a[224:227], v40 offset:8192
 v_mfma_f32_16x16x32_bf16 a[192:195], a[80:83], a[100:103], a[192:195]
 ds_read_b128 a[240:243], v41 offset:8192
 v_mfma_f32_16x16x32_bf16 a[196:199], a[68:71], a[96:99], a[196:199]
 ds_read_b128 a[228:231], v40 offset:10240
 v_mfma_f32_16x16x32_bf16 a[196:199], a[84:87], a[100:103], a[196:199]
 ds_read_b128 a[244:247], v41 offset:10240
 v_mfma_f32_16x16x32_bf16 a[200:203], a[72:75], a[96:99], a[200:203]
 ds_read_b128 a[232:235], v40 offset:12288
 v_mfma_f32_16x16x32_bf16 a[200:203], a[88:91], a[100:103], a[200:203]
 ds_read_b128 a[248:251], v41 offset:12288
 v_mfma_f32_16x16x32_bf16 a[204:207], a[76:79], a[96:99], a[204:207]
 ds_read_b128 a[236:239], v40 offset:14336
 v_mfma_f32_16x16x32_bf16 a[204:207], a[92:95], a[100:103], a[204:207]
 ds_read_b128 a[252:255], v41 offset:14336
 v_mfma_f32_16x16x32_bf16 a[220:223], a[76:79], a[104:107], a[220:223]
 ds_read_b64_tr_b16 a[120:121], v49 offset:0
 v_mfma_f32_16x16x32_bf16 a[220:223], a[92:95], a[108:111], a[220:223]
 ds_read_b64_tr_b16 a[122:123], v49 offset:512
 v_mfma_f32_16x16x32_bf16 a[216:219], a[72:75], a[104:107], a[216:219]
 ds_read_b64_tr_b16 a[124:125], v49 offset:4096
 v_mfma_f32_16x16x32_bf16 a[216:219], a[88:91], a[108:111], a[216:219]
 ds_read_b64_tr_b16 a[126:127], v49 offset:4608
 v_mfma_f32_16x16x32_bf16 a[212:215], a[68:71], a[104:107], a[212:215]
 ds_read_b64_tr_b16 a[96:97], v50 offset:0
 v_mfma_f32_16x16x32_bf16 a[212:215], a[84:87], a[108:111], a[212:215]
 ds_read_b64_tr_b16 a[98:99], v50 offset:512
 v_mfma_f32_16x16x32_bf16 a[208:211], a[64:67], a[104:107], a[208:211]
 ds_read_b64_tr_b16 a[100:101], v50 offset:4096
 v_mfma_f32_16x16x32_bf16 a[208:211], a[80:83], a[108:111], a[208:211]
 ds_read_b64_tr_b16 a[102:103], v50 offset:4608
F_step17:
 s_waitcnt lgkmcnt(8)
 v_mfma_f32_16x16x32_bf16 a[0:3], a[112:115], a[224:227], a[0:3]
 ds_read_b64_tr_b16 a[104:105], v51 offset:0
 v_mfma_f32_16x16x32_bf16 a[0:3], a[116:119], a[240:243], a[0:3]
 v_mfma_f32_16x16x32_bf16 a[4:7], a[112:115], a[228:231], a[4:7]
 ds_read_b64_tr_b16 a[106:107], v51 offset:512
 v_mfma_f32_16x16x32_bf16 a[4:7], a[116:119], a[244:247], a[4:7]
 s_add_u32 m0, s46, 8192
 s_xor_b32 s33, s99, 1408
 v_mfma_f32_16x16x32_bf16 a[8:11], a[112:115], a[232:235], a[8:11]
 ds_read_b64_tr_b16 a[108:109], v51 offset:4096
 v_mfma_f32_16x16x32_bf16 a[8:11], a[116:119], a[248:251], a[8:11]
 buffer_load_dwordx4 v24, s[28:31], s33 offen offset:0 lds
 v_mfma_f32_16x16x32_bf16 a[12:15], a[112:115], a[236:239], a[12:15]
 ds_read_b64_tr_b16 a[110:111], v51 offset:4608
 v_mfma_f32_16x16x32_bf16 a[12:15], a[116:119], a[252:255], a[12:15]
 s_waitcnt lgkmcnt(8)
 v_mfma_f32_16x16x32_bf16 a[28:31], a[120:123], a[236:239], a[28:31]
 ds_read_b64_tr_b16 a[112:113], v48 offset:8192
 v_mfma_f32_16x16x32_bf16 a[28:31], a[124:127], a[252:255], a[28:31]
 buffer_load_dwordx4 v25, s[28:31], s33 offen offset:1024 lds
 v_mfma_f32_16x16x32_bf16 a[24:27], a[120:123], a[232:235], a[24:27]
 ds_read_b64_tr_b16 a[114:115], v48 offset:8704
 v_mfma_f32_16x16x32_bf16 a[24:27], a[124:127], a[248:251], a[24:27]
 buffer_store_dwordx4 v[140:143], v56, s[20:23], s87 offen offset:128 sc1
 v_mfma_f32_16x16x32_bf16 a[20:23], a[120:123], a[228:231], a[20:23]
 ds_read_b64_tr_b16 a[116:117], v48 offset:12288
 v_mfma_f32_16x16x32_bf16 a[20:23], a[124:127], a[244:247], a[20:23]
 v_mfma_f32_16x16x32_bf16 a[16:19], a[120:123], a[224:227], a[16:19]
 ds_read_b64_tr_b16 a[118:119], v48 offset:12800
 v_mfma_f32_16x16x32_bf16 a[16:19], a[124:127], a[240:243], a[16:19]
 s_waitcnt lgkmcnt(8)
 v_mfma_f32_16x16x32_bf16 a[32:35], a[96:99], a[224:227], a[32:35]
 ds_read_b64_tr_b16 a[120:121], v49 offset:8192
 v_mfma_f32_16x16x32_bf16 a[32:35], a[100:103], a[240:243], a[32:35]
 buffer_load_dwordx4 v26, s[28:31], s33 offen offset:2048 lds
 v_mfma_f32_16x16x32_bf16 a[36:39], a[96:99], a[228:231], a[36:39]
 ds_read_b64_tr_b16 a[122:123], v49 offset:8704
 v_mfma_f32_16x16x32_bf16 a[36:39], a[100:103], a[244:247], a[36:39]
 v_mfma_f32_16x16x32_bf16 a[40:43], a[96:99], a[232:235], a[40:43]
 ds_read_b64_tr_b16 a[124:125], v49 offset:12288
 v_mfma_f32_16x16x32_bf16 a[40:43], a[100:103], a[248:251], a[40:43]
 buffer_load_dwordx4 v27, s[28:31], s33 offen offset:3072 lds
 v_mfma_f32_16x16x32_bf16 a[44:47], a[96:99], a[236:239], a[44:47]
 ds_read_b64_tr_b16 a[126:127], v49 offset:12800
 v_mfma_f32_16x16x32_bf16 a[44:47], a[100:103], a[252:255], a[44:47]
 s_waitcnt lgkmcnt(8)
 v_mfma_f32_16x16x32_bf16 a[60:63], a[104:107], a[236:239], a[60:63]
 ds_read_b64_tr_b16 a[96:97], v50 offset:8192
 v_mfma_f32_16x16x32_bf16 a[60:63], a[108:111], a[252:255], a[60:63]
 s_add_u32 m0, s46, 12288
 v_mfma_f32_16x16x32_bf16 a[56:59], a[104:107], a[232:235], a[56:59]
 ds_read_b64_tr_b16 a[98:99], v50 offset:8704
 v_mfma_f32_16x16x32_bf16 a[56:59], a[108:111], a[248:251], a[56:59]
 buffer_load_dwordx4 v28, s[28:31], s33 offen offset:0 lds
 v_mfma_f32_16x16x32_bf16 a[52:55], a[104:107], a[228:231], a[52:55]
 ds_read_b64_tr_b16 a[100:101], v50 offset:12288
 v_mfma_f32_16x16x32_bf16 a[52:55], a[108:111], a[244:247], a[52:55]
 v_mfma_f32_16x16x32_bf16 a[48:51], a[104:107], a[224:227], a[48:51]
 ds_read_b64_tr_b16 a[102:103], v50 offset:12800
 v_mfma_f32_16x16x32_bf16 a[48:51], a[108:111], a[240:243], a[48:51]
 s_waitcnt lgkmcnt(8)
 v_mfma_f32_16x16x32_bf16 a[128:131], a[112:115], a[224:227], a[128:131]
 ds_read_b64_tr_b16 a[104:105], v51 offset:8192
 v_mfma_f32_16x16x32_bf16 a[128:131], a[116:119], a[240:243], a[128:131]
 buffer_load_dwordx4 v29, s[28:31], s33 offen offset:1024 lds
 v_mfma_f32_16x16x32_bf16 a[132:135], a[112:115], a[228:231], a[132:135]
 ds_read_b64_tr_b16 a[106:107], v51 offset:8704
 v_mfma_f32_16x16x32_bf16 a[132:135], a[116:119], a[244:247], a[132:135]
 v_mfma_f32_16x16x32_bf16 a[136:139], a[112:115], a[232:235], a[136:139]
 ds_read_b64_tr_b16 a[108:109], v51 offset:12288
 v_mfma_f32_16x16x32_bf16 a[136:139], a[116:119], a[248:251], a[136:139]
 buffer_load_dwordx4 v30, s[28:31], s33 offen offset:2048 lds
 v_mfma_f32_16x16x32_bf16 a[140:143], a[112:115], a[236:239], a[140:143]
 ds_read_b64_tr_b16 a[110:111], v51 offset:12800
 v_mfma_f32_16x16x32_bf16 a[140:143], a[116:119], a[252:255], a[140:143]
 s_waitcnt lgkmcnt(8)
 v_mfma_f32_16x16x32_bf16 a[156:159], a[120:123], a[236:239], a[156:159]
 ds_read_b64_tr_b16 a[112:113], v52 offset:0
 v_mfma_f32_16x16x32_bf16 a[156:159], a[124:127], a[252:255], a[156:159]
 v_mfma_f32_16x16x32_bf16 a[152:155], a[120:123], a[232:235], a[152:155]
 ds_read_b64_tr_b16 a[114:115], v52 offset:256
 v_mfma_f32_16x16x32_bf16 a[152:155], a[124:127], a[248:251], a[152:155]
 buffer_load_dwordx4 v31, s[28:31], s33 offen offset:3072 lds
 v_mfma_f32_16x16x32_bf16 a[148:151], a[120:123], a[228:231], a[148:151]
 ds_read_b64_tr_b16 a[116:117], v52 offset:8192
 v_mfma_f32_16x16x32_bf16 a[148:151], a[124:127], a[244:247], a[148:151]
 v_mfma_f32_16x16x32_bf16 a[144:147], a[120:123], a[224:227], a[144:147]
 ds_read_b64_tr_b16 a[118:119], v52 offset:8448
 v_mfma_f32_16x16x32_bf16 a[144:147], a[124:127], a[240:243], a[144:147]
 s_waitcnt lgkmcnt(8)
 v_mfma_f32_16x16x32_bf16 a[160:163], a[96:99], a[224:227], a[160:163]
 ds_read_b64_tr_b16 a[120:121], v53 offset:0
 s_add_u32 m0, s43, 0x18000
 v_mfma_f32_16x16x32_bf16 a[160:163], a[100:103], a[240:243], a[160:163]
 s_xor_b32 s34, s98, 0x580000
 v_mfma_f32_16x16x32_bf16 a[164:167], a[96:99], a[228:231], a[164:167]
 ds_read_b64_tr_b16 a[122:123], v53 offset:256
 v_mfma_f32_16x16x32_bf16 a[164:167], a[100:103], a[244:247], a[164:167]
 buffer_load_dwordx4 v32, s[16:19], s34 offen offset:0 lds
 v_mfma_f32_16x16x32_bf16 a[168:171], a[96:99], a[232:235], a[168:171]
 ds_read_b64_tr_b16 a[124:125], v53 offset:8192
 v_mfma_f32_16x16x32_bf16 a[168:171], a[100:103], a[248:251], a[168:171]
 buffer_store_dwordx4 v[160:163], v56, s[20:23], s86 offen offset:2048 sc1
 v_mfma_f32_16x16x32_bf16 a[172:175], a[96:99], a[236:239], a[172:175]
 ds_read_b64_tr_b16 a[126:127], v53 offset:8448
 v_mfma_f32_16x16x32_bf16 a[172:175], a[100:103], a[252:255], a[172:175]
 s_waitcnt lgkmcnt(8)
 v_mfma_f32_16x16x32_bf16 a[188:191], a[104:107], a[236:239], a[188:191]
 ds_read_b64_tr_b16 a[96:97], v52 offset:1024
 v_mfma_f32_16x16x32_bf16 a[188:191], a[108:111], a[252:255], a[188:191]
 buffer_load_dwordx4 v33, s[16:19], s34 offen offset:1024 lds
 v_mfma_f32_16x16x32_bf16 a[184:187], a[104:107], a[232:235], a[184:187]
 ds_read_b64_tr_b16 a[98:99], v52 offset:1280
 v_mfma_f32_16x16x32_bf16 a[184:187], a[108:111], a[248:251], a[184:187]
 buffer_load_dwordx4 v34, s[16:19], s34 offen offset:2048 lds
 v_mfma_f32_16x16x32_bf16 a[180:183], a[104:107], a[228:231], a[180:183]
 ds_read_b64_tr_b16 a[100:101], v52 offset:9216
 v_mfma_f32_16x16x32_bf16 a[180:183], a[108:111], a[244:247], a[180:183]
 v_mfma_f32_16x16x32_bf16 a[176:179], a[104:107], a[224:227], a[176:179]
 ds_read_b64_tr_b16 a[102:103], v52 offset:9472
 v_mfma_f32_16x16x32_bf16 a[176:179], a[108:111], a[240:243], a[176:179]
 s_waitcnt lgkmcnt(8)
 v_mfma_f32_16x16x32_bf16 v[80:83], a[112:115], a[224:227], v[80:83]
 ds_read_b64_tr_b16 a[104:105], v53 offset:1024
 v_mfma_f32_16x16x32_bf16 v[80:83], a[116:119], a[240:243], v[80:83]
 buffer_load_dwordx4 v35, s[16:19], s34 offen offset:3072 lds
 v_mfma_f32_16x16x32_bf16 v[84:87], a[112:115], a[228:231], v[84:87]
 ds_read_b64_tr_b16 a[106:107], v53 offset:1280
 v_mfma_f32_16x16x32_bf16 v[84:87], a[116:119], a[244:247], v[84:87]
 v_mfma_f32_16x16x32_bf16 v[88:91], a[112:115], a[232:235], v[88:91]
 ds_read_b64_tr_b16 a[108:109], v53 offset:9216
 v_mfma_f32_16x16x32_bf16 v[88:91], a[116:119], a[248:251], v[88:91]
 v_mfma_f32_16x16x32_bf16 v[92:95], a[112:115], a[236:239], v[92:95]
 ds_read_b64_tr_b16 a[110:111], v53 offset:9472
 v_mfma_f32_16x16x32_bf16 v[92:95], a[116:119], a[252:255], v[92:95]
 s_add_u32 m0, s44, 0x18000
 s_waitcnt lgkmcnt(8)
 v_mfma_f32_16x16x32_bf16 v[124:127], a[120:123], a[236:239], v[124:127]
 ds_read_b64_tr_b16 a[112:113], v52 offset:2048
 s_mov_b32 s35, 0x420000
 v_mfma_f32_16x16x32_bf16 v[124:127], a[124:127], a[252:255], v[124:127]
 buffer_load_dwordx4 v36, s[24:27], s35 offen offset:0 lds
 v_mfma_f32_16x16x32_bf16 v[120:123], a[120:123], a[232:235], v[120:123]
 ds_read_b64_tr_b16 a[114:115], v52 offset:2304
 v_mfma_f32_16x16x32_bf16 v[120:123], a[124:127], a[248:251], v[120:123]
 v_mfma_f32_16x16x32_bf16 v[116:119], a[120:123], a[228:231], v[116:119]
 ds_read_b64_tr_b16 a[116:117], v52 offset:10240
 v_mfma_f32_16x16x32_bf16 v[116:119], a[124:127], a[244:247], v[116:119]
 buffer_load_dwordx4 v37, s[24:27], s35 offen offset:1024 lds
 v_mfma_f32_16x16x32_bf16 v[112:115], a[120:123], a[224:227], v[112:115]
 ds_read_b64_tr_b16 a[118:119], v52 offset:10496
 v_mfma_f32_16x16x32_bf16 v[112:115], a[124:127], a[240:243], v[112:115]
 s_waitcnt lgkmcnt(8)
 v_mfma_f32_16x16x32_bf16 v[144:147], a[96:99], a[224:227], v[144:147]
 ds_read_b64_tr_b16 a[120:121], v53 offset:2048
 v_mfma_f32_16x16x32_bf16 v[144:147], a[100:103], a[240:243], v[144:147]
 v_mfma_f32_16x16x32_bf16 v[148:151], a[96:99], a[228:231], v[148:151]
 ds_read_b64_tr_b16 a[122:123], v53 offset:2304
 v_mfma_f32_16x16x32_bf16 v[148:151], a[100:103], a[244:247], v[148:151]
 buffer_load_dwordx4 v38, s[24:27], s35 offen offset:2048 lds
 v_mfma_f32_16x16x32_bf16 v[152:155], a[96:99], a[232:235], v[152:155]
 ds_read_b64_tr_b16 a[124:125], v53 offset:10240
 v_mfma_f32_16x16x32_bf16 v[152:155], a[100:103], a[248:251], v[152:155]
 v_mfma_f32_16x16x32_bf16 v[156:159], a[96:99], a[236:239], v[156:159]
 ds_read_b64_tr_b16 a[126:127], v53 offset:10496
 v_mfma_f32_16x16x32_bf16 v[156:159], a[100:103], a[252:255], v[156:159]
 s_waitcnt lgkmcnt(8)
 v_mfma_f32_16x16x32_bf16 v[188:191], a[104:107], a[236:239], v[188:191]
 v_mfma_f32_16x16x32_bf16 v[188:191], a[108:111], a[252:255], v[188:191]
 v_mfma_f32_16x16x32_bf16 v[184:187], a[104:107], a[232:235], v[184:187]
 v_mfma_f32_16x16x32_bf16 v[184:187], a[108:111], a[248:251], v[184:187]
 s_waitcnt lgkmcnt(0) vmcnt(18)
 s_barrier
 v_mfma_f32_16x16x32_bf16 v[180:183], a[104:107], a[228:231], v[180:183]
 ds_read_b64_tr_b16 a[96:97], v42 offset:0
 v_mfma_f32_16x16x32_bf16 v[180:183], a[108:111], a[244:247], v[180:183]
 ds_read_b64_tr_b16 a[98:99], v42 offset:512
 v_mfma_f32_16x16x32_bf16 v[176:179], a[104:107], a[224:227], v[176:179]
 ds_read_b64_tr_b16 a[100:101], v42 offset:4096
 buffer_store_dwordx4 v[164:167], v56, s[20:23], s86 offen offset:2176 sc1
 v_mfma_f32_16x16x32_bf16 v[176:179], a[108:111], a[240:243], v[176:179]
 ds_read_b64_tr_b16 a[102:103], v42 offset:4608
 v_mfma_f32_16x16x32_bf16 a[192:195], a[224:227], a[112:115], a[192:195]
 ds_read_b128 a[64:67], v40 offset:0
 v_mfma_f32_16x16x32_bf16 a[192:195], a[240:243], a[116:119], a[192:195]
 ds_read_b128 a[80:83], v41 offset:0
 v_mfma_f32_16x16x32_bf16 a[196:199], a[228:231], a[112:115], a[196:199]
 ds_read_b128 a[68:71], v40 offset:2048
 v_mfma_f32_16x16x32_bf16 a[196:199], a[244:247], a[116:119], a[196:199]
 ds_read_b128 a[84:87], v41 offset:2048
 v_mfma_f32_16x16x32_bf16 a[200:203], a[232:235], a[112:115], a[200:203]
 ds_read_b128 a[72:75], v40 offset:4096
 v_mfma_f32_16x16x32_bf16 a[200:203], a[248:251], a[116:119], a[200:203]
 ds_read_b128 a[88:91], v41 offset:4096
 v_mfma_f32_16x16x32_bf16 a[204:207], a[236:239], a[112:115], a[204:207]
 ds_read_b128 a[76:79], v40 offset:6144
 v_mfma_f32_16x16x32_bf16 a[204:207], a[252:255], a[116:119], a[204:207]
 ds_read_b128 a[92:95], v41 offset:6144
 v_mfma_f32_16x16x32_bf16 a[220:223], a[236:239], a[120:123], a[220:223]
 ds_read_b64_tr_b16 a[104:105], v43 offset:0
 v_mfma_f32_16x16x32_bf16 a[220:223], a[252:255], a[124:127], a[220:223]
 ds_read_b64_tr_b16 a[106:107], v43 offset:512
 v_mfma_f32_16x16x32_bf16 a[216:219], a[232:235], a[120:123], a[216:219]
 ds_read_b64_tr_b16 a[108:109], v43 offset:4096
 v_mfma_f32_16x16x32_bf16 a[216:219], a[248:251], a[124:127], a[216:219]
 ds_read_b64_tr_b16 a[110:111], v43 offset:4608
 v_mfma_f32_16x16x32_bf16 a[212:215], a[228:231], a[120:123], a[212:215]
 ds_read_b64_tr_b16 a[112:113], v44 offset:0
 v_mfma_f32_16x16x32_bf16 a[212:215], a[244:247], a[124:127], a[212:215]
 ds_read_b64_tr_b16 a[114:115], v44 offset:512
 v_mfma_f32_16x16x32_bf16 a[208:211], a[224:227], a[120:123], a[208:211]
 ds_read_b64_tr_b16 a[116:117], v44 offset:4096
 v_mfma_f32_16x16x32_bf16 a[208:211], a[240:243], a[124:127], a[208:211]
 ds_read_b64_tr_b16 a[118:119], v44 offset:4608
F_step18:
 s_waitcnt lgkmcnt(8)
 v_mfma_f32_16x16x32_bf16 a[0:3], a[96:99], a[64:67], a[0:3]
 ds_read_b64_tr_b16 a[120:121], v45 offset:0
 v_mfma_f32_16x16x32_bf16 a[0:3], a[100:103], a[80:83], a[0:3]
 v_mfma_f32_16x16x32_bf16 a[4:7], a[96:99], a[68:71], a[4:7]
 ds_read_b64_tr_b16 a[122:123], v45 offset:512
 v_mfma_f32_16x16x32_bf16 a[4:7], a[100:103], a[84:87], a[4:7]
 s_add_u32 m0, s46, 0
 s_xor_b32 s33, s99, 1536
 v_mfma_f32_16x16x32_bf16 a[8:11], a[96:99], a[72:75], a[8:11]
 ds_read_b64_tr_b16 a[124:125], v45 offset:4096
 v_mfma_f32_16x16x32_bf16 a[8:11], a[100:103], a[88:91], a[8:11]
 buffer_load_dwordx4 v24, s[28:31], s33 offen offset:0 lds
 v_mfma_f32_16x16x32_bf16 a[12:15], a[96:99], a[76:79], a[12:15]
 ds_read_b64_tr_b16 a[126:127], v45 offset:4608
 v_mfma_f32_16x16x32_bf16 a[12:15], a[100:103], a[92:95], a[12:15]
 s_waitcnt lgkmcnt(8)
 v_mfma_f32_16x16x32_bf16 a[28:31], a[104:107], a[76:79], a[28:31]
 ds_read_b64_tr_b16 a[96:97], v42 offset:8192
 v_mfma_f32_16x16x32_bf16 a[28:31], a[108:111], a[92:95], a[28:31]
 buffer_load_dwordx4 v25, s[28:31], s33 offen offset:1024 lds
 v_mfma_f32_16x16x32_bf16 a[24:27], a[104:107], a[72:75], a[24:27]
 ds_read_b64_tr_b16 a[98:99], v42 offset:8704
 v_mfma_f32_16x16x32_bf16 a[24:27], a[108:111], a[88:91], a[24:27]
 buffer_store_dwordx4 v[168:171], v56, s[20:23], s87 offen offset:2048 sc1
 v_mfma_f32_16x16x32_bf16 a[20:23], a[104:107], a[68:71], a[20:23]
 ds_read_b64_tr_b16 a[100:101], v42 offset:12288
 v_mfma_f32_16x16x32_bf16 a[20:23], a[108:111], a[84:87], a[20:23]
 v_mfma_f32_16x16x32_bf16 a[16:19], a[104:107], a[64:67], a[16:19]
 ds_read_b64_tr_b16 a[102:103], v42 offset:12800
 v_mfma_f32_16x16x32_bf16 a[16:19], a[108:111], a[80:83], a[16:19]
 s_waitcnt lgkmcnt(8)
 v_mfma_f32_16x16x32_bf16 a[32:35], a[112:115], a[64:67], a[32:35]
 ds_read_b64_tr_b16 a[104:105], v43 offset:8192
 v_mfma_f32_16x16x32_bf16 a[32:35], a[116:119], a[80:83], a[32:35]
 buffer_load_dwordx4 v26, s[28:31], s33 offen offset:2048 lds
 v_mfma_f32_16x16x32_bf16 a[36:39], a[112:115], a[68:71], a[36:39]
 ds_read_b64_tr_b16 a[106:107], v43 offset:8704
 v_mfma_f32_16x16x32_bf16 a[36:39], a[116:119], a[84:87], a[36:39]
 v_mfma_f32_16x16x32_bf16 a[40:43], a[112:115], a[72:75], a[40:43]
 ds_read_b64_tr_b16 a[108:109], v43 offset:12288
 v_mfma_f32_16x16x32_bf16 a[40:43], a[116:119], a[88:91], a[40:43]
 buffer_load_dwordx4 v27, s[28:31], s33 offen offset:3072 lds
 v_mfma_f32_16x16x32_bf16 a[44:47], a[112:115], a[76:79], a[44:47]
 ds_read_b64_tr_b16 a[110:111], v43 offset:12800
 v_mfma_f32_16x16x32_bf16 a[44:47], a[116:119], a[92:95], a[44:47]
 s_waitcnt lgkmcnt(8)
 v_mfma_f32_16x16x32_bf16 a[60:63], a[120:123], a[76:79], a[60:63]
 ds_read_b64_tr_b16 a[112:113], v44 offset:8192
 v_mfma_f32_16x16x32_bf16 a[60:63], a[124:127], a[92:95], a[60:63]
 s_add_u32 m0, s46, 4096
 v_mfma_f32_16x16x32_bf16 a[56:59], a[120:123], a[72:75], a[56:59]
 ds_read_b64_tr_b16 a[114:115], v44 offset:8704
 v_mfma_f32_16x16x32_bf16 a[56:59], a[124:127], a[88:91], a[56:59]
 buffer_load_dwordx4 v28, s[28:31], s33 offen offset:0 lds
 v_mfma_f32_16x16x32_bf16 a[52:55], a[120:123], a[68:71], a[52:55]
 ds_read_b64_tr_b16 a[116:117], v44 offset:12288
 v_mfma_f32_16x16x32_bf16 a[52:55], a[124:127], a[84:87], a[52:55]
 v_mfma_f32_16x16x32_bf16 a[48:51], a[120:123], a[64:67], a[48:51]
 ds_read_b64_tr_b16 a[118:119], v44 offset:12800
 v_mfma_f32_16x16x32_bf16 a[48:51], a[124:127], a[80:83], a[48:51]
 s_waitcnt lgkmcnt(8)
 v_mfma_f32_16x16x32_bf16 a[128:131], a[96:99], a[64:67], a[128:131]
 ds_read_b64_tr_b16 a[120:121], v45 offset:8192
 v_mfma_f32_16x16x32_bf16 a[128:131], a[100:103], a[80:83], a[128:131]
 buffer_load_dwordx4 v29, s[28:31], s33 offen offset:1024 lds
 v_mfma_f32_16x16x32_bf16 a[132:135], a[96:99], a[68:71], a[132:135]
 ds_read_b64_tr_b16 a[122:123], v45 offset:8704
 v_mfma_f32_16x16x32_bf16 a[132:135], a[100:103], a[84:87], a[132:135]
 v_mfma_f32_16x16x32_bf16 a[136:139], a[96:99], a[72:75], a[136:139]
 ds_read_b64_tr_b16 a[124:125], v45 offset:12288
 v_mfma_f32_16x16x32_bf16 a[136:139], a[100:103], a[88:91], a[136:139]
 buffer_load_dwordx4 v30, s[28:31], s33 offen offset:2048 lds
 v_mfma_f32_16x16x32_bf16 a[140:143], a[96:99], a[76:79], a[140:143]
 ds_read_b64_tr_b16 a[126:127], v45 offset:12800
 v_mfma_f32_16x16x32_bf16 a[140:143], a[100:103], a[92:95], a[140:143]
 s_waitcnt lgkmcnt(8)
 v_mfma_f32_16x16x32_bf16 a[156:159], a[104:107], a[76:79], a[156:159]
 ds_read_b64_tr_b16 a[96:97], v46 offset:0
 v_mfma_f32_16x16x32_bf16 a[156:159], a[108:111], a[92:95], a[156:159]
 v_mfma_f32_16x16x32_bf16 a[152:155], a[104:107], a[72:75], a[152:155]
 ds_read_b64_tr_b16 a[98:99], v46 offset:256
 v_mfma_f32_16x16x32_bf16 a[152:155], a[108:111], a[88:91], a[152:155]
 buffer_load_dwordx4 v31, s[28:31], s33 offen offset:3072 lds
 v_mfma_f32_16x16x32_bf16 a[148:151], a[104:107], a[68:71], a[148:151]
 ds_read_b64_tr_b16 a[100:101], v46 offset:8192
 v_mfma_f32_16x16x32_bf16 a[148:151], a[108:111], a[84:87], a[148:151]
 v_mfma_f32_16x16x32_bf16 a[144:147], a[104:107], a[64:67], a[144:147]
 ds_read_b64_tr_b16 a[102:103], v46 offset:8448
 v_mfma_f32_16x16x32_bf16 a[144:147], a[108:111], a[80:83], a[144:147]
 s_waitcnt lgkmcnt(8)
 v_mfma_f32_16x16x32_bf16 a[160:163], a[112:115], a[64:67], a[160:163]
 ds_read_b64_tr_b16 a[104:105], v47 offset:0
 s_add_u32 m0, s43, 0x20000
 v_mfma_f32_16x16x32_bf16 a[160:163], a[116:119], a[80:83], a[160:163]
 s_xor_b32 s34, s98, 0x600000
 v_mfma_f32_16x16x32_bf16 a[164:167], a[112:115], a[68:71], a[164:167]
 ds_read_b64_tr_b16 a[106:107], v47 offset:256
 v_mfma_f32_16x16x32_bf16 a[164:167], a[116:119], a[84:87], a[164:167]
 buffer_load_dwordx4 v32, s[16:19], s34 offen offset:0 lds
 v_mfma_f32_16x16x32_bf16 a[168:171], a[112:115], a[72:75], a[168:171]
 ds_read_b64_tr_b16 a[108:109], v47 offset:8192
 v_mfma_f32_16x16x32_bf16 a[168:171], a[116:119], a[88:91], a[168:171]
 v_mfma_f32_16x16x32_bf16 a[172:175], a[112:115], a[76:79], a[172:175]
 ds_read_b64_tr_b16 a[110:111], v47 offset:8448
 v_mfma_f32_16x16x32_bf16 a[172:175], a[116:119], a[92:95], a[172:175]
 s_waitcnt lgkmcnt(8)
 v_mfma_f32_16x16x32_bf16 a[188:191], a[120:123], a[76:79], a[188:191]
 ds_read_b64_tr_b16 a[112:113], v46 offset:1024
 v_mfma_f32_16x16x32_bf16 a[188:191], a[124:127], a[92:95], a[188:191]
 buffer_load_dwordx4 v33, s[16:19], s34 offen offset:1024 lds
 v_mfma_f32_16x16x32_bf16 a[184:187], a[120:123], a[72:75], a[184:187]
 ds_read_b64_tr_b16 a[114:115], v46 offset:1280
 v_mfma_f32_16x16x32_bf16 a[184:187], a[124:127], a[88:91], a[184:187]
 buffer_load_dwordx4 v34, s[16:19], s34 offen offset:2048 lds
 v_mfma_f32_16x16x32_bf16 a[180:183], a[120:123], a[68:71], a[180:183]
 ds_read_b64_tr_b16 a[116:117], v46 offset:9216
 v_mfma_f32_16x16x32_bf16 a[180:183], a[124:127], a[84:87], a[180:183]
 v_mfma_f32_16x16x32_bf16 a[176:179], a[120:123], a[64:67], a[176:179]
 ds_read_b64_tr_b16 a[118:119], v46 offset:9472
 v_mfma_f32_16x16x32_bf16 a[176:179], a[124:127], a[80:83], a[176:179]
 s_waitcnt lgkmcnt(8)
 v_mfma_f32_16x16x32_bf16 v[80:83], a[96:99], a[64:67], v[80:83]
 ds_read_b64_tr_b16 a[120:121], v47 offset:1024
 v_mfma_f32_16x16x32_bf16 v[80:83], a[100:103], a[80:83], v[80:83]
 buffer_load_dwordx4 v35, s[16:19], s34 offen offset:3072 lds
 v_mfma_f32_16x16x32_bf16 v[84:87], a[96:99], a[68:71], v[84:87]
 ds_read_b64_tr_b16 a[122:123], v47 offset:1280
 v_mfma_f32_16x16x32_bf16 v[84:87], a[100:103], a[84:87], v[84:87]
 v_mfma_f32_16x16x32_bf16 v[88:91], a[96:99], a[72:75], v[88:91]
 ds_read_b64_tr_b16 a[124:125], v47 offset:9216
 v_mfma_f32_16x16x32_bf16 v[88:91], a[100:103], a[88:91], v[88:91]
 v_mfma_f32_16x16x32_bf16 v[92:95], a[96:99], a[76:79], v[92:95]
 ds_read_b64_tr_b16 a[126:127], v47 offset:9472
 v_mfma_f32_16x16x32_bf16 v[92:95], a[100:103], a[92:95], v[92:95]
 s_add_u32 m0, s44, 0x20000
 s_waitcnt lgkmcnt(8)
 v_mfma_f32_16x16x32_bf16 v[124:127], a[104:107], a[76:79], v[124:127]
 ds_read_b64_tr_b16 a[96:97], v46 offset:2048
 s_mov_b32 s35, 0x480000
 v_mfma_f32_16x16x32_bf16 v[124:127], a[108:111], a[92:95], v[124:127]
 buffer_load_dwordx4 v36, s[24:27], s35 offen offset:0 lds
 v_mfma_f32_16x16x32_bf16 v[120:123], a[104:107], a[72:75], v[120:123]
 ds_read_b64_tr_b16 a[98:99], v46 offset:2304
 v_mfma_f32_16x16x32_bf16 v[120:123], a[108:111], a[88:91], v[120:123]
 v_mfma_f32_16x16x32_bf16 v[116:119], a[104:107], a[68:71], v[116:119]
 ds_read_b64_tr_b16 a[100:101], v46 offset:10240
 v_mfma_f32_16x16x32_bf16 v[116:119], a[108:111], a[84:87], v[116:119]
 buffer_load_dwordx4 v37, s[24:27], s35 offen offset:1024 lds
 v_mfma_f32_16x16x32_bf16 v[112:115], a[104:107], a[64:67], v[112:115]
 ds_read_b64_tr_b16 a[102:103], v46 offset:10496
 v_mfma_f32_16x16x32_bf16 v[112:115], a[108:111], a[80:83], v[112:115]
 s_waitcnt lgkmcnt(8)
 v_mfma_f32_16x16x32_bf16 v[144:147], a[112:115], a[64:67], v[144:147]
 ds_read_b64_tr_b16 a[104:105], v47 offset:2048
 v_mfma_f32_16x16x32_bf16 v[144:147], a[116:119], a[80:83], v[144:147]
 v_mfma_f32_16x16x32_bf16 v[148:151], a[112:115], a[68:71], v[148:151]
 ds_read_b64_tr_b16 a[106:107], v47 offset:2304
 v_mfma_f32_16x16x32_bf16 v[148:151], a[116:119], a[84:87], v[148:151]
 buffer_load_dwordx4 v38, s[24:27], s35 offen offset:2048 lds
 v_mfma_f32_16x16x32_bf16 v[152:155], a[112:115], a[72:75], v[152:155]
 ds_read_b64_tr_b16 a[108:109], v47 offset:10240
 v_mfma_f32_16x16x32_bf16 v[152:155], a[116:119], a[88:91], v[152:155]
 v_mfma_f32_16x16x32_bf16 v[156:159], a[112:115], a[76:79], v[156:159]
 ds_read_b64_tr_b16 a[110:111], v47 offset:10496
 v_mfma_f32_16x16x32_bf16 v[156:159], a[116:119], a[92:95], v[156:159]
 s_waitcnt lgkmcnt(8)
 v_mfma_f32_16x16x32_bf16 v[188:191], a[120:123], a[76:79], v[188:191]
 v_mfma_f32_16x16x32_bf16 v[188:191], a[124:127], a[92:95], v[188:191]
 v_mfma_f32_16x16x32_bf16 v[184:187], a[120:123], a[72:75], v[184:187]
 v_mfma_f32_16x16x32_bf16 v[184:187], a[124:127], a[88:91], v[184:187]
 s_waitcnt lgkmcnt(0) vmcnt(17)
 s_barrier
 v_mfma_f32_16x16x32_bf16 v[180:183], a[120:123], a[68:71], v[180:183]
 ds_read_b64_tr_b16 a[112:113], v42 offset:32768
 v_mfma_f32_16x16x32_bf16 v[180:183], a[124:127], a[84:87], v[180:183]
 ds_read_b64_tr_b16 a[114:115], v42 offset:33280
 v_mfma_f32_16x16x32_bf16 v[176:179], a[120:123], a[64:67], v[176:179]
 ds_read_b64_tr_b16 a[116:117], v42 offset:36864
 buffer_store_dwordx4 v[172:175], v56, s[20:23], s87 offen offset:2176 sc1
 v_mfma_f32_16x16x32_bf16 v[176:179], a[124:127], a[80:83], v[176:179]
 ds_read_b64_tr_b16 a[118:119], v42 offset:37376
 v_mfma_f32_16x16x32_bf16 a[192:195], a[64:67], a[96:99], a[192:195]
 ds_read_b128 a[224:227], v40 offset:8192
 v_mfma_f32_16x16x32_bf16 a[192:195], a[80:83], a[100:103], a[192:195]
 ds_read_b128 a[240:243], v41 offset:8192
 v_mfma_f32_16x16x32_bf16 a[196:199], a[68:71], a[96:99], a[196:199]
 ds_read_b128 a[228:231], v40 offset:10240
 v_mfma_f32_16x16x32_bf16 a[196:199], a[84:87], a[100:103], a[196:199]
 ds_read_b128 a[244:247], v41 offset:10240
 v_mfma_f32_16x16x32_bf16 a[200:203], a[72:75], a[96:99], a[200:203]
 ds_read_b128 a[232:235], v40 offset:12288
 v_mfma_f32_16x16x32_bf16 a[200:203], a[88:91], a[100:103], a[200:203]
 ds_read_b128 a[248:251], v41 offset:12288
 v_mfma_f32_16x16x32_bf16 a[204:207], a[76:79], a[96:99], a[204:207]
 ds_read_b128 a[236:239], v40 offset:14336
 v_mfma_f32_16x16x32_bf16 a[204:207], a[92:95], a[100:103], a[204:207]
 ds_read_b128 a[252:255], v41 offset:14336
 v_mfma_f32_16x16x32_bf16 a[220:223], a[76:79], a[104:107], a[220:223]
 ds_read_b64_tr_b16 a[120:121], v43 offset:32768
 v_mfma_f32_16x16x32_bf16 a[220:223], a[92:95], a[108:111], a[220:223]
 ds_read_b64_tr_b16 a[122:123], v43 offset:33280
 v_mfma_f32_16x16x32_bf16 a[216:219], a[72:75], a[104:107], a[216:219]
 ds_read_b64_tr_b16 a[124:125], v43 offset:36864
 v_mfma_f32_16x16x32_bf16 a[216:219], a[88:91], a[108:111], a[216:219]
 ds_read_b64_tr_b16 a[126:127], v43 offset:37376
 v_mfma_f32_16x16x32_bf16 a[212:215], a[68:71], a[104:107], a[212:215]
 ds_read_b64_tr_b16 a[96:97], v44 offset:32768
 v_mfma_f32_16x16x32_bf16 a[212:215], a[84:87], a[108:111], a[212:215]
 ds_read_b64_tr_b16 a[98:99], v44 offset:33280
 v_mfma_f32_16x16x32_bf16 a[208:211], a[64:67], a[104:107], a[208:211]
 ds_read_b64_tr_b16 a[100:101], v44 offset:36864
 v_mfma_f32_16x16x32_bf16 a[208:211], a[80:83], a[108:111], a[208:211]
 ds_read_b64_tr_b16 a[102:103], v44 offset:37376
F_step19:
 s_waitcnt lgkmcnt(8)
 v_mfma_f32_16x16x32_bf16 a[0:3], a[112:115], a[224:227], a[0:3]
 ds_read_b64_tr_b16 a[104:105], v45 offset:32768
 v_mfma_f32_16x16x32_bf16 a[0:3], a[116:119], a[240:243], a[0:3]
 v_mfma_f32_16x16x32_bf16 a[4:7], a[112:115], a[228:231], a[4:7]
 ds_read_b64_tr_b16 a[106:107], v45 offset:33280
 v_mfma_f32_16x16x32_bf16 a[4:7], a[116:119], a[244:247], a[4:7]
 s_add_u32 m0, s46, 8192
 s_xor_b32 s33, s99, 1664
 v_mfma_f32_16x16x32_bf16 a[8:11], a[112:115], a[232:235], a[8:11]
 ds_read_b64_tr_b16 a[108:109], v45 offset:36864
 v_mfma_f32_16x16x32_bf16 a[8:11], a[116:119], a[248:251], a[8:11]
 buffer_load_dwordx4 v24, s[28:31], s33 offen offset:0 lds
 v_mfma_f32_16x16x32_bf16 a[12:15], a[112:115], a[236:239], a[12:15]
 ds_read_b64_tr_b16 a[110:111], v45 offset:37376
 v_mfma_f32_16x16x32_bf16 a[12:15], a[116:119], a[252:255], a[12:15]
 s_waitcnt lgkmcnt(8)
 v_mfma_f32_16x16x32_bf16 a[28:31], a[120:123], a[236:239], a[28:31]
 ds_read_b64_tr_b16 a[112:113], v42 offset:40960
 v_mfma_f32_16x16x32_bf16 a[28:31], a[124:127], a[252:255], a[28:31]
 buffer_load_dwordx4 v25, s[28:31], s33 offen offset:1024 lds
 v_mfma_f32_16x16x32_bf16 a[24:27], a[120:123], a[232:235], a[24:27]
 ds_read_b64_tr_b16 a[114:115], v42 offset:41472
 v_mfma_f32_16x16x32_bf16 a[24:27], a[124:127], a[248:251], a[24:27]
 v_mfma_f32_16x16x32_bf16 a[20:23], a[120:123], a[228:231], a[20:23]
 ds_read_b64_tr_b16 a[116:117], v42 offset:45056
 v_mfma_f32_16x16x32_bf16 a[20:23], a[124:127], a[244:247], a[20:23]
 buffer_load_dwordx4 v26, s[28:31], s33 offen offset:2048 lds
 v_mfma_f32_16x16x32_bf16 a[16:19], a[120:123], a[224:227], a[16:19]
 ds_read_b64_tr_b16 a[118:119], v42 offset:45568
 v_mfma_f32_16x16x32_bf16 a[16:19], a[124:127], a[240:243], a[16:19]
 s_waitcnt lgkmcnt(8)
 v_mfma_f32_16x16x32_bf16 a[32:35], a[96:99], a[224:227], a[32:35]
 ds_read_b64_tr_b16 a[120:121], v43 offset:40960
 v_mfma_f32_16x16x32_bf16 a[32:35], a[100:103], a[240:243], a[32:35]
 v_mfma_f32_16x16x32_bf16 a[36:39], a[96:99], a[228:231], a[36:39]
 ds_read_b64_tr_b16 a[122:123], v43 offset:41472
 v_mfma_f32_16x16x32_bf16 a[36:39], a[100:103], a[244:247], a[36:39]
 buffer_load_dwordx4 v27, s[28:31], s33 offen offset:3072 lds
 v_mfma_f32_16x16x32_bf16 a[40:43], a[96:99], a[232:235], a[40:43]
 ds_read_b64_tr_b16 a[124:125], v43 offset:45056
 v_mfma_f32_16x16x32_bf16 a[40:43], a[100:103], a[248:251], a[40:43]
 v_mfma_f32_16x16x32_bf16 a[44:47], a[96:99], a[236:239], a[44:47]
 ds_read_b64_tr_b16 a[126:127], v43 offset:45568
 v_mfma_f32_16x16x32_bf16 a[44:47], a[100:103], a[252:255], a[44:47]
 s_waitcnt lgkmcnt(8)
 v_mfma_f32_16x16x32_bf16 a[60:63], a[104:107], a[236:239], a[60:63]
 ds_read_b64_tr_b16 a[96:97], v44 offset:40960
 s_add_u32 m0, s46, 12288
 v_mfma_f32_16x16x32_bf16 a[60:63], a[108:111], a[252:255], a[60:63]
 buffer_load_dwordx4 v28, s[28:31], s33 offen offset:0 lds
 v_mfma_f32_16x16x32_bf16 a[56:59], a[104:107], a[232:235], a[56:59]
 ds_read_b64_tr_b16 a[98:99], v44 offset:41472
 v_mfma_f32_16x16x32_bf16 a[56:59], a[108:111], a[248:251], a[56:59]
 v_mfma_f32_16x16x32_bf16 a[52:55], a[104:107], a[228:231], a[52:55]
 ds_read_b64_tr_b16 a[100:101], v44 offset:45056
 v_mfma_f32_16x16x32_bf16 a[52:55], a[108:111], a[244:247], a[52:55]
 v_mfma_f32_16x16x32_bf16 a[48:51], a[104:107], a[224:227], a[48:51]
 ds_read_b64_tr_b16 a[102:103], v44 offset:45568
 v_mfma_f32_16x16x32_bf16 a[48:51], a[108:111], a[240:243], a[48:51]
 s_waitcnt lgkmcnt(8)
 v_mfma_f32_16x16x32_bf16 a[128:131], a[112:115], a[224:227], a[128:131]
 ds_read_b64_tr_b16 a[104:105], v45 offset:40960
 v_mfma_f32_16x16x32_bf16 a[128:131], a[116:119], a[240:243], a[128:131]
 buffer_load_dwordx4 v29, s[28:31], s33 offen offset:1024 lds
 v_mfma_f32_16x16x32_bf16 a[132:135], a[112:115], a[228:231], a[132:135]
 ds_read_b64_tr_b16 a[106:107], v45 offset:41472
 v_mfma_f32_16x16x32_bf16 a[132:135], a[116:119], a[244:247], a[132:135]
 buffer_load_dwordx4 v30, s[28:31], s33 offen offset:2048 lds
 v_mfma_f32_16x16x32_bf16 a[136:139], a[112:115], a[232:235], a[136:139]
 ds_read_b64_tr_b16 a[108:109], v45 offset:45056
 v_mfma_f32_16x16x32_bf16 a[136:139], a[116:119], a[248:251], a[136:139]
 v_mfma_f32_16x16x32_bf16 a[140:143], a[112:115], a[236:239], a[140:143]
 ds_read_b64_tr_b16 a[110:111], v45 offset:45568
 v_mfma_f32_16x16x32_bf16 a[140:143], a[116:119], a[252:255], a[140:143]
 s_waitcnt lgkmcnt(8)
 v_mfma_f32_16x16x32_bf16 a[156:159], a[120:123], a[236:239], a[156:159]
 ds_read_b64_tr_b16 a[112:113], v46 offset:32768
 v_mfma_f32_16x16x32_bf16 a[156:159], a[124:127], a[252:255], a[156:159]
 buffer_load_dwordx4 v31, s[28:31], s33 offen offset:3072 lds
 v_mfma_f32_16x16x32_bf16 a[152:155], a[120:123], a[232:235], a[152:155]
 ds_read_b64_tr_b16 a[114:115], v46 offset:33024
 v_mfma_f32_16x16x32_bf16 a[152:155], a[124:127], a[248:251], a[152:155]
 v_mfma_f32_16x16x32_bf16 a[148:151], a[120:123], a[228:231], a[148:151]
 ds_read_b64_tr_b16 a[116:117], v46 offset:40960
 v_mfma_f32_16x16x32_bf16 a[148:151], a[124:127], a[244:247], a[148:151]
 v_mfma_f32_16x16x32_bf16 a[144:147], a[120:123], a[224:227], a[144:147]
 ds_read_b64_tr_b16 a[118:119], v46 offset:41216
 s_add_u32 m0, s43, 0x10000
 v_mfma_f32_16x16x32_bf16 a[144:147], a[124:127], a[240:243], a[144:147]
 s_xor_b32 s34, s98, 0x680000
 s_waitcnt lgkmcnt(8)
 v_mfma_f32_16x16x32_bf16 a[160:163], a[96:99], a[224:227], a[160:163]
 ds_read_b64_tr_b16 a[120:121], v47 offset:32768
 v_mfma_f32_16x16x32_bf16 a[160:163], a[100:103], a[240:243], a[160:163]
 buffer_load_dwordx4 v32, s[16:19], s34 offen offset:0 lds
 v_mfma_f32_16x16x32_bf16 a[164:167], a[96:99], a[228:231], a[164:167]
 ds_read_b64_tr_b16 a[122:123], v47 offset:33024
 v_mfma_f32_16x16x32_bf16 a[164:167], a[100:103], a[244:247], a[164:167]
 buffer_load_dwordx4 v33, s[16:19], s34 offen offset:1024 lds
 v_mfma_f32_16x16x32_bf16 a[168:171], a[96:99], a[232:235], a[168:171]
 ds_read_b64_tr_b16 a[124:125], v47 offset:40960
 v_mfma_f32_16x16x32_bf16 a[168:171], a[100:103], a[248:251], a[168:171]
 v_mfma_f32_16x16x32_bf16 a[172:175], a[96:99], a[236:239], a[172:175]
 ds_read_b64_tr_b16 a[126:127], v47 offset:41216
 v_mfma_f32_16x16x32_bf16 a[172:175], a[100:103], a[252:255], a[172:175]
 s_waitcnt lgkmcnt(8)
 v_mfma_f32_16x16x32_bf16 a[188:191], a[104:107], a[236:239], a[188:191]
 ds_read_b64_tr_b16 a[96:97], v46 offset:33792
 v_mfma_f32_16x16x32_bf16 a[188:191], a[108:111], a[252:255], a[188:191]
 buffer_load_dwordx4 v34, s[16:19], s34 offen offset:2048 lds
 v_mfma_f32_16x16x32_bf16 a[184:187], a[104:107], a[232:235], a[184:187]
 ds_read_b64_tr_b16 a[98:99], v46 offset:34048
 v_mfma_f32_16x16x32_bf16 a[184:187], a[108:111], a[248:251], a[184:187]
 v_mfma_f32_16x16x32_bf16 a[180:183], a[104:107], a[228:231], a[180:183]
 ds_read_b64_tr_b16 a[100:101], v46 offset:41984
 v_mfma_f32_16x16x32_bf16 a[180:183], a[108:111], a[244:247], a[180:183]
 v_mfma_f32_16x16x32_bf16 a[176:179], a[104:107], a[224:227], a[176:179]
 ds_read_b64_tr_b16 a[102:103], v46 offset:42240
 v_mfma_f32_16x16x32_bf16 a[176:179], a[108:111], a[240:243], a[176:179]
 s_waitcnt lgkmcnt(8)
 v_mfma_f32_16x16x32_bf16 v[80:83], a[112:115], a[224:227], v[80:83]
 ds_read_b64_tr_b16 a[104:105], v47 offset:33792
 v_mfma_f32_16x16x32_bf16 v[80:83], a[116:119], a[240:243], v[80:83]
 buffer_load_dwordx4 v35, s[16:19], s34 offen offset:3072 lds
 v_mfma_f32_16x16x32_bf16 v[84:87], a[112:115], a[228:231], v[84:87]
 ds_read_b64_tr_b16 a[106:107], v47 offset:34048
 v_mfma_f32_16x16x32_bf16 v[84:87], a[116:119], a[244:247], v[84:87]
 s_add_u32 m0, s44, 0x10000
 s_mov_b32 s35, 0x4e0000
 v_mfma_f32_16x16x32_bf16 v[88:91], a[112:115], a[232:235], v[88:91]
 ds_read_b64_tr_b16 a[108:109], v47 offset:41984
 v_mfma_f32_16x16x32_bf16 v[88:91], a[116:119], a[248:251], v[88:91]
 buffer_load_dwordx4 v36, s[24:27], s35 offen offset:0 lds
 v_mfma_f32_16x16x32_bf16 v[92:95], a[112:115], a[236:239], v[92:95]
 ds_read_b64_tr_b16 a[110:111], v47 offset:42240
 v_mfma_f32_16x16x32_bf16 v[92:95], a[116:119], a[252:255], v[92:95]
 s_waitcnt lgkmcnt(8)
 v_mfma_f32_16x16x32_bf16 v[124:127], a[120:123], a[236:239], v[124:127]
 ds_read_b64_tr_b16 a[112:113], v46 offset:34816
 v_mfma_f32_16x16x32_bf16 v[124:127], a[124:127], a[252:255], v[124:127]
 buffer_load_dwordx4 v37, s[24:27], s35 offen offset:1024 lds
 v_mfma_f32_16x16x32_bf16 v[120:123], a[120:123], a[232:235], v[120:123]
 ds_read_b64_tr_b16 a[114:115], v46 offset:35072
 v_mfma_f32_16x16x32_bf16 v[120:123], a[124:127], a[248:251], v[120:123]
 v_mfma_f32_16x16x32_bf16 v[116:119], a[120:123], a[228:231], v[116:119]
 ds_read_b64_tr_b16 a[116:117], v46 offset:43008
 v_mfma_f32_16x16x32_bf16 v[116:119], a[124:127], a[244:247], v[116:119]
 v_mfma_f32_16x16x32_bf16 v[112:115], a[120:123], a[224:227], v[112:115]
 ds_read_b64_tr_b16 a[118:119], v46 offset:43264
 v_mfma_f32_16x16x32_bf16 v[112:115], a[124:127], a[240:243], v[112:115]
 s_waitcnt lgkmcnt(8)
 v_mfma_f32_16x16x32_bf16 v[144:147], a[96:99], a[224:227], v[144:147]
 ds_read_b64_tr_b16 a[120:121], v47 offset:34816
 v_mfma_f32_16x16x32_bf16 v[144:147], a[100:103], a[240:243], v[144:147]
 buffer_load_dwordx4 v38, s[24:27], s35 offen offset:2048 lds
 v_mfma_f32_16x16x32_bf16 v[148:151], a[96:99], a[228:231], v[148:151]
 ds_read_b64_tr_b16 a[122:123], v47 offset:35072
 v_mfma_f32_16x16x32_bf16 v[148:151], a[100:103], a[244:247], v[148:151]
 v_mfma_f32_16x16x32_bf16 v[152:155], a[96:99], a[232:235], v[152:155]
 ds_read_b64_tr_b16 a[124:125], v47 offset:43008
 v_mfma_f32_16x16x32_bf16 v[152:155], a[100:103], a[248:251], v[152:155]
 v_mfma_f32_16x16x32_bf16 v[156:159], a[96:99], a[236:239], v[156:159]
 ds_read_b64_tr_b16 a[126:127], v47 offset:43264
 v_min_u32 v5, 10, v2
 v_mfma_f32_16x16x32_bf16 v[156:159], a[100:103], a[252:255], v[156:159]
 v_mad_u32_u24 v5, s45, 11, v5
 s_waitcnt lgkmcnt(8)
 v_mfma_f32_16x16x32_bf16 v[188:191], a[104:107], a[236:239], v[188:191]
 v_lshlrev_b32 v5, 7, v5
 v_mfma_f32_16x16x32_bf16 v[188:191], a[108:111], a[252:255], v[188:191]
 v_add_u32 v5, F_e2-F_pc, v5
 v_mfma_f32_16x16x32_bf16 v[184:187], a[104:107], a[232:235], v[184:187]
 global_load_dword v60, v5, s[90:91]
 v_mfma_f32_16x16x32_bf16 v[184:187], a[108:111], a[248:251], v[184:187]
 s_waitcnt lgkmcnt(0) vmcnt(17)
 s_barrier
 v_mfma_f32_16x16x32_bf16 v[180:183], a[104:107], a[228:231], v[180:183]
 ds_read_b64_tr_b16 a[96:97], v48 offset:0
 v_mfma_f32_16x16x32_bf16 v[180:183], a[108:111], a[244:247], v[180:183]
 ds_read_b64_tr_b16 a[98:99], v48 offset:512
 v_mfma_f32_16x16x32_bf16 v[176:179], a[104:107], a[224:227], v[176:179]
 ds_read_b64_tr_b16 a[100:101], v48 offset:4096
 v_mfma_f32_16x16x32_bf16 v[176:179], a[108:111], a[240:243], v[176:179]
 ds_read_b64_tr_b16 a[102:103], v48 offset:4608
 v_mfma_f32_16x16x32_bf16 a[192:195], a[224:227], a[112:115], a[192:195]
 ds_read_b128 a[64:67], v40 offset:0
 v_mfma_f32_16x16x32_bf16 a[192:195], a[240:243], a[116:119], a[192:195]
 ds_read_b128 a[80:83], v41 offset:0
 v_mfma_f32_16x16x32_bf16 a[196:199], a[228:231], a[112:115], a[196:199]
 ds_read_b128 a[68:71], v40 offset:2048
 v_mfma_f32_16x16x32_bf16 a[196:199], a[244:247], a[116:119], a[196:199]
 ds_read_b128 a[84:87], v41 offset:2048
 v_mfma_f32_16x16x32_bf16 a[200:203], a[232:235], a[112:115], a[200:203]
 ds_read_b128 a[72:75], v40 offset:4096
 v_mfma_f32_16x16x32_bf16 a[200:203], a[248:251], a[116:119], a[200:203]
 ds_read_b128 a[88:91], v41 offset:4096
 v_mfma_f32_16x16x32_bf16 a[204:207], a[236:239], a[112:115], a[204:207]
 ds_read_b128 a[76:79], v40 offset:6144
 v_mfma_f32_16x16x32_bf16 a[204:207], a[252:255], a[116:119], a[204:207]
 ds_read_b128 a[92:95], v41 offset:6144
 v_mfma_f32_16x16x32_bf16 a[220:223], a[236:239], a[120:123], a[220:223]
 ds_read_b64_tr_b16 a[104:105], v49 offset:0
 v_mfma_f32_16x16x32_bf16 a[220:223], a[252:255], a[124:127], a[220:223]
 ds_read_b64_tr_b16 a[106:107], v49 offset:512
 v_mfma_f32_16x16x32_bf16 a[216:219], a[232:235], a[120:123], a[216:219]
 ds_read_b64_tr_b16 a[108:109], v49 offset:4096
 v_mfma_f32_16x16x32_bf16 a[216:219], a[248:251], a[124:127], a[216:219]
 ds_read_b64_tr_b16 a[110:111], v49 offset:4608
 v_mfma_f32_16x16x32_bf16 a[212:215], a[228:231], a[120:123], a[212:215]
 ds_read_b64_tr_b16 a[112:113], v50 offset:0
 v_mfma_f32_16x16x32_bf16 a[212:215], a[244:247], a[124:127], a[212:215]
 ds_read_b64_tr_b16 a[114:115], v50 offset:512
 v_mfma_f32_16x16x32_bf16 a[208:211], a[224:227], a[120:123], a[208:211]
 ds_read_b64_tr_b16 a[116:117], v50 offset:4096
 v_mfma_f32_16x16x32_bf16 a[208:211], a[240:243], a[124:127], a[208:211]
 ds_read_b64_tr_b16 a[118:119], v50 offset:4608
F_step20:
 s_waitcnt lgkmcnt(8)
 v_mfma_f32_16x16x32_bf16 a[0:3], a[96:99], a[64:67], a[0:3]
 ds_read_b64_tr_b16 a[120:121], v51 offset:0
 v_mfma_f32_16x16x32_bf16 a[0:3], a[100:103], a[80:83], a[0:3]
 v_mfma_f32_16x16x32_bf16 a[4:7], a[96:99], a[68:71], a[4:7]
 ds_read_b64_tr_b16 a[122:123], v51 offset:512
 v_mfma_f32_16x16x32_bf16 a[4:7], a[100:103], a[84:87], a[4:7]
 s_add_u32 m0, s46, 0
 s_xor_b32 s33, s99, 1792
 v_mfma_f32_16x16x32_bf16 a[8:11], a[96:99], a[72:75], a[8:11]
 ds_read_b64_tr_b16 a[124:125], v51 offset:4096
 v_mfma_f32_16x16x32_bf16 a[8:11], a[100:103], a[88:91], a[8:11]
 buffer_load_dwordx4 v24, s[28:31], s33 offen offset:0 lds
 v_mfma_f32_16x16x32_bf16 a[12:15], a[96:99], a[76:79], a[12:15]
 ds_read_b64_tr_b16 a[126:127], v51 offset:4608
 v_mfma_f32_16x16x32_bf16 a[12:15], a[100:103], a[92:95], a[12:15]
 s_waitcnt lgkmcnt(8)
 v_mfma_f32_16x16x32_bf16 a[28:31], a[104:107], a[76:79], a[28:31]
 ds_read_b64_tr_b16 a[96:97], v48 offset:8192
 v_mfma_f32_16x16x32_bf16 a[28:31], a[108:111], a[92:95], a[28:31]
 buffer_load_dwordx4 v25, s[28:31], s33 offen offset:1024 lds
 v_mfma_f32_16x16x32_bf16 a[24:27], a[104:107], a[72:75], a[24:27]
 ds_read_b64_tr_b16 a[98:99], v48 offset:8704
 v_mfma_f32_16x16x32_bf16 a[24:27], a[108:111], a[88:91], a[24:27]
 v_mfma_f32_16x16x32_bf16 a[20:23], a[104:107], a[68:71], a[20:23]
 ds_read_b64_tr_b16 a[100:101], v48 offset:12288
 v_mfma_f32_16x16x32_bf16 a[20:23], a[108:111], a[84:87], a[20:23]
 v_mfma_f32_16x16x32_bf16 a[16:19], a[104:107], a[64:67], a[16:19]
 ds_read_b64_tr_b16 a[102:103], v48 offset:12800
 v_mfma_f32_16x16x32_bf16 a[16:19], a[108:111], a[80:83], a[16:19]
 s_waitcnt lgkmcnt(8)
 v_mfma_f32_16x16x32_bf16 a[32:35], a[112:115], a[64:67], a[32:35]
 ds_read_b64_tr_b16 a[104:105], v49 offset:8192
 v_mfma_f32_16x16x32_bf16 a[32:35], a[116:119], a[80:83], a[32:35]
 buffer_load_dwordx4 v26, s[28:31], s33 offen offset:2048 lds
 v_mfma_f32_16x16x32_bf16 a[36:39], a[112:115], a[68:71], a[36:39]
 ds_read_b64_tr_b16 a[106:107], v49 offset:8704
 v_mfma_f32_16x16x32_bf16 a[36:39], a[116:119], a[84:87], a[36:39]
 v_mfma_f32_16x16x32_bf16 a[40:43], a[112:115], a[72:75], a[40:43]
 ds_read_b64_tr_b16 a[108:109], v49 offset:12288
 v_mfma_f32_16x16x32_bf16 a[40:43], a[116:119], a[88:91], a[40:43]
 buffer_load_dwordx4 v27, s[28:31], s33 offen offset:3072 lds
 v_mfma_f32_16x16x32_bf16 a[44:47], a[112:115], a[76:79], a[44:47]
 ds_read_b64_tr_b16 a[110:111], v49 offset:12800
 v_mfma_f32_16x16x32_bf16 a[44:47], a[116:119], a[92:95], a[44:47]
 s_waitcnt lgkmcnt(8)
 v_mfma_f32_16x16x32_bf16 a[60:63], a[120:123], a[76:79], a[60:63]
 ds_read_b64_tr_b16 a[112:113], v50 offset:8192
 v_mfma_f32_16x16x32_bf16 a[60:63], a[124:127], a[92:95], a[60:63]
 s_add_u32 m0, s46, 4096
 v_mfma_f32_16x16x32_bf16 a[56:59], a[120:123], a[72:75], a[56:59]
 ds_read_b64_tr_b16 a[114:115], v50 offset:8704
 v_mfma_f32_16x16x32_bf16 a[56:59], a[124:127], a[88:91], a[56:59]
 buffer_load_dwordx4 v28, s[28:31], s33 offen offset:0 lds
 v_mfma_f32_16x16x32_bf16 a[52:55], a[120:123], a[68:71], a[52:55]
 ds_read_b64_tr_b16 a[116:117], v50 offset:12288
 v_mfma_f32_16x16x32_bf16 a[52:55], a[124:127], a[84:87], a[52:55]
 v_mfma_f32_16x16x32_bf16 a[48:51], a[120:123], a[64:67], a[48:51]
 ds_read_b64_tr_b16 a[118:119], v50 offset:12800
 v_mfma_f32_16x16x32_bf16 a[48:51], a[124:127], a[80:83], a[48:51]
 s_waitcnt lgkmcnt(8)
 v_mfma_f32_16x16x32_bf16 a[128:131], a[96:99], a[64:67], a[128:131]
 ds_read_b64_tr_b16 a[120:121], v51 offset:8192
 v_mfma_f32_16x16x32_bf16 a[128:131], a[100:103], a[80:83], a[128:131]
 buffer_load_dwordx4 v29, s[28:31], s33 offen offset:1024 lds
 v_mfma_f32_16x16x32_bf16 a[132:135], a[96:99], a[68:71], a[132:135]
 ds_read_b64_tr_b16 a[122:123], v51 offset:8704
 v_mfma_f32_16x16x32_bf16 a[132:135], a[100:103], a[84:87], a[132:135]
 v_mfma_f32_16x16x32_bf16 a[136:139], a[96:99], a[72:75], a[136:139]
 ds_read_b64_tr_b16 a[124:125], v51 offset:12288
 v_mfma_f32_16x16x32_bf16 a[136:139], a[100:103], a[88:91], a[136:139]
 buffer_load_dwordx4 v30, s[28:31], s33 offen offset:2048 lds
 v_mfma_f32_16x16x32_bf16 a[140:143], a[96:99], a[76:79], a[140:143]
 ds_read_b64_tr_b16 a[126:127], v51 offset:12800
 v_mfma_f32_16x16x32_bf16 a[140:143], a[100:103], a[92:95], a[140:143]
 s_waitcnt lgkmcnt(8)
 v_mfma_f32_16x16x32_bf16 a[156:159], a[104:107], a[76:79], a[156:159]
 ds_read_b64_tr_b16 a[96:97], v52 offset:0
 v_mfma_f32_16x16x32_bf16 a[156:159], a[108:111], a[92:95], a[156:159]
 v_mfma_f32_16x16x32_bf16 a[152:155], a[104:107], a[72:75], a[152:155]
 ds_read_b64_tr_b16 a[98:99], v52 offset:256
 v_mfma_f32_16x16x32_bf16 a[152:155], a[108:111], a[88:91], a[152:155]
 buffer_load_dwordx4 v31, s[28:31], s33 offen offset:3072 lds
 v_mfma_f32_16x16x32_bf16 a[148:151], a[104:107], a[68:71], a[148:151]
 ds_read_b64_tr_b16 a[100:101], v52 offset:8192
 v_mfma_f32_16x16x32_bf16 a[148:151], a[108:111], a[84:87], a[148:151]
 v_mfma_f32_16x16x32_bf16 a[144:147], a[104:107], a[64:67], a[144:147]
 ds_read_b64_tr_b16 a[102:103], v52 offset:8448
 v_mfma_f32_16x16x32_bf16 a[144:147], a[108:111], a[80:83], a[144:147]
 s_waitcnt lgkmcnt(8)
 v_mfma_f32_16x16x32_bf16 a[160:163], a[112:115], a[64:67], a[160:163]
 ds_read_b64_tr_b16 a[104:105], v53 offset:0
 s_add_u32 m0, s43, 0x18000
 v_mfma_f32_16x16x32_bf16 a[160:163], a[116:119], a[80:83], a[160:163]
 s_xor_b32 s34, s98, 0x700000
 v_mfma_f32_16x16x32_bf16 a[164:167], a[112:115], a[68:71], a[164:167]
 ds_read_b64_tr_b16 a[106:107], v53 offset:256
 v_mfma_f32_16x16x32_bf16 a[164:167], a[116:119], a[84:87], a[164:167]
 buffer_load_dwordx4 v32, s[16:19], s34 offen offset:0 lds
 v_mfma_f32_16x16x32_bf16 a[168:171], a[112:115], a[72:75], a[168:171]
 ds_read_b64_tr_b16 a[108:109], v53 offset:8192
 v_mfma_f32_16x16x32_bf16 a[168:171], a[116:119], a[88:91], a[168:171]
 v_mfma_f32_16x16x32_bf16 a[172:175], a[112:115], a[76:79], a[172:175]
 ds_read_b64_tr_b16 a[110:111], v53 offset:8448
 v_mfma_f32_16x16x32_bf16 a[172:175], a[116:119], a[92:95], a[172:175]
 s_waitcnt lgkmcnt(8)
 v_mfma_f32_16x16x32_bf16 a[188:191], a[120:123], a[76:79], a[188:191]
 ds_read_b64_tr_b16 a[112:113], v52 offset:1024
 v_mfma_f32_16x16x32_bf16 a[188:191], a[124:127], a[92:95], a[188:191]
 buffer_load_dwordx4 v33, s[16:19], s34 offen offset:1024 lds
 v_mfma_f32_16x16x32_bf16 a[184:187], a[120:123], a[72:75], a[184:187]
 ds_read_b64_tr_b16 a[114:115], v52 offset:1280
 v_mfma_f32_16x16x32_bf16 a[184:187], a[124:127], a[88:91], a[184:187]
 buffer_load_dwordx4 v34, s[16:19], s34 offen offset:2048 lds
 v_mfma_f32_16x16x32_bf16 a[180:183], a[120:123], a[68:71], a[180:183]
 ds_read_b64_tr_b16 a[116:117], v52 offset:9216
 v_mfma_f32_16x16x32_bf16 a[180:183], a[124:127], a[84:87], a[180:183]
 v_mfma_f32_16x16x32_bf16 a[176:179], a[120:123], a[64:67], a[176:179]
 ds_read_b64_tr_b16 a[118:119], v52 offset:9472
 v_mfma_f32_16x16x32_bf16 a[176:179], a[124:127], a[80:83], a[176:179]
 s_waitcnt lgkmcnt(8)
 v_mfma_f32_16x16x32_bf16 v[80:83], a[96:99], a[64:67], v[80:83]
 ds_read_b64_tr_b16 a[120:121], v53 offset:1024
 v_mfma_f32_16x16x32_bf16 v[80:83], a[100:103], a[80:83], v[80:83]
 buffer_load_dwordx4 v35, s[16:19], s34 offen offset:3072 lds
 v_mfma_f32_16x16x32_bf16 v[84:87], a[96:99], a[68:71], v[84:87]
 ds_read_b64_tr_b16 a[122:123], v53 offset:1280
 v_mfma_f32_16x16x32_bf16 v[84:87], a[100:103], a[84:87], v[84:87]
 v_mfma_f32_16x16x32_bf16 v[88:91], a[96:99], a[72:75], v[88:91]
 ds_read_b64_tr_b16 a[124:125], v53 offset:9216
 v_mfma_f32_16x16x32_bf16 v[88:91], a[100:103], a[88:91], v[88:91]
 v_mfma_f32_16x16x32_bf16 v[92:95], a[96:99], a[76:79], v[92:95]
 ds_read_b64_tr_b16 a[126:127], v53 offset:9472
 v_mfma_f32_16x16x32_bf16 v[92:95], a[100:103], a[92:95], v[92:95]
 s_add_u32 m0, s44, 0x18000
 s_waitcnt lgkmcnt(8)
 v_mfma_f32_16x16x32_bf16 v[124:127], a[104:107], a[76:79], v[124:127]
 ds_read_b64_tr_b16 a[96:97], v52 offset:2048
 s_mov_b32 s35, 0x540000
 v_mfma_f32_16x16x32_bf16 v[124:127], a[108:111], a[92:95], v[124:127]
 buffer_load_dwordx4 v36, s[24:27], s35 offen offset:0 lds
 v_mfma_f32_16x16x32_bf16 v[120:123], a[104:107], a[72:75], v[120:123]
 ds_read_b64_tr_b16 a[98:99], v52 offset:2304
 v_mfma_f32_16x16x32_bf16 v[120:123], a[108:111], a[88:91], v[120:123]
 v_mfma_f32_16x16x32_bf16 v[116:119], a[104:107], a[68:71], v[116:119]
 ds_read_b64_tr_b16 a[100:101], v52 offset:10240
 v_mfma_f32_16x16x32_bf16 v[116:119], a[108:111], a[84:87], v[116:119]
 buffer_load_dwordx4 v37, s[24:27], s35 offen offset:1024 lds
 v_mfma_f32_16x16x32_bf16 v[112:115], a[104:107], a[64:67], v[112:115]
 ds_read_b64_tr_b16 a[102:103], v52 offset:10496
 v_mfma_f32_16x16x32_bf16 v[112:115], a[108:111], a[80:83], v[112:115]
 s_waitcnt lgkmcnt(8)
 v_mfma_f32_16x16x32_bf16 v[144:147], a[112:115], a[64:67], v[144:147]
 ds_read_b64_tr_b16 a[104:105], v53 offset:2048
 v_mfma_f32_16x16x32_bf16 v[144:147], a[116:119], a[80:83], v[144:147]
 v_mfma_f32_16x16x32_bf16 v[148:151], a[112:115], a[68:71], v[148:151]
 ds_read_b64_tr_b16 a[106:107], v53 offset:2304
 v_mfma_f32_16x16x32_bf16 v[148:151], a[116:119], a[84:87], v[148:151]
 buffer_load_dwordx4 v38, s[24:27], s35 offen offset:2048 lds
 v_mfma_f32_16x16x32_bf16 v[152:155], a[112:115], a[72:75], v[152:155]
 ds_read_b64_tr_b16 a[108:109], v53 offset:10240
 v_mfma_f32_16x16x32_bf16 v[152:155], a[116:119], a[88:91], v[152:155]
 v_mfma_f32_16x16x32_bf16 v[156:159], a[112:115], a[76:79], v[156:159]
 ds_read_b64_tr_b16 a[110:111], v53 offset:10496
 v_mfma_f32_16x16x32_bf16 v[156:159], a[116:119], a[92:95], v[156:159]
 s_waitcnt lgkmcnt(8)
 v_mfma_f32_16x16x32_bf16 v[188:191], a[120:123], a[76:79], v[188:191]
 v_mfma_f32_16x16x32_bf16 v[188:191], a[124:127], a[92:95], v[188:191]
 v_mfma_f32_16x16x32_bf16 v[184:187], a[120:123], a[72:75], v[184:187]
 v_mfma_f32_16x16x32_bf16 v[184:187], a[124:127], a[88:91], v[184:187]
 s_waitcnt lgkmcnt(0) vmcnt(16)
 s_barrier
 v_mov_b32 v61, s89
 buffer_store_dword v61, v58, s[20:23], s32 offen sc1
 v_mfma_f32_16x16x32_bf16 v[180:183], a[120:123], a[68:71], v[180:183]
 ds_read_b64_tr_b16 a[112:113], v42 offset:0
 v_mfma_f32_16x16x32_bf16 v[180:183], a[124:127], a[84:87], v[180:183]
 ds_read_b64_tr_b16 a[114:115], v42 offset:512
 v_mfma_f32_16x16x32_bf16 v[176:179], a[120:123], a[64:67], v[176:179]
 ds_read_b64_tr_b16 a[116:117], v42 offset:4096
 v_mfma_f32_16x16x32_bf16 v[176:179], a[124:127], a[80:83], v[176:179]
 ds_read_b64_tr_b16 a[118:119], v42 offset:4608
 v_mfma_f32_16x16x32_bf16 a[192:195], a[64:67], a[96:99], a[192:195]
 ds_read_b128 a[224:227], v40 offset:8192
 v_mfma_f32_16x16x32_bf16 a[192:195], a[80:83], a[100:103], a[192:195]
 ds_read_b128 a[240:243], v41 offset:8192
 v_mfma_f32_16x16x32_bf16 a[196:199], a[68:71], a[96:99], a[196:199]
 ds_read_b128 a[228:231], v40 offset:10240
 v_mfma_f32_16x16x32_bf16 a[196:199], a[84:87], a[100:103], a[196:199]
 ds_read_b128 a[244:247], v41 offset:10240
 v_mfma_f32_16x16x32_bf16 a[200:203], a[72:75], a[96:99], a[200:203]
 ds_read_b128 a[232:235], v40 offset:12288
 v_mfma_f32_16x16x32_bf16 a[200:203], a[88:91], a[100:103], a[200:203]
 ds_read_b128 a[248:251], v41 offset:12288
 v_mfma_f32_16x16x32_bf16 a[204:207], a[76:79], a[96:99], a[204:207]
 ds_read_b128 a[236:239], v40 offset:14336
 v_mfma_f32_16x16x32_bf16 a[204:207], a[92:95], a[100:103], a[204:207]
 ds_read_b128 a[252:255], v41 offset:14336
 v_mfma_f32_16x16x32_bf16 a[220:223], a[76:79], a[104:107], a[220:223]
 ds_read_b64_tr_b16 a[120:121], v43 offset:0
 v_mfma_f32_16x16x32_bf16 a[220:223], a[92:95], a[108:111], a[220:223]
 ds_read_b64_tr_b16 a[122:123], v43 offset:512
 v_mfma_f32_16x16x32_bf16 a[216:219], a[72:75], a[104:107], a[216:219]
 ds_read_b64_tr_b16 a[124:125], v43 offset:4096
 v_mfma_f32_16x16x32_bf16 a[216:219], a[88:91], a[108:111], a[216:219]
 ds_read_b64_tr_b16 a[126:127], v43 offset:4608
 v_mfma_f32_16x16x32_bf16 a[212:215], a[68:71], a[104:107], a[212:215]
 ds_read_b64_tr_b16 a[96:97], v44 offset:0
 v_mfma_f32_16x16x32_bf16 a[212:215], a[84:87], a[108:111], a[212:215]
 ds_read_b64_tr_b16 a[98:99], v44 offset:512
 v_mfma_f32_16x16x32_bf16 a[208:211], a[64:67], a[104:107], a[208:211]
 ds_read_b64_tr_b16 a[100:101], v44 offset:4096
 v_mfma_f32_16x16x32_bf16 a[208:211], a[80:83], a[108:111], a[208:211]
 ds_read_b64_tr_b16 a[102:103], v44 offset:4608
F_step21:
 s_waitcnt lgkmcnt(8)
 v_mfma_f32_16x16x32_bf16 a[0:3], a[112:115], a[224:227], a[0:3]
 ds_read_b64_tr_b16 a[104:105], v45 offset:0
 v_mfma_f32_16x16x32_bf16 a[0:3], a[116:119], a[240:243], a[0:3]
 v_mfma_f32_16x16x32_bf16 a[4:7], a[112:115], a[228:231], a[4:7]
 ds_read_b64_tr_b16 a[106:107], v45 offset:512
 v_mfma_f32_16x16x32_bf16 a[4:7], a[116:119], a[244:247], a[4:7]
 s_add_u32 m0, s46, 8192
 s_xor_b32 s33, s99, 1920
 v_mfma_f32_16x16x32_bf16 a[8:11], a[112:115], a[232:235], a[8:11]
 ds_read_b64_tr_b16 a[108:109], v45 offset:4096
 v_mfma_f32_16x16x32_bf16 a[8:11], a[116:119], a[248:251], a[8:11]
 buffer_load_dwordx4 v24, s[28:31], s33 offen offset:0 lds
 v_mfma_f32_16x16x32_bf16 a[12:15], a[112:115], a[236:239], a[12:15]
 ds_read_b64_tr_b16 a[110:111], v45 offset:4608
 v_mfma_f32_16x16x32_bf16 a[12:15], a[116:119], a[252:255], a[12:15]
 s_waitcnt lgkmcnt(8)
 v_mfma_f32_16x16x32_bf16 a[28:31], a[120:123], a[236:239], a[28:31]
 ds_read_b64_tr_b16 a[112:113], v42 offset:8192
 v_mfma_f32_16x16x32_bf16 a[28:31], a[124:127], a[252:255], a[28:31]
 buffer_load_dwordx4 v25, s[28:31], s33 offen offset:1024 lds
 v_mfma_f32_16x16x32_bf16 a[24:27], a[120:123], a[232:235], a[24:27]
 ds_read_b64_tr_b16 a[114:115], v42 offset:8704
 v_mfma_f32_16x16x32_bf16 a[24:27], a[124:127], a[248:251], a[24:27]
 v_mfma_f32_16x16x32_bf16 a[20:23], a[120:123], a[228:231], a[20:23]
 ds_read_b64_tr_b16 a[116:117], v42 offset:12288
 v_mfma_f32_16x16x32_bf16 a[20:23], a[124:127], a[244:247], a[20:23]
 v_mfma_f32_16x16x32_bf16 a[16:19], a[120:123], a[224:227], a[16:19]
 ds_read_b64_tr_b16 a[118:119], v42 offset:12800
 v_mfma_f32_16x16x32_bf16 a[16:19], a[124:127], a[240:243], a[16:19]
 s_waitcnt lgkmcnt(8)
 v_mfma_f32_16x16x32_bf16 a[32:35], a[96:99], a[224:227], a[32:35]
 ds_read_b64_tr_b16 a[120:121], v43 offset:8192
 v_mfma_f32_16x16x32_bf16 a[32:35], a[100:103], a[240:243], a[32:35]
 buffer_load_dwordx4 v26, s[28:31], s33 offen offset:2048 lds
 v_mfma_f32_16x16x32_bf16 a[36:39], a[96:99], a[228:231], a[36:39]
 ds_read_b64_tr_b16 a[122:123], v43 offset:8704
 v_mfma_f32_16x16x32_bf16 a[36:39], a[100:103], a[244:247], a[36:39]
 v_mfma_f32_16x16x32_bf16 a[40:43], a[96:99], a[232:235], a[40:43]
 ds_read_b64_tr_b16 a[124:125], v43 offset:12288
 v_mfma_f32_16x16x32_bf16 a[40:43], a[100:103], a[248:251], a[40:43]
 buffer_load_dwordx4 v27, s[28:31], s33 offen offset:3072 lds
 v_mfma_f32_16x16x32_bf16 a[44:47], a[96:99], a[236:239], a[44:47]
 ds_read_b64_tr_b16 a[126:127], v43 offset:12800
 v_mfma_f32_16x16x32_bf16 a[44:47], a[100:103], a[252:255], a[44:47]
 s_waitcnt lgkmcnt(8)
 v_mfma_f32_16x16x32_bf16 a[60:63], a[104:107], a[236:239], a[60:63]
 ds_read_b64_tr_b16 a[96:97], v44 offset:8192
 v_mfma_f32_16x16x32_bf16 a[60:63], a[108:111], a[252:255], a[60:63]
 s_add_u32 m0, s46, 12288
 v_mfma_f32_16x16x32_bf16 a[56:59], a[104:107], a[232:235], a[56:59]
 ds_read_b64_tr_b16 a[98:99], v44 offset:8704
 v_mfma_f32_16x16x32_bf16 a[56:59], a[108:111], a[248:251], a[56:59]
 buffer_load_dwordx4 v28, s[28:31], s33 offen offset:0 lds
 v_mfma_f32_16x16x32_bf16 a[52:55], a[104:107], a[228:231], a[52:55]
 ds_read_b64_tr_b16 a[100:101], v44 offset:12288
 v_mfma_f32_16x16x32_bf16 a[52:55], a[108:111], a[244:247], a[52:55]
 v_mfma_f32_16x16x32_bf16 a[48:51], a[104:107], a[224:227], a[48:51]
 ds_read_b64_tr_b16 a[102:103], v44 offset:12800
 v_mfma_f32_16x16x32_bf16 a[48:51], a[108:111], a[240:243], a[48:51]
 s_waitcnt lgkmcnt(8)
 v_mfma_f32_16x16x32_bf16 a[128:131], a[112:115], a[224:227], a[128:131]
 ds_read_b64_tr_b16 a[104:105], v45 offset:8192
 v_mfma_f32_16x16x32_bf16 a[128:131], a[116:119], a[240:243], a[128:131]
 buffer_load_dwordx4 v29, s[28:31], s33 offen offset:1024 lds
 v_mfma_f32_16x16x32_bf16 a[132:135], a[112:115], a[228:231], a[132:135]
 ds_read_b64_tr_b16 a[106:107], v45 offset:8704
 v_mfma_f32_16x16x32_bf16 a[132:135], a[116:119], a[244:247], a[132:135]
 v_mfma_f32_16x16x32_bf16 a[136:139], a[112:115], a[232:235], a[136:139]
 ds_read_b64_tr_b16 a[108:109], v45 offset:12288
 v_mfma_f32_16x16x32_bf16 a[136:139], a[116:119], a[248:251], a[136:139]
 buffer_load_dwordx4 v30, s[28:31], s33 offen offset:2048 lds
 v_mfma_f32_16x16x32_bf16 a[140:143], a[112:115], a[236:239], a[140:143]
 ds_read_b64_tr_b16 a[110:111], v45 offset:12800
 v_mfma_f32_16x16x32_bf16 a[140:143], a[116:119], a[252:255], a[140:143]
 s_waitcnt lgkmcnt(8)
 v_mfma_f32_16x16x32_bf16 a[156:159], a[120:123], a[236:239], a[156:159]
 ds_read_b64_tr_b16 a[112:113], v46 offset:0
 v_mfma_f32_16x16x32_bf16 a[156:159], a[124:127], a[252:255], a[156:159]
 v_mfma_f32_16x16x32_bf16 a[152:155], a[120:123], a[232:235], a[152:155]
 ds_read_b64_tr_b16 a[114:115], v46 offset:256
 v_mfma_f32_16x16x32_bf16 a[152:155], a[124:127], a[248:251], a[152:155]
 buffer_load_dwordx4 v31, s[28:31], s33 offen offset:3072 lds
 v_mfma_f32_16x16x32_bf16 a[148:151], a[120:123], a[228:231], a[148:151]
 ds_read_b64_tr_b16 a[116:117], v46 offset:8192
 v_mfma_f32_16x16x32_bf16 a[148:151], a[124:127], a[244:247], a[148:151]
 v_mfma_f32_16x16x32_bf16 a[144:147], a[120:123], a[224:227], a[144:147]
 ds_read_b64_tr_b16 a[118:119], v46 offset:8448
 v_mfma_f32_16x16x32_bf16 a[144:147], a[124:127], a[240:243], a[144:147]
 s_waitcnt lgkmcnt(8)
 v_mfma_f32_16x16x32_bf16 a[160:163], a[96:99], a[224:227], a[160:163]
 ds_read_b64_tr_b16 a[120:121], v47 offset:0
 s_add_u32 m0, s43, 0x20000
 v_mfma_f32_16x16x32_bf16 a[160:163], a[100:103], a[240:243], a[160:163]
 s_xor_b32 s34, s98, 0x780000
 v_mfma_f32_16x16x32_bf16 a[164:167], a[96:99], a[228:231], a[164:167]
 ds_read_b64_tr_b16 a[122:123], v47 offset:256
 v_mfma_f32_16x16x32_bf16 a[164:167], a[100:103], a[244:247], a[164:167]
 buffer_load_dwordx4 v32, s[16:19], s34 offen offset:0 lds
 v_mfma_f32_16x16x32_bf16 a[168:171], a[96:99], a[232:235], a[168:171]
 ds_read_b64_tr_b16 a[124:125], v47 offset:8192
 v_mfma_f32_16x16x32_bf16 a[168:171], a[100:103], a[248:251], a[168:171]
 v_mfma_f32_16x16x32_bf16 a[172:175], a[96:99], a[236:239], a[172:175]
 ds_read_b64_tr_b16 a[126:127], v47 offset:8448
 v_mfma_f32_16x16x32_bf16 a[172:175], a[100:103], a[252:255], a[172:175]
 s_waitcnt lgkmcnt(8)
 v_mfma_f32_16x16x32_bf16 a[188:191], a[104:107], a[236:239], a[188:191]
 ds_read_b64_tr_b16 a[96:97], v46 offset:1024
 v_mfma_f32_16x16x32_bf16 a[188:191], a[108:111], a[252:255], a[188:191]
 buffer_load_dwordx4 v33, s[16:19], s34 offen offset:1024 lds
 v_mfma_f32_16x16x32_bf16 a[184:187], a[104:107], a[232:235], a[184:187]
 ds_read_b64_tr_b16 a[98:99], v46 offset:1280
 v_mfma_f32_16x16x32_bf16 a[184:187], a[108:111], a[248:251], a[184:187]
 buffer_load_dwordx4 v34, s[16:19], s34 offen offset:2048 lds
 v_mfma_f32_16x16x32_bf16 a[180:183], a[104:107], a[228:231], a[180:183]
 ds_read_b64_tr_b16 a[100:101], v46 offset:9216
 v_mfma_f32_16x16x32_bf16 a[180:183], a[108:111], a[244:247], a[180:183]
 v_mfma_f32_16x16x32_bf16 a[176:179], a[104:107], a[224:227], a[176:179]
 ds_read_b64_tr_b16 a[102:103], v46 offset:9472
 v_mfma_f32_16x16x32_bf16 a[176:179], a[108:111], a[240:243], a[176:179]
 s_waitcnt lgkmcnt(8)
 v_mfma_f32_16x16x32_bf16 v[80:83], a[112:115], a[224:227], v[80:83]
 ds_read_b64_tr_b16 a[104:105], v47 offset:1024
 v_mfma_f32_16x16x32_bf16 v[80:83], a[116:119], a[240:243], v[80:83]
 buffer_load_dwordx4 v35, s[16:19], s34 offen offset:3072 lds
 v_mfma_f32_16x16x32_bf16 v[84:87], a[112:115], a[228:231], v[84:87]
 ds_read_b64_tr_b16 a[106:107], v47 offset:1280
 v_mfma_f32_16x16x32_bf16 v[84:87], a[116:119], a[244:247], v[84:87]
 v_mfma_f32_16x16x32_bf16 v[88:91], a[112:115], a[232:235], v[88:91]
 ds_read_b64_tr_b16 a[108:109], v47 offset:9216
 v_mfma_f32_16x16x32_bf16 v[88:91], a[116:119], a[248:251], v[88:91]
 v_mfma_f32_16x16x32_bf16 v[92:95], a[112:115], a[236:239], v[92:95]
 ds_read_b64_tr_b16 a[110:111], v47 offset:9472
 v_mfma_f32_16x16x32_bf16 v[92:95], a[116:119], a[252:255], v[92:95]
 s_add_u32 m0, s44, 0x20000
 s_waitcnt lgkmcnt(8)
 v_mfma_f32_16x16x32_bf16 v[124:127], a[120:123], a[236:239], v[124:127]
 ds_read_b64_tr_b16 a[112:113], v46 offset:2048
 s_mov_b32 s35, 0x5a0000
 v_mfma_f32_16x16x32_bf16 v[124:127], a[124:127], a[252:255], v[124:127]
 buffer_load_dwordx4 v36, s[24:27], s35 offen offset:0 lds
 v_mfma_f32_16x16x32_bf16 v[120:123], a[120:123], a[232:235], v[120:123]
 ds_read_b64_tr_b16 a[114:115], v46 offset:2304
 v_mfma_f32_16x16x32_bf16 v[120:123], a[124:127], a[248:251], v[120:123]
 v_mfma_f32_16x16x32_bf16 v[116:119], a[120:123], a[228:231], v[116:119]
 ds_read_b64_tr_b16 a[116:117], v46 offset:10240
 v_mfma_f32_16x16x32_bf16 v[116:119], a[124:127], a[244:247], v[116:119]
 buffer_load_dwordx4 v37, s[24:27], s35 offen offset:1024 lds
 v_mfma_f32_16x16x32_bf16 v[112:115], a[120:123], a[224:227], v[112:115]
 ds_read_b64_tr_b16 a[118:119], v46 offset:10496
 v_mfma_f32_16x16x32_bf16 v[112:115], a[124:127], a[240:243], v[112:115]
 s_waitcnt lgkmcnt(8)
 v_mfma_f32_16x16x32_bf16 v[144:147], a[96:99], a[224:227], v[144:147]
 ds_read_b64_tr_b16 a[120:121], v47 offset:2048
 v_mfma_f32_16x16x32_bf16 v[144:147], a[100:103], a[240:243], v[144:147]
 v_mfma_f32_16x16x32_bf16 v[148:151], a[96:99], a[228:231], v[148:151]
 ds_read_b64_tr_b16 a[122:123], v47 offset:2304
 v_mfma_f32_16x16x32_bf16 v[148:151], a[100:103], a[244:247], v[148:151]
 buffer_load_dwordx4 v38, s[24:27], s35 offen offset:2048 lds
 v_mfma_f32_16x16x32_bf16 v[152:155], a[96:99], a[232:235], v[152:155]
 ds_read_b64_tr_b16 a[124:125], v47 offset:10240
 v_mfma_f32_16x16x32_bf16 v[152:155], a[100:103], a[248:251], v[152:155]
 v_mfma_f32_16x16x32_bf16 v[156:159], a[96:99], a[236:239], v[156:159]
 ds_read_b64_tr_b16 a[126:127], v47 offset:10496
 v_mfma_f32_16x16x32_bf16 v[156:159], a[100:103], a[252:255], v[156:159]
 s_waitcnt lgkmcnt(8)
 v_mfma_f32_16x16x32_bf16 v[188:191], a[104:107], a[236:239], v[188:191]
 v_mfma_f32_16x16x32_bf16 v[188:191], a[108:111], a[252:255], v[188:191]
 v_mfma_f32_16x16x32_bf16 v[184:187], a[104:107], a[232:235], v[184:187]
 v_mfma_f32_16x16x32_bf16 v[184:187], a[108:111], a[248:251], v[184:187]
 s_waitcnt lgkmcnt(0) vmcnt(16)
 s_barrier
 v_mfma_f32_16x16x32_bf16 v[180:183], a[104:107], a[228:231], v[180:183]
 ds_read_b64_tr_b16 a[96:97], v42 offset:32768
 v_mfma_f32_16x16x32_bf16 v[180:183], a[108:111], a[244:247], v[180:183]
 ds_read_b64_tr_b16 a[98:99], v42 offset:33280
 v_mfma_f32_16x16x32_bf16 v[176:179], a[104:107], a[224:227], v[176:179]
 ds_read_b64_tr_b16 a[100:101], v42 offset:36864
 v_mfma_f32_16x16x32_bf16 v[176:179], a[108:111], a[240:243], v[176:179]
 ds_read_b64_tr_b16 a[102:103], v42 offset:37376
 v_mfma_f32_16x16x32_bf16 a[192:195], a[224:227], a[112:115], a[192:195]
 ds_read_b128 a[64:67], v40 offset:0
 v_mfma_f32_16x16x32_bf16 a[192:195], a[240:243], a[116:119], a[192:195]
 ds_read_b128 a[80:83], v41 offset:0
 v_mfma_f32_16x16x32_bf16 a[196:199], a[228:231], a[112:115], a[196:199]
 ds_read_b128 a[68:71], v40 offset:2048
 v_mfma_f32_16x16x32_bf16 a[196:199], a[244:247], a[116:119], a[196:199]
 ds_read_b128 a[84:87], v41 offset:2048
 v_mfma_f32_16x16x32_bf16 a[200:203], a[232:235], a[112:115], a[200:203]
 ds_read_b128 a[72:75], v40 offset:4096
 v_mfma_f32_16x16x32_bf16 a[200:203], a[248:251], a[116:119], a[200:203]
 ds_read_b128 a[88:91], v41 offset:4096
 v_mfma_f32_16x16x32_bf16 a[204:207], a[236:239], a[112:115], a[204:207]
 ds_read_b128 a[76:79], v40 offset:6144
 v_mfma_f32_16x16x32_bf16 a[204:207], a[252:255], a[116:119], a[204:207]
 ds_read_b128 a[92:95], v41 offset:6144
 v_mfma_f32_16x16x32_bf16 a[220:223], a[236:239], a[120:123], a[220:223]
 ds_read_b64_tr_b16 a[104:105], v43 offset:32768
 v_mfma_f32_16x16x32_bf16 a[220:223], a[252:255], a[124:127], a[220:223]
 ds_read_b64_tr_b16 a[106:107], v43 offset:33280
 v_mfma_f32_16x16x32_bf16 a[216:219], a[232:235], a[120:123], a[216:219]
 ds_read_b64_tr_b16 a[108:109], v43 offset:36864
 v_mfma_f32_16x16x32_bf16 a[216:219], a[248:251], a[124:127], a[216:219]
 ds_read_b64_tr_b16 a[110:111], v43 offset:37376
 v_mfma_f32_16x16x32_bf16 a[212:215], a[228:231], a[120:123], a[212:215]
 ds_read_b64_tr_b16 a[112:113], v44 offset:32768
 v_mfma_f32_16x16x32_bf16 a[212:215], a[244:247], a[124:127], a[212:215]
 ds_read_b64_tr_b16 a[114:115], v44 offset:33280
 v_mfma_f32_16x16x32_bf16 a[208:211], a[224:227], a[120:123], a[208:211]
 ds_read_b64_tr_b16 a[116:117], v44 offset:36864
 v_mfma_f32_16x16x32_bf16 a[208:211], a[240:243], a[124:127], a[208:211]
 ds_read_b64_tr_b16 a[118:119], v44 offset:37376
F_step22:
 s_waitcnt lgkmcnt(8)
 v_mfma_f32_16x16x32_bf16 a[0:3], a[96:99], a[64:67], a[0:3]
 ds_read_b64_tr_b16 a[120:121], v45 offset:32768
 v_mfma_f32_16x16x32_bf16 a[0:3], a[100:103], a[80:83], a[0:3]
 v_mfma_f32_16x16x32_bf16 a[4:7], a[96:99], a[68:71], a[4:7]
 ds_read_b64_tr_b16 a[122:123], v45 offset:33280
 v_readfirstlane_b32 s33, v58
 v_mfma_f32_16x16x32_bf16 a[4:7], a[100:103], a[84:87], a[4:7]
 v_lshlrev_b32 v10, 4, v2
 v_mfma_f32_16x16x32_bf16 a[8:11], a[96:99], a[72:75], a[8:11]
 ds_read_b64_tr_b16 a[124:125], v45 offset:36864
 s_lshl_b32 s41, s52, 12
 v_mfma_f32_16x16x32_bf16 a[8:11], a[100:103], a[88:91], a[8:11]
 v_add_u32 v11, s41, v10
 v_mfma_f32_16x16x32_bf16 a[12:15], a[96:99], a[76:79], a[12:15]
 ds_read_b64_tr_b16 a[126:127], v45 offset:37376
 s_add_u32 s58, s55, 1
 v_mfma_f32_16x16x32_bf16 a[12:15], a[100:103], a[92:95], a[12:15]
 s_lshl_b32 s58, s58, 16
 s_waitcnt lgkmcnt(8)
 v_mfma_f32_16x16x32_bf16 a[28:31], a[104:107], a[76:79], a[28:31]
 ds_read_b64_tr_b16 a[96:97], v42 offset:40960
 s_add_u32 s58, s58, s40
 v_mfma_f32_16x16x32_bf16 a[28:31], a[108:111], a[92:95], a[28:31]
 v_mfma_f32_16x16x32_bf16 a[24:27], a[104:107], a[72:75], a[24:27]
 ds_read_b64_tr_b16 a[98:99], v42 offset:41472
 s_mov_b32 s8, s20
 v_mfma_f32_16x16x32_bf16 a[24:27], a[108:111], a[88:91], a[24:27]
 s_mov_b32 s9, s21
 v_mfma_f32_16x16x32_bf16 a[20:23], a[104:107], a[68:71], a[20:23]
 ds_read_b64_tr_b16 a[100:101], v42 offset:45056
 s_mov_b32 s10, s58
 v_mfma_f32_16x16x32_bf16 a[20:23], a[108:111], a[84:87], a[20:23]
 s_mov_b32 s11, 0x20000
 v_mfma_f32_16x16x32_bf16 a[16:19], a[104:107], a[64:67], a[16:19]
 ds_read_b64_tr_b16 a[102:103], v42 offset:45568
 v_and_b32 v3, 31, v2
 v_mfma_f32_16x16x32_bf16 a[16:19], a[108:111], a[80:83], a[16:19]
 v_lshrrev_b32 v4, 5, v2
 s_waitcnt lgkmcnt(8)
 v_mfma_f32_16x16x32_bf16 a[32:35], a[112:115], a[64:67], a[32:35]
 ds_read_b64_tr_b16 a[104:105], v43 offset:40960
 v_mfma_f32_16x16x32_bf16 a[32:35], a[116:119], a[80:83], a[32:35]
 v_lshlrev_b32 v5, 2, v3
 v_mfma_f32_16x16x32_bf16 a[36:39], a[112:115], a[68:71], a[36:39]
 ds_read_b64_tr_b16 a[106:107], v43 offset:41472
 s_lshl_b32 s64, s56, 7
 v_mfma_f32_16x16x32_bf16 a[36:39], a[116:119], a[84:87], a[36:39]
 s_lshl_b32 s65, s57, 7
 v_mfma_f32_16x16x32_bf16 a[40:43], a[112:115], a[72:75], a[40:43]
 ds_read_b64_tr_b16 a[108:109], v43 offset:45056
 s_add_u32 s64, s64, 0x3b00000
 v_mfma_f32_16x16x32_bf16 a[40:43], a[116:119], a[88:91], a[40:43]
 s_add_u32 s65, s65, 0x3b00000
 v_mfma_f32_16x16x32_bf16 a[44:47], a[112:115], a[76:79], a[44:47]
 ds_read_b64_tr_b16 a[110:111], v43 offset:45568
 s_mov_b32 s60, 0x3e0293ee
 v_mfma_f32_16x16x32_bf16 a[44:47], a[116:119], a[92:95], a[44:47]
 s_waitcnt lgkmcnt(8)
 v_mfma_f32_16x16x32_bf16 a[60:63], a[120:123], a[76:79], a[60:63]
 ds_read_b64_tr_b16 a[112:113], v44 offset:40960
 s_mov_b32 s61, s60
 v_mfma_f32_16x16x32_bf16 a[60:63], a[124:127], a[92:95], a[60:63]
 s_lshl_b32 s62, s52, 12
 v_mfma_f32_16x16x32_bf16 a[56:59], a[120:123], a[72:75], a[56:59]
 ds_read_b64_tr_b16 a[114:115], v44 offset:41472
 s_add_u32 s62, s62, 98304
 v_mfma_f32_16x16x32_bf16 a[56:59], a[124:127], a[88:91], a[56:59]
 v_add_u32 v9, s62, v10
 v_mfma_f32_16x16x32_bf16 a[52:55], a[120:123], a[68:71], a[52:55]
 ds_read_b64_tr_b16 a[116:117], v44 offset:45056
 v_and_b32 v12, 15, v2
 v_mfma_f32_16x16x32_bf16 a[52:55], a[124:127], a[84:87], a[52:55]
 v_lshrrev_b32 v13, 4, v2
 v_mfma_f32_16x16x32_bf16 a[48:51], a[120:123], a[64:67], a[48:51]
 ds_read_b64_tr_b16 a[118:119], v44 offset:45568
 v_mfma_f32_16x16x32_bf16 a[48:51], a[124:127], a[80:83], a[48:51]
 s_mul_i32 s62, s52, 8704
 s_waitcnt lgkmcnt(8)
 v_mfma_f32_16x16x32_bf16 a[128:131], a[96:99], a[64:67], a[128:131]
 ds_read_b64_tr_b16 a[120:121], v45 offset:40960
 s_add_u32 s62, s62, 114688
 v_mfma_f32_16x16x32_bf16 a[128:131], a[100:103], a[80:83], a[128:131]
 v_mov_b32 v14, s62
 v_mfma_f32_16x16x32_bf16 a[132:135], a[96:99], a[68:71], a[132:135]
 ds_read_b64_tr_b16 a[122:123], v45 offset:41472
 s_movk_i32 s62, 136
 v_mfma_f32_16x16x32_bf16 a[132:135], a[100:103], a[84:87], a[132:135]
 v_mad_u32_u24 v12, v12, s62, v14
 v_mfma_f32_16x16x32_bf16 a[136:139], a[96:99], a[72:75], a[136:139]
 ds_read_b64_tr_b16 a[124:125], v45 offset:45056
 v_lshl_add_u32 v12, v13, 3, v12
 v_mfma_f32_16x16x32_bf16 a[136:139], a[100:103], a[88:91], a[136:139]
 v_mfma_f32_16x16x32_bf16 a[140:143], a[96:99], a[76:79], a[140:143]
 ds_read_b64_tr_b16 a[126:127], v45 offset:45568
 s_lshl_b32 s63, s52, 5
 v_mfma_f32_16x16x32_bf16 a[140:143], a[100:103], a[92:95], a[140:143]
 s_add_u32 s63, s63, 114688
 s_waitcnt lgkmcnt(8)
 v_mfma_f32_16x16x32_bf16 a[156:159], a[104:107], a[76:79], a[156:159]
 ds_read_b64_tr_b16 a[96:97], v46 offset:32768
 v_mov_b32 v14, s63
 v_mfma_f32_16x16x32_bf16 a[156:159], a[108:111], a[92:95], a[156:159]
 v_lshrrev_b32 v13, 2, v2
 v_mfma_f32_16x16x32_bf16 a[152:155], a[104:107], a[72:75], a[152:155]
 ds_read_b64_tr_b16 a[98:99], v46 offset:33024
 v_mad_u32_u24 v13, v13, s62, v14
 v_mfma_f32_16x16x32_bf16 a[152:155], a[108:111], a[88:91], a[152:155]
 v_and_b32 v15, 3, v2
 v_mfma_f32_16x16x32_bf16 a[148:151], a[104:107], a[68:71], a[148:151]
 ds_read_b64_tr_b16 a[100:101], v46 offset:40960
 v_lshl_add_u32 v13, v15, 3, v13
 v_mfma_f32_16x16x32_bf16 a[148:151], a[108:111], a[84:87], a[148:151]
 v_mfma_f32_16x16x32_bf16 a[144:147], a[104:107], a[64:67], a[144:147]
 ds_read_b64_tr_b16 a[102:103], v46 offset:41216
 v_add_u32 v15, 98304, v10
 v_mfma_f32_16x16x32_bf16 a[144:147], a[108:111], a[80:83], a[144:147]
 s_lshl_b32 s58, s53, 3
 s_waitcnt lgkmcnt(8)
 v_mfma_f32_16x16x32_bf16 a[160:163], a[112:115], a[64:67], a[160:163]
 ds_read_b64_tr_b16 a[104:105], v47 offset:32768
 s_add_u32 s58, s58, s54
 v_mfma_f32_16x16x32_bf16 a[160:163], a[116:119], a[80:83], a[160:163]
 s_mul_i32 s58, s58, 12288
 v_mfma_f32_16x16x32_bf16 a[164:167], a[112:115], a[68:71], a[164:167]
 ds_read_b64_tr_b16 a[106:107], v47 offset:33024
 s_mul_i32 s62, s52, 3072
 v_mfma_f32_16x16x32_bf16 a[164:167], a[116:119], a[84:87], a[164:167]
 s_add_u32 s58, s58, s62
 v_mfma_f32_16x16x32_bf16 a[168:171], a[112:115], a[72:75], a[168:171]
 ds_read_b64_tr_b16 a[108:109], v47 offset:40960
 v_mfma_f32_16x16x32_bf16 a[168:171], a[116:119], a[88:91], a[168:171]
 s_add_u32 s58, s58, 0x3800000
 v_mfma_f32_16x16x32_bf16 a[172:175], a[112:115], a[76:79], a[172:175]
 ds_read_b64_tr_b16 a[110:111], v47 offset:41216
 v_and_b32 v14, 15, v3
 v_mfma_f32_16x16x32_bf16 a[172:175], a[116:119], a[92:95], a[172:175]
 v_lshlrev_b32 v14, 4, v14
 s_waitcnt lgkmcnt(8)
 v_mfma_f32_16x16x32_bf16 a[188:191], a[120:123], a[76:79], a[188:191]
 ds_read_b64_tr_b16 a[112:113], v46 offset:33792
 v_lshl_add_u32 v14, v4, 8, v14
 v_mfma_f32_16x16x32_bf16 a[188:191], a[124:127], a[92:95], a[188:191]
 v_lshrrev_b32 v8, 4, v3
 v_mfma_f32_16x16x32_bf16 a[184:187], a[120:123], a[72:75], a[184:187]
 ds_read_b64_tr_b16 a[114:115], v46 offset:34048
 v_lshl_add_u32 v14, v8, 10, v14
 v_mfma_f32_16x16x32_bf16 a[184:187], a[124:127], a[88:91], a[184:187]
 v_mfma_f32_16x16x32_bf16 a[180:183], a[120:123], a[68:71], a[180:183]
 ds_read_b64_tr_b16 a[116:117], v46 offset:41984
 s_lshl_b32 s66, s52, 5
 v_mfma_f32_16x16x32_bf16 a[180:183], a[124:127], a[84:87], a[180:183]
 v_lshlrev_b32 v4, 2, v4
 v_mfma_f32_16x16x32_bf16 a[176:179], a[120:123], a[64:67], a[176:179]
 ds_read_b64_tr_b16 a[118:119], v46 offset:42240
 v_sub_u32 v4, v3, v4
 v_mfma_f32_16x16x32_bf16 a[176:179], a[124:127], a[80:83], a[176:179]
 v_add_u32 v4, s66, v4
 s_waitcnt lgkmcnt(8)
 v_mfma_f32_16x16x32_bf16 v[80:83], a[96:99], a[64:67], v[80:83]
 ds_read_b64_tr_b16 a[120:121], v47 offset:33792
 v_cvt_f32_i32 v4, v4
 v_mfma_f32_16x16x32_bf16 v[80:83], a[100:103], a[80:83], v[80:83]
 v_add_f32 v4, 0.5, v4
 v_mfma_f32_16x16x32_bf16 v[84:87], a[96:99], a[68:71], v[84:87]
 ds_read_b64_tr_b16 a[122:123], v47 offset:34048
 v_mfma_f32_16x16x32_bf16 v[84:87], a[100:103], a[84:87], v[84:87]
 v_mul_f32 v4, 0x5f800000, v4
 v_mfma_f32_16x16x32_bf16 v[88:91], a[96:99], a[72:75], v[88:91]
 ds_read_b64_tr_b16 a[124:125], v47 offset:41984
 s_lshl_b32 s66, s52, 11
 v_mfma_f32_16x16x32_bf16 v[88:91], a[100:103], a[88:91], v[88:91]
 v_add_u32 v3, s66, v14
 v_mfma_f32_16x16x32_bf16 v[92:95], a[96:99], a[76:79], v[92:95]
 ds_read_b64_tr_b16 a[126:127], v47 offset:42240
 v_lshlrev_b32 v14, 7, v0
 v_mfma_f32_16x16x32_bf16 v[92:95], a[100:103], a[92:95], v[92:95]
 s_lshr_b32 s48, s2, 3
 s_waitcnt lgkmcnt(8)
 v_mfma_f32_16x16x32_bf16 v[124:127], a[104:107], a[76:79], v[124:127]
 ds_read_b64_tr_b16 a[96:97], v46 offset:34816
 s_mul_i32 s77, s54, 1310720
 v_mfma_f32_16x16x32_bf16 v[124:127], a[108:111], a[92:95], v[124:127]
 v_mfma_f32_16x16x32_bf16 v[120:123], a[104:107], a[72:75], v[120:123]
 ds_read_b64_tr_b16 a[98:99], v46 offset:35072
 s_mul_i32 s78, s55, 1310720
 v_mfma_f32_16x16x32_bf16 v[120:123], a[108:111], a[88:91], v[120:123]
 s_lshl_b32 s66, s53, 15
 v_mfma_f32_16x16x32_bf16 v[116:119], a[104:107], a[68:71], v[116:119]
 ds_read_b64_tr_b16 a[100:101], v46 offset:43008
 s_add_u32 s66, s66, 0x4040000
 v_mfma_f32_16x16x32_bf16 v[116:119], a[108:111], a[84:87], v[116:119]
 s_add_u32 s69, s77, s66
 v_mfma_f32_16x16x32_bf16 v[112:115], a[104:107], a[64:67], v[112:115]
 ds_read_b64_tr_b16 a[102:103], v46 offset:43264
 s_add_u32 s70, s78, s66
 v_mfma_f32_16x16x32_bf16 v[112:115], a[108:111], a[80:83], v[112:115]
 s_mov_b32 s39, 0x47800000
 s_waitcnt lgkmcnt(8)
 v_mfma_f32_16x16x32_bf16 v[144:147], a[112:115], a[64:67], v[144:147]
 ds_read_b64_tr_b16 a[104:105], v47 offset:34816
 s_mov_b32 s44, 0
 v_mfma_f32_16x16x32_bf16 v[144:147], a[116:119], a[80:83], v[144:147]
 v_mfma_f32_16x16x32_bf16 v[148:151], a[112:115], a[68:71], v[148:151]
 ds_read_b64_tr_b16 a[106:107], v47 offset:35072
 s_lshl_b32 s47, s54, 2
 v_mfma_f32_16x16x32_bf16 v[148:151], a[116:119], a[84:87], v[148:151]
 s_sub_u32 s45, s47, 2
 v_mfma_f32_16x16x32_bf16 v[152:155], a[112:115], a[72:75], v[152:155]
 ds_read_b64_tr_b16 a[108:109], v47 offset:43008
 s_mov_b32 s46, 30
 v_mfma_f32_16x16x32_bf16 v[152:155], a[116:119], a[88:91], v[152:155]
 s_mov_b32 s42, 0x8000
 v_mfma_f32_16x16x32_bf16 v[156:159], a[112:115], a[76:79], v[156:159]
 ds_read_b64_tr_b16 a[110:111], v47 offset:43264
 s_mov_b32 s12, s82
 v_mfma_f32_16x16x32_bf16 v[156:159], a[116:119], a[92:95], v[156:159]
 s_and_b32 s13, s83, 0xffff
 s_waitcnt lgkmcnt(8)
 v_mfma_f32_16x16x32_bf16 v[188:191], a[120:123], a[76:79], v[188:191]
 v_mfma_f32_16x16x32_bf16 v[188:191], a[124:127], a[92:95], v[188:191]
 s_mov_b32 s14, 0x800000
 v_mfma_f32_16x16x32_bf16 v[184:187], a[120:123], a[72:75], v[184:187]
 s_mov_b32 s15, 0x20000
 v_mfma_f32_16x16x32_bf16 v[184:187], a[124:127], a[88:91], v[184:187]
 s_waitcnt lgkmcnt(0) vmcnt(0)
 s_barrier
 v_mfma_f32_16x16x32_bf16 v[180:183], a[120:123], a[68:71], v[180:183]
 ds_read_b64_tr_b16 a[112:113], v52 offset:2048
 s_mov_b32 s16, s80
 v_mfma_f32_16x16x32_bf16 v[180:183], a[124:127], a[84:87], v[180:183]
 ds_read_b64_tr_b16 a[114:115], v52 offset:2304
 s_and_b32 s17, s81, 0xffff
 v_mfma_f32_16x16x32_bf16 v[176:179], a[120:123], a[64:67], v[176:179]
 ds_read_b64_tr_b16 a[116:117], v52 offset:10240
 s_mov_b32 s18, 0x200000
 v_mfma_f32_16x16x32_bf16 v[176:179], a[124:127], a[80:83], v[176:179]
 ds_read_b64_tr_b16 a[118:119], v52 offset:10496
 v_mfma_f32_16x16x32_bf16 a[192:195], a[64:67], a[96:99], a[192:195]
 ds_read_b128 a[224:227], v40 offset:8192
 s_mov_b32 s19, 0x20000
 v_mfma_f32_16x16x32_bf16 a[192:195], a[80:83], a[100:103], a[192:195]
 ds_read_b128 a[240:243], v41 offset:8192
 s_lshl_b32 s75, s2, 15
 v_mfma_f32_16x16x32_bf16 a[196:199], a[68:71], a[96:99], a[196:199]
 ds_read_b128 a[228:231], v40 offset:10240
 s_lshl_b32 s76, s2, 13
 v_mfma_f32_16x16x32_bf16 a[196:199], a[84:87], a[100:103], a[196:199]
 ds_read_b128 a[244:247], v41 offset:10240
 s_lshl_b32 s72, s52, 13
 v_mfma_f32_16x16x32_bf16 a[200:203], a[72:75], a[96:99], a[200:203]
 ds_read_b128 a[232:235], v40 offset:12288
 s_add_u32 s72, s72, 0x20000
 v_mfma_f32_16x16x32_bf16 a[200:203], a[88:91], a[100:103], a[200:203]
 ds_read_b128 a[248:251], v41 offset:12288
 s_add_u32 s79, s47, 5
 v_mfma_f32_16x16x32_bf16 a[204:207], a[76:79], a[96:99], a[204:207]
 ds_read_b128 a[236:239], v40 offset:14336
 s_mov_b64 s[30:31], 0xff
 v_mfma_f32_16x16x32_bf16 a[204:207], a[92:95], a[100:103], a[204:207]
 ds_read_b128 a[252:255], v41 offset:14336
 v_mfma_f32_16x16x32_bf16 a[220:223], a[76:79], a[104:107], a[220:223]
 ds_read_b64_tr_b16 a[120:121], v53 offset:2048
 s_lshr_b32 s95, s54, 1
 v_mfma_f32_16x16x32_bf16 a[220:223], a[92:95], a[108:111], a[220:223]
 ds_read_b64_tr_b16 a[122:123], v53 offset:2304
 s_and_b32 s95, s95, s54
 v_mfma_f32_16x16x32_bf16 a[216:219], a[72:75], a[104:107], a[216:219]
 ds_read_b64_tr_b16 a[124:125], v53 offset:10240
 s_lshr_b32 s66, s54, 2
 v_mfma_f32_16x16x32_bf16 a[216:219], a[88:91], a[108:111], a[216:219]
 ds_read_b64_tr_b16 a[126:127], v53 offset:10496
 s_and_b32 s95, s95, s66
 v_mfma_f32_16x16x32_bf16 a[212:215], a[68:71], a[104:107], a[212:215]
 ds_read_b64_tr_b16 a[96:97], v52 offset:1024
 s_mul_i32 s95, s95, -95
 v_mfma_f32_16x16x32_bf16 a[212:215], a[84:87], a[108:111], a[212:215]
 ds_read_b64_tr_b16 a[98:99], v52 offset:1280
 s_add_u32 s95, s95, 99
 v_mfma_f32_16x16x32_bf16 a[208:211], a[64:67], a[104:107], a[208:211]
 ds_read_b64_tr_b16 a[100:101], v52 offset:9216
 v_mfma_f32_16x16x32_bf16 a[208:211], a[80:83], a[108:111], a[208:211]
 ds_read_b64_tr_b16 a[102:103], v52 offset:9472
F_step23:
 s_waitcnt lgkmcnt(8)
 v_mfma_f32_16x16x32_bf16 a[192:195], a[224:227], a[112:115], a[192:195]
 ds_read_b64_tr_b16 a[104:105], v53 offset:1024
 v_mfma_f32_16x16x32_bf16 a[192:195], a[240:243], a[116:119], a[192:195]
 buffer_load_dword v59, v39, s[20:23], s32 offen sc1
 v_mfma_f32_16x16x32_bf16 a[196:199], a[228:231], a[112:115], a[196:199]
 ds_read_b64_tr_b16 a[106:107], v53 offset:1280
 v_mfma_f32_16x16x32_bf16 a[196:199], a[244:247], a[116:119], a[196:199]
 v_mfma_f32_16x16x32_bf16 a[200:203], a[232:235], a[112:115], a[200:203]
 ds_read_b64_tr_b16 a[108:109], v53 offset:9216
 v_mfma_f32_16x16x32_bf16 a[200:203], a[248:251], a[116:119], a[200:203]
 v_mfma_f32_16x16x32_bf16 a[204:207], a[236:239], a[112:115], a[204:207]
 ds_read_b64_tr_b16 a[110:111], v53 offset:9472
 v_mfma_f32_16x16x32_bf16 a[204:207], a[252:255], a[116:119], a[204:207]
 s_waitcnt lgkmcnt(8)
 v_mfma_f32_16x16x32_bf16 a[220:223], a[236:239], a[120:123], a[220:223]
 ds_read_b64_tr_b16 a[112:113], v52 offset:0
 v_mfma_f32_16x16x32_bf16 a[220:223], a[252:255], a[124:127], a[220:223]
 v_mfma_f32_16x16x32_bf16 a[216:219], a[232:235], a[120:123], a[216:219]
 ds_read_b64_tr_b16 a[114:115], v52 offset:256
 v_mfma_f32_16x16x32_bf16 a[216:219], a[248:251], a[124:127], a[216:219]
 v_mfma_f32_16x16x32_bf16 a[212:215], a[228:231], a[120:123], a[212:215]
 ds_read_b64_tr_b16 a[116:117], v52 offset:8192
 v_accvgpr_read_b32 v192, a192
 v_mfma_f32_16x16x32_bf16 a[212:215], a[244:247], a[124:127], a[212:215]
 v_accvgpr_read_b32 v193, a193
 v_accvgpr_read_b32 v194, a194
 v_mfma_f32_16x16x32_bf16 a[208:211], a[224:227], a[120:123], a[208:211]
 ds_read_b64_tr_b16 a[118:119], v52 offset:8448
 v_accvgpr_read_b32 v195, a195
 v_mfma_f32_16x16x32_bf16 a[208:211], a[240:243], a[124:127], a[208:211]
 v_accvgpr_read_b32 v196, a196
 s_waitcnt lgkmcnt(8)
 v_mfma_f32_16x16x32_bf16 v[144:147], a[96:99], a[224:227], v[144:147]
 ds_read_b64_tr_b16 a[120:121], v53 offset:0
 v_accvgpr_read_b32 v197, a197
 v_mfma_f32_16x16x32_bf16 v[144:147], a[100:103], a[240:243], v[144:147]
 v_accvgpr_read_b32 v198, a198
 v_accvgpr_read_b32 v199, a199
 v_mfma_f32_16x16x32_bf16 v[148:151], a[96:99], a[228:231], v[148:151]
 ds_read_b64_tr_b16 a[122:123], v53 offset:256
 v_cvt_pk_bf16_f32 v128, v192, v193
 v_mfma_f32_16x16x32_bf16 v[148:151], a[100:103], a[244:247], v[148:151]
 v_cvt_pk_bf16_f32 v129, v194, v195
 v_cvt_pk_bf16_f32 v130, v196, v197
 v_mfma_f32_16x16x32_bf16 v[152:155], a[96:99], a[232:235], v[152:155]
 ds_read_b64_tr_b16 a[124:125], v53 offset:8192
 v_cvt_pk_bf16_f32 v131, v198, v199
 v_mfma_f32_16x16x32_bf16 v[152:155], a[100:103], a[248:251], v[152:155]
 v_accvgpr_read_b32 v200, a200
 v_accvgpr_read_b32 v201, a201
 v_mfma_f32_16x16x32_bf16 v[156:159], a[96:99], a[236:239], v[156:159]
 ds_read_b64_tr_b16 a[126:127], v53 offset:8448
 v_accvgpr_read_b32 v202, a202
 v_mfma_f32_16x16x32_bf16 v[156:159], a[100:103], a[252:255], v[156:159]
 v_accvgpr_read_b32 v203, a203
 s_waitcnt lgkmcnt(8)
 v_mfma_f32_16x16x32_bf16 v[188:191], a[104:107], a[236:239], v[188:191]
 ds_read_b64_tr_b16 a[96:97], v48 offset:0
 v_accvgpr_read_b32 v204, a204
 v_mfma_f32_16x16x32_bf16 v[188:191], a[108:111], a[252:255], v[188:191]
 v_accvgpr_read_b32 v205, a205
 v_accvgpr_read_b32 v206, a206
 v_mfma_f32_16x16x32_bf16 v[184:187], a[104:107], a[232:235], v[184:187]
 ds_read_b64_tr_b16 a[98:99], v48 offset:512
 v_accvgpr_read_b32 v207, a207
 v_mfma_f32_16x16x32_bf16 v[184:187], a[108:111], a[248:251], v[184:187]
 v_cvt_pk_bf16_f32 v136, v200, v201
 v_cvt_pk_bf16_f32 v137, v202, v203
 v_mfma_f32_16x16x32_bf16 v[180:183], a[104:107], a[228:231], v[180:183]
 ds_read_b64_tr_b16 a[100:101], v48 offset:4096
 v_cvt_pk_bf16_f32 v138, v204, v205
 v_mfma_f32_16x16x32_bf16 v[180:183], a[108:111], a[244:247], v[180:183]
 v_cvt_pk_bf16_f32 v139, v206, v207
 v_accvgpr_read_b32 v192, a208
 v_mfma_f32_16x16x32_bf16 v[176:179], a[104:107], a[224:227], v[176:179]
 ds_read_b64_tr_b16 a[102:103], v48 offset:4608
 v_accvgpr_read_b32 v193, a209
 v_mfma_f32_16x16x32_bf16 v[176:179], a[108:111], a[240:243], v[176:179]
 v_accvgpr_read_b32 v194, a210
 s_waitcnt lgkmcnt(8)
 v_mfma_f32_16x16x32_bf16 v[80:83], a[112:115], a[224:227], v[80:83]
 ds_read_b64_tr_b16 a[104:105], v49 offset:0
 v_accvgpr_read_b32 v195, a211
 v_mfma_f32_16x16x32_bf16 v[80:83], a[116:119], a[240:243], v[80:83]
 v_accvgpr_read_b32 v196, a212
 v_accvgpr_read_b32 v197, a213
 v_mfma_f32_16x16x32_bf16 v[84:87], a[112:115], a[228:231], v[84:87]
 ds_read_b64_tr_b16 a[106:107], v49 offset:512
 v_accvgpr_read_b32 v198, a214
 v_mfma_f32_16x16x32_bf16 v[84:87], a[116:119], a[244:247], v[84:87]
 v_accvgpr_read_b32 v199, a215
 v_cvt_pk_bf16_f32 v132, v192, v193
 v_mfma_f32_16x16x32_bf16 v[88:91], a[112:115], a[232:235], v[88:91]
 ds_read_b64_tr_b16 a[108:109], v49 offset:4096
 v_cvt_pk_bf16_f32 v133, v194, v195
 v_mfma_f32_16x16x32_bf16 v[88:91], a[116:119], a[248:251], v[88:91]
 v_cvt_pk_bf16_f32 v134, v196, v197
 v_cvt_pk_bf16_f32 v135, v198, v199
 v_mfma_f32_16x16x32_bf16 v[92:95], a[112:115], a[236:239], v[92:95]
 ds_read_b64_tr_b16 a[110:111], v49 offset:4608
 v_accvgpr_read_b32 v200, a216
 v_mfma_f32_16x16x32_bf16 v[92:95], a[116:119], a[252:255], v[92:95]
 v_accvgpr_read_b32 v201, a217
 s_waitcnt lgkmcnt(8)
 v_mfma_f32_16x16x32_bf16 v[124:127], a[120:123], a[236:239], v[124:127]
 ds_read_b64_tr_b16 a[112:113], v50 offset:0
 v_accvgpr_read_b32 v202, a218
 v_mfma_f32_16x16x32_bf16 v[124:127], a[124:127], a[252:255], v[124:127]
 v_accvgpr_read_b32 v203, a219
 v_accvgpr_read_b32 v204, a220
 v_mfma_f32_16x16x32_bf16 v[120:123], a[120:123], a[232:235], v[120:123]
 ds_read_b64_tr_b16 a[114:115], v50 offset:512
 v_accvgpr_read_b32 v205, a221
 v_mfma_f32_16x16x32_bf16 v[120:123], a[124:127], a[248:251], v[120:123]
 v_accvgpr_read_b32 v206, a222
 v_mfma_f32_16x16x32_bf16 v[116:119], a[120:123], a[228:231], v[116:119]
 ds_read_b64_tr_b16 a[116:117], v50 offset:4096
 v_accvgpr_read_b32 v207, a223
 v_mfma_f32_16x16x32_bf16 v[116:119], a[124:127], a[244:247], v[116:119]
 v_cvt_pk_bf16_f32 v140, v200, v201
 v_mfma_f32_16x16x32_bf16 v[112:115], a[120:123], a[224:227], v[112:115]
 ds_read_b64_tr_b16 a[118:119], v50 offset:4608
 v_cvt_pk_bf16_f32 v141, v202, v203
 v_mfma_f32_16x16x32_bf16 v[112:115], a[124:127], a[240:243], v[112:115]
 v_cvt_pk_bf16_f32 v142, v204, v205
 s_waitcnt lgkmcnt(8)
 v_mfma_f32_16x16x32_bf16 a[0:3], a[96:99], a[224:227], a[0:3]
 ds_read_b64_tr_b16 a[120:121], v51 offset:0
 v_cvt_pk_bf16_f32 v143, v206, v207
 v_mfma_f32_16x16x32_bf16 a[0:3], a[100:103], a[240:243], a[0:3]
 v_cvt_pk_bf16_f32 v144, v144, v145
 v_mfma_f32_16x16x32_bf16 a[4:7], a[96:99], a[228:231], a[4:7]
 ds_read_b64_tr_b16 a[122:123], v51 offset:512
 v_cvt_pk_bf16_f32 v145, v146, v147
 v_mfma_f32_16x16x32_bf16 a[4:7], a[100:103], a[244:247], a[4:7]
 v_cvt_pk_bf16_f32 v146, v176, v177
 v_mfma_f32_16x16x32_bf16 a[8:11], a[96:99], a[232:235], a[8:11]
 ds_read_b64_tr_b16 a[124:125], v51 offset:4096
 v_cvt_pk_bf16_f32 v147, v178, v179
 v_mfma_f32_16x16x32_bf16 a[8:11], a[100:103], a[248:251], a[8:11]
 v_cvt_pk_bf16_f32 v148, v148, v149
 v_mfma_f32_16x16x32_bf16 a[12:15], a[96:99], a[236:239], a[12:15]
 ds_read_b64_tr_b16 a[126:127], v51 offset:4608
 v_cvt_pk_bf16_f32 v149, v150, v151
 v_mfma_f32_16x16x32_bf16 a[12:15], a[100:103], a[252:255], a[12:15]
 v_cvt_pk_bf16_f32 v150, v180, v181
 s_waitcnt lgkmcnt(8)
 v_mfma_f32_16x16x32_bf16 a[28:31], a[104:107], a[236:239], a[28:31]
 ds_read_b64_tr_b16 a[96:97], v48 offset:8192
 v_cvt_pk_bf16_f32 v151, v182, v183
 v_mfma_f32_16x16x32_bf16 a[28:31], a[108:111], a[252:255], a[28:31]
 v_cvt_pk_bf16_f32 v152, v152, v153
 v_mfma_f32_16x16x32_bf16 a[24:27], a[104:107], a[232:235], a[24:27]
 ds_read_b64_tr_b16 a[98:99], v48 offset:8704
 v_cvt_pk_bf16_f32 v153, v154, v155
 v_mfma_f32_16x16x32_bf16 a[24:27], a[108:111], a[248:251], a[24:27]
 v_cvt_pk_bf16_f32 v154, v184, v185
 v_mfma_f32_16x16x32_bf16 a[20:23], a[104:107], a[228:231], a[20:23]
 ds_read_b64_tr_b16 a[100:101], v48 offset:12288
 v_cvt_pk_bf16_f32 v155, v186, v187
 v_mfma_f32_16x16x32_bf16 a[20:23], a[108:111], a[244:247], a[20:23]
 v_cvt_pk_bf16_f32 v156, v156, v157
 v_mfma_f32_16x16x32_bf16 a[16:19], a[104:107], a[224:227], a[16:19]
 ds_read_b64_tr_b16 a[102:103], v48 offset:12800
 v_cvt_pk_bf16_f32 v157, v158, v159
 v_mfma_f32_16x16x32_bf16 a[16:19], a[108:111], a[240:243], a[16:19]
 v_cvt_pk_bf16_f32 v158, v188, v189
 s_waitcnt lgkmcnt(8)
 v_mfma_f32_16x16x32_bf16 a[32:35], a[112:115], a[224:227], a[32:35]
 ds_read_b64_tr_b16 a[104:105], v49 offset:8192
 v_cvt_pk_bf16_f32 v159, v190, v191
 v_mfma_f32_16x16x32_bf16 a[32:35], a[116:119], a[240:243], a[32:35]
 v_cvt_pk_bf16_f32 v80, v80, v81
 v_mfma_f32_16x16x32_bf16 a[36:39], a[112:115], a[228:231], a[36:39]
 ds_read_b64_tr_b16 a[106:107], v49 offset:8704
 v_cvt_pk_bf16_f32 v81, v82, v83
 v_mfma_f32_16x16x32_bf16 a[36:39], a[116:119], a[244:247], a[36:39]
 v_cvt_pk_bf16_f32 v82, v112, v113
 v_mfma_f32_16x16x32_bf16 a[40:43], a[112:115], a[232:235], a[40:43]
 ds_read_b64_tr_b16 a[108:109], v49 offset:12288
 v_cvt_pk_bf16_f32 v83, v114, v115
 v_mfma_f32_16x16x32_bf16 a[40:43], a[116:119], a[248:251], a[40:43]
 v_cvt_pk_bf16_f32 v84, v84, v85
 v_mfma_f32_16x16x32_bf16 a[44:47], a[112:115], a[236:239], a[44:47]
 ds_read_b64_tr_b16 a[110:111], v49 offset:12800
 v_cvt_pk_bf16_f32 v85, v86, v87
 v_mfma_f32_16x16x32_bf16 a[44:47], a[116:119], a[252:255], a[44:47]
 v_cvt_pk_bf16_f32 v86, v116, v117
 s_waitcnt lgkmcnt(8)
 v_mfma_f32_16x16x32_bf16 a[60:63], a[120:123], a[236:239], a[60:63]
 ds_read_b64_tr_b16 a[112:113], v50 offset:8192
 v_cvt_pk_bf16_f32 v87, v118, v119
 v_mfma_f32_16x16x32_bf16 a[60:63], a[124:127], a[252:255], a[60:63]
 v_cvt_pk_bf16_f32 v88, v88, v89
 v_mfma_f32_16x16x32_bf16 a[56:59], a[120:123], a[232:235], a[56:59]
 ds_read_b64_tr_b16 a[114:115], v50 offset:8704
 v_cvt_pk_bf16_f32 v89, v90, v91
 v_mfma_f32_16x16x32_bf16 a[56:59], a[124:127], a[248:251], a[56:59]
 v_cvt_pk_bf16_f32 v90, v120, v121
 v_mfma_f32_16x16x32_bf16 a[52:55], a[120:123], a[228:231], a[52:55]
 ds_read_b64_tr_b16 a[116:117], v50 offset:12288
 v_cvt_pk_bf16_f32 v91, v122, v123
 v_mfma_f32_16x16x32_bf16 a[52:55], a[124:127], a[244:247], a[52:55]
 v_cvt_pk_bf16_f32 v92, v92, v93
 v_mfma_f32_16x16x32_bf16 a[48:51], a[120:123], a[224:227], a[48:51]
 ds_read_b64_tr_b16 a[118:119], v50 offset:12800
 v_cvt_pk_bf16_f32 v93, v94, v95
 v_mfma_f32_16x16x32_bf16 a[48:51], a[124:127], a[240:243], a[48:51]
 v_cvt_pk_bf16_f32 v94, v124, v125
 s_waitcnt lgkmcnt(8)
 v_mfma_f32_16x16x32_bf16 a[128:131], a[96:99], a[224:227], a[128:131]
 ds_read_b64_tr_b16 a[120:121], v51 offset:8192
 v_cvt_pk_bf16_f32 v95, v126, v127
 v_mfma_f32_16x16x32_bf16 a[128:131], a[100:103], a[240:243], a[128:131]
 v_accvgpr_read_b32 v192, a8
 v_mfma_f32_16x16x32_bf16 a[132:135], a[96:99], a[228:231], a[132:135]
 ds_read_b64_tr_b16 a[122:123], v51 offset:8704
 v_accvgpr_read_b32 v193, a9
 v_mfma_f32_16x16x32_bf16 a[132:135], a[100:103], a[244:247], a[132:135]
 v_accvgpr_read_b32 v194, a10
 v_mfma_f32_16x16x32_bf16 a[136:139], a[96:99], a[232:235], a[136:139]
 ds_read_b64_tr_b16 a[124:125], v51 offset:12288
 v_accvgpr_read_b32 v195, a11
 v_mfma_f32_16x16x32_bf16 a[136:139], a[100:103], a[248:251], a[136:139]
 v_accvgpr_read_b32 v196, a24
 v_mfma_f32_16x16x32_bf16 a[140:143], a[96:99], a[236:239], a[140:143]
 ds_read_b64_tr_b16 a[126:127], v51 offset:12800
 v_accvgpr_read_b32 v197, a25
 v_mfma_f32_16x16x32_bf16 a[140:143], a[100:103], a[252:255], a[140:143]
 v_accvgpr_read_b32 v198, a26
 s_waitcnt lgkmcnt(8)
 v_mfma_f32_16x16x32_bf16 a[156:159], a[104:107], a[236:239], a[156:159]
 v_accvgpr_read_b32 v199, a27
 v_mfma_f32_16x16x32_bf16 a[156:159], a[108:111], a[252:255], a[156:159]
 v_accvgpr_read_b32 v200, a12
 v_mfma_f32_16x16x32_bf16 a[152:155], a[104:107], a[232:235], a[152:155]
 v_accvgpr_read_b32 v201, a13
 v_mfma_f32_16x16x32_bf16 a[152:155], a[108:111], a[248:251], a[152:155]
 v_accvgpr_read_b32 v202, a14
 v_mfma_f32_16x16x32_bf16 a[148:151], a[104:107], a[228:231], a[148:151]
 v_accvgpr_read_b32 v203, a15
 v_mfma_f32_16x16x32_bf16 a[148:151], a[108:111], a[244:247], a[148:151]
 v_accvgpr_read_b32 v204, a28
 v_mfma_f32_16x16x32_bf16 a[144:147], a[104:107], a[224:227], a[144:147]
 v_accvgpr_read_b32 v205, a29
 v_mfma_f32_16x16x32_bf16 a[144:147], a[108:111], a[240:243], a[144:147]
 v_accvgpr_read_b32 v206, a30
 s_waitcnt lgkmcnt(4)
 v_mfma_f32_16x16x32_bf16 a[160:163], a[112:115], a[224:227], a[160:163]
 v_accvgpr_read_b32 v207, a31
 v_mfma_f32_16x16x32_bf16 a[160:163], a[116:119], a[240:243], a[160:163]
 v_mfma_f32_16x16x32_bf16 a[164:167], a[112:115], a[228:231], a[164:167]
 v_mfma_f32_16x16x32_bf16 a[164:167], a[116:119], a[244:247], a[164:167]
 v_mfma_f32_16x16x32_bf16 a[168:171], a[112:115], a[232:235], a[168:171]
 v_mfma_f32_16x16x32_bf16 a[168:171], a[116:119], a[248:251], a[168:171]
 v_mfma_f32_16x16x32_bf16 a[172:175], a[112:115], a[236:239], a[172:175]
 v_mfma_f32_16x16x32_bf16 a[172:175], a[116:119], a[252:255], a[172:175]
 s_waitcnt lgkmcnt(0)
 v_mfma_f32_16x16x32_bf16 a[188:191], a[120:123], a[236:239], a[188:191]
 v_mfma_f32_16x16x32_bf16 a[188:191], a[124:127], a[252:255], a[188:191]
 v_mfma_f32_16x16x32_bf16 a[184:187], a[120:123], a[232:235], a[184:187]
 v_mfma_f32_16x16x32_bf16 a[184:187], a[124:127], a[248:251], a[184:187]
 v_mfma_f32_16x16x32_bf16 a[180:183], a[120:123], a[228:231], a[180:183]
 v_mfma_f32_16x16x32_bf16 a[180:183], a[124:127], a[244:247], a[180:183]
 v_mfma_f32_16x16x32_bf16 a[176:179], a[120:123], a[224:227], a[176:179]
 v_mfma_f32_16x16x32_bf16 a[176:179], a[124:127], a[240:243], a[176:179]
F_e2:
 s_waitcnt vmcnt(0) lgkmcnt(0)
 v_cmp_gt_u32 s[66:67], 0x40000000, v39
 v_cmp_ne_u32 vcc, s89, v59
 s_nop 0
 s_and_b64 vcc, vcc, s[66:67]
 s_cbranch_vccnz F_spin1
F_spin1_b:
 s_barrier
 v_pk_mul_f32 v[192:193], v[192:193], s[60:61]
 v_pk_mul_f32 v[194:195], v[194:195], s[60:61]
 v_pk_mul_f32 v[196:197], v[196:197], s[60:61]
 v_pk_mul_f32 v[198:199], v[198:199], s[60:61]
 v_cvt_pk_bf16_f32 v48, v192, v193
 v_cvt_pk_bf16_f32 v49, v194, v195
 v_cvt_pk_bf16_f32 v50, v196, v197
 v_cvt_pk_bf16_f32 v51, v198, v199
 v_pk_mul_f32 v[200:201], v[200:201], s[60:61]
 v_pk_mul_f32 v[202:203], v[202:203], s[60:61]
 v_pk_mul_f32 v[204:205], v[204:205], s[60:61]
 v_pk_mul_f32 v[206:207], v[206:207], s[60:61]
 v_cvt_pk_bf16_f32 v52, v200, v201
 v_cvt_pk_bf16_f32 v53, v202, v203
 v_cvt_pk_bf16_f32 v54, v204, v205
 v_cvt_pk_bf16_f32 v55, v206, v207
 v_mfma_f32_16x16x32_bf16 v[96:99], v[16:19], v[144:147], 0
 v_accvgpr_read_b32 v208, a40
 v_accvgpr_read_b32 v209, a41
 v_accvgpr_read_b32 v210, a42
 s_mov_b32 m0, s41
 s_add_u32 s41, s41, 0x4000
 buffer_load_dwordx4 v11, s[8:11], s40 offen offset:0 sc1 lds
 v_accvgpr_read_b32 v211, a43
 v_mfma_f32_16x16x32_bf16 v[100:103], v[20:23], v[144:147], 0
 v_accvgpr_read_b32 v212, a56
 v_accvgpr_read_b32 v213, a57
 v_accvgpr_read_b32 v214, a58
 v_accvgpr_read_b32 v215, a59
 v_pk_mul_f32 v[208:209], v[208:209], s[60:61]
 v_pk_mul_f32 v[210:211], v[210:211], s[60:61]
 v_pk_mul_f32 v[212:213], v[212:213], s[60:61]
 v_pk_mul_f32 v[214:215], v[214:215], s[60:61]
 v_cvt_pk_bf16_f32 v56, v208, v209
 v_cvt_pk_bf16_f32 v57, v210, v211
 v_cvt_pk_bf16_f32 v58, v212, v213
 v_cvt_pk_bf16_f32 v59, v214, v215
 v_mfma_f32_16x16x32_bf16 v[104:107], v[16:19], v[148:151], 0
 v_accvgpr_read_b32 v216, a44
 v_accvgpr_read_b32 v217, a45
 v_accvgpr_read_b32 v218, a46
 v_accvgpr_read_b32 v219, a47
 v_mfma_f32_16x16x32_bf16 v[108:111], v[20:23], v[148:151], 0
 buffer_load_dwordx4 v11, s[8:11], s40 offen offset:1024 sc1 lds
 v_accvgpr_read_b32 v220, a60
 v_accvgpr_read_b32 v221, a61
 v_accvgpr_read_b32 v222, a62
 v_accvgpr_read_b32 v223, a63
 v_pk_mul_f32 v[216:217], v[216:217], s[60:61]
 v_pk_mul_f32 v[218:219], v[218:219], s[60:61]
 v_pk_mul_f32 v[220:221], v[220:221], s[60:61]
 v_pk_mul_f32 v[222:223], v[222:223], s[60:61]
 v_cvt_pk_bf16_f32 v60, v216, v217
 v_cvt_pk_bf16_f32 v61, v218, v219
 v_cvt_pk_bf16_f32 v62, v220, v221
 v_cvt_pk_bf16_f32 v63, v222, v223
 v_permlane16_swap_b32 v48, v52
 v_permlane16_swap_b32 v49, v53
 v_permlane16_swap_b32 v50, v54
 v_permlane16_swap_b32 v51, v55
 v_mfma_f32_16x16x32_bf16 v[112:115], v[16:19], v[152:155], 0
 v_accvgpr_read_b32 v192, a136
 v_accvgpr_read_b32 v193, a137
 v_accvgpr_read_b32 v194, a138
 buffer_load_dwordx4 v11, s[8:11], s40 offen offset:2048 sc1 lds
 v_accvgpr_read_b32 v195, a139
 v_mfma_f32_16x16x32_bf16 v[116:119], v[20:23], v[152:155], 0
 v_accvgpr_read_b32 v196, a152
 v_accvgpr_read_b32 v197, a153
 v_accvgpr_read_b32 v198, a154
 v_accvgpr_read_b32 v199, a155
 v_pk_mul_f32 v[192:193], v[192:193], s[60:61]
 v_pk_mul_f32 v[194:195], v[194:195], s[60:61]
 v_pk_mul_f32 v[196:197], v[196:197], s[60:61]
 v_pk_mul_f32 v[198:199], v[198:199], s[60:61]
 v_cvt_pk_bf16_f32 v64, v192, v193
 v_cvt_pk_bf16_f32 v65, v194, v195
 v_cvt_pk_bf16_f32 v66, v196, v197
 v_cvt_pk_bf16_f32 v67, v198, v199
 v_mfma_f32_16x16x32_bf16 v[120:123], v[16:19], v[156:159], 0
 v_accvgpr_read_b32 v200, a140
 v_accvgpr_read_b32 v201, a141
 v_accvgpr_read_b32 v202, a142
 v_accvgpr_read_b32 v203, a143
 v_mfma_f32_16x16x32_bf16 v[124:127], v[20:23], v[156:159], 0
 buffer_load_dwordx4 v11, s[8:11], s40 offen offset:3072 sc1 lds
 s_add_u32 s40, s40, 0x4000
 v_accvgpr_read_b32 v204, a156
 v_accvgpr_read_b32 v205, a157
 v_accvgpr_read_b32 v206, a158
 v_accvgpr_read_b32 v207, a159
 v_pk_mul_f32 v[200:201], v[200:201], s[60:61]
 v_pk_mul_f32 v[202:203], v[202:203], s[60:61]
 v_pk_mul_f32 v[204:205], v[204:205], s[60:61]
 v_pk_mul_f32 v[206:207], v[206:207], s[60:61]
 v_cvt_pk_bf16_f32 v68, v200, v201
 v_cvt_pk_bf16_f32 v69, v202, v203
 v_cvt_pk_bf16_f32 v70, v204, v205
 v_cvt_pk_bf16_f32 v71, v206, v207
 v_permlane16_swap_b32 v56, v60
 v_permlane16_swap_b32 v57, v61
 v_permlane16_swap_b32 v58, v62
 v_permlane16_swap_b32 v59, v63
 v_mfma_f32_16x16x32_bf16 v[160:163], v[16:19], v[80:83], 0
 v_accvgpr_read_b32 v208, a168
 v_accvgpr_read_b32 v209, a169
 v_accvgpr_read_b32 v210, a170
 s_mov_b32 m0, s41
 s_add_u32 s41, s41, 0x4000
 buffer_load_dwordx4 v11, s[8:11], s40 offen offset:0 sc1 lds
 v_accvgpr_read_b32 v211, a171
 v_mfma_f32_16x16x32_bf16 v[164:167], v[20:23], v[80:83], 0
 v_accvgpr_read_b32 v212, a184
 v_accvgpr_read_b32 v213, a185
 v_accvgpr_read_b32 v214, a186
 v_accvgpr_read_b32 v215, a187
 v_pk_mul_f32 v[208:209], v[208:209], s[60:61]
 v_pk_mul_f32 v[210:211], v[210:211], s[60:61]
 v_pk_mul_f32 v[212:213], v[212:213], s[60:61]
 v_pk_mul_f32 v[214:215], v[214:215], s[60:61]
 v_cvt_pk_bf16_f32 v72, v208, v209
 v_cvt_pk_bf16_f32 v73, v210, v211
 v_cvt_pk_bf16_f32 v74, v212, v213
 v_cvt_pk_bf16_f32 v75, v214, v215
 v_mfma_f32_16x16x32_bf16 v[168:171], v[16:19], v[84:87], 0
 v_accvgpr_read_b32 v216, a172
 v_accvgpr_read_b32 v217, a173
 v_accvgpr_read_b32 v218, a174
 v_accvgpr_read_b32 v219, a175
 v_mfma_f32_16x16x32_bf16 v[172:175], v[20:23], v[84:87], 0
 buffer_load_dwordx4 v11, s[8:11], s40 offen offset:1024 sc1 lds
 v_accvgpr_read_b32 v220, a188
 v_accvgpr_read_b32 v221, a189
 v_accvgpr_read_b32 v222, a190
 v_accvgpr_read_b32 v223, a191
 v_pk_mul_f32 v[216:217], v[216:217], s[60:61]
 v_pk_mul_f32 v[218:219], v[218:219], s[60:61]
 v_pk_mul_f32 v[220:221], v[220:221], s[60:61]
 v_pk_mul_f32 v[222:223], v[222:223], s[60:61]
 v_cvt_pk_bf16_f32 v76, v216, v217
 v_cvt_pk_bf16_f32 v77, v218, v219
 v_cvt_pk_bf16_f32 v78, v220, v221
 v_cvt_pk_bf16_f32 v79, v222, v223
 v_permlane16_swap_b32 v64, v68
 v_permlane16_swap_b32 v65, v69
 v_permlane16_swap_b32 v66, v70
 v_permlane16_swap_b32 v67, v71
 v_mfma_f32_16x16x32_bf16 v[176:179], v[16:19], v[88:91], 0
 v_accvgpr_read_b32 v192, a32
 v_accvgpr_read_b32 v193, a33
 v_accvgpr_read_b32 v194, a34
 buffer_load_dwordx4 v11, s[8:11], s40 offen offset:2048 sc1 lds
 v_accvgpr_read_b32 v195, a35
 v_mfma_f32_16x16x32_bf16 v[180:183], v[20:23], v[88:91], 0
 v_accvgpr_read_b32 v196, a48
 v_accvgpr_read_b32 v197, a49
 v_accvgpr_read_b32 v198, a50
 v_accvgpr_read_b32 v199, a51
 v_pk_mul_f32 v[192:193], v[192:193], s[60:61]
 v_pk_mul_f32 v[194:195], v[194:195], s[60:61]
 v_pk_mul_f32 v[196:197], v[196:197], s[60:61]
 v_pk_mul_f32 v[198:199], v[198:199], s[60:61]
 v_cvt_pk_bf16_f32 v24, v192, v193
 v_cvt_pk_bf16_f32 v25, v194, v195
 v_cvt_pk_bf16_f32 v26, v196, v197
 v_cvt_pk_bf16_f32 v27, v198, v199
 v_mfma_f32_16x16x32_bf16 v[184:187], v[16:19], v[92:95], 0
 v_accvgpr_read_b32 v200, a36
 v_accvgpr_read_b32 v201, a37
 v_accvgpr_read_b32 v202, a38
 v_accvgpr_read_b32 v203, a39
 v_mfma_f32_16x16x32_bf16 v[188:191], v[20:23], v[92:95], 0
 buffer_load_dwordx4 v11, s[8:11], s40 offen offset:3072 sc1 lds
 s_add_u32 s40, s40, 0x4000
 v_accvgpr_read_b32 v204, a52
 v_accvgpr_read_b32 v205, a53
 v_accvgpr_read_b32 v206, a54
 v_accvgpr_read_b32 v207, a55
 v_pk_mul_f32 v[200:201], v[200:201], s[60:61]
 v_pk_mul_f32 v[202:203], v[202:203], s[60:61]
 v_pk_mul_f32 v[204:205], v[204:205], s[60:61]
 v_pk_mul_f32 v[206:207], v[206:207], s[60:61]
 v_cvt_pk_bf16_f32 v28, v200, v201
 v_cvt_pk_bf16_f32 v29, v202, v203
 v_cvt_pk_bf16_f32 v30, v204, v205
 v_cvt_pk_bf16_f32 v31, v206, v207
 v_permlane16_swap_b32 v72, v76
 v_permlane16_swap_b32 v73, v77
 v_permlane16_swap_b32 v74, v78
 v_permlane16_swap_b32 v75, v79
 v_accvgpr_read_b32 v208, a128
 v_accvgpr_read_b32 v209, a129
 v_accvgpr_read_b32 v210, a130
 v_accvgpr_read_b32 v211, a131
 s_mov_b32 m0, s41
 s_add_u32 s41, s41, 0x4000
 buffer_load_dwordx4 v11, s[8:11], s40 offen offset:0 sc1 lds
 v_accvgpr_read_b32 v212, a144
 v_accvgpr_read_b32 v213, a145
 v_accvgpr_read_b32 v214, a146
 v_accvgpr_read_b32 v215, a147
 v_pk_mul_f32 v[208:209], v[208:209], s[60:61]
 v_pk_mul_f32 v[210:211], v[210:211], s[60:61]
 v_pk_mul_f32 v[212:213], v[212:213], s[60:61]
 v_pk_mul_f32 v[214:215], v[214:215], s[60:61]
 v_cvt_pk_bf16_f32 v32, v208, v209
 v_cvt_pk_bf16_f32 v33, v210, v211
 v_cvt_pk_bf16_f32 v34, v212, v213
 v_cvt_pk_bf16_f32 v35, v214, v215
 v_accvgpr_read_b32 v216, a132
 v_accvgpr_read_b32 v217, a133
 v_accvgpr_read_b32 v218, a134
 v_accvgpr_read_b32 v219, a135
 v_accvgpr_read_b32 v220, a148
 v_accvgpr_read_b32 v221, a149
 v_accvgpr_read_b32 v222, a150
 v_accvgpr_read_b32 v223, a151
 buffer_load_dwordx4 v11, s[8:11], s40 offen offset:1024 sc1 lds
 v_pk_mul_f32 v[216:217], v[216:217], s[60:61]
 v_pk_mul_f32 v[218:219], v[218:219], s[60:61]
 v_pk_mul_f32 v[220:221], v[220:221], s[60:61]
 v_pk_mul_f32 v[222:223], v[222:223], s[60:61]
 v_cvt_pk_bf16_f32 v36, v216, v217
 v_cvt_pk_bf16_f32 v37, v218, v219
 v_cvt_pk_bf16_f32 v38, v220, v221
 v_cvt_pk_bf16_f32 v39, v222, v223
 v_permlane16_swap_b32 v24, v28
 v_permlane16_swap_b32 v25, v29
 v_permlane16_swap_b32 v26, v30
 v_permlane16_swap_b32 v27, v31
 v_accvgpr_read_b32 v192, a160
 v_accvgpr_read_b32 v193, a161
 v_accvgpr_read_b32 v194, a162
 v_accvgpr_read_b32 v195, a163
 v_accvgpr_read_b32 v196, a176
 v_accvgpr_read_b32 v197, a177
 v_accvgpr_read_b32 v198, a178
 v_accvgpr_read_b32 v199, a179
 buffer_load_dwordx4 v11, s[8:11], s40 offen offset:2048 sc1 lds
 v_pk_mul_f32 v[192:193], v[192:193], s[60:61]
 v_pk_mul_f32 v[194:195], v[194:195], s[60:61]
 v_pk_mul_f32 v[196:197], v[196:197], s[60:61]
 v_pk_mul_f32 v[198:199], v[198:199], s[60:61]
 v_cvt_pk_bf16_f32 v40, v192, v193
 v_cvt_pk_bf16_f32 v41, v194, v195
 v_cvt_pk_bf16_f32 v42, v196, v197
 v_cvt_pk_bf16_f32 v43, v198, v199
 v_accvgpr_read_b32 v200, a164
 v_accvgpr_read_b32 v201, a165
 v_accvgpr_read_b32 v202, a166
 v_accvgpr_read_b32 v203, a167
 v_accvgpr_read_b32 v204, a180
 v_accvgpr_read_b32 v205, a181
 v_accvgpr_read_b32 v206, a182
 v_accvgpr_read_b32 v207, a183
 v_pk_mul_f32 v[200:201], v[200:201], s[60:61]
 v_pk_mul_f32 v[202:203], v[202:203], s[60:61]
 v_pk_mul_f32 v[204:205], v[204:205], s[60:61]
 v_pk_mul_f32 v[206:207], v[206:207], s[60:61]
 buffer_load_dwordx4 v11, s[8:11], s40 offen offset:3072 sc1 lds
 s_add_u32 s40, s40, 0x4000
 v_cvt_pk_bf16_f32 v44, v200, v201
 v_cvt_pk_bf16_f32 v45, v202, v203
 v_cvt_pk_bf16_f32 v46, v204, v205
 v_cvt_pk_bf16_f32 v47, v206, v207
 v_permlane16_swap_b32 v32, v36
 v_permlane16_swap_b32 v33, v37
 v_permlane16_swap_b32 v34, v38
 v_permlane16_swap_b32 v35, v39
 v_accvgpr_read_b32 v208, a0
 v_accvgpr_read_b32 v209, a1
 v_accvgpr_read_b32 v210, a2
 v_accvgpr_read_b32 v211, a3
 v_accvgpr_read_b32 v212, a16
 v_accvgpr_read_b32 v213, a17
 v_accvgpr_read_b32 v214, a18
 v_accvgpr_read_b32 v215, a19
 v_pk_mul_f32 v[208:209], v[208:209], s[60:61]
 v_pk_mul_f32 v[210:211], v[210:211], s[60:61]
 v_pk_mul_f32 v[212:213], v[212:213], s[60:61]
 v_pk_mul_f32 v[214:215], v[214:215], s[60:61]
 buffer_load_dword v224, v5, s[20:23], s64 offen sc1
 v_cvt_pk_bf16_f32 v16, v208, v209
 v_cvt_pk_bf16_f32 v17, v210, v211
 v_cvt_pk_bf16_f32 v18, v212, v213
 v_cvt_pk_bf16_f32 v19, v214, v215
 v_accvgpr_read_b32 v216, a4
 v_accvgpr_read_b32 v217, a5
 v_accvgpr_read_b32 v218, a6
 v_accvgpr_read_b32 v219, a7
 v_accvgpr_read_b32 v220, a20
 v_accvgpr_read_b32 v221, a21
 v_accvgpr_read_b32 v222, a22
 v_accvgpr_read_b32 v223, a23
 v_pk_mul_f32 v[216:217], v[216:217], s[60:61]
 v_pk_mul_f32 v[218:219], v[218:219], s[60:61]
 v_pk_mul_f32 v[220:221], v[220:221], s[60:61]
 v_pk_mul_f32 v[222:223], v[222:223], s[60:61]
 v_cvt_pk_bf16_f32 v20, v216, v217
 v_cvt_pk_bf16_f32 v21, v218, v219
 v_cvt_pk_bf16_f32 v22, v220, v221
 v_cvt_pk_bf16_f32 v23, v222, v223
 buffer_load_dword v225, v5, s[20:23], s65 offen sc1
 v_permlane16_swap_b32 v40, v44
 v_permlane16_swap_b32 v41, v45
 v_permlane16_swap_b32 v42, v46
 v_permlane16_swap_b32 v43, v47
 v_permlane16_swap_b32 v16, v20
 v_permlane16_swap_b32 v17, v21
 v_permlane16_swap_b32 v18, v22
 v_permlane16_swap_b32 v19, v23
 v_max3_f32 v192, v96, v97, v98
 v_max3_f32 v228, v112, v113, v114
 v_max3_f32 v194, v104, v105, v106
 v_max3_f32 v230, v120, v121, v122
 v_max3_f32 v193, -v96, -v97, -v98
 v_max3_f32 v229, -v112, -v113, -v114
 v_max3_f32 v195, -v104, -v105, -v106
 v_max3_f32 v231, -v120, -v121, -v122
 v_max3_f32 v192, v192, v99, v100
 v_max3_f32 v228, v228, v115, v116
 v_max3_f32 v194, v194, v107, v108
 v_max3_f32 v230, v230, v123, v124
 ds_write_b128 v9, v[128:131] offset:0
 v_max3_f32 v193, v193, -v99, -v100
 v_max3_f32 v229, v229, -v115, -v116
 v_max3_f32 v195, v195, -v107, -v108
 v_max3_f32 v231, v231, -v123, -v124
 v_max3_f32 v192, v192, v101, v102
 v_max3_f32 v228, v228, v117, v118
 v_max3_f32 v194, v194, v109, v110
 v_max3_f32 v230, v230, v125, v126
 v_max3_f32 v193, v193, -v101, -v102
 v_max3_f32 v229, v229, -v117, -v118
 v_max3_f32 v195, v195, -v109, -v110
 v_max3_f32 v231, v231, -v125, -v126
 v_max_f32 v192, v192, v103
 v_max_f32 v228, v228, v119
 v_max_f32 v194, v194, v111
 v_max_f32 v230, v230, v127
 v_max_f32_e64 v193, v193, -v103
 v_max_f32_e64 v229, v229, -v119
 v_max_f32_e64 v195, v195, -v111
 v_max_f32_e64 v231, v231, -v127
 ds_write_b128 v9, v[132:135] offset:1024
 v_permlane16_swap_b32 v192, v193
 v_permlane16_swap_b32 v228, v229
 v_permlane16_swap_b32 v194, v195
 v_permlane16_swap_b32 v230, v231
 v_max_f32 v192, v192, v193
 v_max_f32 v228, v228, v229
 v_max_f32 v194, v194, v195
 v_max_f32 v230, v230, v231
 s_nop 0
 v_permlane32_swap_b32 v192, v194
 v_permlane32_swap_b32 v228, v230
 v_max_f32 v192, v192, v194
 v_max_f32 v228, v228, v230
 v_mov_b32 v194, v192
 v_mov_b32 v230, v228
 s_nop 0
 v_permlane32_swap_b32 v192, v194
 v_permlane32_swap_b32 v228, v230
 v_mov_b32 v193, v192
 v_mov_b32 v229, v228
 v_mov_b32 v195, v194
 v_mov_b32 v231, v230
 ds_write_b128 v9, v[136:139] offset:2048
 v_permlane16_swap_b32 v192, v193
 v_permlane16_swap_b32 v228, v229
 v_permlane16_swap_b32 v194, v195
 v_permlane16_swap_b32 v230, v231
 v_pk_mul_f32 v[192:193], v[192:193], s[50:51]
 v_pk_mul_f32 v[228:229], v[228:229], s[50:51]
 v_pk_mul_f32 v[194:195], v[194:195], s[50:51]
 v_pk_mul_f32 v[230:231], v[230:231], s[50:51]
 v_pk_fma_f32 v[196:197], v[96:97], s[50:51], v[192:193] op_sel:[0,0,1] op_sel_hi:[1,1,1] neg_lo:[1,0,1] neg_hi:[1,0,1]
 v_pk_fma_f32 v[232:233], v[112:113], s[50:51], v[228:229] op_sel:[0,0,1] op_sel_hi:[1,1,1] neg_lo:[1,0,1] neg_hi:[1,0,1]
 v_pk_fma_f32 v[204:205], v[104:105], s[50:51], v[194:195] op_sel:[0,0,1] op_sel_hi:[1,1,1] neg_lo:[1,0,1] neg_hi:[1,0,1]
 v_pk_fma_f32 v[240:241], v[120:121], s[50:51], v[230:231] op_sel:[0,0,1] op_sel_hi:[1,1,1] neg_lo:[1,0,1] neg_hi:[1,0,1]
 v_pk_fma_f32 v[96:97], v[96:97], s[50:51], v[192:193] op_sel_hi:[1,1,0] neg_lo:[0,0,1] neg_hi:[0,0,1]
 v_pk_fma_f32 v[112:113], v[112:113], s[50:51], v[228:229] op_sel_hi:[1,1,0] neg_lo:[0,0,1] neg_hi:[0,0,1]
 v_pk_fma_f32 v[104:105], v[104:105], s[50:51], v[194:195] op_sel_hi:[1,1,0] neg_lo:[0,0,1] neg_hi:[0,0,1]
 v_pk_fma_f32 v[120:121], v[120:121], s[50:51], v[230:231] op_sel_hi:[1,1,0] neg_lo:[0,0,1] neg_hi:[0,0,1]
 v_pk_fma_f32 v[198:199], v[98:99], s[50:51], v[192:193] op_sel:[0,0,1] op_sel_hi:[1,1,1] neg_lo:[1,0,1] neg_hi:[1,0,1]
 v_pk_fma_f32 v[234:235], v[114:115], s[50:51], v[228:229] op_sel:[0,0,1] op_sel_hi:[1,1,1] neg_lo:[1,0,1] neg_hi:[1,0,1]
 v_pk_fma_f32 v[206:207], v[106:107], s[50:51], v[194:195] op_sel:[0,0,1] op_sel_hi:[1,1,1] neg_lo:[1,0,1] neg_hi:[1,0,1]
 v_pk_fma_f32 v[242:243], v[122:123], s[50:51], v[230:231] op_sel:[0,0,1] op_sel_hi:[1,1,1] neg_lo:[1,0,1] neg_hi:[1,0,1]
 ds_write_b128 v9, v[140:143] offset:3072
 v_pk_fma_f32 v[98:99], v[98:99], s[50:51], v[192:193] op_sel_hi:[1,1,0] neg_lo:[0,0,1] neg_hi:[0,0,1]
 v_pk_fma_f32 v[114:115], v[114:115], s[50:51], v[228:229] op_sel_hi:[1,1,0] neg_lo:[0,0,1] neg_hi:[0,0,1]
 v_pk_fma_f32 v[106:107], v[106:107], s[50:51], v[194:195] op_sel_hi:[1,1,0] neg_lo:[0,0,1] neg_hi:[0,0,1]
 v_pk_fma_f32 v[122:123], v[122:123], s[50:51], v[230:231] op_sel_hi:[1,1,0] neg_lo:[0,0,1] neg_hi:[0,0,1]
 v_pk_fma_f32 v[200:201], v[100:101], s[50:51], v[192:193] op_sel:[0,0,1] op_sel_hi:[1,1,1] neg_lo:[1,0,1] neg_hi:[1,0,1]
 v_pk_fma_f32 v[236:237], v[116:117], s[50:51], v[228:229] op_sel:[0,0,1] op_sel_hi:[1,1,1] neg_lo:[1,0,1] neg_hi:[1,0,1]
 v_pk_fma_f32 v[208:209], v[108:109], s[50:51], v[194:195] op_sel:[0,0,1] op_sel_hi:[1,1,1] neg_lo:[1,0,1] neg_hi:[1,0,1]
 v_pk_fma_f32 v[244:245], v[124:125], s[50:51], v[230:231] op_sel:[0,0,1] op_sel_hi:[1,1,1] neg_lo:[1,0,1] neg_hi:[1,0,1]
 v_pk_fma_f32 v[100:101], v[100:101], s[50:51], v[192:193] op_sel_hi:[1,1,0] neg_lo:[0,0,1] neg_hi:[0,0,1]
 v_pk_fma_f32 v[116:117], v[116:117], s[50:51], v[228:229] op_sel_hi:[1,1,0] neg_lo:[0,0,1] neg_hi:[0,0,1]
 v_pk_fma_f32 v[108:109], v[108:109], s[50:51], v[194:195] op_sel_hi:[1,1,0] neg_lo:[0,0,1] neg_hi:[0,0,1]
 v_pk_fma_f32 v[124:125], v[124:125], s[50:51], v[230:231] op_sel_hi:[1,1,0] neg_lo:[0,0,1] neg_hi:[0,0,1]
 v_pk_fma_f32 v[202:203], v[102:103], s[50:51], v[192:193] op_sel:[0,0,1] op_sel_hi:[1,1,1] neg_lo:[1,0,1] neg_hi:[1,0,1]
 v_pk_fma_f32 v[238:239], v[118:119], s[50:51], v[228:229] op_sel:[0,0,1] op_sel_hi:[1,1,1] neg_lo:[1,0,1] neg_hi:[1,0,1]
 v_pk_fma_f32 v[210:211], v[110:111], s[50:51], v[194:195] op_sel:[0,0,1] op_sel_hi:[1,1,1] neg_lo:[1,0,1] neg_hi:[1,0,1]
 v_pk_fma_f32 v[246:247], v[126:127], s[50:51], v[230:231] op_sel:[0,0,1] op_sel_hi:[1,1,1] neg_lo:[1,0,1] neg_hi:[1,0,1]
 v_pk_fma_f32 v[102:103], v[102:103], s[50:51], v[192:193] op_sel_hi:[1,1,0] neg_lo:[0,0,1] neg_hi:[0,0,1]
 v_pk_fma_f32 v[118:119], v[118:119], s[50:51], v[228:229] op_sel_hi:[1,1,0] neg_lo:[0,0,1] neg_hi:[0,0,1]
 v_pk_fma_f32 v[110:111], v[110:111], s[50:51], v[194:195] op_sel_hi:[1,1,0] neg_lo:[0,0,1] neg_hi:[0,0,1]
 v_pk_fma_f32 v[126:127], v[126:127], s[50:51], v[230:231] op_sel_hi:[1,1,0] neg_lo:[0,0,1] neg_hi:[0,0,1]
 v_exp_f32 v196, v196
 v_exp_f32 v232, v232
 v_exp_f32 v204, v204
 v_exp_f32 v240, v240
 v_exp_f32 v96, v96
 v_exp_f32 v112, v112
 v_exp_f32 v104, v104
 v_exp_f32 v120, v120
 v_exp_f32 v197, v197
 v_exp_f32 v233, v233
 v_exp_f32 v205, v205
 v_exp_f32 v241, v241
 v_exp_f32 v97, v97
 v_exp_f32 v113, v113
 v_exp_f32 v105, v105
 v_exp_f32 v121, v121
 v_exp_f32 v198, v198
 v_exp_f32 v234, v234
 v_exp_f32 v206, v206
 v_exp_f32 v242, v242
 v_exp_f32 v98, v98
 v_exp_f32 v114, v114
 v_exp_f32 v106, v106
 v_exp_f32 v122, v122
 v_exp_f32 v199, v199
 v_exp_f32 v235, v235
 v_exp_f32 v207, v207
 v_exp_f32 v243, v243
 v_exp_f32 v99, v99
 v_exp_f32 v115, v115
 v_exp_f32 v107, v107
 v_exp_f32 v123, v123
 v_exp_f32 v200, v200
 v_exp_f32 v236, v236
 v_exp_f32 v208, v208
 v_exp_f32 v244, v244
 v_exp_f32 v100, v100
 v_exp_f32 v116, v116
 v_exp_f32 v108, v108
 v_exp_f32 v124, v124
 v_exp_f32 v201, v201
 v_exp_f32 v237, v237
 v_exp_f32 v209, v209
 v_exp_f32 v245, v245
 v_exp_f32 v101, v101
 v_exp_f32 v117, v117
 v_exp_f32 v109, v109
 v_exp_f32 v125, v125
 v_exp_f32 v202, v202
 v_exp_f32 v238, v238
 v_exp_f32 v210, v210
 v_exp_f32 v246, v246
 v_exp_f32 v102, v102
 v_exp_f32 v118, v118
 v_exp_f32 v110, v110
 v_exp_f32 v126, v126
 v_exp_f32 v203, v203
 v_exp_f32 v239, v239
 v_exp_f32 v211, v211
 v_exp_f32 v247, v247
 v_exp_f32 v103, v103
 v_exp_f32 v119, v119
 v_exp_f32 v111, v111
 v_exp_f32 v127, v127
 v_pk_add_f32 v[212:213], v[96:97], v[98:99]
 v_pk_add_f32 v[248:249], v[112:113], v[114:115]
 v_pk_add_f32 v[216:217], v[104:105], v[106:107]
 v_pk_add_f32 v[252:253], v[120:121], v[122:123]
 v_pk_add_f32 v[214:215], v[196:197], v[198:199]
 v_pk_add_f32 v[250:251], v[232:233], v[234:235]
 v_pk_add_f32 v[218:219], v[204:205], v[206:207]
 v_pk_add_f32 v[254:255], v[240:241], v[242:243]
 v_pk_add_f32 v[212:213], v[212:213], v[100:101]
 v_pk_add_f32 v[248:249], v[248:249], v[116:117]
 v_pk_add_f32 v[216:217], v[216:217], v[108:109]
 v_pk_add_f32 v[252:253], v[252:253], v[124:125]
 v_pk_add_f32 v[214:215], v[214:215], v[200:201]
 v_pk_add_f32 v[250:251], v[250:251], v[236:237]
 v_pk_add_f32 v[218:219], v[218:219], v[208:209]
 v_pk_add_f32 v[254:255], v[254:255], v[244:245]
 v_pk_add_f32 v[212:213], v[212:213], v[102:103]
 v_pk_add_f32 v[248:249], v[248:249], v[118:119]
 v_pk_add_f32 v[216:217], v[216:217], v[110:111]
 v_pk_add_f32 v[252:253], v[252:253], v[126:127]
 v_pk_add_f32 v[214:215], v[214:215], v[202:203]
 v_pk_add_f32 v[250:251], v[250:251], v[238:239]
 v_pk_add_f32 v[218:219], v[218:219], v[210:211]
 v_pk_add_f32 v[254:255], v[254:255], v[246:247]
 v_add_f32 v192, v212, v213
 v_add_f32 v228, v248, v249
 v_add_f32 v194, v216, v217
 v_add_f32 v230, v252, v253
 v_add_f32 v193, v214, v215
 v_add_f32 v229, v250, v251
 v_add_f32 v195, v218, v219
 v_add_f32 v231, v254, v255
 v_permlane16_swap_b32 v192, v193
 v_permlane16_swap_b32 v228, v229
 v_permlane16_swap_b32 v194, v195
 v_permlane16_swap_b32 v230, v231
 v_add_f32 v192, v192, v193
 v_add_f32 v228, v228, v229
 v_add_f32 v194, v194, v195
 v_add_f32 v230, v230, v231
 s_nop 0
 v_permlane32_swap_b32 v192, v194
 v_permlane32_swap_b32 v228, v230
 v_add_f32 v192, v192, v194
 v_add_f32 v228, v228, v230
 v_mov_b32 v194, v192
 v_mov_b32 v230, v228
 s_nop 0
 v_permlane32_swap_b32 v192, v194
 v_permlane32_swap_b32 v228, v230
 v_mov_b32 v193, v192
 v_mov_b32 v229, v228
 v_mov_b32 v195, v194
 v_mov_b32 v231, v230
 v_permlane16_swap_b32 v192, v193
 v_permlane16_swap_b32 v228, v229
 v_permlane16_swap_b32 v194, v195
 v_permlane16_swap_b32 v230, v231
 v_rcp_f32 v192, v192
 v_rcp_f32 v228, v228
 v_rcp_f32 v193, v193
 v_rcp_f32 v229, v229
 v_rcp_f32 v194, v194
 v_rcp_f32 v230, v230
 v_rcp_f32 v195, v195
 v_rcp_f32 v231, v231
 v_pk_mul_f32 v[96:97], v[96:97], v[192:193] op_sel_hi:[1,0]
 v_pk_mul_f32 v[112:113], v[112:113], v[228:229] op_sel_hi:[1,0]
 v_pk_mul_f32 v[104:105], v[104:105], v[194:195] op_sel_hi:[1,0]
 v_pk_mul_f32 v[120:121], v[120:121], v[230:231] op_sel_hi:[1,0]
 v_pk_mul_f32 v[196:197], v[196:197], v[192:193] op_sel:[0,1] op_sel_hi:[1,1]
 v_pk_mul_f32 v[232:233], v[232:233], v[228:229] op_sel:[0,1] op_sel_hi:[1,1]
 v_pk_mul_f32 v[204:205], v[204:205], v[194:195] op_sel:[0,1] op_sel_hi:[1,1]
 v_pk_mul_f32 v[240:241], v[240:241], v[230:231] op_sel:[0,1] op_sel_hi:[1,1]
 v_pk_mul_f32 v[98:99], v[98:99], v[192:193] op_sel_hi:[1,0]
 v_pk_mul_f32 v[114:115], v[114:115], v[228:229] op_sel_hi:[1,0]
 v_pk_mul_f32 v[106:107], v[106:107], v[194:195] op_sel_hi:[1,0]
 v_pk_mul_f32 v[122:123], v[122:123], v[230:231] op_sel_hi:[1,0]
 v_pk_mul_f32 v[198:199], v[198:199], v[192:193] op_sel:[0,1] op_sel_hi:[1,1]
 v_pk_mul_f32 v[234:235], v[234:235], v[228:229] op_sel:[0,1] op_sel_hi:[1,1]
 v_pk_mul_f32 v[206:207], v[206:207], v[194:195] op_sel:[0,1] op_sel_hi:[1,1]
 v_pk_mul_f32 v[242:243], v[242:243], v[230:231] op_sel:[0,1] op_sel_hi:[1,1]
 v_pk_mul_f32 v[100:101], v[100:101], v[192:193] op_sel_hi:[1,0]
 v_pk_mul_f32 v[116:117], v[116:117], v[228:229] op_sel_hi:[1,0]
 v_pk_mul_f32 v[108:109], v[108:109], v[194:195] op_sel_hi:[1,0]
 v_pk_mul_f32 v[124:125], v[124:125], v[230:231] op_sel_hi:[1,0]
 v_pk_mul_f32 v[200:201], v[200:201], v[192:193] op_sel:[0,1] op_sel_hi:[1,1]
 v_pk_mul_f32 v[236:237], v[236:237], v[228:229] op_sel:[0,1] op_sel_hi:[1,1]
 v_pk_mul_f32 v[208:209], v[208:209], v[194:195] op_sel:[0,1] op_sel_hi:[1,1]
 v_pk_mul_f32 v[244:245], v[244:245], v[230:231] op_sel:[0,1] op_sel_hi:[1,1]
 v_pk_mul_f32 v[102:103], v[102:103], v[192:193] op_sel_hi:[1,0]
 v_pk_mul_f32 v[118:119], v[118:119], v[228:229] op_sel_hi:[1,0]
 v_pk_mul_f32 v[110:111], v[110:111], v[194:195] op_sel_hi:[1,0]
 v_pk_mul_f32 v[126:127], v[126:127], v[230:231] op_sel_hi:[1,0]
 v_pk_mul_f32 v[202:203], v[202:203], v[192:193] op_sel:[0,1] op_sel_hi:[1,1]
 v_pk_mul_f32 v[238:239], v[238:239], v[228:229] op_sel:[0,1] op_sel_hi:[1,1]
 v_pk_mul_f32 v[210:211], v[210:211], v[194:195] op_sel:[0,1] op_sel_hi:[1,1]
 v_pk_mul_f32 v[246:247], v[246:247], v[230:231] op_sel:[0,1] op_sel_hi:[1,1]
 v_cvt_pk_bf16_f32 v96, v96, v97
 v_cvt_pk_bf16_f32 v112, v112, v113
 v_cvt_pk_bf16_f32 v104, v104, v105
 v_cvt_pk_bf16_f32 v120, v120, v121
 v_cvt_pk_bf16_f32 v97, v98, v99
 v_cvt_pk_bf16_f32 v113, v114, v115
 v_cvt_pk_bf16_f32 v105, v106, v107
 v_cvt_pk_bf16_f32 v121, v122, v123
 v_cvt_pk_bf16_f32 v98, v100, v101
 v_cvt_pk_bf16_f32 v114, v116, v117
 v_cvt_pk_bf16_f32 v106, v108, v109
 v_cvt_pk_bf16_f32 v122, v124, v125
 v_cvt_pk_bf16_f32 v99, v102, v103
 v_cvt_pk_bf16_f32 v115, v118, v119
 v_cvt_pk_bf16_f32 v107, v110, v111
 v_cvt_pk_bf16_f32 v123, v126, v127
 v_cvt_pk_bf16_f32 v100, v196, v197
 v_cvt_pk_bf16_f32 v116, v232, v233
 v_cvt_pk_bf16_f32 v108, v204, v205
 v_cvt_pk_bf16_f32 v124, v240, v241
 v_cvt_pk_bf16_f32 v101, v198, v199
 v_cvt_pk_bf16_f32 v117, v234, v235
 v_cvt_pk_bf16_f32 v109, v206, v207
 v_cvt_pk_bf16_f32 v125, v242, v243
 v_cvt_pk_bf16_f32 v102, v200, v201
 v_cvt_pk_bf16_f32 v118, v236, v237
 v_cvt_pk_bf16_f32 v110, v208, v209
 v_cvt_pk_bf16_f32 v126, v244, v245
 v_cvt_pk_bf16_f32 v103, v202, v203
 v_cvt_pk_bf16_f32 v119, v238, v239
 v_cvt_pk_bf16_f32 v111, v210, v211
 v_cvt_pk_bf16_f32 v127, v246, v247
 v_mov_b32 v144, 0x3f803f80
 v_mov_b32 v145, v144
 v_mov_b32 v146, v144
 v_mov_b32 v147, v144
 ds_write_b64 v12, v[96:97] offset:0
 v_max3_f32 v192, v160, v161, v162
 v_max3_f32 v228, v176, v177, v178
 v_max3_f32 v194, v168, v169, v170
 v_max3_f32 v230, v184, v185, v186
 ds_write_b64 v12, v[98:99] offset:32
 v_max3_f32 v193, -v160, -v161, -v162
 v_max3_f32 v229, -v176, -v177, -v178
 v_max3_f32 v195, -v168, -v169, -v170
 v_max3_f32 v231, -v184, -v185, -v186
 ds_write_b64 v12, v[100:101] offset:64
 v_max3_f32 v192, v192, v163, v164
 v_max3_f32 v228, v228, v179, v180
 v_max3_f32 v194, v194, v171, v172
 v_max3_f32 v230, v230, v187, v188
 ds_write_b64 v12, v[102:103] offset:96
 v_max3_f32 v193, v193, -v163, -v164
 v_max3_f32 v229, v229, -v179, -v180
 v_max3_f32 v195, v195, -v171, -v172
 v_max3_f32 v231, v231, -v187, -v188
 ds_write_b64 v12, v[104:105] offset:2176
 v_max3_f32 v192, v192, v165, v166
 v_max3_f32 v228, v228, v181, v182
 v_max3_f32 v194, v194, v173, v174
 v_max3_f32 v230, v230, v189, v190
 ds_write_b64 v12, v[106:107] offset:2208
 v_max3_f32 v193, v193, -v165, -v166
 v_max3_f32 v229, v229, -v181, -v182
 v_max3_f32 v195, v195, -v173, -v174
 v_max3_f32 v231, v231, -v189, -v190
 ds_write_b64 v12, v[108:109] offset:2240
 v_max_f32 v192, v192, v167
 v_max_f32 v228, v228, v183
 v_max_f32 v194, v194, v175
 v_max_f32 v230, v230, v191
 ds_write_b64 v12, v[110:111] offset:2272
 v_max_f32_e64 v193, v193, -v167
 v_max_f32_e64 v229, v229, -v183
 v_max_f32_e64 v195, v195, -v175
 v_max_f32_e64 v231, v231, -v191
 ds_write_b64 v12, v[112:113] offset:4352
 v_permlane16_swap_b32 v192, v193
 v_permlane16_swap_b32 v228, v229
 v_permlane16_swap_b32 v194, v195
 v_permlane16_swap_b32 v230, v231
 ds_write_b64 v12, v[114:115] offset:4384
 v_max_f32 v192, v192, v193
 v_max_f32 v228, v228, v229
 v_max_f32 v194, v194, v195
 v_max_f32 v230, v230, v231
 ds_write_b64 v12, v[116:117] offset:4416
 v_permlane32_swap_b32 v192, v194
 v_permlane32_swap_b32 v228, v230
 v_max_f32 v192, v192, v194
 v_max_f32 v228, v228, v230
 ds_write_b64 v12, v[118:119] offset:4448
 v_mov_b32 v194, v192
 v_mov_b32 v230, v228
 s_nop 0
 v_permlane32_swap_b32 v192, v194
 v_permlane32_swap_b32 v228, v230
 ds_write_b64 v12, v[120:121] offset:6528
 v_mov_b32 v193, v192
 v_mov_b32 v229, v228
 v_mov_b32 v195, v194
 v_mov_b32 v231, v230
 ds_write_b64 v12, v[122:123] offset:6560
 v_permlane16_swap_b32 v192, v193
 v_permlane16_swap_b32 v228, v229
 v_permlane16_swap_b32 v194, v195
 v_permlane16_swap_b32 v230, v231
 ds_write_b64 v12, v[124:125] offset:6592
 v_pk_mul_f32 v[192:193], v[192:193], s[50:51]
 v_pk_mul_f32 v[228:229], v[228:229], s[50:51]
 v_pk_mul_f32 v[194:195], v[194:195], s[50:51]
 v_pk_mul_f32 v[230:231], v[230:231], s[50:51]
 ds_write_b64 v12, v[126:127] offset:6624
 v_pk_fma_f32 v[196:197], v[160:161], s[50:51], v[192:193] op_sel:[0,0,1] op_sel_hi:[1,1,1] neg_lo:[1,0,1] neg_hi:[1,0,1]
 v_pk_fma_f32 v[232:233], v[176:177], s[50:51], v[228:229] op_sel:[0,0,1] op_sel_hi:[1,1,1] neg_lo:[1,0,1] neg_hi:[1,0,1]
 v_pk_fma_f32 v[204:205], v[168:169], s[50:51], v[194:195] op_sel:[0,0,1] op_sel_hi:[1,1,1] neg_lo:[1,0,1] neg_hi:[1,0,1]
 v_pk_fma_f32 v[240:241], v[184:185], s[50:51], v[230:231] op_sel:[0,0,1] op_sel_hi:[1,1,1] neg_lo:[1,0,1] neg_hi:[1,0,1]
 v_pk_fma_f32 v[160:161], v[160:161], s[50:51], v[192:193] op_sel_hi:[1,1,0] neg_lo:[0,0,1] neg_hi:[0,0,1]
 v_pk_fma_f32 v[176:177], v[176:177], s[50:51], v[228:229] op_sel_hi:[1,1,0] neg_lo:[0,0,1] neg_hi:[0,0,1]
 v_pk_fma_f32 v[168:169], v[168:169], s[50:51], v[194:195] op_sel_hi:[1,1,0] neg_lo:[0,0,1] neg_hi:[0,0,1]
 v_pk_fma_f32 v[184:185], v[184:185], s[50:51], v[230:231] op_sel_hi:[1,1,0] neg_lo:[0,0,1] neg_hi:[0,0,1]
 v_pk_fma_f32 v[198:199], v[162:163], s[50:51], v[192:193] op_sel:[0,0,1] op_sel_hi:[1,1,1] neg_lo:[1,0,1] neg_hi:[1,0,1]
 v_pk_fma_f32 v[234:235], v[178:179], s[50:51], v[228:229] op_sel:[0,0,1] op_sel_hi:[1,1,1] neg_lo:[1,0,1] neg_hi:[1,0,1]
 v_pk_fma_f32 v[206:207], v[170:171], s[50:51], v[194:195] op_sel:[0,0,1] op_sel_hi:[1,1,1] neg_lo:[1,0,1] neg_hi:[1,0,1]
 v_pk_fma_f32 v[242:243], v[186:187], s[50:51], v[230:231] op_sel:[0,0,1] op_sel_hi:[1,1,1] neg_lo:[1,0,1] neg_hi:[1,0,1]
 v_pk_fma_f32 v[162:163], v[162:163], s[50:51], v[192:193] op_sel_hi:[1,1,0] neg_lo:[0,0,1] neg_hi:[0,0,1]
 v_pk_fma_f32 v[178:179], v[178:179], s[50:51], v[228:229] op_sel_hi:[1,1,0] neg_lo:[0,0,1] neg_hi:[0,0,1]
 v_pk_fma_f32 v[170:171], v[170:171], s[50:51], v[194:195] op_sel_hi:[1,1,0] neg_lo:[0,0,1] neg_hi:[0,0,1]
 v_pk_fma_f32 v[186:187], v[186:187], s[50:51], v[230:231] op_sel_hi:[1,1,0] neg_lo:[0,0,1] neg_hi:[0,0,1]
 s_waitcnt lgkmcnt(0) vmcnt(6)
 s_barrier
 ds_read_b64_tr_b16 a[64:65], v13 offset:0
 ds_read_b64_tr_b16 a[66:67], v13 offset:2176
 ds_read_b128 a[0:3], v15 offset:0
 ds_read_b128 a[4:7], v15 offset:1024
 ds_read_b64_tr_b16 a[68:69], v13 offset:4352
 ds_read_b64_tr_b16 a[70:71], v13 offset:6528
 ds_read_b128 a[8:11], v15 offset:2048
 ds_read_b128 a[12:15], v15 offset:3072
 ds_read_b64_tr_b16 a[72:73], v13 offset:8704
 ds_read_b64_tr_b16 a[74:75], v13 offset:10880
 ds_read_b128 a[16:19], v15 offset:4096
 ds_read_b128 a[20:23], v15 offset:5120
 ds_read_b64_tr_b16 a[76:77], v13 offset:13056
 ds_read_b64_tr_b16 a[78:79], v13 offset:15232
 ds_read_b128 a[24:27], v15 offset:6144
 ds_read_b128 a[28:31], v15 offset:7168
 ds_read_b64_tr_b16 a[80:81], v13 offset:17408
 ds_read_b64_tr_b16 a[82:83], v13 offset:19584
 ds_read_b128 a[32:35], v15 offset:8192
 ds_read_b128 a[36:39], v15 offset:9216
 ds_read_b64_tr_b16 a[84:85], v13 offset:21760
 ds_read_b64_tr_b16 a[86:87], v13 offset:23936
 ds_read_b128 a[40:43], v15 offset:10240
 ds_read_b128 a[44:47], v15 offset:11264
 ds_read_b64_tr_b16 a[88:89], v13 offset:26112
 ds_read_b64_tr_b16 a[90:91], v13 offset:28288
 ds_read_b128 a[48:51], v15 offset:12288
 ds_read_b128 a[52:55], v15 offset:13312
 ds_read_b64_tr_b16 a[92:93], v13 offset:30464
 ds_read_b64_tr_b16 a[94:95], v13 offset:32640
 ds_read_b128 a[56:59], v15 offset:14336
 ds_read_b128 a[60:63], v15 offset:15360
 ds_read_b128 a[128:131], v10 offset:0
 ds_read_b128 a[132:135], v10 offset:1024
 ds_read_b128 a[136:139], v10 offset:2048
 ds_read_b128 a[140:143], v10 offset:3072
 ds_read_b128 a[144:147], v10 offset:4096
 ds_read_b128 a[148:151], v10 offset:5120
 ds_read_b128 a[152:155], v10 offset:6144
 ds_read_b128 a[156:159], v10 offset:7168
 v_pk_fma_f32 v[200:201], v[164:165], s[50:51], v[192:193] op_sel:[0,0,1] op_sel_hi:[1,1,1] neg_lo:[1,0,1] neg_hi:[1,0,1]
 v_pk_fma_f32 v[236:237], v[180:181], s[50:51], v[228:229] op_sel:[0,0,1] op_sel_hi:[1,1,1] neg_lo:[1,0,1] neg_hi:[1,0,1]
 v_pk_fma_f32 v[208:209], v[172:173], s[50:51], v[194:195] op_sel:[0,0,1] op_sel_hi:[1,1,1] neg_lo:[1,0,1] neg_hi:[1,0,1]
 v_pk_fma_f32 v[244:245], v[188:189], s[50:51], v[230:231] op_sel:[0,0,1] op_sel_hi:[1,1,1] neg_lo:[1,0,1] neg_hi:[1,0,1]
 v_pk_fma_f32 v[164:165], v[164:165], s[50:51], v[192:193] op_sel_hi:[1,1,0] neg_lo:[0,0,1] neg_hi:[0,0,1]
 v_pk_fma_f32 v[180:181], v[180:181], s[50:51], v[228:229] op_sel_hi:[1,1,0] neg_lo:[0,0,1] neg_hi:[0,0,1]
 v_pk_fma_f32 v[172:173], v[172:173], s[50:51], v[194:195] op_sel_hi:[1,1,0] neg_lo:[0,0,1] neg_hi:[0,0,1]
 v_pk_fma_f32 v[188:189], v[188:189], s[50:51], v[230:231] op_sel_hi:[1,1,0] neg_lo:[0,0,1] neg_hi:[0,0,1]
 v_pk_fma_f32 v[202:203], v[166:167], s[50:51], v[192:193] op_sel:[0,0,1] op_sel_hi:[1,1,1] neg_lo:[1,0,1] neg_hi:[1,0,1]
 v_pk_fma_f32 v[238:239], v[182:183], s[50:51], v[228:229] op_sel:[0,0,1] op_sel_hi:[1,1,1] neg_lo:[1,0,1] neg_hi:[1,0,1]
 v_pk_fma_f32 v[210:211], v[174:175], s[50:51], v[194:195] op_sel:[0,0,1] op_sel_hi:[1,1,1] neg_lo:[1,0,1] neg_hi:[1,0,1]
 v_pk_fma_f32 v[246:247], v[190:191], s[50:51], v[230:231] op_sel:[0,0,1] op_sel_hi:[1,1,1] neg_lo:[1,0,1] neg_hi:[1,0,1]
 v_pk_fma_f32 v[166:167], v[166:167], s[50:51], v[192:193] op_sel_hi:[1,1,0] neg_lo:[0,0,1] neg_hi:[0,0,1]
 v_pk_fma_f32 v[182:183], v[182:183], s[50:51], v[228:229] op_sel_hi:[1,1,0] neg_lo:[0,0,1] neg_hi:[0,0,1]
 v_pk_fma_f32 v[174:175], v[174:175], s[50:51], v[194:195] op_sel_hi:[1,1,0] neg_lo:[0,0,1] neg_hi:[0,0,1]
 v_pk_fma_f32 v[190:191], v[190:191], s[50:51], v[230:231] op_sel_hi:[1,1,0] neg_lo:[0,0,1] neg_hi:[0,0,1]
 s_waitcnt lgkmcnt(15)
 v_mfma_f32_16x16x32_bf16 v[128:131], a[64:67], a[0:3], 0
 v_exp_f32 v196, v196
 v_mfma_f32_16x16x32_bf16 v[132:135], a[64:67], a[4:7], 0
 v_exp_f32 v232, v232
 v_mfma_f32_16x16x32_bf16 v[136:139], a[64:67], v[144:147], 0
 v_exp_f32 v204, v204
 v_mfma_f32_16x16x32_bf16 v[128:131], a[68:71], a[8:11], v[128:131]
 v_exp_f32 v240, v240
 v_mfma_f32_16x16x32_bf16 v[132:135], a[68:71], a[12:15], v[132:135]
 v_exp_f32 v160, v160
 v_mfma_f32_16x16x32_bf16 v[136:139], a[68:71], v[144:147], v[136:139]
 v_exp_f32 v176, v176
 v_mfma_f32_16x16x32_bf16 v[128:131], a[72:75], a[16:19], v[128:131]
 v_exp_f32 v168, v168
 v_mfma_f32_16x16x32_bf16 v[132:135], a[72:75], a[20:23], v[132:135]
 v_exp_f32 v184, v184
 v_mfma_f32_16x16x32_bf16 v[136:139], a[72:75], v[144:147], v[136:139]
 v_exp_f32 v197, v197
 v_mfma_f32_16x16x32_bf16 v[128:131], a[76:79], a[24:27], v[128:131]
 v_exp_f32 v233, v233
 v_mfma_f32_16x16x32_bf16 v[132:135], a[76:79], a[28:31], v[132:135]
 v_exp_f32 v205, v205
 v_mfma_f32_16x16x32_bf16 v[136:139], a[76:79], v[144:147], v[136:139]
 v_exp_f32 v241, v241
 v_mfma_f32_16x16x32_bf16 v[128:131], a[80:83], a[32:35], v[128:131]
 v_exp_f32 v161, v161
 v_mfma_f32_16x16x32_bf16 v[132:135], a[80:83], a[36:39], v[132:135]
 v_exp_f32 v177, v177
 v_mfma_f32_16x16x32_bf16 v[136:139], a[80:83], v[144:147], v[136:139]
 v_exp_f32 v169, v169
 v_mfma_f32_16x16x32_bf16 v[128:131], a[84:87], a[40:43], v[128:131]
 v_exp_f32 v185, v185
 v_mfma_f32_16x16x32_bf16 v[132:135], a[84:87], a[44:47], v[132:135]
 v_exp_f32 v198, v198
 v_mfma_f32_16x16x32_bf16 v[136:139], a[84:87], v[144:147], v[136:139]
 v_exp_f32 v234, v234
 s_waitcnt lgkmcnt(12)
 v_mfma_f32_16x16x32_bf16 v[128:131], a[88:91], a[48:51], v[128:131]
 v_exp_f32 v206, v206
 v_mfma_f32_16x16x32_bf16 v[132:135], a[88:91], a[52:55], v[132:135]
 v_exp_f32 v242, v242
 v_mfma_f32_16x16x32_bf16 v[136:139], a[88:91], v[144:147], v[136:139]
 v_exp_f32 v162, v162
 s_waitcnt lgkmcnt(8)
 v_mfma_f32_16x16x32_bf16 v[128:131], a[92:95], a[56:59], v[128:131]
 v_exp_f32 v178, v178
 v_mfma_f32_16x16x32_bf16 v[132:135], a[92:95], a[60:63], v[132:135]
 v_exp_f32 v170, v170
 v_mfma_f32_16x16x32_bf16 v[136:139], a[92:95], v[144:147], v[136:139]
 v_exp_f32 v186, v186
 s_waitcnt lgkmcnt(7)
 v_mfma_f32_32x32x16_bf16 v[80:95], a[128:131], v[16:19], 0
 s_mov_b32 m0, s41
 s_add_u32 s41, s41, 0x4000
 buffer_load_dwordx4 v11, s[8:11], s40 offen offset:0 sc1 lds
 v_exp_f32 v199, v199
 v_exp_f32 v235, v235
 v_exp_f32 v207, v207
 v_mfma_f32_32x32x16_bf16 v[96:111], a[128:131], v[48:51], 0
 buffer_load_dwordx4 v11, s[8:11], s40 offen offset:1024 sc1 lds
 v_exp_f32 v243, v243
 v_exp_f32 v163, v163
 v_exp_f32 v179, v179
 s_waitcnt lgkmcnt(6)
 v_mfma_f32_32x32x16_bf16 v[80:95], a[132:135], v[20:23], v[80:95]
 buffer_load_dwordx4 v11, s[8:11], s40 offen offset:2048 sc1 lds
 v_exp_f32 v171, v171
 v_exp_f32 v187, v187
 v_exp_f32 v200, v200
 v_mfma_f32_32x32x16_bf16 v[96:111], a[132:135], v[52:55], v[96:111]
 buffer_load_dwordx4 v11, s[8:11], s40 offen offset:3072 sc1 lds
 s_add_u32 s40, s40, 0x4000
 v_exp_f32 v236, v236
 v_exp_f32 v208, v208
 v_exp_f32 v244, v244
 s_waitcnt lgkmcnt(5)
 v_mfma_f32_32x32x16_bf16 v[80:95], a[136:139], v[24:27], v[80:95]
 v_exp_f32 v164, v164
 v_exp_f32 v180, v180
 v_exp_f32 v172, v172
 v_mfma_f32_32x32x16_bf16 v[96:111], a[136:139], v[56:59], v[96:111]
 v_exp_f32 v188, v188
 v_exp_f32 v201, v201
 v_exp_f32 v237, v237
 s_waitcnt lgkmcnt(4)
 v_mfma_f32_32x32x16_bf16 v[80:95], a[140:143], v[28:31], v[80:95]
 v_exp_f32 v209, v209
 v_exp_f32 v245, v245
 v_exp_f32 v165, v165
 buffer_store_dwordx4 v[128:131], v10, s[20:23], s58 offen offset:0 sc1
 buffer_store_dwordx4 v[132:135], v10, s[20:23], s58 offen offset:1024 sc1
 buffer_store_dwordx4 v[136:139], v10, s[20:23], s58 offen offset:2048 sc1
 v_mfma_f32_32x32x16_bf16 v[96:111], a[140:143], v[60:63], v[96:111]
 v_exp_f32 v181, v181
 v_exp_f32 v173, v173
 v_exp_f32 v189, v189
 s_waitcnt lgkmcnt(3)
 v_mfma_f32_32x32x16_bf16 v[80:95], a[144:147], v[32:35], v[80:95]
 v_exp_f32 v202, v202
 v_exp_f32 v238, v238
 v_exp_f32 v210, v210
 v_mfma_f32_32x32x16_bf16 v[96:111], a[144:147], v[64:67], v[96:111]
 v_exp_f32 v246, v246
 v_exp_f32 v166, v166
 v_exp_f32 v182, v182
 s_waitcnt lgkmcnt(2)
 v_mfma_f32_32x32x16_bf16 v[80:95], a[148:151], v[36:39], v[80:95]
 v_exp_f32 v174, v174
 v_exp_f32 v190, v190
 v_exp_f32 v203, v203
 v_mfma_f32_32x32x16_bf16 v[96:111], a[148:151], v[68:71], v[96:111]
 v_exp_f32 v239, v239
 v_exp_f32 v211, v211
 v_exp_f32 v247, v247
 s_waitcnt lgkmcnt(1)
 v_mfma_f32_32x32x16_bf16 v[80:95], a[152:155], v[40:43], v[80:95]
 v_exp_f32 v167, v167
 v_exp_f32 v183, v183
 v_exp_f32 v175, v175
 v_mfma_f32_32x32x16_bf16 v[96:111], a[152:155], v[72:75], v[96:111]
 v_exp_f32 v191, v191
 s_waitcnt lgkmcnt(0)
 v_mfma_f32_32x32x16_bf16 v[80:95], a[156:159], v[44:47], v[80:95]
 v_mfma_f32_32x32x16_bf16 v[96:111], a[156:159], v[76:79], v[96:111]
 v_pk_add_f32 v[212:213], v[160:161], v[162:163]
 v_pk_add_f32 v[248:249], v[176:177], v[178:179]
 v_pk_add_f32 v[216:217], v[168:169], v[170:171]
 v_pk_add_f32 v[252:253], v[184:185], v[186:187]
 v_pk_add_f32 v[214:215], v[196:197], v[198:199]
 v_pk_add_f32 v[250:251], v[232:233], v[234:235]
 v_pk_add_f32 v[218:219], v[204:205], v[206:207]
 v_pk_add_f32 v[254:255], v[240:241], v[242:243]
 v_pk_add_f32 v[212:213], v[212:213], v[164:165]
 v_pk_add_f32 v[248:249], v[248:249], v[180:181]
 v_pk_add_f32 v[216:217], v[216:217], v[172:173]
 v_pk_add_f32 v[252:253], v[252:253], v[188:189]
 v_pk_add_f32 v[214:215], v[214:215], v[200:201]
 v_pk_add_f32 v[250:251], v[250:251], v[236:237]
 v_pk_add_f32 v[218:219], v[218:219], v[208:209]
 v_pk_add_f32 v[254:255], v[254:255], v[244:245]
 v_pk_add_f32 v[212:213], v[212:213], v[166:167]
 v_pk_add_f32 v[248:249], v[248:249], v[182:183]
 v_pk_add_f32 v[216:217], v[216:217], v[174:175]
 v_pk_add_f32 v[252:253], v[252:253], v[190:191]
 v_pk_add_f32 v[214:215], v[214:215], v[202:203]
 v_pk_add_f32 v[250:251], v[250:251], v[238:239]
 v_pk_add_f32 v[218:219], v[218:219], v[210:211]
 v_pk_add_f32 v[254:255], v[254:255], v[246:247]
 v_add_f32 v192, v212, v213
 v_add_f32 v228, v248, v249
 v_add_f32 v194, v216, v217
 v_add_f32 v230, v252, v253
 v_add_f32 v193, v214, v215
 v_add_f32 v229, v250, v251
 v_add_f32 v195, v218, v219
 v_add_f32 v231, v254, v255
 v_permlane16_swap_b32 v192, v193
 v_permlane16_swap_b32 v228, v229
 v_permlane16_swap_b32 v194, v195
 v_permlane16_swap_b32 v230, v231
 v_add_f32 v192, v192, v193
 v_add_f32 v228, v228, v229
 v_add_f32 v194, v194, v195
 v_add_f32 v230, v230, v231
 s_nop 0
 v_permlane32_swap_b32 v192, v194
 v_permlane32_swap_b32 v228, v230
 v_add_f32 v192, v192, v194
 v_add_f32 v228, v228, v230
 v_mov_b32 v194, v192
 v_mov_b32 v230, v228
 s_nop 0
 v_permlane32_swap_b32 v192, v194
 v_permlane32_swap_b32 v228, v230
 v_mov_b32 v193, v192
 v_mov_b32 v229, v228
 v_mov_b32 v195, v194
 v_mov_b32 v231, v230
 v_permlane16_swap_b32 v192, v193
 v_permlane16_swap_b32 v228, v229
 v_permlane16_swap_b32 v194, v195
 v_permlane16_swap_b32 v230, v231
 v_rcp_f32 v192, v192
 v_rcp_f32 v228, v228
 v_rcp_f32 v193, v193
 v_rcp_f32 v229, v229
 v_rcp_f32 v194, v194
 v_rcp_f32 v230, v230
 v_rcp_f32 v195, v195
 v_rcp_f32 v231, v231
 v_pk_mul_f32 v[160:161], v[160:161], v[192:193] op_sel_hi:[1,0]
 v_pk_mul_f32 v[176:177], v[176:177], v[228:229] op_sel_hi:[1,0]
 v_pk_mul_f32 v[168:169], v[168:169], v[194:195] op_sel_hi:[1,0]
 v_pk_mul_f32 v[184:185], v[184:185], v[230:231] op_sel_hi:[1,0]
 v_pk_mul_f32 v[196:197], v[196:197], v[192:193] op_sel:[0,1] op_sel_hi:[1,1]
 v_pk_mul_f32 v[232:233], v[232:233], v[228:229] op_sel:[0,1] op_sel_hi:[1,1]
 v_pk_mul_f32 v[204:205], v[204:205], v[194:195] op_sel:[0,1] op_sel_hi:[1,1]
 v_pk_mul_f32 v[240:241], v[240:241], v[230:231] op_sel:[0,1] op_sel_hi:[1,1]
 v_pk_mul_f32 v[162:163], v[162:163], v[192:193] op_sel_hi:[1,0]
 v_pk_mul_f32 v[178:179], v[178:179], v[228:229] op_sel_hi:[1,0]
 v_pk_mul_f32 v[170:171], v[170:171], v[194:195] op_sel_hi:[1,0]
 v_pk_mul_f32 v[186:187], v[186:187], v[230:231] op_sel_hi:[1,0]
 v_pk_mul_f32 v[198:199], v[198:199], v[192:193] op_sel:[0,1] op_sel_hi:[1,1]
 v_pk_mul_f32 v[234:235], v[234:235], v[228:229] op_sel:[0,1] op_sel_hi:[1,1]
 v_pk_mul_f32 v[206:207], v[206:207], v[194:195] op_sel:[0,1] op_sel_hi:[1,1]
 v_pk_mul_f32 v[242:243], v[242:243], v[230:231] op_sel:[0,1] op_sel_hi:[1,1]
 v_pk_mul_f32 v[164:165], v[164:165], v[192:193] op_sel_hi:[1,0]
 v_pk_mul_f32 v[180:181], v[180:181], v[228:229] op_sel_hi:[1,0]
 v_pk_mul_f32 v[172:173], v[172:173], v[194:195] op_sel_hi:[1,0]
 v_pk_mul_f32 v[188:189], v[188:189], v[230:231] op_sel_hi:[1,0]
 v_pk_mul_f32 v[200:201], v[200:201], v[192:193] op_sel:[0,1] op_sel_hi:[1,1]
 v_pk_mul_f32 v[236:237], v[236:237], v[228:229] op_sel:[0,1] op_sel_hi:[1,1]
 v_pk_mul_f32 v[208:209], v[208:209], v[194:195] op_sel:[0,1] op_sel_hi:[1,1]
 v_pk_mul_f32 v[244:245], v[244:245], v[230:231] op_sel:[0,1] op_sel_hi:[1,1]
 v_pk_mul_f32 v[166:167], v[166:167], v[192:193] op_sel_hi:[1,0]
 v_pk_mul_f32 v[182:183], v[182:183], v[228:229] op_sel_hi:[1,0]
 v_pk_mul_f32 v[174:175], v[174:175], v[194:195] op_sel_hi:[1,0]
 v_pk_mul_f32 v[190:191], v[190:191], v[230:231] op_sel_hi:[1,0]
 v_pk_mul_f32 v[202:203], v[202:203], v[192:193] op_sel:[0,1] op_sel_hi:[1,1]
 v_pk_mul_f32 v[238:239], v[238:239], v[228:229] op_sel:[0,1] op_sel_hi:[1,1]
 v_pk_mul_f32 v[210:211], v[210:211], v[194:195] op_sel:[0,1] op_sel_hi:[1,1]
 v_pk_mul_f32 v[246:247], v[246:247], v[230:231] op_sel:[0,1] op_sel_hi:[1,1]
 v_cvt_pk_bf16_f32 v160, v160, v161
 v_cvt_pk_bf16_f32 v176, v176, v177
 v_cvt_pk_bf16_f32 v168, v168, v169
 v_cvt_pk_bf16_f32 v184, v184, v185
 v_cvt_pk_bf16_f32 v161, v162, v163
 v_cvt_pk_bf16_f32 v177, v178, v179
 v_cvt_pk_bf16_f32 v169, v170, v171
 v_cvt_pk_bf16_f32 v185, v186, v187
 v_cvt_pk_bf16_f32 v162, v164, v165
 v_cvt_pk_bf16_f32 v178, v180, v181
 v_cvt_pk_bf16_f32 v170, v172, v173
 v_cvt_pk_bf16_f32 v186, v188, v189
 v_cvt_pk_bf16_f32 v163, v166, v167
 v_cvt_pk_bf16_f32 v179, v182, v183
 v_cvt_pk_bf16_f32 v171, v174, v175
 v_cvt_pk_bf16_f32 v187, v190, v191
 v_cvt_pk_bf16_f32 v164, v196, v197
 v_cvt_pk_bf16_f32 v180, v232, v233
 v_cvt_pk_bf16_f32 v172, v204, v205
 v_cvt_pk_bf16_f32 v188, v240, v241
 v_cvt_pk_bf16_f32 v165, v198, v199
 v_cvt_pk_bf16_f32 v181, v234, v235
 v_cvt_pk_bf16_f32 v173, v206, v207
 v_cvt_pk_bf16_f32 v189, v242, v243
 v_cvt_pk_bf16_f32 v166, v200, v201
 v_cvt_pk_bf16_f32 v182, v236, v237
 v_cvt_pk_bf16_f32 v174, v208, v209
 v_cvt_pk_bf16_f32 v190, v244, v245
 v_cvt_pk_bf16_f32 v167, v202, v203
 v_cvt_pk_bf16_f32 v183, v238, v239
 v_cvt_pk_bf16_f32 v175, v210, v211
 v_cvt_pk_bf16_f32 v191, v246, v247
 v_mov_b32 v228, 0
 v_mov_b32 v229, 0
 v_mov_b32 v230, v4
 v_mov_b32 v231, v4
 v_mov_b32 v12, v3
 v_lshrrev_b32 v15, 2, v14
 v_mov_b32 v8, v10
 v_add_u32 v9, 0x4000, v10
 v_add_u32 v13, s72, v10
 s_sub_u32 m0, s41, 0x4000
 s_sub_u32 s40, s40, 0x4000
 s_waitcnt vmcnt(7)
 s_barrier
 v_sub_f32 v224, 1.0, v224
 ds_write_b128 v13, v[160:163] offset:0
 v_sub_f32 v225, 1.0, v225
 s_cmp_eq_u32 s54, 0
 s_cbranch_scc1 K2_mask0
K2_mask0_b:
 v_max3_f32 v240, v80, v81, v82
 v_max3_f32 v240, v240, v83, v84
 v_max3_f32 v240, v240, v85, v86
 v_max3_f32 v240, v240, v87, v88
 v_max3_f32 v240, v240, v89, v90
 ds_write_b128 v13, v[164:167] offset:1024
 v_max3_f32 v240, v240, v91, v92
 v_max3_f32 v240, v240, v93, v94
 v_max_f32 v240, v240, v95
 v_mov_b32 v241, v240
 s_nop 1
 v_permlane32_swap_b32 v240, v241
 v_max_f32 v240, v240, v241
 ds_write_b128 v13, v[168:171] offset:2048
 v_mov_b32 v241, v240
 v_max3_f32 v242, v96, v97, v98
 v_max3_f32 v242, v242, v99, v100
 v_max3_f32 v242, v242, v101, v102
 v_max3_f32 v242, v242, v103, v104
 v_max3_f32 v242, v242, v105, v106
 ds_write_b128 v13, v[172:175] offset:3072
 v_max3_f32 v242, v242, v107, v108
 v_max3_f32 v242, v242, v109, v110
 v_max_f32 v242, v242, v111
 v_mov_b32 v243, v242
 s_nop 1
 v_permlane32_swap_b32 v242, v243
 v_max_f32 v242, v242, v243
 ds_write_b128 v13, v[176:179] offset:4096
 v_mov_b32 v243, v242
 v_pk_add_f32 v[80:81], v[80:81], v[240:241] neg_lo:[0,1] neg_hi:[0,1]
 v_pk_add_f32 v[82:83], v[82:83], v[240:241] neg_lo:[0,1] neg_hi:[0,1]
 v_pk_add_f32 v[84:85], v[84:85], v[240:241] neg_lo:[0,1] neg_hi:[0,1]
 v_pk_add_f32 v[86:87], v[86:87], v[240:241] neg_lo:[0,1] neg_hi:[0,1]
 v_pk_add_f32 v[88:89], v[88:89], v[240:241] neg_lo:[0,1] neg_hi:[0,1]
 ds_write_b128 v13, v[180:183] offset:5120
 v_pk_add_f32 v[90:91], v[90:91], v[240:241] neg_lo:[0,1] neg_hi:[0,1]
 v_pk_add_f32 v[92:93], v[92:93], v[240:241] neg_lo:[0,1] neg_hi:[0,1]
 v_pk_add_f32 v[94:95], v[94:95], v[240:241] neg_lo:[0,1] neg_hi:[0,1]
 v_pk_add_f32 v[96:97], v[96:97], v[242:243] neg_lo:[0,1] neg_hi:[0,1]
 v_pk_add_f32 v[98:99], v[98:99], v[242:243] neg_lo:[0,1] neg_hi:[0,1]
 v_pk_add_f32 v[100:101], v[100:101], v[242:243] neg_lo:[0,1] neg_hi:[0,1]
 ds_write_b128 v13, v[184:187] offset:6144
 v_pk_add_f32 v[102:103], v[102:103], v[242:243] neg_lo:[0,1] neg_hi:[0,1]
 v_pk_add_f32 v[104:105], v[104:105], v[242:243] neg_lo:[0,1] neg_hi:[0,1]
 v_pk_add_f32 v[106:107], v[106:107], v[242:243] neg_lo:[0,1] neg_hi:[0,1]
 v_pk_add_f32 v[108:109], v[108:109], v[242:243] neg_lo:[0,1] neg_hi:[0,1]
 v_pk_add_f32 v[110:111], v[110:111], v[242:243] neg_lo:[0,1] neg_hi:[0,1]
 v_pk_add_f32 v[144:145], v[240:241], 0 neg_lo:[1,0] neg_hi:[1,0]
 ds_write_b128 v13, v[188:191] offset:7168
 v_pk_add_f32 v[146:147], v[240:241], 0 neg_lo:[1,0] neg_hi:[1,0]
 v_pk_add_f32 v[148:149], v[240:241], 0 neg_lo:[1,0] neg_hi:[1,0]
 v_pk_add_f32 v[150:151], v[240:241], 0 neg_lo:[1,0] neg_hi:[1,0]
 v_pk_add_f32 v[152:153], v[240:241], 0 neg_lo:[1,0] neg_hi:[1,0]
 v_pk_add_f32 v[154:155], v[240:241], 0 neg_lo:[1,0] neg_hi:[1,0]
 v_pk_add_f32 v[156:157], v[240:241], 0 neg_lo:[1,0] neg_hi:[1,0]
 v_pk_add_f32 v[158:159], v[240:241], 0 neg_lo:[1,0] neg_hi:[1,0]
 ds_read_b128 a[128:131], v9 offset:0
 ds_read_b128 a[132:135], v9 offset:1024
 ds_read_b128 a[136:139], v9 offset:2048
 ds_read_b128 a[140:143], v9 offset:3072
 ds_read_b128 a[144:147], v9 offset:4096
 ds_read_b128 a[148:151], v9 offset:5120
 ds_read_b128 a[152:155], v9 offset:6144
 ds_read_b128 a[156:159], v9 offset:7168
 s_cmp_eq_u32 s54, 0
 s_cbranch_scc1 K2_mask1
K2_mask1_b:
 v_exp_f32 v208, v80
 v_exp_f32 v209, v81
 s_nop 0
 v_add_f32 v226, v208, v209
 v_cvt_pk_bf16_f32 v192, v208, v209
 v_exp_f32 v210, v82
 v_exp_f32 v211, v83
 v_add_f32 v226, v226, v210
 v_add_f32 v226, v226, v211
 v_cvt_pk_bf16_f32 v193, v210, v211
 v_exp_f32 v212, v84
 v_exp_f32 v213, v85
 v_add_f32 v226, v226, v212
 v_add_f32 v226, v226, v213
 v_cvt_pk_bf16_f32 v194, v212, v213
 v_exp_f32 v214, v86
 v_exp_f32 v215, v87
 v_add_f32 v226, v226, v214
 v_add_f32 v226, v226, v215
 v_cvt_pk_bf16_f32 v195, v214, v215
 v_exp_f32 v208, v88
 v_exp_f32 v209, v89
 s_waitcnt lgkmcnt(8)
 v_pk_add_f32 v[160:161], v[242:243], 0 neg_lo:[1,0] neg_hi:[1,0]
 v_pk_add_f32 v[162:163], v[242:243], 0 neg_lo:[1,0] neg_hi:[1,0]
 v_pk_add_f32 v[164:165], v[242:243], 0 neg_lo:[1,0] neg_hi:[1,0]
 v_pk_add_f32 v[166:167], v[242:243], 0 neg_lo:[1,0] neg_hi:[1,0]
 v_pk_add_f32 v[168:169], v[242:243], 0 neg_lo:[1,0] neg_hi:[1,0]
 v_pk_add_f32 v[170:171], v[242:243], 0 neg_lo:[1,0] neg_hi:[1,0]
 v_pk_add_f32 v[172:173], v[242:243], 0 neg_lo:[1,0] neg_hi:[1,0]
 v_pk_add_f32 v[174:175], v[242:243], 0 neg_lo:[1,0] neg_hi:[1,0]
 v_pk_add_f32 v[176:177], v[242:243], 0 neg_lo:[1,0] neg_hi:[1,0]
 v_pk_add_f32 v[178:179], v[242:243], 0 neg_lo:[1,0] neg_hi:[1,0]
 v_pk_add_f32 v[180:181], v[242:243], 0 neg_lo:[1,0] neg_hi:[1,0]
 v_pk_add_f32 v[182:183], v[242:243], 0 neg_lo:[1,0] neg_hi:[1,0]
 v_pk_add_f32 v[184:185], v[242:243], 0 neg_lo:[1,0] neg_hi:[1,0]
 v_pk_add_f32 v[186:187], v[242:243], 0 neg_lo:[1,0] neg_hi:[1,0]
 v_pk_add_f32 v[188:189], v[242:243], 0 neg_lo:[1,0] neg_hi:[1,0]
 v_pk_add_f32 v[190:191], v[242:243], 0 neg_lo:[1,0] neg_hi:[1,0]
 s_lshl_b32 s47, s54, 1
 s_add_u32 s47, s47, 1
 s_waitcnt lgkmcnt(6)
 v_mfma_f32_32x32x16_bf16 v[112:127], a[128:131], v[16:19], v[144:159]
 s_add_u32 m0, m0, 0x4000
 s_and_b32 m0, m0, 0x1ffff
 s_add_u32 s40, s40, 0x4000
 v_add_f32 v226, v226, v208
 v_exp_f32 v210, v90
 v_mfma_f32_32x32x16_bf16 v[128:143], a[128:131], v[48:51], v[160:175]
 ds_read_b128 a[192:195], v8 offset:8192
 v_add_f32 v226, v226, v209
 v_cvt_pk_bf16_f32 v196, v208, v209
 v_exp_f32 v211, v91
 v_mfma_f32_32x32x16_bf16 v[112:127], a[132:135], v[20:23], v[112:127]
 ds_read_b128 a[196:199], v8 offset:9216
 buffer_load_dwordx4 v11, s[8:11], s40 offen offset:0 sc1 lds
 v_add_f32 v226, v226, v210
 v_exp_f32 v212, v92
 v_mfma_f32_32x32x16_bf16 v[128:143], a[132:135], v[52:55], v[128:143]
 buffer_load_dwordx4 v11, s[8:11], s40 offen offset:1024 sc1 lds
 v_add_f32 v226, v226, v211
 v_exp_f32 v213, v93
 s_waitcnt lgkmcnt(6)
 v_mfma_f32_32x32x16_bf16 v[112:127], a[136:139], v[24:27], v[112:127]
 ds_read_b128 a[200:203], v8 offset:10240
 s_cmp_ge_i32 s44, s45
 s_cbranch_scc1 K2_prep1
K2_prep1_b:
 v_cvt_pk_bf16_f32 v197, v210, v211
 v_exp_f32 v214, v94
 v_mfma_f32_32x32x16_bf16 v[128:143], a[136:139], v[56:59], v[128:143]
 buffer_load_dwordx4 v11, s[8:11], s40 offen offset:2048 sc1 lds
 v_add_f32 v226, v226, v212
 v_add_f32 v226, v226, v213
 v_exp_f32 v215, v95
 v_mfma_f32_32x32x16_bf16 v[112:127], a[140:143], v[28:31], v[112:127]
 v_cvt_pk_bf16_f32 v198, v212, v213
 v_add_f32 v226, v226, v214
 v_add_f32 v226, v226, v215
 v_cmp_nge_f32 vcc, s39, v226
 v_exp_f32 v216, v96
 v_mfma_f32_32x32x16_bf16 v[128:143], a[140:143], v[60:63], v[128:143]
 ds_read_b128 a[204:207], v8 offset:11264
 v_cvt_pk_bf16_f32 v199, v214, v215
 s_cbranch_vccnz K2_rare2
K2_back2:
 v_exp_f32 v217, v97
 s_waitcnt lgkmcnt(6)
 v_mfma_f32_32x32x16_bf16 v[112:127], a[144:147], v[32:35], v[112:127]
 buffer_load_dwordx4 v11, s[8:11], s40 offen offset:3072 sc1 lds
 s_add_u32 m0, m0, 0x4000
 s_and_b32 m0, m0, 0x1ffff
 v_exp_f32 v218, v98
 v_mfma_f32_32x32x16_bf16 v[128:143], a[144:147], v[64:67], v[128:143]
 ds_read_b128 a[208:211], v8 offset:12288
 s_add_u32 s40, s40, 0x4000
 buffer_load_dwordx4 v11, s[8:11], s40 offen offset:0 sc1 lds
 v_exp_f32 v219, v99
 v_mfma_f32_32x32x16_bf16 v[112:127], a[148:151], v[36:39], v[112:127]
 buffer_load_dwordx4 v11, s[8:11], s40 offen offset:1024 sc1 lds
 v_add_f32 v228, v228, v226
 v_add_f32 v227, v216, v217
 v_exp_f32 v220, v100
 v_mfma_f32_32x32x16_bf16 v[128:143], a[148:151], v[68:71], v[128:143]
 ds_read_b128 a[212:215], v8 offset:13312
 buffer_load_dwordx4 v11, s[8:11], s40 offen offset:2048 sc1 lds
 v_exp_f32 v221, v101
 s_waitcnt lgkmcnt(6)
 v_mfma_f32_32x32x16_bf16 v[112:127], a[152:155], v[40:43], v[112:127]
 v_cvt_pk_bf16_f32 v200, v216, v217
 v_add_f32 v227, v227, v218
 v_add_f32 v227, v227, v219
 v_exp_f32 v222, v102
 v_mfma_f32_32x32x16_bf16 v[128:143], a[152:155], v[72:75], v[128:143]
 buffer_load_dwordx4 v11, s[8:11], s40 offen offset:3072 sc1 lds
 s_add_u32 m0, m0, 0x4000
 s_and_b32 m0, m0, 0x1ffff
 v_exp_f32 v223, v103
 v_mfma_f32_32x32x16_bf16 v[112:127], a[156:159], v[44:47], v[112:127]
 ds_read_b128 a[216:219], v8 offset:14336
 s_add_u32 s40, s40, 0x4000
 v_cvt_pk_bf16_f32 v201, v218, v219
 v_add_f32 v227, v227, v220
 v_exp_f32 v216, v104
 v_mfma_f32_32x32x16_bf16 v[128:143], a[156:159], v[76:79], v[128:143]
 ds_read_b128 a[220:223], v8 offset:15360
 buffer_load_dwordx4 v11, s[8:11], s40 offen offset:0 sc1 lds
 v_exp_f32 v217, v105
 s_waitcnt lgkmcnt(4)
 v_mfma_f32_32x32x16_bf16 a[0:15], a[192:195], v[192:195], 0
 buffer_load_dwordx4 v11, s[8:11], s40 offen offset:1024 sc1 lds
 v_add_f32 v227, v227, v221
 v_cvt_pk_bf16_f32 v202, v220, v221
 v_exp_f32 v218, v106
 v_mfma_f32_32x32x16_bf16 a[16:31], a[196:199], v[192:195], 0
 buffer_load_dwordx4 v11, s[8:11], s40 offen offset:2048 sc1 lds
 v_add_f32 v227, v227, v222
 v_add_f32 v227, v227, v223
 v_exp_f32 v219, v107
 v_mfma_f32_32x32x16_bf16 a[32:47], a[200:203], v[192:195], 0
 v_cvt_pk_bf16_f32 v203, v222, v223
 v_add_f32 v227, v227, v216
 v_add_f32 v227, v227, v217
 v_exp_f32 v220, v108
 v_mfma_f32_32x32x16_bf16 a[48:63], a[204:207], v[192:195], 0
 buffer_load_dwordx4 v11, s[8:11], s40 offen offset:3072 sc1 lds
 v_cvt_pk_bf16_f32 v204, v216, v217
 v_exp_f32 v221, v109
 s_waitcnt lgkmcnt(0)
 v_mfma_f32_32x32x16_bf16 a[0:15], a[208:211], v[196:199], a[0:15]
 v_add_u32 v8, s42, v10
 v_add_f32 v227, v227, v218
 v_add_f32 v227, v227, v219
 v_cvt_pk_bf16_f32 v205, v218, v219
 v_exp_f32 v222, v110
 v_mfma_f32_32x32x16_bf16 a[16:31], a[212:215], v[196:199], a[16:31]
 v_add_f32 v227, v227, v220
 v_add_f32 v227, v227, v221
 v_cvt_pk_bf16_f32 v206, v220, v221
 v_exp_f32 v223, v111
 v_mfma_f32_32x32x16_bf16 a[32:47], a[216:219], v[196:199], a[32:47]
 ds_read_b128 a[128:131], v8 offset:0
 v_add_f32 v227, v227, v222
 v_add_f32 v227, v227, v223
 v_cmp_nge_f32 vcc, s39, v227
 v_exp_f32 v208, v112
 v_mfma_f32_32x32x16_bf16 a[48:63], a[220:223], v[196:199], a[48:63]
 ds_read_b128 a[132:135], v8 offset:1024
 v_cvt_pk_bf16_f32 v207, v222, v223
 s_cbranch_vccnz K2_rare3
K2_back3:
 v_exp_f32 v209, v113
 v_mfma_f32_32x32x16_bf16 a[64:79], a[192:195], v[200:203], 0
 ds_read_b128 a[136:139], v8 offset:2048
 s_add_u32 s42, s42, 0x4000
 s_and_b32 s42, s42, 0x1ffff
 v_add_f32 v229, v229, v227
 v_exp_f32 v210, v114
 v_mfma_f32_32x32x16_bf16 a[80:95], a[196:199], v[200:203], 0
 ds_read_b128 a[140:143], v8 offset:3072
 s_add_u32 m0, m0, 0x4000
 s_and_b32 m0, m0, 0x1ffff
 s_add_u32 s40, s40, 0x4000
 v_exp_f32 v211, v115
 v_mfma_f32_32x32x16_bf16 a[96:111], a[200:203], v[200:203], 0
 buffer_load_dwordx4 v11, s[8:11], s40 offen offset:0 sc1 lds
 s_add_u32 s44, s44, 1
 v_add_f32 v226, v208, v209
 v_exp_f32 v212, v116
 v_mfma_f32_32x32x16_bf16 a[112:127], a[204:207], v[200:203], 0
 ds_read_b128 a[144:147], v8 offset:4096
 v_cvt_pk_bf16_f32 v192, v208, v209
 v_add_f32 v226, v226, v210
 v_exp_f32 v213, v117
 v_mfma_f32_32x32x16_bf16 a[64:79], a[208:211], v[204:207], a[64:79]
 ds_read_b128 a[148:151], v8 offset:5120
 v_add_f32 v226, v226, v211
 v_cvt_pk_bf16_f32 v193, v210, v211
 v_add_f32 v226, v226, v212
 v_exp_f32 v214, v118
 v_mfma_f32_32x32x16_bf16 a[80:95], a[212:215], v[204:207], a[80:95]
 ds_read_b128 a[152:155], v8 offset:6144
 buffer_load_dwordx4 v11, s[8:11], s40 offen offset:1024 sc1 lds
 v_add_f32 v226, v226, v213
 v_exp_f32 v215, v119
 v_mfma_f32_32x32x16_bf16 a[96:111], a[216:219], v[204:207], a[96:111]
 ds_read_b128 a[156:159], v8 offset:7168
 v_cvt_pk_bf16_f32 v194, v212, v213
 v_add_f32 v226, v226, v214
 v_add_f32 v226, v226, v215
 v_exp_f32 v208, v120
 v_mfma_f32_32x32x16_bf16 a[112:127], a[220:223], v[204:207], a[112:127]
 v_cvt_pk_bf16_f32 v195, v214, v215
 v_exp_f32 v209, v121
 s_waitcnt lgkmcnt(6)
 v_mfma_f32_32x32x16_bf16 v[80:95], a[128:131], v[16:19], v[144:159]
 v_add_f32 v226, v226, v208
 v_add_f32 v226, v226, v209
 v_cvt_pk_bf16_f32 v196, v208, v209
 v_exp_f32 v210, v122
 v_mfma_f32_32x32x16_bf16 v[96:111], a[128:131], v[48:51], v[160:175]
 ds_read_b128 a[192:195], v9 offset:8192
 v_exp_f32 v211, v123
 v_mfma_f32_32x32x16_bf16 v[80:95], a[132:135], v[20:23], v[80:95]
 ds_read_b128 a[196:199], v9 offset:9216
 buffer_load_dwordx4 v11, s[8:11], s40 offen offset:2048 sc1 lds
 v_add_f32 v226, v226, v210
 v_exp_f32 v212, v124
 v_mfma_f32_32x32x16_bf16 v[96:111], a[132:135], v[52:55], v[96:111]
 v_add_f32 v226, v226, v211
 v_cvt_pk_bf16_f32 v197, v210, v211
 v_exp_f32 v213, v125
 s_waitcnt lgkmcnt(6)
 v_mfma_f32_32x32x16_bf16 v[80:95], a[136:139], v[24:27], v[80:95]
 ds_read_b128 a[200:203], v9 offset:10240
 s_cmp_ge_i32 s44, s45
 s_cbranch_scc1 K2_prep4
K2_prep4_b:
 v_add_f32 v226, v226, v212
 v_exp_f32 v214, v126
 v_mfma_f32_32x32x16_bf16 v[96:111], a[136:139], v[56:59], v[96:111]
 v_add_f32 v226, v226, v213
 v_cvt_pk_bf16_f32 v198, v212, v213
 v_exp_f32 v215, v127
 v_mfma_f32_32x32x16_bf16 v[80:95], a[140:143], v[28:31], v[80:95]
 v_add_f32 v226, v226, v214
 v_add_f32 v226, v226, v215
 v_cmp_nge_f32 vcc, s39, v226
 v_exp_f32 v216, v128
 v_mfma_f32_32x32x16_bf16 v[96:111], a[140:143], v[60:63], v[96:111]
 ds_read_b128 a[204:207], v9 offset:11264
 v_cvt_pk_bf16_f32 v199, v214, v215
 s_cbranch_vccnz K2_rare5
K2_back5:
 v_exp_f32 v217, v129
 s_waitcnt lgkmcnt(6)
 v_mfma_f32_32x32x16_bf16 v[80:95], a[144:147], v[32:35], v[80:95]
 v_add_f32 v228, v228, v226
 v_add_f32 v227, v216, v217
 v_cvt_pk_bf16_f32 v200, v216, v217
 v_exp_f32 v218, v130
 v_mfma_f32_32x32x16_bf16 v[96:111], a[144:147], v[64:67], v[96:111]
 ds_read_b128 a[208:211], v9 offset:12288
 v_exp_f32 v219, v131
 v_mfma_f32_32x32x16_bf16 v[80:95], a[148:151], v[36:39], v[80:95]
 v_add_f32 v227, v227, v218
 v_add_f32 v227, v227, v219
 v_cvt_pk_bf16_f32 v201, v218, v219
 v_exp_f32 v220, v132
 v_mfma_f32_32x32x16_bf16 v[96:111], a[148:151], v[68:71], v[96:111]
 ds_read_b128 a[212:215], v9 offset:13312
 buffer_load_dwordx4 v11, s[8:11], s40 offen offset:3072 sc1 lds
 v_exp_f32 v221, v133
 s_waitcnt lgkmcnt(6)
 v_mfma_f32_32x32x16_bf16 v[80:95], a[152:155], v[40:43], v[80:95]
 v_add_f32 v227, v227, v220
 v_add_f32 v227, v227, v221
 v_cvt_pk_bf16_f32 v202, v220, v221
 v_exp_f32 v222, v134
 v_mfma_f32_32x32x16_bf16 v[96:111], a[152:155], v[72:75], v[96:111]
 v_exp_f32 v223, v135
 v_mfma_f32_32x32x16_bf16 v[80:95], a[156:159], v[44:47], v[80:95]
 ds_read_b128 a[216:219], v9 offset:14336
 v_add_f32 v227, v227, v222
 v_add_f32 v227, v227, v223
 v_cvt_pk_bf16_f32 v203, v222, v223
 v_exp_f32 v216, v136
 v_mfma_f32_32x32x16_bf16 v[96:111], a[156:159], v[76:79], v[96:111]
 ds_read_b128 a[220:223], v9 offset:15360
 v_exp_f32 v217, v137
 s_waitcnt lgkmcnt(4)
 v_mfma_f32_32x32x16_bf16 a[0:15], a[192:195], v[192:195], a[0:15]
 v_add_f32 v227, v227, v216
 v_add_f32 v227, v227, v217
 v_cvt_pk_bf16_f32 v204, v216, v217
 v_exp_f32 v218, v138
 v_mfma_f32_32x32x16_bf16 a[16:31], a[196:199], v[192:195], a[16:31]
 v_exp_f32 v219, v139
 v_mfma_f32_32x32x16_bf16 a[32:47], a[200:203], v[192:195], a[32:47]
 v_add_f32 v227, v227, v218
 v_add_f32 v227, v227, v219
 v_cvt_pk_bf16_f32 v205, v218, v219
 v_exp_f32 v220, v140
 v_mfma_f32_32x32x16_bf16 a[48:63], a[204:207], v[192:195], a[48:63]
 v_exp_f32 v221, v141
 s_waitcnt lgkmcnt(0)
 v_mfma_f32_32x32x16_bf16 a[0:15], a[208:211], v[196:199], a[0:15]
 v_add_u32 v9, s42, v10
 v_add_f32 v227, v227, v220
 v_add_f32 v227, v227, v221
 v_cvt_pk_bf16_f32 v206, v220, v221
 v_exp_f32 v222, v142
 v_mfma_f32_32x32x16_bf16 a[16:31], a[212:215], v[196:199], a[16:31]
 v_exp_f32 v223, v143
 s_cmp_eq_u32 s44, 1
 s_cbranch_scc1 K2_sig
 s_waitcnt lgkmcnt(0) vmcnt(12)
 s_barrier
K2_sig_b:
 v_mfma_f32_32x32x16_bf16 a[32:47], a[216:219], v[196:199], a[32:47]
 ds_read_b128 a[128:131], v9 offset:0
 v_add_f32 v227, v227, v222
 v_add_f32 v227, v227, v223
 v_cmp_nge_f32 vcc, s39, v227
 v_exp_f32 v208, v80
 v_mfma_f32_32x32x16_bf16 a[48:63], a[220:223], v[196:199], a[48:63]
 ds_read_b128 a[132:135], v9 offset:1024
 v_cvt_pk_bf16_f32 v207, v222, v223
 s_cbranch_vccnz K2_rare6
K2_back6:
 v_add_f32 v229, v229, v227
 v_exp_f32 v209, v81
 v_mfma_f32_32x32x16_bf16 a[64:79], a[192:195], v[200:203], a[64:79]
 ds_read_b128 a[136:139], v9 offset:2048
 s_add_u32 s42, s42, 0x4000
 s_and_b32 s42, s42, 0x1ffff
 s_add_u32 m0, m0, 0x4000
 v_exp_f32 v210, v82
 v_mfma_f32_32x32x16_bf16 a[80:95], a[196:199], v[200:203], a[80:95]
 ds_read_b128 a[140:143], v9 offset:3072
 s_and_b32 m0, m0, 0x1ffff
 s_add_u32 s40, s40, 0x4000
 s_add_u32 s44, s44, 1
 v_exp_f32 v211, v83
 v_mfma_f32_32x32x16_bf16 a[96:111], a[200:203], v[200:203], a[96:111]
 buffer_load_dwordx4 v11, s[8:11], s40 offen offset:0 sc1 lds
 v_add_f32 v226, v208, v209
 v_cvt_pk_bf16_f32 v192, v208, v209
 v_exp_f32 v212, v84
 v_mfma_f32_32x32x16_bf16 a[112:127], a[204:207], v[200:203], a[112:127]
 ds_read_b128 a[144:147], v9 offset:4096
 v_add_f32 v226, v226, v210
 v_add_f32 v226, v226, v211
 v_cvt_pk_bf16_f32 v193, v210, v211
 v_exp_f32 v213, v85
 v_mfma_f32_32x32x16_bf16 a[64:79], a[208:211], v[204:207], a[64:79]
 ds_read_b128 a[148:151], v9 offset:5120
 v_add_f32 v226, v226, v212
 v_add_f32 v226, v226, v213
 v_cvt_pk_bf16_f32 v194, v212, v213
 v_exp_f32 v214, v86
 v_mfma_f32_32x32x16_bf16 a[80:95], a[212:215], v[204:207], a[80:95]
 ds_read_b128 a[152:155], v9 offset:6144
 buffer_load_dwordx4 v11, s[8:11], s40 offen offset:1024 sc1 lds
 v_exp_f32 v215, v87
 v_mfma_f32_32x32x16_bf16 a[96:111], a[216:219], v[204:207], a[96:111]
 ds_read_b128 a[156:159], v9 offset:7168
 v_add_f32 v226, v226, v214
 v_add_f32 v226, v226, v215
 v_cvt_pk_bf16_f32 v195, v214, v215
 v_exp_f32 v208, v88
 v_mfma_f32_32x32x16_bf16 a[112:127], a[220:223], v[204:207], a[112:127]
 v_exp_f32 v209, v89
 s_cmp_eq_u32 s54, 0
 s_cbranch_scc1 K2_pairT
 s_sub_u32 s47, s47, 3
 s_cmp_eq_u32 s47, 0
 s_cbranch_scc1 K2_maskD
K2_loopD:
 s_waitcnt lgkmcnt(6)
 v_mfma_f32_32x32x16_bf16 v[112:127], a[128:131], v[16:19], v[144:159]
 v_add_f32 v226, v226, v208
 v_add_f32 v226, v226, v209
 v_cvt_pk_bf16_f32 v196, v208, v209
 v_exp_f32 v210, v90
 v_mfma_f32_32x32x16_bf16 v[128:143], a[128:131], v[48:51], v[160:175]
 ds_read_b128 a[192:195], v8 offset:8192
 v_exp_f32 v211, v91
 v_mfma_f32_32x32x16_bf16 v[112:127], a[132:135], v[20:23], v[112:127]
 ds_read_b128 a[196:199], v8 offset:9216
 buffer_load_dwordx4 v11, s[8:11], s40 offen offset:2048 sc1 lds
 v_add_f32 v226, v226, v210
 v_exp_f32 v212, v92
 v_mfma_f32_32x32x16_bf16 v[128:143], a[132:135], v[52:55], v[128:143]
 v_add_f32 v226, v226, v211
 v_cvt_pk_bf16_f32 v197, v210, v211
 v_exp_f32 v213, v93
 s_waitcnt lgkmcnt(6)
 v_mfma_f32_32x32x16_bf16 v[112:127], a[136:139], v[24:27], v[112:127]
 ds_read_b128 a[200:203], v8 offset:10240
 v_add_f32 v226, v226, v212
 v_add_f32 v226, v226, v213
 v_cvt_pk_bf16_f32 v198, v212, v213
 v_exp_f32 v214, v94
 v_mfma_f32_32x32x16_bf16 v[128:143], a[136:139], v[56:59], v[128:143]
 v_exp_f32 v215, v95
 v_mfma_f32_32x32x16_bf16 v[112:127], a[140:143], v[28:31], v[112:127]
 v_add_f32 v226, v226, v214
 v_add_f32 v226, v226, v215
 v_cmp_nge_f32 vcc, s39, v226
 v_exp_f32 v216, v96
 v_mfma_f32_32x32x16_bf16 v[128:143], a[140:143], v[60:63], v[128:143]
 ds_read_b128 a[204:207], v8 offset:11264
 v_cvt_pk_bf16_f32 v199, v214, v215
 s_cbranch_vccnz K2_rare7
K2_back7:
 v_exp_f32 v217, v97
 s_waitcnt lgkmcnt(6)
 v_mfma_f32_32x32x16_bf16 v[112:127], a[144:147], v[32:35], v[112:127]
 v_add_f32 v228, v228, v226
 v_add_f32 v227, v216, v217
 v_cvt_pk_bf16_f32 v200, v216, v217
 v_exp_f32 v218, v98
 v_mfma_f32_32x32x16_bf16 v[128:143], a[144:147], v[64:67], v[128:143]
 ds_read_b128 a[208:211], v8 offset:12288
 v_exp_f32 v219, v99
 v_mfma_f32_32x32x16_bf16 v[112:127], a[148:151], v[36:39], v[112:127]
 v_add_f32 v227, v227, v218
 v_add_f32 v227, v227, v219
 v_cvt_pk_bf16_f32 v201, v218, v219
 v_exp_f32 v220, v100
 v_mfma_f32_32x32x16_bf16 v[128:143], a[148:151], v[68:71], v[128:143]
 ds_read_b128 a[212:215], v8 offset:13312
 buffer_load_dwordx4 v11, s[8:11], s40 offen offset:3072 sc1 lds
 v_exp_f32 v221, v101
 s_waitcnt lgkmcnt(6)
 v_mfma_f32_32x32x16_bf16 v[112:127], a[152:155], v[40:43], v[112:127]
 v_add_f32 v227, v227, v220
 v_add_f32 v227, v227, v221
 v_cvt_pk_bf16_f32 v202, v220, v221
 v_exp_f32 v222, v102
 v_mfma_f32_32x32x16_bf16 v[128:143], a[152:155], v[72:75], v[128:143]
 v_exp_f32 v223, v103
 v_mfma_f32_32x32x16_bf16 v[112:127], a[156:159], v[44:47], v[112:127]
 ds_read_b128 a[216:219], v8 offset:14336
 v_add_f32 v227, v227, v222
 v_add_f32 v227, v227, v223
 v_cvt_pk_bf16_f32 v203, v222, v223
 v_exp_f32 v216, v104
 v_mfma_f32_32x32x16_bf16 v[128:143], a[156:159], v[76:79], v[128:143]
 ds_read_b128 a[220:223], v8 offset:15360
 v_exp_f32 v217, v105
 s_waitcnt lgkmcnt(4)
 v_mfma_f32_32x32x16_bf16 a[0:15], a[192:195], v[192:195], a[0:15]
 v_add_f32 v227, v227, v216
 v_add_f32 v227, v227, v217
 v_cvt_pk_bf16_f32 v204, v216, v217
 v_exp_f32 v218, v106
 v_mfma_f32_32x32x16_bf16 a[16:31], a[196:199], v[192:195], a[16:31]
 v_exp_f32 v219, v107
 v_mfma_f32_32x32x16_bf16 a[32:47], a[200:203], v[192:195], a[32:47]
 v_add_f32 v227, v227, v218
 v_add_f32 v227, v227, v219
 v_cvt_pk_bf16_f32 v205, v218, v219
 v_exp_f32 v220, v108
 v_mfma_f32_32x32x16_bf16 a[48:63], a[204:207], v[192:195], a[48:63]
 v_exp_f32 v221, v109
 s_waitcnt lgkmcnt(0)
 v_mfma_f32_32x32x16_bf16 a[0:15], a[208:211], v[196:199], a[0:15]
 v_add_u32 v8, s42, v10
 v_add_f32 v227, v227, v220
 v_add_f32 v227, v227, v221
 v_cvt_pk_bf16_f32 v206, v220, v221
 v_exp_f32 v222, v110
 v_mfma_f32_32x32x16_bf16 a[16:31], a[212:215], v[196:199], a[16:31]
 v_exp_f32 v223, v111
 v_mfma_f32_32x32x16_bf16 a[32:47], a[216:219], v[196:199], a[32:47]
 ds_read_b128 a[128:131], v8 offset:0
 v_add_f32 v227, v227, v222
 v_add_f32 v227, v227, v223
 v_cmp_nge_f32 vcc, s39, v227
 v_exp_f32 v208, v112
 v_mfma_f32_32x32x16_bf16 a[48:63], a[220:223], v[196:199], a[48:63]
 ds_read_b128 a[132:135], v8 offset:1024
 v_cvt_pk_bf16_f32 v207, v222, v223
 s_cbranch_vccnz K2_rare8
K2_back8:
 v_exp_f32 v209, v113
 v_mfma_f32_32x32x16_bf16 a[64:79], a[192:195], v[200:203], a[64:79]
 ds_read_b128 a[136:139], v8 offset:2048
 s_add_u32 s42, s42, 0x4000
 s_and_b32 s42, s42, 0x1ffff
 v_add_f32 v229, v229, v227
 v_exp_f32 v210, v114
 v_mfma_f32_32x32x16_bf16 a[80:95], a[196:199], v[200:203], a[80:95]
 ds_read_b128 a[140:143], v8 offset:3072
 s_add_u32 m0, m0, 0x4000
 s_and_b32 m0, m0, 0x1ffff
 s_add_u32 s40, s40, 0x4000
 v_exp_f32 v211, v115
 v_mfma_f32_32x32x16_bf16 a[96:111], a[200:203], v[200:203], a[96:111]
 buffer_load_dwordx4 v11, s[8:11], s40 offen offset:0 sc1 lds
 s_add_u32 s44, s44, 1
 v_add_f32 v226, v208, v209
 v_exp_f32 v212, v116
 v_mfma_f32_32x32x16_bf16 a[112:127], a[204:207], v[200:203], a[112:127]
 ds_read_b128 a[144:147], v8 offset:4096
 v_cvt_pk_bf16_f32 v192, v208, v209
 v_add_f32 v226, v226, v210
 v_exp_f32 v213, v117
 v_mfma_f32_32x32x16_bf16 a[64:79], a[208:211], v[204:207], a[64:79]
 ds_read_b128 a[148:151], v8 offset:5120
 v_add_f32 v226, v226, v211
 v_cvt_pk_bf16_f32 v193, v210, v211
 v_add_f32 v226, v226, v212
 v_exp_f32 v214, v118
 v_mfma_f32_32x32x16_bf16 a[80:95], a[212:215], v[204:207], a[80:95]
 ds_read_b128 a[152:155], v8 offset:6144
 buffer_load_dwordx4 v11, s[8:11], s40 offen offset:1024 sc1 lds
 v_add_f32 v226, v226, v213
 v_exp_f32 v215, v119
 v_mfma_f32_32x32x16_bf16 a[96:111], a[216:219], v[204:207], a[96:111]
 ds_read_b128 a[156:159], v8 offset:7168
 v_cvt_pk_bf16_f32 v194, v212, v213
 v_add_f32 v226, v226, v214
 v_add_f32 v226, v226, v215
 v_exp_f32 v208, v120
 v_mfma_f32_32x32x16_bf16 a[112:127], a[220:223], v[204:207], a[112:127]
 v_cvt_pk_bf16_f32 v195, v214, v215
 v_exp_f32 v209, v121
 s_waitcnt lgkmcnt(6)
 v_mfma_f32_32x32x16_bf16 v[80:95], a[128:131], v[16:19], v[144:159]
 v_add_f32 v226, v226, v208
 v_add_f32 v226, v226, v209
 v_cvt_pk_bf16_f32 v196, v208, v209
 v_exp_f32 v210, v122
 v_mfma_f32_32x32x16_bf16 v[96:111], a[128:131], v[48:51], v[160:175]
 ds_read_b128 a[192:195], v9 offset:8192
 v_exp_f32 v211, v123
 v_mfma_f32_32x32x16_bf16 v[80:95], a[132:135], v[20:23], v[80:95]
 ds_read_b128 a[196:199], v9 offset:9216
 buffer_load_dwordx4 v11, s[8:11], s40 offen offset:2048 sc1 lds
 v_add_f32 v226, v226, v210
 v_exp_f32 v212, v124
 v_mfma_f32_32x32x16_bf16 v[96:111], a[132:135], v[52:55], v[96:111]
 v_add_f32 v226, v226, v211
 v_cvt_pk_bf16_f32 v197, v210, v211
 v_exp_f32 v213, v125
 s_waitcnt lgkmcnt(6)
 v_mfma_f32_32x32x16_bf16 v[80:95], a[136:139], v[24:27], v[80:95]
 ds_read_b128 a[200:203], v9 offset:10240
 v_add_f32 v226, v226, v212
 v_add_f32 v226, v226, v213
 v_cvt_pk_bf16_f32 v198, v212, v213
 v_exp_f32 v214, v126
 v_mfma_f32_32x32x16_bf16 v[96:111], a[136:139], v[56:59], v[96:111]
 v_exp_f32 v215, v127
 v_mfma_f32_32x32x16_bf16 v[80:95], a[140:143], v[28:31], v[80:95]
 v_add_f32 v226, v226, v214
 v_add_f32 v226, v226, v215
 v_cmp_nge_f32 vcc, s39, v226
 v_exp_f32 v216, v128
 v_mfma_f32_32x32x16_bf16 v[96:111], a[140:143], v[60:63], v[96:111]
 ds_read_b128 a[204:207], v9 offset:11264
 v_cvt_pk_bf16_f32 v199, v214, v215
 s_cbranch_vccnz K2_rare9
K2_back9:
 v_exp_f32 v217, v129
 s_waitcnt lgkmcnt(6)
 v_mfma_f32_32x32x16_bf16 v[80:95], a[144:147], v[32:35], v[80:95]
 v_add_f32 v228, v228, v226
 v_add_f32 v227, v216, v217
 v_cvt_pk_bf16_f32 v200, v216, v217
 v_exp_f32 v218, v130
 v_mfma_f32_32x32x16_bf16 v[96:111], a[144:147], v[64:67], v[96:111]
 ds_read_b128 a[208:211], v9 offset:12288
 v_exp_f32 v219, v131
 v_mfma_f32_32x32x16_bf16 v[80:95], a[148:151], v[36:39], v[80:95]
 v_add_f32 v227, v227, v218
 v_add_f32 v227, v227, v219
 v_cvt_pk_bf16_f32 v201, v218, v219
 v_exp_f32 v220, v132
 v_mfma_f32_32x32x16_bf16 v[96:111], a[148:151], v[68:71], v[96:111]
 ds_read_b128 a[212:215], v9 offset:13312
 buffer_load_dwordx4 v11, s[8:11], s40 offen offset:3072 sc1 lds
 v_exp_f32 v221, v133
 s_waitcnt lgkmcnt(6)
 v_mfma_f32_32x32x16_bf16 v[80:95], a[152:155], v[40:43], v[80:95]
 v_add_f32 v227, v227, v220
 v_add_f32 v227, v227, v221
 v_cvt_pk_bf16_f32 v202, v220, v221
 v_exp_f32 v222, v134
 v_mfma_f32_32x32x16_bf16 v[96:111], a[152:155], v[72:75], v[96:111]
 v_exp_f32 v223, v135
 v_mfma_f32_32x32x16_bf16 v[80:95], a[156:159], v[44:47], v[80:95]
 ds_read_b128 a[216:219], v9 offset:14336
 v_add_f32 v227, v227, v222
 v_add_f32 v227, v227, v223
 v_cvt_pk_bf16_f32 v203, v222, v223
 v_exp_f32 v216, v136
 v_mfma_f32_32x32x16_bf16 v[96:111], a[156:159], v[76:79], v[96:111]
 ds_read_b128 a[220:223], v9 offset:15360
 v_exp_f32 v217, v137
 s_waitcnt lgkmcnt(4)
 v_mfma_f32_32x32x16_bf16 a[0:15], a[192:195], v[192:195], a[0:15]
 v_add_f32 v227, v227, v216
 v_add_f32 v227, v227, v217
 v_cvt_pk_bf16_f32 v204, v216, v217
 v_exp_f32 v218, v138
 v_mfma_f32_32x32x16_bf16 a[16:31], a[196:199], v[192:195], a[16:31]
 v_exp_f32 v219, v139
 v_mfma_f32_32x32x16_bf16 a[32:47], a[200:203], v[192:195], a[32:47]
 v_add_f32 v227, v227, v218
 v_add_f32 v227, v227, v219
 v_cvt_pk_bf16_f32 v205, v218, v219
 v_exp_f32 v220, v140
 v_mfma_f32_32x32x16_bf16 a[48:63], a[204:207], v[192:195], a[48:63]
 v_exp_f32 v221, v141
 s_waitcnt lgkmcnt(0)
 v_mfma_f32_32x32x16_bf16 a[0:15], a[208:211], v[196:199], a[0:15]
 v_add_u32 v9, s42, v10
 v_add_f32 v227, v227, v220
 v_add_f32 v227, v227, v221
 v_cvt_pk_bf16_f32 v206, v220, v221
 v_exp_f32 v222, v142
 v_mfma_f32_32x32x16_bf16 a[16:31], a[212:215], v[196:199], a[16:31]
 v_exp_f32 v223, v143
 s_waitcnt lgkmcnt(0) vmcnt(12)
 s_barrier
 v_mfma_f32_32x32x16_bf16 a[32:47], a[216:219], v[196:199], a[32:47]
 ds_read_b128 a[128:131], v9 offset:0
 v_add_f32 v227, v227, v222
 v_add_f32 v227, v227, v223
 v_cmp_nge_f32 vcc, s39, v227
 v_exp_f32 v208, v80
 v_mfma_f32_32x32x16_bf16 a[48:63], a[220:223], v[196:199], a[48:63]
 ds_read_b128 a[132:135], v9 offset:1024
 v_cvt_pk_bf16_f32 v207, v222, v223
 s_cbranch_vccnz K2_rare10
K2_back10:
 v_add_f32 v229, v229, v227
 v_exp_f32 v209, v81
 v_mfma_f32_32x32x16_bf16 a[64:79], a[192:195], v[200:203], a[64:79]
 ds_read_b128 a[136:139], v9 offset:2048
 s_add_u32 s42, s42, 0x4000
 s_and_b32 s42, s42, 0x1ffff
 s_add_u32 m0, m0, 0x4000
 v_exp_f32 v210, v82
 v_mfma_f32_32x32x16_bf16 a[80:95], a[196:199], v[200:203], a[80:95]
 ds_read_b128 a[140:143], v9 offset:3072
 s_and_b32 m0, m0, 0x1ffff
 s_add_u32 s40, s40, 0x4000
 s_add_u32 s44, s44, 1
 v_exp_f32 v211, v83
 v_mfma_f32_32x32x16_bf16 a[96:111], a[200:203], v[200:203], a[96:111]
 buffer_load_dwordx4 v11, s[8:11], s40 offen offset:0 sc1 lds
 v_add_f32 v226, v208, v209
 v_cvt_pk_bf16_f32 v192, v208, v209
 v_exp_f32 v212, v84
 v_mfma_f32_32x32x16_bf16 a[112:127], a[204:207], v[200:203], a[112:127]
 ds_read_b128 a[144:147], v9 offset:4096
 v_add_f32 v226, v226, v210
 v_add_f32 v226, v226, v211
 v_cvt_pk_bf16_f32 v193, v210, v211
 v_exp_f32 v213, v85
 v_mfma_f32_32x32x16_bf16 a[64:79], a[208:211], v[204:207], a[64:79]
 ds_read_b128 a[148:151], v9 offset:5120
 v_add_f32 v226, v226, v212
 v_add_f32 v226, v226, v213
 v_cvt_pk_bf16_f32 v194, v212, v213
 v_exp_f32 v214, v86
 v_mfma_f32_32x32x16_bf16 a[80:95], a[212:215], v[204:207], a[80:95]
 ds_read_b128 a[152:155], v9 offset:6144
 buffer_load_dwordx4 v11, s[8:11], s40 offen offset:1024 sc1 lds
 v_exp_f32 v215, v87
 v_mfma_f32_32x32x16_bf16 a[96:111], a[216:219], v[204:207], a[96:111]
 ds_read_b128 a[156:159], v9 offset:7168
 v_add_f32 v226, v226, v214
 v_add_f32 v226, v226, v215
 v_cvt_pk_bf16_f32 v195, v214, v215
 v_exp_f32 v208, v88
 v_mfma_f32_32x32x16_bf16 a[112:127], a[220:223], v[204:207], a[112:127]
 v_exp_f32 v209, v89
 s_cmp_eq_u32 s44, s95
 s_cbranch_scc1 K2_lin
K2_lin_b:
 s_sub_u32 s47, s47, 1
 s_cmp_lg_u32 s47, 0
 s_cbranch_scc1 K2_loopD
K2_maskD:
 s_mov_b32 s47, 2
K2_loopM:
 s_waitcnt lgkmcnt(6)
 v_mfma_f32_32x32x16_bf16 v[112:127], a[128:131], v[16:19], v[144:159]
 v_add_f32 v226, v226, v208
 v_add_f32 v226, v226, v209
 v_cvt_pk_bf16_f32 v196, v208, v209
 v_exp_f32 v210, v90
 v_mfma_f32_32x32x16_bf16 v[128:143], a[128:131], v[48:51], v[160:175]
 ds_read_b128 a[192:195], v8 offset:8192
 v_exp_f32 v211, v91
 v_mfma_f32_32x32x16_bf16 v[112:127], a[132:135], v[20:23], v[112:127]
 ds_read_b128 a[196:199], v8 offset:9216
 buffer_load_dwordx4 v11, s[8:11], s40 offen offset:2048 sc1 lds
 v_add_f32 v226, v226, v210
 v_exp_f32 v212, v92
 v_mfma_f32_32x32x16_bf16 v[128:143], a[132:135], v[52:55], v[128:143]
 v_add_f32 v226, v226, v211
 v_cvt_pk_bf16_f32 v197, v210, v211
 v_add_f32 v240, 0x00000000, v230
 v_exp_f32 v213, v93
 s_waitcnt lgkmcnt(6)
 v_mfma_f32_32x32x16_bf16 v[112:127], a[136:139], v[24:27], v[112:127]
 ds_read_b128 a[200:203], v8 offset:10240
 v_add_f32 v226, v226, v212
 v_add_f32 v226, v226, v213
 v_cvt_pk_bf16_f32 v198, v212, v213
 v_exp_f32 v214, v94
 v_mfma_f32_32x32x16_bf16 v[128:143], a[136:139], v[56:59], v[128:143]
 v_min_f32 v144, v144, v240
 v_add_f32 v241, 0xdf800000, v230
 v_min_f32 v145, v145, v241
 v_exp_f32 v215, v95
 v_mfma_f32_32x32x16_bf16 v[112:127], a[140:143], v[28:31], v[112:127]
 v_add_f32 v226, v226, v214
 v_add_f32 v226, v226, v215
 v_cmp_nge_f32 vcc, s39, v226
 v_exp_f32 v216, v96
 v_mfma_f32_32x32x16_bf16 v[128:143], a[140:143], v[60:63], v[128:143]
 ds_read_b128 a[204:207], v8 offset:11264
 v_cvt_pk_bf16_f32 v199, v214, v215
 s_cbranch_vccnz K2_rare11
K2_back11:
 v_exp_f32 v217, v97
 s_waitcnt lgkmcnt(6)
 v_mfma_f32_32x32x16_bf16 v[112:127], a[144:147], v[32:35], v[112:127]
 v_add_f32 v228, v228, v226
 v_add_f32 v227, v216, v217
 v_cvt_pk_bf16_f32 v200, v216, v217
 v_exp_f32 v218, v98
 v_mfma_f32_32x32x16_bf16 v[128:143], a[144:147], v[64:67], v[128:143]
 ds_read_b128 a[208:211], v8 offset:12288
 v_add_f32 v242, 0xe0000000, v230
 v_min_f32 v146, v146, v242
 v_add_f32 v243, 0xe0400000, v230
 v_exp_f32 v219, v99
 v_mfma_f32_32x32x16_bf16 v[112:127], a[148:151], v[36:39], v[112:127]
 v_add_f32 v227, v227, v218
 v_add_f32 v227, v227, v219
 v_cvt_pk_bf16_f32 v201, v218, v219
 v_exp_f32 v220, v100
 v_mfma_f32_32x32x16_bf16 v[128:143], a[148:151], v[68:71], v[128:143]
 ds_read_b128 a[212:215], v8 offset:13312
 buffer_load_dwordx4 v11, s[8:11], s40 offen offset:3072 sc1 lds
 v_exp_f32 v221, v101
 s_waitcnt lgkmcnt(6)
 v_mfma_f32_32x32x16_bf16 v[112:127], a[152:155], v[40:43], v[112:127]
 v_add_f32 v227, v227, v220
 v_add_f32 v227, v227, v221
 v_cvt_pk_bf16_f32 v202, v220, v221
 v_exp_f32 v222, v102
 v_mfma_f32_32x32x16_bf16 v[128:143], a[152:155], v[72:75], v[128:143]
 v_min_f32 v147, v147, v243
 v_add_f32 v240, 0xe1000000, v230
 v_min_f32 v148, v148, v240
 v_exp_f32 v223, v103
 v_mfma_f32_32x32x16_bf16 v[112:127], a[156:159], v[44:47], v[112:127]
 ds_read_b128 a[216:219], v8 offset:14336
 v_add_f32 v227, v227, v222
 v_add_f32 v227, v227, v223
 v_cvt_pk_bf16_f32 v203, v222, v223
 v_exp_f32 v216, v104
 v_mfma_f32_32x32x16_bf16 v[128:143], a[156:159], v[76:79], v[128:143]
 ds_read_b128 a[220:223], v8 offset:15360
 v_add_f32 v241, 0xe1100000, v230
 v_min_f32 v149, v149, v241
 v_exp_f32 v217, v105
 s_waitcnt lgkmcnt(4)
 v_mfma_f32_32x32x16_bf16 a[0:15], a[192:195], v[192:195], a[0:15]
 v_add_f32 v227, v227, v216
 v_add_f32 v227, v227, v217
 v_cvt_pk_bf16_f32 v204, v216, v217
 v_exp_f32 v218, v106
 v_mfma_f32_32x32x16_bf16 a[16:31], a[196:199], v[192:195], a[16:31]
 v_add_f32 v242, 0xe1200000, v230
 v_min_f32 v150, v150, v242
 v_add_f32 v243, 0xe1300000, v230
 v_exp_f32 v219, v107
 v_mfma_f32_32x32x16_bf16 a[32:47], a[200:203], v[192:195], a[32:47]
 v_add_f32 v227, v227, v218
 v_add_f32 v227, v227, v219
 v_cvt_pk_bf16_f32 v205, v218, v219
 v_exp_f32 v220, v108
 v_mfma_f32_32x32x16_bf16 a[48:63], a[204:207], v[192:195], a[48:63]
 v_min_f32 v151, v151, v243
 v_add_f32 v240, 0xe1800000, v230
 v_min_f32 v152, v152, v240
 v_exp_f32 v221, v109
 s_waitcnt lgkmcnt(0)
 v_mfma_f32_32x32x16_bf16 a[0:15], a[208:211], v[196:199], a[0:15]
 v_add_u32 v8, s42, v10
 v_add_f32 v227, v227, v220
 v_add_f32 v227, v227, v221
 v_cvt_pk_bf16_f32 v206, v220, v221
 v_exp_f32 v222, v110
 v_mfma_f32_32x32x16_bf16 a[16:31], a[212:215], v[196:199], a[16:31]
 v_add_f32 v241, 0xe1880000, v230
 v_min_f32 v153, v153, v241
 v_add_f32 v242, 0xe1900000, v230
 v_exp_f32 v223, v111
 v_mfma_f32_32x32x16_bf16 a[32:47], a[216:219], v[196:199], a[32:47]
 ds_read_b128 a[128:131], v8 offset:0
 v_add_f32 v227, v227, v222
 v_add_f32 v227, v227, v223
 v_cmp_nge_f32 vcc, s39, v227
 v_exp_f32 v208, v112
 v_mfma_f32_32x32x16_bf16 a[48:63], a[220:223], v[196:199], a[48:63]
 ds_read_b128 a[132:135], v8 offset:1024
 v_cvt_pk_bf16_f32 v207, v222, v223
 s_cbranch_vccnz K2_rare12
K2_back12:
 v_exp_f32 v209, v113
 v_mfma_f32_32x32x16_bf16 a[64:79], a[192:195], v[200:203], a[64:79]
 ds_read_b128 a[136:139], v8 offset:2048
 s_add_u32 s42, s42, 0x4000
 s_and_b32 s42, s42, 0x1ffff
 v_add_f32 v229, v229, v227
 v_exp_f32 v210, v114
 v_mfma_f32_32x32x16_bf16 a[80:95], a[196:199], v[200:203], a[80:95]
 ds_read_b128 a[140:143], v8 offset:3072
 s_add_u32 m0, m0, 0x4000
 s_and_b32 m0, m0, 0x1ffff
 s_add_u32 s40, s40, 0x4000
 v_exp_f32 v211, v115
 v_mfma_f32_32x32x16_bf16 a[96:111], a[200:203], v[200:203], a[96:111]
 buffer_load_dwordx4 v11, s[8:11], s40 offen offset:0 sc1 lds
 s_add_u32 s44, s44, 1
 v_add_f32 v226, v208, v209
 v_exp_f32 v212, v116
 v_mfma_f32_32x32x16_bf16 a[112:127], a[204:207], v[200:203], a[112:127]
 ds_read_b128 a[144:147], v8 offset:4096
 v_cvt_pk_bf16_f32 v192, v208, v209
 v_add_f32 v226, v226, v210
 v_exp_f32 v213, v117
 v_mfma_f32_32x32x16_bf16 a[64:79], a[208:211], v[204:207], a[64:79]
 ds_read_b128 a[148:151], v8 offset:5120
 v_add_f32 v226, v226, v211
 v_cvt_pk_bf16_f32 v193, v210, v211
 v_add_f32 v226, v226, v212
 v_exp_f32 v214, v118
 v_mfma_f32_32x32x16_bf16 a[80:95], a[212:215], v[204:207], a[80:95]
 ds_read_b128 a[152:155], v8 offset:6144
 buffer_load_dwordx4 v11, s[8:11], s40 offen offset:1024 sc1 lds
 v_add_f32 v226, v226, v213
 v_exp_f32 v215, v119
 v_mfma_f32_32x32x16_bf16 a[96:111], a[216:219], v[204:207], a[96:111]
 ds_read_b128 a[156:159], v8 offset:7168
 v_cvt_pk_bf16_f32 v194, v212, v213
 v_add_f32 v226, v226, v214
 v_add_f32 v226, v226, v215
 v_exp_f32 v208, v120
 v_mfma_f32_32x32x16_bf16 a[112:127], a[220:223], v[204:207], a[112:127]
 v_cvt_pk_bf16_f32 v195, v214, v215
 v_min_f32 v154, v154, v242
 v_add_f32 v243, 0xe1980000, v230
 v_min_f32 v155, v155, v243
 v_add_f32 v240, 0xe1c00000, v230
 v_min_f32 v156, v156, v240
 v_add_f32 v241, 0xe1c80000, v230
 v_min_f32 v157, v157, v241
 v_add_f32 v242, 0xe1d00000, v230
 v_min_f32 v158, v158, v242
 v_add_f32 v243, 0xe1d80000, v230
 v_min_f32 v159, v159, v243
 v_add_f32 v230, 0xe2000000, v230
 v_exp_f32 v209, v121
 s_waitcnt lgkmcnt(6)
 v_mfma_f32_32x32x16_bf16 v[80:95], a[128:131], v[16:19], v[144:159]
 v_add_f32 v226, v226, v208
 v_add_f32 v226, v226, v209
 v_cvt_pk_bf16_f32 v196, v208, v209
 v_exp_f32 v210, v122
 v_mfma_f32_32x32x16_bf16 v[96:111], a[128:131], v[48:51], v[160:175]
 ds_read_b128 a[192:195], v9 offset:8192
 v_exp_f32 v211, v123
 v_mfma_f32_32x32x16_bf16 v[80:95], a[132:135], v[20:23], v[80:95]
 ds_read_b128 a[196:199], v9 offset:9216
 buffer_load_dwordx4 v11, s[8:11], s40 offen offset:2048 sc1 lds
 v_add_f32 v226, v226, v210
 v_exp_f32 v212, v124
 v_mfma_f32_32x32x16_bf16 v[96:111], a[132:135], v[52:55], v[96:111]
 v_add_f32 v226, v226, v211
 v_cvt_pk_bf16_f32 v197, v210, v211
 v_add_f32 v240, 0x00000000, v230
 v_exp_f32 v213, v125
 s_waitcnt lgkmcnt(6)
 v_mfma_f32_32x32x16_bf16 v[80:95], a[136:139], v[24:27], v[80:95]
 ds_read_b128 a[200:203], v9 offset:10240
 v_add_f32 v226, v226, v212
 v_add_f32 v226, v226, v213
 v_cvt_pk_bf16_f32 v198, v212, v213
 v_exp_f32 v214, v126
 v_mfma_f32_32x32x16_bf16 v[96:111], a[136:139], v[56:59], v[96:111]
 v_min_f32 v144, v144, v240
 v_add_f32 v241, 0xdf800000, v230
 v_min_f32 v145, v145, v241
 v_exp_f32 v215, v127
 v_mfma_f32_32x32x16_bf16 v[80:95], a[140:143], v[28:31], v[80:95]
 v_add_f32 v226, v226, v214
 v_add_f32 v226, v226, v215
 v_cmp_nge_f32 vcc, s39, v226
 v_exp_f32 v216, v128
 v_mfma_f32_32x32x16_bf16 v[96:111], a[140:143], v[60:63], v[96:111]
 ds_read_b128 a[204:207], v9 offset:11264
 v_cvt_pk_bf16_f32 v199, v214, v215
 s_cbranch_vccnz K2_rare13
K2_back13:
 v_exp_f32 v217, v129
 s_waitcnt lgkmcnt(6)
 v_mfma_f32_32x32x16_bf16 v[80:95], a[144:147], v[32:35], v[80:95]
 v_add_f32 v228, v228, v226
 v_add_f32 v227, v216, v217
 v_cvt_pk_bf16_f32 v200, v216, v217
 v_exp_f32 v218, v130
 v_mfma_f32_32x32x16_bf16 v[96:111], a[144:147], v[64:67], v[96:111]
 ds_read_b128 a[208:211], v9 offset:12288
 v_add_f32 v242, 0xe0000000, v230
 v_min_f32 v146, v146, v242
 v_add_f32 v243, 0xe0400000, v230
 v_exp_f32 v219, v131
 v_mfma_f32_32x32x16_bf16 v[80:95], a[148:151], v[36:39], v[80:95]
 v_add_f32 v227, v227, v218
 v_add_f32 v227, v227, v219
 v_cvt_pk_bf16_f32 v201, v218, v219
 v_exp_f32 v220, v132
 v_mfma_f32_32x32x16_bf16 v[96:111], a[148:151], v[68:71], v[96:111]
 ds_read_b128 a[212:215], v9 offset:13312
 buffer_load_dwordx4 v11, s[8:11], s40 offen offset:3072 sc1 lds
 v_exp_f32 v221, v133
 s_waitcnt lgkmcnt(6)
 v_mfma_f32_32x32x16_bf16 v[80:95], a[152:155], v[40:43], v[80:95]
 v_add_f32 v227, v227, v220
 v_add_f32 v227, v227, v221
 v_cvt_pk_bf16_f32 v202, v220, v221
 v_exp_f32 v222, v134
 v_mfma_f32_32x32x16_bf16 v[96:111], a[152:155], v[72:75], v[96:111]
 v_min_f32 v147, v147, v243
 v_add_f32 v240, 0xe1000000, v230
 v_min_f32 v148, v148, v240
 v_exp_f32 v223, v135
 v_mfma_f32_32x32x16_bf16 v[80:95], a[156:159], v[44:47], v[80:95]
 ds_read_b128 a[216:219], v9 offset:14336
 v_add_f32 v227, v227, v222
 v_add_f32 v227, v227, v223
 v_cvt_pk_bf16_f32 v203, v222, v223
 v_exp_f32 v216, v136
 v_mfma_f32_32x32x16_bf16 v[96:111], a[156:159], v[76:79], v[96:111]
 ds_read_b128 a[220:223], v9 offset:15360
 v_add_f32 v241, 0xe1100000, v230
 v_min_f32 v149, v149, v241
 v_exp_f32 v217, v137
 s_waitcnt lgkmcnt(4)
 v_mfma_f32_32x32x16_bf16 a[0:15], a[192:195], v[192:195], a[0:15]
 v_add_f32 v227, v227, v216
 v_add_f32 v227, v227, v217
 v_cvt_pk_bf16_f32 v204, v216, v217
 v_exp_f32 v218, v138
 v_mfma_f32_32x32x16_bf16 a[16:31], a[196:199], v[192:195], a[16:31]
 v_add_f32 v242, 0xe1200000, v230
 v_min_f32 v150, v150, v242
 v_add_f32 v243, 0xe1300000, v230
 v_exp_f32 v219, v139
 v_mfma_f32_32x32x16_bf16 a[32:47], a[200:203], v[192:195], a[32:47]
 v_add_f32 v227, v227, v218
 v_add_f32 v227, v227, v219
 v_cvt_pk_bf16_f32 v205, v218, v219
 v_exp_f32 v220, v140
 v_mfma_f32_32x32x16_bf16 a[48:63], a[204:207], v[192:195], a[48:63]
 v_min_f32 v151, v151, v243
 v_add_f32 v240, 0xe1800000, v230
 v_min_f32 v152, v152, v240
 v_exp_f32 v221, v141
 s_waitcnt lgkmcnt(0)
 v_mfma_f32_32x32x16_bf16 a[0:15], a[208:211], v[196:199], a[0:15]
 v_add_u32 v9, s42, v10
 v_add_f32 v227, v227, v220
 v_add_f32 v227, v227, v221
 v_cvt_pk_bf16_f32 v206, v220, v221
 v_exp_f32 v222, v142
 v_mfma_f32_32x32x16_bf16 a[16:31], a[212:215], v[196:199], a[16:31]
 v_add_f32 v241, 0xe1880000, v230
 v_min_f32 v153, v153, v241
 v_exp_f32 v223, v143
 s_waitcnt lgkmcnt(0) vmcnt(12)
 s_barrier
 v_mfma_f32_32x32x16_bf16 a[32:47], a[216:219], v[196:199], a[32:47]
 ds_read_b128 a[128:131], v9 offset:0
 v_add_f32 v227, v227, v222
 v_add_f32 v227, v227, v223
 v_cmp_nge_f32 vcc, s39, v227
 v_exp_f32 v208, v80
 v_mfma_f32_32x32x16_bf16 a[48:63], a[220:223], v[196:199], a[48:63]
 ds_read_b128 a[132:135], v9 offset:1024
 v_cvt_pk_bf16_f32 v207, v222, v223
 s_cbranch_vccnz K2_rare14
K2_back14:
 v_add_f32 v229, v229, v227
 v_exp_f32 v209, v81
 v_mfma_f32_32x32x16_bf16 a[64:79], a[192:195], v[200:203], a[64:79]
 ds_read_b128 a[136:139], v9 offset:2048
 s_add_u32 s42, s42, 0x4000
 s_and_b32 s42, s42, 0x1ffff
 s_add_u32 m0, m0, 0x4000
 v_exp_f32 v210, v82
 v_mfma_f32_32x32x16_bf16 a[80:95], a[196:199], v[200:203], a[80:95]
 ds_read_b128 a[140:143], v9 offset:3072
 s_and_b32 m0, m0, 0x1ffff
 s_add_u32 s40, s40, 0x4000
 s_add_u32 s44, s44, 1
 v_exp_f32 v211, v83
 v_mfma_f32_32x32x16_bf16 a[96:111], a[200:203], v[200:203], a[96:111]
 buffer_load_dwordx4 v11, s[8:11], s40 offen offset:0 sc1 lds
 v_add_f32 v226, v208, v209
 v_cvt_pk_bf16_f32 v192, v208, v209
 v_exp_f32 v212, v84
 v_mfma_f32_32x32x16_bf16 a[112:127], a[204:207], v[200:203], a[112:127]
 ds_read_b128 a[144:147], v9 offset:4096
 v_add_f32 v226, v226, v210
 v_add_f32 v226, v226, v211
 v_cvt_pk_bf16_f32 v193, v210, v211
 v_exp_f32 v213, v85
 v_mfma_f32_32x32x16_bf16 a[64:79], a[208:211], v[204:207], a[64:79]
 ds_read_b128 a[148:151], v9 offset:5120
 v_add_f32 v226, v226, v212
 v_add_f32 v226, v226, v213
 v_cvt_pk_bf16_f32 v194, v212, v213
 v_exp_f32 v214, v86
 v_mfma_f32_32x32x16_bf16 a[80:95], a[212:215], v[204:207], a[80:95]
 ds_read_b128 a[152:155], v9 offset:6144
 buffer_load_dwordx4 v11, s[8:11], s40 offen offset:1024 sc1 lds
 v_add_f32 v242, 0xe1900000, v230
 v_exp_f32 v215, v87
 v_mfma_f32_32x32x16_bf16 a[96:111], a[216:219], v[204:207], a[96:111]
 ds_read_b128 a[156:159], v9 offset:7168
 v_add_f32 v226, v226, v214
 v_add_f32 v226, v226, v215
 v_cvt_pk_bf16_f32 v195, v214, v215
 v_exp_f32 v208, v88
 v_mfma_f32_32x32x16_bf16 a[112:127], a[220:223], v[204:207], a[112:127]
 v_min_f32 v154, v154, v242
 v_add_f32 v243, 0xe1980000, v230
 v_min_f32 v155, v155, v243
 v_add_f32 v240, 0xe1c00000, v230
 v_min_f32 v156, v156, v240
 v_add_f32 v241, 0xe1c80000, v230
 v_min_f32 v157, v157, v241
 v_add_f32 v242, 0xe1d00000, v230
 v_min_f32 v158, v158, v242
 v_add_f32 v243, 0xe1d80000, v230
 v_min_f32 v159, v159, v243
 v_add_f32 v230, 0xe2000000, v230
 v_exp_f32 v209, v89
 s_sub_u32 s47, s47, 1
 s_cmp_lg_u32 s47, 0
 s_cbranch_scc1 K2_loopM
K2_pairT:
 s_waitcnt lgkmcnt(6)
 v_mfma_f32_32x32x16_bf16 v[112:127], a[128:131], v[16:19], v[144:159]
 buffer_load_dword v13, v1, s[20:23], s49 offen sc1
 buffer_load_dword v247, v14, s[12:15], s75 offen
 buffer_load_dword v247, v15, s[16:19], s76 offen
 v_exp_f32 v210, v90
 v_mfma_f32_32x32x16_bf16 v[128:143], a[128:131], v[48:51], v[160:175]
 ds_read_b128 a[192:195], v8 offset:8192
 v_add_f32 v226, v226, v208
 v_add_f32 v226, v226, v209
 v_cvt_pk_bf16_f32 v196, v208, v209
 v_exp_f32 v211, v91
 v_mfma_f32_32x32x16_bf16 v[112:127], a[132:135], v[20:23], v[112:127]
 ds_read_b128 a[196:199], v8 offset:9216
 buffer_load_dwordx4 v11, s[8:11], s40 offen offset:2048 sc1 lds
 v_add_f32 v226, v226, v210
 v_exp_f32 v212, v92
 v_mfma_f32_32x32x16_bf16 v[128:143], a[132:135], v[52:55], v[128:143]
 v_add_f32 v226, v226, v211
 v_cvt_pk_bf16_f32 v197, v210, v211
 v_exp_f32 v213, v93
 s_waitcnt lgkmcnt(6)
 v_mfma_f32_32x32x16_bf16 v[112:127], a[136:139], v[24:27], v[112:127]
 ds_read_b128 a[200:203], v8 offset:10240
 s_cmp_ge_i32 s44, s46
 s_cbranch_scc1 K2_prep15
K2_prep15_b:
 v_add_f32 v226, v226, v212
 v_exp_f32 v214, v94
 v_mfma_f32_32x32x16_bf16 v[128:143], a[136:139], v[56:59], v[128:143]
 v_add_f32 v226, v226, v213
 v_cvt_pk_bf16_f32 v198, v212, v213
 v_exp_f32 v215, v95
 v_mfma_f32_32x32x16_bf16 v[112:127], a[140:143], v[28:31], v[112:127]
 v_add_f32 v226, v226, v214
 v_add_f32 v226, v226, v215
 v_cmp_nge_f32 vcc, s39, v226
 v_exp_f32 v216, v96
 v_mfma_f32_32x32x16_bf16 v[128:143], a[140:143], v[60:63], v[128:143]
 ds_read_b128 a[204:207], v8 offset:11264
 v_cvt_pk_bf16_f32 v199, v214, v215
 s_cbranch_vccnz K2_rare16
K2_back16:
 v_exp_f32 v217, v97
 s_waitcnt lgkmcnt(6)
 v_mfma_f32_32x32x16_bf16 v[112:127], a[144:147], v[32:35], v[112:127]
 v_add_f32 v228, v228, v226
 v_add_f32 v227, v216, v217
 v_cvt_pk_bf16_f32 v200, v216, v217
 v_exp_f32 v218, v98
 v_mfma_f32_32x32x16_bf16 v[128:143], a[144:147], v[64:67], v[128:143]
 ds_read_b128 a[208:211], v8 offset:12288
 v_exp_f32 v219, v99
 v_mfma_f32_32x32x16_bf16 v[112:127], a[148:151], v[36:39], v[112:127]
 v_add_f32 v227, v227, v218
 v_add_f32 v227, v227, v219
 v_cvt_pk_bf16_f32 v201, v218, v219
 v_exp_f32 v220, v100
 v_mfma_f32_32x32x16_bf16 v[128:143], a[148:151], v[68:71], v[128:143]
 ds_read_b128 a[212:215], v8 offset:13312
 buffer_load_dwordx4 v11, s[8:11], s40 offen offset:3072 sc1 lds
 v_exp_f32 v221, v101
 s_waitcnt lgkmcnt(6)
 v_mfma_f32_32x32x16_bf16 v[112:127], a[152:155], v[40:43], v[112:127]
 v_add_f32 v227, v227, v220
 v_add_f32 v227, v227, v221
 v_cvt_pk_bf16_f32 v202, v220, v221
 v_exp_f32 v222, v102
 v_mfma_f32_32x32x16_bf16 v[128:143], a[152:155], v[72:75], v[128:143]
 v_exp_f32 v223, v103
 v_mfma_f32_32x32x16_bf16 v[112:127], a[156:159], v[44:47], v[112:127]
 ds_read_b128 a[216:219], v8 offset:14336
 v_add_f32 v227, v227, v222
 v_add_f32 v227, v227, v223
 v_cvt_pk_bf16_f32 v203, v222, v223
 v_exp_f32 v216, v104
 v_mfma_f32_32x32x16_bf16 v[128:143], a[156:159], v[76:79], v[128:143]
 ds_read_b128 a[220:223], v8 offset:15360
 v_exp_f32 v217, v105
 s_waitcnt lgkmcnt(4)
 v_mfma_f32_32x32x16_bf16 a[0:15], a[192:195], v[192:195], a[0:15]
 v_add_f32 v227, v227, v216
 v_add_f32 v227, v227, v217
 v_cvt_pk_bf16_f32 v204, v216, v217
 v_exp_f32 v218, v106
 v_mfma_f32_32x32x16_bf16 a[16:31], a[196:199], v[192:195], a[16:31]
 v_exp_f32 v219, v107
 v_mfma_f32_32x32x16_bf16 a[32:47], a[200:203], v[192:195], a[32:47]
 v_add_f32 v227, v227, v218
 v_add_f32 v227, v227, v219
 v_cvt_pk_bf16_f32 v205, v218, v219
 v_exp_f32 v220, v108
 v_mfma_f32_32x32x16_bf16 a[48:63], a[204:207], v[192:195], a[48:63]
 v_exp_f32 v221, v109
 s_waitcnt lgkmcnt(0)
 v_mfma_f32_32x32x16_bf16 a[0:15], a[208:211], v[196:199], a[0:15]
 v_add_u32 v8, s42, v10
 v_add_f32 v227, v227, v220
 v_add_f32 v227, v227, v221
 v_cvt_pk_bf16_f32 v206, v220, v221
 v_exp_f32 v222, v110
 v_mfma_f32_32x32x16_bf16 a[16:31], a[212:215], v[196:199], a[16:31]
 v_exp_f32 v223, v111
 s_waitcnt lgkmcnt(0) vmcnt(15)
 s_barrier
 v_mfma_f32_32x32x16_bf16 a[32:47], a[216:219], v[196:199], a[32:47]
 ds_read_b128 a[128:131], v8 offset:0
 v_add_f32 v227, v227, v222
 v_add_f32 v227, v227, v223
 v_cmp_nge_f32 vcc, s39, v227
 v_exp_f32 v208, v112
 v_mfma_f32_32x32x16_bf16 a[48:63], a[220:223], v[196:199], a[48:63]
 ds_read_b128 a[132:135], v8 offset:16384
 ds_read_b128 a[136:139], v8 offset:1024
 v_cvt_pk_bf16_f32 v207, v222, v223
 s_cbranch_vccnz K2_rare17
K2_back17:
 v_exp_f32 v209, v113
 v_mfma_f32_32x32x16_bf16 a[64:79], a[192:195], v[200:203], a[64:79]
 ds_read_b128 a[140:143], v8 offset:17408
 s_add_u32 s42, s42, 0x8000
 s_and_b32 s42, s42, 0x1ffff
 v_add_f32 v229, v229, v227
 v_exp_f32 v210, v114
 v_mfma_f32_32x32x16_bf16 a[80:95], a[196:199], v[200:203], a[80:95]
 ds_read_b128 a[144:147], v8 offset:2048
 s_add_u32 m0, m0, 0x4000
 s_and_b32 m0, m0, 0x1ffff
 s_add_u32 s40, s40, 0x4000
 v_exp_f32 v211, v115
 v_mfma_f32_32x32x16_bf16 a[96:111], a[200:203], v[200:203], a[96:111]
 ds_read_b128 a[148:151], v8 offset:18432
 buffer_load_dwordx4 v11, s[8:11], s40 offen offset:0 sc1 lds
 s_add_u32 s44, s44, 1
 v_exp_f32 v212, v116
 v_mfma_f32_32x32x16_bf16 a[112:127], a[204:207], v[200:203], a[112:127]
 ds_read_b128 a[152:155], v8 offset:3072
 ds_read_b128 a[156:159], v8 offset:19456
 v_add_f32 v226, v208, v209
 v_cvt_pk_bf16_f32 v192, v208, v209
 v_exp_f32 v213, v117
 v_mfma_f32_32x32x16_bf16 a[64:79], a[208:211], v[204:207], a[64:79]
 ds_read_b128 a[160:163], v8 offset:4096
 v_add_f32 v226, v226, v210
 v_add_f32 v226, v226, v211
 v_cvt_pk_bf16_f32 v193, v210, v211
 v_exp_f32 v214, v118
 v_mfma_f32_32x32x16_bf16 a[80:95], a[212:215], v[204:207], a[80:95]
 ds_read_b128 a[164:167], v8 offset:20480
 buffer_load_dwordx4 v11, s[8:11], s40 offen offset:1024 sc1 lds
 v_add_f32 v226, v226, v212
 v_exp_f32 v215, v119
 v_mfma_f32_32x32x16_bf16 a[96:111], a[216:219], v[204:207], a[96:111]
 ds_read_b128 a[168:171], v8 offset:5120
 v_add_f32 v226, v226, v213
 v_cvt_pk_bf16_f32 v194, v212, v213
 v_add_f32 v226, v226, v214
 v_exp_f32 v208, v120
 v_mfma_f32_32x32x16_bf16 a[112:127], a[220:223], v[204:207], a[112:127]
 ds_read_b128 a[172:175], v8 offset:21504
 v_add_f32 v226, v226, v215
 v_cvt_pk_bf16_f32 v195, v214, v215
 v_exp_f32 v209, v121
 s_mul_i32 s71, s53, 98304
 s_add_u32 s71, s71, 0x3800000
 s_mul_i32 s72, s52, 3072
 s_add_u32 s72, s72, s71
 s_add_u32 s72, s72, 2048
 s_lshr_b32 s66, s52, 1
 s_mul_i32 s66, s66, 6144
 s_add_u32 s71, s71, s66
 s_and_b32 s66, s52, 1
 s_lshl_b32 s66, s66, 10
 s_add_u32 s71, s71, s66
 v_and_b32 v14, 7, v2
 v_mul_u32_u24 v14, 0x3000, v14
 v_add_u32 v14, v14, v10
 v_and_b32 v15, 15, v2
 v_lshlrev_b32 v15, 2, v15
 s_waitcnt vmcnt(6)
 v_cmp_ne_u32 vcc, s89, v13
 s_nop 0
 s_and_b64 vcc, vcc, s[30:31]
 s_cbranch_vccnz K2_spin
K2_spin_b:
 s_waitcnt lgkmcnt(8)
 v_mfma_f32_32x32x16_bf16 v[80:95], a[128:131], v[48:51], v[160:175]
 ds_read_b128 a[176:179], v8 offset:6144
 buffer_load_dwordx4 v[16:19], v10, s[20:23], s71 offen offset:0 sc1
 v_add_f32 v226, v226, v208
 v_exp_f32 v210, v122
 v_mfma_f32_32x32x16_bf16 v[96:111], a[132:135], v[48:51], v[176:191]
 ds_read_b128 a[180:183], v8 offset:22528
 buffer_load_dwordx4 v[20:23], v10, s[20:23], s71 offen offset:3072 sc1
 s_add_u32 s71, s71, 12288
 v_exp_f32 v211, v123
 v_mfma_f32_32x32x16_bf16 v[80:95], a[136:139], v[52:55], v[80:95]
 buffer_load_dwordx4 v[24:27], v10, s[20:23], s71 offen offset:0 sc1
 v_add_f32 v226, v226, v209
 v_cvt_pk_bf16_f32 v196, v208, v209
 v_exp_f32 v212, v124
 v_mfma_f32_32x32x16_bf16 v[96:111], a[140:143], v[52:55], v[96:111]
 buffer_load_dwordx4 v[28:31], v10, s[20:23], s71 offen offset:3072 sc1
 s_add_u32 s71, s71, 12288
 v_exp_f32 v213, v125
 s_waitcnt lgkmcnt(6)
 v_mfma_f32_32x32x16_bf16 v[80:95], a[144:147], v[56:59], v[80:95]
 ds_read_b128 a[184:187], v8 offset:7168
 ds_read_b128 a[188:191], v8 offset:23552
 buffer_load_dwordx4 v[32:35], v10, s[20:23], s71 offen offset:0 sc1
 v_exp_f32 v214, v126
 v_mfma_f32_32x32x16_bf16 v[96:111], a[148:151], v[56:59], v[96:111]
 buffer_load_dwordx4 v[36:39], v10, s[20:23], s71 offen offset:3072 sc1
 s_add_u32 s71, s71, 12288
 v_add_f32 v226, v226, v210
 v_exp_f32 v215, v127
 v_mfma_f32_32x32x16_bf16 v[80:95], a[152:155], v[60:63], v[80:95]
 v_add_f32 v226, v226, v211
 v_cvt_pk_bf16_f32 v197, v210, v211
 v_add_f32 v226, v226, v212
 v_add_f32 v226, v226, v213
 v_cvt_pk_bf16_f32 v198, v212, v213
 v_add_f32 v226, v226, v214
 v_add_f32 v226, v226, v215
 v_cmp_nge_f32 vcc, s39, v226
 v_exp_f32 v216, v128
 v_mfma_f32_32x32x16_bf16 v[96:111], a[156:159], v[60:63], v[96:111]
 ds_read_b128 a[192:195], v9 offset:8192
 v_cvt_pk_bf16_f32 v199, v214, v215
 s_cbranch_vccnz K2_rare19
K2_back19:
 v_exp_f32 v217, v129
 s_waitcnt lgkmcnt(5)
 v_mfma_f32_32x32x16_bf16 v[80:95], a[160:163], v[64:67], v[80:95]
 ds_read_b128 a[196:199], v9 offset:9216
 buffer_load_dwordx4 v[40:43], v10, s[20:23], s71 offen offset:0 sc1
 v_add_f32 v228, v228, v226
 v_exp_f32 v218, v130
 v_mfma_f32_32x32x16_bf16 v[96:111], a[164:167], v[64:67], v[96:111]
 ds_read_b128 a[200:203], v9 offset:10240
 buffer_load_dwordx4 v[44:47], v10, s[20:23], s71 offen offset:3072 sc1
 s_add_u32 s71, s71, 12288
 v_exp_f32 v219, v131
 v_mfma_f32_32x32x16_bf16 v[80:95], a[168:171], v[68:71], v[80:95]
 buffer_load_dwordx4 a[224:227], v10, s[20:23], s71 offen offset:0 sc1
 s_cmp_ge_i32 s44, s46
 s_cbranch_scc1 K2_prep18
K2_prep18_b:
 v_exp_f32 v220, v132
 v_mfma_f32_32x32x16_bf16 v[96:111], a[172:175], v[68:71], v[96:111]
 buffer_load_dwordx4 a[228:231], v10, s[20:23], s71 offen offset:3072 sc1
 s_add_u32 s71, s71, 12288
 v_exp_f32 v221, v133
 s_waitcnt lgkmcnt(3)
 v_mfma_f32_32x32x16_bf16 v[80:95], a[176:179], v[72:75], v[80:95]
 ds_read_b128 a[204:207], v9 offset:11264
 buffer_load_dwordx4 a[232:235], v10, s[20:23], s71 offen offset:0 sc1
 v_add_f32 v227, v216, v217
 v_cvt_pk_bf16_f32 v200, v216, v217
 v_exp_f32 v222, v134
 v_mfma_f32_32x32x16_bf16 v[96:111], a[180:183], v[72:75], v[96:111]
 ds_read_b128 a[208:211], v9 offset:12288
 buffer_load_dwordx4 a[236:239], v10, s[20:23], s71 offen offset:3072 sc1
 s_add_u32 s71, s71, 12288
 v_exp_f32 v223, v135
 v_mfma_f32_32x32x16_bf16 v[80:95], a[184:187], v[76:79], v[80:95]
 buffer_load_dwordx4 a[240:243], v10, s[20:23], s71 offen offset:0 sc1
 v_add_f32 v227, v227, v218
 v_add_f32 v227, v227, v219
 v_cvt_pk_bf16_f32 v201, v218, v219
 v_exp_f32 v216, v136
 v_mfma_f32_32x32x16_bf16 v[96:111], a[188:191], v[76:79], v[96:111]
 buffer_load_dwordx4 a[244:247], v10, s[20:23], s71 offen offset:3072 sc1
 s_add_u32 s71, s71, 12288
 v_exp_f32 v217, v137
 s_waitcnt lgkmcnt(1)
 v_mfma_f32_32x32x16_bf16 a[0:15], a[192:195], v[192:195], a[0:15]
 ds_read_b128 a[212:215], v9 offset:13312
 ds_read_b128 a[216:219], v9 offset:14336
 ds_read_b128 a[220:223], v9 offset:15360
 buffer_load_dwordx4 a[248:251], v10, s[20:23], s71 offen offset:0 sc1
 v_add_f32 v227, v227, v220
 v_add_f32 v227, v227, v221
 v_cvt_pk_bf16_f32 v202, v220, v221
 v_exp_f32 v218, v138
 v_mfma_f32_32x32x16_bf16 a[16:31], a[196:199], v[192:195], a[16:31]
 buffer_load_dwordx4 a[252:255], v10, s[20:23], s71 offen offset:3072 sc1
 s_add_u32 s71, s71, 12288
 v_add_f32 v227, v227, v222
 v_exp_f32 v219, v139
 v_mfma_f32_32x32x16_bf16 a[32:47], a[200:203], v[192:195], a[32:47]
 buffer_load_dwordx4 v[248:251], v14, s[20:23], s72 offen sc1
 v_add_f32 v227, v227, v223
 v_cvt_pk_bf16_f32 v203, v222, v223
 v_exp_f32 v220, v140
 v_mfma_f32_32x32x16_bf16 a[48:63], a[204:207], v[192:195], a[48:63]
 buffer_load_dword v252, v15, s[20:23], s64 offen offset:0 sc1
 v_add_f32 v227, v227, v216
 v_exp_f32 v221, v141
 s_waitcnt lgkmcnt(0)
 v_mfma_f32_32x32x16_bf16 a[0:15], a[208:211], v[196:199], a[0:15]
 buffer_load_dword v253, v15, s[20:23], s64 offen offset:64 sc1
 v_add_f32 v227, v227, v217
 v_cvt_pk_bf16_f32 v204, v216, v217
 v_exp_f32 v222, v142
 v_mfma_f32_32x32x16_bf16 a[16:31], a[212:215], v[196:199], a[16:31]
 v_add_u32 v9, s42, v10
 buffer_load_dwordx4 v11, s[8:11], s40 offen offset:2048 sc1 lds
 buffer_load_dwordx4 v11, s[8:11], s40 offen offset:3072 sc1 lds
 buffer_load_dword v254, v15, s[20:23], s65 offen offset:0 sc1
 buffer_load_dword v255, v15, s[20:23], s65 offen offset:64 sc1
 v_exp_f32 v223, v143
 s_waitcnt lgkmcnt(0) vmcnt(27)
 s_barrier
 v_mfma_f32_32x32x16_bf16 a[32:47], a[216:219], v[196:199], a[32:47]
 v_add_f32 v227, v227, v218
 v_add_f32 v227, v227, v219
 v_cvt_pk_bf16_f32 v205, v218, v219
 v_add_f32 v227, v227, v220
 v_add_f32 v227, v227, v221
 v_cvt_pk_bf16_f32 v206, v220, v221
 v_add_f32 v227, v227, v222
 v_add_f32 v227, v227, v223
 v_cmp_nge_f32 vcc, s39, v227
 v_exp_f32 v208, v80
 v_mfma_f32_32x32x16_bf16 a[48:63], a[220:223], v[196:199], a[48:63]
 ds_read_b128 a[128:131], v9 offset:0
 ds_read_b128 a[132:135], v9 offset:16384
 v_cvt_pk_bf16_f32 v207, v222, v223
 s_cbranch_vccnz K2_rare20
K2_back20:
 v_exp_f32 v209, v81
 v_mfma_f32_32x32x16_bf16 a[64:79], a[192:195], v[200:203], a[64:79]
 ds_read_b128 a[136:139], v9 offset:1024
 ds_read_b128 a[140:143], v9 offset:17408
 s_add_u32 s42, s42, 0x8000
 v_add_f32 v229, v229, v227
 v_exp_f32 v210, v82
 v_mfma_f32_32x32x16_bf16 a[80:95], a[196:199], v[200:203], a[80:95]
 ds_read_b128 a[144:147], v9 offset:2048
 s_and_b32 s42, s42, 0x1ffff
 s_add_u32 m0, m0, 0x4000
 s_and_b32 m0, m0, 0x1ffff
 v_exp_f32 v211, v83
 v_mfma_f32_32x32x16_bf16 a[96:111], a[200:203], v[200:203], a[96:111]
 ds_read_b128 a[148:151], v9 offset:18432
 s_add_u32 s40, s40, 0x4000
 buffer_load_dwordx4 v11, s[8:11], s40 offen offset:0 sc1 lds
 v_exp_f32 v212, v84
 v_mfma_f32_32x32x16_bf16 a[112:127], a[204:207], v[200:203], a[112:127]
 ds_read_b128 a[152:155], v9 offset:3072
 ds_read_b128 a[156:159], v9 offset:19456
 s_add_u32 s44, s44, 1
 v_add_f32 v226, v208, v209
 v_exp_f32 v213, v85
 v_mfma_f32_32x32x16_bf16 a[64:79], a[208:211], v[204:207], a[64:79]
 ds_read_b128 a[160:163], v9 offset:4096
 v_cvt_pk_bf16_f32 v192, v208, v209
 v_add_f32 v226, v226, v210
 v_add_f32 v226, v226, v211
 v_exp_f32 v214, v86
 v_mfma_f32_32x32x16_bf16 a[80:95], a[212:215], v[204:207], a[80:95]
 ds_read_b128 a[164:167], v9 offset:20480
 buffer_load_dwordx4 v11, s[8:11], s40 offen offset:1024 sc1 lds
 v_cvt_pk_bf16_f32 v193, v210, v211
 v_exp_f32 v215, v87
 v_mfma_f32_32x32x16_bf16 a[96:111], a[216:219], v[204:207], a[96:111]
 ds_read_b128 a[168:171], v9 offset:5120
 v_add_f32 v226, v226, v212
 v_add_f32 v226, v226, v213
 v_cvt_pk_bf16_f32 v194, v212, v213
 v_exp_f32 v208, v88
 v_mfma_f32_32x32x16_bf16 a[112:127], a[220:223], v[204:207], a[112:127]
 ds_read_b128 a[172:175], v9 offset:21504
 v_add_f32 v226, v226, v214
 v_add_f32 v226, v226, v215
 v_cvt_pk_bf16_f32 v195, v214, v215
 v_exp_f32 v209, v89
 v_mov_b32 v232, v228
 s_nop 1
 v_permlane32_swap_b32 v228, v232
 v_add_f32 v232, v232, v228
 v_rcp_f32 v232, v232
 s_nop 0
 v_mul_f32 v232, v232, v224
 v_mov_b32 v233, v232
 v_accvgpr_read_b32 v240, a0
 v_accvgpr_read_b32 v241, a1
 v_accvgpr_read_b32 v242, a2
 v_accvgpr_read_b32 v243, a3
 v_accvgpr_read_b32 v244, a4
 v_accvgpr_read_b32 v245, a5
 v_accvgpr_read_b32 v246, a6
 v_accvgpr_read_b32 v247, a7
 v_pk_mul_f32 v[240:241], v[240:241], v[232:233]
 v_pk_mul_f32 v[242:243], v[242:243], v[232:233]
 v_pk_mul_f32 v[244:245], v[244:245], v[232:233]
 v_pk_mul_f32 v[246:247], v[246:247], v[232:233]
 v_cvt_pk_bf16_f32 v240, v240, v241
 v_cvt_pk_bf16_f32 v241, v242, v243
 v_cvt_pk_bf16_f32 v242, v244, v245
 v_cvt_pk_bf16_f32 v243, v246, v247
 buffer_store_dwordx4 v[240:243], v12, s[20:23], s69 offen offset:0 sc1
 v_accvgpr_read_b32 v216, a8
 v_accvgpr_read_b32 v217, a9
 v_accvgpr_read_b32 v218, a10
 v_accvgpr_read_b32 v219, a11
 v_accvgpr_read_b32 v220, a12
 v_accvgpr_read_b32 v221, a13
 v_accvgpr_read_b32 v222, a14
 v_accvgpr_read_b32 v223, a15
 v_pk_mul_f32 v[216:217], v[216:217], v[232:233]
 v_pk_mul_f32 v[218:219], v[218:219], v[232:233]
 v_pk_mul_f32 v[220:221], v[220:221], v[232:233]
 v_pk_mul_f32 v[222:223], v[222:223], v[232:233]
 v_cvt_pk_bf16_f32 v216, v216, v217
 v_cvt_pk_bf16_f32 v217, v218, v219
 v_cvt_pk_bf16_f32 v218, v220, v221
 v_cvt_pk_bf16_f32 v219, v222, v223
 buffer_store_dwordx4 v[216:219], v12, s[20:23], s69 offen offset:512 sc1
 s_add_u32 s69, s69, 8192
 v_accvgpr_read_b32 v200, a16
 v_accvgpr_read_b32 v201, a17
 v_accvgpr_read_b32 v202, a18
 v_accvgpr_read_b32 v203, a19
 v_accvgpr_read_b32 v204, a20
 v_accvgpr_read_b32 v205, a21
 v_accvgpr_read_b32 v206, a22
 v_accvgpr_read_b32 v207, a23
 v_pk_mul_f32 v[200:201], v[200:201], v[232:233]
 v_pk_mul_f32 v[202:203], v[202:203], v[232:233]
 v_pk_mul_f32 v[204:205], v[204:205], v[232:233]
 v_pk_mul_f32 v[206:207], v[206:207], v[232:233]
 v_cvt_pk_bf16_f32 v200, v200, v201
 v_cvt_pk_bf16_f32 v201, v202, v203
 v_cvt_pk_bf16_f32 v202, v204, v205
 v_cvt_pk_bf16_f32 v203, v206, v207
 buffer_store_dwordx4 v[200:203], v12, s[20:23], s69 offen offset:0 sc1
 v_accvgpr_read_b32 v240, a24
 v_accvgpr_read_b32 v241, a25
 v_accvgpr_read_b32 v242, a26
 v_accvgpr_read_b32 v243, a27
 v_accvgpr_read_b32 v244, a28
 v_accvgpr_read_b32 v245, a29
 v_accvgpr_read_b32 v246, a30
 v_accvgpr_read_b32 v247, a31
 v_pk_mul_f32 v[240:241], v[240:241], v[232:233]
 v_pk_mul_f32 v[242:243], v[242:243], v[232:233]
 v_pk_mul_f32 v[244:245], v[244:245], v[232:233]
 v_pk_mul_f32 v[246:247], v[246:247], v[232:233]
 v_cvt_pk_bf16_f32 v240, v240, v241
 v_cvt_pk_bf16_f32 v241, v242, v243
 v_cvt_pk_bf16_f32 v242, v244, v245
 v_cvt_pk_bf16_f32 v243, v246, v247
 buffer_store_dwordx4 v[240:243], v12, s[20:23], s69 offen offset:512 sc1
 s_add_u32 s69, s69, 8192
 v_accvgpr_read_b32 v216, a32
 v_accvgpr_read_b32 v217, a33
 v_accvgpr_read_b32 v218, a34
 v_accvgpr_read_b32 v219, a35
 v_accvgpr_read_b32 v220, a36
 v_accvgpr_read_b32 v221, a37
 v_accvgpr_read_b32 v222, a38
 v_accvgpr_read_b32 v223, a39
 v_pk_mul_f32 v[216:217], v[216:217], v[232:233]
 v_pk_mul_f32 v[218:219], v[218:219], v[232:233]
 v_pk_mul_f32 v[220:221], v[220:221], v[232:233]
 v_pk_mul_f32 v[222:223], v[222:223], v[232:233]
 v_cvt_pk_bf16_f32 v216, v216, v217
 v_cvt_pk_bf16_f32 v217, v218, v219
 v_cvt_pk_bf16_f32 v218, v220, v221
 v_cvt_pk_bf16_f32 v219, v222, v223
 buffer_store_dwordx4 v[216:219], v12, s[20:23], s69 offen offset:0 sc1
 v_accvgpr_read_b32 v200, a40
 v_accvgpr_read_b32 v201, a41
 v_accvgpr_read_b32 v202, a42
 v_accvgpr_read_b32 v203, a43
 v_accvgpr_read_b32 v204, a44
 v_accvgpr_read_b32 v205, a45
 v_accvgpr_read_b32 v206, a46
 v_accvgpr_read_b32 v207, a47
 v_pk_mul_f32 v[200:201], v[200:201], v[232:233]
 v_pk_mul_f32 v[202:203], v[202:203], v[232:233]
 v_pk_mul_f32 v[204:205], v[204:205], v[232:233]
 v_pk_mul_f32 v[206:207], v[206:207], v[232:233]
 v_cvt_pk_bf16_f32 v200, v200, v201
 v_cvt_pk_bf16_f32 v201, v202, v203
 v_cvt_pk_bf16_f32 v202, v204, v205
 v_cvt_pk_bf16_f32 v203, v206, v207
 buffer_store_dwordx4 v[200:203], v12, s[20:23], s69 offen offset:512 sc1
 s_add_u32 s69, s69, 8192
 v_accvgpr_read_b32 v240, a48
 v_accvgpr_read_b32 v241, a49
 v_accvgpr_read_b32 v242, a50
 v_accvgpr_read_b32 v243, a51
 v_accvgpr_read_b32 v244, a52
 v_accvgpr_read_b32 v245, a53
 v_accvgpr_read_b32 v246, a54
 v_accvgpr_read_b32 v247, a55
 v_pk_mul_f32 v[240:241], v[240:241], v[232:233]
 v_pk_mul_f32 v[242:243], v[242:243], v[232:233]
 v_pk_mul_f32 v[244:245], v[244:245], v[232:233]
 v_pk_mul_f32 v[246:247], v[246:247], v[232:233]
 v_cvt_pk_bf16_f32 v240, v240, v241
 v_cvt_pk_bf16_f32 v241, v242, v243
 v_cvt_pk_bf16_f32 v242, v244, v245
 v_cvt_pk_bf16_f32 v243, v246, v247
 buffer_store_dwordx4 v[240:243], v12, s[20:23], s69 offen offset:0 sc1
 v_accvgpr_read_b32 v216, a56
 v_accvgpr_read_b32 v217, a57
 v_accvgpr_read_b32 v218, a58
 v_accvgpr_read_b32 v219, a59
 v_accvgpr_read_b32 v220, a60
 v_accvgpr_read_b32 v221, a61
 v_accvgpr_read_b32 v222, a62
 v_accvgpr_read_b32 v223, a63
 v_pk_mul_f32 v[216:217], v[216:217], v[232:233]
 v_pk_mul_f32 v[218:219], v[218:219], v[232:233]
 v_pk_mul_f32 v[220:221], v[220:221], v[232:233]
 v_pk_mul_f32 v[222:223], v[222:223], v[232:233]
 v_cvt_pk_bf16_f32 v216, v216, v217
 v_cvt_pk_bf16_f32 v217, v218, v219
 v_cvt_pk_bf16_f32 v218, v220, v221
 v_cvt_pk_bf16_f32 v219, v222, v223
 buffer_store_dwordx4 v[216:219], v12, s[20:23], s69 offen offset:512 sc1
 s_cmp_eq_u32 s54, 7
 s_cbranch_scc1 K2_nolin
 s_lshl_b32 s66, s52, 13
 s_add_u32 s66, s66, 0x20000
 v_add_u32 v13, s66, v10
 v_lshrrev_b32 v14, 1, v10
 v_add_u32 v15, s66, v14
 v_add_u32 v14, 0x20000, v14
 v_add_u32 v5, 0x20000, v10
 ds_read_b128 a[0:3], v13 offset:0
 ds_read_b128 a[4:7], v13 offset:1024
 ds_read_b128 a[8:11], v13 offset:2048
 ds_read_b128 a[12:15], v13 offset:3072
 ds_read_b128 a[16:19], v13 offset:4096
 ds_read_b128 a[20:23], v13 offset:5120
 ds_read_b128 a[24:27], v13 offset:6144
 ds_read_b128 a[28:31], v13 offset:7168
 s_waitcnt vmcnt(10)
 v_pk_add_f32 v[16:17], v[16:17], v[24:25]
 v_pk_add_f32 v[18:19], v[18:19], v[26:27]
 v_pk_add_f32 v[20:21], v[20:21], v[28:29]
 v_pk_add_f32 v[22:23], v[22:23], v[30:31]
 v_add_f32_dpp v248, v248, v248 row_ror:1 row_mask:0xf bank_mask:0xf
 v_add_f32_dpp v249, v249, v249 row_ror:1 row_mask:0xf bank_mask:0xf
 v_add_f32_dpp v250, v250, v250 row_ror:1 row_mask:0xf bank_mask:0xf
 v_add_f32_dpp v251, v251, v251 row_ror:1 row_mask:0xf bank_mask:0xf
 v_pk_add_f32 v[16:17], v[16:17], v[32:33]
 v_pk_add_f32 v[18:19], v[18:19], v[34:35]
 v_pk_add_f32 v[20:21], v[20:21], v[36:37]
 v_pk_add_f32 v[22:23], v[22:23], v[38:39]
 v_add_f32_dpp v248, v248, v248 row_ror:2 row_mask:0xf bank_mask:0xf
 v_add_f32_dpp v249, v249, v249 row_ror:2 row_mask:0xf bank_mask:0xf
 v_add_f32_dpp v250, v250, v250 row_ror:2 row_mask:0xf bank_mask:0xf
 v_add_f32_dpp v251, v251, v251 row_ror:2 row_mask:0xf bank_mask:0xf
 v_pk_add_f32 v[16:17], v[16:17], v[40:41]
 v_pk_add_f32 v[18:19], v[18:19], v[42:43]
 v_pk_add_f32 v[20:21], v[20:21], v[44:45]
 v_pk_add_f32 v[22:23], v[22:23], v[46:47]
 v_add_f32_dpp v248, v248, v248 row_ror:4 row_mask:0xf bank_mask:0xf
 v_add_f32_dpp v249, v249, v249 row_ror:4 row_mask:0xf bank_mask:0xf
 v_add_f32_dpp v250, v250, v250 row_ror:4 row_mask:0xf bank_mask:0xf
 v_add_f32_dpp v251, v251, v251 row_ror:4 row_mask:0xf bank_mask:0xf
 v_accvgpr_read_b32 v240, a224
 v_accvgpr_read_b32 v241, a225
 v_accvgpr_read_b32 v242, a226
 v_accvgpr_read_b32 v243, a227
 v_accvgpr_read_b32 v244, a228
 v_accvgpr_read_b32 v245, a229
 v_accvgpr_read_b32 v246, a230
 v_accvgpr_read_b32 v247, a231
 v_pk_add_f32 v[16:17], v[16:17], v[240:241]
 v_pk_add_f32 v[18:19], v[18:19], v[242:243]
 v_pk_add_f32 v[20:21], v[20:21], v[244:245]
 v_pk_add_f32 v[22:23], v[22:23], v[246:247]
 v_accvgpr_read_b32 v240, a232
 v_accvgpr_read_b32 v241, a233
 v_accvgpr_read_b32 v242, a234
 v_accvgpr_read_b32 v243, a235
 v_accvgpr_read_b32 v244, a236
 v_accvgpr_read_b32 v245, a237
 v_accvgpr_read_b32 v246, a238
 v_accvgpr_read_b32 v247, a239
 v_pk_add_f32 v[16:17], v[16:17], v[240:241]
 v_pk_add_f32 v[18:19], v[18:19], v[242:243]
 v_pk_add_f32 v[20:21], v[20:21], v[244:245]
 v_pk_add_f32 v[22:23], v[22:23], v[246:247]
 v_accvgpr_read_b32 v240, a240
 v_accvgpr_read_b32 v241, a241
 v_accvgpr_read_b32 v242, a242
 v_accvgpr_read_b32 v243, a243
 v_accvgpr_read_b32 v244, a244
 v_accvgpr_read_b32 v245, a245
 v_accvgpr_read_b32 v246, a246
 v_accvgpr_read_b32 v247, a247
 v_pk_add_f32 v[16:17], v[16:17], v[240:241]
 v_pk_add_f32 v[18:19], v[18:19], v[242:243]
 v_pk_add_f32 v[20:21], v[20:21], v[244:245]
 v_pk_add_f32 v[22:23], v[22:23], v[246:247]
 v_accvgpr_read_b32 v240, a248
 v_accvgpr_read_b32 v241, a249
 v_accvgpr_read_b32 v242, a250
 v_accvgpr_read_b32 v243, a251
 v_accvgpr_read_b32 v244, a252
 v_accvgpr_read_b32 v245, a253
 v_accvgpr_read_b32 v246, a254
 v_accvgpr_read_b32 v247, a255
 v_pk_add_f32 v[16:17], v[16:17], v[240:241]
 v_pk_add_f32 v[18:19], v[18:19], v[242:243]
 v_pk_add_f32 v[20:21], v[20:21], v[244:245]
 v_pk_add_f32 v[22:23], v[22:23], v[246:247]
 v_cvt_pk_bf16_f32 v16, v16, v17
 v_cvt_pk_bf16_f32 v17, v18, v19
 v_cvt_pk_bf16_f32 v18, v20, v21
 v_cvt_pk_bf16_f32 v19, v22, v23
 v_cvt_pk_bf16_f32 v248, v248, v249
 v_cvt_pk_bf16_f32 v249, v250, v251
 s_waitcnt lgkmcnt(0)
 ds_write_b128 v13, v[16:19]
 ds_write_b64 v15, v[248:249] offset:1024
 s_lshl_b32 s72, s53, 13
 s_lshl_b32 s73, s52, 11
 s_add_u32 s72, s72, s73
 s_add_u32 s72, s72, 0x4000000
 s_add_u32 s73, s72, s77
 s_add_u32 s74, s72, s78
 s_waitcnt lgkmcnt(0)
 s_barrier
 ds_read_b64 a[48:49], v14 offset:1024
 ds_read_b64 a[50:51], v14 offset:9216
 ds_read_b64 a[52:53], v14 offset:17408
 ds_read_b64 a[54:55], v14 offset:25600
 ds_read_b128 a[32:35], v5 offset:0
 ds_read_b128 a[36:39], v5 offset:16384
 ds_read_b128 a[40:43], v5 offset:8192
 ds_read_b128 a[44:47], v5 offset:24576
 s_waitcnt lgkmcnt(0)
 v_mfma_f32_16x16x32_bf16 v[232:235], a[48:51], a[0:3], 0
 v_mfma_f32_16x16x32_bf16 v[232:235], a[52:55], a[4:7], v[232:235]
 v_mfma_f32_16x16x32_bf16 v[236:239], a[48:51], a[8:11], 0
 v_mfma_f32_16x16x32_bf16 v[236:239], a[52:55], a[12:15], v[236:239]
 v_mfma_f32_16x16x32_bf16 v[240:243], a[48:51], a[16:19], 0
 v_mfma_f32_16x16x32_bf16 v[240:243], a[52:55], a[20:23], v[240:243]
 v_mfma_f32_16x16x32_bf16 v[244:247], a[48:51], a[24:27], 0
 v_mfma_f32_16x16x32_bf16 v[244:247], a[52:55], a[28:31], v[244:247]
 v_mfma_f32_16x16x32_bf16 v[16:19], a[32:35], a[0:3], 0
 v_mfma_f32_16x16x32_bf16 v[16:19], a[36:39], a[4:7], v[16:19]
 v_mfma_f32_16x16x32_bf16 v[24:27], a[32:35], a[8:11], 0
 v_mfma_f32_16x16x32_bf16 v[24:27], a[36:39], a[12:15], v[24:27]
 v_mfma_f32_16x16x32_bf16 v[32:35], a[32:35], a[16:19], 0
 v_mfma_f32_16x16x32_bf16 v[32:35], a[36:39], a[20:23], v[32:35]
 v_mfma_f32_16x16x32_bf16 v[40:43], a[32:35], a[24:27], 0
 v_mfma_f32_16x16x32_bf16 v[40:43], a[36:39], a[28:31], v[40:43]
 v_mfma_f32_16x16x32_bf16 v[20:23], a[40:43], a[0:3], 0
 v_mfma_f32_16x16x32_bf16 v[20:23], a[44:47], a[4:7], v[20:23]
 v_mfma_f32_16x16x32_bf16 v[28:31], a[40:43], a[8:11], 0
 v_mfma_f32_16x16x32_bf16 v[28:31], a[44:47], a[12:15], v[28:31]
 v_mfma_f32_16x16x32_bf16 v[36:39], a[40:43], a[16:19], 0
 v_mfma_f32_16x16x32_bf16 v[36:39], a[44:47], a[20:23], v[36:39]
 v_mfma_f32_16x16x32_bf16 v[44:47], a[40:43], a[24:27], 0
 v_mfma_f32_16x16x32_bf16 v[44:47], a[44:47], a[28:31], v[44:47]
 v_add_f32 v232, 0x358637bd, v232
 v_rcp_f32 v232, v232
 s_nop 0
 v_mul_f32 v232, v232, v252
 v_mov_b32 v233, v232
 v_add_f32 v236, 0x358637bd, v236
 v_rcp_f32 v236, v236
 s_nop 0
 v_mul_f32 v236, v236, v253
 v_mov_b32 v237, v236
 v_add_f32 v240, 0x358637bd, v240
 v_rcp_f32 v240, v240
 s_nop 0
 v_mul_f32 v240, v240, v254
 v_mov_b32 v241, v240
 v_add_f32 v244, 0x358637bd, v244
 v_rcp_f32 v244, v244
 s_nop 0
 v_mul_f32 v244, v244, v255
 v_mov_b32 v245, v244
 v_pk_mul_f32 v[16:17], v[16:17], v[232:233]
 v_pk_mul_f32 v[18:19], v[18:19], v[232:233]
 v_pk_mul_f32 v[20:21], v[20:21], v[232:233]
 v_pk_mul_f32 v[22:23], v[22:23], v[232:233]
 v_cvt_pk_bf16_f32 v16, v16, v17
 v_cvt_pk_bf16_f32 v17, v18, v19
 v_cvt_pk_bf16_f32 v18, v20, v21
 v_cvt_pk_bf16_f32 v19, v22, v23
 buffer_store_dwordx4 v[16:19], v10, s[20:23], s73 offen offset:0 sc1
 v_pk_mul_f32 v[24:25], v[24:25], v[236:237]
 v_pk_mul_f32 v[26:27], v[26:27], v[236:237]
 v_pk_mul_f32 v[28:29], v[28:29], v[236:237]
 v_pk_mul_f32 v[30:31], v[30:31], v[236:237]
 v_cvt_pk_bf16_f32 v24, v24, v25
 v_cvt_pk_bf16_f32 v25, v26, v27
 v_cvt_pk_bf16_f32 v26, v28, v29
 v_cvt_pk_bf16_f32 v27, v30, v31
 buffer_store_dwordx4 v[24:27], v10, s[20:23], s73 offen offset:1024 sc1
 v_pk_mul_f32 v[32:33], v[32:33], v[240:241]
 v_pk_mul_f32 v[34:35], v[34:35], v[240:241]
 v_pk_mul_f32 v[36:37], v[36:37], v[240:241]
 v_pk_mul_f32 v[38:39], v[38:39], v[240:241]
 v_cvt_pk_bf16_f32 v32, v32, v33
 v_cvt_pk_bf16_f32 v33, v34, v35
 v_cvt_pk_bf16_f32 v34, v36, v37
 v_cvt_pk_bf16_f32 v35, v38, v39
 buffer_store_dwordx4 v[32:35], v10, s[20:23], s74 offen offset:0 sc1
 v_pk_mul_f32 v[40:41], v[40:41], v[244:245]
 v_pk_mul_f32 v[42:43], v[42:43], v[244:245]
 v_pk_mul_f32 v[44:45], v[44:45], v[244:245]
 v_pk_mul_f32 v[46:47], v[46:47], v[244:245]
 v_cvt_pk_bf16_f32 v40, v40, v41
 v_cvt_pk_bf16_f32 v41, v42, v43
 v_cvt_pk_bf16_f32 v42, v44, v45
 v_cvt_pk_bf16_f32 v43, v46, v47
 buffer_store_dwordx4 v[40:43], v10, s[20:23], s74 offen offset:1024 sc1
K2_nolin_b:
 s_lshl_b32 s47, s54, 1
 s_sub_u32 s47, 14, s47
 s_cmp_eq_u32 s47, 0
 s_cbranch_scc1 K2_tail
K2_loopS:
 s_waitcnt lgkmcnt(8)
 v_mfma_f32_32x32x16_bf16 v[112:127], a[128:131], v[48:51], v[160:175]
 ds_read_b128 a[176:179], v9 offset:6144
 ds_read_b128 a[180:183], v9 offset:22528
 v_add_f32 v226, v226, v208
 v_add_f32 v226, v226, v209
 v_exp_f32 v210, v90
 v_mfma_f32_32x32x16_bf16 v[128:143], a[132:135], v[48:51], v[176:191]
 ds_read_b128 a[184:187], v9 offset:7168
 v_cvt_pk_bf16_f32 v196, v208, v209
 v_exp_f32 v211, v91
 v_mfma_f32_32x32x16_bf16 v[112:127], a[136:139], v[52:55], v[112:127]
 ds_read_b128 a[188:191], v9 offset:23552
 buffer_load_dwordx4 v11, s[8:11], s40 offen offset:2048 sc1 lds
 v_add_f32 v226, v226, v210
 v_exp_f32 v212, v92
 v_mfma_f32_32x32x16_bf16 v[128:143], a[140:143], v[52:55], v[128:143]
 ds_read_b128 a[192:195], v8 offset:8192
 v_add_f32 v226, v226, v211
 v_cvt_pk_bf16_f32 v197, v210, v211
 v_exp_f32 v213, v93
 s_waitcnt lgkmcnt(9)
 v_mfma_f32_32x32x16_bf16 v[112:127], a[144:147], v[56:59], v[112:127]
 ds_read_b128 a[196:199], v8 offset:9216
 s_cmp_ge_i32 s44, s46
 s_cbranch_scc1 K2_prep21
K2_prep21_b:
 v_add_f32 v226, v226, v212
 v_exp_f32 v214, v94
 v_mfma_f32_32x32x16_bf16 v[128:143], a[148:151], v[56:59], v[128:143]
 ds_read_b128 a[200:203], v8 offset:10240
 buffer_load_dwordx4 v11, s[8:11], s40 offen offset:3072 sc1 lds
 v_add_f32 v226, v226, v213
 v_exp_f32 v215, v95
 v_mfma_f32_32x32x16_bf16 v[112:127], a[152:155], v[60:63], v[112:127]
 v_cvt_pk_bf16_f32 v198, v212, v213
 v_add_f32 v226, v226, v214
 v_add_f32 v226, v226, v215
 v_cmp_nge_f32 vcc, s39, v226
 v_exp_f32 v216, v96
 v_mfma_f32_32x32x16_bf16 v[128:143], a[156:159], v[60:63], v[128:143]
 ds_read_b128 a[204:207], v8 offset:11264
 v_cvt_pk_bf16_f32 v199, v214, v215
 s_cbranch_vccnz K2_rare22
K2_back22:
 v_exp_f32 v217, v97
 s_waitcnt lgkmcnt(8)
 v_mfma_f32_32x32x16_bf16 v[112:127], a[160:163], v[64:67], v[112:127]
 ds_read_b128 a[208:211], v8 offset:12288
 ds_read_b128 a[212:215], v8 offset:13312
 s_add_u32 m0, m0, 0x4000
 s_and_b32 m0, m0, 0x1ffff
 v_exp_f32 v218, v98
 v_mfma_f32_32x32x16_bf16 v[128:143], a[164:167], v[64:67], v[128:143]
 ds_read_b128 a[216:219], v8 offset:14336
 s_add_u32 s40, s40, 0x4000
 buffer_load_dwordx4 v11, s[8:11], s40 offen offset:0 sc1 lds
 v_exp_f32 v219, v99
 v_mfma_f32_32x32x16_bf16 v[112:127], a[168:171], v[68:71], v[112:127]
 ds_read_b128 a[220:223], v8 offset:15360
 v_add_f32 v229, v229, v226
 v_add_f32 v227, v216, v217
 v_cvt_pk_bf16_f32 v200, v216, v217
 v_exp_f32 v220, v100
 v_mfma_f32_32x32x16_bf16 v[128:143], a[172:175], v[68:71], v[128:143]
 ds_read_b128 a[224:227], v8 offset:24576
 buffer_load_dwordx4 v11, s[8:11], s40 offen offset:1024 sc1 lds
 v_exp_f32 v221, v101
 s_waitcnt lgkmcnt(9)
 v_mfma_f32_32x32x16_bf16 v[112:127], a[176:179], v[72:75], v[112:127]
 ds_read_b128 a[228:231], v8 offset:25600
 v_add_f32 v227, v227, v218
 v_add_f32 v227, v227, v219
 v_cvt_pk_bf16_f32 v201, v218, v219
 v_exp_f32 v222, v102
 v_mfma_f32_32x32x16_bf16 v[128:143], a[180:183], v[72:75], v[128:143]
 ds_read_b128 a[232:235], v8 offset:26624
 v_add_f32 v227, v227, v220
 v_add_f32 v227, v227, v221
 v_cvt_pk_bf16_f32 v202, v220, v221
 v_exp_f32 v223, v103
 v_mfma_f32_32x32x16_bf16 v[112:127], a[184:187], v[76:79], v[112:127]
 ds_read_b128 a[236:239], v8 offset:27648
 buffer_load_dwordx4 v11, s[8:11], s40 offen offset:2048 sc1 lds
 v_add_f32 v227, v227, v222
 v_exp_f32 v216, v104
 v_mfma_f32_32x32x16_bf16 v[128:143], a[188:191], v[76:79], v[128:143]
 ds_read_b128 a[240:243], v8 offset:28672
 v_add_f32 v227, v227, v223
 v_cvt_pk_bf16_f32 v203, v222, v223
 v_exp_f32 v217, v105
 s_waitcnt lgkmcnt(9)
 v_mfma_f32_32x32x16_bf16 a[64:79], a[192:195], v[192:195], a[64:79]
 ds_read_b128 a[244:247], v8 offset:29696
 v_add_f32 v227, v227, v216
 v_add_f32 v227, v227, v217
 v_cvt_pk_bf16_f32 v204, v216, v217
 v_exp_f32 v218, v106
 v_mfma_f32_32x32x16_bf16 a[80:95], a[196:199], v[192:195], a[80:95]
 ds_read_b128 a[248:251], v8 offset:30720
 buffer_load_dwordx4 v11, s[8:11], s40 offen offset:3072 sc1 lds
 v_exp_f32 v219, v107
 v_mfma_f32_32x32x16_bf16 a[96:111], a[200:203], v[192:195], a[96:111]
 ds_read_b128 a[252:255], v8 offset:31744
 v_add_f32 v227, v227, v218
 v_add_f32 v227, v227, v219
 v_cvt_pk_bf16_f32 v205, v218, v219
 v_exp_f32 v220, v108
 v_mfma_f32_32x32x16_bf16 a[112:127], a[204:207], v[192:195], a[112:127]
 v_exp_f32 v221, v109
 s_waitcnt lgkmcnt(8)
 v_mfma_f32_32x32x16_bf16 a[64:79], a[208:211], v[196:199], a[64:79]
 v_add_u32 v8, s42, v10
 v_add_f32 v227, v227, v220
 v_add_f32 v227, v227, v221
 v_cvt_pk_bf16_f32 v206, v220, v221
 v_exp_f32 v222, v110
 v_mfma_f32_32x32x16_bf16 a[80:95], a[212:215], v[196:199], a[80:95]
 v_exp_f32 v223, v111
 s_waitcnt lgkmcnt(0) vmcnt(8)
 s_barrier
 v_mfma_f32_32x32x16_bf16 a[96:111], a[216:219], v[196:199], a[96:111]
 ds_read_b128 a[128:131], v8 offset:0
 v_add_f32 v227, v227, v222
 v_add_f32 v227, v227, v223
 v_cmp_nge_f32 vcc, s39, v227
 v_exp_f32 v208, v112
 v_mfma_f32_32x32x16_bf16 a[112:127], a[220:223], v[196:199], a[112:127]
 ds_read_b128 a[132:135], v8 offset:16384
 ds_read_b128 a[136:139], v8 offset:1024
 v_cvt_pk_bf16_f32 v207, v222, v223
 s_cbranch_vccnz K2_rare23
K2_back23:
 v_exp_f32 v209, v113
 v_mfma_f32_32x32x16_bf16 a[64:79], a[224:227], v[200:203], a[64:79]
 ds_read_b128 a[140:143], v8 offset:17408
 s_add_u32 s42, s42, 0x8000
 s_and_b32 s42, s42, 0x1ffff
 v_add_f32 v229, v229, v227
 v_exp_f32 v210, v114
 v_mfma_f32_32x32x16_bf16 a[80:95], a[228:231], v[200:203], a[80:95]
 ds_read_b128 a[144:147], v8 offset:2048
 s_add_u32 m0, m0, 0x4000
 s_and_b32 m0, m0, 0x1ffff
 s_add_u32 s40, s40, 0x4000
 v_exp_f32 v211, v115
 v_mfma_f32_32x32x16_bf16 a[96:111], a[232:235], v[200:203], a[96:111]
 ds_read_b128 a[148:151], v8 offset:18432
 buffer_load_dwordx4 v11, s[8:11], s40 offen offset:0 sc1 lds
 s_add_u32 s44, s44, 1
 v_exp_f32 v212, v116
 v_mfma_f32_32x32x16_bf16 a[112:127], a[236:239], v[200:203], a[112:127]
 ds_read_b128 a[152:155], v8 offset:3072
 ds_read_b128 a[156:159], v8 offset:19456
 v_add_f32 v226, v208, v209
 v_cvt_pk_bf16_f32 v192, v208, v209
 v_exp_f32 v213, v117
 v_mfma_f32_32x32x16_bf16 a[64:79], a[240:243], v[204:207], a[64:79]
 ds_read_b128 a[160:163], v8 offset:4096
 v_add_f32 v226, v226, v210
 v_add_f32 v226, v226, v211
 v_cvt_pk_bf16_f32 v193, v210, v211
 v_exp_f32 v214, v118
 v_mfma_f32_32x32x16_bf16 a[80:95], a[244:247], v[204:207], a[80:95]
 ds_read_b128 a[164:167], v8 offset:20480
 buffer_load_dwordx4 v11, s[8:11], s40 offen offset:1024 sc1 lds
 v_add_f32 v226, v226, v212
 v_exp_f32 v215, v119
 v_mfma_f32_32x32x16_bf16 a[96:111], a[248:251], v[204:207], a[96:111]
 ds_read_b128 a[168:171], v8 offset:5120
 v_add_f32 v226, v226, v213
 v_cvt_pk_bf16_f32 v194, v212, v213
 v_add_f32 v226, v226, v214
 v_exp_f32 v208, v120
 v_mfma_f32_32x32x16_bf16 a[112:127], a[252:255], v[204:207], a[112:127]
 ds_read_b128 a[172:175], v8 offset:21504
 v_add_f32 v226, v226, v215
 v_cvt_pk_bf16_f32 v195, v214, v215
 v_exp_f32 v209, v121
 s_waitcnt lgkmcnt(8)
 v_mfma_f32_32x32x16_bf16 v[80:95], a[128:131], v[48:51], v[160:175]
 ds_read_b128 a[176:179], v8 offset:6144
 ds_read_b128 a[180:183], v8 offset:22528
 v_add_f32 v226, v226, v208
 v_add_f32 v226, v226, v209
 v_exp_f32 v210, v122
 v_mfma_f32_32x32x16_bf16 v[96:111], a[132:135], v[48:51], v[176:191]
 ds_read_b128 a[184:187], v8 offset:7168
 v_cvt_pk_bf16_f32 v196, v208, v209
 v_exp_f32 v211, v123
 v_mfma_f32_32x32x16_bf16 v[80:95], a[136:139], v[52:55], v[80:95]
 ds_read_b128 a[188:191], v8 offset:23552
 buffer_load_dwordx4 v11, s[8:11], s40 offen offset:2048 sc1 lds
 v_add_f32 v226, v226, v210
 v_exp_f32 v212, v124
 v_mfma_f32_32x32x16_bf16 v[96:111], a[140:143], v[52:55], v[96:111]
 ds_read_b128 a[192:195], v9 offset:8192
 v_add_f32 v226, v226, v211
 v_cvt_pk_bf16_f32 v197, v210, v211
 v_exp_f32 v213, v125
 s_waitcnt lgkmcnt(9)
 v_mfma_f32_32x32x16_bf16 v[80:95], a[144:147], v[56:59], v[80:95]
 ds_read_b128 a[196:199], v9 offset:9216
 s_cmp_ge_i32 s44, s46
 s_cbranch_scc1 K2_prep24
K2_prep24_b:
 v_add_f32 v226, v226, v212
 v_exp_f32 v214, v126
 v_mfma_f32_32x32x16_bf16 v[96:111], a[148:151], v[56:59], v[96:111]
 ds_read_b128 a[200:203], v9 offset:10240
 buffer_load_dwordx4 v11, s[8:11], s40 offen offset:3072 sc1 lds
 v_add_f32 v226, v226, v213
 v_exp_f32 v215, v127
 v_mfma_f32_32x32x16_bf16 v[80:95], a[152:155], v[60:63], v[80:95]
 v_cvt_pk_bf16_f32 v198, v212, v213
 v_add_f32 v226, v226, v214
 v_add_f32 v226, v226, v215
 v_cmp_nge_f32 vcc, s39, v226
 v_exp_f32 v216, v128
 v_mfma_f32_32x32x16_bf16 v[96:111], a[156:159], v[60:63], v[96:111]
 ds_read_b128 a[204:207], v9 offset:11264
 v_cvt_pk_bf16_f32 v199, v214, v215
 s_cbranch_vccnz K2_rare25
K2_back25:
 v_exp_f32 v217, v129
 s_waitcnt lgkmcnt(8)
 v_mfma_f32_32x32x16_bf16 v[80:95], a[160:163], v[64:67], v[80:95]
 ds_read_b128 a[208:211], v9 offset:12288
 ds_read_b128 a[212:215], v9 offset:13312
 s_add_u32 m0, m0, 0x4000
 s_and_b32 m0, m0, 0x1ffff
 v_exp_f32 v218, v130
 v_mfma_f32_32x32x16_bf16 v[96:111], a[164:167], v[64:67], v[96:111]
 ds_read_b128 a[216:219], v9 offset:14336
 s_add_u32 s40, s40, 0x4000
 buffer_load_dwordx4 v11, s[8:11], s40 offen offset:0 sc1 lds
 v_exp_f32 v219, v131
 v_mfma_f32_32x32x16_bf16 v[80:95], a[168:171], v[68:71], v[80:95]
 ds_read_b128 a[220:223], v9 offset:15360
 v_add_f32 v229, v229, v226
 v_add_f32 v227, v216, v217
 v_cvt_pk_bf16_f32 v200, v216, v217
 v_exp_f32 v220, v132
 v_mfma_f32_32x32x16_bf16 v[96:111], a[172:175], v[68:71], v[96:111]
 ds_read_b128 a[224:227], v9 offset:24576
 buffer_load_dwordx4 v11, s[8:11], s40 offen offset:1024 sc1 lds
 v_exp_f32 v221, v133
 s_waitcnt lgkmcnt(9)
 v_mfma_f32_32x32x16_bf16 v[80:95], a[176:179], v[72:75], v[80:95]
 ds_read_b128 a[228:231], v9 offset:25600
 v_add_f32 v227, v227, v218
 v_add_f32 v227, v227, v219
 v_cvt_pk_bf16_f32 v201, v218, v219
 v_exp_f32 v222, v134
 v_mfma_f32_32x32x16_bf16 v[96:111], a[180:183], v[72:75], v[96:111]
 ds_read_b128 a[232:235], v9 offset:26624
 v_add_f32 v227, v227, v220
 v_add_f32 v227, v227, v221
 v_cvt_pk_bf16_f32 v202, v220, v221
 v_exp_f32 v223, v135
 v_mfma_f32_32x32x16_bf16 v[80:95], a[184:187], v[76:79], v[80:95]
 ds_read_b128 a[236:239], v9 offset:27648
 buffer_load_dwordx4 v11, s[8:11], s40 offen offset:2048 sc1 lds
 v_add_f32 v227, v227, v222
 v_exp_f32 v216, v136
 v_mfma_f32_32x32x16_bf16 v[96:111], a[188:191], v[76:79], v[96:111]
 ds_read_b128 a[240:243], v9 offset:28672
 v_add_f32 v227, v227, v223
 v_cvt_pk_bf16_f32 v203, v222, v223
 v_exp_f32 v217, v137
 s_waitcnt lgkmcnt(9)
 v_mfma_f32_32x32x16_bf16 a[64:79], a[192:195], v[192:195], a[64:79]
 ds_read_b128 a[244:247], v9 offset:29696
 v_add_f32 v227, v227, v216
 v_add_f32 v227, v227, v217
 v_cvt_pk_bf16_f32 v204, v216, v217
 v_exp_f32 v218, v138
 v_mfma_f32_32x32x16_bf16 a[80:95], a[196:199], v[192:195], a[80:95]
 ds_read_b128 a[248:251], v9 offset:30720
 buffer_load_dwordx4 v11, s[8:11], s40 offen offset:3072 sc1 lds
 v_exp_f32 v219, v139
 v_mfma_f32_32x32x16_bf16 a[96:111], a[200:203], v[192:195], a[96:111]
 ds_read_b128 a[252:255], v9 offset:31744
 v_add_f32 v227, v227, v218
 v_add_f32 v227, v227, v219
 v_cvt_pk_bf16_f32 v205, v218, v219
 v_exp_f32 v220, v140
 v_mfma_f32_32x32x16_bf16 a[112:127], a[204:207], v[192:195], a[112:127]
 v_exp_f32 v221, v141
 s_waitcnt lgkmcnt(8)
 v_mfma_f32_32x32x16_bf16 a[64:79], a[208:211], v[196:199], a[64:79]
 v_add_u32 v9, s42, v10
 v_add_f32 v227, v227, v220
 v_add_f32 v227, v227, v221
 v_cvt_pk_bf16_f32 v206, v220, v221
 v_exp_f32 v222, v142
 v_mfma_f32_32x32x16_bf16 a[80:95], a[212:215], v[196:199], a[80:95]
 v_exp_f32 v223, v143
 s_waitcnt lgkmcnt(0) vmcnt(8)
 s_barrier
 s_cmp_eq_u32 s44, s79
 s_cbranch_scc1 K2_sig2
K2_sig2_b:
 v_mfma_f32_32x32x16_bf16 a[96:111], a[216:219], v[196:199], a[96:111]
 v_add_f32 v227, v227, v222
 v_add_f32 v227, v227, v223
 v_cmp_nge_f32 vcc, s39, v227
 v_exp_f32 v208, v80
 v_mfma_f32_32x32x16_bf16 a[112:127], a[220:223], v[196:199], a[112:127]
 ds_read_b128 a[128:131], v9 offset:0
 ds_read_b128 a[132:135], v9 offset:16384
 v_cvt_pk_bf16_f32 v207, v222, v223
 s_cbranch_vccnz K2_rare26
K2_back26:
 v_exp_f32 v209, v81
 v_mfma_f32_32x32x16_bf16 a[64:79], a[224:227], v[200:203], a[64:79]
 ds_read_b128 a[136:139], v9 offset:1024
 ds_read_b128 a[140:143], v9 offset:17408
 s_add_u32 s42, s42, 0x8000
 v_add_f32 v229, v229, v227
 v_exp_f32 v210, v82
 v_mfma_f32_32x32x16_bf16 a[80:95], a[228:231], v[200:203], a[80:95]
 ds_read_b128 a[144:147], v9 offset:2048
 s_and_b32 s42, s42, 0x1ffff
 s_add_u32 m0, m0, 0x4000
 s_and_b32 m0, m0, 0x1ffff
 v_exp_f32 v211, v83
 v_mfma_f32_32x32x16_bf16 a[96:111], a[232:235], v[200:203], a[96:111]
 ds_read_b128 a[148:151], v9 offset:18432
 s_add_u32 s40, s40, 0x4000
 buffer_load_dwordx4 v11, s[8:11], s40 offen offset:0 sc1 lds
 v_exp_f32 v212, v84
 v_mfma_f32_32x32x16_bf16 a[112:127], a[236:239], v[200:203], a[112:127]
 ds_read_b128 a[152:155], v9 offset:3072
 ds_read_b128 a[156:159], v9 offset:19456
 s_add_u32 s44, s44, 1
 v_add_f32 v226, v208, v209
 v_exp_f32 v213, v85
 v_mfma_f32_32x32x16_bf16 a[64:79], a[240:243], v[204:207], a[64:79]
 ds_read_b128 a[160:163], v9 offset:4096
 v_cvt_pk_bf16_f32 v192, v208, v209
 v_add_f32 v226, v226, v210
 v_add_f32 v226, v226, v211
 v_exp_f32 v214, v86
 v_mfma_f32_32x32x16_bf16 a[80:95], a[244:247], v[204:207], a[80:95]
 ds_read_b128 a[164:167], v9 offset:20480
 buffer_load_dwordx4 v11, s[8:11], s40 offen offset:1024 sc1 lds
 v_cvt_pk_bf16_f32 v193, v210, v211
 v_exp_f32 v215, v87
 v_mfma_f32_32x32x16_bf16 a[96:111], a[248:251], v[204:207], a[96:111]
 ds_read_b128 a[168:171], v9 offset:5120
 v_add_f32 v226, v226, v212
 v_add_f32 v226, v226, v213
 v_cvt_pk_bf16_f32 v194, v212, v213
 v_exp_f32 v208, v88
 v_mfma_f32_32x32x16_bf16 a[112:127], a[252:255], v[204:207], a[112:127]
 ds_read_b128 a[172:175], v9 offset:21504
 v_add_f32 v226, v226, v214
 v_add_f32 v226, v226, v215
 v_cvt_pk_bf16_f32 v195, v214, v215
 v_exp_f32 v209, v89
 s_sub_u32 s47, s47, 1
 s_cmp_lg_u32 s47, 0
 s_cbranch_scc1 K2_loopS
K2_tail:
 s_bfe_u32 s3, s2, 0x20003
 s_lshr_b32 s61, s3, 1
 s_xor_b32 s61, s61, 1
 s_xor_b32 s3, s3, s61
 s_lshr_b32 s61, s2, 5
 s_and_b32 s60, s2, 6
 s_and_b32 s58, s3, 1
 s_add_u32 s62, s60, s58
 s_sub_u32 s63, 14, s60
 s_add_u32 s63, s63, s58
 s_sub_u32 s66, 15, s63
 s_bitcmp1_b32 s3, 1
 s_cselect_b32 s60, s63, s62
 s_cselect_b32 s59, s66, s62
 s_cmp_ge_u32 s60, 7
 s_cselect_b32 s28, 0xf, 0
 s_mov_b32 s29, 0
 s_lshl_b32 s59, s59, 7
 s_and_b32 s62, s2, 1
 s_mov_b32 s49, 0x3b20000
 s_mov_b64 s[30:31], 0xf
 v_lshrrev_b32 v3, 3, v2
 v_and_b32 v4, 7, v2
 v_bfe_u32 v5, v3, 1, 1
 v_lshlrev_b32 v5, 2, v5
 v_xor_b32 v4, v4, v5
 v_lshlrev_b32 v4, 4, v4
 v_lshl_add_u32 v4, v3, 11, v4
 s_lshl_b32 s55, s61, 8
 v_add_u32 v252, s55, v4
 v_add_u32 v253, 15360, v252
 v_add_u32 v254, 30720, v252
 v_add_u32 v255, 46080, v252
 s_add_u32 s55, s52, 0
 s_and_b32 s55, s55, 3
 s_lshl_b32 s55, s55, 11
 v_add_u32 v248, s55, v10
 s_add_u32 s55, s52, 1
 s_and_b32 s55, s55, 3
 s_lshl_b32 s55, s55, 11
 v_add_u32 v249, s55, v10
 s_add_u32 s55, s52, 2
 s_and_b32 s55, s55, 3
 s_lshl_b32 s55, s55, 11
 v_add_u32 v250, s55, v10
 s_add_u32 s55, s52, 3
 s_and_b32 s55, s55, 3
 s_lshl_b32 s55, s55, 11
 v_add_u32 v251, s55, v10
 s_lshl_b32 s57, s62, 4
 s_lshl_b32 s55, s52, 2
 s_add_u32 s57, s57, s55
 s_mul_i32 s56, s60, 1310720
 s_add_u32 s56, s56, 0x3ffe000
 s_lshl_b32 s55, s57, 13
 s_add_u32 s35, s56, s55
 s_lshl_b32 s55, s57, 15
 s_add_u32 s40, s56, s55
 s_add_u32 s40, s40, 262144
 s_lshl_b32 s63, s62, 7
 s_xor_b32 s55, s63, 128
 s_lshl_b32 s34, s57, 16
 s_add_u32 s42, s34, s63
 s_add_u32 s34, s34, s55
 s_lshl_b32 s41, s57, 18
 s_add_u32 s43, s41, s63
 s_add_u32 s41, s41, s55
 s_and_b32 s55, s54, 1
 s_lshl_b32 s55, s55, 16
 s_lshl_b32 s46, s52, 13
 s_add_u32 s84, s55, s46
 s_add_u32 s85, s84, 0x8000
 s_add_u32 s86, s46, 0x20000
 s_xor_b32 s87, s84, 0x10000
 s_mov_b32 s8, s16
 s_mov_b32 s9, s17
 s_mov_b32 s10, s18
 s_mov_b32 s11, 0x20000
 v_lshrrev_b32 v3, 5, v2
 v_lshlrev_b32 v3, 11, v3
 v_bfe_u32 v4, v2, 2, 3
 v_lshl_add_u32 v3, v4, 7, v3
 v_bfe_u32 v4, v2, 3, 1
 v_lshlrev_b32 v4, 2, v4
 v_and_b32 v5, 3, v2
 v_or_b32 v4, v4, v5
 v_lshl_add_u32 v5, v4, 4, v3
 v_xor_b32 v4, 4, v4
 v_lshl_add_u32 v4, v4, 4, v3
 v_add_u32 v14, s84, v5
 v_add_u32 v15, s84, v4
 v_add_u32 v240, s86, v5
 v_add_u32 v241, s86, v4
 v_add_u32 v242, s87, v5
 v_add_u32 v243, s87, v4
 s_lshl_b32 s55, s57, 10
 s_add_u32 s55, s55, s59
 v_min_u32 v1, 3, v2
 v_lshlrev_b32 v1, 10, v1
 v_add_u32 v1, s55, v1
 s_add_u32 s47, s2, 1
 s_and_b32 s47, s47, 3
 s_mov_b32 s44, 0x3b28000
 s_sub_u32 s35, s35, 0x2000
 s_sub_u32 s40, s40, 0x2000
 s_xor_b32 s55, s3, s61
 s_and_b32 s55, s55, 1
 s_lshl_b32 s98, s55, 18
 s_lshl_b32 s56, s55, 15
 s_sub_u32 s99, 0x4000, s56
 s_lshl_b32 s56, s55, 14
 s_add_u32 s35, s35, s56
 s_add_u32 s40, s40, s56
 s_lshl_b32 s56, s55, 17
 s_add_u32 s34, s34, s56
 s_add_u32 s42, s42, s56
 s_add_u32 s41, s41, s56
 s_add_u32 s43, s43, s56
 s_cmp_eq_u32 s54, 7
 s_cbranch_scc1 K2_w7
 s_waitcnt vmcnt(0)
K2_w7_b:
 s_barrier
 s_waitcnt lgkmcnt(8)
 v_mfma_f32_32x32x16_bf16 v[112:127], a[128:131], v[48:51], v[160:175]
 ds_read_b128 a[176:179], v9 offset:6144
 buffer_load_dword v13, v1, s[20:23], s49 offen sc1
 s_add_u32 m0, s84, 0
 v_exp_f32 v210, v90
 v_mfma_f32_32x32x16_bf16 v[128:143], a[132:135], v[48:51], v[176:191]
 ds_read_b128 a[180:183], v9 offset:22528
 ds_read_b128 a[184:187], v9 offset:7168
 buffer_load_dwordx4 v252, s[8:11], s34 offen offset:0 lds
 v_exp_f32 v211, v91
 v_mfma_f32_32x32x16_bf16 v[112:127], a[136:139], v[52:55], v[112:127]
 ds_read_b128 a[188:191], v9 offset:23552
 buffer_load_dwordx4 v253, s[8:11], s34 offen offset:1024 lds
 v_add_f32 v226, v226, v208
 v_exp_f32 v212, v92
 v_mfma_f32_32x32x16_bf16 v[128:143], a[140:143], v[52:55], v[128:143]
 ds_read_b128 a[192:195], v8 offset:8192
 v_add_f32 v226, v226, v209
 v_cvt_pk_bf16_f32 v196, v208, v209
 v_exp_f32 v213, v93
 s_waitcnt lgkmcnt(9)
 v_mfma_f32_32x32x16_bf16 v[112:127], a[144:147], v[56:59], v[112:127]
 ds_read_b128 a[196:199], v8 offset:9216
 buffer_load_dwordx4 v254, s[8:11], s34 offen offset:2048 lds
 v_add_f32 v226, v226, v210
 v_exp_f32 v214, v94
 v_mfma_f32_32x32x16_bf16 v[128:143], a[148:151], v[56:59], v[128:143]
 ds_read_b128 a[200:203], v8 offset:10240
 v_add_f32 v226, v226, v211
 v_cvt_pk_bf16_f32 v197, v210, v211
 v_add_f32 v226, v226, v212
 v_exp_f32 v215, v95
 v_mfma_f32_32x32x16_bf16 v[112:127], a[152:155], v[60:63], v[112:127]
 v_add_f32 v226, v226, v213
 v_cvt_pk_bf16_f32 v198, v212, v213
 v_add_f32 v226, v226, v214
 v_add_f32 v226, v226, v215
 v_cmp_nge_f32 vcc, s39, v226
 v_exp_f32 v216, v96
 v_mfma_f32_32x32x16_bf16 v[128:143], a[156:159], v[60:63], v[128:143]
 ds_read_b128 a[204:207], v8 offset:11264
 v_cvt_pk_bf16_f32 v199, v214, v215
 s_cbranch_vccnz K2_rare27
K2_back27:
 v_exp_f32 v217, v97
 s_waitcnt lgkmcnt(8)
 v_mfma_f32_32x32x16_bf16 v[112:127], a[160:163], v[64:67], v[112:127]
 buffer_load_dwordx4 v255, s[8:11], s34 offen offset:3072 lds
 s_add_u32 s34, s34, 0x10000
 s_add_u32 m0, s85, 0
 v_exp_f32 v218, v98
 v_mfma_f32_32x32x16_bf16 v[128:143], a[164:167], v[64:67], v[128:143]
 ds_read_b128 a[208:211], v8 offset:12288
 ds_read_b128 a[212:215], v8 offset:13312
 buffer_load_dwordx4 v252, s[8:11], s34 offen offset:0 lds
 v_exp_f32 v219, v99
 v_mfma_f32_32x32x16_bf16 v[112:127], a[168:171], v[68:71], v[112:127]
 ds_read_b128 a[216:219], v8 offset:14336
 ds_read_b128 a[220:223], v8 offset:15360
 buffer_load_dwordx4 v253, s[8:11], s34 offen offset:1024 lds
 v_exp_f32 v220, v100
 v_mfma_f32_32x32x16_bf16 v[128:143], a[172:175], v[68:71], v[128:143]
 ds_read_b128 a[224:227], v8 offset:24576
 v_add_f32 v229, v229, v226
 v_add_f32 v227, v216, v217
 v_exp_f32 v221, v101
 s_waitcnt lgkmcnt(9)
 v_mfma_f32_32x32x16_bf16 v[112:127], a[176:179], v[72:75], v[112:127]
 ds_read_b128 a[228:231], v8 offset:25600
 buffer_load_dwordx4 v254, s[8:11], s34 offen offset:2048 lds
 v_cvt_pk_bf16_f32 v200, v216, v217
 v_exp_f32 v222, v102
 v_mfma_f32_32x32x16_bf16 v[128:143], a[180:183], v[72:75], v[128:143]
 ds_read_b128 a[232:235], v8 offset:26624
 v_add_f32 v227, v227, v218
 v_add_f32 v227, v227, v219
 v_cvt_pk_bf16_f32 v201, v218, v219
 v_exp_f32 v223, v103
 v_mfma_f32_32x32x16_bf16 v[112:127], a[184:187], v[76:79], v[112:127]
 ds_read_b128 a[236:239], v8 offset:27648
 buffer_load_dwordx4 v255, s[8:11], s34 offen offset:3072 lds
 v_add_f32 v227, v227, v220
 v_exp_f32 v216, v104
 v_mfma_f32_32x32x16_bf16 v[128:143], a[188:191], v[76:79], v[128:143]
 ds_read_b128 a[240:243], v8 offset:28672
 s_add_u32 s34, s34, 0x10000
 s_add_u32 m0, s84, 4096
 v_exp_f32 v217, v105
 s_waitcnt lgkmcnt(9)
 v_mfma_f32_32x32x16_bf16 a[64:79], a[192:195], v[192:195], a[64:79]
 buffer_load_dwordx4 v252, s[8:11], s42 offen offset:0 lds
 v_add_f32 v227, v227, v221
 v_cvt_pk_bf16_f32 v202, v220, v221
 v_exp_f32 v218, v106
 v_mfma_f32_32x32x16_bf16 a[80:95], a[196:199], v[192:195], a[80:95]
 ds_read_b128 a[244:247], v8 offset:29696
 ds_read_b128 a[248:251], v8 offset:30720
 buffer_load_dwordx4 v253, s[8:11], s42 offen offset:1024 lds
 v_exp_f32 v219, v107
 v_mfma_f32_32x32x16_bf16 a[96:111], a[200:203], v[192:195], a[96:111]
 ds_read_b128 a[252:255], v8 offset:31744
 v_add_f32 v227, v227, v222
 v_add_f32 v227, v227, v223
 v_cvt_pk_bf16_f32 v203, v222, v223
 v_exp_f32 v220, v108
 v_mfma_f32_32x32x16_bf16 a[112:127], a[204:207], v[192:195], a[112:127]
 buffer_load_dwordx4 v254, s[8:11], s42 offen offset:2048 lds
 v_add_f32 v227, v227, v216
 v_exp_f32 v221, v109
 s_waitcnt lgkmcnt(8)
 v_mfma_f32_32x32x16_bf16 a[64:79], a[208:211], v[196:199], a[64:79]
 v_add_f32 v227, v227, v217
 v_cvt_pk_bf16_f32 v204, v216, v217
 v_add_f32 v227, v227, v218
 v_exp_f32 v222, v110
 v_mfma_f32_32x32x16_bf16 a[80:95], a[212:215], v[196:199], a[80:95]
 buffer_load_dwordx4 v255, s[8:11], s42 offen offset:3072 lds
 v_add_f32 v227, v227, v219
 v_cvt_pk_bf16_f32 v205, v218, v219
 v_exp_f32 v223, v111
 v_mfma_f32_32x32x16_bf16 a[96:111], a[216:219], v[196:199], a[96:111]
 v_add_f32 v227, v227, v220
 v_add_f32 v227, v227, v221
 v_cvt_pk_bf16_f32 v206, v220, v221
 v_add_f32 v227, v227, v222
 v_add_f32 v227, v227, v223
 v_cmp_nge_f32 vcc, s39, v227
 v_exp_f32 v208, v112
 v_mfma_f32_32x32x16_bf16 a[112:127], a[220:223], v[196:199], a[112:127]
 s_add_u32 s42, s42, 0x10000
 v_cvt_pk_bf16_f32 v207, v222, v223
 s_cbranch_vccnz K2_rare28
K2_back28:
 v_exp_f32 v209, v113
 s_waitcnt lgkmcnt(4)
 v_mfma_f32_32x32x16_bf16 a[64:79], a[224:227], v[200:203], a[64:79]
 s_add_u32 m0, s85, 4096
 v_add_f32 v229, v229, v227
 v_add_f32 v226, v208, v209
 v_cvt_pk_bf16_f32 v192, v208, v209
 v_exp_f32 v210, v114
 v_mfma_f32_32x32x16_bf16 a[80:95], a[228:231], v[200:203], a[80:95]
 buffer_load_dwordx4 v252, s[8:11], s42 offen offset:0 lds
 v_exp_f32 v211, v115
 v_mfma_f32_32x32x16_bf16 a[96:111], a[232:235], v[200:203], a[96:111]
 buffer_load_dwordx4 v253, s[8:11], s42 offen offset:1024 lds
 v_add_f32 v226, v226, v210
 v_add_f32 v226, v226, v211
 v_exp_f32 v212, v116
 v_mfma_f32_32x32x16_bf16 a[112:127], a[236:239], v[200:203], a[112:127]
 buffer_load_dwordx4 v254, s[8:11], s42 offen offset:2048 lds
 v_cvt_pk_bf16_f32 v193, v210, v211
 v_exp_f32 v213, v117
 s_waitcnt lgkmcnt(0)
 v_mfma_f32_32x32x16_bf16 a[64:79], a[240:243], v[204:207], a[64:79]
 v_add_f32 v226, v226, v212
 v_add_f32 v226, v226, v213
 v_cvt_pk_bf16_f32 v194, v212, v213
 v_exp_f32 v214, v118
 v_mfma_f32_32x32x16_bf16 a[80:95], a[244:247], v[204:207], a[80:95]
 buffer_load_dwordx4 v255, s[8:11], s42 offen offset:3072 lds
 v_exp_f32 v215, v119
 v_mfma_f32_32x32x16_bf16 a[96:111], a[248:251], v[204:207], a[96:111]
 v_add_f32 v226, v226, v214
 v_add_f32 v226, v226, v215
 v_cvt_pk_bf16_f32 v195, v214, v215
 v_exp_f32 v208, v120
 v_mfma_f32_32x32x16_bf16 a[112:127], a[252:255], v[204:207], a[112:127]
 v_exp_f32 v209, v121
 s_waitcnt vmcnt(16)
 v_cmp_ne_u32 vcc, s89, v13
 s_nop 0
 s_and_b64 vcc, vcc, s[30:31]
 s_cbranch_vccnz K2_spin2
K2_spin2_b:
 s_barrier
 ds_read_b128 a[192:195], v9 offset:8192
 ds_read_b128 a[196:199], v9 offset:9216
 s_add_u32 s42, s42, 0x10000
 s_sub_u32 s34, s34, s98
 s_add_u32 m0, s86, 0
 v_add_f32 v226, v226, v208
 v_add_f32 v226, v226, v209
 v_cvt_pk_bf16_f32 v196, v208, v209
 v_exp_f32 v210, v122
 ds_read_b128 a[200:203], v9 offset:10240
 ds_read_b128 a[204:207], v9 offset:11264
 buffer_load_dwordx4 v252, s[8:11], s34 offen offset:0 lds
 buffer_load_dwordx4 v253, s[8:11], s34 offen offset:1024 lds
 buffer_load_dwordx4 v254, s[8:11], s34 offen offset:2048 lds
 v_exp_f32 v211, v123
 ds_read_b128 a[208:211], v9 offset:12288
 ds_read_b128 a[212:215], v9 offset:13312
 buffer_load_dwordx4 v255, s[8:11], s34 offen offset:3072 lds
 s_add_u32 s34, s34, 0x10000
 s_add_u32 m0, s87, 0
 v_add_f32 v226, v226, v210
 v_add_f32 v226, v226, v211
 v_cvt_pk_bf16_f32 v197, v210, v211
 v_exp_f32 v212, v124
 ds_read_b128 a[216:219], v9 offset:14336
 ds_read_b128 a[220:223], v9 offset:15360
 buffer_load_dwordx4 v252, s[8:11], s34 offen offset:0 lds
 v_exp_f32 v213, v125
 ds_read_b128 a[224:227], v9 offset:24576
 ds_read_b128 a[228:231], v9 offset:25600
 buffer_load_dwordx4 v253, s[8:11], s34 offen offset:1024 lds
 v_add_f32 v226, v226, v212
 v_add_f32 v226, v226, v213
 v_cvt_pk_bf16_f32 v198, v212, v213
 v_exp_f32 v214, v126
 ds_read_b128 a[232:235], v9 offset:26624
 ds_read_b128 a[236:239], v9 offset:27648
 buffer_load_dwordx4 v254, s[8:11], s34 offen offset:2048 lds
 v_exp_f32 v215, v127
 ds_read_b128 a[240:243], v9 offset:28672
 ds_read_b128 a[244:247], v9 offset:29696
 buffer_load_dwordx4 v255, s[8:11], s34 offen offset:3072 lds
 s_add_u32 s34, s34, 0x10000
 s_sub_u32 s42, s42, s98
 s_add_u32 m0, s86, 4096
 v_add_f32 v226, v226, v214
 v_add_f32 v226, v226, v215
 v_cmp_nge_f32 vcc, s39, v226
 v_cvt_pk_bf16_f32 v199, v214, v215
 v_exp_f32 v216, v128
 ds_read_b128 a[248:251], v9 offset:30720
 ds_read_b128 a[252:255], v9 offset:31744
 buffer_load_dwordx4 v252, s[8:11], s42 offen offset:0 lds
 s_cbranch_vccnz K2_rare29
K2_back29:
 v_add_f32 v229, v229, v226
 v_exp_f32 v217, v129
 buffer_load_dwordx4 v253, s[8:11], s42 offen offset:1024 lds
 v_add_f32 v227, v216, v217
 v_cvt_pk_bf16_f32 v200, v216, v217
 v_exp_f32 v218, v130
 buffer_load_dwordx4 v254, s[8:11], s42 offen offset:2048 lds
 v_exp_f32 v219, v131
 buffer_load_dwordx4 v255, s[8:11], s42 offen offset:3072 lds
 s_add_u32 s42, s42, 0x10000
 s_add_u32 m0, s87, 4096
 v_add_f32 v227, v227, v218
 v_add_f32 v227, v227, v219
 v_cvt_pk_bf16_f32 v201, v218, v219
 v_exp_f32 v220, v132
 buffer_load_dwordx4 v252, s[8:11], s42 offen offset:0 lds
 v_exp_f32 v221, v133
 buffer_load_dwordx4 v253, s[8:11], s42 offen offset:1024 lds
 v_add_f32 v227, v227, v220
 v_add_f32 v227, v227, v221
 v_cvt_pk_bf16_f32 v202, v220, v221
 v_exp_f32 v222, v134
 buffer_load_dwordx4 v254, s[8:11], s42 offen offset:2048 lds
 v_exp_f32 v223, v135
 buffer_load_dwordx4 v255, s[8:11], s42 offen offset:3072 lds
 s_add_u32 s42, s42, 0x10000
 s_add_u32 s35, s35, 0x4000
 s_add_u32 s36, s35, 0x2000
 v_add_f32 v227, v227, v222
 v_add_f32 v227, v227, v223
 v_cvt_pk_bf16_f32 v203, v222, v223
 v_exp_f32 v216, v136
 buffer_load_dwordx4 v[16:19], v248, s[20:23], s35 offen offset:0 sc1
 v_exp_f32 v217, v137
 s_waitcnt lgkmcnt(12)
 v_mfma_f32_32x32x16_bf16 a[64:79], a[192:195], v[192:195], a[64:79]
 buffer_load_dwordx4 v[20:23], v248, s[20:23], s35 offen offset:1024 sc1
 v_add_f32 v227, v227, v216
 v_add_f32 v227, v227, v217
 v_exp_f32 v218, v138
 v_mfma_f32_32x32x16_bf16 a[80:95], a[196:199], v[192:195], a[80:95]
 buffer_load_dwordx4 v[24:27], v248, s[20:23], s36 offen offset:0 sc1
 v_cvt_pk_bf16_f32 v204, v216, v217
 v_exp_f32 v219, v139
 v_mfma_f32_32x32x16_bf16 a[96:111], a[200:203], v[192:195], a[96:111]
 buffer_load_dwordx4 v[28:31], v248, s[20:23], s36 offen offset:1024 sc1
 v_add_f32 v227, v227, v218
 v_add_f32 v227, v227, v219
 v_exp_f32 v220, v140
 v_mfma_f32_32x32x16_bf16 a[112:127], a[204:207], v[192:195], a[112:127]
 buffer_load_dwordx4 v[32:35], v249, s[20:23], s35 offen offset:0 sc1
 v_cvt_pk_bf16_f32 v205, v218, v219
 v_exp_f32 v221, v141
 s_waitcnt lgkmcnt(8)
 v_mfma_f32_32x32x16_bf16 a[64:79], a[208:211], v[196:199], a[64:79]
 buffer_load_dwordx4 v[36:39], v249, s[20:23], s35 offen offset:1024 sc1
 v_add_f32 v227, v227, v220
 v_add_f32 v227, v227, v221
 v_exp_f32 v222, v142
 v_mfma_f32_32x32x16_bf16 a[80:95], a[212:215], v[196:199], a[80:95]
 buffer_load_dwordx4 v[40:43], v249, s[20:23], s36 offen offset:0 sc1
 v_cvt_pk_bf16_f32 v206, v220, v221
 v_exp_f32 v223, v143
 v_mfma_f32_32x32x16_bf16 a[96:111], a[216:219], v[196:199], a[96:111]
 buffer_load_dwordx4 v[44:47], v249, s[20:23], s36 offen offset:1024 sc1
 v_add_f32 v227, v227, v222
 v_add_f32 v227, v227, v223
 v_cmp_nge_f32 vcc, s39, v227
 v_mfma_f32_32x32x16_bf16 a[112:127], a[220:223], v[196:199], a[112:127]
 s_mov_b32 s37, s35
 s_mov_b32 s38, s36
 v_cvt_pk_bf16_f32 v207, v222, v223
 s_cbranch_vccnz K2_rare30
K2_back30:
 s_waitcnt lgkmcnt(4)
 v_mfma_f32_32x32x16_bf16 a[64:79], a[224:227], v[200:203], a[64:79]
 buffer_load_dwordx4 v[48:51], v250, s[20:23], s37 offen offset:0 sc1
 v_add_f32 v229, v229, v227
 v_mfma_f32_32x32x16_bf16 a[80:95], a[228:231], v[200:203], a[80:95]
 buffer_load_dwordx4 v[52:55], v250, s[20:23], s37 offen offset:1024 sc1
 v_mfma_f32_32x32x16_bf16 a[96:111], a[232:235], v[200:203], a[96:111]
 buffer_load_dwordx4 v[56:59], v250, s[20:23], s38 offen offset:0 sc1
 v_mfma_f32_32x32x16_bf16 a[112:127], a[236:239], v[200:203], a[112:127]
 buffer_load_dwordx4 v[60:63], v250, s[20:23], s38 offen offset:1024 sc1
 s_waitcnt lgkmcnt(0)
 v_mfma_f32_32x32x16_bf16 a[64:79], a[240:243], v[204:207], a[64:79]
 buffer_load_dwordx4 v[64:67], v251, s[20:23], s37 offen offset:0 sc1
 v_mfma_f32_32x32x16_bf16 a[80:95], a[244:247], v[204:207], a[80:95]
 buffer_load_dwordx4 v[68:71], v251, s[20:23], s37 offen offset:1024 sc1
 v_mfma_f32_32x32x16_bf16 a[96:111], a[248:251], v[204:207], a[96:111]
 buffer_load_dwordx4 v[72:75], v251, s[20:23], s38 offen offset:0 sc1
 v_mfma_f32_32x32x16_bf16 a[112:127], a[252:255], v[204:207], a[112:127]
 buffer_load_dwordx4 v[76:79], v251, s[20:23], s38 offen offset:1024 sc1
 v_mov_b32 v232, v229
 s_nop 1
 v_permlane32_swap_b32 v229, v232
 v_add_f32 v232, v232, v229
 v_rcp_f32 v232, v232
 s_nop 0
 v_mul_f32 v232, v232, v225
 v_mov_b32 v233, v232
 v_accvgpr_read_b32 v112, a64
 v_accvgpr_read_b32 v113, a65
 v_accvgpr_read_b32 v114, a66
 v_accvgpr_read_b32 v115, a67
 v_accvgpr_read_b32 v116, a68
 v_accvgpr_read_b32 v117, a69
 v_accvgpr_read_b32 v118, a70
 v_accvgpr_read_b32 v119, a71
 v_pk_mul_f32 v[112:113], v[112:113], v[232:233]
 v_pk_mul_f32 v[114:115], v[114:115], v[232:233]
 v_pk_mul_f32 v[116:117], v[116:117], v[232:233]
 v_pk_mul_f32 v[118:119], v[118:119], v[232:233]
 v_cvt_pk_bf16_f32 v112, v112, v113
 v_cvt_pk_bf16_f32 v113, v114, v115
 v_cvt_pk_bf16_f32 v114, v116, v117
 v_cvt_pk_bf16_f32 v115, v118, v119
 buffer_store_dwordx4 v[112:115], v12, s[20:23], s70 offen offset:0 sc1
 v_accvgpr_read_b32 v120, a72
 v_accvgpr_read_b32 v121, a73
 v_accvgpr_read_b32 v122, a74
 v_accvgpr_read_b32 v123, a75
 v_accvgpr_read_b32 v124, a76
 v_accvgpr_read_b32 v125, a77
 v_accvgpr_read_b32 v126, a78
 v_accvgpr_read_b32 v127, a79
 v_pk_mul_f32 v[120:121], v[120:121], v[232:233]
 v_pk_mul_f32 v[122:123], v[122:123], v[232:233]
 v_pk_mul_f32 v[124:125], v[124:125], v[232:233]
 v_pk_mul_f32 v[126:127], v[126:127], v[232:233]
 v_cvt_pk_bf16_f32 v120, v120, v121
 v_cvt_pk_bf16_f32 v121, v122, v123
 v_cvt_pk_bf16_f32 v122, v124, v125
 v_cvt_pk_bf16_f32 v123, v126, v127
 buffer_store_dwordx4 v[120:123], v12, s[20:23], s70 offen offset:512 sc1
 s_add_u32 s70, s70, 8192
 v_accvgpr_read_b32 v128, a80
 v_accvgpr_read_b32 v129, a81
 v_accvgpr_read_b32 v130, a82
 v_accvgpr_read_b32 v131, a83
 v_accvgpr_read_b32 v132, a84
 v_accvgpr_read_b32 v133, a85
 v_accvgpr_read_b32 v134, a86
 v_accvgpr_read_b32 v135, a87
 v_pk_mul_f32 v[128:129], v[128:129], v[232:233]
 v_pk_mul_f32 v[130:131], v[130:131], v[232:233]
 v_pk_mul_f32 v[132:133], v[132:133], v[232:233]
 v_pk_mul_f32 v[134:135], v[134:135], v[232:233]
 v_cvt_pk_bf16_f32 v128, v128, v129
 v_cvt_pk_bf16_f32 v129, v130, v131
 v_cvt_pk_bf16_f32 v130, v132, v133
 v_cvt_pk_bf16_f32 v131, v134, v135
 buffer_store_dwordx4 v[128:131], v12, s[20:23], s70 offen offset:0 sc1
 v_accvgpr_read_b32 v136, a88
 v_accvgpr_read_b32 v137, a89
 v_accvgpr_read_b32 v138, a90
 v_accvgpr_read_b32 v139, a91
 v_accvgpr_read_b32 v140, a92
 v_accvgpr_read_b32 v141, a93
 v_accvgpr_read_b32 v142, a94
 v_accvgpr_read_b32 v143, a95
 v_pk_mul_f32 v[136:137], v[136:137], v[232:233]
 v_pk_mul_f32 v[138:139], v[138:139], v[232:233]
 v_pk_mul_f32 v[140:141], v[140:141], v[232:233]
 v_pk_mul_f32 v[142:143], v[142:143], v[232:233]
 v_cvt_pk_bf16_f32 v136, v136, v137
 v_cvt_pk_bf16_f32 v137, v138, v139
 v_cvt_pk_bf16_f32 v138, v140, v141
 v_cvt_pk_bf16_f32 v139, v142, v143
 buffer_store_dwordx4 v[136:139], v12, s[20:23], s70 offen offset:512 sc1
 s_add_u32 s70, s70, 8192
 v_accvgpr_read_b32 v112, a96
 v_accvgpr_read_b32 v113, a97
 v_accvgpr_read_b32 v114, a98
 v_accvgpr_read_b32 v115, a99
 v_accvgpr_read_b32 v116, a100
 v_accvgpr_read_b32 v117, a101
 v_accvgpr_read_b32 v118, a102
 v_accvgpr_read_b32 v119, a103
 v_pk_mul_f32 v[112:113], v[112:113], v[232:233]
 v_pk_mul_f32 v[114:115], v[114:115], v[232:233]
 v_pk_mul_f32 v[116:117], v[116:117], v[232:233]
 v_pk_mul_f32 v[118:119], v[118:119], v[232:233]
 v_cvt_pk_bf16_f32 v112, v112, v113
 v_cvt_pk_bf16_f32 v113, v114, v115
 v_cvt_pk_bf16_f32 v114, v116, v117
 v_cvt_pk_bf16_f32 v115, v118, v119
 buffer_store_dwordx4 v[112:115], v12, s[20:23], s70 offen offset:0 sc1
 v_accvgpr_read_b32 v120, a104
 v_accvgpr_read_b32 v121, a105
 v_accvgpr_read_b32 v122, a106
 v_accvgpr_read_b32 v123, a107
 v_accvgpr_read_b32 v124, a108
 v_accvgpr_read_b32 v125, a109
 v_accvgpr_read_b32 v126, a110
 v_accvgpr_read_b32 v127, a111
 v_pk_mul_f32 v[120:121], v[120:121], v[232:233]
 v_pk_mul_f32 v[122:123], v[122:123], v[232:233]
 v_pk_mul_f32 v[124:125], v[124:125], v[232:233]
 v_pk_mul_f32 v[126:127], v[126:127], v[232:233]
 v_cvt_pk_bf16_f32 v120, v120, v121
 v_cvt_pk_bf16_f32 v121, v122, v123
 v_cvt_pk_bf16_f32 v122, v124, v125
 v_cvt_pk_bf16_f32 v123, v126, v127
 buffer_store_dwordx4 v[120:123], v12, s[20:23], s70 offen offset:512 sc1
 s_add_u32 s70, s70, 8192
 v_accvgpr_read_b32 v128, a112
 v_accvgpr_read_b32 v129, a113
 v_accvgpr_read_b32 v130, a114
 v_accvgpr_read_b32 v131, a115
 v_accvgpr_read_b32 v132, a116
 v_accvgpr_read_b32 v133, a117
 v_accvgpr_read_b32 v134, a118
 v_accvgpr_read_b32 v135, a119
 v_pk_mul_f32 v[128:129], v[128:129], v[232:233]
 v_pk_mul_f32 v[130:131], v[130:131], v[232:233]
 v_pk_mul_f32 v[132:133], v[132:133], v[232:233]
 v_pk_mul_f32 v[134:135], v[134:135], v[232:233]
 v_cvt_pk_bf16_f32 v128, v128, v129
 v_cvt_pk_bf16_f32 v129, v130, v131
 v_cvt_pk_bf16_f32 v130, v132, v133
 v_cvt_pk_bf16_f32 v131, v134, v135
 buffer_store_dwordx4 v[128:131], v12, s[20:23], s70 offen offset:0 sc1
 v_accvgpr_read_b32 v136, a120
 v_accvgpr_read_b32 v137, a121
 v_accvgpr_read_b32 v138, a122
 v_accvgpr_read_b32 v139, a123
 v_accvgpr_read_b32 v140, a124
 v_accvgpr_read_b32 v141, a125
 v_accvgpr_read_b32 v142, a126
 v_accvgpr_read_b32 v143, a127
 v_pk_mul_f32 v[136:137], v[136:137], v[232:233]
 v_pk_mul_f32 v[138:139], v[138:139], v[232:233]
 v_pk_mul_f32 v[140:141], v[140:141], v[232:233]
 v_pk_mul_f32 v[142:143], v[142:143], v[232:233]
 v_cvt_pk_bf16_f32 v136, v136, v137
 v_cvt_pk_bf16_f32 v137, v138, v139
 v_cvt_pk_bf16_f32 v138, v140, v141
 v_cvt_pk_bf16_f32 v139, v142, v143
 buffer_store_dwordx4 v[136:139], v12, s[20:23], s70 offen offset:512 sc1
 s_add_u32 s35, s35, s99
 s_add_u32 s36, s35, 0x2000
 buffer_load_dwordx4 v[80:83], v248, s[20:23], s35 offen offset:0 sc1
 buffer_load_dwordx4 v[84:87], v248, s[20:23], s35 offen offset:1024 sc1
 buffer_load_dwordx4 v[88:91], v248, s[20:23], s36 offen offset:0 sc1
 buffer_load_dwordx4 v[92:95], v248, s[20:23], s36 offen offset:1024 sc1
 buffer_load_dwordx4 v[96:99], v249, s[20:23], s35 offen offset:0 sc1
 buffer_load_dwordx4 v[100:103], v249, s[20:23], s35 offen offset:1024 sc1
 buffer_load_dwordx4 v[104:107], v249, s[20:23], s36 offen offset:0 sc1
 buffer_load_dwordx4 v[108:111], v249, s[20:23], s36 offen offset:1024 sc1
 s_mov_b32 s49, s44
 s_mov_b32 s45, 0
 s_waitcnt vmcnt(32)
 ds_read_b64_tr_b16 v[144:145], v14 offset:0
 ds_read_b64_tr_b16 v[146:147], v14 offset:1024
 ds_read_b64_tr_b16 v[148:149], v14 offset:32768
 ds_read_b64_tr_b16 v[150:151], v14 offset:33792
 ds_read_b64_tr_b16 v[152:153], v14 offset:8
 ds_read_b64_tr_b16 v[154:155], v14 offset:1032
 ds_read_b64_tr_b16 v[156:157], v14 offset:32776
 ds_read_b64_tr_b16 v[158:159], v14 offset:33800
 ds_read_b64_tr_b16 v[160:161], v15 offset:0
 ds_read_b64_tr_b16 v[162:163], v15 offset:1024
 ds_read_b64_tr_b16 v[164:165], v15 offset:32768
 ds_read_b64_tr_b16 v[166:167], v15 offset:33792
 ds_read_b64_tr_b16 v[168:169], v15 offset:8
 ds_read_b64_tr_b16 v[170:171], v15 offset:1032
 ds_read_b64_tr_b16 v[172:173], v15 offset:32776
 ds_read_b64_tr_b16 v[174:175], v15 offset:33800
 s_waitcnt vmcnt(24)
 s_mov_b32 s8, s12
 s_mov_b32 s9, s13
 s_mov_b32 s10, s14
 s_lshl_b32 s55, s47, 18
 s_add_u32 s34, s41, s55
 s_add_u32 s42, s43, s55
 buffer_load_dword v13, v1, s[20:23], s49 offen sc1
 s_waitcnt lgkmcnt(12)
 v_mfma_f32_16x16x32_bf16 a[0:3], v[144:147], v[16:19], 0
 s_mov_b32 s37, s35
 s_mov_b32 s38, s36
 v_mfma_f32_16x16x32_bf16 a[0:3], v[148:151], v[24:27], a[0:3]
 buffer_load_dwordx4 v[112:115], v250, s[20:23], s37 offen offset:0 sc1
 v_mfma_f32_16x16x32_bf16 a[32:35], v[144:147], v[20:23], 0
 ds_read_b64_tr_b16 v[176:177], v14 offset:4096
 v_mfma_f32_16x16x32_bf16 a[32:35], v[148:151], v[28:31], a[32:35]
 s_waitcnt lgkmcnt(9)
 v_mfma_f32_16x16x32_bf16 a[36:39], v[152:155], v[20:23], 0
 buffer_load_dwordx4 v[116:119], v250, s[20:23], s37 offen offset:1024 sc1
 v_mfma_f32_16x16x32_bf16 a[36:39], v[156:159], v[28:31], a[36:39]
 ds_read_b64_tr_b16 v[178:179], v14 offset:5120
 v_mfma_f32_16x16x32_bf16 a[4:7], v[152:155], v[16:19], 0
 v_mfma_f32_16x16x32_bf16 a[4:7], v[156:159], v[24:27], a[4:7]
 s_waitcnt lgkmcnt(6)
 v_mfma_f32_16x16x32_bf16 a[8:11], v[160:163], v[16:19], 0
 buffer_load_dwordx4 v[120:123], v250, s[20:23], s38 offen offset:0 sc1
 v_mfma_f32_16x16x32_bf16 a[8:11], v[164:167], v[24:27], a[8:11]
 ds_read_b64_tr_b16 v[180:181], v14 offset:36864
 v_mfma_f32_16x16x32_bf16 a[40:43], v[160:163], v[20:23], 0
 v_mfma_f32_16x16x32_bf16 a[40:43], v[164:167], v[28:31], a[40:43]
 s_waitcnt lgkmcnt(3)
 v_mfma_f32_16x16x32_bf16 a[44:47], v[168:171], v[20:23], 0
 ds_read_b64_tr_b16 v[182:183], v14 offset:37888
 v_mfma_f32_16x16x32_bf16 a[44:47], v[172:175], v[28:31], a[44:47]
 buffer_load_dwordx4 v[124:127], v250, s[20:23], s38 offen offset:1024 sc1
 v_mfma_f32_16x16x32_bf16 a[12:15], v[168:171], v[16:19], 0
 v_mfma_f32_16x16x32_bf16 a[12:15], v[172:175], v[24:27], a[12:15]
 v_mfma_f32_16x16x32_bf16 a[108:111], v[168:171], v[36:39], 0
 ds_read_b64_tr_b16 v[184:185], v14 offset:4104
 v_mfma_f32_16x16x32_bf16 a[108:111], v[172:175], v[44:47], a[108:111]
 v_mfma_f32_16x16x32_bf16 a[76:79], v[168:171], v[32:35], 0
 buffer_load_dwordx4 v[128:131], v251, s[20:23], s37 offen offset:0 sc1
 v_mfma_f32_16x16x32_bf16 a[76:79], v[172:175], v[40:43], a[76:79]
 ds_read_b64_tr_b16 v[186:187], v14 offset:5128
 v_mfma_f32_16x16x32_bf16 a[72:75], v[160:163], v[32:35], 0
 v_mfma_f32_16x16x32_bf16 a[72:75], v[164:167], v[40:43], a[72:75]
 buffer_load_dwordx4 v[132:135], v251, s[20:23], s37 offen offset:1024 sc1
 v_mfma_f32_16x16x32_bf16 a[104:107], v[160:163], v[36:39], 0
 v_mfma_f32_16x16x32_bf16 a[104:107], v[164:167], v[44:47], a[104:107]
 ds_read_b64_tr_b16 v[188:189], v14 offset:36872
 v_mfma_f32_16x16x32_bf16 a[100:103], v[152:155], v[36:39], 0
 v_mfma_f32_16x16x32_bf16 a[100:103], v[156:159], v[44:47], a[100:103]
 buffer_load_dwordx4 v[136:139], v251, s[20:23], s38 offen offset:0 sc1
 v_mfma_f32_16x16x32_bf16 a[68:71], v[152:155], v[32:35], 0
 ds_read_b64_tr_b16 v[190:191], v14 offset:37896
 v_mfma_f32_16x16x32_bf16 a[68:71], v[156:159], v[40:43], a[68:71]
 v_mfma_f32_16x16x32_bf16 a[64:67], v[144:147], v[32:35], 0
 v_mfma_f32_16x16x32_bf16 a[64:67], v[148:151], v[40:43], a[64:67]
 buffer_load_dwordx4 v[140:143], v251, s[20:23], s38 offen offset:1024 sc1
 v_mfma_f32_16x16x32_bf16 a[96:99], v[144:147], v[36:39], 0
 ds_read_b64_tr_b16 v[192:193], v15 offset:4096
 v_mfma_f32_16x16x32_bf16 a[96:99], v[148:151], v[44:47], a[96:99]
 s_waitcnt vmcnt(25)
 v_mfma_f32_16x16x32_bf16 a[128:131], v[144:147], v[48:51], 0
 v_mfma_f32_16x16x32_bf16 a[128:131], v[148:151], v[56:59], a[128:131]
 ds_read_b64_tr_b16 v[194:195], v15 offset:5120
 v_mfma_f32_16x16x32_bf16 a[160:163], v[144:147], v[52:55], 0
 s_add_u32 m0, s84, 0
 v_mfma_f32_16x16x32_bf16 a[160:163], v[148:151], v[60:63], a[160:163]
 buffer_load_dwordx4 v252, s[8:11], s34 offen offset:0 lds
 v_mfma_f32_16x16x32_bf16 a[164:167], v[152:155], v[52:55], 0
 v_mfma_f32_16x16x32_bf16 a[164:167], v[156:159], v[60:63], a[164:167]
 ds_read_b64_tr_b16 v[196:197], v15 offset:36864
 v_mfma_f32_16x16x32_bf16 a[132:135], v[152:155], v[48:51], 0
 buffer_load_dwordx4 v253, s[8:11], s34 offen offset:1024 lds
 v_mfma_f32_16x16x32_bf16 a[132:135], v[156:159], v[56:59], a[132:135]
 v_mfma_f32_16x16x32_bf16 a[136:139], v[160:163], v[48:51], 0
 ds_read_b64_tr_b16 v[198:199], v15 offset:37888
 v_mfma_f32_16x16x32_bf16 a[136:139], v[164:167], v[56:59], a[136:139]
 v_mfma_f32_16x16x32_bf16 a[168:171], v[160:163], v[52:55], 0
 buffer_load_dwordx4 v254, s[8:11], s34 offen offset:2048 lds
 v_mfma_f32_16x16x32_bf16 a[168:171], v[164:167], v[60:63], a[168:171]
 v_mfma_f32_16x16x32_bf16 a[172:175], v[168:171], v[52:55], 0
 ds_read_b64_tr_b16 v[200:201], v15 offset:4104
 v_mfma_f32_16x16x32_bf16 a[172:175], v[172:175], v[60:63], a[172:175]
 v_mfma_f32_16x16x32_bf16 a[140:143], v[168:171], v[48:51], 0
 buffer_load_dwordx4 v255, s[8:11], s34 offen offset:3072 lds
 v_mfma_f32_16x16x32_bf16 a[140:143], v[172:175], v[56:59], a[140:143]
 ds_read_b64_tr_b16 v[202:203], v15 offset:5128
 v_mfma_f32_16x16x32_bf16 a[236:239], v[168:171], v[68:71], 0
 s_add_u32 s34, s34, 0x10000
 v_mfma_f32_16x16x32_bf16 a[236:239], v[172:175], v[76:79], a[236:239]
 s_add_u32 m0, s85, 0
 v_mfma_f32_16x16x32_bf16 a[204:207], v[168:171], v[64:67], 0
 buffer_load_dwordx4 v252, s[8:11], s34 offen offset:0 lds
 v_mfma_f32_16x16x32_bf16 a[204:207], v[172:175], v[72:75], a[204:207]
 ds_read_b64_tr_b16 v[204:205], v15 offset:36872
 v_mfma_f32_16x16x32_bf16 a[200:203], v[160:163], v[64:67], 0
 v_mfma_f32_16x16x32_bf16 a[200:203], v[164:167], v[72:75], a[200:203]
 buffer_load_dwordx4 v253, s[8:11], s34 offen offset:1024 lds
 v_mfma_f32_16x16x32_bf16 a[232:235], v[160:163], v[68:71], 0
 ds_read_b64_tr_b16 v[206:207], v15 offset:37896
 v_mfma_f32_16x16x32_bf16 a[232:235], v[164:167], v[76:79], a[232:235]
 v_mfma_f32_16x16x32_bf16 a[228:231], v[152:155], v[68:71], 0
 v_mfma_f32_16x16x32_bf16 a[228:231], v[156:159], v[76:79], a[228:231]
 buffer_load_dwordx4 v254, s[8:11], s34 offen offset:2048 lds
 v_mfma_f32_16x16x32_bf16 a[196:199], v[152:155], v[64:67], 0
 v_mfma_f32_16x16x32_bf16 a[196:199], v[156:159], v[72:75], a[196:199]
 v_mfma_f32_16x16x32_bf16 a[192:195], v[144:147], v[64:67], 0
 buffer_load_dwordx4 v255, s[8:11], s34 offen offset:3072 lds
 v_mfma_f32_16x16x32_bf16 a[192:195], v[148:151], v[72:75], a[192:195]
 s_add_u32 s34, s34, 0x10000
 v_mfma_f32_16x16x32_bf16 a[224:227], v[144:147], v[68:71], 0
 v_mfma_f32_16x16x32_bf16 a[224:227], v[148:151], v[76:79], a[224:227]
 s_waitcnt vmcnt(16)
 s_barrier
 v_mov_b32 v3, 0x40000000
 v_writelane_b32 v3, s33, 0
 v_mov_b32 v4, s89
 s_mov_b32 s66, 0x3b28000
 buffer_store_dword v4, v3, s[20:23], s66 offen sc1
 s_waitcnt lgkmcnt(0)
 v_mfma_f32_16x16x32_bf16 a[16:19], v[176:179], v[16:19], 0
 s_add_u32 m0, s84, 4096
 v_mfma_f32_16x16x32_bf16 a[16:19], v[180:183], v[24:27], a[16:19]
 buffer_load_dwordx4 v252, s[8:11], s42 offen offset:0 lds
 v_mfma_f32_16x16x32_bf16 a[48:51], v[176:179], v[20:23], 0
 ds_read_b64_tr_b16 v[144:145], v240 offset:0
 v_mfma_f32_16x16x32_bf16 a[48:51], v[180:183], v[28:31], a[48:51]
 v_mfma_f32_16x16x32_bf16 a[52:55], v[184:187], v[20:23], 0
 buffer_load_dwordx4 v253, s[8:11], s42 offen offset:1024 lds
 v_mfma_f32_16x16x32_bf16 a[52:55], v[188:191], v[28:31], a[52:55]
 ds_read_b64_tr_b16 v[146:147], v240 offset:1024
 v_mfma_f32_16x16x32_bf16 a[20:23], v[184:187], v[16:19], 0
 v_mfma_f32_16x16x32_bf16 a[20:23], v[188:191], v[24:27], a[20:23]
 v_mfma_f32_16x16x32_bf16 a[24:27], v[192:195], v[16:19], 0
 buffer_load_dwordx4 v254, s[8:11], s42 offen offset:2048 lds
 v_mfma_f32_16x16x32_bf16 a[24:27], v[196:199], v[24:27], a[24:27]
 ds_read_b64_tr_b16 v[148:149], v242 offset:0
 v_mfma_f32_16x16x32_bf16 a[56:59], v[192:195], v[20:23], 0
 v_mfma_f32_16x16x32_bf16 a[56:59], v[196:199], v[28:31], a[56:59]
 v_mfma_f32_16x16x32_bf16 a[60:63], v[200:203], v[20:23], 0
 ds_read_b64_tr_b16 v[150:151], v242 offset:1024
 v_mfma_f32_16x16x32_bf16 a[60:63], v[204:207], v[28:31], a[60:63]
 buffer_load_dwordx4 v255, s[8:11], s42 offen offset:3072 lds
 v_mfma_f32_16x16x32_bf16 a[28:31], v[200:203], v[16:19], 0
 v_mfma_f32_16x16x32_bf16 a[28:31], v[204:207], v[24:27], a[28:31]
 v_mfma_f32_16x16x32_bf16 a[124:127], v[200:203], v[36:39], 0
 ds_read_b64_tr_b16 v[152:153], v240 offset:8
 s_add_u32 s42, s42, 0x10000
 v_mfma_f32_16x16x32_bf16 a[124:127], v[204:207], v[44:47], a[124:127]
 s_add_u32 m0, s85, 4096
 v_mfma_f32_16x16x32_bf16 a[92:95], v[200:203], v[32:35], 0
 buffer_load_dwordx4 v252, s[8:11], s42 offen offset:0 lds
 v_mfma_f32_16x16x32_bf16 a[92:95], v[204:207], v[40:43], a[92:95]
 ds_read_b64_tr_b16 v[154:155], v240 offset:1032
 v_mfma_f32_16x16x32_bf16 a[88:91], v[192:195], v[32:35], 0
 v_mfma_f32_16x16x32_bf16 a[88:91], v[196:199], v[40:43], a[88:91]
 buffer_load_dwordx4 v253, s[8:11], s42 offen offset:1024 lds
 v_mfma_f32_16x16x32_bf16 a[120:123], v[192:195], v[36:39], 0
 v_mfma_f32_16x16x32_bf16 a[120:123], v[196:199], v[44:47], a[120:123]
 ds_read_b64_tr_b16 v[156:157], v242 offset:8
 v_mfma_f32_16x16x32_bf16 a[116:119], v[184:187], v[36:39], 0
 v_mfma_f32_16x16x32_bf16 a[116:119], v[188:191], v[44:47], a[116:119]
 buffer_load_dwordx4 v254, s[8:11], s42 offen offset:2048 lds
 v_mfma_f32_16x16x32_bf16 a[84:87], v[184:187], v[32:35], 0
 ds_read_b64_tr_b16 v[158:159], v242 offset:1032
 v_mfma_f32_16x16x32_bf16 a[84:87], v[188:191], v[40:43], a[84:87]
 v_mfma_f32_16x16x32_bf16 a[80:83], v[176:179], v[32:35], 0
 v_mfma_f32_16x16x32_bf16 a[80:83], v[180:183], v[40:43], a[80:83]
 buffer_load_dwordx4 v255, s[8:11], s42 offen offset:3072 lds
 v_mfma_f32_16x16x32_bf16 a[112:115], v[176:179], v[36:39], 0
 ds_read_b64_tr_b16 v[160:161], v241 offset:0
 v_mfma_f32_16x16x32_bf16 a[112:115], v[180:183], v[44:47], a[112:115]
 s_waitcnt vmcnt(25)
 s_lshl_b32 s30, 1, s47
 s_and_b32 s30, s30, s28
 v_cmp_ne_u32 vcc, s89, v13
 s_nop 0
 s_and_b64 vcc, vcc, s[30:31]
 s_cbranch_vccnz K3_spin
K3_spin_b:
 s_lshl_b32 s55, s47, 15
 s_add_u32 s35, s40, s55
 s_add_u32 s47, s47, 1
 s_and_b32 s47, s47, 3
 v_mfma_f32_16x16x32_bf16 a[144:147], v[176:179], v[48:51], 0
 s_add_u32 s42, s42, 0x10000
 v_mfma_f32_16x16x32_bf16 a[144:147], v[180:183], v[56:59], a[144:147]
 ds_read_b64_tr_b16 v[162:163], v241 offset:1024
 s_add_u32 s35, s35, 0x4000
 v_mfma_f32_16x16x32_bf16 a[176:179], v[176:179], v[52:55], 0
 s_add_u32 s36, s35, 0x2000
 v_mfma_f32_16x16x32_bf16 a[176:179], v[180:183], v[60:63], a[176:179]
 buffer_load_dwordx4 v[16:19], v248, s[20:23], s35 offen offset:0 sc1
 v_mfma_f32_16x16x32_bf16 a[180:183], v[184:187], v[52:55], 0
 v_mfma_f32_16x16x32_bf16 a[180:183], v[188:191], v[60:63], a[180:183]
 ds_read_b64_tr_b16 v[164:165], v243 offset:0
 v_mfma_f32_16x16x32_bf16 a[148:151], v[184:187], v[48:51], 0
 buffer_load_dwordx4 v[20:23], v248, s[20:23], s35 offen offset:1024 sc1
 v_mfma_f32_16x16x32_bf16 a[148:151], v[188:191], v[56:59], a[148:151]
 v_mfma_f32_16x16x32_bf16 a[152:155], v[192:195], v[48:51], 0
 ds_read_b64_tr_b16 v[166:167], v243 offset:1024
 v_mfma_f32_16x16x32_bf16 a[152:155], v[196:199], v[56:59], a[152:155]
 v_mfma_f32_16x16x32_bf16 a[184:187], v[192:195], v[52:55], 0
 buffer_load_dwordx4 v[24:27], v248, s[20:23], s36 offen offset:0 sc1
 v_mfma_f32_16x16x32_bf16 a[184:187], v[196:199], v[60:63], a[184:187]
 v_mfma_f32_16x16x32_bf16 a[188:191], v[200:203], v[52:55], 0
 ds_read_b64_tr_b16 v[168:169], v241 offset:8
 v_mfma_f32_16x16x32_bf16 a[188:191], v[204:207], v[60:63], a[188:191]
 v_mfma_f32_16x16x32_bf16 a[156:159], v[200:203], v[48:51], 0
 buffer_load_dwordx4 v[28:31], v248, s[20:23], s36 offen offset:1024 sc1
 v_mfma_f32_16x16x32_bf16 a[156:159], v[204:207], v[56:59], a[156:159]
 ds_read_b64_tr_b16 v[170:171], v241 offset:1032
 v_mfma_f32_16x16x32_bf16 a[252:255], v[200:203], v[68:71], 0
 v_mfma_f32_16x16x32_bf16 a[252:255], v[204:207], v[76:79], a[252:255]
 v_mfma_f32_16x16x32_bf16 a[220:223], v[200:203], v[64:67], 0
 buffer_load_dwordx4 v[32:35], v249, s[20:23], s35 offen offset:0 sc1
 v_mfma_f32_16x16x32_bf16 a[220:223], v[204:207], v[72:75], a[220:223]
 ds_read_b64_tr_b16 v[172:173], v243 offset:8
 v_mfma_f32_16x16x32_bf16 a[216:219], v[192:195], v[64:67], 0
 v_mfma_f32_16x16x32_bf16 a[216:219], v[196:199], v[72:75], a[216:219]
 buffer_load_dwordx4 v[36:39], v249, s[20:23], s35 offen offset:1024 sc1
 v_mfma_f32_16x16x32_bf16 a[248:251], v[192:195], v[68:71], 0
 ds_read_b64_tr_b16 v[174:175], v243 offset:1032
 v_mfma_f32_16x16x32_bf16 a[248:251], v[196:199], v[76:79], a[248:251]
 v_mfma_f32_16x16x32_bf16 a[244:247], v[184:187], v[68:71], 0
 v_mfma_f32_16x16x32_bf16 a[244:247], v[188:191], v[76:79], a[244:247]
 buffer_load_dwordx4 v[40:43], v249, s[20:23], s36 offen offset:0 sc1
 v_mfma_f32_16x16x32_bf16 a[212:215], v[184:187], v[64:67], 0
 v_mfma_f32_16x16x32_bf16 a[212:215], v[188:191], v[72:75], a[212:215]
 v_mfma_f32_16x16x32_bf16 a[208:211], v[176:179], v[64:67], 0
 buffer_load_dwordx4 v[44:47], v249, s[20:23], s36 offen offset:1024 sc1
 v_mfma_f32_16x16x32_bf16 a[208:211], v[180:183], v[72:75], a[208:211]
 v_mfma_f32_16x16x32_bf16 a[240:243], v[176:179], v[68:71], 0
 v_mfma_f32_16x16x32_bf16 a[240:243], v[180:183], v[76:79], a[240:243]
 s_waitcnt vmcnt(32)
 s_waitcnt lgkmcnt(12)
 v_mfma_f32_16x16x32_bf16 a[0:3], v[144:147], v[80:83], a[0:3]
 s_mov_b32 s37, s35
 s_mov_b32 s38, s36
 v_mfma_f32_16x16x32_bf16 a[0:3], v[148:151], v[88:91], a[0:3]
 buffer_load_dwordx4 v[48:51], v250, s[20:23], s37 offen offset:0 sc1
 v_mfma_f32_16x16x32_bf16 a[32:35], v[144:147], v[84:87], a[32:35]
 ds_read_b64_tr_b16 v[176:177], v240 offset:4096
 v_mfma_f32_16x16x32_bf16 a[32:35], v[148:151], v[92:95], a[32:35]
 s_waitcnt lgkmcnt(9)
 v_mfma_f32_16x16x32_bf16 a[36:39], v[152:155], v[84:87], a[36:39]
 buffer_load_dwordx4 v[52:55], v250, s[20:23], s37 offen offset:1024 sc1
 v_mfma_f32_16x16x32_bf16 a[36:39], v[156:159], v[92:95], a[36:39]
 ds_read_b64_tr_b16 v[178:179], v240 offset:5120
 v_mfma_f32_16x16x32_bf16 a[4:7], v[152:155], v[80:83], a[4:7]
 v_mfma_f32_16x16x32_bf16 a[4:7], v[156:159], v[88:91], a[4:7]
 s_waitcnt lgkmcnt(6)
 v_mfma_f32_16x16x32_bf16 a[8:11], v[160:163], v[80:83], a[8:11]
 buffer_load_dwordx4 v[56:59], v250, s[20:23], s38 offen offset:0 sc1
 v_mfma_f32_16x16x32_bf16 a[8:11], v[164:167], v[88:91], a[8:11]
 ds_read_b64_tr_b16 v[180:181], v242 offset:4096
 v_mfma_f32_16x16x32_bf16 a[40:43], v[160:163], v[84:87], a[40:43]
 v_mfma_f32_16x16x32_bf16 a[40:43], v[164:167], v[92:95], a[40:43]
 s_waitcnt lgkmcnt(3)
 v_mfma_f32_16x16x32_bf16 a[44:47], v[168:171], v[84:87], a[44:47]
 ds_read_b64_tr_b16 v[182:183], v242 offset:5120
 v_mfma_f32_16x16x32_bf16 a[44:47], v[172:175], v[92:95], a[44:47]
 buffer_load_dwordx4 v[60:63], v250, s[20:23], s38 offen offset:1024 sc1
 v_mfma_f32_16x16x32_bf16 a[12:15], v[168:171], v[80:83], a[12:15]
 v_mfma_f32_16x16x32_bf16 a[12:15], v[172:175], v[88:91], a[12:15]
 v_mfma_f32_16x16x32_bf16 a[108:111], v[168:171], v[100:103], a[108:111]
 ds_read_b64_tr_b16 v[184:185], v240 offset:4104
 v_mfma_f32_16x16x32_bf16 a[108:111], v[172:175], v[108:111], a[108:111]
 v_mfma_f32_16x16x32_bf16 a[76:79], v[168:171], v[96:99], a[76:79]
 buffer_load_dwordx4 v[64:67], v251, s[20:23], s37 offen offset:0 sc1
 v_mfma_f32_16x16x32_bf16 a[76:79], v[172:175], v[104:107], a[76:79]
 ds_read_b64_tr_b16 v[186:187], v240 offset:5128
 v_mfma_f32_16x16x32_bf16 a[72:75], v[160:163], v[96:99], a[72:75]
 v_mfma_f32_16x16x32_bf16 a[72:75], v[164:167], v[104:107], a[72:75]
 buffer_load_dwordx4 v[68:71], v251, s[20:23], s37 offen offset:1024 sc1
 v_mfma_f32_16x16x32_bf16 a[104:107], v[160:163], v[100:103], a[104:107]
 v_mfma_f32_16x16x32_bf16 a[104:107], v[164:167], v[108:111], a[104:107]
 ds_read_b64_tr_b16 v[188:189], v242 offset:4104
 v_mfma_f32_16x16x32_bf16 a[100:103], v[152:155], v[100:103], a[100:103]
 v_mfma_f32_16x16x32_bf16 a[100:103], v[156:159], v[108:111], a[100:103]
 buffer_load_dwordx4 v[72:75], v251, s[20:23], s38 offen offset:0 sc1
 v_mfma_f32_16x16x32_bf16 a[68:71], v[152:155], v[96:99], a[68:71]
 ds_read_b64_tr_b16 v[190:191], v242 offset:5128
 v_mfma_f32_16x16x32_bf16 a[68:71], v[156:159], v[104:107], a[68:71]
 v_mfma_f32_16x16x32_bf16 a[64:67], v[144:147], v[96:99], a[64:67]
 v_mfma_f32_16x16x32_bf16 a[64:67], v[148:151], v[104:107], a[64:67]
 buffer_load_dwordx4 v[76:79], v251, s[20:23], s38 offen offset:1024 sc1
 v_mfma_f32_16x16x32_bf16 a[96:99], v[144:147], v[100:103], a[96:99]
 ds_read_b64_tr_b16 v[192:193], v241 offset:4096
 v_mfma_f32_16x16x32_bf16 a[96:99], v[148:151], v[108:111], a[96:99]
 s_waitcnt vmcnt(32)
 v_mfma_f32_16x16x32_bf16 a[128:131], v[144:147], v[112:115], a[128:131]
 v_mfma_f32_16x16x32_bf16 a[128:131], v[148:151], v[120:123], a[128:131]
 ds_read_b64_tr_b16 v[194:195], v241 offset:5120
 s_sub_u32 s34, s34, s98
 v_mfma_f32_16x16x32_bf16 a[160:163], v[144:147], v[116:119], a[160:163]
 s_add_u32 m0, s86, 0
 v_mfma_f32_16x16x32_bf16 a[160:163], v[148:151], v[124:127], a[160:163]
 buffer_load_dwordx4 v252, s[8:11], s34 offen offset:0 lds
 v_mfma_f32_16x16x32_bf16 a[164:167], v[152:155], v[116:119], a[164:167]
 v_mfma_f32_16x16x32_bf16 a[164:167], v[156:159], v[124:127], a[164:167]
 ds_read_b64_tr_b16 v[196:197], v243 offset:4096
 v_mfma_f32_16x16x32_bf16 a[132:135], v[152:155], v[112:115], a[132:135]
 buffer_load_dwordx4 v253, s[8:11], s34 offen offset:1024 lds
 v_mfma_f32_16x16x32_bf16 a[132:135], v[156:159], v[120:123], a[132:135]
 v_mfma_f32_16x16x32_bf16 a[136:139], v[160:163], v[112:115], a[136:139]
 ds_read_b64_tr_b16 v[198:199], v243 offset:5120
 v_mfma_f32_16x16x32_bf16 a[136:139], v[164:167], v[120:123], a[136:139]
 v_mfma_f32_16x16x32_bf16 a[168:171], v[160:163], v[116:119], a[168:171]
 buffer_load_dwordx4 v254, s[8:11], s34 offen offset:2048 lds
 v_mfma_f32_16x16x32_bf16 a[168:171], v[164:167], v[124:127], a[168:171]
 v_mfma_f32_16x16x32_bf16 a[172:175], v[168:171], v[116:119], a[172:175]
 ds_read_b64_tr_b16 v[200:201], v241 offset:4104
 v_mfma_f32_16x16x32_bf16 a[172:175], v[172:175], v[124:127], a[172:175]
 v_mfma_f32_16x16x32_bf16 a[140:143], v[168:171], v[112:115], a[140:143]
 buffer_load_dwordx4 v255, s[8:11], s34 offen offset:3072 lds
 v_mfma_f32_16x16x32_bf16 a[140:143], v[172:175], v[120:123], a[140:143]
 ds_read_b64_tr_b16 v[202:203], v241 offset:5128
 v_mfma_f32_16x16x32_bf16 a[236:239], v[168:171], v[132:135], a[236:239]
 s_add_u32 s34, s34, 0x10000
 v_mfma_f32_16x16x32_bf16 a[236:239], v[172:175], v[140:143], a[236:239]
 s_add_u32 m0, s87, 0
 v_mfma_f32_16x16x32_bf16 a[204:207], v[168:171], v[128:131], a[204:207]
 buffer_load_dwordx4 v252, s[8:11], s34 offen offset:0 lds
 v_mfma_f32_16x16x32_bf16 a[204:207], v[172:175], v[136:139], a[204:207]
 ds_read_b64_tr_b16 v[204:205], v243 offset:4104
 v_mfma_f32_16x16x32_bf16 a[200:203], v[160:163], v[128:131], a[200:203]
 v_mfma_f32_16x16x32_bf16 a[200:203], v[164:167], v[136:139], a[200:203]
 buffer_load_dwordx4 v253, s[8:11], s34 offen offset:1024 lds
 v_mfma_f32_16x16x32_bf16 a[232:235], v[160:163], v[132:135], a[232:235]
 ds_read_b64_tr_b16 v[206:207], v243 offset:5128
 v_mfma_f32_16x16x32_bf16 a[232:235], v[164:167], v[140:143], a[232:235]
 v_mfma_f32_16x16x32_bf16 a[228:231], v[152:155], v[132:135], a[228:231]
 v_mfma_f32_16x16x32_bf16 a[228:231], v[156:159], v[140:143], a[228:231]
 buffer_load_dwordx4 v254, s[8:11], s34 offen offset:2048 lds
 v_mfma_f32_16x16x32_bf16 a[196:199], v[152:155], v[128:131], a[196:199]
 v_mfma_f32_16x16x32_bf16 a[196:199], v[156:159], v[136:139], a[196:199]
 v_mfma_f32_16x16x32_bf16 a[192:195], v[144:147], v[128:131], a[192:195]
 buffer_load_dwordx4 v255, s[8:11], s34 offen offset:3072 lds
 v_mfma_f32_16x16x32_bf16 a[192:195], v[148:151], v[136:139], a[192:195]
 s_add_u32 s34, s34, 0x10000
 v_mfma_f32_16x16x32_bf16 a[224:227], v[144:147], v[132:135], a[224:227]
 v_mfma_f32_16x16x32_bf16 a[224:227], v[148:151], v[140:143], a[224:227]
 s_waitcnt vmcnt(32)
 s_waitcnt lgkmcnt(0)
 v_mfma_f32_16x16x32_bf16 a[16:19], v[176:179], v[80:83], a[16:19]
 s_sub_u32 s42, s42, s98
 s_add_u32 m0, s86, 4096
 v_mfma_f32_16x16x32_bf16 a[16:19], v[180:183], v[88:91], a[16:19]
 buffer_load_dwordx4 v252, s[8:11], s42 offen offset:0 lds
 v_mfma_f32_16x16x32_bf16 a[48:51], v[176:179], v[84:87], a[48:51]
 ds_read_b64_tr_b16 v[144:145], v14 offset:0
 v_mfma_f32_16x16x32_bf16 a[48:51], v[180:183], v[92:95], a[48:51]
 v_mfma_f32_16x16x32_bf16 a[52:55], v[184:187], v[84:87], a[52:55]
 buffer_load_dwordx4 v253, s[8:11], s42 offen offset:1024 lds
 v_mfma_f32_16x16x32_bf16 a[52:55], v[188:191], v[92:95], a[52:55]
 ds_read_b64_tr_b16 v[146:147], v14 offset:1024
 v_mfma_f32_16x16x32_bf16 a[20:23], v[184:187], v[80:83], a[20:23]
 v_mfma_f32_16x16x32_bf16 a[20:23], v[188:191], v[88:91], a[20:23]
 v_mfma_f32_16x16x32_bf16 a[24:27], v[192:195], v[80:83], a[24:27]
 buffer_load_dwordx4 v254, s[8:11], s42 offen offset:2048 lds
 v_mfma_f32_16x16x32_bf16 a[24:27], v[196:199], v[88:91], a[24:27]
 ds_read_b64_tr_b16 v[148:149], v14 offset:32768
 v_mfma_f32_16x16x32_bf16 a[56:59], v[192:195], v[84:87], a[56:59]
 v_mfma_f32_16x16x32_bf16 a[56:59], v[196:199], v[92:95], a[56:59]
 v_mfma_f32_16x16x32_bf16 a[60:63], v[200:203], v[84:87], a[60:63]
 ds_read_b64_tr_b16 v[150:151], v14 offset:33792
 v_mfma_f32_16x16x32_bf16 a[60:63], v[204:207], v[92:95], a[60:63]
 buffer_load_dwordx4 v255, s[8:11], s42 offen offset:3072 lds
 v_mfma_f32_16x16x32_bf16 a[28:31], v[200:203], v[80:83], a[28:31]
 v_mfma_f32_16x16x32_bf16 a[28:31], v[204:207], v[88:91], a[28:31]
 v_mfma_f32_16x16x32_bf16 a[124:127], v[200:203], v[100:103], a[124:127]
 ds_read_b64_tr_b16 v[152:153], v14 offset:8
 s_add_u32 s42, s42, 0x10000
 v_mfma_f32_16x16x32_bf16 a[124:127], v[204:207], v[108:111], a[124:127]
 s_add_u32 m0, s87, 4096
 v_mfma_f32_16x16x32_bf16 a[92:95], v[200:203], v[96:99], a[92:95]
 buffer_load_dwordx4 v252, s[8:11], s42 offen offset:0 lds
 v_mfma_f32_16x16x32_bf16 a[92:95], v[204:207], v[104:107], a[92:95]
 ds_read_b64_tr_b16 v[154:155], v14 offset:1032
 v_mfma_f32_16x16x32_bf16 a[88:91], v[192:195], v[96:99], a[88:91]
 v_mfma_f32_16x16x32_bf16 a[88:91], v[196:199], v[104:107], a[88:91]
 buffer_load_dwordx4 v253, s[8:11], s42 offen offset:1024 lds
 v_mfma_f32_16x16x32_bf16 a[120:123], v[192:195], v[100:103], a[120:123]
 v_mfma_f32_16x16x32_bf16 a[120:123], v[196:199], v[108:111], a[120:123]
 ds_read_b64_tr_b16 v[156:157], v14 offset:32776
 v_mfma_f32_16x16x32_bf16 a[116:119], v[184:187], v[100:103], a[116:119]
 v_mfma_f32_16x16x32_bf16 a[116:119], v[188:191], v[108:111], a[116:119]
 buffer_load_dwordx4 v254, s[8:11], s42 offen offset:2048 lds
 v_mfma_f32_16x16x32_bf16 a[84:87], v[184:187], v[96:99], a[84:87]
 ds_read_b64_tr_b16 v[158:159], v14 offset:33800
 v_mfma_f32_16x16x32_bf16 a[84:87], v[188:191], v[104:107], a[84:87]
 v_mfma_f32_16x16x32_bf16 a[80:83], v[176:179], v[96:99], a[80:83]
 v_mfma_f32_16x16x32_bf16 a[80:83], v[180:183], v[104:107], a[80:83]
 buffer_load_dwordx4 v255, s[8:11], s42 offen offset:3072 lds
 v_mfma_f32_16x16x32_bf16 a[112:115], v[176:179], v[100:103], a[112:115]
 ds_read_b64_tr_b16 v[160:161], v15 offset:0
 v_mfma_f32_16x16x32_bf16 a[112:115], v[180:183], v[108:111], a[112:115]
 v_mfma_f32_16x16x32_bf16 a[144:147], v[176:179], v[112:115], a[144:147]
 s_add_u32 s42, s42, 0x10000
 v_mfma_f32_16x16x32_bf16 a[144:147], v[180:183], v[120:123], a[144:147]
 ds_read_b64_tr_b16 v[162:163], v15 offset:1024
 s_add_u32 s35, s35, s99
 v_mfma_f32_16x16x32_bf16 a[176:179], v[176:179], v[116:119], a[176:179]
 s_add_u32 s36, s35, 0x2000
 v_mfma_f32_16x16x32_bf16 a[176:179], v[180:183], v[124:127], a[176:179]
 buffer_load_dwordx4 v[80:83], v248, s[20:23], s35 offen offset:0 sc1
 v_mfma_f32_16x16x32_bf16 a[180:183], v[184:187], v[116:119], a[180:183]
 v_mfma_f32_16x16x32_bf16 a[180:183], v[188:191], v[124:127], a[180:183]
 ds_read_b64_tr_b16 v[164:165], v15 offset:32768
 v_mfma_f32_16x16x32_bf16 a[148:151], v[184:187], v[112:115], a[148:151]
 buffer_load_dwordx4 v[84:87], v248, s[20:23], s35 offen offset:1024 sc1
 v_mfma_f32_16x16x32_bf16 a[148:151], v[188:191], v[120:123], a[148:151]
 v_mfma_f32_16x16x32_bf16 a[152:155], v[192:195], v[112:115], a[152:155]
 ds_read_b64_tr_b16 v[166:167], v15 offset:33792
 v_mfma_f32_16x16x32_bf16 a[152:155], v[196:199], v[120:123], a[152:155]
 v_mfma_f32_16x16x32_bf16 a[184:187], v[192:195], v[116:119], a[184:187]
 buffer_load_dwordx4 v[88:91], v248, s[20:23], s36 offen offset:0 sc1
 v_mfma_f32_16x16x32_bf16 a[184:187], v[196:199], v[124:127], a[184:187]
 v_mfma_f32_16x16x32_bf16 a[188:191], v[200:203], v[116:119], a[188:191]
 ds_read_b64_tr_b16 v[168:169], v15 offset:8
 v_mfma_f32_16x16x32_bf16 a[188:191], v[204:207], v[124:127], a[188:191]
 v_mfma_f32_16x16x32_bf16 a[156:159], v[200:203], v[112:115], a[156:159]
 buffer_load_dwordx4 v[92:95], v248, s[20:23], s36 offen offset:1024 sc1
 v_mfma_f32_16x16x32_bf16 a[156:159], v[204:207], v[120:123], a[156:159]
 ds_read_b64_tr_b16 v[170:171], v15 offset:1032
 v_mfma_f32_16x16x32_bf16 a[252:255], v[200:203], v[132:135], a[252:255]
 v_mfma_f32_16x16x32_bf16 a[252:255], v[204:207], v[140:143], a[252:255]
 v_mfma_f32_16x16x32_bf16 a[220:223], v[200:203], v[128:131], a[220:223]
 buffer_load_dwordx4 v[96:99], v249, s[20:23], s35 offen offset:0 sc1
 v_mfma_f32_16x16x32_bf16 a[220:223], v[204:207], v[136:139], a[220:223]
 ds_read_b64_tr_b16 v[172:173], v15 offset:32776
 v_mfma_f32_16x16x32_bf16 a[216:219], v[192:195], v[128:131], a[216:219]
 v_mfma_f32_16x16x32_bf16 a[216:219], v[196:199], v[136:139], a[216:219]
 buffer_load_dwordx4 v[100:103], v249, s[20:23], s35 offen offset:1024 sc1
 v_mfma_f32_16x16x32_bf16 a[248:251], v[192:195], v[132:135], a[248:251]
 ds_read_b64_tr_b16 v[174:175], v15 offset:33800
 v_mfma_f32_16x16x32_bf16 a[248:251], v[196:199], v[140:143], a[248:251]
 v_mfma_f32_16x16x32_bf16 a[244:247], v[184:187], v[132:135], a[244:247]
 v_mfma_f32_16x16x32_bf16 a[244:247], v[188:191], v[140:143], a[244:247]
 buffer_load_dwordx4 v[104:107], v249, s[20:23], s36 offen offset:0 sc1
 v_mfma_f32_16x16x32_bf16 a[212:215], v[184:187], v[128:131], a[212:215]
 v_mfma_f32_16x16x32_bf16 a[212:215], v[188:191], v[136:139], a[212:215]
 v_mfma_f32_16x16x32_bf16 a[208:211], v[176:179], v[128:131], a[208:211]
 buffer_load_dwordx4 v[108:111], v249, s[20:23], s36 offen offset:1024 sc1
 v_mfma_f32_16x16x32_bf16 a[208:211], v[180:183], v[136:139], a[208:211]
 v_mfma_f32_16x16x32_bf16 a[240:243], v[176:179], v[132:135], a[240:243]
 v_mfma_f32_16x16x32_bf16 a[240:243], v[180:183], v[140:143], a[240:243]
 s_lshr_b32 s45, s2, 3
 v_min_u32 v12, 3, v2
 v_mad_u32_u24 v12, s45, 4, v12
 v_lshlrev_b32 v12, 7, v12
 v_add_u32 v12, K3_last-F_pc, v12
 s_mov_b32 s45, 1
K3_loop:
 s_waitcnt vmcnt(32)
 s_lshl_b32 s55, s47, 18
 s_add_u32 s34, s41, s55
 s_add_u32 s42, s43, s55
 buffer_load_dword v13, v1, s[20:23], s49 offen sc1
 s_waitcnt lgkmcnt(12)
 v_mfma_f32_16x16x32_bf16 a[0:3], v[144:147], v[16:19], a[0:3]
 s_mov_b32 s37, s35
 s_mov_b32 s38, s36
 v_mfma_f32_16x16x32_bf16 a[0:3], v[148:151], v[24:27], a[0:3]
 buffer_load_dwordx4 v[112:115], v250, s[20:23], s37 offen offset:0 sc1
 v_mfma_f32_16x16x32_bf16 a[32:35], v[144:147], v[20:23], a[32:35]
 ds_read_b64_tr_b16 v[176:177], v14 offset:4096
 v_mfma_f32_16x16x32_bf16 a[32:35], v[148:151], v[28:31], a[32:35]
 s_waitcnt lgkmcnt(9)
 v_mfma_f32_16x16x32_bf16 a[36:39], v[152:155], v[20:23], a[36:39]
 buffer_load_dwordx4 v[116:119], v250, s[20:23], s37 offen offset:1024 sc1
 v_mfma_f32_16x16x32_bf16 a[36:39], v[156:159], v[28:31], a[36:39]
 ds_read_b64_tr_b16 v[178:179], v14 offset:5120
 v_mfma_f32_16x16x32_bf16 a[4:7], v[152:155], v[16:19], a[4:7]
 v_mfma_f32_16x16x32_bf16 a[4:7], v[156:159], v[24:27], a[4:7]
 s_waitcnt lgkmcnt(6)
 v_mfma_f32_16x16x32_bf16 a[8:11], v[160:163], v[16:19], a[8:11]
 buffer_load_dwordx4 v[120:123], v250, s[20:23], s38 offen offset:0 sc1
 v_mfma_f32_16x16x32_bf16 a[8:11], v[164:167], v[24:27], a[8:11]
 ds_read_b64_tr_b16 v[180:181], v14 offset:36864
 v_mfma_f32_16x16x32_bf16 a[40:43], v[160:163], v[20:23], a[40:43]
 v_mfma_f32_16x16x32_bf16 a[40:43], v[164:167], v[28:31], a[40:43]
 s_waitcnt lgkmcnt(3)
 v_mfma_f32_16x16x32_bf16 a[44:47], v[168:171], v[20:23], a[44:47]
 ds_read_b64_tr_b16 v[182:183], v14 offset:37888
 v_mfma_f32_16x16x32_bf16 a[44:47], v[172:175], v[28:31], a[44:47]
 buffer_load_dwordx4 v[124:127], v250, s[20:23], s38 offen offset:1024 sc1
 v_mfma_f32_16x16x32_bf16 a[12:15], v[168:171], v[16:19], a[12:15]
 v_mfma_f32_16x16x32_bf16 a[12:15], v[172:175], v[24:27], a[12:15]
 v_mfma_f32_16x16x32_bf16 a[108:111], v[168:171], v[36:39], a[108:111]
 ds_read_b64_tr_b16 v[184:185], v14 offset:4104
 v_mfma_f32_16x16x32_bf16 a[108:111], v[172:175], v[44:47], a[108:111]
 v_mfma_f32_16x16x32_bf16 a[76:79], v[168:171], v[32:35], a[76:79]
 buffer_load_dwordx4 v[128:131], v251, s[20:23], s37 offen offset:0 sc1
 v_mfma_f32_16x16x32_bf16 a[76:79], v[172:175], v[40:43], a[76:79]
 ds_read_b64_tr_b16 v[186:187], v14 offset:5128
 v_mfma_f32_16x16x32_bf16 a[72:75], v[160:163], v[32:35], a[72:75]
 v_mfma_f32_16x16x32_bf16 a[72:75], v[164:167], v[40:43], a[72:75]
 buffer_load_dwordx4 v[132:135], v251, s[20:23], s37 offen offset:1024 sc1
 v_mfma_f32_16x16x32_bf16 a[104:107], v[160:163], v[36:39], a[104:107]
 v_mfma_f32_16x16x32_bf16 a[104:107], v[164:167], v[44:47], a[104:107]
 ds_read_b64_tr_b16 v[188:189], v14 offset:36872
 v_mfma_f32_16x16x32_bf16 a[100:103], v[152:155], v[36:39], a[100:103]
 v_mfma_f32_16x16x32_bf16 a[100:103], v[156:159], v[44:47], a[100:103]
 buffer_load_dwordx4 v[136:139], v251, s[20:23], s38 offen offset:0 sc1
 v_mfma_f32_16x16x32_bf16 a[68:71], v[152:155], v[32:35], a[68:71]
 ds_read_b64_tr_b16 v[190:191], v14 offset:37896
 v_mfma_f32_16x16x32_bf16 a[68:71], v[156:159], v[40:43], a[68:71]
 v_mfma_f32_16x16x32_bf16 a[64:67], v[144:147], v[32:35], a[64:67]
 v_mfma_f32_16x16x32_bf16 a[64:67], v[148:151], v[40:43], a[64:67]
 buffer_load_dwordx4 v[140:143], v251, s[20:23], s38 offen offset:1024 sc1
 v_mfma_f32_16x16x32_bf16 a[96:99], v[144:147], v[36:39], a[96:99]
 ds_read_b64_tr_b16 v[192:193], v15 offset:4096
 v_mfma_f32_16x16x32_bf16 a[96:99], v[148:151], v[44:47], a[96:99]
 s_waitcnt vmcnt(32)
 v_mfma_f32_16x16x32_bf16 a[128:131], v[144:147], v[48:51], a[128:131]
 v_mfma_f32_16x16x32_bf16 a[128:131], v[148:151], v[56:59], a[128:131]
 ds_read_b64_tr_b16 v[194:195], v15 offset:5120
 v_mfma_f32_16x16x32_bf16 a[160:163], v[144:147], v[52:55], a[160:163]
 s_add_u32 m0, s84, 0
 v_mfma_f32_16x16x32_bf16 a[160:163], v[148:151], v[60:63], a[160:163]
 buffer_load_dwordx4 v252, s[8:11], s34 offen offset:0 lds
 v_mfma_f32_16x16x32_bf16 a[164:167], v[152:155], v[52:55], a[164:167]
 v_mfma_f32_16x16x32_bf16 a[164:167], v[156:159], v[60:63], a[164:167]
 ds_read_b64_tr_b16 v[196:197], v15 offset:36864
 v_mfma_f32_16x16x32_bf16 a[132:135], v[152:155], v[48:51], a[132:135]
 buffer_load_dwordx4 v253, s[8:11], s34 offen offset:1024 lds
 v_mfma_f32_16x16x32_bf16 a[132:135], v[156:159], v[56:59], a[132:135]
 v_mfma_f32_16x16x32_bf16 a[136:139], v[160:163], v[48:51], a[136:139]
 ds_read_b64_tr_b16 v[198:199], v15 offset:37888
 v_mfma_f32_16x16x32_bf16 a[136:139], v[164:167], v[56:59], a[136:139]
 v_mfma_f32_16x16x32_bf16 a[168:171], v[160:163], v[52:55], a[168:171]
 buffer_load_dwordx4 v254, s[8:11], s34 offen offset:2048 lds
 v_mfma_f32_16x16x32_bf16 a[168:171], v[164:167], v[60:63], a[168:171]
 v_mfma_f32_16x16x32_bf16 a[172:175], v[168:171], v[52:55], a[172:175]
 ds_read_b64_tr_b16 v[200:201], v15 offset:4104
 v_mfma_f32_16x16x32_bf16 a[172:175], v[172:175], v[60:63], a[172:175]
 v_mfma_f32_16x16x32_bf16 a[140:143], v[168:171], v[48:51], a[140:143]
 buffer_load_dwordx4 v255, s[8:11], s34 offen offset:3072 lds
 v_mfma_f32_16x16x32_bf16 a[140:143], v[172:175], v[56:59], a[140:143]
 ds_read_b64_tr_b16 v[202:203], v15 offset:5128
 v_mfma_f32_16x16x32_bf16 a[236:239], v[168:171], v[68:71], a[236:239]
 s_add_u32 s34, s34, 0x10000
 v_mfma_f32_16x16x32_bf16 a[236:239], v[172:175], v[76:79], a[236:239]
 s_add_u32 m0, s85, 0
 v_mfma_f32_16x16x32_bf16 a[204:207], v[168:171], v[64:67], a[204:207]
 buffer_load_dwordx4 v252, s[8:11], s34 offen offset:0 lds
 v_mfma_f32_16x16x32_bf16 a[204:207], v[172:175], v[72:75], a[204:207]
 ds_read_b64_tr_b16 v[204:205], v15 offset:36872
 v_mfma_f32_16x16x32_bf16 a[200:203], v[160:163], v[64:67], a[200:203]
 v_mfma_f32_16x16x32_bf16 a[200:203], v[164:167], v[72:75], a[200:203]
 buffer_load_dwordx4 v253, s[8:11], s34 offen offset:1024 lds
 v_mfma_f32_16x16x32_bf16 a[232:235], v[160:163], v[68:71], a[232:235]
 ds_read_b64_tr_b16 v[206:207], v15 offset:37896
 v_mfma_f32_16x16x32_bf16 a[232:235], v[164:167], v[76:79], a[232:235]
 v_mfma_f32_16x16x32_bf16 a[228:231], v[152:155], v[68:71], a[228:231]
 v_mfma_f32_16x16x32_bf16 a[228:231], v[156:159], v[76:79], a[228:231]
 buffer_load_dwordx4 v254, s[8:11], s34 offen offset:2048 lds
 v_mfma_f32_16x16x32_bf16 a[196:199], v[152:155], v[64:67], a[196:199]
 v_mfma_f32_16x16x32_bf16 a[196:199], v[156:159], v[72:75], a[196:199]
 v_mfma_f32_16x16x32_bf16 a[192:195], v[144:147], v[64:67], a[192:195]
 buffer_load_dwordx4 v255, s[8:11], s34 offen offset:3072 lds
 v_mfma_f32_16x16x32_bf16 a[192:195], v[148:151], v[72:75], a[192:195]
 s_add_u32 s34, s34, 0x10000
 v_mfma_f32_16x16x32_bf16 a[224:227], v[144:147], v[68:71], a[224:227]
 v_mfma_f32_16x16x32_bf16 a[224:227], v[148:151], v[76:79], a[224:227]
 s_waitcnt vmcnt(32)
 s_waitcnt lgkmcnt(0)
 v_mfma_f32_16x16x32_bf16 a[16:19], v[176:179], v[16:19], a[16:19]
 s_add_u32 m0, s84, 4096
 v_mfma_f32_16x16x32_bf16 a[16:19], v[180:183], v[24:27], a[16:19]
 buffer_load_dwordx4 v252, s[8:11], s42 offen offset:0 lds
 v_mfma_f32_16x16x32_bf16 a[48:51], v[176:179], v[20:23], a[48:51]
 ds_read_b64_tr_b16 v[144:145], v240 offset:0
 v_mfma_f32_16x16x32_bf16 a[48:51], v[180:183], v[28:31], a[48:51]
 v_mfma_f32_16x16x32_bf16 a[52:55], v[184:187], v[20:23], a[52:55]
 buffer_load_dwordx4 v253, s[8:11], s42 offen offset:1024 lds
 v_mfma_f32_16x16x32_bf16 a[52:55], v[188:191], v[28:31], a[52:55]
 ds_read_b64_tr_b16 v[146:147], v240 offset:1024
 v_mfma_f32_16x16x32_bf16 a[20:23], v[184:187], v[16:19], a[20:23]
 v_mfma_f32_16x16x32_bf16 a[20:23], v[188:191], v[24:27], a[20:23]
 v_mfma_f32_16x16x32_bf16 a[24:27], v[192:195], v[16:19], a[24:27]
 buffer_load_dwordx4 v254, s[8:11], s42 offen offset:2048 lds
 v_mfma_f32_16x16x32_bf16 a[24:27], v[196:199], v[24:27], a[24:27]
 ds_read_b64_tr_b16 v[148:149], v242 offset:0
 v_mfma_f32_16x16x32_bf16 a[56:59], v[192:195], v[20:23], a[56:59]
 v_mfma_f32_16x16x32_bf16 a[56:59], v[196:199], v[28:31], a[56:59]
 v_mfma_f32_16x16x32_bf16 a[60:63], v[200:203], v[20:23], a[60:63]
 ds_read_b64_tr_b16 v[150:151], v242 offset:1024
 v_mfma_f32_16x16x32_bf16 a[60:63], v[204:207], v[28:31], a[60:63]
 buffer_load_dwordx4 v255, s[8:11], s42 offen offset:3072 lds
 v_mfma_f32_16x16x32_bf16 a[28:31], v[200:203], v[16:19], a[28:31]
 v_mfma_f32_16x16x32_bf16 a[28:31], v[204:207], v[24:27], a[28:31]
 v_mfma_f32_16x16x32_bf16 a[124:127], v[200:203], v[36:39], a[124:127]
 ds_read_b64_tr_b16 v[152:153], v240 offset:8
 s_add_u32 s42, s42, 0x10000
 v_mfma_f32_16x16x32_bf16 a[124:127], v[204:207], v[44:47], a[124:127]
 s_add_u32 m0, s85, 4096
 v_mfma_f32_16x16x32_bf16 a[92:95], v[200:203], v[32:35], a[92:95]
 buffer_load_dwordx4 v252, s[8:11], s42 offen offset:0 lds
 v_mfma_f32_16x16x32_bf16 a[92:95], v[204:207], v[40:43], a[92:95]
 ds_read_b64_tr_b16 v[154:155], v240 offset:1032
 v_mfma_f32_16x16x32_bf16 a[88:91], v[192:195], v[32:35], a[88:91]
 v_mfma_f32_16x16x32_bf16 a[88:91], v[196:199], v[40:43], a[88:91]
 buffer_load_dwordx4 v253, s[8:11], s42 offen offset:1024 lds
 v_mfma_f32_16x16x32_bf16 a[120:123], v[192:195], v[36:39], a[120:123]
 v_mfma_f32_16x16x32_bf16 a[120:123], v[196:199], v[44:47], a[120:123]
 ds_read_b64_tr_b16 v[156:157], v242 offset:8
 v_mfma_f32_16x16x32_bf16 a[116:119], v[184:187], v[36:39], a[116:119]
 v_mfma_f32_16x16x32_bf16 a[116:119], v[188:191], v[44:47], a[116:119]
 buffer_load_dwordx4 v254, s[8:11], s42 offen offset:2048 lds
 v_mfma_f32_16x16x32_bf16 a[84:87], v[184:187], v[32:35], a[84:87]
 ds_read_b64_tr_b16 v[158:159], v242 offset:1032
 v_mfma_f32_16x16x32_bf16 a[84:87], v[188:191], v[40:43], a[84:87]
 v_mfma_f32_16x16x32_bf16 a[80:83], v[176:179], v[32:35], a[80:83]
 v_mfma_f32_16x16x32_bf16 a[80:83], v[180:183], v[40:43], a[80:83]
 buffer_load_dwordx4 v255, s[8:11], s42 offen offset:3072 lds
 v_mfma_f32_16x16x32_bf16 a[112:115], v[176:179], v[36:39], a[112:115]
 ds_read_b64_tr_b16 v[160:161], v241 offset:0
 v_mfma_f32_16x16x32_bf16 a[112:115], v[180:183], v[44:47], a[112:115]
 s_waitcnt vmcnt(24)
 s_lshl_b32 s30, 1, s47
 s_and_b32 s30, s30, s28
 v_cmp_ne_u32 vcc, s89, v13
 s_nop 0
 s_and_b64 vcc, vcc, s[30:31]
 s_cbranch_vccnz K3_spinl
K3_spinl_b:
 s_lshl_b32 s55, s47, 15
 s_add_u32 s35, s40, s55
 s_add_u32 s47, s47, 1
 s_and_b32 s47, s47, 3
 v_mfma_f32_16x16x32_bf16 a[144:147], v[176:179], v[48:51], a[144:147]
 s_add_u32 s42, s42, 0x10000
 v_mfma_f32_16x16x32_bf16 a[144:147], v[180:183], v[56:59], a[144:147]
 ds_read_b64_tr_b16 v[162:163], v241 offset:1024
 s_add_u32 s35, s35, 0x4000
 v_mfma_f32_16x16x32_bf16 a[176:179], v[176:179], v[52:55], a[176:179]
 s_add_u32 s36, s35, 0x2000
 v_mfma_f32_16x16x32_bf16 a[176:179], v[180:183], v[60:63], a[176:179]
 buffer_load_dwordx4 v[16:19], v248, s[20:23], s35 offen offset:0 sc1
 v_mfma_f32_16x16x32_bf16 a[180:183], v[184:187], v[52:55], a[180:183]
 v_mfma_f32_16x16x32_bf16 a[180:183], v[188:191], v[60:63], a[180:183]
 ds_read_b64_tr_b16 v[164:165], v243 offset:0
 v_mfma_f32_16x16x32_bf16 a[148:151], v[184:187], v[48:51], a[148:151]
 buffer_load_dwordx4 v[20:23], v248, s[20:23], s35 offen offset:1024 sc1
 v_mfma_f32_16x16x32_bf16 a[148:151], v[188:191], v[56:59], a[148:151]
 v_mfma_f32_16x16x32_bf16 a[152:155], v[192:195], v[48:51], a[152:155]
 ds_read_b64_tr_b16 v[166:167], v243 offset:1024
 v_mfma_f32_16x16x32_bf16 a[152:155], v[196:199], v[56:59], a[152:155]
 v_mfma_f32_16x16x32_bf16 a[184:187], v[192:195], v[52:55], a[184:187]
 buffer_load_dwordx4 v[24:27], v248, s[20:23], s36 offen offset:0 sc1
 v_mfma_f32_16x16x32_bf16 a[184:187], v[196:199], v[60:63], a[184:187]
 v_mfma_f32_16x16x32_bf16 a[188:191], v[200:203], v[52:55], a[188:191]
 ds_read_b64_tr_b16 v[168:169], v241 offset:8
 v_mfma_f32_16x16x32_bf16 a[188:191], v[204:207], v[60:63], a[188:191]
 v_mfma_f32_16x16x32_bf16 a[156:159], v[200:203], v[48:51], a[156:159]
 buffer_load_dwordx4 v[28:31], v248, s[20:23], s36 offen offset:1024 sc1
 v_mfma_f32_16x16x32_bf16 a[156:159], v[204:207], v[56:59], a[156:159]
 ds_read_b64_tr_b16 v[170:171], v241 offset:1032
 v_mfma_f32_16x16x32_bf16 a[252:255], v[200:203], v[68:71], a[252:255]
 v_mfma_f32_16x16x32_bf16 a[252:255], v[204:207], v[76:79], a[252:255]
 v_mfma_f32_16x16x32_bf16 a[220:223], v[200:203], v[64:67], a[220:223]
 buffer_load_dwordx4 v[32:35], v249, s[20:23], s35 offen offset:0 sc1
 v_mfma_f32_16x16x32_bf16 a[220:223], v[204:207], v[72:75], a[220:223]
 ds_read_b64_tr_b16 v[172:173], v243 offset:8
 v_mfma_f32_16x16x32_bf16 a[216:219], v[192:195], v[64:67], a[216:219]
 v_mfma_f32_16x16x32_bf16 a[216:219], v[196:199], v[72:75], a[216:219]
 buffer_load_dwordx4 v[36:39], v249, s[20:23], s35 offen offset:1024 sc1
 v_mfma_f32_16x16x32_bf16 a[248:251], v[192:195], v[68:71], a[248:251]
 ds_read_b64_tr_b16 v[174:175], v243 offset:1032
 v_mfma_f32_16x16x32_bf16 a[248:251], v[196:199], v[76:79], a[248:251]
 v_mfma_f32_16x16x32_bf16 a[244:247], v[184:187], v[68:71], a[244:247]
 v_mfma_f32_16x16x32_bf16 a[244:247], v[188:191], v[76:79], a[244:247]
 buffer_load_dwordx4 v[40:43], v249, s[20:23], s36 offen offset:0 sc1
 v_mfma_f32_16x16x32_bf16 a[212:215], v[184:187], v[64:67], a[212:215]
 v_mfma_f32_16x16x32_bf16 a[212:215], v[188:191], v[72:75], a[212:215]
 v_mfma_f32_16x16x32_bf16 a[208:211], v[176:179], v[64:67], a[208:211]
 buffer_load_dwordx4 v[44:47], v249, s[20:23], s36 offen offset:1024 sc1
 v_mfma_f32_16x16x32_bf16 a[208:211], v[180:183], v[72:75], a[208:211]
 v_mfma_f32_16x16x32_bf16 a[240:243], v[176:179], v[68:71], a[240:243]
 v_mfma_f32_16x16x32_bf16 a[240:243], v[180:183], v[76:79], a[240:243]
 s_waitcnt vmcnt(32)
 global_load_dword v11, v12, s[90:91]
 s_waitcnt lgkmcnt(12)
 v_mfma_f32_16x16x32_bf16 a[0:3], v[144:147], v[80:83], a[0:3]
 s_mov_b32 s37, s35
 s_mov_b32 s38, s36
 v_mfma_f32_16x16x32_bf16 a[0:3], v[148:151], v[88:91], a[0:3]
 buffer_load_dwordx4 v[48:51], v250, s[20:23], s37 offen offset:0 sc1
 v_mfma_f32_16x16x32_bf16 a[32:35], v[144:147], v[84:87], a[32:35]
 ds_read_b64_tr_b16 v[176:177], v240 offset:4096
 v_mfma_f32_16x16x32_bf16 a[32:35], v[148:151], v[92:95], a[32:35]
 s_waitcnt lgkmcnt(9)
 v_mfma_f32_16x16x32_bf16 a[36:39], v[152:155], v[84:87], a[36:39]
 buffer_load_dwordx4 v[52:55], v250, s[20:23], s37 offen offset:1024 sc1
 v_mfma_f32_16x16x32_bf16 a[36:39], v[156:159], v[92:95], a[36:39]
 ds_read_b64_tr_b16 v[178:179], v240 offset:5120
 v_mfma_f32_16x16x32_bf16 a[4:7], v[152:155], v[80:83], a[4:7]
 v_mfma_f32_16x16x32_bf16 a[4:7], v[156:159], v[88:91], a[4:7]
 s_waitcnt lgkmcnt(6)
 v_mfma_f32_16x16x32_bf16 a[8:11], v[160:163], v[80:83], a[8:11]
 buffer_load_dwordx4 v[56:59], v250, s[20:23], s38 offen offset:0 sc1
 v_mfma_f32_16x16x32_bf16 a[8:11], v[164:167], v[88:91], a[8:11]
 ds_read_b64_tr_b16 v[180:181], v242 offset:4096
 v_mfma_f32_16x16x32_bf16 a[40:43], v[160:163], v[84:87], a[40:43]
 v_mfma_f32_16x16x32_bf16 a[40:43], v[164:167], v[92:95], a[40:43]
 s_waitcnt lgkmcnt(3)
 v_mfma_f32_16x16x32_bf16 a[44:47], v[168:171], v[84:87], a[44:47]
 ds_read_b64_tr_b16 v[182:183], v242 offset:5120
 v_mfma_f32_16x16x32_bf16 a[44:47], v[172:175], v[92:95], a[44:47]
 buffer_load_dwordx4 v[60:63], v250, s[20:23], s38 offen offset:1024 sc1
 v_mfma_f32_16x16x32_bf16 a[12:15], v[168:171], v[80:83], a[12:15]
 v_mfma_f32_16x16x32_bf16 a[12:15], v[172:175], v[88:91], a[12:15]
 v_mfma_f32_16x16x32_bf16 a[108:111], v[168:171], v[100:103], a[108:111]
 ds_read_b64_tr_b16 v[184:185], v240 offset:4104
 v_mfma_f32_16x16x32_bf16 a[108:111], v[172:175], v[108:111], a[108:111]
 v_mfma_f32_16x16x32_bf16 a[76:79], v[168:171], v[96:99], a[76:79]
 buffer_load_dwordx4 v[64:67], v251, s[20:23], s37 offen offset:0 sc1
 v_mfma_f32_16x16x32_bf16 a[76:79], v[172:175], v[104:107], a[76:79]
 ds_read_b64_tr_b16 v[186:187], v240 offset:5128
 v_mfma_f32_16x16x32_bf16 a[72:75], v[160:163], v[96:99], a[72:75]
 v_mfma_f32_16x16x32_bf16 a[72:75], v[164:167], v[104:107], a[72:75]
 buffer_load_dwordx4 v[68:71], v251, s[20:23], s37 offen offset:1024 sc1
 v_mfma_f32_16x16x32_bf16 a[104:107], v[160:163], v[100:103], a[104:107]
 v_mfma_f32_16x16x32_bf16 a[104:107], v[164:167], v[108:111], a[104:107]
 ds_read_b64_tr_b16 v[188:189], v242 offset:4104
 v_mfma_f32_16x16x32_bf16 a[100:103], v[152:155], v[100:103], a[100:103]
 v_mfma_f32_16x16x32_bf16 a[100:103], v[156:159], v[108:111], a[100:103]
 buffer_load_dwordx4 v[72:75], v251, s[20:23], s38 offen offset:0 sc1
 v_mfma_f32_16x16x32_bf16 a[68:71], v[152:155], v[96:99], a[68:71]
 ds_read_b64_tr_b16 v[190:191], v242 offset:5128
 v_mfma_f32_16x16x32_bf16 a[68:71], v[156:159], v[104:107], a[68:71]
 v_mfma_f32_16x16x32_bf16 a[64:67], v[144:147], v[96:99], a[64:67]
 v_mfma_f32_16x16x32_bf16 a[64:67], v[148:151], v[104:107], a[64:67]
 buffer_load_dwordx4 v[76:79], v251, s[20:23], s38 offen offset:1024 sc1
 v_mfma_f32_16x16x32_bf16 a[96:99], v[144:147], v[100:103], a[96:99]
 ds_read_b64_tr_b16 v[192:193], v241 offset:4096
 v_mfma_f32_16x16x32_bf16 a[96:99], v[148:151], v[108:111], a[96:99]
 s_waitcnt vmcnt(32)
 v_mfma_f32_16x16x32_bf16 a[128:131], v[144:147], v[112:115], a[128:131]
 v_mfma_f32_16x16x32_bf16 a[128:131], v[148:151], v[120:123], a[128:131]
 ds_read_b64_tr_b16 v[194:195], v241 offset:5120
 s_sub_u32 s34, s34, s98
 v_mfma_f32_16x16x32_bf16 a[160:163], v[144:147], v[116:119], a[160:163]
 s_add_u32 m0, s86, 0
 v_mfma_f32_16x16x32_bf16 a[160:163], v[148:151], v[124:127], a[160:163]
 buffer_load_dwordx4 v252, s[8:11], s34 offen offset:0 lds
 v_mfma_f32_16x16x32_bf16 a[164:167], v[152:155], v[116:119], a[164:167]
 v_mfma_f32_16x16x32_bf16 a[164:167], v[156:159], v[124:127], a[164:167]
 ds_read_b64_tr_b16 v[196:197], v243 offset:4096
 v_mfma_f32_16x16x32_bf16 a[132:135], v[152:155], v[112:115], a[132:135]
 buffer_load_dwordx4 v253, s[8:11], s34 offen offset:1024 lds
 v_mfma_f32_16x16x32_bf16 a[132:135], v[156:159], v[120:123], a[132:135]
 v_mfma_f32_16x16x32_bf16 a[136:139], v[160:163], v[112:115], a[136:139]
 ds_read_b64_tr_b16 v[198:199], v243 offset:5120
 v_mfma_f32_16x16x32_bf16 a[136:139], v[164:167], v[120:123], a[136:139]
 v_mfma_f32_16x16x32_bf16 a[168:171], v[160:163], v[116:119], a[168:171]
 buffer_load_dwordx4 v254, s[8:11], s34 offen offset:2048 lds
 v_mfma_f32_16x16x32_bf16 a[168:171], v[164:167], v[124:127], a[168:171]
 v_mfma_f32_16x16x32_bf16 a[172:175], v[168:171], v[116:119], a[172:175]
 ds_read_b64_tr_b16 v[200:201], v241 offset:4104
 v_mfma_f32_16x16x32_bf16 a[172:175], v[172:175], v[124:127], a[172:175]
 v_mfma_f32_16x16x32_bf16 a[140:143], v[168:171], v[112:115], a[140:143]
 buffer_load_dwordx4 v255, s[8:11], s34 offen offset:3072 lds
 v_mfma_f32_16x16x32_bf16 a[140:143], v[172:175], v[120:123], a[140:143]
 ds_read_b64_tr_b16 v[202:203], v241 offset:5128
 v_mfma_f32_16x16x32_bf16 a[236:239], v[168:171], v[132:135], a[236:239]
 s_add_u32 s34, s34, 0x10000
 v_mfma_f32_16x16x32_bf16 a[236:239], v[172:175], v[140:143], a[236:239]
 s_add_u32 m0, s87, 0
 v_mfma_f32_16x16x32_bf16 a[204:207], v[168:171], v[128:131], a[204:207]
 buffer_load_dwordx4 v252, s[8:11], s34 offen offset:0 lds
 v_mfma_f32_16x16x32_bf16 a[204:207], v[172:175], v[136:139], a[204:207]
 ds_read_b64_tr_b16 v[204:205], v243 offset:4104
 v_mfma_f32_16x16x32_bf16 a[200:203], v[160:163], v[128:131], a[200:203]
 v_mfma_f32_16x16x32_bf16 a[200:203], v[164:167], v[136:139], a[200:203]
 buffer_load_dwordx4 v253, s[8:11], s34 offen offset:1024 lds
 v_mfma_f32_16x16x32_bf16 a[232:235], v[160:163], v[132:135], a[232:235]
 ds_read_b64_tr_b16 v[206:207], v243 offset:5128
 v_mfma_f32_16x16x32_bf16 a[232:235], v[164:167], v[140:143], a[232:235]
 v_mfma_f32_16x16x32_bf16 a[228:231], v[152:155], v[132:135], a[228:231]
 v_mfma_f32_16x16x32_bf16 a[228:231], v[156:159], v[140:143], a[228:231]
 buffer_load_dwordx4 v254, s[8:11], s34 offen offset:2048 lds
 v_mfma_f32_16x16x32_bf16 a[196:199], v[152:155], v[128:131], a[196:199]
 v_mfma_f32_16x16x32_bf16 a[196:199], v[156:159], v[136:139], a[196:199]
 v_mfma_f32_16x16x32_bf16 a[192:195], v[144:147], v[128:131], a[192:195]
 buffer_load_dwordx4 v255, s[8:11], s34 offen offset:3072 lds
 v_mfma_f32_16x16x32_bf16 a[192:195], v[148:151], v[136:139], a[192:195]
 s_add_u32 s34, s34, 0x10000
 v_mfma_f32_16x16x32_bf16 a[224:227], v[144:147], v[132:135], a[224:227]
 v_mfma_f32_16x16x32_bf16 a[224:227], v[148:151], v[140:143], a[224:227]
 s_waitcnt vmcnt(32)
 s_waitcnt lgkmcnt(0)
 v_mfma_f32_16x16x32_bf16 a[16:19], v[176:179], v[80:83], a[16:19]
 s_sub_u32 s42, s42, s98
 s_add_u32 m0, s86, 4096
 v_mfma_f32_16x16x32_bf16 a[16:19], v[180:183], v[88:91], a[16:19]
 buffer_load_dwordx4 v252, s[8:11], s42 offen offset:0 lds
 v_mfma_f32_16x16x32_bf16 a[48:51], v[176:179], v[84:87], a[48:51]
 ds_read_b64_tr_b16 v[144:145], v14 offset:0
 v_mfma_f32_16x16x32_bf16 a[48:51], v[180:183], v[92:95], a[48:51]
 v_mfma_f32_16x16x32_bf16 a[52:55], v[184:187], v[84:87], a[52:55]
 buffer_load_dwordx4 v253, s[8:11], s42 offen offset:1024 lds
 v_mfma_f32_16x16x32_bf16 a[52:55], v[188:191], v[92:95], a[52:55]
 ds_read_b64_tr_b16 v[146:147], v14 offset:1024
 v_mfma_f32_16x16x32_bf16 a[20:23], v[184:187], v[80:83], a[20:23]
 v_mfma_f32_16x16x32_bf16 a[20:23], v[188:191], v[88:91], a[20:23]
 v_mfma_f32_16x16x32_bf16 a[24:27], v[192:195], v[80:83], a[24:27]
 buffer_load_dwordx4 v254, s[8:11], s42 offen offset:2048 lds
 v_mfma_f32_16x16x32_bf16 a[24:27], v[196:199], v[88:91], a[24:27]
 ds_read_b64_tr_b16 v[148:149], v14 offset:32768
 v_mfma_f32_16x16x32_bf16 a[56:59], v[192:195], v[84:87], a[56:59]
 v_mfma_f32_16x16x32_bf16 a[56:59], v[196:199], v[92:95], a[56:59]
 v_mfma_f32_16x16x32_bf16 a[60:63], v[200:203], v[84:87], a[60:63]
 ds_read_b64_tr_b16 v[150:151], v14 offset:33792
 v_mfma_f32_16x16x32_bf16 a[60:63], v[204:207], v[92:95], a[60:63]
 buffer_load_dwordx4 v255, s[8:11], s42 offen offset:3072 lds
 v_mfma_f32_16x16x32_bf16 a[28:31], v[200:203], v[80:83], a[28:31]
 v_mfma_f32_16x16x32_bf16 a[28:31], v[204:207], v[88:91], a[28:31]
 v_mfma_f32_16x16x32_bf16 a[124:127], v[200:203], v[100:103], a[124:127]
 ds_read_b64_tr_b16 v[152:153], v14 offset:8
 s_add_u32 s42, s42, 0x10000
 v_mfma_f32_16x16x32_bf16 a[124:127], v[204:207], v[108:111], a[124:127]
 s_add_u32 m0, s87, 4096
 v_mfma_f32_16x16x32_bf16 a[92:95], v[200:203], v[96:99], a[92:95]
 buffer_load_dwordx4 v252, s[8:11], s42 offen offset:0 lds
 v_mfma_f32_16x16x32_bf16 a[92:95], v[204:207], v[104:107], a[92:95]
 ds_read_b64_tr_b16 v[154:155], v14 offset:1032
 v_mfma_f32_16x16x32_bf16 a[88:91], v[192:195], v[96:99], a[88:91]
 v_mfma_f32_16x16x32_bf16 a[88:91], v[196:199], v[104:107], a[88:91]
 buffer_load_dwordx4 v253, s[8:11], s42 offen offset:1024 lds
 v_mfma_f32_16x16x32_bf16 a[120:123], v[192:195], v[100:103], a[120:123]
 v_mfma_f32_16x16x32_bf16 a[120:123], v[196:199], v[108:111], a[120:123]
 ds_read_b64_tr_b16 v[156:157], v14 offset:32776
 v_mfma_f32_16x16x32_bf16 a[116:119], v[184:187], v[100:103], a[116:119]
 v_mfma_f32_16x16x32_bf16 a[116:119], v[188:191], v[108:111], a[116:119]
 buffer_load_dwordx4 v254, s[8:11], s42 offen offset:2048 lds
 v_mfma_f32_16x16x32_bf16 a[84:87], v[184:187], v[96:99], a[84:87]
 ds_read_b64_tr_b16 v[158:159], v14 offset:33800
 v_mfma_f32_16x16x32_bf16 a[84:87], v[188:191], v[104:107], a[84:87]
 v_mfma_f32_16x16x32_bf16 a[80:83], v[176:179], v[96:99], a[80:83]
 v_mfma_f32_16x16x32_bf16 a[80:83], v[180:183], v[104:107], a[80:83]
 buffer_load_dwordx4 v255, s[8:11], s42 offen offset:3072 lds
 v_mfma_f32_16x16x32_bf16 a[112:115], v[176:179], v[100:103], a[112:115]
 ds_read_b64_tr_b16 v[160:161], v15 offset:0
 v_mfma_f32_16x16x32_bf16 a[112:115], v[180:183], v[108:111], a[112:115]
 v_mfma_f32_16x16x32_bf16 a[144:147], v[176:179], v[112:115], a[144:147]
 s_add_u32 s42, s42, 0x10000
 v_mfma_f32_16x16x32_bf16 a[144:147], v[180:183], v[120:123], a[144:147]
 ds_read_b64_tr_b16 v[162:163], v15 offset:1024
 s_add_u32 s35, s35, s99
 v_mfma_f32_16x16x32_bf16 a[176:179], v[176:179], v[116:119], a[176:179]
 s_add_u32 s36, s35, 0x2000
 v_mfma_f32_16x16x32_bf16 a[176:179], v[180:183], v[124:127], a[176:179]
 buffer_load_dwordx4 v[80:83], v248, s[20:23], s35 offen offset:0 sc1
 v_mfma_f32_16x16x32_bf16 a[180:183], v[184:187], v[116:119], a[180:183]
 v_mfma_f32_16x16x32_bf16 a[180:183], v[188:191], v[124:127], a[180:183]
 ds_read_b64_tr_b16 v[164:165], v15 offset:32768
 v_mfma_f32_16x16x32_bf16 a[148:151], v[184:187], v[112:115], a[148:151]
 buffer_load_dwordx4 v[84:87], v248, s[20:23], s35 offen offset:1024 sc1
 v_mfma_f32_16x16x32_bf16 a[148:151], v[188:191], v[120:123], a[148:151]
 v_mfma_f32_16x16x32_bf16 a[152:155], v[192:195], v[112:115], a[152:155]
 ds_read_b64_tr_b16 v[166:167], v15 offset:33792
 v_mfma_f32_16x16x32_bf16 a[152:155], v[196:199], v[120:123], a[152:155]
 v_mfma_f32_16x16x32_bf16 a[184:187], v[192:195], v[116:119], a[184:187]
 buffer_load_dwordx4 v[88:91], v248, s[20:23], s36 offen offset:0 sc1
 v_mfma_f32_16x16x32_bf16 a[184:187], v[196:199], v[124:127], a[184:187]
 v_mfma_f32_16x16x32_bf16 a[188:191], v[200:203], v[116:119], a[188:191]
 ds_read_b64_tr_b16 v[168:169], v15 offset:8
 v_mfma_f32_16x16x32_bf16 a[188:191], v[204:207], v[124:127], a[188:191]
 v_mfma_f32_16x16x32_bf16 a[156:159], v[200:203], v[112:115], a[156:159]
 buffer_load_dwordx4 v[92:95], v248, s[20:23], s36 offen offset:1024 sc1
 v_mfma_f32_16x16x32_bf16 a[156:159], v[204:207], v[120:123], a[156:159]
 ds_read_b64_tr_b16 v[170:171], v15 offset:1032
 v_mfma_f32_16x16x32_bf16 a[252:255], v[200:203], v[132:135], a[252:255]
 v_mfma_f32_16x16x32_bf16 a[252:255], v[204:207], v[140:143], a[252:255]
 v_mfma_f32_16x16x32_bf16 a[220:223], v[200:203], v[128:131], a[220:223]
 buffer_load_dwordx4 v[96:99], v249, s[20:23], s35 offen offset:0 sc1
 v_mfma_f32_16x16x32_bf16 a[220:223], v[204:207], v[136:139], a[220:223]
 ds_read_b64_tr_b16 v[172:173], v15 offset:32776
 v_mfma_f32_16x16x32_bf16 a[216:219], v[192:195], v[128:131], a[216:219]
 v_mfma_f32_16x16x32_bf16 a[216:219], v[196:199], v[136:139], a[216:219]
 buffer_load_dwordx4 v[100:103], v249, s[20:23], s35 offen offset:1024 sc1
 v_mfma_f32_16x16x32_bf16 a[248:251], v[192:195], v[132:135], a[248:251]
 ds_read_b64_tr_b16 v[174:175], v15 offset:33800
 v_mfma_f32_16x16x32_bf16 a[248:251], v[196:199], v[140:143], a[248:251]
 v_mfma_f32_16x16x32_bf16 a[244:247], v[184:187], v[132:135], a[244:247]
 v_mfma_f32_16x16x32_bf16 a[244:247], v[188:191], v[140:143], a[244:247]
 buffer_load_dwordx4 v[104:107], v249, s[20:23], s36 offen offset:0 sc1
 v_mfma_f32_16x16x32_bf16 a[212:215], v[184:187], v[128:131], a[212:215]
 v_mfma_f32_16x16x32_bf16 a[212:215], v[188:191], v[136:139], a[212:215]
 v_mfma_f32_16x16x32_bf16 a[208:211], v[176:179], v[128:131], a[208:211]
 buffer_load_dwordx4 v[108:111], v249, s[20:23], s36 offen offset:1024 sc1
 v_mfma_f32_16x16x32_bf16 a[208:211], v[180:183], v[136:139], a[208:211]
 v_mfma_f32_16x16x32_bf16 a[240:243], v[176:179], v[132:135], a[240:243]
 v_mfma_f32_16x16x32_bf16 a[240:243], v[180:183], v[140:143], a[240:243]
 s_add_u32 s45, s45, 1
 s_cmp_lt_u32 s45, 4
 s_cbranch_scc1 K3_loop
K3_last:
 s_waitcnt vmcnt(32)
 s_waitcnt lgkmcnt(12)
 v_mfma_f32_16x16x32_bf16 a[0:3], v[144:147], v[16:19], a[0:3]
 s_mov_b32 s37, s35
 s_mov_b32 s38, s36
 v_mfma_f32_16x16x32_bf16 a[0:3], v[148:151], v[24:27], a[0:3]
 buffer_load_dwordx4 v[112:115], v250, s[20:23], s37 offen offset:0 sc1
 v_add_u32 v208, s84, v10
 v_mfma_f32_16x16x32_bf16 a[32:35], v[144:147], v[20:23], a[32:35]
 ds_read_b64_tr_b16 v[176:177], v14 offset:4096
 s_sub_u32 s55, s52, 1
 v_mfma_f32_16x16x32_bf16 a[32:35], v[148:151], v[28:31], a[32:35]
 s_waitcnt lgkmcnt(9)
 v_mfma_f32_16x16x32_bf16 a[36:39], v[152:155], v[20:23], a[36:39]
 buffer_load_dwordx4 v[116:119], v250, s[20:23], s37 offen offset:1024 sc1
 s_and_b32 s55, s55, 3
 v_mfma_f32_16x16x32_bf16 a[36:39], v[156:159], v[28:31], a[36:39]
 ds_read_b64_tr_b16 v[178:179], v14 offset:5120
 v_mfma_f32_16x16x32_bf16 a[4:7], v[152:155], v[16:19], a[4:7]
 s_sub_u32 s55, s55, s52
 v_mfma_f32_16x16x32_bf16 a[4:7], v[156:159], v[24:27], a[4:7]
 s_lshl_b32 s55, s55, 13
 s_waitcnt lgkmcnt(6)
 v_mfma_f32_16x16x32_bf16 a[8:11], v[160:163], v[16:19], a[8:11]
 buffer_load_dwordx4 v[120:123], v250, s[20:23], s38 offen offset:0 sc1
 v_mfma_f32_16x16x32_bf16 a[8:11], v[164:167], v[24:27], a[8:11]
 ds_read_b64_tr_b16 v[180:181], v14 offset:36864
 v_add_u32 v213, s55, v208
 v_mfma_f32_16x16x32_bf16 a[40:43], v[160:163], v[20:23], a[40:43]
 v_mfma_f32_16x16x32_bf16 a[40:43], v[164:167], v[28:31], a[40:43]
 v_add_u32 v209, s85, v10
 s_waitcnt lgkmcnt(3)
 v_mfma_f32_16x16x32_bf16 a[44:47], v[168:171], v[20:23], a[44:47]
 ds_read_b64_tr_b16 v[182:183], v14 offset:37888
 s_sub_u32 s55, s52, 2
 v_mfma_f32_16x16x32_bf16 a[44:47], v[172:175], v[28:31], a[44:47]
 buffer_load_dwordx4 v[124:127], v250, s[20:23], s38 offen offset:1024 sc1
 v_mfma_f32_16x16x32_bf16 a[12:15], v[168:171], v[16:19], a[12:15]
 s_and_b32 s55, s55, 3
 v_mfma_f32_16x16x32_bf16 a[12:15], v[172:175], v[24:27], a[12:15]
 v_mfma_f32_16x16x32_bf16 a[108:111], v[168:171], v[36:39], a[108:111]
 ds_read_b64_tr_b16 v[184:185], v14 offset:4104
 s_sub_u32 s55, s55, s52
 v_mfma_f32_16x16x32_bf16 a[108:111], v[172:175], v[44:47], a[108:111]
 s_lshl_b32 s55, s55, 13
 v_mfma_f32_16x16x32_bf16 a[76:79], v[168:171], v[32:35], a[76:79]
 buffer_load_dwordx4 v[128:131], v251, s[20:23], s37 offen offset:0 sc1
 v_mfma_f32_16x16x32_bf16 a[76:79], v[172:175], v[40:43], a[76:79]
 ds_read_b64_tr_b16 v[186:187], v14 offset:5128
 v_add_u32 v214, s55, v209
 v_mfma_f32_16x16x32_bf16 a[72:75], v[160:163], v[32:35], a[72:75]
 v_mfma_f32_16x16x32_bf16 a[72:75], v[164:167], v[40:43], a[72:75]
 buffer_load_dwordx4 v[132:135], v251, s[20:23], s37 offen offset:1024 sc1
 v_add_u32 v210, s87, v10
 v_mfma_f32_16x16x32_bf16 a[104:107], v[160:163], v[36:39], a[104:107]
 v_add_u32 v210, 0x8000, v210
 v_mfma_f32_16x16x32_bf16 a[104:107], v[164:167], v[44:47], a[104:107]
 ds_read_b64_tr_b16 v[188:189], v14 offset:36872
 v_mfma_f32_16x16x32_bf16 a[100:103], v[152:155], v[36:39], a[100:103]
 s_sub_u32 s55, s52, 3
 v_mfma_f32_16x16x32_bf16 a[100:103], v[156:159], v[44:47], a[100:103]
 buffer_load_dwordx4 v[136:139], v251, s[20:23], s38 offen offset:0 sc1
 v_mfma_f32_16x16x32_bf16 a[68:71], v[152:155], v[32:35], a[68:71]
 ds_read_b64_tr_b16 v[190:191], v14 offset:37896
 s_and_b32 s55, s55, 3
 v_mfma_f32_16x16x32_bf16 a[68:71], v[156:159], v[40:43], a[68:71]
 s_sub_u32 s55, s55, s52
 v_mfma_f32_16x16x32_bf16 a[64:67], v[144:147], v[32:35], a[64:67]
 v_mfma_f32_16x16x32_bf16 a[64:67], v[148:151], v[40:43], a[64:67]
 buffer_load_dwordx4 v[140:143], v251, s[20:23], s38 offen offset:1024 sc1
 s_lshl_b32 s55, s55, 13
 v_mfma_f32_16x16x32_bf16 a[96:99], v[144:147], v[36:39], a[96:99]
 ds_read_b64_tr_b16 v[192:193], v15 offset:4096
 v_mfma_f32_16x16x32_bf16 a[96:99], v[148:151], v[44:47], a[96:99]
 v_add_u32 v215, s55, v210
 s_waitcnt vmcnt(32)
 v_mfma_f32_16x16x32_bf16 a[128:131], v[144:147], v[48:51], a[128:131]
 v_add_u32 v211, s86, v10
 v_mfma_f32_16x16x32_bf16 a[128:131], v[148:151], v[56:59], a[128:131]
 ds_read_b64_tr_b16 v[194:195], v15 offset:5120
 v_mfma_f32_16x16x32_bf16 a[160:163], v[144:147], v[52:55], a[160:163]
 s_sub_u32 s55, s52, 1
 v_mfma_f32_16x16x32_bf16 a[160:163], v[148:151], v[60:63], a[160:163]
 v_mfma_f32_16x16x32_bf16 a[164:167], v[152:155], v[52:55], a[164:167]
 s_and_b32 s55, s55, 3
 v_mfma_f32_16x16x32_bf16 a[164:167], v[156:159], v[60:63], a[164:167]
 ds_read_b64_tr_b16 v[196:197], v15 offset:36864
 s_sub_u32 s55, s55, s52
 v_mfma_f32_16x16x32_bf16 a[132:135], v[152:155], v[48:51], a[132:135]
 v_mfma_f32_16x16x32_bf16 a[132:135], v[156:159], v[56:59], a[132:135]
 s_lshl_b32 s55, s55, 13
 v_mfma_f32_16x16x32_bf16 a[136:139], v[160:163], v[48:51], a[136:139]
 ds_read_b64_tr_b16 v[198:199], v15 offset:37888
 v_mfma_f32_16x16x32_bf16 a[136:139], v[164:167], v[56:59], a[136:139]
 v_add_u32 v216, s55, v211
 v_mfma_f32_16x16x32_bf16 a[168:171], v[160:163], v[52:55], a[168:171]
 v_add_u32 v212, s87, v10
 v_mfma_f32_16x16x32_bf16 a[168:171], v[164:167], v[60:63], a[168:171]
 v_mfma_f32_16x16x32_bf16 a[172:175], v[168:171], v[52:55], a[172:175]
 ds_read_b64_tr_b16 v[200:201], v15 offset:4104
 s_sub_u32 s55, s52, 2
 v_mfma_f32_16x16x32_bf16 a[172:175], v[172:175], v[60:63], a[172:175]
 v_mfma_f32_16x16x32_bf16 a[140:143], v[168:171], v[48:51], a[140:143]
 s_and_b32 s55, s55, 3
 v_mfma_f32_16x16x32_bf16 a[140:143], v[172:175], v[56:59], a[140:143]
 ds_read_b64_tr_b16 v[202:203], v15 offset:5128
 s_sub_u32 s55, s55, s52
 v_mfma_f32_16x16x32_bf16 a[236:239], v[168:171], v[68:71], a[236:239]
 v_mfma_f32_16x16x32_bf16 a[236:239], v[172:175], v[76:79], a[236:239]
 s_lshl_b32 s55, s55, 13
 v_mfma_f32_16x16x32_bf16 a[204:207], v[168:171], v[64:67], a[204:207]
 v_mfma_f32_16x16x32_bf16 a[204:207], v[172:175], v[72:75], a[204:207]
 ds_read_b64_tr_b16 v[204:205], v15 offset:36872
 v_add_u32 v217, s55, v212
 v_mfma_f32_16x16x32_bf16 a[200:203], v[160:163], v[64:67], a[200:203]
 s_sub_u32 s55, s52, 3
 v_mfma_f32_16x16x32_bf16 a[200:203], v[164:167], v[72:75], a[200:203]
 v_mfma_f32_16x16x32_bf16 a[232:235], v[160:163], v[68:71], a[232:235]
 ds_read_b64_tr_b16 v[206:207], v15 offset:37896
 s_and_b32 s55, s55, 3
 v_mfma_f32_16x16x32_bf16 a[232:235], v[164:167], v[76:79], a[232:235]
 v_mfma_f32_16x16x32_bf16 a[228:231], v[152:155], v[68:71], a[228:231]
 s_sub_u32 s55, s55, s52
 v_mfma_f32_16x16x32_bf16 a[228:231], v[156:159], v[76:79], a[228:231]
 s_lshl_b32 s55, s55, 13
 v_mfma_f32_16x16x32_bf16 a[196:199], v[152:155], v[64:67], a[196:199]
 v_mfma_f32_16x16x32_bf16 a[196:199], v[156:159], v[72:75], a[196:199]
 v_add_u32 v218, s55, v208
 v_mfma_f32_16x16x32_bf16 a[192:195], v[144:147], v[64:67], a[192:195]
 v_mfma_f32_16x16x32_bf16 a[192:195], v[148:151], v[72:75], a[192:195]
 v_mfma_f32_16x16x32_bf16 a[224:227], v[144:147], v[68:71], a[224:227]
 v_mfma_f32_16x16x32_bf16 a[224:227], v[148:151], v[76:79], a[224:227]
 s_waitcnt vmcnt(24)
 s_waitcnt lgkmcnt(0)
 v_mfma_f32_16x16x32_bf16 a[16:19], v[176:179], v[16:19], a[16:19]
 v_mfma_f32_16x16x32_bf16 a[16:19], v[180:183], v[24:27], a[16:19]
 s_lshl_b32 s55, s2, 2
 v_mfma_f32_16x16x32_bf16 a[48:51], v[176:179], v[20:23], a[48:51]
 ds_read_b64_tr_b16 v[144:145], v240 offset:0
 s_add_u32 s55, s55, s52
 v_mfma_f32_16x16x32_bf16 a[48:51], v[180:183], v[28:31], a[48:51]
 v_mfma_f32_16x16x32_bf16 a[52:55], v[184:187], v[20:23], a[52:55]
 s_lshl_b32 s55, s55, 13
 v_mfma_f32_16x16x32_bf16 a[52:55], v[188:191], v[28:31], a[52:55]
 ds_read_b64_tr_b16 v[146:147], v240 offset:1024
 v_mfma_f32_16x16x32_bf16 a[20:23], v[184:187], v[16:19], a[20:23]
 s_add_u32 s56, s55, 0x6000000
 v_mfma_f32_16x16x32_bf16 a[20:23], v[188:191], v[24:27], a[20:23]
 v_mfma_f32_16x16x32_bf16 a[24:27], v[192:195], v[16:19], a[24:27]
 s_xor_b32 s55, s55, 0x8000
 v_mfma_f32_16x16x32_bf16 a[24:27], v[196:199], v[24:27], a[24:27]
 ds_read_b64_tr_b16 v[148:149], v242 offset:0
 v_mfma_f32_16x16x32_bf16 a[56:59], v[192:195], v[20:23], a[56:59]
 s_add_u32 s57, s55, 0x6000000
 v_mfma_f32_16x16x32_bf16 a[56:59], v[196:199], v[28:31], a[56:59]
 v_mfma_f32_16x16x32_bf16 a[60:63], v[200:203], v[20:23], a[60:63]
 ds_read_b64_tr_b16 v[150:151], v242 offset:1024
 s_add_u32 s58, s56, 4096
 v_mfma_f32_16x16x32_bf16 a[60:63], v[204:207], v[28:31], a[60:63]
 v_mfma_f32_16x16x32_bf16 a[28:31], v[200:203], v[16:19], a[28:31]
 s_add_u32 s59, s57, 4096
 v_mfma_f32_16x16x32_bf16 a[28:31], v[204:207], v[24:27], a[28:31]
 v_mfma_f32_16x16x32_bf16 a[124:127], v[200:203], v[36:39], a[124:127]
 ds_read_b64_tr_b16 v[152:153], v240 offset:8
 s_xor_b32 s63, s53, 4
 v_mfma_f32_16x16x32_bf16 a[124:127], v[204:207], v[44:47], a[124:127]
 v_mfma_f32_16x16x32_bf16 a[92:95], v[200:203], v[32:35], a[92:95]
 s_lshl_b32 s63, s63, 10
 v_mfma_f32_16x16x32_bf16 a[92:95], v[204:207], v[40:43], a[92:95]
 ds_read_b64_tr_b16 v[154:155], v240 offset:1032
 v_mfma_f32_16x16x32_bf16 a[88:91], v[192:195], v[32:35], a[88:91]
 s_lshl_b32 s55, s54, 7
 v_mfma_f32_16x16x32_bf16 a[88:91], v[196:199], v[40:43], a[88:91]
 v_mfma_f32_16x16x32_bf16 a[120:123], v[192:195], v[36:39], a[120:123]
 s_add_u32 s63, s63, s55
 v_mfma_f32_16x16x32_bf16 a[120:123], v[196:199], v[44:47], a[120:123]
 ds_read_b64_tr_b16 v[156:157], v242 offset:8
 v_mfma_f32_16x16x32_bf16 a[116:119], v[184:187], v[36:39], a[116:119]
 v_mov_b32 v1, s63
 v_mfma_f32_16x16x32_bf16 a[116:119], v[188:191], v[44:47], a[116:119]
 v_mfma_f32_16x16x32_bf16 a[84:87], v[184:187], v[32:35], a[84:87]
 ds_read_b64_tr_b16 v[158:159], v242 offset:1032
 s_mov_b32 s49, 0x3b38000
 v_mfma_f32_16x16x32_bf16 a[84:87], v[188:191], v[40:43], a[84:87]
 v_mfma_f32_16x16x32_bf16 a[80:83], v[176:179], v[32:35], a[80:83]
 s_mov_b32 s30, 0xf
 v_mfma_f32_16x16x32_bf16 a[80:83], v[180:183], v[40:43], a[80:83]
 v_mfma_f32_16x16x32_bf16 a[112:115], v[176:179], v[36:39], a[112:115]
 ds_read_b64_tr_b16 v[160:161], v241 offset:0
 s_mov_b32 s24, s96
 v_mfma_f32_16x16x32_bf16 a[112:115], v[180:183], v[44:47], a[112:115]
 s_and_b32 s25, s97, 0xffff
 v_mfma_f32_16x16x32_bf16 a[144:147], v[176:179], v[48:51], a[144:147]
 v_mfma_f32_16x16x32_bf16 a[144:147], v[180:183], v[56:59], a[144:147]
 ds_read_b64_tr_b16 v[162:163], v241 offset:1024
 s_mov_b32 s26, 0x400000
 v_mfma_f32_16x16x32_bf16 a[176:179], v[176:179], v[52:55], a[176:179]
 v_mfma_f32_16x16x32_bf16 a[176:179], v[180:183], v[60:63], a[176:179]
 s_mov_b32 s27, 0x20000
 v_mfma_f32_16x16x32_bf16 a[180:183], v[184:187], v[52:55], a[180:183]
 v_mfma_f32_16x16x32_bf16 a[180:183], v[188:191], v[60:63], a[180:183]
 ds_read_b64_tr_b16 v[164:165], v243 offset:0
 s_lshl_b32 s64, s60, 18
 v_mfma_f32_16x16x32_bf16 a[148:151], v[184:187], v[48:51], a[148:151]
 v_mfma_f32_16x16x32_bf16 a[148:151], v[188:191], v[56:59], a[148:151]
 s_lshl_b32 s65, s52, 16
 v_mfma_f32_16x16x32_bf16 a[152:155], v[192:195], v[48:51], a[152:155]
 ds_read_b64_tr_b16 v[166:167], v243 offset:1024
 v_mfma_f32_16x16x32_bf16 a[152:155], v[196:199], v[56:59], a[152:155]
 s_add_u32 s64, s64, s65
 v_mfma_f32_16x16x32_bf16 a[184:187], v[192:195], v[52:55], a[184:187]
 v_mfma_f32_16x16x32_bf16 a[184:187], v[196:199], v[60:63], a[184:187]
 s_lshl_b32 s65, s61, 8
 v_mfma_f32_16x16x32_bf16 a[188:191], v[200:203], v[52:55], a[188:191]
 ds_read_b64_tr_b16 v[168:169], v241 offset:8
 v_mfma_f32_16x16x32_bf16 a[188:191], v[204:207], v[60:63], a[188:191]
 s_add_u32 s64, s64, s65
 v_mfma_f32_16x16x32_bf16 a[156:159], v[200:203], v[48:51], a[156:159]
 v_mfma_f32_16x16x32_bf16 a[156:159], v[204:207], v[56:59], a[156:159]
 ds_read_b64_tr_b16 v[170:171], v241 offset:1032
 s_lshl_b32 s65, s62, 7
 v_mfma_f32_16x16x32_bf16 a[252:255], v[200:203], v[68:71], a[252:255]
 v_mfma_f32_16x16x32_bf16 a[252:255], v[204:207], v[76:79], a[252:255]
 s_add_u32 s64, s64, s65
 v_mfma_f32_16x16x32_bf16 a[220:223], v[200:203], v[64:67], a[220:223]
 v_mfma_f32_16x16x32_bf16 a[220:223], v[204:207], v[72:75], a[220:223]
 ds_read_b64_tr_b16 v[172:173], v243 offset:8
 s_add_u32 s65, s64, 0x8000
 v_mfma_f32_16x16x32_bf16 a[216:219], v[192:195], v[64:67], a[216:219]
 v_mfma_f32_16x16x32_bf16 a[216:219], v[196:199], v[72:75], a[216:219]
 v_and_b32 v5, 15, v2
 v_mfma_f32_16x16x32_bf16 a[248:251], v[192:195], v[68:71], a[248:251]
 ds_read_b64_tr_b16 v[174:175], v243 offset:1032
 v_mfma_f32_16x16x32_bf16 a[248:251], v[196:199], v[76:79], a[248:251]
 v_lshlrev_b32 v5, 11, v5
 v_mfma_f32_16x16x32_bf16 a[244:247], v[184:187], v[68:71], a[244:247]
 v_mfma_f32_16x16x32_bf16 a[244:247], v[188:191], v[76:79], a[244:247]
 v_lshrrev_b32 v13, 4, v2
 v_mfma_f32_16x16x32_bf16 a[212:215], v[184:187], v[64:67], a[212:215]
 v_mfma_f32_16x16x32_bf16 a[212:215], v[188:191], v[72:75], a[212:215]
 v_lshl_add_u32 v9, v13, 4, v5
 v_mfma_f32_16x16x32_bf16 a[208:211], v[176:179], v[64:67], a[208:211]
 v_mfma_f32_16x16x32_bf16 a[208:211], v[180:183], v[72:75], a[208:211]
 v_mfma_f32_16x16x32_bf16 a[240:243], v[176:179], v[68:71], a[240:243]
 v_mfma_f32_16x16x32_bf16 a[240:243], v[180:183], v[76:79], a[240:243]
 s_waitcnt vmcnt(0)
 s_waitcnt lgkmcnt(12)
 v_mfma_f32_16x16x32_bf16 a[64:67], v[144:147], v[96:99], a[64:67]
 v_mfma_f32_16x16x32_bf16 a[64:67], v[148:151], v[104:107], a[64:67]
 v_mfma_f32_16x16x32_bf16 a[96:99], v[144:147], v[100:103], a[96:99]
 ds_read_b64_tr_b16 v[176:177], v240 offset:4096
 v_mfma_f32_16x16x32_bf16 a[96:99], v[148:151], v[108:111], a[96:99]
 s_waitcnt lgkmcnt(9)
 v_mfma_f32_16x16x32_bf16 a[100:103], v[152:155], v[100:103], a[100:103]
 v_mfma_f32_16x16x32_bf16 a[100:103], v[156:159], v[108:111], a[100:103]
 ds_read_b64_tr_b16 v[178:179], v240 offset:5120
 v_mfma_f32_16x16x32_bf16 a[68:71], v[152:155], v[96:99], a[68:71]
 v_mfma_f32_16x16x32_bf16 a[68:71], v[156:159], v[104:107], a[68:71]
 s_waitcnt lgkmcnt(6)
 v_mfma_f32_16x16x32_bf16 a[72:75], v[160:163], v[96:99], a[72:75]
 v_mfma_f32_16x16x32_bf16 a[72:75], v[164:167], v[104:107], a[72:75]
 ds_read_b64_tr_b16 v[180:181], v242 offset:4096
 v_mfma_f32_16x16x32_bf16 a[104:107], v[160:163], v[100:103], a[104:107]
 v_mfma_f32_16x16x32_bf16 a[104:107], v[164:167], v[108:111], a[104:107]
 s_waitcnt lgkmcnt(3)
 v_mfma_f32_16x16x32_bf16 a[108:111], v[168:171], v[100:103], a[108:111]
 ds_read_b64_tr_b16 v[182:183], v242 offset:5120
 v_mfma_f32_16x16x32_bf16 a[108:111], v[172:175], v[108:111], a[108:111]
 v_mfma_f32_16x16x32_bf16 a[76:79], v[168:171], v[96:99], a[76:79]
 v_mfma_f32_16x16x32_bf16 a[76:79], v[172:175], v[104:107], a[76:79]
 v_mfma_f32_16x16x32_bf16 a[172:175], v[168:171], v[116:119], a[172:175]
 ds_read_b64_tr_b16 v[184:185], v240 offset:4104
 v_mfma_f32_16x16x32_bf16 a[172:175], v[172:175], v[124:127], a[172:175]
 v_mfma_f32_16x16x32_bf16 a[140:143], v[168:171], v[112:115], a[140:143]
 ds_write_b128 v208, a[64:67] offset:0
 v_mfma_f32_16x16x32_bf16 a[140:143], v[172:175], v[120:123], a[140:143]
 ds_read_b64_tr_b16 v[186:187], v240 offset:5128
 ds_write_b128 v208, a[68:71] offset:1024
 v_mfma_f32_16x16x32_bf16 a[136:139], v[160:163], v[112:115], a[136:139]
 v_mfma_f32_16x16x32_bf16 a[136:139], v[164:167], v[120:123], a[136:139]
 ds_write_b128 v208, a[72:75] offset:2048
 v_mfma_f32_16x16x32_bf16 a[168:171], v[160:163], v[116:119], a[168:171]
 v_mfma_f32_16x16x32_bf16 a[168:171], v[164:167], v[124:127], a[168:171]
 ds_read_b64_tr_b16 v[188:189], v242 offset:4104
 ds_write_b128 v208, a[76:79] offset:3072
 v_mfma_f32_16x16x32_bf16 a[164:167], v[152:155], v[116:119], a[164:167]
 v_mfma_f32_16x16x32_bf16 a[164:167], v[156:159], v[124:127], a[164:167]
 ds_write_b128 v208, a[96:99] offset:4096
 v_mfma_f32_16x16x32_bf16 a[132:135], v[152:155], v[112:115], a[132:135]
 ds_read_b64_tr_b16 v[190:191], v242 offset:5128
 ds_write_b128 v208, a[100:103] offset:5120
 v_mfma_f32_16x16x32_bf16 a[132:135], v[156:159], v[120:123], a[132:135]
 v_mfma_f32_16x16x32_bf16 a[128:131], v[144:147], v[112:115], a[128:131]
 ds_write_b128 v208, a[104:107] offset:6144
 v_mfma_f32_16x16x32_bf16 a[128:131], v[148:151], v[120:123], a[128:131]
 v_mfma_f32_16x16x32_bf16 a[160:163], v[144:147], v[116:119], a[160:163]
 ds_read_b64_tr_b16 v[192:193], v241 offset:4096
 ds_write_b128 v208, a[108:111] offset:7168
 v_mfma_f32_16x16x32_bf16 a[160:163], v[148:151], v[124:127], a[160:163]
 v_mfma_f32_16x16x32_bf16 a[192:195], v[144:147], v[128:131], a[192:195]
 v_mfma_f32_16x16x32_bf16 a[192:195], v[148:151], v[136:139], a[192:195]
 ds_read_b64_tr_b16 v[194:195], v241 offset:5120
 v_mfma_f32_16x16x32_bf16 a[224:227], v[144:147], v[132:135], a[224:227]
 ds_write_b128 v209, a[128:131] offset:0
 v_mfma_f32_16x16x32_bf16 a[224:227], v[148:151], v[140:143], a[224:227]
 ds_write_b128 v209, a[132:135] offset:1024
 v_mfma_f32_16x16x32_bf16 a[228:231], v[152:155], v[132:135], a[228:231]
 v_mfma_f32_16x16x32_bf16 a[228:231], v[156:159], v[140:143], a[228:231]
 ds_read_b64_tr_b16 v[196:197], v243 offset:4096
 ds_write_b128 v209, a[136:139] offset:2048
 v_mfma_f32_16x16x32_bf16 a[196:199], v[152:155], v[128:131], a[196:199]
 v_mfma_f32_16x16x32_bf16 a[196:199], v[156:159], v[136:139], a[196:199]
 ds_write_b128 v209, a[140:143] offset:3072
 v_mfma_f32_16x16x32_bf16 a[200:203], v[160:163], v[128:131], a[200:203]
 ds_read_b64_tr_b16 v[198:199], v243 offset:5120
 v_mfma_f32_16x16x32_bf16 a[200:203], v[164:167], v[136:139], a[200:203]
 ds_write_b128 v209, a[160:163] offset:4096
 v_mfma_f32_16x16x32_bf16 a[232:235], v[160:163], v[132:135], a[232:235]
 ds_write_b128 v209, a[164:167] offset:5120
 v_mfma_f32_16x16x32_bf16 a[232:235], v[164:167], v[140:143], a[232:235]
 v_mfma_f32_16x16x32_bf16 a[236:239], v[168:171], v[132:135], a[236:239]
 ds_read_b64_tr_b16 v[200:201], v241 offset:4104
 ds_write_b128 v209, a[168:171] offset:6144
 v_mfma_f32_16x16x32_bf16 a[236:239], v[172:175], v[140:143], a[236:239]
 v_mfma_f32_16x16x32_bf16 a[204:207], v[168:171], v[128:131], a[204:207]
 ds_write_b128 v209, a[172:175] offset:7168
 v_mfma_f32_16x16x32_bf16 a[204:207], v[172:175], v[136:139], a[204:207]
 ds_read_b64_tr_b16 v[202:203], v241 offset:5128
 v_mfma_f32_16x16x32_bf16 a[44:47], v[168:171], v[84:87], a[44:47]
 v_mfma_f32_16x16x32_bf16 a[44:47], v[172:175], v[92:95], a[44:47]
 v_mfma_f32_16x16x32_bf16 a[12:15], v[168:171], v[80:83], a[12:15]
 ds_write_b128 v210, a[192:195] offset:0
 v_mfma_f32_16x16x32_bf16 a[12:15], v[172:175], v[88:91], a[12:15]
 ds_read_b64_tr_b16 v[204:205], v243 offset:4104
 ds_write_b128 v210, a[196:199] offset:1024
 v_mfma_f32_16x16x32_bf16 a[8:11], v[160:163], v[80:83], a[8:11]
 v_mfma_f32_16x16x32_bf16 a[8:11], v[164:167], v[88:91], a[8:11]
 ds_write_b128 v210, a[200:203] offset:2048
 v_mfma_f32_16x16x32_bf16 a[40:43], v[160:163], v[84:87], a[40:43]
 ds_read_b64_tr_b16 v[206:207], v243 offset:5128
 v_mfma_f32_16x16x32_bf16 a[40:43], v[164:167], v[92:95], a[40:43]
 ds_write_b128 v210, a[204:207] offset:3072
 v_mfma_f32_16x16x32_bf16 a[36:39], v[152:155], v[84:87], a[36:39]
 v_mfma_f32_16x16x32_bf16 a[36:39], v[156:159], v[92:95], a[36:39]
 ds_write_b128 v210, a[224:227] offset:4096
 v_mfma_f32_16x16x32_bf16 a[4:7], v[152:155], v[80:83], a[4:7]
 ds_write_b128 v210, a[228:231] offset:5120
 v_mfma_f32_16x16x32_bf16 a[4:7], v[156:159], v[88:91], a[4:7]
 v_mfma_f32_16x16x32_bf16 a[0:3], v[144:147], v[80:83], a[0:3]
 ds_write_b128 v210, a[232:235] offset:6144
 v_mfma_f32_16x16x32_bf16 a[0:3], v[148:151], v[88:91], a[0:3]
 v_mfma_f32_16x16x32_bf16 a[32:35], v[144:147], v[84:87], a[32:35]
 ds_write_b128 v210, a[236:239] offset:7168
 v_mfma_f32_16x16x32_bf16 a[32:35], v[148:151], v[92:95], a[32:35]
 s_nop 4
 v_accvgpr_read_b32 v16, a0
 v_accvgpr_read_b32 v17, a1
 v_accvgpr_read_b32 v18, a2
 v_accvgpr_read_b32 v19, a3
 v_accvgpr_read_b32 v20, a4
 v_accvgpr_read_b32 v21, a5
 v_accvgpr_read_b32 v22, a6
 v_accvgpr_read_b32 v23, a7
 v_accvgpr_read_b32 v24, a8
 v_accvgpr_read_b32 v25, a9
 v_accvgpr_read_b32 v26, a10
 v_accvgpr_read_b32 v27, a11
 v_accvgpr_read_b32 v28, a12
 v_accvgpr_read_b32 v29, a13
 v_accvgpr_read_b32 v30, a14
 v_accvgpr_read_b32 v31, a15
 v_accvgpr_read_b32 v32, a32
 v_accvgpr_read_b32 v33, a33
 v_accvgpr_read_b32 v34, a34
 v_accvgpr_read_b32 v35, a35
 v_accvgpr_read_b32 v36, a36
 v_accvgpr_read_b32 v37, a37
 v_accvgpr_read_b32 v38, a38
 v_accvgpr_read_b32 v39, a39
 v_accvgpr_read_b32 v40, a40
 v_accvgpr_read_b32 v41, a41
 v_accvgpr_read_b32 v42, a42
 v_accvgpr_read_b32 v43, a43
 v_accvgpr_read_b32 v44, a44
 v_accvgpr_read_b32 v45, a45
 v_accvgpr_read_b32 v46, a46
 v_accvgpr_read_b32 v47, a47
 s_waitcnt lgkmcnt(0)
 s_barrier
 ds_read_b128 v[48:51], v213 offset:0
 ds_read_b128 v[52:55], v213 offset:1024
 ds_read_b128 v[56:59], v213 offset:2048
 ds_read_b128 v[60:63], v213 offset:3072
 ds_read_b128 v[64:67], v213 offset:4096
 ds_read_b128 v[68:71], v213 offset:5120
 ds_read_b128 v[72:75], v213 offset:6144
 ds_read_b128 v[76:79], v213 offset:7168
 ds_read_b128 v[144:147], v214 offset:0
 ds_read_b128 v[148:151], v214 offset:1024
 ds_read_b128 v[152:155], v214 offset:2048
 ds_read_b128 v[156:159], v214 offset:3072
 ds_read_b128 v[160:163], v214 offset:4096
 ds_read_b128 v[164:167], v214 offset:5120
 ds_read_b128 v[168:171], v214 offset:6144
 ds_read_b128 v[172:175], v214 offset:7168
 s_waitcnt lgkmcnt(8)
 v_pk_add_f32 v[16:17], v[16:17], v[48:49]
 v_pk_add_f32 v[18:19], v[18:19], v[50:51]
 v_pk_add_f32 v[20:21], v[20:21], v[52:53]
 v_pk_add_f32 v[22:23], v[22:23], v[54:55]
 v_pk_add_f32 v[24:25], v[24:25], v[56:57]
 v_pk_add_f32 v[26:27], v[26:27], v[58:59]
 v_pk_add_f32 v[28:29], v[28:29], v[60:61]
 v_pk_add_f32 v[30:31], v[30:31], v[62:63]
 v_pk_add_f32 v[32:33], v[32:33], v[64:65]
 v_pk_add_f32 v[34:35], v[34:35], v[66:67]
 v_pk_add_f32 v[36:37], v[36:37], v[68:69]
 v_pk_add_f32 v[38:39], v[38:39], v[70:71]
 v_pk_add_f32 v[40:41], v[40:41], v[72:73]
 v_pk_add_f32 v[42:43], v[42:43], v[74:75]
 v_pk_add_f32 v[44:45], v[44:45], v[76:77]
 v_pk_add_f32 v[46:47], v[46:47], v[78:79]
 ds_read_b128 v[48:51], v215 offset:0
 ds_read_b128 v[52:55], v215 offset:1024
 ds_read_b128 v[56:59], v215 offset:2048
 ds_read_b128 v[60:63], v215 offset:3072
 ds_read_b128 v[64:67], v215 offset:4096
 ds_read_b128 v[68:71], v215 offset:5120
 ds_read_b128 v[72:75], v215 offset:6144
 ds_read_b128 v[76:79], v215 offset:7168
 s_waitcnt lgkmcnt(8)
 v_pk_add_f32 v[16:17], v[16:17], v[144:145]
 v_pk_add_f32 v[18:19], v[18:19], v[146:147]
 v_pk_add_f32 v[20:21], v[20:21], v[148:149]
 v_pk_add_f32 v[22:23], v[22:23], v[150:151]
 v_pk_add_f32 v[24:25], v[24:25], v[152:153]
 v_pk_add_f32 v[26:27], v[26:27], v[154:155]
 v_pk_add_f32 v[28:29], v[28:29], v[156:157]
 v_pk_add_f32 v[30:31], v[30:31], v[158:159]
 v_pk_add_f32 v[32:33], v[32:33], v[160:161]
 v_pk_add_f32 v[34:35], v[34:35], v[162:163]
 v_pk_add_f32 v[36:37], v[36:37], v[164:165]
 v_pk_add_f32 v[38:39], v[38:39], v[166:167]
 v_pk_add_f32 v[40:41], v[40:41], v[168:169]
 v_pk_add_f32 v[42:43], v[42:43], v[170:171]
 v_pk_add_f32 v[44:45], v[44:45], v[172:173]
 v_pk_add_f32 v[46:47], v[46:47], v[174:175]
 s_waitcnt lgkmcnt(0)
 v_pk_add_f32 v[16:17], v[16:17], v[48:49]
 v_pk_add_f32 v[18:19], v[18:19], v[50:51]
 v_pk_add_f32 v[20:21], v[20:21], v[52:53]
 v_pk_add_f32 v[22:23], v[22:23], v[54:55]
 v_pk_add_f32 v[24:25], v[24:25], v[56:57]
 v_pk_add_f32 v[26:27], v[26:27], v[58:59]
 v_pk_add_f32 v[28:29], v[28:29], v[60:61]
 v_pk_add_f32 v[30:31], v[30:31], v[62:63]
 v_pk_add_f32 v[32:33], v[32:33], v[64:65]
 v_pk_add_f32 v[34:35], v[34:35], v[66:67]
 v_pk_add_f32 v[36:37], v[36:37], v[68:69]
 v_pk_add_f32 v[38:39], v[38:39], v[70:71]
 v_pk_add_f32 v[40:41], v[40:41], v[72:73]
 v_pk_add_f32 v[42:43], v[42:43], v[74:75]
 v_pk_add_f32 v[44:45], v[44:45], v[76:77]
 v_pk_add_f32 v[46:47], v[46:47], v[78:79]
 v_mfma_f32_16x16x32_bf16 a[80:83], v[176:179], v[96:99], a[80:83]
 buffer_store_dwordx4 v[16:19], v10, s[20:23], s56 offen offset:0 sc1
 v_mfma_f32_16x16x32_bf16 a[80:83], v[180:183], v[104:107], a[80:83]
 v_mfma_f32_16x16x32_bf16 a[112:115], v[176:179], v[100:103], a[112:115]
 buffer_store_dwordx4 v[20:23], v10, s[20:23], s56 offen offset:1024 sc1
 v_mfma_f32_16x16x32_bf16 a[112:115], v[180:183], v[108:111], a[112:115]
 v_mfma_f32_16x16x32_bf16 a[116:119], v[184:187], v[100:103], a[116:119]
 buffer_store_dwordx4 v[24:27], v10, s[20:23], s56 offen offset:2048 sc1
 v_mfma_f32_16x16x32_bf16 a[116:119], v[188:191], v[108:111], a[116:119]
 v_mfma_f32_16x16x32_bf16 a[84:87], v[184:187], v[96:99], a[84:87]
 buffer_store_dwordx4 v[28:31], v10, s[20:23], s56 offen offset:3072 sc1
 v_mfma_f32_16x16x32_bf16 a[84:87], v[188:191], v[104:107], a[84:87]
 v_mfma_f32_16x16x32_bf16 a[88:91], v[192:195], v[96:99], a[88:91]
 buffer_store_dwordx4 v[32:35], v10, s[20:23], s58 offen offset:0 sc1
 v_mfma_f32_16x16x32_bf16 a[88:91], v[196:199], v[104:107], a[88:91]
 v_mfma_f32_16x16x32_bf16 a[120:123], v[192:195], v[100:103], a[120:123]
 buffer_store_dwordx4 v[36:39], v10, s[20:23], s58 offen offset:1024 sc1
 v_mfma_f32_16x16x32_bf16 a[120:123], v[196:199], v[108:111], a[120:123]
 v_mfma_f32_16x16x32_bf16 a[124:127], v[200:203], v[100:103], a[124:127]
 buffer_store_dwordx4 v[40:43], v10, s[20:23], s58 offen offset:2048 sc1
 v_mfma_f32_16x16x32_bf16 a[124:127], v[204:207], v[108:111], a[124:127]
 v_mfma_f32_16x16x32_bf16 a[92:95], v[200:203], v[96:99], a[92:95]
 buffer_store_dwordx4 v[44:47], v10, s[20:23], s58 offen offset:3072 sc1
 v_mfma_f32_16x16x32_bf16 a[92:95], v[204:207], v[104:107], a[92:95]
 v_mfma_f32_16x16x32_bf16 a[188:191], v[200:203], v[116:119], a[188:191]
 v_mfma_f32_16x16x32_bf16 a[188:191], v[204:207], v[124:127], a[188:191]
 v_mfma_f32_16x16x32_bf16 a[156:159], v[200:203], v[112:115], a[156:159]
 ds_write_b128 v211, a[80:83] offset:0
 v_mfma_f32_16x16x32_bf16 a[156:159], v[204:207], v[120:123], a[156:159]
 ds_write_b128 v211, a[84:87] offset:1024
 v_mfma_f32_16x16x32_bf16 a[152:155], v[192:195], v[112:115], a[152:155]
 v_mfma_f32_16x16x32_bf16 a[152:155], v[196:199], v[120:123], a[152:155]
 ds_write_b128 v211, a[88:91] offset:2048
 v_mfma_f32_16x16x32_bf16 a[184:187], v[192:195], v[116:119], a[184:187]
 v_mfma_f32_16x16x32_bf16 a[184:187], v[196:199], v[124:127], a[184:187]
 ds_write_b128 v211, a[92:95] offset:3072
 v_mfma_f32_16x16x32_bf16 a[180:183], v[184:187], v[116:119], a[180:183]
 v_mfma_f32_16x16x32_bf16 a[180:183], v[188:191], v[124:127], a[180:183]
 ds_write_b128 v211, a[112:115] offset:4096
 v_mfma_f32_16x16x32_bf16 a[148:151], v[184:187], v[112:115], a[148:151]
 ds_write_b128 v211, a[116:119] offset:5120
 v_mfma_f32_16x16x32_bf16 a[148:151], v[188:191], v[120:123], a[148:151]
 v_mfma_f32_16x16x32_bf16 a[144:147], v[176:179], v[112:115], a[144:147]
 ds_write_b128 v211, a[120:123] offset:6144
 v_mfma_f32_16x16x32_bf16 a[144:147], v[180:183], v[120:123], a[144:147]
 v_mfma_f32_16x16x32_bf16 a[176:179], v[176:179], v[116:119], a[176:179]
 ds_write_b128 v211, a[124:127] offset:7168
 v_mfma_f32_16x16x32_bf16 a[176:179], v[180:183], v[124:127], a[176:179]
 v_mfma_f32_16x16x32_bf16 a[208:211], v[176:179], v[128:131], a[208:211]
 v_mfma_f32_16x16x32_bf16 a[208:211], v[180:183], v[136:139], a[208:211]
 v_mfma_f32_16x16x32_bf16 a[240:243], v[176:179], v[132:135], a[240:243]
 s_nop 1
 ds_write_b128 v212, a[144:147] offset:0
 v_mfma_f32_16x16x32_bf16 a[240:243], v[180:183], v[140:143], a[240:243]
 ds_write_b128 v212, a[148:151] offset:1024
 v_mfma_f32_16x16x32_bf16 a[244:247], v[184:187], v[132:135], a[244:247]
 v_mfma_f32_16x16x32_bf16 a[244:247], v[188:191], v[140:143], a[244:247]
 ds_write_b128 v212, a[152:155] offset:2048
 v_mfma_f32_16x16x32_bf16 a[212:215], v[184:187], v[128:131], a[212:215]
 v_mfma_f32_16x16x32_bf16 a[212:215], v[188:191], v[136:139], a[212:215]
 ds_write_b128 v212, a[156:159] offset:3072
 v_mfma_f32_16x16x32_bf16 a[216:219], v[192:195], v[128:131], a[216:219]
 v_mfma_f32_16x16x32_bf16 a[216:219], v[196:199], v[136:139], a[216:219]
 ds_write_b128 v212, a[176:179] offset:4096
 v_mfma_f32_16x16x32_bf16 a[248:251], v[192:195], v[132:135], a[248:251]
 ds_write_b128 v212, a[180:183] offset:5120
 v_mfma_f32_16x16x32_bf16 a[248:251], v[196:199], v[140:143], a[248:251]
 v_mfma_f32_16x16x32_bf16 a[252:255], v[200:203], v[132:135], a[252:255]
 ds_write_b128 v212, a[184:187] offset:6144
 v_mfma_f32_16x16x32_bf16 a[252:255], v[204:207], v[140:143], a[252:255]
 v_mfma_f32_16x16x32_bf16 a[220:223], v[200:203], v[128:131], a[220:223]
 ds_write_b128 v212, a[188:191] offset:7168
 v_mfma_f32_16x16x32_bf16 a[220:223], v[204:207], v[136:139], a[220:223]
 v_mfma_f32_16x16x32_bf16 a[60:63], v[200:203], v[84:87], a[60:63]
 v_mfma_f32_16x16x32_bf16 a[60:63], v[204:207], v[92:95], a[60:63]
 v_mfma_f32_16x16x32_bf16 a[28:31], v[200:203], v[80:83], a[28:31]
 v_mfma_f32_16x16x32_bf16 a[28:31], v[204:207], v[88:91], a[28:31]
 v_mfma_f32_16x16x32_bf16 a[24:27], v[192:195], v[80:83], a[24:27]
 v_mfma_f32_16x16x32_bf16 a[24:27], v[196:199], v[88:91], a[24:27]
 v_mfma_f32_16x16x32_bf16 a[56:59], v[192:195], v[84:87], a[56:59]
 v_mfma_f32_16x16x32_bf16 a[56:59], v[196:199], v[92:95], a[56:59]
 v_mfma_f32_16x16x32_bf16 a[52:55], v[184:187], v[84:87], a[52:55]
 v_mfma_f32_16x16x32_bf16 a[52:55], v[188:191], v[92:95], a[52:55]
 v_mfma_f32_16x16x32_bf16 a[20:23], v[184:187], v[80:83], a[20:23]
 v_mfma_f32_16x16x32_bf16 a[20:23], v[188:191], v[88:91], a[20:23]
 v_mfma_f32_16x16x32_bf16 a[16:19], v[176:179], v[80:83], a[16:19]
 v_mfma_f32_16x16x32_bf16 a[16:19], v[180:183], v[88:91], a[16:19]
 v_mfma_f32_16x16x32_bf16 a[48:51], v[176:179], v[84:87], a[48:51]
 v_mfma_f32_16x16x32_bf16 a[48:51], v[180:183], v[92:95], a[48:51]
 s_waitcnt vmcnt(0)
 s_barrier
 v_mov_b32 v13, 0x40000000
 v_writelane_b32 v13, s33, 0
 v_mov_b32 v5, s89
 s_mov_b32 s66, 0x3b38000
 buffer_store_dword v5, v13, s[20:23], s66 offen sc1
 ds_write_b128 v208, a[208:211] offset:0
 ds_write_b128 v208, a[212:215] offset:1024
 ds_write_b128 v208, a[216:219] offset:2048
 ds_write_b128 v208, a[220:223] offset:3072
 ds_write_b128 v208, a[240:243] offset:4096
 ds_write_b128 v208, a[244:247] offset:5120
 ds_write_b128 v208, a[248:251] offset:6144
 ds_write_b128 v208, a[252:255] offset:7168
 v_accvgpr_read_b32 v160, a16
 v_accvgpr_read_b32 v161, a17
 v_accvgpr_read_b32 v162, a18
 v_accvgpr_read_b32 v163, a19
 v_accvgpr_read_b32 v164, a20
 v_accvgpr_read_b32 v165, a21
 v_accvgpr_read_b32 v166, a22
 v_accvgpr_read_b32 v167, a23
 v_accvgpr_read_b32 v168, a24
 v_accvgpr_read_b32 v169, a25
 v_accvgpr_read_b32 v170, a26
 v_accvgpr_read_b32 v171, a27
 v_accvgpr_read_b32 v172, a28
 v_accvgpr_read_b32 v173, a29
 v_accvgpr_read_b32 v174, a30
 v_accvgpr_read_b32 v175, a31
 v_accvgpr_read_b32 v176, a48
 v_accvgpr_read_b32 v177, a49
 v_accvgpr_read_b32 v178, a50
 v_accvgpr_read_b32 v179, a51
 v_accvgpr_read_b32 v180, a52
 v_accvgpr_read_b32 v181, a53
 v_accvgpr_read_b32 v182, a54
 v_accvgpr_read_b32 v183, a55
 v_accvgpr_read_b32 v184, a56
 v_accvgpr_read_b32 v185, a57
 v_accvgpr_read_b32 v186, a58
 v_accvgpr_read_b32 v187, a59
 v_accvgpr_read_b32 v188, a60
 v_accvgpr_read_b32 v189, a61
 v_accvgpr_read_b32 v190, a62
 v_accvgpr_read_b32 v191, a63
 s_waitcnt lgkmcnt(0)
 s_barrier
 ds_read_b128 v[48:51], v216 offset:0
 ds_read_b128 v[52:55], v216 offset:1024
 ds_read_b128 v[56:59], v216 offset:2048
 ds_read_b128 v[60:63], v216 offset:3072
 ds_read_b128 v[64:67], v216 offset:4096
 ds_read_b128 v[68:71], v216 offset:5120
 ds_read_b128 v[72:75], v216 offset:6144
 ds_read_b128 v[76:79], v216 offset:7168
 ds_read_b128 v[80:83], v217 offset:0
 ds_read_b128 v[84:87], v217 offset:1024
 ds_read_b128 v[88:91], v217 offset:2048
 ds_read_b128 v[92:95], v217 offset:3072
 ds_read_b128 v[96:99], v217 offset:4096
 ds_read_b128 v[100:103], v217 offset:5120
 ds_read_b128 v[104:107], v217 offset:6144
 ds_read_b128 v[108:111], v217 offset:7168
 ds_read_b128 v[112:115], v218 offset:0
 ds_read_b128 v[116:119], v218 offset:1024
 ds_read_b128 v[120:123], v218 offset:2048
 ds_read_b128 v[124:127], v218 offset:3072
 ds_read_b128 v[128:131], v218 offset:4096
 ds_read_b128 v[132:135], v218 offset:5120
 ds_read_b128 v[136:139], v218 offset:6144
 ds_read_b128 v[140:143], v218 offset:7168
 buffer_load_dword v13, v1, s[20:23], s49 offen sc1
 s_waitcnt lgkmcnt(0)
 v_pk_add_f32 v[160:161], v[160:161], v[48:49]
 v_pk_add_f32 v[162:163], v[162:163], v[50:51]
 v_pk_add_f32 v[164:165], v[164:165], v[52:53]
 v_pk_add_f32 v[166:167], v[166:167], v[54:55]
 v_pk_add_f32 v[168:169], v[168:169], v[56:57]
 v_pk_add_f32 v[170:171], v[170:171], v[58:59]
 v_pk_add_f32 v[172:173], v[172:173], v[60:61]
 v_pk_add_f32 v[174:175], v[174:175], v[62:63]
 v_pk_add_f32 v[176:177], v[176:177], v[64:65]
 v_pk_add_f32 v[178:179], v[178:179], v[66:67]
 v_pk_add_f32 v[180:181], v[180:181], v[68:69]
 v_pk_add_f32 v[182:183], v[182:183], v[70:71]
 v_pk_add_f32 v[184:185], v[184:185], v[72:73]
 v_pk_add_f32 v[186:187], v[186:187], v[74:75]
 v_pk_add_f32 v[188:189], v[188:189], v[76:77]
 v_pk_add_f32 v[190:191], v[190:191], v[78:79]
 v_pk_add_f32 v[160:161], v[160:161], v[80:81]
 v_pk_add_f32 v[162:163], v[162:163], v[82:83]
 v_pk_add_f32 v[164:165], v[164:165], v[84:85]
 v_pk_add_f32 v[166:167], v[166:167], v[86:87]
 v_pk_add_f32 v[168:169], v[168:169], v[88:89]
 v_pk_add_f32 v[170:171], v[170:171], v[90:91]
 v_pk_add_f32 v[172:173], v[172:173], v[92:93]
 v_pk_add_f32 v[174:175], v[174:175], v[94:95]
 v_pk_add_f32 v[176:177], v[176:177], v[96:97]
 v_pk_add_f32 v[178:179], v[178:179], v[98:99]
 v_pk_add_f32 v[180:181], v[180:181], v[100:101]
 v_pk_add_f32 v[182:183], v[182:183], v[102:103]
 v_pk_add_f32 v[184:185], v[184:185], v[104:105]
 v_pk_add_f32 v[186:187], v[186:187], v[106:107]
 v_pk_add_f32 v[188:189], v[188:189], v[108:109]
 v_pk_add_f32 v[190:191], v[190:191], v[110:111]
 v_pk_add_f32 v[160:161], v[160:161], v[112:113]
 v_pk_add_f32 v[162:163], v[162:163], v[114:115]
 v_pk_add_f32 v[164:165], v[164:165], v[116:117]
 v_pk_add_f32 v[166:167], v[166:167], v[118:119]
 v_pk_add_f32 v[168:169], v[168:169], v[120:121]
 v_pk_add_f32 v[170:171], v[170:171], v[122:123]
 v_pk_add_f32 v[172:173], v[172:173], v[124:125]
 v_pk_add_f32 v[174:175], v[174:175], v[126:127]
 v_pk_add_f32 v[176:177], v[176:177], v[128:129]
 v_pk_add_f32 v[178:179], v[178:179], v[130:131]
 v_pk_add_f32 v[180:181], v[180:181], v[132:133]
 v_pk_add_f32 v[182:183], v[182:183], v[134:135]
 v_pk_add_f32 v[184:185], v[184:185], v[136:137]
 v_pk_add_f32 v[186:187], v[186:187], v[138:139]
 v_pk_add_f32 v[188:189], v[188:189], v[140:141]
 v_pk_add_f32 v[190:191], v[190:191], v[142:143]
 s_waitcnt vmcnt(0)
 v_cmp_ne_u32 vcc, s89, v13
 s_nop 0
 s_and_b64 vcc, vcc, s[30:31]
 s_cbranch_vccnz K3_spin2
K3_spin2_b:
 buffer_load_dwordx4 v[64:67], v10, s[20:23], s57 offen offset:0 sc1
 buffer_load_dwordx4 v[68:71], v10, s[20:23], s57 offen offset:1024 sc1
 buffer_load_dwordx4 v[72:75], v10, s[20:23], s57 offen offset:2048 sc1
 buffer_load_dwordx4 v[76:79], v10, s[20:23], s57 offen offset:3072 sc1
 buffer_load_dwordx4 v[80:83], v10, s[20:23], s59 offen offset:0 sc1
 buffer_load_dwordx4 v[84:87], v10, s[20:23], s59 offen offset:1024 sc1
 buffer_load_dwordx4 v[88:91], v10, s[20:23], s59 offen offset:2048 sc1
 buffer_load_dwordx4 v[92:95], v10, s[20:23], s59 offen offset:3072 sc1
 s_waitcnt vmcnt(6)
 v_pk_add_f32 v[160:161], v[160:161], v[64:65]
 v_pk_add_f32 v[162:163], v[162:163], v[66:67]
 v_pk_add_f32 v[164:165], v[164:165], v[68:69]
 v_pk_add_f32 v[166:167], v[166:167], v[70:71]
 v_cvt_pk_bf16_f32 v160, v160, v161
 v_cvt_pk_bf16_f32 v161, v162, v163
 v_cvt_pk_bf16_f32 v162, v164, v165
 v_cvt_pk_bf16_f32 v163, v166, v167
 buffer_store_dwordx4 v[160:163], v9, s[24:27], s64 offen offset:0 sc1
 s_waitcnt vmcnt(5)
 v_pk_add_f32 v[168:169], v[168:169], v[72:73]
 v_pk_add_f32 v[170:171], v[170:171], v[74:75]
 v_pk_add_f32 v[172:173], v[172:173], v[76:77]
 v_pk_add_f32 v[174:175], v[174:175], v[78:79]
 v_cvt_pk_bf16_f32 v168, v168, v169
 v_cvt_pk_bf16_f32 v169, v170, v171
 v_cvt_pk_bf16_f32 v170, v172, v173
 v_cvt_pk_bf16_f32 v171, v174, v175
 buffer_store_dwordx4 v[168:171], v9, s[24:27], s64 offen offset:64 sc1
 s_waitcnt vmcnt(4)
 v_pk_add_f32 v[176:177], v[176:177], v[80:81]
 v_pk_add_f32 v[178:179], v[178:179], v[82:83]
 v_pk_add_f32 v[180:181], v[180:181], v[84:85]
 v_pk_add_f32 v[182:183], v[182:183], v[86:87]
 v_cvt_pk_bf16_f32 v176, v176, v177
 v_cvt_pk_bf16_f32 v177, v178, v179
 v_cvt_pk_bf16_f32 v178, v180, v181
 v_cvt_pk_bf16_f32 v179, v182, v183
 buffer_store_dwordx4 v[176:179], v9, s[24:27], s65 offen offset:0 sc1
 s_waitcnt vmcnt(3)
 v_pk_add_f32 v[184:185], v[184:185], v[88:89]
 v_pk_add_f32 v[186:187], v[186:187], v[90:91]
 v_pk_add_f32 v[188:189], v[188:189], v[92:93]
 v_pk_add_f32 v[190:191], v[190:191], v[94:95]
 v_cvt_pk_bf16_f32 v184, v184, v185
 v_cvt_pk_bf16_f32 v185, v186, v187
 v_cvt_pk_bf16_f32 v186, v188, v189
 v_cvt_pk_bf16_f32 v187, v190, v191
 buffer_store_dwordx4 v[184:187], v9, s[24:27], s65 offen offset:64 sc1
F_end:
 s_endpgm
F_spin0:
 s_mov_b32 s88, 0
F_spin0_l:
 s_sleep 4
 buffer_load_dword v60, off, s[36:39], 0 sc1
 s_waitcnt vmcnt(0)
 v_readfirstlane_b32 s89, v60
 s_add_u32 s88, s88, 1
 s_cmp_gt_u32 s88, 0x80000
 s_cbranch_scc1 F_spin0_b
 s_cmp_eq_u32 s89, 0
 s_cbranch_scc1 F_spin0_l
 s_branch F_spin0_b
F_spin1:
 s_mov_b32 s88, 0
F_spin1_l:
 s_sleep 4
 buffer_load_dword v59, v39, s[20:23], s32 offen sc1
 s_waitcnt vmcnt(0)
 v_cmp_ne_u32 vcc, s89, v59
 s_nop 0
 s_and_b64 vcc, vcc, s[66:67]
 s_add_u32 s88, s88, 1
 s_cmp_gt_u32 s88, 0x80000
 s_cbranch_scc1 F_spin1_b
 s_cbranch_vccnz F_spin1_l
 s_branch F_spin1_b
K2_mask0:
 v_add_f32 v232, 0x00000000, v230
 v_min_f32 v80, v80, v232
 v_add_f32 v233, 0xdf800000, v230
 v_min_f32 v81, v81, v233
 v_add_f32 v234, 0xe0000000, v230
 v_min_f32 v82, v82, v234
 v_add_f32 v235, 0xe0400000, v230
 v_min_f32 v83, v83, v235
 v_add_f32 v232, 0xe1000000, v230
 v_min_f32 v84, v84, v232
 v_add_f32 v233, 0xe1100000, v230
 v_min_f32 v85, v85, v233
 v_add_f32 v234, 0xe1200000, v230
 v_min_f32 v86, v86, v234
 v_add_f32 v235, 0xe1300000, v230
 v_min_f32 v87, v87, v235
 v_add_f32 v232, 0xe1800000, v230
 v_min_f32 v88, v88, v232
 v_add_f32 v233, 0xe1880000, v230
 v_min_f32 v89, v89, v233
 v_add_f32 v234, 0xe1900000, v230
 v_min_f32 v90, v90, v234
 v_add_f32 v235, 0xe1980000, v230
 v_min_f32 v91, v91, v235
 v_add_f32 v232, 0xe1c00000, v230
 v_min_f32 v92, v92, v232
 v_add_f32 v233, 0xe1c80000, v230
 v_min_f32 v93, v93, v233
 v_add_f32 v234, 0xe1d00000, v230
 v_min_f32 v94, v94, v234
 v_add_f32 v235, 0xe1d80000, v230
 v_min_f32 v95, v95, v235
 v_add_f32 v230, 0xe2000000, v230
 s_branch K2_mask0_b
K2_mask1:
 v_add_f32 v232, 0x00000000, v230
 v_min_f32 v144, v144, v232
 v_add_f32 v233, 0xdf800000, v230
 v_min_f32 v145, v145, v233
 v_add_f32 v234, 0xe0000000, v230
 v_min_f32 v146, v146, v234
 v_add_f32 v235, 0xe0400000, v230
 v_min_f32 v147, v147, v235
 v_add_f32 v232, 0xe1000000, v230
 v_min_f32 v148, v148, v232
 v_add_f32 v233, 0xe1100000, v230
 v_min_f32 v149, v149, v233
 v_add_f32 v234, 0xe1200000, v230
 v_min_f32 v150, v150, v234
 v_add_f32 v235, 0xe1300000, v230
 v_min_f32 v151, v151, v235
 v_add_f32 v232, 0xe1800000, v230
 v_min_f32 v152, v152, v232
 v_add_f32 v233, 0xe1880000, v230
 v_min_f32 v153, v153, v233
 v_add_f32 v234, 0xe1900000, v230
 v_min_f32 v154, v154, v234
 v_add_f32 v235, 0xe1980000, v230
 v_min_f32 v155, v155, v235
 v_add_f32 v232, 0xe1c00000, v230
 v_min_f32 v156, v156, v232
 v_add_f32 v233, 0xe1c80000, v230
 v_min_f32 v157, v157, v233
 v_add_f32 v234, 0xe1d00000, v230
 v_min_f32 v158, v158, v234
 v_add_f32 v235, 0xe1d80000, v230
 v_min_f32 v159, v159, v235
 v_add_f32 v230, 0xe2000000, v230
 s_branch K2_mask1_b
K2_prep1:
 v_add_f32 v232, 0x00000000, v230
 v_min_f32 v144, v144, v232
 v_add_f32 v233, 0xdf800000, v230
 v_min_f32 v145, v145, v233
 v_add_f32 v234, 0xe0000000, v230
 v_min_f32 v146, v146, v234
 v_add_f32 v235, 0xe0400000, v230
 v_min_f32 v147, v147, v235
 v_add_f32 v232, 0xe1000000, v230
 v_min_f32 v148, v148, v232
 v_add_f32 v233, 0xe1100000, v230
 v_min_f32 v149, v149, v233
 v_add_f32 v234, 0xe1200000, v230
 v_min_f32 v150, v150, v234
 v_add_f32 v235, 0xe1300000, v230
 v_min_f32 v151, v151, v235
 v_add_f32 v232, 0xe1800000, v230
 v_min_f32 v152, v152, v232
 v_add_f32 v233, 0xe1880000, v230
 v_min_f32 v153, v153, v233
 v_add_f32 v234, 0xe1900000, v230
 v_min_f32 v154, v154, v234
 v_add_f32 v235, 0xe1980000, v230
 v_min_f32 v155, v155, v235
 v_add_f32 v232, 0xe1c00000, v230
 v_min_f32 v156, v156, v232
 v_add_f32 v233, 0xe1c80000, v230
 v_min_f32 v157, v157, v233
 v_add_f32 v234, 0xe1d00000, v230
 v_min_f32 v158, v158, v234
 v_add_f32 v235, 0xe1d80000, v230
 v_min_f32 v159, v159, v235
 v_add_f32 v230, 0xe2000000, v230
 s_branch K2_prep1_b
K2_prep4:
 v_add_f32 v232, 0x00000000, v230
 v_min_f32 v144, v144, v232
 v_add_f32 v233, 0xdf800000, v230
 v_min_f32 v145, v145, v233
 v_add_f32 v234, 0xe0000000, v230
 v_min_f32 v146, v146, v234
 v_add_f32 v235, 0xe0400000, v230
 v_min_f32 v147, v147, v235
 v_add_f32 v232, 0xe1000000, v230
 v_min_f32 v148, v148, v232
 v_add_f32 v233, 0xe1100000, v230
 v_min_f32 v149, v149, v233
 v_add_f32 v234, 0xe1200000, v230
 v_min_f32 v150, v150, v234
 v_add_f32 v235, 0xe1300000, v230
 v_min_f32 v151, v151, v235
 v_add_f32 v232, 0xe1800000, v230
 v_min_f32 v152, v152, v232
 v_add_f32 v233, 0xe1880000, v230
 v_min_f32 v153, v153, v233
 v_add_f32 v234, 0xe1900000, v230
 v_min_f32 v154, v154, v234
 v_add_f32 v235, 0xe1980000, v230
 v_min_f32 v155, v155, v235
 v_add_f32 v232, 0xe1c00000, v230
 v_min_f32 v156, v156, v232
 v_add_f32 v233, 0xe1c80000, v230
 v_min_f32 v157, v157, v233
 v_add_f32 v234, 0xe1d00000, v230
 v_min_f32 v158, v158, v234
 v_add_f32 v235, 0xe1d80000, v230
 v_min_f32 v159, v159, v235
 v_add_f32 v230, 0xe2000000, v230
 s_branch K2_prep4_b
K2_sig:
 s_waitcnt lgkmcnt(0) vmcnt(8)
 s_barrier
 v_mov_b32 v13, 0x40000000
 v_writelane_b32 v13, s33, 0
 v_mov_b32 v5, s89
 s_mov_b32 s66, 0x3b18000
 buffer_store_dword v5, v13, s[20:23], s66 offen sc1
 s_branch K2_sig_b
K2_lin:
 s_cmp_eq_u32 s95, 6
 s_cbranch_scc1 K2_lin2
 s_cmp_eq_u32 s95, 10
 s_cbranch_scc1 K2_lin3
 s_cmp_eq_u32 s95, 14
 s_cbranch_scc1 K2_lin4
 buffer_load_dword v13, v1, s[20:23], s49 offen sc1
 s_mov_b32 s95, 6
 s_branch K2_lin_b
K2_lin4:
 v_mov_b32 v13, 0x40000000
 v_writelane_b32 v13, s33, 0
 v_mov_b32 v5, s89
 s_mov_b32 s66, 0x3b20000
 buffer_store_dword v5, v13, s[20:23], s66 offen sc1
 s_mov_b32 s95, 99
 s_branch K2_lin_b
K2_lin2:
 s_mul_i32 s71, s53, 98304
 s_add_u32 s71, s71, 0x3800000
 s_mul_i32 s72, s52, 3072
 s_add_u32 s72, s72, s71
 s_add_u32 s72, s72, 2048
 s_lshr_b32 s66, s52, 1
 s_mul_i32 s66, s66, 6144
 s_add_u32 s71, s71, s66
 s_and_b32 s66, s52, 1
 s_lshl_b32 s66, s66, 10
 s_add_u32 s71, s71, s66
 v_and_b32 v3, 7, v2
 v_mul_u32_u24 v3, 0x3000, v3
 v_add_u32 v3, v3, v10
 v_and_b32 v4, 15, v2
 v_lshlrev_b32 v4, 2, v4
 s_mov_b32 s88, 0
 s_waitcnt vmcnt(8)
K2_lin2l:
 v_cmp_ne_u32 vcc, s89, v13
 s_nop 0
 s_and_b64 vcc, vcc, s[30:31]
 s_cbranch_vccz K2_lin2g
 s_sleep 2
 buffer_load_dword v13, v1, s[20:23], s49 offen sc1
 s_waitcnt vmcnt(0)
 s_add_u32 s88, s88, 1
 s_cmp_lt_u32 s88, 0x80000
 s_cbranch_scc1 K2_lin2l
K2_lin2g:
 buffer_load_dwordx4 a[160:163], v10, s[20:23], s71 offen offset:0 sc1
 buffer_load_dwordx4 a[164:167], v10, s[20:23], s71 offen offset:3072 sc1
 s_add_u32 s71, s71, 12288
 buffer_load_dwordx4 a[168:171], v10, s[20:23], s71 offen offset:0 sc1
 buffer_load_dwordx4 a[172:175], v10, s[20:23], s71 offen offset:3072 sc1
 s_add_u32 s71, s71, 12288
 buffer_load_dwordx4 a[176:179], v10, s[20:23], s71 offen offset:0 sc1
 buffer_load_dwordx4 a[180:183], v10, s[20:23], s71 offen offset:3072 sc1
 s_add_u32 s71, s71, 12288
 buffer_load_dwordx4 a[184:187], v10, s[20:23], s71 offen offset:0 sc1
 buffer_load_dwordx4 a[188:191], v10, s[20:23], s71 offen offset:3072 sc1
 s_add_u32 s71, s71, 12288
 buffer_load_dwordx4 a[224:227], v10, s[20:23], s71 offen offset:0 sc1
 buffer_load_dwordx4 a[228:231], v10, s[20:23], s71 offen offset:3072 sc1
 s_add_u32 s71, s71, 12288
 buffer_load_dwordx4 a[232:235], v10, s[20:23], s71 offen offset:0 sc1
 buffer_load_dwordx4 a[236:239], v10, s[20:23], s71 offen offset:3072 sc1
 s_add_u32 s71, s71, 12288
 buffer_load_dwordx4 a[240:243], v10, s[20:23], s71 offen offset:0 sc1
 buffer_load_dwordx4 a[244:247], v10, s[20:23], s71 offen offset:3072 sc1
 s_add_u32 s71, s71, 12288
 buffer_load_dwordx4 a[248:251], v10, s[20:23], s71 offen offset:0 sc1
 buffer_load_dwordx4 a[252:255], v10, s[20:23], s71 offen offset:3072 sc1
 s_add_u32 s71, s71, 12288
 buffer_load_dwordx4 v[248:251], v3, s[20:23], s72 offen sc1
 buffer_load_dword v252, v4, s[20:23], s64 offen offset:0 sc1
 buffer_load_dword v253, v4, s[20:23], s64 offen offset:64 sc1
 buffer_load_dword v254, v4, s[20:23], s65 offen offset:0 sc1
 buffer_load_dword v255, v4, s[20:23], s65 offen offset:64 sc1
 s_mov_b32 s95, 10
 s_branch K2_lin_b
K2_lin3:
 s_nop 7
 s_lshl_b32 s66, s52, 13
 s_add_u32 s66, s66, 0x20000
 v_add_u32 v13, s66, v10
 v_lshrrev_b32 v3, 1, v10
 v_add_u32 v4, s66, v3
 v_add_u32 v3, 0x20000, v3
 v_add_u32 v5, 0x20000, v10
 s_waitcnt vmcnt(16)
 v_accvgpr_read_b32 v216, a160
 v_accvgpr_read_b32 v217, a161
 v_accvgpr_read_b32 v218, a162
 v_accvgpr_read_b32 v219, a163
 v_accvgpr_read_b32 v220, a164
 v_accvgpr_read_b32 v221, a165
 v_accvgpr_read_b32 v222, a166
 v_accvgpr_read_b32 v223, a167
 v_accvgpr_read_b32 v240, a168
 v_accvgpr_read_b32 v241, a169
 v_accvgpr_read_b32 v242, a170
 v_accvgpr_read_b32 v243, a171
 v_accvgpr_read_b32 v244, a172
 v_accvgpr_read_b32 v245, a173
 v_accvgpr_read_b32 v246, a174
 v_accvgpr_read_b32 v247, a175
 v_pk_add_f32 v[216:217], v[216:217], v[240:241]
 v_pk_add_f32 v[218:219], v[218:219], v[242:243]
 v_pk_add_f32 v[220:221], v[220:221], v[244:245]
 v_pk_add_f32 v[222:223], v[222:223], v[246:247]
 v_add_f32_dpp v248, v248, v248 row_ror:1 row_mask:0xf bank_mask:0xf
 v_add_f32_dpp v249, v249, v249 row_ror:1 row_mask:0xf bank_mask:0xf
 v_add_f32_dpp v250, v250, v250 row_ror:1 row_mask:0xf bank_mask:0xf
 v_add_f32_dpp v251, v251, v251 row_ror:1 row_mask:0xf bank_mask:0xf
 v_accvgpr_read_b32 v240, a176
 v_accvgpr_read_b32 v241, a177
 v_accvgpr_read_b32 v242, a178
 v_accvgpr_read_b32 v243, a179
 v_accvgpr_read_b32 v244, a180
 v_accvgpr_read_b32 v245, a181
 v_accvgpr_read_b32 v246, a182
 v_accvgpr_read_b32 v247, a183
 v_pk_add_f32 v[216:217], v[216:217], v[240:241]
 v_pk_add_f32 v[218:219], v[218:219], v[242:243]
 v_pk_add_f32 v[220:221], v[220:221], v[244:245]
 v_pk_add_f32 v[222:223], v[222:223], v[246:247]
 v_add_f32_dpp v248, v248, v248 row_ror:2 row_mask:0xf bank_mask:0xf
 v_add_f32_dpp v249, v249, v249 row_ror:2 row_mask:0xf bank_mask:0xf
 v_add_f32_dpp v250, v250, v250 row_ror:2 row_mask:0xf bank_mask:0xf
 v_add_f32_dpp v251, v251, v251 row_ror:2 row_mask:0xf bank_mask:0xf
 v_accvgpr_read_b32 v240, a184
 v_accvgpr_read_b32 v241, a185
 v_accvgpr_read_b32 v242, a186
 v_accvgpr_read_b32 v243, a187
 v_accvgpr_read_b32 v244, a188
 v_accvgpr_read_b32 v245, a189
 v_accvgpr_read_b32 v246, a190
 v_accvgpr_read_b32 v247, a191
 v_pk_add_f32 v[216:217], v[216:217], v[240:241]
 v_pk_add_f32 v[218:219], v[218:219], v[242:243]
 v_pk_add_f32 v[220:221], v[220:221], v[244:245]
 v_pk_add_f32 v[222:223], v[222:223], v[246:247]
 v_add_f32_dpp v248, v248, v248 row_ror:4 row_mask:0xf bank_mask:0xf
 v_add_f32_dpp v249, v249, v249 row_ror:4 row_mask:0xf bank_mask:0xf
 v_add_f32_dpp v250, v250, v250 row_ror:4 row_mask:0xf bank_mask:0xf
 v_add_f32_dpp v251, v251, v251 row_ror:4 row_mask:0xf bank_mask:0xf
 ds_read_b128 a[160:163], v13 offset:0
 ds_read_b128 a[164:167], v13 offset:1024
 ds_read_b128 a[168:171], v13 offset:2048
 ds_read_b128 a[172:175], v13 offset:3072
 ds_read_b128 a[176:179], v13 offset:4096
 ds_read_b128 a[180:183], v13 offset:5120
 ds_read_b128 a[184:187], v13 offset:6144
 ds_read_b128 a[188:191], v13 offset:7168
 v_accvgpr_read_b32 v240, a224
 v_accvgpr_read_b32 v241, a225
 v_accvgpr_read_b32 v242, a226
 v_accvgpr_read_b32 v243, a227
 v_accvgpr_read_b32 v244, a228
 v_accvgpr_read_b32 v245, a229
 v_accvgpr_read_b32 v246, a230
 v_accvgpr_read_b32 v247, a231
 v_pk_add_f32 v[216:217], v[216:217], v[240:241]
 v_pk_add_f32 v[218:219], v[218:219], v[242:243]
 v_pk_add_f32 v[220:221], v[220:221], v[244:245]
 v_pk_add_f32 v[222:223], v[222:223], v[246:247]
 v_accvgpr_read_b32 v240, a232
 v_accvgpr_read_b32 v241, a233
 v_accvgpr_read_b32 v242, a234
 v_accvgpr_read_b32 v243, a235
 v_accvgpr_read_b32 v244, a236
 v_accvgpr_read_b32 v245, a237
 v_accvgpr_read_b32 v246, a238
 v_accvgpr_read_b32 v247, a239
 v_pk_add_f32 v[216:217], v[216:217], v[240:241]
 v_pk_add_f32 v[218:219], v[218:219], v[242:243]
 v_pk_add_f32 v[220:221], v[220:221], v[244:245]
 v_pk_add_f32 v[222:223], v[222:223], v[246:247]
 v_accvgpr_read_b32 v240, a240
 v_accvgpr_read_b32 v241, a241
 v_accvgpr_read_b32 v242, a242
 v_accvgpr_read_b32 v243, a243
 v_accvgpr_read_b32 v244, a244
 v_accvgpr_read_b32 v245, a245
 v_accvgpr_read_b32 v246, a246
 v_accvgpr_read_b32 v247, a247
 v_pk_add_f32 v[216:217], v[216:217], v[240:241]
 v_pk_add_f32 v[218:219], v[218:219], v[242:243]
 v_pk_add_f32 v[220:221], v[220:221], v[244:245]
 v_pk_add_f32 v[222:223], v[222:223], v[246:247]
 v_accvgpr_read_b32 v240, a248
 v_accvgpr_read_b32 v241, a249
 v_accvgpr_read_b32 v242, a250
 v_accvgpr_read_b32 v243, a251
 v_accvgpr_read_b32 v244, a252
 v_accvgpr_read_b32 v245, a253
 v_accvgpr_read_b32 v246, a254
 v_accvgpr_read_b32 v247, a255
 v_pk_add_f32 v[216:217], v[216:217], v[240:241]
 v_pk_add_f32 v[218:219], v[218:219], v[242:243]
 v_pk_add_f32 v[220:221], v[220:221], v[244:245]
 v_pk_add_f32 v[222:223], v[222:223], v[246:247]
 v_cvt_pk_bf16_f32 v216, v216, v217
 v_cvt_pk_bf16_f32 v217, v218, v219
 v_cvt_pk_bf16_f32 v218, v220, v221
 v_cvt_pk_bf16_f32 v219, v222, v223
 v_cvt_pk_bf16_f32 v248, v248, v249
 v_cvt_pk_bf16_f32 v249, v250, v251
 s_waitcnt lgkmcnt(0)
 ds_write_b128 v13, v[216:219]
 ds_write_b64 v4, v[248:249] offset:1024
 s_lshl_b32 s72, s53, 13
 s_lshl_b32 s73, s52, 11
 s_add_u32 s72, s72, s73
 s_add_u32 s72, s72, 0x4000000
 s_add_u32 s73, s72, s77
 s_add_u32 s74, s72, s78
 s_waitcnt lgkmcnt(0)
 s_barrier
 ds_read_b64 a[240:241], v3 offset:1024
 ds_read_b64 a[242:243], v3 offset:9216
 ds_read_b64 a[244:245], v3 offset:17408
 ds_read_b64 a[246:247], v3 offset:25600
 ds_read_b128 a[224:227], v5 offset:0
 ds_read_b128 a[228:231], v5 offset:16384
 ds_read_b128 a[232:235], v5 offset:8192
 ds_read_b128 a[236:239], v5 offset:24576
 s_waitcnt lgkmcnt(0)
 v_mfma_f32_16x16x32_bf16 v[232:235], a[240:243], a[160:163], 0
 v_mfma_f32_16x16x32_bf16 v[232:235], a[244:247], a[164:167], v[232:235]
 v_mfma_f32_16x16x32_bf16 v[236:239], a[240:243], a[168:171], 0
 v_mfma_f32_16x16x32_bf16 v[236:239], a[244:247], a[172:175], v[236:239]
 v_mfma_f32_16x16x32_bf16 v[240:243], a[240:243], a[176:179], 0
 v_mfma_f32_16x16x32_bf16 v[240:243], a[244:247], a[180:183], v[240:243]
 v_mfma_f32_16x16x32_bf16 v[244:247], a[240:243], a[184:187], 0
 v_mfma_f32_16x16x32_bf16 v[244:247], a[244:247], a[188:191], v[244:247]
 v_mfma_f32_16x16x32_bf16 v[176:179], a[224:227], a[160:163], 0
 v_mfma_f32_16x16x32_bf16 v[176:179], a[228:231], a[164:167], v[176:179]
 v_mfma_f32_16x16x32_bf16 v[184:187], a[224:227], a[168:171], 0
 v_mfma_f32_16x16x32_bf16 v[184:187], a[228:231], a[172:175], v[184:187]
 v_mfma_f32_16x16x32_bf16 v[200:203], a[224:227], a[176:179], 0
 v_mfma_f32_16x16x32_bf16 v[200:203], a[228:231], a[180:183], v[200:203]
 v_mfma_f32_16x16x32_bf16 v[216:219], a[224:227], a[184:187], 0
 v_mfma_f32_16x16x32_bf16 v[216:219], a[228:231], a[188:191], v[216:219]
 v_mfma_f32_16x16x32_bf16 v[180:183], a[232:235], a[160:163], 0
 v_mfma_f32_16x16x32_bf16 v[180:183], a[236:239], a[164:167], v[180:183]
 v_mfma_f32_16x16x32_bf16 v[188:191], a[232:235], a[168:171], 0
 v_mfma_f32_16x16x32_bf16 v[188:191], a[236:239], a[172:175], v[188:191]
 v_mfma_f32_16x16x32_bf16 v[204:207], a[232:235], a[176:179], 0
 v_mfma_f32_16x16x32_bf16 v[204:207], a[236:239], a[180:183], v[204:207]
 v_mfma_f32_16x16x32_bf16 v[220:223], a[232:235], a[184:187], 0
 v_mfma_f32_16x16x32_bf16 v[220:223], a[236:239], a[188:191], v[220:223]
 v_add_f32 v232, 0x358637bd, v232
 v_rcp_f32 v232, v232
 s_nop 0
 v_mul_f32 v232, v232, v252
 v_mov_b32 v233, v232
 v_add_f32 v236, 0x358637bd, v236
 v_rcp_f32 v236, v236
 s_nop 0
 v_mul_f32 v236, v236, v253
 v_mov_b32 v237, v236
 v_add_f32 v240, 0x358637bd, v240
 v_rcp_f32 v240, v240
 s_nop 0
 v_mul_f32 v240, v240, v254
 v_mov_b32 v241, v240
 v_add_f32 v244, 0x358637bd, v244
 v_rcp_f32 v244, v244
 s_nop 0
 v_mul_f32 v244, v244, v255
 v_mov_b32 v245, v244
 v_pk_mul_f32 v[176:177], v[176:177], v[232:233]
 v_pk_mul_f32 v[178:179], v[178:179], v[232:233]
 v_pk_mul_f32 v[180:181], v[180:181], v[232:233]
 v_pk_mul_f32 v[182:183], v[182:183], v[232:233]
 v_cvt_pk_bf16_f32 v176, v176, v177
 v_cvt_pk_bf16_f32 v177, v178, v179
 v_cvt_pk_bf16_f32 v178, v180, v181
 v_cvt_pk_bf16_f32 v179, v182, v183
 buffer_store_dwordx4 v[176:179], v10, s[20:23], s73 offen offset:0 sc1
 v_pk_mul_f32 v[184:185], v[184:185], v[236:237]
 v_pk_mul_f32 v[186:187], v[186:187], v[236:237]
 v_pk_mul_f32 v[188:189], v[188:189], v[236:237]
 v_pk_mul_f32 v[190:191], v[190:191], v[236:237]
 v_cvt_pk_bf16_f32 v184, v184, v185
 v_cvt_pk_bf16_f32 v185, v186, v187
 v_cvt_pk_bf16_f32 v186, v188, v189
 v_cvt_pk_bf16_f32 v187, v190, v191
 buffer_store_dwordx4 v[184:187], v10, s[20:23], s73 offen offset:1024 sc1
 v_pk_mul_f32 v[200:201], v[200:201], v[240:241]
 v_pk_mul_f32 v[202:203], v[202:203], v[240:241]
 v_pk_mul_f32 v[204:205], v[204:205], v[240:241]
 v_pk_mul_f32 v[206:207], v[206:207], v[240:241]
 v_cvt_pk_bf16_f32 v200, v200, v201
 v_cvt_pk_bf16_f32 v201, v202, v203
 v_cvt_pk_bf16_f32 v202, v204, v205
 v_cvt_pk_bf16_f32 v203, v206, v207
 buffer_store_dwordx4 v[200:203], v10, s[20:23], s74 offen offset:0 sc1
 v_pk_mul_f32 v[216:217], v[216:217], v[244:245]
 v_pk_mul_f32 v[218:219], v[218:219], v[244:245]
 v_pk_mul_f32 v[220:221], v[220:221], v[244:245]
 v_pk_mul_f32 v[222:223], v[222:223], v[244:245]
 v_cvt_pk_bf16_f32 v216, v216, v217
 v_cvt_pk_bf16_f32 v217, v218, v219
 v_cvt_pk_bf16_f32 v218, v220, v221
 v_cvt_pk_bf16_f32 v219, v222, v223
 buffer_store_dwordx4 v[216:219], v10, s[20:23], s74 offen offset:1024 sc1
 v_mov_b32 v176, v160
 v_mov_b32 v177, v161
 v_mov_b32 v178, v162
 v_mov_b32 v179, v163
 v_mov_b32 v180, v164
 v_mov_b32 v181, v165
 v_mov_b32 v182, v166
 v_mov_b32 v183, v167
 v_mov_b32 v184, v168
 v_mov_b32 v185, v169
 v_mov_b32 v186, v170
 v_mov_b32 v187, v171
 v_mov_b32 v188, v172
 v_mov_b32 v189, v173
 v_mov_b32 v190, v174
 v_mov_b32 v191, v175
 s_mov_b32 s95, 14
 s_branch K2_lin_b
K2_prep15:
 v_min_u32 v236, 3, v2
 v_mad_u32_u24 v236, s48, 4, v236
 v_lshlrev_b32 v236, 7, v236
 v_add_u32 v236, K2_tail-F_pc, v236
 global_load_dword v247, v236, s[90:91]
 v_add_f32 v232, 0x00000000, v231
 v_min_f32 v160, v160, v232
 v_add_f32 v233, 0xdf800000, v231
 v_min_f32 v161, v161, v233
 v_add_f32 v234, 0xe0000000, v231
 v_min_f32 v162, v162, v234
 v_add_f32 v235, 0xe0400000, v231
 v_min_f32 v163, v163, v235
 v_add_f32 v232, 0xe1000000, v231
 v_min_f32 v164, v164, v232
 v_add_f32 v233, 0xe1100000, v231
 v_min_f32 v165, v165, v233
 v_add_f32 v234, 0xe1200000, v231
 v_min_f32 v166, v166, v234
 v_add_f32 v235, 0xe1300000, v231
 v_min_f32 v167, v167, v235
 v_add_f32 v232, 0xe1800000, v231
 v_min_f32 v168, v168, v232
 v_add_f32 v233, 0xe1880000, v231
 v_min_f32 v169, v169, v233
 v_add_f32 v234, 0xe1900000, v231
 v_min_f32 v170, v170, v234
 v_add_f32 v235, 0xe1980000, v231
 v_min_f32 v171, v171, v235
 v_add_f32 v232, 0xe1c00000, v231
 v_min_f32 v172, v172, v232
 v_add_f32 v233, 0xe1c80000, v231
 v_min_f32 v173, v173, v233
 v_add_f32 v234, 0xe1d00000, v231
 v_min_f32 v174, v174, v234
 v_add_f32 v235, 0xe1d80000, v231
 v_min_f32 v175, v175, v235
 v_add_f32 v231, 0xe2000000, v231
 v_add_f32 v232, 0x00000000, v231
 v_min_f32 v176, v176, v232
 v_add_f32 v233, 0xdf800000, v231
 v_min_f32 v177, v177, v233
 v_add_f32 v234, 0xe0000000, v231
 v_min_f32 v178, v178, v234
 v_add_f32 v235, 0xe0400000, v231
 v_min_f32 v179, v179, v235
 v_add_f32 v232, 0xe1000000, v231
 v_min_f32 v180, v180, v232
 v_add_f32 v233, 0xe1100000, v231
 v_min_f32 v181, v181, v233
 v_add_f32 v234, 0xe1200000, v231
 v_min_f32 v182, v182, v234
 v_add_f32 v235, 0xe1300000, v231
 v_min_f32 v183, v183, v235
 v_add_f32 v232, 0xe1800000, v231
 v_min_f32 v184, v184, v232
 v_add_f32 v233, 0xe1880000, v231
 v_min_f32 v185, v185, v233
 v_add_f32 v234, 0xe1900000, v231
 v_min_f32 v186, v186, v234
 v_add_f32 v235, 0xe1980000, v231
 v_min_f32 v187, v187, v235
 v_add_f32 v232, 0xe1c00000, v231
 v_min_f32 v188, v188, v232
 v_add_f32 v233, 0xe1c80000, v231
 v_min_f32 v189, v189, v233
 v_add_f32 v234, 0xe1d00000, v231
 v_min_f32 v190, v190, v234
 v_add_f32 v235, 0xe1d80000, v231
 v_min_f32 v191, v191, v235
 v_add_f32 v231, 0xe2000000, v231
 s_branch K2_prep15_b
K2_spin:
 s_mov_b32 s88, 0
K2_spin_l:
 s_sleep 2
 buffer_load_dword v13, v1, s[20:23], s49 offen sc1
 s_waitcnt vmcnt(0)
 v_cmp_ne_u32 vcc, s89, v13
 s_nop 0
 s_and_b64 vcc, vcc, s[30:31]
 s_add_u32 s88, s88, 1
 s_cmp_gt_u32 s88, 0x80000
 s_cbranch_scc1 K2_spin_b
 s_cbranch_vccnz K2_spin_l
 s_branch K2_spin_b
K2_prep18:
 v_add_f32 v232, 0x00000000, v231
 v_min_f32 v160, v160, v232
 v_add_f32 v233, 0xdf800000, v231
 v_min_f32 v161, v161, v233
 v_add_f32 v234, 0xe0000000, v231
 v_min_f32 v162, v162, v234
 v_add_f32 v235, 0xe0400000, v231
 v_min_f32 v163, v163, v235
 v_add_f32 v232, 0xe1000000, v231
 v_min_f32 v164, v164, v232
 v_add_f32 v233, 0xe1100000, v231
 v_min_f32 v165, v165, v233
 v_add_f32 v234, 0xe1200000, v231
 v_min_f32 v166, v166, v234
 v_add_f32 v235, 0xe1300000, v231
 v_min_f32 v167, v167, v235
 v_add_f32 v232, 0xe1800000, v231
 v_min_f32 v168, v168, v232
 v_add_f32 v233, 0xe1880000, v231
 v_min_f32 v169, v169, v233
 v_add_f32 v234, 0xe1900000, v231
 v_min_f32 v170, v170, v234
 v_add_f32 v235, 0xe1980000, v231
 v_min_f32 v171, v171, v235
 v_add_f32 v232, 0xe1c00000, v231
 v_min_f32 v172, v172, v232
 v_add_f32 v233, 0xe1c80000, v231
 v_min_f32 v173, v173, v233
 v_add_f32 v234, 0xe1d00000, v231
 v_min_f32 v174, v174, v234
 v_add_f32 v235, 0xe1d80000, v231
 v_min_f32 v175, v175, v235
 v_add_f32 v231, 0xe2000000, v231
 v_add_f32 v232, 0x00000000, v231
 v_min_f32 v176, v176, v232
 v_add_f32 v233, 0xdf800000, v231
 v_min_f32 v177, v177, v233
 v_add_f32 v234, 0xe0000000, v231
 v_min_f32 v178, v178, v234
 v_add_f32 v235, 0xe0400000, v231
 v_min_f32 v179, v179, v235
 v_add_f32 v232, 0xe1000000, v231
 v_min_f32 v180, v180, v232
 v_add_f32 v233, 0xe1100000, v231
 v_min_f32 v181, v181, v233
 v_add_f32 v234, 0xe1200000, v231
 v_min_f32 v182, v182, v234
 v_add_f32 v235, 0xe1300000, v231
 v_min_f32 v183, v183, v235
 v_add_f32 v232, 0xe1800000, v231
 v_min_f32 v184, v184, v232
 v_add_f32 v233, 0xe1880000, v231
 v_min_f32 v185, v185, v233
 v_add_f32 v234, 0xe1900000, v231
 v_min_f32 v186, v186, v234
 v_add_f32 v235, 0xe1980000, v231
 v_min_f32 v187, v187, v235
 v_add_f32 v232, 0xe1c00000, v231
 v_min_f32 v188, v188, v232
 v_add_f32 v233, 0xe1c80000, v231
 v_min_f32 v189, v189, v233
 v_add_f32 v234, 0xe1d00000, v231
 v_min_f32 v190, v190, v234
 v_add_f32 v235, 0xe1d80000, v231
 v_min_f32 v191, v191, v235
 v_add_f32 v231, 0xe2000000, v231
 s_branch K2_prep18_b
K2_nolin:
 s_waitcnt vmcnt(10)
 s_branch K2_nolin_b
K2_prep21:
 v_min_u32 v236, 3, v2
 v_mad_u32_u24 v236, s48, 4, v236
 v_lshlrev_b32 v236, 7, v236
 v_add_u32 v236, K2_tail-F_pc, v236
 global_load_dword v247, v236, s[90:91]
 v_add_f32 v232, 0x00000000, v231
 v_min_f32 v160, v160, v232
 v_add_f32 v233, 0xdf800000, v231
 v_min_f32 v161, v161, v233
 v_add_f32 v234, 0xe0000000, v231
 v_min_f32 v162, v162, v234
 v_add_f32 v235, 0xe0400000, v231
 v_min_f32 v163, v163, v235
 v_add_f32 v232, 0xe1000000, v231
 v_min_f32 v164, v164, v232
 v_add_f32 v233, 0xe1100000, v231
 v_min_f32 v165, v165, v233
 v_add_f32 v234, 0xe1200000, v231
 v_min_f32 v166, v166, v234
 v_add_f32 v235, 0xe1300000, v231
 v_min_f32 v167, v167, v235
 v_add_f32 v232, 0xe1800000, v231
 v_min_f32 v168, v168, v232
 v_add_f32 v233, 0xe1880000, v231
 v_min_f32 v169, v169, v233
 v_add_f32 v234, 0xe1900000, v231
 v_min_f32 v170, v170, v234
 v_add_f32 v235, 0xe1980000, v231
 v_min_f32 v171, v171, v235
 v_add_f32 v232, 0xe1c00000, v231
 v_min_f32 v172, v172, v232
 v_add_f32 v233, 0xe1c80000, v231
 v_min_f32 v173, v173, v233
 v_add_f32 v234, 0xe1d00000, v231
 v_min_f32 v174, v174, v234
 v_add_f32 v235, 0xe1d80000, v231
 v_min_f32 v175, v175, v235
 v_add_f32 v231, 0xe2000000, v231
 v_add_f32 v232, 0x00000000, v231
 v_min_f32 v176, v176, v232
 v_add_f32 v233, 0xdf800000, v231
 v_min_f32 v177, v177, v233
 v_add_f32 v234, 0xe0000000, v231
 v_min_f32 v178, v178, v234
 v_add_f32 v235, 0xe0400000, v231
 v_min_f32 v179, v179, v235
 v_add_f32 v232, 0xe1000000, v231
 v_min_f32 v180, v180, v232
 v_add_f32 v233, 0xe1100000, v231
 v_min_f32 v181, v181, v233
 v_add_f32 v234, 0xe1200000, v231
 v_min_f32 v182, v182, v234
 v_add_f32 v235, 0xe1300000, v231
 v_min_f32 v183, v183, v235
 v_add_f32 v232, 0xe1800000, v231
 v_min_f32 v184, v184, v232
 v_add_f32 v233, 0xe1880000, v231
 v_min_f32 v185, v185, v233
 v_add_f32 v234, 0xe1900000, v231
 v_min_f32 v186, v186, v234
 v_add_f32 v235, 0xe1980000, v231
 v_min_f32 v187, v187, v235
 v_add_f32 v232, 0xe1c00000, v231
 v_min_f32 v188, v188, v232
 v_add_f32 v233, 0xe1c80000, v231
 v_min_f32 v189, v189, v233
 v_add_f32 v234, 0xe1d00000, v231
 v_min_f32 v190, v190, v234
 v_add_f32 v235, 0xe1d80000, v231
 v_min_f32 v191, v191, v235
 v_add_f32 v231, 0xe2000000, v231
 s_branch K2_prep21_b
K2_prep24:
 v_add_f32 v232, 0x00000000, v231
 v_min_f32 v160, v160, v232
 v_add_f32 v233, 0xdf800000, v231
 v_min_f32 v161, v161, v233
 v_add_f32 v234, 0xe0000000, v231
 v_min_f32 v162, v162, v234
 v_add_f32 v235, 0xe0400000, v231
 v_min_f32 v163, v163, v235
 v_add_f32 v232, 0xe1000000, v231
 v_min_f32 v164, v164, v232
 v_add_f32 v233, 0xe1100000, v231
 v_min_f32 v165, v165, v233
 v_add_f32 v234, 0xe1200000, v231
 v_min_f32 v166, v166, v234
 v_add_f32 v235, 0xe1300000, v231
 v_min_f32 v167, v167, v235
 v_add_f32 v232, 0xe1800000, v231
 v_min_f32 v168, v168, v232
 v_add_f32 v233, 0xe1880000, v231
 v_min_f32 v169, v169, v233
 v_add_f32 v234, 0xe1900000, v231
 v_min_f32 v170, v170, v234
 v_add_f32 v235, 0xe1980000, v231
 v_min_f32 v171, v171, v235
 v_add_f32 v232, 0xe1c00000, v231
 v_min_f32 v172, v172, v232
 v_add_f32 v233, 0xe1c80000, v231
 v_min_f32 v173, v173, v233
 v_add_f32 v234, 0xe1d00000, v231
 v_min_f32 v174, v174, v234
 v_add_f32 v235, 0xe1d80000, v231
 v_min_f32 v175, v175, v235
 v_add_f32 v231, 0xe2000000, v231
 v_add_f32 v232, 0x00000000, v231
 v_min_f32 v176, v176, v232
 v_add_f32 v233, 0xdf800000, v231
 v_min_f32 v177, v177, v233
 v_add_f32 v234, 0xe0000000, v231
 v_min_f32 v178, v178, v234
 v_add_f32 v235, 0xe0400000, v231
 v_min_f32 v179, v179, v235
 v_add_f32 v232, 0xe1000000, v231
 v_min_f32 v180, v180, v232
 v_add_f32 v233, 0xe1100000, v231
 v_min_f32 v181, v181, v233
 v_add_f32 v234, 0xe1200000, v231
 v_min_f32 v182, v182, v234
 v_add_f32 v235, 0xe1300000, v231
 v_min_f32 v183, v183, v235
 v_add_f32 v232, 0xe1800000, v231
 v_min_f32 v184, v184, v232
 v_add_f32 v233, 0xe1880000, v231
 v_min_f32 v185, v185, v233
 v_add_f32 v234, 0xe1900000, v231
 v_min_f32 v186, v186, v234
 v_add_f32 v235, 0xe1980000, v231
 v_min_f32 v187, v187, v235
 v_add_f32 v232, 0xe1c00000, v231
 v_min_f32 v188, v188, v232
 v_add_f32 v233, 0xe1c80000, v231
 v_min_f32 v189, v189, v233
 v_add_f32 v234, 0xe1d00000, v231
 v_min_f32 v190, v190, v234
 v_add_f32 v235, 0xe1d80000, v231
 v_min_f32 v191, v191, v235
 v_add_f32 v231, 0xe2000000, v231
 s_branch K2_prep24_b
K2_sig2:
 v_mov_b32 v13, 0x40000000
 v_writelane_b32 v13, s33, 0
 v_mov_b32 v5, s89
 s_mov_b32 s66, 0x3b20000
 buffer_store_dword v5, v13, s[20:23], s66 offen sc1
 s_branch K2_sig2_b
K2_w7:
 s_waitcnt vmcnt(8)
 s_branch K2_w7_b
K2_spin2:
 s_mov_b32 s88, 0
K2_spin2_l:
 s_sleep 2
 buffer_load_dword v13, v1, s[20:23], s49 offen sc1
 s_waitcnt vmcnt(0)
 v_cmp_ne_u32 vcc, s89, v13
 s_nop 0
 s_and_b64 vcc, vcc, s[30:31]
 s_add_u32 s88, s88, 1
 s_cmp_gt_u32 s88, 0x80000
 s_cbranch_scc1 K2_spin2_b
 s_cbranch_vccnz K2_spin2_l
 s_branch K2_spin2_b
K3_spin:
 s_mov_b32 s88, 0
 buffer_load_dword v13, v1, s[20:23], s49 offen sc1
K3_spin_l:
 s_sleep 3
 buffer_load_dword v8, v1, s[20:23], s49 offen sc1
 s_waitcnt vmcnt(1)
 v_cmp_ne_u32 vcc, s89, v13
 s_nop 0
 s_and_b64 vcc, vcc, s[30:31]
 s_cbranch_vccz K3_spin_b
 s_sleep 3
 buffer_load_dword v13, v1, s[20:23], s49 offen sc1
 s_waitcnt vmcnt(1)
 v_cmp_ne_u32 vcc, s89, v8
 s_nop 0
 s_and_b64 vcc, vcc, s[30:31]
 s_add_u32 s88, s88, 1
 s_cmp_gt_u32 s88, 0x80000
 s_cbranch_scc1 K3_spin_b
 s_cbranch_vccnz K3_spin_l
 s_branch K3_spin_b
K3_spinl:
 s_mov_b32 s88, 0
 buffer_load_dword v13, v1, s[20:23], s49 offen sc1
K3_spinl_l:
 s_sleep 3
 buffer_load_dword v8, v1, s[20:23], s49 offen sc1
 s_waitcnt vmcnt(1)
 v_cmp_ne_u32 vcc, s89, v13
 s_nop 0
 s_and_b64 vcc, vcc, s[30:31]
 s_cbranch_vccz K3_spinl_b
 s_sleep 3
 buffer_load_dword v13, v1, s[20:23], s49 offen sc1
 s_waitcnt vmcnt(1)
 v_cmp_ne_u32 vcc, s89, v8
 s_nop 0
 s_and_b64 vcc, vcc, s[30:31]
 s_add_u32 s88, s88, 1
 s_cmp_gt_u32 s88, 0x80000
 s_cbranch_scc1 K3_spinl_b
 s_cbranch_vccnz K3_spinl_l
 s_branch K3_spinl_b
K3_spin2:
 s_mov_b32 s88, 0
 buffer_load_dword v13, v1, s[20:23], s49 offen sc1
K3_spin2_l:
 s_sleep 3
 buffer_load_dword v8, v1, s[20:23], s49 offen sc1
 s_waitcnt vmcnt(1)
 v_cmp_ne_u32 vcc, s89, v13
 s_nop 0
 s_and_b64 vcc, vcc, s[30:31]
 s_cbranch_vccz K3_spin2_b
 s_sleep 3
 buffer_load_dword v13, v1, s[20:23], s49 offen sc1
 s_waitcnt vmcnt(1)
 v_cmp_ne_u32 vcc, s89, v8
 s_nop 0
 s_and_b64 vcc, vcc, s[30:31]
 s_add_u32 s88, s88, 1
 s_cmp_gt_u32 s88, 0x80000
 s_cbranch_scc1 K3_spin2_b
 s_cbranch_vccnz K3_spin2_l
 s_branch K3_spin2_b
K2_rare2:
 s_nop 15
 s_nop 15
 v_max3_f32 v232, v80, v81, v82
 v_max3_f32 v232, v232, v83, v84
 v_max3_f32 v232, v232, v85, v86
 v_max3_f32 v232, v232, v87, v88
 v_max3_f32 v232, v232, v89, v90
 v_max3_f32 v232, v232, v91, v92
 v_max3_f32 v232, v232, v93, v94
 v_max_f32 v232, v232, v95
 v_mov_b32 v233, v232
 s_nop 1
 v_permlane32_swap_b32 v232, v233
 v_max_f32 v232, v232, v233
 v_max_f32 v232, 0, v232
 v_sub_f32 v80, v80, v232
 v_sub_f32 v81, v81, v232
 v_sub_f32 v82, v82, v232
 v_sub_f32 v83, v83, v232
 v_sub_f32 v84, v84, v232
 v_sub_f32 v85, v85, v232
 v_sub_f32 v86, v86, v232
 v_sub_f32 v87, v87, v232
 v_sub_f32 v88, v88, v232
 v_sub_f32 v89, v89, v232
 v_sub_f32 v90, v90, v232
 v_sub_f32 v91, v91, v232
 v_sub_f32 v92, v92, v232
 v_sub_f32 v93, v93, v232
 v_sub_f32 v94, v94, v232
 v_sub_f32 v95, v95, v232
 v_sub_f32 v112, v112, v232
 v_sub_f32 v113, v113, v232
 v_sub_f32 v114, v114, v232
 v_sub_f32 v115, v115, v232
 v_sub_f32 v116, v116, v232
 v_sub_f32 v117, v117, v232
 v_sub_f32 v118, v118, v232
 v_sub_f32 v119, v119, v232
 v_sub_f32 v120, v120, v232
 v_sub_f32 v121, v121, v232
 v_sub_f32 v122, v122, v232
 v_sub_f32 v123, v123, v232
 v_sub_f32 v124, v124, v232
 v_sub_f32 v125, v125, v232
 v_sub_f32 v126, v126, v232
 v_sub_f32 v127, v127, v232
 v_sub_f32 v144, v144, v232
 v_sub_f32 v145, v145, v232
 v_sub_f32 v146, v146, v232
 v_sub_f32 v147, v147, v232
 v_sub_f32 v148, v148, v232
 v_sub_f32 v149, v149, v232
 v_sub_f32 v150, v150, v232
 v_sub_f32 v151, v151, v232
 v_sub_f32 v152, v152, v232
 v_sub_f32 v153, v153, v232
 v_sub_f32 v154, v154, v232
 v_sub_f32 v155, v155, v232
 v_sub_f32 v156, v156, v232
 v_sub_f32 v157, v157, v232
 v_sub_f32 v158, v158, v232
 v_sub_f32 v159, v159, v232
 v_exp_f32 v233, -v232
 s_nop 0
 v_mul_f32 v228, v228, v233
 v_accvgpr_read_b32 v236, a0
 v_accvgpr_read_b32 v237, a1
 v_accvgpr_read_b32 v238, a2
 v_accvgpr_read_b32 v239, a3
 v_mul_f32 v236, v236, v233
 v_mul_f32 v237, v237, v233
 v_mul_f32 v238, v238, v233
 v_mul_f32 v239, v239, v233
 v_accvgpr_write_b32 a0, v236
 v_accvgpr_write_b32 a1, v237
 v_accvgpr_write_b32 a2, v238
 v_accvgpr_write_b32 a3, v239
 v_accvgpr_read_b32 v236, a4
 v_accvgpr_read_b32 v237, a5
 v_accvgpr_read_b32 v238, a6
 v_accvgpr_read_b32 v239, a7
 v_mul_f32 v236, v236, v233
 v_mul_f32 v237, v237, v233
 v_mul_f32 v238, v238, v233
 v_mul_f32 v239, v239, v233
 v_accvgpr_write_b32 a4, v236
 v_accvgpr_write_b32 a5, v237
 v_accvgpr_write_b32 a6, v238
 v_accvgpr_write_b32 a7, v239
 v_accvgpr_read_b32 v236, a8
 v_accvgpr_read_b32 v237, a9
 v_accvgpr_read_b32 v238, a10
 v_accvgpr_read_b32 v239, a11
 v_mul_f32 v236, v236, v233
 v_mul_f32 v237, v237, v233
 v_mul_f32 v238, v238, v233
 v_mul_f32 v239, v239, v233
 v_accvgpr_write_b32 a8, v236
 v_accvgpr_write_b32 a9, v237
 v_accvgpr_write_b32 a10, v238
 v_accvgpr_write_b32 a11, v239
 v_accvgpr_read_b32 v236, a12
 v_accvgpr_read_b32 v237, a13
 v_accvgpr_read_b32 v238, a14
 v_accvgpr_read_b32 v239, a15
 v_mul_f32 v236, v236, v233
 v_mul_f32 v237, v237, v233
 v_mul_f32 v238, v238, v233
 v_mul_f32 v239, v239, v233
 v_accvgpr_write_b32 a12, v236
 v_accvgpr_write_b32 a13, v237
 v_accvgpr_write_b32 a14, v238
 v_accvgpr_write_b32 a15, v239
 v_accvgpr_read_b32 v236, a16
 v_accvgpr_read_b32 v237, a17
 v_accvgpr_read_b32 v238, a18
 v_accvgpr_read_b32 v239, a19
 v_mul_f32 v236, v236, v233
 v_mul_f32 v237, v237, v233
 v_mul_f32 v238, v238, v233
 v_mul_f32 v239, v239, v233
 v_accvgpr_write_b32 a16, v236
 v_accvgpr_write_b32 a17, v237
 v_accvgpr_write_b32 a18, v238
 v_accvgpr_write_b32 a19, v239
 v_accvgpr_read_b32 v236, a20
 v_accvgpr_read_b32 v237, a21
 v_accvgpr_read_b32 v238, a22
 v_accvgpr_read_b32 v239, a23
 v_mul_f32 v236, v236, v233
 v_mul_f32 v237, v237, v233
 v_mul_f32 v238, v238, v233
 v_mul_f32 v239, v239, v233
 v_accvgpr_write_b32 a20, v236
 v_accvgpr_write_b32 a21, v237
 v_accvgpr_write_b32 a22, v238
 v_accvgpr_write_b32 a23, v239
 v_accvgpr_read_b32 v236, a24
 v_accvgpr_read_b32 v237, a25
 v_accvgpr_read_b32 v238, a26
 v_accvgpr_read_b32 v239, a27
 v_mul_f32 v236, v236, v233
 v_mul_f32 v237, v237, v233
 v_mul_f32 v238, v238, v233
 v_mul_f32 v239, v239, v233
 v_accvgpr_write_b32 a24, v236
 v_accvgpr_write_b32 a25, v237
 v_accvgpr_write_b32 a26, v238
 v_accvgpr_write_b32 a27, v239
 v_accvgpr_read_b32 v236, a28
 v_accvgpr_read_b32 v237, a29
 v_accvgpr_read_b32 v238, a30
 v_accvgpr_read_b32 v239, a31
 v_mul_f32 v236, v236, v233
 v_mul_f32 v237, v237, v233
 v_mul_f32 v238, v238, v233
 v_mul_f32 v239, v239, v233
 v_accvgpr_write_b32 a28, v236
 v_accvgpr_write_b32 a29, v237
 v_accvgpr_write_b32 a30, v238
 v_accvgpr_write_b32 a31, v239
 v_accvgpr_read_b32 v236, a32
 v_accvgpr_read_b32 v237, a33
 v_accvgpr_read_b32 v238, a34
 v_accvgpr_read_b32 v239, a35
 v_mul_f32 v236, v236, v233
 v_mul_f32 v237, v237, v233
 v_mul_f32 v238, v238, v233
 v_mul_f32 v239, v239, v233
 v_accvgpr_write_b32 a32, v236
 v_accvgpr_write_b32 a33, v237
 v_accvgpr_write_b32 a34, v238
 v_accvgpr_write_b32 a35, v239
 v_accvgpr_read_b32 v236, a36
 v_accvgpr_read_b32 v237, a37
 v_accvgpr_read_b32 v238, a38
 v_accvgpr_read_b32 v239, a39
 v_mul_f32 v236, v236, v233
 v_mul_f32 v237, v237, v233
 v_mul_f32 v238, v238, v233
 v_mul_f32 v239, v239, v233
 v_accvgpr_write_b32 a36, v236
 v_accvgpr_write_b32 a37, v237
 v_accvgpr_write_b32 a38, v238
 v_accvgpr_write_b32 a39, v239
 v_accvgpr_read_b32 v236, a40
 v_accvgpr_read_b32 v237, a41
 v_accvgpr_read_b32 v238, a42
 v_accvgpr_read_b32 v239, a43
 v_mul_f32 v236, v236, v233
 v_mul_f32 v237, v237, v233
 v_mul_f32 v238, v238, v233
 v_mul_f32 v239, v239, v233
 v_accvgpr_write_b32 a40, v236
 v_accvgpr_write_b32 a41, v237
 v_accvgpr_write_b32 a42, v238
 v_accvgpr_write_b32 a43, v239
 v_accvgpr_read_b32 v236, a44
 v_accvgpr_read_b32 v237, a45
 v_accvgpr_read_b32 v238, a46
 v_accvgpr_read_b32 v239, a47
 v_mul_f32 v236, v236, v233
 v_mul_f32 v237, v237, v233
 v_mul_f32 v238, v238, v233
 v_mul_f32 v239, v239, v233
 v_accvgpr_write_b32 a44, v236
 v_accvgpr_write_b32 a45, v237
 v_accvgpr_write_b32 a46, v238
 v_accvgpr_write_b32 a47, v239
 v_accvgpr_read_b32 v236, a48
 v_accvgpr_read_b32 v237, a49
 v_accvgpr_read_b32 v238, a50
 v_accvgpr_read_b32 v239, a51
 v_mul_f32 v236, v236, v233
 v_mul_f32 v237, v237, v233
 v_mul_f32 v238, v238, v233
 v_mul_f32 v239, v239, v233
 v_accvgpr_write_b32 a48, v236
 v_accvgpr_write_b32 a49, v237
 v_accvgpr_write_b32 a50, v238
 v_accvgpr_write_b32 a51, v239
 v_accvgpr_read_b32 v236, a52
 v_accvgpr_read_b32 v237, a53
 v_accvgpr_read_b32 v238, a54
 v_accvgpr_read_b32 v239, a55
 v_mul_f32 v236, v236, v233
 v_mul_f32 v237, v237, v233
 v_mul_f32 v238, v238, v233
 v_mul_f32 v239, v239, v233
 v_accvgpr_write_b32 a52, v236
 v_accvgpr_write_b32 a53, v237
 v_accvgpr_write_b32 a54, v238
 v_accvgpr_write_b32 a55, v239
 v_accvgpr_read_b32 v236, a56
 v_accvgpr_read_b32 v237, a57
 v_accvgpr_read_b32 v238, a58
 v_accvgpr_read_b32 v239, a59
 v_mul_f32 v236, v236, v233
 v_mul_f32 v237, v237, v233
 v_mul_f32 v238, v238, v233
 v_mul_f32 v239, v239, v233
 v_accvgpr_write_b32 a56, v236
 v_accvgpr_write_b32 a57, v237
 v_accvgpr_write_b32 a58, v238
 v_accvgpr_write_b32 a59, v239
 v_accvgpr_read_b32 v236, a60
 v_accvgpr_read_b32 v237, a61
 v_accvgpr_read_b32 v238, a62
 v_accvgpr_read_b32 v239, a63
 v_mul_f32 v236, v236, v233
 v_mul_f32 v237, v237, v233
 v_mul_f32 v238, v238, v233
 v_mul_f32 v239, v239, v233
 v_accvgpr_write_b32 a60, v236
 v_accvgpr_write_b32 a61, v237
 v_accvgpr_write_b32 a62, v238
 v_accvgpr_write_b32 a63, v239
 v_exp_f32 v208, v80
 v_exp_f32 v209, v81
 s_nop 0
 v_add_f32 v226, v208, v209
 v_cvt_pk_bf16_f32 v192, v208, v209
 v_exp_f32 v210, v82
 v_exp_f32 v211, v83
 v_add_f32 v226, v226, v210
 v_add_f32 v226, v226, v211
 v_cvt_pk_bf16_f32 v193, v210, v211
 v_exp_f32 v212, v84
 v_exp_f32 v213, v85
 v_add_f32 v226, v226, v212
 v_add_f32 v226, v226, v213
 v_cvt_pk_bf16_f32 v194, v212, v213
 v_exp_f32 v214, v86
 v_exp_f32 v215, v87
 v_add_f32 v226, v226, v214
 v_add_f32 v226, v226, v215
 v_cvt_pk_bf16_f32 v195, v214, v215
 v_exp_f32 v208, v88
 v_exp_f32 v209, v89
 v_add_f32 v226, v226, v208
 v_exp_f32 v210, v90
 v_add_f32 v226, v226, v209
 v_cvt_pk_bf16_f32 v196, v208, v209
 v_exp_f32 v211, v91
 v_add_f32 v226, v226, v210
 v_exp_f32 v212, v92
 v_add_f32 v226, v226, v211
 v_exp_f32 v213, v93
 v_cvt_pk_bf16_f32 v197, v210, v211
 v_exp_f32 v214, v94
 v_add_f32 v226, v226, v212
 v_add_f32 v226, v226, v213
 v_exp_f32 v215, v95
 v_cvt_pk_bf16_f32 v198, v212, v213
 v_add_f32 v226, v226, v214
 v_add_f32 v226, v226, v215
 v_cvt_pk_bf16_f32 v199, v214, v215
 s_nop 3
 s_branch K2_back2
K2_rare3:
 s_nop 15
 s_nop 15
 v_max3_f32 v232, v96, v97, v98
 v_max3_f32 v232, v232, v99, v100
 v_max3_f32 v232, v232, v101, v102
 v_max3_f32 v232, v232, v103, v104
 v_max3_f32 v232, v232, v105, v106
 v_max3_f32 v232, v232, v107, v108
 v_max3_f32 v232, v232, v109, v110
 v_max_f32 v232, v232, v111
 v_mov_b32 v233, v232
 s_nop 1
 v_permlane32_swap_b32 v232, v233
 v_max_f32 v232, v232, v233
 v_max_f32 v232, 0, v232
 v_sub_f32 v96, v96, v232
 v_sub_f32 v97, v97, v232
 v_sub_f32 v98, v98, v232
 v_sub_f32 v99, v99, v232
 v_sub_f32 v100, v100, v232
 v_sub_f32 v101, v101, v232
 v_sub_f32 v102, v102, v232
 v_sub_f32 v103, v103, v232
 v_sub_f32 v104, v104, v232
 v_sub_f32 v105, v105, v232
 v_sub_f32 v106, v106, v232
 v_sub_f32 v107, v107, v232
 v_sub_f32 v108, v108, v232
 v_sub_f32 v109, v109, v232
 v_sub_f32 v110, v110, v232
 v_sub_f32 v111, v111, v232
 v_sub_f32 v128, v128, v232
 v_sub_f32 v129, v129, v232
 v_sub_f32 v130, v130, v232
 v_sub_f32 v131, v131, v232
 v_sub_f32 v132, v132, v232
 v_sub_f32 v133, v133, v232
 v_sub_f32 v134, v134, v232
 v_sub_f32 v135, v135, v232
 v_sub_f32 v136, v136, v232
 v_sub_f32 v137, v137, v232
 v_sub_f32 v138, v138, v232
 v_sub_f32 v139, v139, v232
 v_sub_f32 v140, v140, v232
 v_sub_f32 v141, v141, v232
 v_sub_f32 v142, v142, v232
 v_sub_f32 v143, v143, v232
 v_sub_f32 v160, v160, v232
 v_sub_f32 v161, v161, v232
 v_sub_f32 v162, v162, v232
 v_sub_f32 v163, v163, v232
 v_sub_f32 v164, v164, v232
 v_sub_f32 v165, v165, v232
 v_sub_f32 v166, v166, v232
 v_sub_f32 v167, v167, v232
 v_sub_f32 v168, v168, v232
 v_sub_f32 v169, v169, v232
 v_sub_f32 v170, v170, v232
 v_sub_f32 v171, v171, v232
 v_sub_f32 v172, v172, v232
 v_sub_f32 v173, v173, v232
 v_sub_f32 v174, v174, v232
 v_sub_f32 v175, v175, v232
 v_sub_f32 v176, v176, v232
 v_sub_f32 v177, v177, v232
 v_sub_f32 v178, v178, v232
 v_sub_f32 v179, v179, v232
 v_sub_f32 v180, v180, v232
 v_sub_f32 v181, v181, v232
 v_sub_f32 v182, v182, v232
 v_sub_f32 v183, v183, v232
 v_sub_f32 v184, v184, v232
 v_sub_f32 v185, v185, v232
 v_sub_f32 v186, v186, v232
 v_sub_f32 v187, v187, v232
 v_sub_f32 v188, v188, v232
 v_sub_f32 v189, v189, v232
 v_sub_f32 v190, v190, v232
 v_sub_f32 v191, v191, v232
 v_exp_f32 v233, -v232
 s_nop 0
 v_mul_f32 v229, v229, v233
 v_accvgpr_read_b32 v236, a64
 v_accvgpr_read_b32 v237, a65
 v_accvgpr_read_b32 v238, a66
 v_accvgpr_read_b32 v239, a67
 v_mul_f32 v236, v236, v233
 v_mul_f32 v237, v237, v233
 v_mul_f32 v238, v238, v233
 v_mul_f32 v239, v239, v233
 v_accvgpr_write_b32 a64, v236
 v_accvgpr_write_b32 a65, v237
 v_accvgpr_write_b32 a66, v238
 v_accvgpr_write_b32 a67, v239
 v_accvgpr_read_b32 v236, a68
 v_accvgpr_read_b32 v237, a69
 v_accvgpr_read_b32 v238, a70
 v_accvgpr_read_b32 v239, a71
 v_mul_f32 v236, v236, v233
 v_mul_f32 v237, v237, v233
 v_mul_f32 v238, v238, v233
 v_mul_f32 v239, v239, v233
 v_accvgpr_write_b32 a68, v236
 v_accvgpr_write_b32 a69, v237
 v_accvgpr_write_b32 a70, v238
 v_accvgpr_write_b32 a71, v239
 v_accvgpr_read_b32 v236, a72
 v_accvgpr_read_b32 v237, a73
 v_accvgpr_read_b32 v238, a74
 v_accvgpr_read_b32 v239, a75
 v_mul_f32 v236, v236, v233
 v_mul_f32 v237, v237, v233
 v_mul_f32 v238, v238, v233
 v_mul_f32 v239, v239, v233
 v_accvgpr_write_b32 a72, v236
 v_accvgpr_write_b32 a73, v237
 v_accvgpr_write_b32 a74, v238
 v_accvgpr_write_b32 a75, v239
 v_accvgpr_read_b32 v236, a76
 v_accvgpr_read_b32 v237, a77
 v_accvgpr_read_b32 v238, a78
 v_accvgpr_read_b32 v239, a79
 v_mul_f32 v236, v236, v233
 v_mul_f32 v237, v237, v233
 v_mul_f32 v238, v238, v233
 v_mul_f32 v239, v239, v233
 v_accvgpr_write_b32 a76, v236
 v_accvgpr_write_b32 a77, v237
 v_accvgpr_write_b32 a78, v238
 v_accvgpr_write_b32 a79, v239
 v_accvgpr_read_b32 v236, a80
 v_accvgpr_read_b32 v237, a81
 v_accvgpr_read_b32 v238, a82
 v_accvgpr_read_b32 v239, a83
 v_mul_f32 v236, v236, v233
 v_mul_f32 v237, v237, v233
 v_mul_f32 v238, v238, v233
 v_mul_f32 v239, v239, v233
 v_accvgpr_write_b32 a80, v236
 v_accvgpr_write_b32 a81, v237
 v_accvgpr_write_b32 a82, v238
 v_accvgpr_write_b32 a83, v239
 v_accvgpr_read_b32 v236, a84
 v_accvgpr_read_b32 v237, a85
 v_accvgpr_read_b32 v238, a86
 v_accvgpr_read_b32 v239, a87
 v_mul_f32 v236, v236, v233
 v_mul_f32 v237, v237, v233
 v_mul_f32 v238, v238, v233
 v_mul_f32 v239, v239, v233
 v_accvgpr_write_b32 a84, v236
 v_accvgpr_write_b32 a85, v237
 v_accvgpr_write_b32 a86, v238
 v_accvgpr_write_b32 a87, v239
 v_accvgpr_read_b32 v236, a88
 v_accvgpr_read_b32 v237, a89
 v_accvgpr_read_b32 v238, a90
 v_accvgpr_read_b32 v239, a91
 v_mul_f32 v236, v236, v233
 v_mul_f32 v237, v237, v233
 v_mul_f32 v238, v238, v233
 v_mul_f32 v239, v239, v233
 v_accvgpr_write_b32 a88, v236
 v_accvgpr_write_b32 a89, v237
 v_accvgpr_write_b32 a90, v238
 v_accvgpr_write_b32 a91, v239
 v_accvgpr_read_b32 v236, a92
 v_accvgpr_read_b32 v237, a93
 v_accvgpr_read_b32 v238, a94
 v_accvgpr_read_b32 v239, a95
 v_mul_f32 v236, v236, v233
 v_mul_f32 v237, v237, v233
 v_mul_f32 v238, v238, v233
 v_mul_f32 v239, v239, v233
 v_accvgpr_write_b32 a92, v236
 v_accvgpr_write_b32 a93, v237
 v_accvgpr_write_b32 a94, v238
 v_accvgpr_write_b32 a95, v239
 v_accvgpr_read_b32 v236, a96
 v_accvgpr_read_b32 v237, a97
 v_accvgpr_read_b32 v238, a98
 v_accvgpr_read_b32 v239, a99
 v_mul_f32 v236, v236, v233
 v_mul_f32 v237, v237, v233
 v_mul_f32 v238, v238, v233
 v_mul_f32 v239, v239, v233
 v_accvgpr_write_b32 a96, v236
 v_accvgpr_write_b32 a97, v237
 v_accvgpr_write_b32 a98, v238
 v_accvgpr_write_b32 a99, v239
 v_accvgpr_read_b32 v236, a100
 v_accvgpr_read_b32 v237, a101
 v_accvgpr_read_b32 v238, a102
 v_accvgpr_read_b32 v239, a103
 v_mul_f32 v236, v236, v233
 v_mul_f32 v237, v237, v233
 v_mul_f32 v238, v238, v233
 v_mul_f32 v239, v239, v233
 v_accvgpr_write_b32 a100, v236
 v_accvgpr_write_b32 a101, v237
 v_accvgpr_write_b32 a102, v238
 v_accvgpr_write_b32 a103, v239
 v_accvgpr_read_b32 v236, a104
 v_accvgpr_read_b32 v237, a105
 v_accvgpr_read_b32 v238, a106
 v_accvgpr_read_b32 v239, a107
 v_mul_f32 v236, v236, v233
 v_mul_f32 v237, v237, v233
 v_mul_f32 v238, v238, v233
 v_mul_f32 v239, v239, v233
 v_accvgpr_write_b32 a104, v236
 v_accvgpr_write_b32 a105, v237
 v_accvgpr_write_b32 a106, v238
 v_accvgpr_write_b32 a107, v239
 v_accvgpr_read_b32 v236, a108
 v_accvgpr_read_b32 v237, a109
 v_accvgpr_read_b32 v238, a110
 v_accvgpr_read_b32 v239, a111
 v_mul_f32 v236, v236, v233
 v_mul_f32 v237, v237, v233
 v_mul_f32 v238, v238, v233
 v_mul_f32 v239, v239, v233
 v_accvgpr_write_b32 a108, v236
 v_accvgpr_write_b32 a109, v237
 v_accvgpr_write_b32 a110, v238
 v_accvgpr_write_b32 a111, v239
 v_accvgpr_read_b32 v236, a112
 v_accvgpr_read_b32 v237, a113
 v_accvgpr_read_b32 v238, a114
 v_accvgpr_read_b32 v239, a115
 v_mul_f32 v236, v236, v233
 v_mul_f32 v237, v237, v233
 v_mul_f32 v238, v238, v233
 v_mul_f32 v239, v239, v233
 v_accvgpr_write_b32 a112, v236
 v_accvgpr_write_b32 a113, v237
 v_accvgpr_write_b32 a114, v238
 v_accvgpr_write_b32 a115, v239
 v_accvgpr_read_b32 v236, a116
 v_accvgpr_read_b32 v237, a117
 v_accvgpr_read_b32 v238, a118
 v_accvgpr_read_b32 v239, a119
 v_mul_f32 v236, v236, v233
 v_mul_f32 v237, v237, v233
 v_mul_f32 v238, v238, v233
 v_mul_f32 v239, v239, v233
 v_accvgpr_write_b32 a116, v236
 v_accvgpr_write_b32 a117, v237
 v_accvgpr_write_b32 a118, v238
 v_accvgpr_write_b32 a119, v239
 v_accvgpr_read_b32 v236, a120
 v_accvgpr_read_b32 v237, a121
 v_accvgpr_read_b32 v238, a122
 v_accvgpr_read_b32 v239, a123
 v_mul_f32 v236, v236, v233
 v_mul_f32 v237, v237, v233
 v_mul_f32 v238, v238, v233
 v_mul_f32 v239, v239, v233
 v_accvgpr_write_b32 a120, v236
 v_accvgpr_write_b32 a121, v237
 v_accvgpr_write_b32 a122, v238
 v_accvgpr_write_b32 a123, v239
 v_accvgpr_read_b32 v236, a124
 v_accvgpr_read_b32 v237, a125
 v_accvgpr_read_b32 v238, a126
 v_accvgpr_read_b32 v239, a127
 v_mul_f32 v236, v236, v233
 v_mul_f32 v237, v237, v233
 v_mul_f32 v238, v238, v233
 v_mul_f32 v239, v239, v233
 v_accvgpr_write_b32 a124, v236
 v_accvgpr_write_b32 a125, v237
 v_accvgpr_write_b32 a126, v238
 v_accvgpr_write_b32 a127, v239
 v_exp_f32 v216, v96
 v_exp_f32 v217, v97
 v_exp_f32 v218, v98
 v_exp_f32 v219, v99
 v_add_f32 v227, v216, v217
 v_exp_f32 v220, v100
 v_exp_f32 v221, v101
 v_cvt_pk_bf16_f32 v200, v216, v217
 v_add_f32 v227, v227, v218
 v_add_f32 v227, v227, v219
 v_exp_f32 v222, v102
 v_exp_f32 v223, v103
 v_cvt_pk_bf16_f32 v201, v218, v219
 v_add_f32 v227, v227, v220
 v_exp_f32 v216, v104
 v_exp_f32 v217, v105
 v_add_f32 v227, v227, v221
 v_cvt_pk_bf16_f32 v202, v220, v221
 v_exp_f32 v218, v106
 v_add_f32 v227, v227, v222
 v_add_f32 v227, v227, v223
 v_exp_f32 v219, v107
 v_cvt_pk_bf16_f32 v203, v222, v223
 v_add_f32 v227, v227, v216
 v_add_f32 v227, v227, v217
 v_exp_f32 v220, v108
 v_cvt_pk_bf16_f32 v204, v216, v217
 v_exp_f32 v221, v109
 v_add_f32 v227, v227, v218
 v_add_f32 v227, v227, v219
 v_cvt_pk_bf16_f32 v205, v218, v219
 v_exp_f32 v222, v110
 v_add_f32 v227, v227, v220
 v_add_f32 v227, v227, v221
 v_cvt_pk_bf16_f32 v206, v220, v221
 v_exp_f32 v223, v111
 v_add_f32 v227, v227, v222
 v_add_f32 v227, v227, v223
 v_cvt_pk_bf16_f32 v207, v222, v223
 s_nop 3
 s_branch K2_back3
K2_rare5:
 s_nop 15
 s_nop 15
 v_max3_f32 v232, v112, v113, v114
 v_max3_f32 v232, v232, v115, v116
 v_max3_f32 v232, v232, v117, v118
 v_max3_f32 v232, v232, v119, v120
 v_max3_f32 v232, v232, v121, v122
 v_max3_f32 v232, v232, v123, v124
 v_max3_f32 v232, v232, v125, v126
 v_max_f32 v232, v232, v127
 v_mov_b32 v233, v232
 s_nop 1
 v_permlane32_swap_b32 v232, v233
 v_max_f32 v232, v232, v233
 v_max_f32 v232, 0, v232
 v_sub_f32 v112, v112, v232
 v_sub_f32 v113, v113, v232
 v_sub_f32 v114, v114, v232
 v_sub_f32 v115, v115, v232
 v_sub_f32 v116, v116, v232
 v_sub_f32 v117, v117, v232
 v_sub_f32 v118, v118, v232
 v_sub_f32 v119, v119, v232
 v_sub_f32 v120, v120, v232
 v_sub_f32 v121, v121, v232
 v_sub_f32 v122, v122, v232
 v_sub_f32 v123, v123, v232
 v_sub_f32 v124, v124, v232
 v_sub_f32 v125, v125, v232
 v_sub_f32 v126, v126, v232
 v_sub_f32 v127, v127, v232
 v_sub_f32 v80, v80, v232
 v_sub_f32 v81, v81, v232
 v_sub_f32 v82, v82, v232
 v_sub_f32 v83, v83, v232
 v_sub_f32 v84, v84, v232
 v_sub_f32 v85, v85, v232
 v_sub_f32 v86, v86, v232
 v_sub_f32 v87, v87, v232
 v_sub_f32 v88, v88, v232
 v_sub_f32 v89, v89, v232
 v_sub_f32 v90, v90, v232
 v_sub_f32 v91, v91, v232
 v_sub_f32 v92, v92, v232
 v_sub_f32 v93, v93, v232
 v_sub_f32 v94, v94, v232
 v_sub_f32 v95, v95, v232
 v_sub_f32 v144, v144, v232
 v_sub_f32 v145, v145, v232
 v_sub_f32 v146, v146, v232
 v_sub_f32 v147, v147, v232
 v_sub_f32 v148, v148, v232
 v_sub_f32 v149, v149, v232
 v_sub_f32 v150, v150, v232
 v_sub_f32 v151, v151, v232
 v_sub_f32 v152, v152, v232
 v_sub_f32 v153, v153, v232
 v_sub_f32 v154, v154, v232
 v_sub_f32 v155, v155, v232
 v_sub_f32 v156, v156, v232
 v_sub_f32 v157, v157, v232
 v_sub_f32 v158, v158, v232
 v_sub_f32 v159, v159, v232
 v_exp_f32 v233, -v232
 s_nop 0
 v_mul_f32 v228, v228, v233
 v_accvgpr_read_b32 v236, a0
 v_accvgpr_read_b32 v237, a1
 v_accvgpr_read_b32 v238, a2
 v_accvgpr_read_b32 v239, a3
 v_mul_f32 v236, v236, v233
 v_mul_f32 v237, v237, v233
 v_mul_f32 v238, v238, v233
 v_mul_f32 v239, v239, v233
 v_accvgpr_write_b32 a0, v236
 v_accvgpr_write_b32 a1, v237
 v_accvgpr_write_b32 a2, v238
 v_accvgpr_write_b32 a3, v239
 v_accvgpr_read_b32 v236, a4
 v_accvgpr_read_b32 v237, a5
 v_accvgpr_read_b32 v238, a6
 v_accvgpr_read_b32 v239, a7
 v_mul_f32 v236, v236, v233
 v_mul_f32 v237, v237, v233
 v_mul_f32 v238, v238, v233
 v_mul_f32 v239, v239, v233
 v_accvgpr_write_b32 a4, v236
 v_accvgpr_write_b32 a5, v237
 v_accvgpr_write_b32 a6, v238
 v_accvgpr_write_b32 a7, v239
 v_accvgpr_read_b32 v236, a8
 v_accvgpr_read_b32 v237, a9
 v_accvgpr_read_b32 v238, a10
 v_accvgpr_read_b32 v239, a11
 v_mul_f32 v236, v236, v233
 v_mul_f32 v237, v237, v233
 v_mul_f32 v238, v238, v233
 v_mul_f32 v239, v239, v233
 v_accvgpr_write_b32 a8, v236
 v_accvgpr_write_b32 a9, v237
 v_accvgpr_write_b32 a10, v238
 v_accvgpr_write_b32 a11, v239
 v_accvgpr_read_b32 v236, a12
 v_accvgpr_read_b32 v237, a13
 v_accvgpr_read_b32 v238, a14
 v_accvgpr_read_b32 v239, a15
 v_mul_f32 v236, v236, v233
 v_mul_f32 v237, v237, v233
 v_mul_f32 v238, v238, v233
 v_mul_f32 v239, v239, v233
 v_accvgpr_write_b32 a12, v236
 v_accvgpr_write_b32 a13, v237
 v_accvgpr_write_b32 a14, v238
 v_accvgpr_write_b32 a15, v239
 v_accvgpr_read_b32 v236, a16
 v_accvgpr_read_b32 v237, a17
 v_accvgpr_read_b32 v238, a18
 v_accvgpr_read_b32 v239, a19
 v_mul_f32 v236, v236, v233
 v_mul_f32 v237, v237, v233
 v_mul_f32 v238, v238, v233
 v_mul_f32 v239, v239, v233
 v_accvgpr_write_b32 a16, v236
 v_accvgpr_write_b32 a17, v237
 v_accvgpr_write_b32 a18, v238
 v_accvgpr_write_b32 a19, v239
 v_accvgpr_read_b32 v236, a20
 v_accvgpr_read_b32 v237, a21
 v_accvgpr_read_b32 v238, a22
 v_accvgpr_read_b32 v239, a23
 v_mul_f32 v236, v236, v233
 v_mul_f32 v237, v237, v233
 v_mul_f32 v238, v238, v233
 v_mul_f32 v239, v239, v233
 v_accvgpr_write_b32 a20, v236
 v_accvgpr_write_b32 a21, v237
 v_accvgpr_write_b32 a22, v238
 v_accvgpr_write_b32 a23, v239
 v_accvgpr_read_b32 v236, a24
 v_accvgpr_read_b32 v237, a25
 v_accvgpr_read_b32 v238, a26
 v_accvgpr_read_b32 v239, a27
 v_mul_f32 v236, v236, v233
 v_mul_f32 v237, v237, v233
 v_mul_f32 v238, v238, v233
 v_mul_f32 v239, v239, v233
 v_accvgpr_write_b32 a24, v236
 v_accvgpr_write_b32 a25, v237
 v_accvgpr_write_b32 a26, v238
 v_accvgpr_write_b32 a27, v239
 v_accvgpr_read_b32 v236, a28
 v_accvgpr_read_b32 v237, a29
 v_accvgpr_read_b32 v238, a30
 v_accvgpr_read_b32 v239, a31
 v_mul_f32 v236, v236, v233
 v_mul_f32 v237, v237, v233
 v_mul_f32 v238, v238, v233
 v_mul_f32 v239, v239, v233
 v_accvgpr_write_b32 a28, v236
 v_accvgpr_write_b32 a29, v237
 v_accvgpr_write_b32 a30, v238
 v_accvgpr_write_b32 a31, v239
 v_accvgpr_read_b32 v236, a32
 v_accvgpr_read_b32 v237, a33
 v_accvgpr_read_b32 v238, a34
 v_accvgpr_read_b32 v239, a35
 v_mul_f32 v236, v236, v233
 v_mul_f32 v237, v237, v233
 v_mul_f32 v238, v238, v233
 v_mul_f32 v239, v239, v233
 v_accvgpr_write_b32 a32, v236
 v_accvgpr_write_b32 a33, v237
 v_accvgpr_write_b32 a34, v238
 v_accvgpr_write_b32 a35, v239
 v_accvgpr_read_b32 v236, a36
 v_accvgpr_read_b32 v237, a37
 v_accvgpr_read_b32 v238, a38
 v_accvgpr_read_b32 v239, a39
 v_mul_f32 v236, v236, v233
 v_mul_f32 v237, v237, v233
 v_mul_f32 v238, v238, v233
 v_mul_f32 v239, v239, v233
 v_accvgpr_write_b32 a36, v236
 v_accvgpr_write_b32 a37, v237
 v_accvgpr_write_b32 a38, v238
 v_accvgpr_write_b32 a39, v239
 v_accvgpr_read_b32 v236, a40
 v_accvgpr_read_b32 v237, a41
 v_accvgpr_read_b32 v238, a42
 v_accvgpr_read_b32 v239, a43
 v_mul_f32 v236, v236, v233
 v_mul_f32 v237, v237, v233
 v_mul_f32 v238, v238, v233
 v_mul_f32 v239, v239, v233
 v_accvgpr_write_b32 a40, v236
 v_accvgpr_write_b32 a41, v237
 v_accvgpr_write_b32 a42, v238
 v_accvgpr_write_b32 a43, v239
 v_accvgpr_read_b32 v236, a44
 v_accvgpr_read_b32 v237, a45
 v_accvgpr_read_b32 v238, a46
 v_accvgpr_read_b32 v239, a47
 v_mul_f32 v236, v236, v233
 v_mul_f32 v237, v237, v233
 v_mul_f32 v238, v238, v233
 v_mul_f32 v239, v239, v233
 v_accvgpr_write_b32 a44, v236
 v_accvgpr_write_b32 a45, v237
 v_accvgpr_write_b32 a46, v238
 v_accvgpr_write_b32 a47, v239
 v_accvgpr_read_b32 v236, a48
 v_accvgpr_read_b32 v237, a49
 v_accvgpr_read_b32 v238, a50
 v_accvgpr_read_b32 v239, a51
 v_mul_f32 v236, v236, v233
 v_mul_f32 v237, v237, v233
 v_mul_f32 v238, v238, v233
 v_mul_f32 v239, v239, v233
 v_accvgpr_write_b32 a48, v236
 v_accvgpr_write_b32 a49, v237
 v_accvgpr_write_b32 a50, v238
 v_accvgpr_write_b32 a51, v239
 v_accvgpr_read_b32 v236, a52
 v_accvgpr_read_b32 v237, a53
 v_accvgpr_read_b32 v238, a54
 v_accvgpr_read_b32 v239, a55
 v_mul_f32 v236, v236, v233
 v_mul_f32 v237, v237, v233
 v_mul_f32 v238, v238, v233
 v_mul_f32 v239, v239, v233
 v_accvgpr_write_b32 a52, v236
 v_accvgpr_write_b32 a53, v237
 v_accvgpr_write_b32 a54, v238
 v_accvgpr_write_b32 a55, v239
 v_accvgpr_read_b32 v236, a56
 v_accvgpr_read_b32 v237, a57
 v_accvgpr_read_b32 v238, a58
 v_accvgpr_read_b32 v239, a59
 v_mul_f32 v236, v236, v233
 v_mul_f32 v237, v237, v233
 v_mul_f32 v238, v238, v233
 v_mul_f32 v239, v239, v233
 v_accvgpr_write_b32 a56, v236
 v_accvgpr_write_b32 a57, v237
 v_accvgpr_write_b32 a58, v238
 v_accvgpr_write_b32 a59, v239
 v_accvgpr_read_b32 v236, a60
 v_accvgpr_read_b32 v237, a61
 v_accvgpr_read_b32 v238, a62
 v_accvgpr_read_b32 v239, a63
 v_mul_f32 v236, v236, v233
 v_mul_f32 v237, v237, v233
 v_mul_f32 v238, v238, v233
 v_mul_f32 v239, v239, v233
 v_accvgpr_write_b32 a60, v236
 v_accvgpr_write_b32 a61, v237
 v_accvgpr_write_b32 a62, v238
 v_accvgpr_write_b32 a63, v239
 v_exp_f32 v208, v112
 v_exp_f32 v209, v113
 s_nop 0
 v_add_f32 v226, v208, v209
 v_cvt_pk_bf16_f32 v192, v208, v209
 v_exp_f32 v210, v114
 v_exp_f32 v211, v115
 v_add_f32 v226, v226, v210
 v_add_f32 v226, v226, v211
 v_cvt_pk_bf16_f32 v193, v210, v211
 v_exp_f32 v212, v116
 v_exp_f32 v213, v117
 v_add_f32 v226, v226, v212
 v_add_f32 v226, v226, v213
 v_cvt_pk_bf16_f32 v194, v212, v213
 v_exp_f32 v214, v118
 v_exp_f32 v215, v119
 v_add_f32 v226, v226, v214
 v_add_f32 v226, v226, v215
 v_cvt_pk_bf16_f32 v195, v214, v215
 v_exp_f32 v208, v120
 v_exp_f32 v209, v121
 v_add_f32 v226, v226, v208
 v_add_f32 v226, v226, v209
 v_cvt_pk_bf16_f32 v196, v208, v209
 v_exp_f32 v210, v122
 v_exp_f32 v211, v123
 v_add_f32 v226, v226, v210
 v_exp_f32 v212, v124
 v_add_f32 v226, v226, v211
 v_cvt_pk_bf16_f32 v197, v210, v211
 v_exp_f32 v213, v125
 v_add_f32 v226, v226, v212
 v_exp_f32 v214, v126
 v_add_f32 v226, v226, v213
 v_cvt_pk_bf16_f32 v198, v212, v213
 v_exp_f32 v215, v127
 v_add_f32 v226, v226, v214
 v_add_f32 v226, v226, v215
 v_cvt_pk_bf16_f32 v199, v214, v215
 s_nop 3
 s_branch K2_back5
K2_rare6:
 s_nop 15
 s_nop 15
 v_max3_f32 v232, v128, v129, v130
 v_max3_f32 v232, v232, v131, v132
 v_max3_f32 v232, v232, v133, v134
 v_max3_f32 v232, v232, v135, v136
 v_max3_f32 v232, v232, v137, v138
 v_max3_f32 v232, v232, v139, v140
 v_max3_f32 v232, v232, v141, v142
 v_max_f32 v232, v232, v143
 v_mov_b32 v233, v232
 s_nop 1
 v_permlane32_swap_b32 v232, v233
 v_max_f32 v232, v232, v233
 v_max_f32 v232, 0, v232
 v_sub_f32 v128, v128, v232
 v_sub_f32 v129, v129, v232
 v_sub_f32 v130, v130, v232
 v_sub_f32 v131, v131, v232
 v_sub_f32 v132, v132, v232
 v_sub_f32 v133, v133, v232
 v_sub_f32 v134, v134, v232
 v_sub_f32 v135, v135, v232
 v_sub_f32 v136, v136, v232
 v_sub_f32 v137, v137, v232
 v_sub_f32 v138, v138, v232
 v_sub_f32 v139, v139, v232
 v_sub_f32 v140, v140, v232
 v_sub_f32 v141, v141, v232
 v_sub_f32 v142, v142, v232
 v_sub_f32 v143, v143, v232
 v_sub_f32 v96, v96, v232
 v_sub_f32 v97, v97, v232
 v_sub_f32 v98, v98, v232
 v_sub_f32 v99, v99, v232
 v_sub_f32 v100, v100, v232
 v_sub_f32 v101, v101, v232
 v_sub_f32 v102, v102, v232
 v_sub_f32 v103, v103, v232
 v_sub_f32 v104, v104, v232
 v_sub_f32 v105, v105, v232
 v_sub_f32 v106, v106, v232
 v_sub_f32 v107, v107, v232
 v_sub_f32 v108, v108, v232
 v_sub_f32 v109, v109, v232
 v_sub_f32 v110, v110, v232
 v_sub_f32 v111, v111, v232
 v_sub_f32 v160, v160, v232
 v_sub_f32 v161, v161, v232
 v_sub_f32 v162, v162, v232
 v_sub_f32 v163, v163, v232
 v_sub_f32 v164, v164, v232
 v_sub_f32 v165, v165, v232
 v_sub_f32 v166, v166, v232
 v_sub_f32 v167, v167, v232
 v_sub_f32 v168, v168, v232
 v_sub_f32 v169, v169, v232
 v_sub_f32 v170, v170, v232
 v_sub_f32 v171, v171, v232
 v_sub_f32 v172, v172, v232
 v_sub_f32 v173, v173, v232
 v_sub_f32 v174, v174, v232
 v_sub_f32 v175, v175, v232
 v_sub_f32 v176, v176, v232
 v_sub_f32 v177, v177, v232
 v_sub_f32 v178, v178, v232
 v_sub_f32 v179, v179, v232
 v_sub_f32 v180, v180, v232
 v_sub_f32 v181, v181, v232
 v_sub_f32 v182, v182, v232
 v_sub_f32 v183, v183, v232
 v_sub_f32 v184, v184, v232
 v_sub_f32 v185, v185, v232
 v_sub_f32 v186, v186, v232
 v_sub_f32 v187, v187, v232
 v_sub_f32 v188, v188, v232
 v_sub_f32 v189, v189, v232
 v_sub_f32 v190, v190, v232
 v_sub_f32 v191, v191, v232
 v_exp_f32 v233, -v232
 s_nop 0
 v_mul_f32 v229, v229, v233
 v_accvgpr_read_b32 v236, a64
 v_accvgpr_read_b32 v237, a65
 v_accvgpr_read_b32 v238, a66
 v_accvgpr_read_b32 v239, a67
 v_mul_f32 v236, v236, v233
 v_mul_f32 v237, v237, v233
 v_mul_f32 v238, v238, v233
 v_mul_f32 v239, v239, v233
 v_accvgpr_write_b32 a64, v236
 v_accvgpr_write_b32 a65, v237
 v_accvgpr_write_b32 a66, v238
 v_accvgpr_write_b32 a67, v239
 v_accvgpr_read_b32 v236, a68
 v_accvgpr_read_b32 v237, a69
 v_accvgpr_read_b32 v238, a70
 v_accvgpr_read_b32 v239, a71
 v_mul_f32 v236, v236, v233
 v_mul_f32 v237, v237, v233
 v_mul_f32 v238, v238, v233
 v_mul_f32 v239, v239, v233
 v_accvgpr_write_b32 a68, v236
 v_accvgpr_write_b32 a69, v237
 v_accvgpr_write_b32 a70, v238
 v_accvgpr_write_b32 a71, v239
 v_accvgpr_read_b32 v236, a72
 v_accvgpr_read_b32 v237, a73
 v_accvgpr_read_b32 v238, a74
 v_accvgpr_read_b32 v239, a75
 v_mul_f32 v236, v236, v233
 v_mul_f32 v237, v237, v233
 v_mul_f32 v238, v238, v233
 v_mul_f32 v239, v239, v233
 v_accvgpr_write_b32 a72, v236
 v_accvgpr_write_b32 a73, v237
 v_accvgpr_write_b32 a74, v238
 v_accvgpr_write_b32 a75, v239
 v_accvgpr_read_b32 v236, a76
 v_accvgpr_read_b32 v237, a77
 v_accvgpr_read_b32 v238, a78
 v_accvgpr_read_b32 v239, a79
 v_mul_f32 v236, v236, v233
 v_mul_f32 v237, v237, v233
 v_mul_f32 v238, v238, v233
 v_mul_f32 v239, v239, v233
 v_accvgpr_write_b32 a76, v236
 v_accvgpr_write_b32 a77, v237
 v_accvgpr_write_b32 a78, v238
 v_accvgpr_write_b32 a79, v239
 v_accvgpr_read_b32 v236, a80
 v_accvgpr_read_b32 v237, a81
 v_accvgpr_read_b32 v238, a82
 v_accvgpr_read_b32 v239, a83
 v_mul_f32 v236, v236, v233
 v_mul_f32 v237, v237, v233
 v_mul_f32 v238, v238, v233
 v_mul_f32 v239, v239, v233
 v_accvgpr_write_b32 a80, v236
 v_accvgpr_write_b32 a81, v237
 v_accvgpr_write_b32 a82, v238
 v_accvgpr_write_b32 a83, v239
 v_accvgpr_read_b32 v236, a84
 v_accvgpr_read_b32 v237, a85
 v_accvgpr_read_b32 v238, a86
 v_accvgpr_read_b32 v239, a87
 v_mul_f32 v236, v236, v233
 v_mul_f32 v237, v237, v233
 v_mul_f32 v238, v238, v233
 v_mul_f32 v239, v239, v233
 v_accvgpr_write_b32 a84, v236
 v_accvgpr_write_b32 a85, v237
 v_accvgpr_write_b32 a86, v238
 v_accvgpr_write_b32 a87, v239
 v_accvgpr_read_b32 v236, a88
 v_accvgpr_read_b32 v237, a89
 v_accvgpr_read_b32 v238, a90
 v_accvgpr_read_b32 v239, a91
 v_mul_f32 v236, v236, v233
 v_mul_f32 v237, v237, v233
 v_mul_f32 v238, v238, v233
 v_mul_f32 v239, v239, v233
 v_accvgpr_write_b32 a88, v236
 v_accvgpr_write_b32 a89, v237
 v_accvgpr_write_b32 a90, v238
 v_accvgpr_write_b32 a91, v239
 v_accvgpr_read_b32 v236, a92
 v_accvgpr_read_b32 v237, a93
 v_accvgpr_read_b32 v238, a94
 v_accvgpr_read_b32 v239, a95
 v_mul_f32 v236, v236, v233
 v_mul_f32 v237, v237, v233
 v_mul_f32 v238, v238, v233
 v_mul_f32 v239, v239, v233
 v_accvgpr_write_b32 a92, v236
 v_accvgpr_write_b32 a93, v237
 v_accvgpr_write_b32 a94, v238
 v_accvgpr_write_b32 a95, v239
 v_accvgpr_read_b32 v236, a96
 v_accvgpr_read_b32 v237, a97
 v_accvgpr_read_b32 v238, a98
 v_accvgpr_read_b32 v239, a99
 v_mul_f32 v236, v236, v233
 v_mul_f32 v237, v237, v233
 v_mul_f32 v238, v238, v233
 v_mul_f32 v239, v239, v233
 v_accvgpr_write_b32 a96, v236
 v_accvgpr_write_b32 a97, v237
 v_accvgpr_write_b32 a98, v238
 v_accvgpr_write_b32 a99, v239
 v_accvgpr_read_b32 v236, a100
 v_accvgpr_read_b32 v237, a101
 v_accvgpr_read_b32 v238, a102
 v_accvgpr_read_b32 v239, a103
 v_mul_f32 v236, v236, v233
 v_mul_f32 v237, v237, v233
 v_mul_f32 v238, v238, v233
 v_mul_f32 v239, v239, v233
 v_accvgpr_write_b32 a100, v236
 v_accvgpr_write_b32 a101, v237
 v_accvgpr_write_b32 a102, v238
 v_accvgpr_write_b32 a103, v239
 v_accvgpr_read_b32 v236, a104
 v_accvgpr_read_b32 v237, a105
 v_accvgpr_read_b32 v238, a106
 v_accvgpr_read_b32 v239, a107
 v_mul_f32 v236, v236, v233
 v_mul_f32 v237, v237, v233
 v_mul_f32 v238, v238, v233
 v_mul_f32 v239, v239, v233
 v_accvgpr_write_b32 a104, v236
 v_accvgpr_write_b32 a105, v237
 v_accvgpr_write_b32 a106, v238
 v_accvgpr_write_b32 a107, v239
 v_accvgpr_read_b32 v236, a108
 v_accvgpr_read_b32 v237, a109
 v_accvgpr_read_b32 v238, a110
 v_accvgpr_read_b32 v239, a111
 v_mul_f32 v236, v236, v233
 v_mul_f32 v237, v237, v233
 v_mul_f32 v238, v238, v233
 v_mul_f32 v239, v239, v233
 v_accvgpr_write_b32 a108, v236
 v_accvgpr_write_b32 a109, v237
 v_accvgpr_write_b32 a110, v238
 v_accvgpr_write_b32 a111, v239
 v_accvgpr_read_b32 v236, a112
 v_accvgpr_read_b32 v237, a113
 v_accvgpr_read_b32 v238, a114
 v_accvgpr_read_b32 v239, a115
 v_mul_f32 v236, v236, v233
 v_mul_f32 v237, v237, v233
 v_mul_f32 v238, v238, v233
 v_mul_f32 v239, v239, v233
 v_accvgpr_write_b32 a112, v236
 v_accvgpr_write_b32 a113, v237
 v_accvgpr_write_b32 a114, v238
 v_accvgpr_write_b32 a115, v239
 v_accvgpr_read_b32 v236, a116
 v_accvgpr_read_b32 v237, a117
 v_accvgpr_read_b32 v238, a118
 v_accvgpr_read_b32 v239, a119
 v_mul_f32 v236, v236, v233
 v_mul_f32 v237, v237, v233
 v_mul_f32 v238, v238, v233
 v_mul_f32 v239, v239, v233
 v_accvgpr_write_b32 a116, v236
 v_accvgpr_write_b32 a117, v237
 v_accvgpr_write_b32 a118, v238
 v_accvgpr_write_b32 a119, v239
 v_accvgpr_read_b32 v236, a120
 v_accvgpr_read_b32 v237, a121
 v_accvgpr_read_b32 v238, a122
 v_accvgpr_read_b32 v239, a123
 v_mul_f32 v236, v236, v233
 v_mul_f32 v237, v237, v233
 v_mul_f32 v238, v238, v233
 v_mul_f32 v239, v239, v233
 v_accvgpr_write_b32 a120, v236
 v_accvgpr_write_b32 a121, v237
 v_accvgpr_write_b32 a122, v238
 v_accvgpr_write_b32 a123, v239
 v_accvgpr_read_b32 v236, a124
 v_accvgpr_read_b32 v237, a125
 v_accvgpr_read_b32 v238, a126
 v_accvgpr_read_b32 v239, a127
 v_mul_f32 v236, v236, v233
 v_mul_f32 v237, v237, v233
 v_mul_f32 v238, v238, v233
 v_mul_f32 v239, v239, v233
 v_accvgpr_write_b32 a124, v236
 v_accvgpr_write_b32 a125, v237
 v_accvgpr_write_b32 a126, v238
 v_accvgpr_write_b32 a127, v239
 v_exp_f32 v216, v128
 v_exp_f32 v217, v129
 s_nop 0
 v_add_f32 v227, v216, v217
 v_cvt_pk_bf16_f32 v200, v216, v217
 v_exp_f32 v218, v130
 v_exp_f32 v219, v131
 v_add_f32 v227, v227, v218
 v_add_f32 v227, v227, v219
 v_cvt_pk_bf16_f32 v201, v218, v219
 v_exp_f32 v220, v132
 v_exp_f32 v221, v133
 v_add_f32 v227, v227, v220
 v_add_f32 v227, v227, v221
 v_cvt_pk_bf16_f32 v202, v220, v221
 v_exp_f32 v222, v134
 v_exp_f32 v223, v135
 v_add_f32 v227, v227, v222
 v_add_f32 v227, v227, v223
 v_cvt_pk_bf16_f32 v203, v222, v223
 v_exp_f32 v216, v136
 v_exp_f32 v217, v137
 v_add_f32 v227, v227, v216
 v_add_f32 v227, v227, v217
 v_cvt_pk_bf16_f32 v204, v216, v217
 v_exp_f32 v218, v138
 v_exp_f32 v219, v139
 v_add_f32 v227, v227, v218
 v_add_f32 v227, v227, v219
 v_cvt_pk_bf16_f32 v205, v218, v219
 v_exp_f32 v220, v140
 v_exp_f32 v221, v141
 v_add_f32 v227, v227, v220
 v_add_f32 v227, v227, v221
 v_cvt_pk_bf16_f32 v206, v220, v221
 v_exp_f32 v222, v142
 v_exp_f32 v223, v143
 v_add_f32 v227, v227, v222
 v_add_f32 v227, v227, v223
 v_cvt_pk_bf16_f32 v207, v222, v223
 s_nop 3
 s_branch K2_back6
K2_rare7:
 s_nop 15
 s_nop 15
 v_max3_f32 v232, v80, v81, v82
 v_max3_f32 v232, v232, v83, v84
 v_max3_f32 v232, v232, v85, v86
 v_max3_f32 v232, v232, v87, v88
 v_max3_f32 v232, v232, v89, v90
 v_max3_f32 v232, v232, v91, v92
 v_max3_f32 v232, v232, v93, v94
 v_max_f32 v232, v232, v95
 v_mov_b32 v233, v232
 s_nop 1
 v_permlane32_swap_b32 v232, v233
 v_max_f32 v232, v232, v233
 v_max_f32 v232, 0, v232
 v_sub_f32 v80, v80, v232
 v_sub_f32 v81, v81, v232
 v_sub_f32 v82, v82, v232
 v_sub_f32 v83, v83, v232
 v_sub_f32 v84, v84, v232
 v_sub_f32 v85, v85, v232
 v_sub_f32 v86, v86, v232
 v_sub_f32 v87, v87, v232
 v_sub_f32 v88, v88, v232
 v_sub_f32 v89, v89, v232
 v_sub_f32 v90, v90, v232
 v_sub_f32 v91, v91, v232
 v_sub_f32 v92, v92, v232
 v_sub_f32 v93, v93, v232
 v_sub_f32 v94, v94, v232
 v_sub_f32 v95, v95, v232
 v_sub_f32 v112, v112, v232
 v_sub_f32 v113, v113, v232
 v_sub_f32 v114, v114, v232
 v_sub_f32 v115, v115, v232
 v_sub_f32 v116, v116, v232
 v_sub_f32 v117, v117, v232
 v_sub_f32 v118, v118, v232
 v_sub_f32 v119, v119, v232
 v_sub_f32 v120, v120, v232
 v_sub_f32 v121, v121, v232
 v_sub_f32 v122, v122, v232
 v_sub_f32 v123, v123, v232
 v_sub_f32 v124, v124, v232
 v_sub_f32 v125, v125, v232
 v_sub_f32 v126, v126, v232
 v_sub_f32 v127, v127, v232
 v_sub_f32 v144, v144, v232
 v_sub_f32 v145, v145, v232
 v_sub_f32 v146, v146, v232
 v_sub_f32 v147, v147, v232
 v_sub_f32 v148, v148, v232
 v_sub_f32 v149, v149, v232
 v_sub_f32 v150, v150, v232
 v_sub_f32 v151, v151, v232
 v_sub_f32 v152, v152, v232
 v_sub_f32 v153, v153, v232
 v_sub_f32 v154, v154, v232
 v_sub_f32 v155, v155, v232
 v_sub_f32 v156, v156, v232
 v_sub_f32 v157, v157, v232
 v_sub_f32 v158, v158, v232
 v_sub_f32 v159, v159, v232
 v_exp_f32 v233, -v232
 s_nop 0
 v_mul_f32 v228, v228, v233
 v_accvgpr_read_b32 v236, a0
 v_accvgpr_read_b32 v237, a1
 v_accvgpr_read_b32 v238, a2
 v_accvgpr_read_b32 v239, a3
 v_mul_f32 v236, v236, v233
 v_mul_f32 v237, v237, v233
 v_mul_f32 v238, v238, v233
 v_mul_f32 v239, v239, v233
 v_accvgpr_write_b32 a0, v236
 v_accvgpr_write_b32 a1, v237
 v_accvgpr_write_b32 a2, v238
 v_accvgpr_write_b32 a3, v239
 v_accvgpr_read_b32 v236, a4
 v_accvgpr_read_b32 v237, a5
 v_accvgpr_read_b32 v238, a6
 v_accvgpr_read_b32 v239, a7
 v_mul_f32 v236, v236, v233
 v_mul_f32 v237, v237, v233
 v_mul_f32 v238, v238, v233
 v_mul_f32 v239, v239, v233
 v_accvgpr_write_b32 a4, v236
 v_accvgpr_write_b32 a5, v237
 v_accvgpr_write_b32 a6, v238
 v_accvgpr_write_b32 a7, v239
 v_accvgpr_read_b32 v236, a8
 v_accvgpr_read_b32 v237, a9
 v_accvgpr_read_b32 v238, a10
 v_accvgpr_read_b32 v239, a11
 v_mul_f32 v236, v236, v233
 v_mul_f32 v237, v237, v233
 v_mul_f32 v238, v238, v233
 v_mul_f32 v239, v239, v233
 v_accvgpr_write_b32 a8, v236
 v_accvgpr_write_b32 a9, v237
 v_accvgpr_write_b32 a10, v238
 v_accvgpr_write_b32 a11, v239
 v_accvgpr_read_b32 v236, a12
 v_accvgpr_read_b32 v237, a13
 v_accvgpr_read_b32 v238, a14
 v_accvgpr_read_b32 v239, a15
 v_mul_f32 v236, v236, v233
 v_mul_f32 v237, v237, v233
 v_mul_f32 v238, v238, v233
 v_mul_f32 v239, v239, v233
 v_accvgpr_write_b32 a12, v236
 v_accvgpr_write_b32 a13, v237
 v_accvgpr_write_b32 a14, v238
 v_accvgpr_write_b32 a15, v239
 v_accvgpr_read_b32 v236, a16
 v_accvgpr_read_b32 v237, a17
 v_accvgpr_read_b32 v238, a18
 v_accvgpr_read_b32 v239, a19
 v_mul_f32 v236, v236, v233
 v_mul_f32 v237, v237, v233
 v_mul_f32 v238, v238, v233
 v_mul_f32 v239, v239, v233
 v_accvgpr_write_b32 a16, v236
 v_accvgpr_write_b32 a17, v237
 v_accvgpr_write_b32 a18, v238
 v_accvgpr_write_b32 a19, v239
 v_accvgpr_read_b32 v236, a20
 v_accvgpr_read_b32 v237, a21
 v_accvgpr_read_b32 v238, a22
 v_accvgpr_read_b32 v239, a23
 v_mul_f32 v236, v236, v233
 v_mul_f32 v237, v237, v233
 v_mul_f32 v238, v238, v233
 v_mul_f32 v239, v239, v233
 v_accvgpr_write_b32 a20, v236
 v_accvgpr_write_b32 a21, v237
 v_accvgpr_write_b32 a22, v238
 v_accvgpr_write_b32 a23, v239
 v_accvgpr_read_b32 v236, a24
 v_accvgpr_read_b32 v237, a25
 v_accvgpr_read_b32 v238, a26
 v_accvgpr_read_b32 v239, a27
 v_mul_f32 v236, v236, v233
 v_mul_f32 v237, v237, v233
 v_mul_f32 v238, v238, v233
 v_mul_f32 v239, v239, v233
 v_accvgpr_write_b32 a24, v236
 v_accvgpr_write_b32 a25, v237
 v_accvgpr_write_b32 a26, v238
 v_accvgpr_write_b32 a27, v239
 v_accvgpr_read_b32 v236, a28
 v_accvgpr_read_b32 v237, a29
 v_accvgpr_read_b32 v238, a30
 v_accvgpr_read_b32 v239, a31
 v_mul_f32 v236, v236, v233
 v_mul_f32 v237, v237, v233
 v_mul_f32 v238, v238, v233
 v_mul_f32 v239, v239, v233
 v_accvgpr_write_b32 a28, v236
 v_accvgpr_write_b32 a29, v237
 v_accvgpr_write_b32 a30, v238
 v_accvgpr_write_b32 a31, v239
 v_accvgpr_read_b32 v236, a32
 v_accvgpr_read_b32 v237, a33
 v_accvgpr_read_b32 v238, a34
 v_accvgpr_read_b32 v239, a35
 v_mul_f32 v236, v236, v233
 v_mul_f32 v237, v237, v233
 v_mul_f32 v238, v238, v233
 v_mul_f32 v239, v239, v233
 v_accvgpr_write_b32 a32, v236
 v_accvgpr_write_b32 a33, v237
 v_accvgpr_write_b32 a34, v238
 v_accvgpr_write_b32 a35, v239
 v_accvgpr_read_b32 v236, a36
 v_accvgpr_read_b32 v237, a37
 v_accvgpr_read_b32 v238, a38
 v_accvgpr_read_b32 v239, a39
 v_mul_f32 v236, v236, v233
 v_mul_f32 v237, v237, v233
 v_mul_f32 v238, v238, v233
 v_mul_f32 v239, v239, v233
 v_accvgpr_write_b32 a36, v236
 v_accvgpr_write_b32 a37, v237
 v_accvgpr_write_b32 a38, v238
 v_accvgpr_write_b32 a39, v239
 v_accvgpr_read_b32 v236, a40
 v_accvgpr_read_b32 v237, a41
 v_accvgpr_read_b32 v238, a42
 v_accvgpr_read_b32 v239, a43
 v_mul_f32 v236, v236, v233
 v_mul_f32 v237, v237, v233
 v_mul_f32 v238, v238, v233
 v_mul_f32 v239, v239, v233
 v_accvgpr_write_b32 a40, v236
 v_accvgpr_write_b32 a41, v237
 v_accvgpr_write_b32 a42, v238
 v_accvgpr_write_b32 a43, v239
 v_accvgpr_read_b32 v236, a44
 v_accvgpr_read_b32 v237, a45
 v_accvgpr_read_b32 v238, a46
 v_accvgpr_read_b32 v239, a47
 v_mul_f32 v236, v236, v233
 v_mul_f32 v237, v237, v233
 v_mul_f32 v238, v238, v233
 v_mul_f32 v239, v239, v233
 v_accvgpr_write_b32 a44, v236
 v_accvgpr_write_b32 a45, v237
 v_accvgpr_write_b32 a46, v238
 v_accvgpr_write_b32 a47, v239
 v_accvgpr_read_b32 v236, a48
 v_accvgpr_read_b32 v237, a49
 v_accvgpr_read_b32 v238, a50
 v_accvgpr_read_b32 v239, a51
 v_mul_f32 v236, v236, v233
 v_mul_f32 v237, v237, v233
 v_mul_f32 v238, v238, v233
 v_mul_f32 v239, v239, v233
 v_accvgpr_write_b32 a48, v236
 v_accvgpr_write_b32 a49, v237
 v_accvgpr_write_b32 a50, v238
 v_accvgpr_write_b32 a51, v239
 v_accvgpr_read_b32 v236, a52
 v_accvgpr_read_b32 v237, a53
 v_accvgpr_read_b32 v238, a54
 v_accvgpr_read_b32 v239, a55
 v_mul_f32 v236, v236, v233
 v_mul_f32 v237, v237, v233
 v_mul_f32 v238, v238, v233
 v_mul_f32 v239, v239, v233
 v_accvgpr_write_b32 a52, v236
 v_accvgpr_write_b32 a53, v237
 v_accvgpr_write_b32 a54, v238
 v_accvgpr_write_b32 a55, v239
 v_accvgpr_read_b32 v236, a56
 v_accvgpr_read_b32 v237, a57
 v_accvgpr_read_b32 v238, a58
 v_accvgpr_read_b32 v239, a59
 v_mul_f32 v236, v236, v233
 v_mul_f32 v237, v237, v233
 v_mul_f32 v238, v238, v233
 v_mul_f32 v239, v239, v233
 v_accvgpr_write_b32 a56, v236
 v_accvgpr_write_b32 a57, v237
 v_accvgpr_write_b32 a58, v238
 v_accvgpr_write_b32 a59, v239
 v_accvgpr_read_b32 v236, a60
 v_accvgpr_read_b32 v237, a61
 v_accvgpr_read_b32 v238, a62
 v_accvgpr_read_b32 v239, a63
 v_mul_f32 v236, v236, v233
 v_mul_f32 v237, v237, v233
 v_mul_f32 v238, v238, v233
 v_mul_f32 v239, v239, v233
 v_accvgpr_write_b32 a60, v236
 v_accvgpr_write_b32 a61, v237
 v_accvgpr_write_b32 a62, v238
 v_accvgpr_write_b32 a63, v239
 v_exp_f32 v208, v80
 v_exp_f32 v209, v81
 s_nop 0
 v_add_f32 v226, v208, v209
 v_cvt_pk_bf16_f32 v192, v208, v209
 v_exp_f32 v210, v82
 v_exp_f32 v211, v83
 v_add_f32 v226, v226, v210
 v_add_f32 v226, v226, v211
 v_cvt_pk_bf16_f32 v193, v210, v211
 v_exp_f32 v212, v84
 v_exp_f32 v213, v85
 v_add_f32 v226, v226, v212
 v_add_f32 v226, v226, v213
 v_cvt_pk_bf16_f32 v194, v212, v213
 v_exp_f32 v214, v86
 v_exp_f32 v215, v87
 v_add_f32 v226, v226, v214
 v_add_f32 v226, v226, v215
 v_cvt_pk_bf16_f32 v195, v214, v215
 v_exp_f32 v208, v88
 v_exp_f32 v209, v89
 v_add_f32 v226, v226, v208
 v_add_f32 v226, v226, v209
 v_cvt_pk_bf16_f32 v196, v208, v209
 v_exp_f32 v210, v90
 v_exp_f32 v211, v91
 v_add_f32 v226, v226, v210
 v_exp_f32 v212, v92
 v_add_f32 v226, v226, v211
 v_cvt_pk_bf16_f32 v197, v210, v211
 v_exp_f32 v213, v93
 v_add_f32 v226, v226, v212
 v_add_f32 v226, v226, v213
 v_cvt_pk_bf16_f32 v198, v212, v213
 v_exp_f32 v214, v94
 v_exp_f32 v215, v95
 v_add_f32 v226, v226, v214
 v_add_f32 v226, v226, v215
 v_cvt_pk_bf16_f32 v199, v214, v215
 s_nop 3
 s_branch K2_back7
K2_rare8:
 s_nop 15
 s_nop 15
 v_max3_f32 v232, v96, v97, v98
 v_max3_f32 v232, v232, v99, v100
 v_max3_f32 v232, v232, v101, v102
 v_max3_f32 v232, v232, v103, v104
 v_max3_f32 v232, v232, v105, v106
 v_max3_f32 v232, v232, v107, v108
 v_max3_f32 v232, v232, v109, v110
 v_max_f32 v232, v232, v111
 v_mov_b32 v233, v232
 s_nop 1
 v_permlane32_swap_b32 v232, v233
 v_max_f32 v232, v232, v233
 v_max_f32 v232, 0, v232
 v_sub_f32 v96, v96, v232
 v_sub_f32 v97, v97, v232
 v_sub_f32 v98, v98, v232
 v_sub_f32 v99, v99, v232
 v_sub_f32 v100, v100, v232
 v_sub_f32 v101, v101, v232
 v_sub_f32 v102, v102, v232
 v_sub_f32 v103, v103, v232
 v_sub_f32 v104, v104, v232
 v_sub_f32 v105, v105, v232
 v_sub_f32 v106, v106, v232
 v_sub_f32 v107, v107, v232
 v_sub_f32 v108, v108, v232
 v_sub_f32 v109, v109, v232
 v_sub_f32 v110, v110, v232
 v_sub_f32 v111, v111, v232
 v_sub_f32 v128, v128, v232
 v_sub_f32 v129, v129, v232
 v_sub_f32 v130, v130, v232
 v_sub_f32 v131, v131, v232
 v_sub_f32 v132, v132, v232
 v_sub_f32 v133, v133, v232
 v_sub_f32 v134, v134, v232
 v_sub_f32 v135, v135, v232
 v_sub_f32 v136, v136, v232
 v_sub_f32 v137, v137, v232
 v_sub_f32 v138, v138, v232
 v_sub_f32 v139, v139, v232
 v_sub_f32 v140, v140, v232
 v_sub_f32 v141, v141, v232
 v_sub_f32 v142, v142, v232
 v_sub_f32 v143, v143, v232
 v_sub_f32 v160, v160, v232
 v_sub_f32 v161, v161, v232
 v_sub_f32 v162, v162, v232
 v_sub_f32 v163, v163, v232
 v_sub_f32 v164, v164, v232
 v_sub_f32 v165, v165, v232
 v_sub_f32 v166, v166, v232
 v_sub_f32 v167, v167, v232
 v_sub_f32 v168, v168, v232
 v_sub_f32 v169, v169, v232
 v_sub_f32 v170, v170, v232
 v_sub_f32 v171, v171, v232
 v_sub_f32 v172, v172, v232
 v_sub_f32 v173, v173, v232
 v_sub_f32 v174, v174, v232
 v_sub_f32 v175, v175, v232
 v_sub_f32 v176, v176, v232
 v_sub_f32 v177, v177, v232
 v_sub_f32 v178, v178, v232
 v_sub_f32 v179, v179, v232
 v_sub_f32 v180, v180, v232
 v_sub_f32 v181, v181, v232
 v_sub_f32 v182, v182, v232
 v_sub_f32 v183, v183, v232
 v_sub_f32 v184, v184, v232
 v_sub_f32 v185, v185, v232
 v_sub_f32 v186, v186, v232
 v_sub_f32 v187, v187, v232
 v_sub_f32 v188, v188, v232
 v_sub_f32 v189, v189, v232
 v_sub_f32 v190, v190, v232
 v_sub_f32 v191, v191, v232
 v_exp_f32 v233, -v232
 s_nop 0
 v_mul_f32 v229, v229, v233
 v_accvgpr_read_b32 v236, a64
 v_accvgpr_read_b32 v237, a65
 v_accvgpr_read_b32 v238, a66
 v_accvgpr_read_b32 v239, a67
 v_mul_f32 v236, v236, v233
 v_mul_f32 v237, v237, v233
 v_mul_f32 v238, v238, v233
 v_mul_f32 v239, v239, v233
 v_accvgpr_write_b32 a64, v236
 v_accvgpr_write_b32 a65, v237
 v_accvgpr_write_b32 a66, v238
 v_accvgpr_write_b32 a67, v239
 v_accvgpr_read_b32 v236, a68
 v_accvgpr_read_b32 v237, a69
 v_accvgpr_read_b32 v238, a70
 v_accvgpr_read_b32 v239, a71
 v_mul_f32 v236, v236, v233
 v_mul_f32 v237, v237, v233
 v_mul_f32 v238, v238, v233
 v_mul_f32 v239, v239, v233
 v_accvgpr_write_b32 a68, v236
 v_accvgpr_write_b32 a69, v237
 v_accvgpr_write_b32 a70, v238
 v_accvgpr_write_b32 a71, v239
 v_accvgpr_read_b32 v236, a72
 v_accvgpr_read_b32 v237, a73
 v_accvgpr_read_b32 v238, a74
 v_accvgpr_read_b32 v239, a75
 v_mul_f32 v236, v236, v233
 v_mul_f32 v237, v237, v233
 v_mul_f32 v238, v238, v233
 v_mul_f32 v239, v239, v233
 v_accvgpr_write_b32 a72, v236
 v_accvgpr_write_b32 a73, v237
 v_accvgpr_write_b32 a74, v238
 v_accvgpr_write_b32 a75, v239
 v_accvgpr_read_b32 v236, a76
 v_accvgpr_read_b32 v237, a77
 v_accvgpr_read_b32 v238, a78
 v_accvgpr_read_b32 v239, a79
 v_mul_f32 v236, v236, v233
 v_mul_f32 v237, v237, v233
 v_mul_f32 v238, v238, v233
 v_mul_f32 v239, v239, v233
 v_accvgpr_write_b32 a76, v236
 v_accvgpr_write_b32 a77, v237
 v_accvgpr_write_b32 a78, v238
 v_accvgpr_write_b32 a79, v239
 v_accvgpr_read_b32 v236, a80
 v_accvgpr_read_b32 v237, a81
 v_accvgpr_read_b32 v238, a82
 v_accvgpr_read_b32 v239, a83
 v_mul_f32 v236, v236, v233
 v_mul_f32 v237, v237, v233
 v_mul_f32 v238, v238, v233
 v_mul_f32 v239, v239, v233
 v_accvgpr_write_b32 a80, v236
 v_accvgpr_write_b32 a81, v237
 v_accvgpr_write_b32 a82, v238
 v_accvgpr_write_b32 a83, v239
 v_accvgpr_read_b32 v236, a84
 v_accvgpr_read_b32 v237, a85
 v_accvgpr_read_b32 v238, a86
 v_accvgpr_read_b32 v239, a87
 v_mul_f32 v236, v236, v233
 v_mul_f32 v237, v237, v233
 v_mul_f32 v238, v238, v233
 v_mul_f32 v239, v239, v233
 v_accvgpr_write_b32 a84, v236
 v_accvgpr_write_b32 a85, v237
 v_accvgpr_write_b32 a86, v238
 v_accvgpr_write_b32 a87, v239
 v_accvgpr_read_b32 v236, a88
 v_accvgpr_read_b32 v237, a89
 v_accvgpr_read_b32 v238, a90
 v_accvgpr_read_b32 v239, a91
 v_mul_f32 v236, v236, v233
 v_mul_f32 v237, v237, v233
 v_mul_f32 v238, v238, v233
 v_mul_f32 v239, v239, v233
 v_accvgpr_write_b32 a88, v236
 v_accvgpr_write_b32 a89, v237
 v_accvgpr_write_b32 a90, v238
 v_accvgpr_write_b32 a91, v239
 v_accvgpr_read_b32 v236, a92
 v_accvgpr_read_b32 v237, a93
 v_accvgpr_read_b32 v238, a94
 v_accvgpr_read_b32 v239, a95
 v_mul_f32 v236, v236, v233
 v_mul_f32 v237, v237, v233
 v_mul_f32 v238, v238, v233
 v_mul_f32 v239, v239, v233
 v_accvgpr_write_b32 a92, v236
 v_accvgpr_write_b32 a93, v237
 v_accvgpr_write_b32 a94, v238
 v_accvgpr_write_b32 a95, v239
 v_accvgpr_read_b32 v236, a96
 v_accvgpr_read_b32 v237, a97
 v_accvgpr_read_b32 v238, a98
 v_accvgpr_read_b32 v239, a99
 v_mul_f32 v236, v236, v233
 v_mul_f32 v237, v237, v233
 v_mul_f32 v238, v238, v233
 v_mul_f32 v239, v239, v233
 v_accvgpr_write_b32 a96, v236
 v_accvgpr_write_b32 a97, v237
 v_accvgpr_write_b32 a98, v238
 v_accvgpr_write_b32 a99, v239
 v_accvgpr_read_b32 v236, a100
 v_accvgpr_read_b32 v237, a101
 v_accvgpr_read_b32 v238, a102
 v_accvgpr_read_b32 v239, a103
 v_mul_f32 v236, v236, v233
 v_mul_f32 v237, v237, v233
 v_mul_f32 v238, v238, v233
 v_mul_f32 v239, v239, v233
 v_accvgpr_write_b32 a100, v236
 v_accvgpr_write_b32 a101, v237
 v_accvgpr_write_b32 a102, v238
 v_accvgpr_write_b32 a103, v239
 v_accvgpr_read_b32 v236, a104
 v_accvgpr_read_b32 v237, a105
 v_accvgpr_read_b32 v238, a106
 v_accvgpr_read_b32 v239, a107
 v_mul_f32 v236, v236, v233
 v_mul_f32 v237, v237, v233
 v_mul_f32 v238, v238, v233
 v_mul_f32 v239, v239, v233
 v_accvgpr_write_b32 a104, v236
 v_accvgpr_write_b32 a105, v237
 v_accvgpr_write_b32 a106, v238
 v_accvgpr_write_b32 a107, v239
 v_accvgpr_read_b32 v236, a108
 v_accvgpr_read_b32 v237, a109
 v_accvgpr_read_b32 v238, a110
 v_accvgpr_read_b32 v239, a111
 v_mul_f32 v236, v236, v233
 v_mul_f32 v237, v237, v233
 v_mul_f32 v238, v238, v233
 v_mul_f32 v239, v239, v233
 v_accvgpr_write_b32 a108, v236
 v_accvgpr_write_b32 a109, v237
 v_accvgpr_write_b32 a110, v238
 v_accvgpr_write_b32 a111, v239
 v_accvgpr_read_b32 v236, a112
 v_accvgpr_read_b32 v237, a113
 v_accvgpr_read_b32 v238, a114
 v_accvgpr_read_b32 v239, a115
 v_mul_f32 v236, v236, v233
 v_mul_f32 v237, v237, v233
 v_mul_f32 v238, v238, v233
 v_mul_f32 v239, v239, v233
 v_accvgpr_write_b32 a112, v236
 v_accvgpr_write_b32 a113, v237
 v_accvgpr_write_b32 a114, v238
 v_accvgpr_write_b32 a115, v239
 v_accvgpr_read_b32 v236, a116
 v_accvgpr_read_b32 v237, a117
 v_accvgpr_read_b32 v238, a118
 v_accvgpr_read_b32 v239, a119
 v_mul_f32 v236, v236, v233
 v_mul_f32 v237, v237, v233
 v_mul_f32 v238, v238, v233
 v_mul_f32 v239, v239, v233
 v_accvgpr_write_b32 a116, v236
 v_accvgpr_write_b32 a117, v237
 v_accvgpr_write_b32 a118, v238
 v_accvgpr_write_b32 a119, v239
 v_accvgpr_read_b32 v236, a120
 v_accvgpr_read_b32 v237, a121
 v_accvgpr_read_b32 v238, a122
 v_accvgpr_read_b32 v239, a123
 v_mul_f32 v236, v236, v233
 v_mul_f32 v237, v237, v233
 v_mul_f32 v238, v238, v233
 v_mul_f32 v239, v239, v233
 v_accvgpr_write_b32 a120, v236
 v_accvgpr_write_b32 a121, v237
 v_accvgpr_write_b32 a122, v238
 v_accvgpr_write_b32 a123, v239
 v_accvgpr_read_b32 v236, a124
 v_accvgpr_read_b32 v237, a125
 v_accvgpr_read_b32 v238, a126
 v_accvgpr_read_b32 v239, a127
 v_mul_f32 v236, v236, v233
 v_mul_f32 v237, v237, v233
 v_mul_f32 v238, v238, v233
 v_mul_f32 v239, v239, v233
 v_accvgpr_write_b32 a124, v236
 v_accvgpr_write_b32 a125, v237
 v_accvgpr_write_b32 a126, v238
 v_accvgpr_write_b32 a127, v239
 v_exp_f32 v216, v96
 v_exp_f32 v217, v97
 s_nop 0
 v_add_f32 v227, v216, v217
 v_cvt_pk_bf16_f32 v200, v216, v217
 v_exp_f32 v218, v98
 v_exp_f32 v219, v99
 v_add_f32 v227, v227, v218
 v_add_f32 v227, v227, v219
 v_cvt_pk_bf16_f32 v201, v218, v219
 v_exp_f32 v220, v100
 v_exp_f32 v221, v101
 v_add_f32 v227, v227, v220
 v_add_f32 v227, v227, v221
 v_cvt_pk_bf16_f32 v202, v220, v221
 v_exp_f32 v222, v102
 v_exp_f32 v223, v103
 v_add_f32 v227, v227, v222
 v_add_f32 v227, v227, v223
 v_cvt_pk_bf16_f32 v203, v222, v223
 v_exp_f32 v216, v104
 v_exp_f32 v217, v105
 v_add_f32 v227, v227, v216
 v_add_f32 v227, v227, v217
 v_cvt_pk_bf16_f32 v204, v216, v217
 v_exp_f32 v218, v106
 v_exp_f32 v219, v107
 v_add_f32 v227, v227, v218
 v_add_f32 v227, v227, v219
 v_cvt_pk_bf16_f32 v205, v218, v219
 v_exp_f32 v220, v108
 v_exp_f32 v221, v109
 v_add_f32 v227, v227, v220
 v_add_f32 v227, v227, v221
 v_cvt_pk_bf16_f32 v206, v220, v221
 v_exp_f32 v222, v110
 v_exp_f32 v223, v111
 v_add_f32 v227, v227, v222
 v_add_f32 v227, v227, v223
 v_cvt_pk_bf16_f32 v207, v222, v223
 s_nop 3
 s_branch K2_back8
K2_rare9:
 s_nop 15
 s_nop 15
 v_max3_f32 v232, v112, v113, v114
 v_max3_f32 v232, v232, v115, v116
 v_max3_f32 v232, v232, v117, v118
 v_max3_f32 v232, v232, v119, v120
 v_max3_f32 v232, v232, v121, v122
 v_max3_f32 v232, v232, v123, v124
 v_max3_f32 v232, v232, v125, v126
 v_max_f32 v232, v232, v127
 v_mov_b32 v233, v232
 s_nop 1
 v_permlane32_swap_b32 v232, v233
 v_max_f32 v232, v232, v233
 v_max_f32 v232, 0, v232
 v_sub_f32 v112, v112, v232
 v_sub_f32 v113, v113, v232
 v_sub_f32 v114, v114, v232
 v_sub_f32 v115, v115, v232
 v_sub_f32 v116, v116, v232
 v_sub_f32 v117, v117, v232
 v_sub_f32 v118, v118, v232
 v_sub_f32 v119, v119, v232
 v_sub_f32 v120, v120, v232
 v_sub_f32 v121, v121, v232
 v_sub_f32 v122, v122, v232
 v_sub_f32 v123, v123, v232
 v_sub_f32 v124, v124, v232
 v_sub_f32 v125, v125, v232
 v_sub_f32 v126, v126, v232
 v_sub_f32 v127, v127, v232
 v_sub_f32 v80, v80, v232
 v_sub_f32 v81, v81, v232
 v_sub_f32 v82, v82, v232
 v_sub_f32 v83, v83, v232
 v_sub_f32 v84, v84, v232
 v_sub_f32 v85, v85, v232
 v_sub_f32 v86, v86, v232
 v_sub_f32 v87, v87, v232
 v_sub_f32 v88, v88, v232
 v_sub_f32 v89, v89, v232
 v_sub_f32 v90, v90, v232
 v_sub_f32 v91, v91, v232
 v_sub_f32 v92, v92, v232
 v_sub_f32 v93, v93, v232
 v_sub_f32 v94, v94, v232
 v_sub_f32 v95, v95, v232
 v_sub_f32 v144, v144, v232
 v_sub_f32 v145, v145, v232
 v_sub_f32 v146, v146, v232
 v_sub_f32 v147, v147, v232
 v_sub_f32 v148, v148, v232
 v_sub_f32 v149, v149, v232
 v_sub_f32 v150, v150, v232
 v_sub_f32 v151, v151, v232
 v_sub_f32 v152, v152, v232
 v_sub_f32 v153, v153, v232
 v_sub_f32 v154, v154, v232
 v_sub_f32 v155, v155, v232
 v_sub_f32 v156, v156, v232
 v_sub_f32 v157, v157, v232
 v_sub_f32 v158, v158, v232
 v_sub_f32 v159, v159, v232
 v_exp_f32 v233, -v232
 s_nop 0
 v_mul_f32 v228, v228, v233
 v_accvgpr_read_b32 v236, a0
 v_accvgpr_read_b32 v237, a1
 v_accvgpr_read_b32 v238, a2
 v_accvgpr_read_b32 v239, a3
 v_mul_f32 v236, v236, v233
 v_mul_f32 v237, v237, v233
 v_mul_f32 v238, v238, v233
 v_mul_f32 v239, v239, v233
 v_accvgpr_write_b32 a0, v236
 v_accvgpr_write_b32 a1, v237
 v_accvgpr_write_b32 a2, v238
 v_accvgpr_write_b32 a3, v239
 v_accvgpr_read_b32 v236, a4
 v_accvgpr_read_b32 v237, a5
 v_accvgpr_read_b32 v238, a6
 v_accvgpr_read_b32 v239, a7
 v_mul_f32 v236, v236, v233
 v_mul_f32 v237, v237, v233
 v_mul_f32 v238, v238, v233
 v_mul_f32 v239, v239, v233
 v_accvgpr_write_b32 a4, v236
 v_accvgpr_write_b32 a5, v237
 v_accvgpr_write_b32 a6, v238
 v_accvgpr_write_b32 a7, v239
 v_accvgpr_read_b32 v236, a8
 v_accvgpr_read_b32 v237, a9
 v_accvgpr_read_b32 v238, a10
 v_accvgpr_read_b32 v239, a11
 v_mul_f32 v236, v236, v233
 v_mul_f32 v237, v237, v233
 v_mul_f32 v238, v238, v233
 v_mul_f32 v239, v239, v233
 v_accvgpr_write_b32 a8, v236
 v_accvgpr_write_b32 a9, v237
 v_accvgpr_write_b32 a10, v238
 v_accvgpr_write_b32 a11, v239
 v_accvgpr_read_b32 v236, a12
 v_accvgpr_read_b32 v237, a13
 v_accvgpr_read_b32 v238, a14
 v_accvgpr_read_b32 v239, a15
 v_mul_f32 v236, v236, v233
 v_mul_f32 v237, v237, v233
 v_mul_f32 v238, v238, v233
 v_mul_f32 v239, v239, v233
 v_accvgpr_write_b32 a12, v236
 v_accvgpr_write_b32 a13, v237
 v_accvgpr_write_b32 a14, v238
 v_accvgpr_write_b32 a15, v239
 v_accvgpr_read_b32 v236, a16
 v_accvgpr_read_b32 v237, a17
 v_accvgpr_read_b32 v238, a18
 v_accvgpr_read_b32 v239, a19
 v_mul_f32 v236, v236, v233
 v_mul_f32 v237, v237, v233
 v_mul_f32 v238, v238, v233
 v_mul_f32 v239, v239, v233
 v_accvgpr_write_b32 a16, v236
 v_accvgpr_write_b32 a17, v237
 v_accvgpr_write_b32 a18, v238
 v_accvgpr_write_b32 a19, v239
 v_accvgpr_read_b32 v236, a20
 v_accvgpr_read_b32 v237, a21
 v_accvgpr_read_b32 v238, a22
 v_accvgpr_read_b32 v239, a23
 v_mul_f32 v236, v236, v233
 v_mul_f32 v237, v237, v233
 v_mul_f32 v238, v238, v233
 v_mul_f32 v239, v239, v233
 v_accvgpr_write_b32 a20, v236
 v_accvgpr_write_b32 a21, v237
 v_accvgpr_write_b32 a22, v238
 v_accvgpr_write_b32 a23, v239
 v_accvgpr_read_b32 v236, a24
 v_accvgpr_read_b32 v237, a25
 v_accvgpr_read_b32 v238, a26
 v_accvgpr_read_b32 v239, a27
 v_mul_f32 v236, v236, v233
 v_mul_f32 v237, v237, v233
 v_mul_f32 v238, v238, v233
 v_mul_f32 v239, v239, v233
 v_accvgpr_write_b32 a24, v236
 v_accvgpr_write_b32 a25, v237
 v_accvgpr_write_b32 a26, v238
 v_accvgpr_write_b32 a27, v239
 v_accvgpr_read_b32 v236, a28
 v_accvgpr_read_b32 v237, a29
 v_accvgpr_read_b32 v238, a30
 v_accvgpr_read_b32 v239, a31
 v_mul_f32 v236, v236, v233
 v_mul_f32 v237, v237, v233
 v_mul_f32 v238, v238, v233
 v_mul_f32 v239, v239, v233
 v_accvgpr_write_b32 a28, v236
 v_accvgpr_write_b32 a29, v237
 v_accvgpr_write_b32 a30, v238
 v_accvgpr_write_b32 a31, v239
 v_accvgpr_read_b32 v236, a32
 v_accvgpr_read_b32 v237, a33
 v_accvgpr_read_b32 v238, a34
 v_accvgpr_read_b32 v239, a35
 v_mul_f32 v236, v236, v233
 v_mul_f32 v237, v237, v233
 v_mul_f32 v238, v238, v233
 v_mul_f32 v239, v239, v233
 v_accvgpr_write_b32 a32, v236
 v_accvgpr_write_b32 a33, v237
 v_accvgpr_write_b32 a34, v238
 v_accvgpr_write_b32 a35, v239
 v_accvgpr_read_b32 v236, a36
 v_accvgpr_read_b32 v237, a37
 v_accvgpr_read_b32 v238, a38
 v_accvgpr_read_b32 v239, a39
 v_mul_f32 v236, v236, v233
 v_mul_f32 v237, v237, v233
 v_mul_f32 v238, v238, v233
 v_mul_f32 v239, v239, v233
 v_accvgpr_write_b32 a36, v236
 v_accvgpr_write_b32 a37, v237
 v_accvgpr_write_b32 a38, v238
 v_accvgpr_write_b32 a39, v239
 v_accvgpr_read_b32 v236, a40
 v_accvgpr_read_b32 v237, a41
 v_accvgpr_read_b32 v238, a42
 v_accvgpr_read_b32 v239, a43
 v_mul_f32 v236, v236, v233
 v_mul_f32 v237, v237, v233
 v_mul_f32 v238, v238, v233
 v_mul_f32 v239, v239, v233
 v_accvgpr_write_b32 a40, v236
 v_accvgpr_write_b32 a41, v237
 v_accvgpr_write_b32 a42, v238
 v_accvgpr_write_b32 a43, v239
 v_accvgpr_read_b32 v236, a44
 v_accvgpr_read_b32 v237, a45
 v_accvgpr_read_b32 v238, a46
 v_accvgpr_read_b32 v239, a47
 v_mul_f32 v236, v236, v233
 v_mul_f32 v237, v237, v233
 v_mul_f32 v238, v238, v233
 v_mul_f32 v239, v239, v233
 v_accvgpr_write_b32 a44, v236
 v_accvgpr_write_b32 a45, v237
 v_accvgpr_write_b32 a46, v238
 v_accvgpr_write_b32 a47, v239
 v_accvgpr_read_b32 v236, a48
 v_accvgpr_read_b32 v237, a49
 v_accvgpr_read_b32 v238, a50
 v_accvgpr_read_b32 v239, a51
 v_mul_f32 v236, v236, v233
 v_mul_f32 v237, v237, v233
 v_mul_f32 v238, v238, v233
 v_mul_f32 v239, v239, v233
 v_accvgpr_write_b32 a48, v236
 v_accvgpr_write_b32 a49, v237
 v_accvgpr_write_b32 a50, v238
 v_accvgpr_write_b32 a51, v239
 v_accvgpr_read_b32 v236, a52
 v_accvgpr_read_b32 v237, a53
 v_accvgpr_read_b32 v238, a54
 v_accvgpr_read_b32 v239, a55
 v_mul_f32 v236, v236, v233
 v_mul_f32 v237, v237, v233
 v_mul_f32 v238, v238, v233
 v_mul_f32 v239, v239, v233
 v_accvgpr_write_b32 a52, v236
 v_accvgpr_write_b32 a53, v237
 v_accvgpr_write_b32 a54, v238
 v_accvgpr_write_b32 a55, v239
 v_accvgpr_read_b32 v236, a56
 v_accvgpr_read_b32 v237, a57
 v_accvgpr_read_b32 v238, a58
 v_accvgpr_read_b32 v239, a59
 v_mul_f32 v236, v236, v233
 v_mul_f32 v237, v237, v233
 v_mul_f32 v238, v238, v233
 v_mul_f32 v239, v239, v233
 v_accvgpr_write_b32 a56, v236
 v_accvgpr_write_b32 a57, v237
 v_accvgpr_write_b32 a58, v238
 v_accvgpr_write_b32 a59, v239
 v_accvgpr_read_b32 v236, a60
 v_accvgpr_read_b32 v237, a61
 v_accvgpr_read_b32 v238, a62
 v_accvgpr_read_b32 v239, a63
 v_mul_f32 v236, v236, v233
 v_mul_f32 v237, v237, v233
 v_mul_f32 v238, v238, v233
 v_mul_f32 v239, v239, v233
 v_accvgpr_write_b32 a60, v236
 v_accvgpr_write_b32 a61, v237
 v_accvgpr_write_b32 a62, v238
 v_accvgpr_write_b32 a63, v239
 v_exp_f32 v208, v112
 v_exp_f32 v209, v113
 s_nop 0
 v_add_f32 v226, v208, v209
 v_cvt_pk_bf16_f32 v192, v208, v209
 v_exp_f32 v210, v114
 v_exp_f32 v211, v115
 v_add_f32 v226, v226, v210
 v_add_f32 v226, v226, v211
 v_cvt_pk_bf16_f32 v193, v210, v211
 v_exp_f32 v212, v116
 v_exp_f32 v213, v117
 v_add_f32 v226, v226, v212
 v_add_f32 v226, v226, v213
 v_cvt_pk_bf16_f32 v194, v212, v213
 v_exp_f32 v214, v118
 v_exp_f32 v215, v119
 v_add_f32 v226, v226, v214
 v_add_f32 v226, v226, v215
 v_cvt_pk_bf16_f32 v195, v214, v215
 v_exp_f32 v208, v120
 v_exp_f32 v209, v121
 v_add_f32 v226, v226, v208
 v_add_f32 v226, v226, v209
 v_cvt_pk_bf16_f32 v196, v208, v209
 v_exp_f32 v210, v122
 v_exp_f32 v211, v123
 v_add_f32 v226, v226, v210
 v_exp_f32 v212, v124
 v_add_f32 v226, v226, v211
 v_cvt_pk_bf16_f32 v197, v210, v211
 v_exp_f32 v213, v125
 v_add_f32 v226, v226, v212
 v_add_f32 v226, v226, v213
 v_cvt_pk_bf16_f32 v198, v212, v213
 v_exp_f32 v214, v126
 v_exp_f32 v215, v127
 v_add_f32 v226, v226, v214
 v_add_f32 v226, v226, v215
 v_cvt_pk_bf16_f32 v199, v214, v215
 s_nop 3
 s_branch K2_back9
K2_rare10:
 s_nop 15
 s_nop 15
 v_max3_f32 v232, v128, v129, v130
 v_max3_f32 v232, v232, v131, v132
 v_max3_f32 v232, v232, v133, v134
 v_max3_f32 v232, v232, v135, v136
 v_max3_f32 v232, v232, v137, v138
 v_max3_f32 v232, v232, v139, v140
 v_max3_f32 v232, v232, v141, v142
 v_max_f32 v232, v232, v143
 v_mov_b32 v233, v232
 s_nop 1
 v_permlane32_swap_b32 v232, v233
 v_max_f32 v232, v232, v233
 v_max_f32 v232, 0, v232
 v_sub_f32 v128, v128, v232
 v_sub_f32 v129, v129, v232
 v_sub_f32 v130, v130, v232
 v_sub_f32 v131, v131, v232
 v_sub_f32 v132, v132, v232
 v_sub_f32 v133, v133, v232
 v_sub_f32 v134, v134, v232
 v_sub_f32 v135, v135, v232
 v_sub_f32 v136, v136, v232
 v_sub_f32 v137, v137, v232
 v_sub_f32 v138, v138, v232
 v_sub_f32 v139, v139, v232
 v_sub_f32 v140, v140, v232
 v_sub_f32 v141, v141, v232
 v_sub_f32 v142, v142, v232
 v_sub_f32 v143, v143, v232
 v_sub_f32 v96, v96, v232
 v_sub_f32 v97, v97, v232
 v_sub_f32 v98, v98, v232
 v_sub_f32 v99, v99, v232
 v_sub_f32 v100, v100, v232
 v_sub_f32 v101, v101, v232
 v_sub_f32 v102, v102, v232
 v_sub_f32 v103, v103, v232
 v_sub_f32 v104, v104, v232
 v_sub_f32 v105, v105, v232
 v_sub_f32 v106, v106, v232
 v_sub_f32 v107, v107, v232
 v_sub_f32 v108, v108, v232
 v_sub_f32 v109, v109, v232
 v_sub_f32 v110, v110, v232
 v_sub_f32 v111, v111, v232
 v_sub_f32 v160, v160, v232
 v_sub_f32 v161, v161, v232
 v_sub_f32 v162, v162, v232
 v_sub_f32 v163, v163, v232
 v_sub_f32 v164, v164, v232
 v_sub_f32 v165, v165, v232
 v_sub_f32 v166, v166, v232
 v_sub_f32 v167, v167, v232
 v_sub_f32 v168, v168, v232
 v_sub_f32 v169, v169, v232
 v_sub_f32 v170, v170, v232
 v_sub_f32 v171, v171, v232
 v_sub_f32 v172, v172, v232
 v_sub_f32 v173, v173, v232
 v_sub_f32 v174, v174, v232
 v_sub_f32 v175, v175, v232
 v_sub_f32 v176, v176, v232
 v_sub_f32 v177, v177, v232
 v_sub_f32 v178, v178, v232
 v_sub_f32 v179, v179, v232
 v_sub_f32 v180, v180, v232
 v_sub_f32 v181, v181, v232
 v_sub_f32 v182, v182, v232
 v_sub_f32 v183, v183, v232
 v_sub_f32 v184, v184, v232
 v_sub_f32 v185, v185, v232
 v_sub_f32 v186, v186, v232
 v_sub_f32 v187, v187, v232
 v_sub_f32 v188, v188, v232
 v_sub_f32 v189, v189, v232
 v_sub_f32 v190, v190, v232
 v_sub_f32 v191, v191, v232
 v_exp_f32 v233, -v232
 s_nop 0
 v_mul_f32 v229, v229, v233
 v_accvgpr_read_b32 v236, a64
 v_accvgpr_read_b32 v237, a65
 v_accvgpr_read_b32 v238, a66
 v_accvgpr_read_b32 v239, a67
 v_mul_f32 v236, v236, v233
 v_mul_f32 v237, v237, v233
 v_mul_f32 v238, v238, v233
 v_mul_f32 v239, v239, v233
 v_accvgpr_write_b32 a64, v236
 v_accvgpr_write_b32 a65, v237
 v_accvgpr_write_b32 a66, v238
 v_accvgpr_write_b32 a67, v239
 v_accvgpr_read_b32 v236, a68
 v_accvgpr_read_b32 v237, a69
 v_accvgpr_read_b32 v238, a70
 v_accvgpr_read_b32 v239, a71
 v_mul_f32 v236, v236, v233
 v_mul_f32 v237, v237, v233
 v_mul_f32 v238, v238, v233
 v_mul_f32 v239, v239, v233
 v_accvgpr_write_b32 a68, v236
 v_accvgpr_write_b32 a69, v237
 v_accvgpr_write_b32 a70, v238
 v_accvgpr_write_b32 a71, v239
 v_accvgpr_read_b32 v236, a72
 v_accvgpr_read_b32 v237, a73
 v_accvgpr_read_b32 v238, a74
 v_accvgpr_read_b32 v239, a75
 v_mul_f32 v236, v236, v233
 v_mul_f32 v237, v237, v233
 v_mul_f32 v238, v238, v233
 v_mul_f32 v239, v239, v233
 v_accvgpr_write_b32 a72, v236
 v_accvgpr_write_b32 a73, v237
 v_accvgpr_write_b32 a74, v238
 v_accvgpr_write_b32 a75, v239
 v_accvgpr_read_b32 v236, a76
 v_accvgpr_read_b32 v237, a77
 v_accvgpr_read_b32 v238, a78
 v_accvgpr_read_b32 v239, a79
 v_mul_f32 v236, v236, v233
 v_mul_f32 v237, v237, v233
 v_mul_f32 v238, v238, v233
 v_mul_f32 v239, v239, v233
 v_accvgpr_write_b32 a76, v236
 v_accvgpr_write_b32 a77, v237
 v_accvgpr_write_b32 a78, v238
 v_accvgpr_write_b32 a79, v239
 v_accvgpr_read_b32 v236, a80
 v_accvgpr_read_b32 v237, a81
 v_accvgpr_read_b32 v238, a82
 v_accvgpr_read_b32 v239, a83
 v_mul_f32 v236, v236, v233
 v_mul_f32 v237, v237, v233
 v_mul_f32 v238, v238, v233
 v_mul_f32 v239, v239, v233
 v_accvgpr_write_b32 a80, v236
 v_accvgpr_write_b32 a81, v237
 v_accvgpr_write_b32 a82, v238
 v_accvgpr_write_b32 a83, v239
 v_accvgpr_read_b32 v236, a84
 v_accvgpr_read_b32 v237, a85
 v_accvgpr_read_b32 v238, a86
 v_accvgpr_read_b32 v239, a87
 v_mul_f32 v236, v236, v233
 v_mul_f32 v237, v237, v233
 v_mul_f32 v238, v238, v233
 v_mul_f32 v239, v239, v233
 v_accvgpr_write_b32 a84, v236
 v_accvgpr_write_b32 a85, v237
 v_accvgpr_write_b32 a86, v238
 v_accvgpr_write_b32 a87, v239
 v_accvgpr_read_b32 v236, a88
 v_accvgpr_read_b32 v237, a89
 v_accvgpr_read_b32 v238, a90
 v_accvgpr_read_b32 v239, a91
 v_mul_f32 v236, v236, v233
 v_mul_f32 v237, v237, v233
 v_mul_f32 v238, v238, v233
 v_mul_f32 v239, v239, v233
 v_accvgpr_write_b32 a88, v236
 v_accvgpr_write_b32 a89, v237
 v_accvgpr_write_b32 a90, v238
 v_accvgpr_write_b32 a91, v239
 v_accvgpr_read_b32 v236, a92
 v_accvgpr_read_b32 v237, a93
 v_accvgpr_read_b32 v238, a94
 v_accvgpr_read_b32 v239, a95
 v_mul_f32 v236, v236, v233
 v_mul_f32 v237, v237, v233
 v_mul_f32 v238, v238, v233
 v_mul_f32 v239, v239, v233
 v_accvgpr_write_b32 a92, v236
 v_accvgpr_write_b32 a93, v237
 v_accvgpr_write_b32 a94, v238
 v_accvgpr_write_b32 a95, v239
 v_accvgpr_read_b32 v236, a96
 v_accvgpr_read_b32 v237, a97
 v_accvgpr_read_b32 v238, a98
 v_accvgpr_read_b32 v239, a99
 v_mul_f32 v236, v236, v233
 v_mul_f32 v237, v237, v233
 v_mul_f32 v238, v238, v233
 v_mul_f32 v239, v239, v233
 v_accvgpr_write_b32 a96, v236
 v_accvgpr_write_b32 a97, v237
 v_accvgpr_write_b32 a98, v238
 v_accvgpr_write_b32 a99, v239
 v_accvgpr_read_b32 v236, a100
 v_accvgpr_read_b32 v237, a101
 v_accvgpr_read_b32 v238, a102
 v_accvgpr_read_b32 v239, a103
 v_mul_f32 v236, v236, v233
 v_mul_f32 v237, v237, v233
 v_mul_f32 v238, v238, v233
 v_mul_f32 v239, v239, v233
 v_accvgpr_write_b32 a100, v236
 v_accvgpr_write_b32 a101, v237
 v_accvgpr_write_b32 a102, v238
 v_accvgpr_write_b32 a103, v239
 v_accvgpr_read_b32 v236, a104
 v_accvgpr_read_b32 v237, a105
 v_accvgpr_read_b32 v238, a106
 v_accvgpr_read_b32 v239, a107
 v_mul_f32 v236, v236, v233
 v_mul_f32 v237, v237, v233
 v_mul_f32 v238, v238, v233
 v_mul_f32 v239, v239, v233
 v_accvgpr_write_b32 a104, v236
 v_accvgpr_write_b32 a105, v237
 v_accvgpr_write_b32 a106, v238
 v_accvgpr_write_b32 a107, v239
 v_accvgpr_read_b32 v236, a108
 v_accvgpr_read_b32 v237, a109
 v_accvgpr_read_b32 v238, a110
 v_accvgpr_read_b32 v239, a111
 v_mul_f32 v236, v236, v233
 v_mul_f32 v237, v237, v233
 v_mul_f32 v238, v238, v233
 v_mul_f32 v239, v239, v233
 v_accvgpr_write_b32 a108, v236
 v_accvgpr_write_b32 a109, v237
 v_accvgpr_write_b32 a110, v238
 v_accvgpr_write_b32 a111, v239
 v_accvgpr_read_b32 v236, a112
 v_accvgpr_read_b32 v237, a113
 v_accvgpr_read_b32 v238, a114
 v_accvgpr_read_b32 v239, a115
 v_mul_f32 v236, v236, v233
 v_mul_f32 v237, v237, v233
 v_mul_f32 v238, v238, v233
 v_mul_f32 v239, v239, v233
 v_accvgpr_write_b32 a112, v236
 v_accvgpr_write_b32 a113, v237
 v_accvgpr_write_b32 a114, v238
 v_accvgpr_write_b32 a115, v239
 v_accvgpr_read_b32 v236, a116
 v_accvgpr_read_b32 v237, a117
 v_accvgpr_read_b32 v238, a118
 v_accvgpr_read_b32 v239, a119
 v_mul_f32 v236, v236, v233
 v_mul_f32 v237, v237, v233
 v_mul_f32 v238, v238, v233
 v_mul_f32 v239, v239, v233
 v_accvgpr_write_b32 a116, v236
 v_accvgpr_write_b32 a117, v237
 v_accvgpr_write_b32 a118, v238
 v_accvgpr_write_b32 a119, v239
 v_accvgpr_read_b32 v236, a120
 v_accvgpr_read_b32 v237, a121
 v_accvgpr_read_b32 v238, a122
 v_accvgpr_read_b32 v239, a123
 v_mul_f32 v236, v236, v233
 v_mul_f32 v237, v237, v233
 v_mul_f32 v238, v238, v233
 v_mul_f32 v239, v239, v233
 v_accvgpr_write_b32 a120, v236
 v_accvgpr_write_b32 a121, v237
 v_accvgpr_write_b32 a122, v238
 v_accvgpr_write_b32 a123, v239
 v_accvgpr_read_b32 v236, a124
 v_accvgpr_read_b32 v237, a125
 v_accvgpr_read_b32 v238, a126
 v_accvgpr_read_b32 v239, a127
 v_mul_f32 v236, v236, v233
 v_mul_f32 v237, v237, v233
 v_mul_f32 v238, v238, v233
 v_mul_f32 v239, v239, v233
 v_accvgpr_write_b32 a124, v236
 v_accvgpr_write_b32 a125, v237
 v_accvgpr_write_b32 a126, v238
 v_accvgpr_write_b32 a127, v239
 v_exp_f32 v216, v128
 v_exp_f32 v217, v129
 s_nop 0
 v_add_f32 v227, v216, v217
 v_cvt_pk_bf16_f32 v200, v216, v217
 v_exp_f32 v218, v130
 v_exp_f32 v219, v131
 v_add_f32 v227, v227, v218
 v_add_f32 v227, v227, v219
 v_cvt_pk_bf16_f32 v201, v218, v219
 v_exp_f32 v220, v132
 v_exp_f32 v221, v133
 v_add_f32 v227, v227, v220
 v_add_f32 v227, v227, v221
 v_cvt_pk_bf16_f32 v202, v220, v221
 v_exp_f32 v222, v134
 v_exp_f32 v223, v135
 v_add_f32 v227, v227, v222
 v_add_f32 v227, v227, v223
 v_cvt_pk_bf16_f32 v203, v222, v223
 v_exp_f32 v216, v136
 v_exp_f32 v217, v137
 v_add_f32 v227, v227, v216
 v_add_f32 v227, v227, v217
 v_cvt_pk_bf16_f32 v204, v216, v217
 v_exp_f32 v218, v138
 v_exp_f32 v219, v139
 v_add_f32 v227, v227, v218
 v_add_f32 v227, v227, v219
 v_cvt_pk_bf16_f32 v205, v218, v219
 v_exp_f32 v220, v140
 v_exp_f32 v221, v141
 v_add_f32 v227, v227, v220
 v_add_f32 v227, v227, v221
 v_cvt_pk_bf16_f32 v206, v220, v221
 v_exp_f32 v222, v142
 v_exp_f32 v223, v143
 v_add_f32 v227, v227, v222
 v_add_f32 v227, v227, v223
 v_cvt_pk_bf16_f32 v207, v222, v223
 s_nop 3
 s_branch K2_back10
K2_rare11:
 s_nop 15
 s_nop 15
 v_max3_f32 v232, v80, v81, v82
 v_max3_f32 v232, v232, v83, v84
 v_max3_f32 v232, v232, v85, v86
 v_max3_f32 v232, v232, v87, v88
 v_max3_f32 v232, v232, v89, v90
 v_max3_f32 v232, v232, v91, v92
 v_max3_f32 v232, v232, v93, v94
 v_max_f32 v232, v232, v95
 v_mov_b32 v233, v232
 s_nop 1
 v_permlane32_swap_b32 v232, v233
 v_max_f32 v232, v232, v233
 v_max_f32 v232, 0, v232
 v_sub_f32 v80, v80, v232
 v_sub_f32 v81, v81, v232
 v_sub_f32 v82, v82, v232
 v_sub_f32 v83, v83, v232
 v_sub_f32 v84, v84, v232
 v_sub_f32 v85, v85, v232
 v_sub_f32 v86, v86, v232
 v_sub_f32 v87, v87, v232
 v_sub_f32 v88, v88, v232
 v_sub_f32 v89, v89, v232
 v_sub_f32 v90, v90, v232
 v_sub_f32 v91, v91, v232
 v_sub_f32 v92, v92, v232
 v_sub_f32 v93, v93, v232
 v_sub_f32 v94, v94, v232
 v_sub_f32 v95, v95, v232
 v_sub_f32 v112, v112, v232
 v_sub_f32 v113, v113, v232
 v_sub_f32 v114, v114, v232
 v_sub_f32 v115, v115, v232
 v_sub_f32 v116, v116, v232
 v_sub_f32 v117, v117, v232
 v_sub_f32 v118, v118, v232
 v_sub_f32 v119, v119, v232
 v_sub_f32 v120, v120, v232
 v_sub_f32 v121, v121, v232
 v_sub_f32 v122, v122, v232
 v_sub_f32 v123, v123, v232
 v_sub_f32 v124, v124, v232
 v_sub_f32 v125, v125, v232
 v_sub_f32 v126, v126, v232
 v_sub_f32 v127, v127, v232
 v_sub_f32 v144, v144, v232
 v_sub_f32 v145, v145, v232
 v_sub_f32 v146, v146, v232
 v_sub_f32 v147, v147, v232
 v_sub_f32 v148, v148, v232
 v_sub_f32 v149, v149, v232
 v_sub_f32 v150, v150, v232
 v_sub_f32 v151, v151, v232
 v_sub_f32 v152, v152, v232
 v_sub_f32 v153, v153, v232
 v_sub_f32 v154, v154, v232
 v_sub_f32 v155, v155, v232
 v_sub_f32 v156, v156, v232
 v_sub_f32 v157, v157, v232
 v_sub_f32 v158, v158, v232
 v_sub_f32 v159, v159, v232
 v_exp_f32 v233, -v232
 s_nop 0
 v_mul_f32 v228, v228, v233
 v_accvgpr_read_b32 v236, a0
 v_accvgpr_read_b32 v237, a1
 v_accvgpr_read_b32 v238, a2
 v_accvgpr_read_b32 v239, a3
 v_mul_f32 v236, v236, v233
 v_mul_f32 v237, v237, v233
 v_mul_f32 v238, v238, v233
 v_mul_f32 v239, v239, v233
 v_accvgpr_write_b32 a0, v236
 v_accvgpr_write_b32 a1, v237
 v_accvgpr_write_b32 a2, v238
 v_accvgpr_write_b32 a3, v239
 v_accvgpr_read_b32 v236, a4
 v_accvgpr_read_b32 v237, a5
 v_accvgpr_read_b32 v238, a6
 v_accvgpr_read_b32 v239, a7
 v_mul_f32 v236, v236, v233
 v_mul_f32 v237, v237, v233
 v_mul_f32 v238, v238, v233
 v_mul_f32 v239, v239, v233
 v_accvgpr_write_b32 a4, v236
 v_accvgpr_write_b32 a5, v237
 v_accvgpr_write_b32 a6, v238
 v_accvgpr_write_b32 a7, v239
 v_accvgpr_read_b32 v236, a8
 v_accvgpr_read_b32 v237, a9
 v_accvgpr_read_b32 v238, a10
 v_accvgpr_read_b32 v239, a11
 v_mul_f32 v236, v236, v233
 v_mul_f32 v237, v237, v233
 v_mul_f32 v238, v238, v233
 v_mul_f32 v239, v239, v233
 v_accvgpr_write_b32 a8, v236
 v_accvgpr_write_b32 a9, v237
 v_accvgpr_write_b32 a10, v238
 v_accvgpr_write_b32 a11, v239
 v_accvgpr_read_b32 v236, a12
 v_accvgpr_read_b32 v237, a13
 v_accvgpr_read_b32 v238, a14
 v_accvgpr_read_b32 v239, a15
 v_mul_f32 v236, v236, v233
 v_mul_f32 v237, v237, v233
 v_mul_f32 v238, v238, v233
 v_mul_f32 v239, v239, v233
 v_accvgpr_write_b32 a12, v236
 v_accvgpr_write_b32 a13, v237
 v_accvgpr_write_b32 a14, v238
 v_accvgpr_write_b32 a15, v239
 v_accvgpr_read_b32 v236, a16
 v_accvgpr_read_b32 v237, a17
 v_accvgpr_read_b32 v238, a18
 v_accvgpr_read_b32 v239, a19
 v_mul_f32 v236, v236, v233
 v_mul_f32 v237, v237, v233
 v_mul_f32 v238, v238, v233
 v_mul_f32 v239, v239, v233
 v_accvgpr_write_b32 a16, v236
 v_accvgpr_write_b32 a17, v237
 v_accvgpr_write_b32 a18, v238
 v_accvgpr_write_b32 a19, v239
 v_accvgpr_read_b32 v236, a20
 v_accvgpr_read_b32 v237, a21
 v_accvgpr_read_b32 v238, a22
 v_accvgpr_read_b32 v239, a23
 v_mul_f32 v236, v236, v233
 v_mul_f32 v237, v237, v233
 v_mul_f32 v238, v238, v233
 v_mul_f32 v239, v239, v233
 v_accvgpr_write_b32 a20, v236
 v_accvgpr_write_b32 a21, v237
 v_accvgpr_write_b32 a22, v238
 v_accvgpr_write_b32 a23, v239
 v_accvgpr_read_b32 v236, a24
 v_accvgpr_read_b32 v237, a25
 v_accvgpr_read_b32 v238, a26
 v_accvgpr_read_b32 v239, a27
 v_mul_f32 v236, v236, v233
 v_mul_f32 v237, v237, v233
 v_mul_f32 v238, v238, v233
 v_mul_f32 v239, v239, v233
 v_accvgpr_write_b32 a24, v236
 v_accvgpr_write_b32 a25, v237
 v_accvgpr_write_b32 a26, v238
 v_accvgpr_write_b32 a27, v239
 v_accvgpr_read_b32 v236, a28
 v_accvgpr_read_b32 v237, a29
 v_accvgpr_read_b32 v238, a30
 v_accvgpr_read_b32 v239, a31
 v_mul_f32 v236, v236, v233
 v_mul_f32 v237, v237, v233
 v_mul_f32 v238, v238, v233
 v_mul_f32 v239, v239, v233
 v_accvgpr_write_b32 a28, v236
 v_accvgpr_write_b32 a29, v237
 v_accvgpr_write_b32 a30, v238
 v_accvgpr_write_b32 a31, v239
 v_accvgpr_read_b32 v236, a32
 v_accvgpr_read_b32 v237, a33
 v_accvgpr_read_b32 v238, a34
 v_accvgpr_read_b32 v239, a35
 v_mul_f32 v236, v236, v233
 v_mul_f32 v237, v237, v233
 v_mul_f32 v238, v238, v233
 v_mul_f32 v239, v239, v233
 v_accvgpr_write_b32 a32, v236
 v_accvgpr_write_b32 a33, v237
 v_accvgpr_write_b32 a34, v238
 v_accvgpr_write_b32 a35, v239
 v_accvgpr_read_b32 v236, a36
 v_accvgpr_read_b32 v237, a37
 v_accvgpr_read_b32 v238, a38
 v_accvgpr_read_b32 v239, a39
 v_mul_f32 v236, v236, v233
 v_mul_f32 v237, v237, v233
 v_mul_f32 v238, v238, v233
 v_mul_f32 v239, v239, v233
 v_accvgpr_write_b32 a36, v236
 v_accvgpr_write_b32 a37, v237
 v_accvgpr_write_b32 a38, v238
 v_accvgpr_write_b32 a39, v239
 v_accvgpr_read_b32 v236, a40
 v_accvgpr_read_b32 v237, a41
 v_accvgpr_read_b32 v238, a42
 v_accvgpr_read_b32 v239, a43
 v_mul_f32 v236, v236, v233
 v_mul_f32 v237, v237, v233
 v_mul_f32 v238, v238, v233
 v_mul_f32 v239, v239, v233
 v_accvgpr_write_b32 a40, v236
 v_accvgpr_write_b32 a41, v237
 v_accvgpr_write_b32 a42, v238
 v_accvgpr_write_b32 a43, v239
 v_accvgpr_read_b32 v236, a44
 v_accvgpr_read_b32 v237, a45
 v_accvgpr_read_b32 v238, a46
 v_accvgpr_read_b32 v239, a47
 v_mul_f32 v236, v236, v233
 v_mul_f32 v237, v237, v233
 v_mul_f32 v238, v238, v233
 v_mul_f32 v239, v239, v233
 v_accvgpr_write_b32 a44, v236
 v_accvgpr_write_b32 a45, v237
 v_accvgpr_write_b32 a46, v238
 v_accvgpr_write_b32 a47, v239
 v_accvgpr_read_b32 v236, a48
 v_accvgpr_read_b32 v237, a49
 v_accvgpr_read_b32 v238, a50
 v_accvgpr_read_b32 v239, a51
 v_mul_f32 v236, v236, v233
 v_mul_f32 v237, v237, v233
 v_mul_f32 v238, v238, v233
 v_mul_f32 v239, v239, v233
 v_accvgpr_write_b32 a48, v236
 v_accvgpr_write_b32 a49, v237
 v_accvgpr_write_b32 a50, v238
 v_accvgpr_write_b32 a51, v239
 v_accvgpr_read_b32 v236, a52
 v_accvgpr_read_b32 v237, a53
 v_accvgpr_read_b32 v238, a54
 v_accvgpr_read_b32 v239, a55
 v_mul_f32 v236, v236, v233
 v_mul_f32 v237, v237, v233
 v_mul_f32 v238, v238, v233
 v_mul_f32 v239, v239, v233
 v_accvgpr_write_b32 a52, v236
 v_accvgpr_write_b32 a53, v237
 v_accvgpr_write_b32 a54, v238
 v_accvgpr_write_b32 a55, v239
 v_accvgpr_read_b32 v236, a56
 v_accvgpr_read_b32 v237, a57
 v_accvgpr_read_b32 v238, a58
 v_accvgpr_read_b32 v239, a59
 v_mul_f32 v236, v236, v233
 v_mul_f32 v237, v237, v233
 v_mul_f32 v238, v238, v233
 v_mul_f32 v239, v239, v233
 v_accvgpr_write_b32 a56, v236
 v_accvgpr_write_b32 a57, v237
 v_accvgpr_write_b32 a58, v238
 v_accvgpr_write_b32 a59, v239
 v_accvgpr_read_b32 v236, a60
 v_accvgpr_read_b32 v237, a61
 v_accvgpr_read_b32 v238, a62
 v_accvgpr_read_b32 v239, a63
 v_mul_f32 v236, v236, v233
 v_mul_f32 v237, v237, v233
 v_mul_f32 v238, v238, v233
 v_mul_f32 v239, v239, v233
 v_accvgpr_write_b32 a60, v236
 v_accvgpr_write_b32 a61, v237
 v_accvgpr_write_b32 a62, v238
 v_accvgpr_write_b32 a63, v239
 v_exp_f32 v208, v80
 v_exp_f32 v209, v81
 s_nop 0
 v_add_f32 v226, v208, v209
 v_cvt_pk_bf16_f32 v192, v208, v209
 v_exp_f32 v210, v82
 v_exp_f32 v211, v83
 v_add_f32 v226, v226, v210
 v_add_f32 v226, v226, v211
 v_cvt_pk_bf16_f32 v193, v210, v211
 v_exp_f32 v212, v84
 v_exp_f32 v213, v85
 v_add_f32 v226, v226, v212
 v_add_f32 v226, v226, v213
 v_cvt_pk_bf16_f32 v194, v212, v213
 v_exp_f32 v214, v86
 v_exp_f32 v215, v87
 v_add_f32 v226, v226, v214
 v_add_f32 v226, v226, v215
 v_cvt_pk_bf16_f32 v195, v214, v215
 v_exp_f32 v208, v88
 v_exp_f32 v209, v89
 v_add_f32 v226, v226, v208
 v_add_f32 v226, v226, v209
 v_cvt_pk_bf16_f32 v196, v208, v209
 v_exp_f32 v210, v90
 v_exp_f32 v211, v91
 v_add_f32 v226, v226, v210
 v_exp_f32 v212, v92
 v_add_f32 v226, v226, v211
 v_cvt_pk_bf16_f32 v197, v210, v211
 v_exp_f32 v213, v93
 v_add_f32 v226, v226, v212
 v_add_f32 v226, v226, v213
 v_cvt_pk_bf16_f32 v198, v212, v213
 v_exp_f32 v214, v94
 v_exp_f32 v215, v95
 v_add_f32 v226, v226, v214
 v_add_f32 v226, v226, v215
 v_cvt_pk_bf16_f32 v199, v214, v215
 s_nop 3
 s_branch K2_back11
K2_rare12:
 s_nop 15
 s_nop 15
 v_max3_f32 v232, v96, v97, v98
 v_max3_f32 v232, v232, v99, v100
 v_max3_f32 v232, v232, v101, v102
 v_max3_f32 v232, v232, v103, v104
 v_max3_f32 v232, v232, v105, v106
 v_max3_f32 v232, v232, v107, v108
 v_max3_f32 v232, v232, v109, v110
 v_max_f32 v232, v232, v111
 v_mov_b32 v233, v232
 s_nop 1
 v_permlane32_swap_b32 v232, v233
 v_max_f32 v232, v232, v233
 v_max_f32 v232, 0, v232
 v_sub_f32 v96, v96, v232
 v_sub_f32 v97, v97, v232
 v_sub_f32 v98, v98, v232
 v_sub_f32 v99, v99, v232
 v_sub_f32 v100, v100, v232
 v_sub_f32 v101, v101, v232
 v_sub_f32 v102, v102, v232
 v_sub_f32 v103, v103, v232
 v_sub_f32 v104, v104, v232
 v_sub_f32 v105, v105, v232
 v_sub_f32 v106, v106, v232
 v_sub_f32 v107, v107, v232
 v_sub_f32 v108, v108, v232
 v_sub_f32 v109, v109, v232
 v_sub_f32 v110, v110, v232
 v_sub_f32 v111, v111, v232
 v_sub_f32 v128, v128, v232
 v_sub_f32 v129, v129, v232
 v_sub_f32 v130, v130, v232
 v_sub_f32 v131, v131, v232
 v_sub_f32 v132, v132, v232
 v_sub_f32 v133, v133, v232
 v_sub_f32 v134, v134, v232
 v_sub_f32 v135, v135, v232
 v_sub_f32 v136, v136, v232
 v_sub_f32 v137, v137, v232
 v_sub_f32 v138, v138, v232
 v_sub_f32 v139, v139, v232
 v_sub_f32 v140, v140, v232
 v_sub_f32 v141, v141, v232
 v_sub_f32 v142, v142, v232
 v_sub_f32 v143, v143, v232
 v_sub_f32 v160, v160, v232
 v_sub_f32 v161, v161, v232
 v_sub_f32 v162, v162, v232
 v_sub_f32 v163, v163, v232
 v_sub_f32 v164, v164, v232
 v_sub_f32 v165, v165, v232
 v_sub_f32 v166, v166, v232
 v_sub_f32 v167, v167, v232
 v_sub_f32 v168, v168, v232
 v_sub_f32 v169, v169, v232
 v_sub_f32 v170, v170, v232
 v_sub_f32 v171, v171, v232
 v_sub_f32 v172, v172, v232
 v_sub_f32 v173, v173, v232
 v_sub_f32 v174, v174, v232
 v_sub_f32 v175, v175, v232
 v_sub_f32 v176, v176, v232
 v_sub_f32 v177, v177, v232
 v_sub_f32 v178, v178, v232
 v_sub_f32 v179, v179, v232
 v_sub_f32 v180, v180, v232
 v_sub_f32 v181, v181, v232
 v_sub_f32 v182, v182, v232
 v_sub_f32 v183, v183, v232
 v_sub_f32 v184, v184, v232
 v_sub_f32 v185, v185, v232
 v_sub_f32 v186, v186, v232
 v_sub_f32 v187, v187, v232
 v_sub_f32 v188, v188, v232
 v_sub_f32 v189, v189, v232
 v_sub_f32 v190, v190, v232
 v_sub_f32 v191, v191, v232
 v_exp_f32 v233, -v232
 s_nop 0
 v_mul_f32 v229, v229, v233
 v_accvgpr_read_b32 v236, a64
 v_accvgpr_read_b32 v237, a65
 v_accvgpr_read_b32 v238, a66
 v_accvgpr_read_b32 v239, a67
 v_mul_f32 v236, v236, v233
 v_mul_f32 v237, v237, v233
 v_mul_f32 v238, v238, v233
 v_mul_f32 v239, v239, v233
 v_accvgpr_write_b32 a64, v236
 v_accvgpr_write_b32 a65, v237
 v_accvgpr_write_b32 a66, v238
 v_accvgpr_write_b32 a67, v239
 v_accvgpr_read_b32 v236, a68
 v_accvgpr_read_b32 v237, a69
 v_accvgpr_read_b32 v238, a70
 v_accvgpr_read_b32 v239, a71
 v_mul_f32 v236, v236, v233
 v_mul_f32 v237, v237, v233
 v_mul_f32 v238, v238, v233
 v_mul_f32 v239, v239, v233
 v_accvgpr_write_b32 a68, v236
 v_accvgpr_write_b32 a69, v237
 v_accvgpr_write_b32 a70, v238
 v_accvgpr_write_b32 a71, v239
 v_accvgpr_read_b32 v236, a72
 v_accvgpr_read_b32 v237, a73
 v_accvgpr_read_b32 v238, a74
 v_accvgpr_read_b32 v239, a75
 v_mul_f32 v236, v236, v233
 v_mul_f32 v237, v237, v233
 v_mul_f32 v238, v238, v233
 v_mul_f32 v239, v239, v233
 v_accvgpr_write_b32 a72, v236
 v_accvgpr_write_b32 a73, v237
 v_accvgpr_write_b32 a74, v238
 v_accvgpr_write_b32 a75, v239
 v_accvgpr_read_b32 v236, a76
 v_accvgpr_read_b32 v237, a77
 v_accvgpr_read_b32 v238, a78
 v_accvgpr_read_b32 v239, a79
 v_mul_f32 v236, v236, v233
 v_mul_f32 v237, v237, v233
 v_mul_f32 v238, v238, v233
 v_mul_f32 v239, v239, v233
 v_accvgpr_write_b32 a76, v236
 v_accvgpr_write_b32 a77, v237
 v_accvgpr_write_b32 a78, v238
 v_accvgpr_write_b32 a79, v239
 v_accvgpr_read_b32 v236, a80
 v_accvgpr_read_b32 v237, a81
 v_accvgpr_read_b32 v238, a82
 v_accvgpr_read_b32 v239, a83
 v_mul_f32 v236, v236, v233
 v_mul_f32 v237, v237, v233
 v_mul_f32 v238, v238, v233
 v_mul_f32 v239, v239, v233
 v_accvgpr_write_b32 a80, v236
 v_accvgpr_write_b32 a81, v237
 v_accvgpr_write_b32 a82, v238
 v_accvgpr_write_b32 a83, v239
 v_accvgpr_read_b32 v236, a84
 v_accvgpr_read_b32 v237, a85
 v_accvgpr_read_b32 v238, a86
 v_accvgpr_read_b32 v239, a87
 v_mul_f32 v236, v236, v233
 v_mul_f32 v237, v237, v233
 v_mul_f32 v238, v238, v233
 v_mul_f32 v239, v239, v233
 v_accvgpr_write_b32 a84, v236
 v_accvgpr_write_b32 a85, v237
 v_accvgpr_write_b32 a86, v238
 v_accvgpr_write_b32 a87, v239
 v_accvgpr_read_b32 v236, a88
 v_accvgpr_read_b32 v237, a89
 v_accvgpr_read_b32 v238, a90
 v_accvgpr_read_b32 v239, a91
 v_mul_f32 v236, v236, v233
 v_mul_f32 v237, v237, v233
 v_mul_f32 v238, v238, v233
 v_mul_f32 v239, v239, v233
 v_accvgpr_write_b32 a88, v236
 v_accvgpr_write_b32 a89, v237
 v_accvgpr_write_b32 a90, v238
 v_accvgpr_write_b32 a91, v239
 v_accvgpr_read_b32 v236, a92
 v_accvgpr_read_b32 v237, a93
 v_accvgpr_read_b32 v238, a94
 v_accvgpr_read_b32 v239, a95
 v_mul_f32 v236, v236, v233
 v_mul_f32 v237, v237, v233
 v_mul_f32 v238, v238, v233
 v_mul_f32 v239, v239, v233
 v_accvgpr_write_b32 a92, v236
 v_accvgpr_write_b32 a93, v237
 v_accvgpr_write_b32 a94, v238
 v_accvgpr_write_b32 a95, v239
 v_accvgpr_read_b32 v236, a96
 v_accvgpr_read_b32 v237, a97
 v_accvgpr_read_b32 v238, a98
 v_accvgpr_read_b32 v239, a99
 v_mul_f32 v236, v236, v233
 v_mul_f32 v237, v237, v233
 v_mul_f32 v238, v238, v233
 v_mul_f32 v239, v239, v233
 v_accvgpr_write_b32 a96, v236
 v_accvgpr_write_b32 a97, v237
 v_accvgpr_write_b32 a98, v238
 v_accvgpr_write_b32 a99, v239
 v_accvgpr_read_b32 v236, a100
 v_accvgpr_read_b32 v237, a101
 v_accvgpr_read_b32 v238, a102
 v_accvgpr_read_b32 v239, a103
 v_mul_f32 v236, v236, v233
 v_mul_f32 v237, v237, v233
 v_mul_f32 v238, v238, v233
 v_mul_f32 v239, v239, v233
 v_accvgpr_write_b32 a100, v236
 v_accvgpr_write_b32 a101, v237
 v_accvgpr_write_b32 a102, v238
 v_accvgpr_write_b32 a103, v239
 v_accvgpr_read_b32 v236, a104
 v_accvgpr_read_b32 v237, a105
 v_accvgpr_read_b32 v238, a106
 v_accvgpr_read_b32 v239, a107
 v_mul_f32 v236, v236, v233
 v_mul_f32 v237, v237, v233
 v_mul_f32 v238, v238, v233
 v_mul_f32 v239, v239, v233
 v_accvgpr_write_b32 a104, v236
 v_accvgpr_write_b32 a105, v237
 v_accvgpr_write_b32 a106, v238
 v_accvgpr_write_b32 a107, v239
 v_accvgpr_read_b32 v236, a108
 v_accvgpr_read_b32 v237, a109
 v_accvgpr_read_b32 v238, a110
 v_accvgpr_read_b32 v239, a111
 v_mul_f32 v236, v236, v233
 v_mul_f32 v237, v237, v233
 v_mul_f32 v238, v238, v233
 v_mul_f32 v239, v239, v233
 v_accvgpr_write_b32 a108, v236
 v_accvgpr_write_b32 a109, v237
 v_accvgpr_write_b32 a110, v238
 v_accvgpr_write_b32 a111, v239
 v_accvgpr_read_b32 v236, a112
 v_accvgpr_read_b32 v237, a113
 v_accvgpr_read_b32 v238, a114
 v_accvgpr_read_b32 v239, a115
 v_mul_f32 v236, v236, v233
 v_mul_f32 v237, v237, v233
 v_mul_f32 v238, v238, v233
 v_mul_f32 v239, v239, v233
 v_accvgpr_write_b32 a112, v236
 v_accvgpr_write_b32 a113, v237
 v_accvgpr_write_b32 a114, v238
 v_accvgpr_write_b32 a115, v239
 v_accvgpr_read_b32 v236, a116
 v_accvgpr_read_b32 v237, a117
 v_accvgpr_read_b32 v238, a118
 v_accvgpr_read_b32 v239, a119
 v_mul_f32 v236, v236, v233
 v_mul_f32 v237, v237, v233
 v_mul_f32 v238, v238, v233
 v_mul_f32 v239, v239, v233
 v_accvgpr_write_b32 a116, v236
 v_accvgpr_write_b32 a117, v237
 v_accvgpr_write_b32 a118, v238
 v_accvgpr_write_b32 a119, v239
 v_accvgpr_read_b32 v236, a120
 v_accvgpr_read_b32 v237, a121
 v_accvgpr_read_b32 v238, a122
 v_accvgpr_read_b32 v239, a123
 v_mul_f32 v236, v236, v233
 v_mul_f32 v237, v237, v233
 v_mul_f32 v238, v238, v233
 v_mul_f32 v239, v239, v233
 v_accvgpr_write_b32 a120, v236
 v_accvgpr_write_b32 a121, v237
 v_accvgpr_write_b32 a122, v238
 v_accvgpr_write_b32 a123, v239
 v_accvgpr_read_b32 v236, a124
 v_accvgpr_read_b32 v237, a125
 v_accvgpr_read_b32 v238, a126
 v_accvgpr_read_b32 v239, a127
 v_mul_f32 v236, v236, v233
 v_mul_f32 v237, v237, v233
 v_mul_f32 v238, v238, v233
 v_mul_f32 v239, v239, v233
 v_accvgpr_write_b32 a124, v236
 v_accvgpr_write_b32 a125, v237
 v_accvgpr_write_b32 a126, v238
 v_accvgpr_write_b32 a127, v239
 v_exp_f32 v216, v96
 v_exp_f32 v217, v97
 s_nop 0
 v_add_f32 v227, v216, v217
 v_cvt_pk_bf16_f32 v200, v216, v217
 v_exp_f32 v218, v98
 v_exp_f32 v219, v99
 v_add_f32 v227, v227, v218
 v_add_f32 v227, v227, v219
 v_cvt_pk_bf16_f32 v201, v218, v219
 v_exp_f32 v220, v100
 v_exp_f32 v221, v101
 v_add_f32 v227, v227, v220
 v_add_f32 v227, v227, v221
 v_cvt_pk_bf16_f32 v202, v220, v221
 v_exp_f32 v222, v102
 v_exp_f32 v223, v103
 v_add_f32 v227, v227, v222
 v_add_f32 v227, v227, v223
 v_cvt_pk_bf16_f32 v203, v222, v223
 v_exp_f32 v216, v104
 v_exp_f32 v217, v105
 v_add_f32 v227, v227, v216
 v_add_f32 v227, v227, v217
 v_cvt_pk_bf16_f32 v204, v216, v217
 v_exp_f32 v218, v106
 v_exp_f32 v219, v107
 v_add_f32 v227, v227, v218
 v_add_f32 v227, v227, v219
 v_cvt_pk_bf16_f32 v205, v218, v219
 v_exp_f32 v220, v108
 v_exp_f32 v221, v109
 v_add_f32 v227, v227, v220
 v_add_f32 v227, v227, v221
 v_cvt_pk_bf16_f32 v206, v220, v221
 v_exp_f32 v222, v110
 v_exp_f32 v223, v111
 v_add_f32 v227, v227, v222
 v_add_f32 v227, v227, v223
 v_cvt_pk_bf16_f32 v207, v222, v223
 s_nop 3
 s_branch K2_back12
K2_rare13:
 s_nop 15
 s_nop 15
 v_max3_f32 v232, v112, v113, v114
 v_max3_f32 v232, v232, v115, v116
 v_max3_f32 v232, v232, v117, v118
 v_max3_f32 v232, v232, v119, v120
 v_max3_f32 v232, v232, v121, v122
 v_max3_f32 v232, v232, v123, v124
 v_max3_f32 v232, v232, v125, v126
 v_max_f32 v232, v232, v127
 v_mov_b32 v233, v232
 s_nop 1
 v_permlane32_swap_b32 v232, v233
 v_max_f32 v232, v232, v233
 v_max_f32 v232, 0, v232
 v_sub_f32 v112, v112, v232
 v_sub_f32 v113, v113, v232
 v_sub_f32 v114, v114, v232
 v_sub_f32 v115, v115, v232
 v_sub_f32 v116, v116, v232
 v_sub_f32 v117, v117, v232
 v_sub_f32 v118, v118, v232
 v_sub_f32 v119, v119, v232
 v_sub_f32 v120, v120, v232
 v_sub_f32 v121, v121, v232
 v_sub_f32 v122, v122, v232
 v_sub_f32 v123, v123, v232
 v_sub_f32 v124, v124, v232
 v_sub_f32 v125, v125, v232
 v_sub_f32 v126, v126, v232
 v_sub_f32 v127, v127, v232
 v_sub_f32 v80, v80, v232
 v_sub_f32 v81, v81, v232
 v_sub_f32 v82, v82, v232
 v_sub_f32 v83, v83, v232
 v_sub_f32 v84, v84, v232
 v_sub_f32 v85, v85, v232
 v_sub_f32 v86, v86, v232
 v_sub_f32 v87, v87, v232
 v_sub_f32 v88, v88, v232
 v_sub_f32 v89, v89, v232
 v_sub_f32 v90, v90, v232
 v_sub_f32 v91, v91, v232
 v_sub_f32 v92, v92, v232
 v_sub_f32 v93, v93, v232
 v_sub_f32 v94, v94, v232
 v_sub_f32 v95, v95, v232
 v_sub_f32 v144, v144, v232
 v_sub_f32 v145, v145, v232
 v_sub_f32 v146, v146, v232
 v_sub_f32 v147, v147, v232
 v_sub_f32 v148, v148, v232
 v_sub_f32 v149, v149, v232
 v_sub_f32 v150, v150, v232
 v_sub_f32 v151, v151, v232
 v_sub_f32 v152, v152, v232
 v_sub_f32 v153, v153, v232
 v_sub_f32 v154, v154, v232
 v_sub_f32 v155, v155, v232
 v_sub_f32 v156, v156, v232
 v_sub_f32 v157, v157, v232
 v_sub_f32 v158, v158, v232
 v_sub_f32 v159, v159, v232
 v_exp_f32 v233, -v232
 s_nop 0
 v_mul_f32 v228, v228, v233
 v_accvgpr_read_b32 v236, a0
 v_accvgpr_read_b32 v237, a1
 v_accvgpr_read_b32 v238, a2
 v_accvgpr_read_b32 v239, a3
 v_mul_f32 v236, v236, v233
 v_mul_f32 v237, v237, v233
 v_mul_f32 v238, v238, v233
 v_mul_f32 v239, v239, v233
 v_accvgpr_write_b32 a0, v236
 v_accvgpr_write_b32 a1, v237
 v_accvgpr_write_b32 a2, v238
 v_accvgpr_write_b32 a3, v239
 v_accvgpr_read_b32 v236, a4
 v_accvgpr_read_b32 v237, a5
 v_accvgpr_read_b32 v238, a6
 v_accvgpr_read_b32 v239, a7
 v_mul_f32 v236, v236, v233
 v_mul_f32 v237, v237, v233
 v_mul_f32 v238, v238, v233
 v_mul_f32 v239, v239, v233
 v_accvgpr_write_b32 a4, v236
 v_accvgpr_write_b32 a5, v237
 v_accvgpr_write_b32 a6, v238
 v_accvgpr_write_b32 a7, v239
 v_accvgpr_read_b32 v236, a8
 v_accvgpr_read_b32 v237, a9
 v_accvgpr_read_b32 v238, a10
 v_accvgpr_read_b32 v239, a11
 v_mul_f32 v236, v236, v233
 v_mul_f32 v237, v237, v233
 v_mul_f32 v238, v238, v233
 v_mul_f32 v239, v239, v233
 v_accvgpr_write_b32 a8, v236
 v_accvgpr_write_b32 a9, v237
 v_accvgpr_write_b32 a10, v238
 v_accvgpr_write_b32 a11, v239
 v_accvgpr_read_b32 v236, a12
 v_accvgpr_read_b32 v237, a13
 v_accvgpr_read_b32 v238, a14
 v_accvgpr_read_b32 v239, a15
 v_mul_f32 v236, v236, v233
 v_mul_f32 v237, v237, v233
 v_mul_f32 v238, v238, v233
 v_mul_f32 v239, v239, v233
 v_accvgpr_write_b32 a12, v236
 v_accvgpr_write_b32 a13, v237
 v_accvgpr_write_b32 a14, v238
 v_accvgpr_write_b32 a15, v239
 v_accvgpr_read_b32 v236, a16
 v_accvgpr_read_b32 v237, a17
 v_accvgpr_read_b32 v238, a18
 v_accvgpr_read_b32 v239, a19
 v_mul_f32 v236, v236, v233
 v_mul_f32 v237, v237, v233
 v_mul_f32 v238, v238, v233
 v_mul_f32 v239, v239, v233
 v_accvgpr_write_b32 a16, v236
 v_accvgpr_write_b32 a17, v237
 v_accvgpr_write_b32 a18, v238
 v_accvgpr_write_b32 a19, v239
 v_accvgpr_read_b32 v236, a20
 v_accvgpr_read_b32 v237, a21
 v_accvgpr_read_b32 v238, a22
 v_accvgpr_read_b32 v239, a23
 v_mul_f32 v236, v236, v233
 v_mul_f32 v237, v237, v233
 v_mul_f32 v238, v238, v233
 v_mul_f32 v239, v239, v233
 v_accvgpr_write_b32 a20, v236
 v_accvgpr_write_b32 a21, v237
 v_accvgpr_write_b32 a22, v238
 v_accvgpr_write_b32 a23, v239
 v_accvgpr_read_b32 v236, a24
 v_accvgpr_read_b32 v237, a25
 v_accvgpr_read_b32 v238, a26
 v_accvgpr_read_b32 v239, a27
 v_mul_f32 v236, v236, v233
 v_mul_f32 v237, v237, v233
 v_mul_f32 v238, v238, v233
 v_mul_f32 v239, v239, v233
 v_accvgpr_write_b32 a24, v236
 v_accvgpr_write_b32 a25, v237
 v_accvgpr_write_b32 a26, v238
 v_accvgpr_write_b32 a27, v239
 v_accvgpr_read_b32 v236, a28
 v_accvgpr_read_b32 v237, a29
 v_accvgpr_read_b32 v238, a30
 v_accvgpr_read_b32 v239, a31
 v_mul_f32 v236, v236, v233
 v_mul_f32 v237, v237, v233
 v_mul_f32 v238, v238, v233
 v_mul_f32 v239, v239, v233
 v_accvgpr_write_b32 a28, v236
 v_accvgpr_write_b32 a29, v237
 v_accvgpr_write_b32 a30, v238
 v_accvgpr_write_b32 a31, v239
 v_accvgpr_read_b32 v236, a32
 v_accvgpr_read_b32 v237, a33
 v_accvgpr_read_b32 v238, a34
 v_accvgpr_read_b32 v239, a35
 v_mul_f32 v236, v236, v233
 v_mul_f32 v237, v237, v233
 v_mul_f32 v238, v238, v233
 v_mul_f32 v239, v239, v233
 v_accvgpr_write_b32 a32, v236
 v_accvgpr_write_b32 a33, v237
 v_accvgpr_write_b32 a34, v238
 v_accvgpr_write_b32 a35, v239
 v_accvgpr_read_b32 v236, a36
 v_accvgpr_read_b32 v237, a37
 v_accvgpr_read_b32 v238, a38
 v_accvgpr_read_b32 v239, a39
 v_mul_f32 v236, v236, v233
 v_mul_f32 v237, v237, v233
 v_mul_f32 v238, v238, v233
 v_mul_f32 v239, v239, v233
 v_accvgpr_write_b32 a36, v236
 v_accvgpr_write_b32 a37, v237
 v_accvgpr_write_b32 a38, v238
 v_accvgpr_write_b32 a39, v239
 v_accvgpr_read_b32 v236, a40
 v_accvgpr_read_b32 v237, a41
 v_accvgpr_read_b32 v238, a42
 v_accvgpr_read_b32 v239, a43
 v_mul_f32 v236, v236, v233
 v_mul_f32 v237, v237, v233
 v_mul_f32 v238, v238, v233
 v_mul_f32 v239, v239, v233
 v_accvgpr_write_b32 a40, v236
 v_accvgpr_write_b32 a41, v237
 v_accvgpr_write_b32 a42, v238
 v_accvgpr_write_b32 a43, v239
 v_accvgpr_read_b32 v236, a44
 v_accvgpr_read_b32 v237, a45
 v_accvgpr_read_b32 v238, a46
 v_accvgpr_read_b32 v239, a47
 v_mul_f32 v236, v236, v233
 v_mul_f32 v237, v237, v233
 v_mul_f32 v238, v238, v233
 v_mul_f32 v239, v239, v233
 v_accvgpr_write_b32 a44, v236
 v_accvgpr_write_b32 a45, v237
 v_accvgpr_write_b32 a46, v238
 v_accvgpr_write_b32 a47, v239
 v_accvgpr_read_b32 v236, a48
 v_accvgpr_read_b32 v237, a49
 v_accvgpr_read_b32 v238, a50
 v_accvgpr_read_b32 v239, a51
 v_mul_f32 v236, v236, v233
 v_mul_f32 v237, v237, v233
 v_mul_f32 v238, v238, v233
 v_mul_f32 v239, v239, v233
 v_accvgpr_write_b32 a48, v236
 v_accvgpr_write_b32 a49, v237
 v_accvgpr_write_b32 a50, v238
 v_accvgpr_write_b32 a51, v239
 v_accvgpr_read_b32 v236, a52
 v_accvgpr_read_b32 v237, a53
 v_accvgpr_read_b32 v238, a54
 v_accvgpr_read_b32 v239, a55
 v_mul_f32 v236, v236, v233
 v_mul_f32 v237, v237, v233
 v_mul_f32 v238, v238, v233
 v_mul_f32 v239, v239, v233
 v_accvgpr_write_b32 a52, v236
 v_accvgpr_write_b32 a53, v237
 v_accvgpr_write_b32 a54, v238
 v_accvgpr_write_b32 a55, v239
 v_accvgpr_read_b32 v236, a56
 v_accvgpr_read_b32 v237, a57
 v_accvgpr_read_b32 v238, a58
 v_accvgpr_read_b32 v239, a59
 v_mul_f32 v236, v236, v233
 v_mul_f32 v237, v237, v233
 v_mul_f32 v238, v238, v233
 v_mul_f32 v239, v239, v233
 v_accvgpr_write_b32 a56, v236
 v_accvgpr_write_b32 a57, v237
 v_accvgpr_write_b32 a58, v238
 v_accvgpr_write_b32 a59, v239
 v_accvgpr_read_b32 v236, a60
 v_accvgpr_read_b32 v237, a61
 v_accvgpr_read_b32 v238, a62
 v_accvgpr_read_b32 v239, a63
 v_mul_f32 v236, v236, v233
 v_mul_f32 v237, v237, v233
 v_mul_f32 v238, v238, v233
 v_mul_f32 v239, v239, v233
 v_accvgpr_write_b32 a60, v236
 v_accvgpr_write_b32 a61, v237
 v_accvgpr_write_b32 a62, v238
 v_accvgpr_write_b32 a63, v239
 v_exp_f32 v208, v112
 v_exp_f32 v209, v113
 s_nop 0
 v_add_f32 v226, v208, v209
 v_cvt_pk_bf16_f32 v192, v208, v209
 v_exp_f32 v210, v114
 v_exp_f32 v211, v115
 v_add_f32 v226, v226, v210
 v_add_f32 v226, v226, v211
 v_cvt_pk_bf16_f32 v193, v210, v211
 v_exp_f32 v212, v116
 v_exp_f32 v213, v117
 v_add_f32 v226, v226, v212
 v_add_f32 v226, v226, v213
 v_cvt_pk_bf16_f32 v194, v212, v213
 v_exp_f32 v214, v118
 v_exp_f32 v215, v119
 v_add_f32 v226, v226, v214
 v_add_f32 v226, v226, v215
 v_cvt_pk_bf16_f32 v195, v214, v215
 v_exp_f32 v208, v120
 v_exp_f32 v209, v121
 v_add_f32 v226, v226, v208
 v_add_f32 v226, v226, v209
 v_cvt_pk_bf16_f32 v196, v208, v209
 v_exp_f32 v210, v122
 v_exp_f32 v211, v123
 v_add_f32 v226, v226, v210
 v_exp_f32 v212, v124
 v_add_f32 v226, v226, v211
 v_cvt_pk_bf16_f32 v197, v210, v211
 v_exp_f32 v213, v125
 v_add_f32 v226, v226, v212
 v_add_f32 v226, v226, v213
 v_cvt_pk_bf16_f32 v198, v212, v213
 v_exp_f32 v214, v126
 v_exp_f32 v215, v127
 v_add_f32 v226, v226, v214
 v_add_f32 v226, v226, v215
 v_cvt_pk_bf16_f32 v199, v214, v215
 s_nop 3
 s_branch K2_back13
K2_rare14:
 s_nop 15
 s_nop 15
 v_max3_f32 v232, v128, v129, v130
 v_max3_f32 v232, v232, v131, v132
 v_max3_f32 v232, v232, v133, v134
 v_max3_f32 v232, v232, v135, v136
 v_max3_f32 v232, v232, v137, v138
 v_max3_f32 v232, v232, v139, v140
 v_max3_f32 v232, v232, v141, v142
 v_max_f32 v232, v232, v143
 v_mov_b32 v233, v232
 s_nop 1
 v_permlane32_swap_b32 v232, v233
 v_max_f32 v232, v232, v233
 v_max_f32 v232, 0, v232
 v_sub_f32 v128, v128, v232
 v_sub_f32 v129, v129, v232
 v_sub_f32 v130, v130, v232
 v_sub_f32 v131, v131, v232
 v_sub_f32 v132, v132, v232
 v_sub_f32 v133, v133, v232
 v_sub_f32 v134, v134, v232
 v_sub_f32 v135, v135, v232
 v_sub_f32 v136, v136, v232
 v_sub_f32 v137, v137, v232
 v_sub_f32 v138, v138, v232
 v_sub_f32 v139, v139, v232
 v_sub_f32 v140, v140, v232
 v_sub_f32 v141, v141, v232
 v_sub_f32 v142, v142, v232
 v_sub_f32 v143, v143, v232
 v_sub_f32 v96, v96, v232
 v_sub_f32 v97, v97, v232
 v_sub_f32 v98, v98, v232
 v_sub_f32 v99, v99, v232
 v_sub_f32 v100, v100, v232
 v_sub_f32 v101, v101, v232
 v_sub_f32 v102, v102, v232
 v_sub_f32 v103, v103, v232
 v_sub_f32 v104, v104, v232
 v_sub_f32 v105, v105, v232
 v_sub_f32 v106, v106, v232
 v_sub_f32 v107, v107, v232
 v_sub_f32 v108, v108, v232
 v_sub_f32 v109, v109, v232
 v_sub_f32 v110, v110, v232
 v_sub_f32 v111, v111, v232
 v_sub_f32 v160, v160, v232
 v_sub_f32 v161, v161, v232
 v_sub_f32 v162, v162, v232
 v_sub_f32 v163, v163, v232
 v_sub_f32 v164, v164, v232
 v_sub_f32 v165, v165, v232
 v_sub_f32 v166, v166, v232
 v_sub_f32 v167, v167, v232
 v_sub_f32 v168, v168, v232
 v_sub_f32 v169, v169, v232
 v_sub_f32 v170, v170, v232
 v_sub_f32 v171, v171, v232
 v_sub_f32 v172, v172, v232
 v_sub_f32 v173, v173, v232
 v_sub_f32 v174, v174, v232
 v_sub_f32 v175, v175, v232
 v_sub_f32 v176, v176, v232
 v_sub_f32 v177, v177, v232
 v_sub_f32 v178, v178, v232
 v_sub_f32 v179, v179, v232
 v_sub_f32 v180, v180, v232
 v_sub_f32 v181, v181, v232
 v_sub_f32 v182, v182, v232
 v_sub_f32 v183, v183, v232
 v_sub_f32 v184, v184, v232
 v_sub_f32 v185, v185, v232
 v_sub_f32 v186, v186, v232
 v_sub_f32 v187, v187, v232
 v_sub_f32 v188, v188, v232
 v_sub_f32 v189, v189, v232
 v_sub_f32 v190, v190, v232
 v_sub_f32 v191, v191, v232
 v_exp_f32 v233, -v232
 s_nop 0
 v_mul_f32 v229, v229, v233
 v_accvgpr_read_b32 v236, a64
 v_accvgpr_read_b32 v237, a65
 v_accvgpr_read_b32 v238, a66
 v_accvgpr_read_b32 v239, a67
 v_mul_f32 v236, v236, v233
 v_mul_f32 v237, v237, v233
 v_mul_f32 v238, v238, v233
 v_mul_f32 v239, v239, v233
 v_accvgpr_write_b32 a64, v236
 v_accvgpr_write_b32 a65, v237
 v_accvgpr_write_b32 a66, v238
 v_accvgpr_write_b32 a67, v239
 v_accvgpr_read_b32 v236, a68
 v_accvgpr_read_b32 v237, a69
 v_accvgpr_read_b32 v238, a70
 v_accvgpr_read_b32 v239, a71
 v_mul_f32 v236, v236, v233
 v_mul_f32 v237, v237, v233
 v_mul_f32 v238, v238, v233
 v_mul_f32 v239, v239, v233
 v_accvgpr_write_b32 a68, v236
 v_accvgpr_write_b32 a69, v237
 v_accvgpr_write_b32 a70, v238
 v_accvgpr_write_b32 a71, v239
 v_accvgpr_read_b32 v236, a72
 v_accvgpr_read_b32 v237, a73
 v_accvgpr_read_b32 v238, a74
 v_accvgpr_read_b32 v239, a75
 v_mul_f32 v236, v236, v233
 v_mul_f32 v237, v237, v233
 v_mul_f32 v238, v238, v233
 v_mul_f32 v239, v239, v233
 v_accvgpr_write_b32 a72, v236
 v_accvgpr_write_b32 a73, v237
 v_accvgpr_write_b32 a74, v238
 v_accvgpr_write_b32 a75, v239
 v_accvgpr_read_b32 v236, a76
 v_accvgpr_read_b32 v237, a77
 v_accvgpr_read_b32 v238, a78
 v_accvgpr_read_b32 v239, a79
 v_mul_f32 v236, v236, v233
 v_mul_f32 v237, v237, v233
 v_mul_f32 v238, v238, v233
 v_mul_f32 v239, v239, v233
 v_accvgpr_write_b32 a76, v236
 v_accvgpr_write_b32 a77, v237
 v_accvgpr_write_b32 a78, v238
 v_accvgpr_write_b32 a79, v239
 v_accvgpr_read_b32 v236, a80
 v_accvgpr_read_b32 v237, a81
 v_accvgpr_read_b32 v238, a82
 v_accvgpr_read_b32 v239, a83
 v_mul_f32 v236, v236, v233
 v_mul_f32 v237, v237, v233
 v_mul_f32 v238, v238, v233
 v_mul_f32 v239, v239, v233
 v_accvgpr_write_b32 a80, v236
 v_accvgpr_write_b32 a81, v237
 v_accvgpr_write_b32 a82, v238
 v_accvgpr_write_b32 a83, v239
 v_accvgpr_read_b32 v236, a84
 v_accvgpr_read_b32 v237, a85
 v_accvgpr_read_b32 v238, a86
 v_accvgpr_read_b32 v239, a87
 v_mul_f32 v236, v236, v233
 v_mul_f32 v237, v237, v233
 v_mul_f32 v238, v238, v233
 v_mul_f32 v239, v239, v233
 v_accvgpr_write_b32 a84, v236
 v_accvgpr_write_b32 a85, v237
 v_accvgpr_write_b32 a86, v238
 v_accvgpr_write_b32 a87, v239
 v_accvgpr_read_b32 v236, a88
 v_accvgpr_read_b32 v237, a89
 v_accvgpr_read_b32 v238, a90
 v_accvgpr_read_b32 v239, a91
 v_mul_f32 v236, v236, v233
 v_mul_f32 v237, v237, v233
 v_mul_f32 v238, v238, v233
 v_mul_f32 v239, v239, v233
 v_accvgpr_write_b32 a88, v236
 v_accvgpr_write_b32 a89, v237
 v_accvgpr_write_b32 a90, v238
 v_accvgpr_write_b32 a91, v239
 v_accvgpr_read_b32 v236, a92
 v_accvgpr_read_b32 v237, a93
 v_accvgpr_read_b32 v238, a94
 v_accvgpr_read_b32 v239, a95
 v_mul_f32 v236, v236, v233
 v_mul_f32 v237, v237, v233
 v_mul_f32 v238, v238, v233
 v_mul_f32 v239, v239, v233
 v_accvgpr_write_b32 a92, v236
 v_accvgpr_write_b32 a93, v237
 v_accvgpr_write_b32 a94, v238
 v_accvgpr_write_b32 a95, v239
 v_accvgpr_read_b32 v236, a96
 v_accvgpr_read_b32 v237, a97
 v_accvgpr_read_b32 v238, a98
 v_accvgpr_read_b32 v239, a99
 v_mul_f32 v236, v236, v233
 v_mul_f32 v237, v237, v233
 v_mul_f32 v238, v238, v233
 v_mul_f32 v239, v239, v233
 v_accvgpr_write_b32 a96, v236
 v_accvgpr_write_b32 a97, v237
 v_accvgpr_write_b32 a98, v238
 v_accvgpr_write_b32 a99, v239
 v_accvgpr_read_b32 v236, a100
 v_accvgpr_read_b32 v237, a101
 v_accvgpr_read_b32 v238, a102
 v_accvgpr_read_b32 v239, a103
 v_mul_f32 v236, v236, v233
 v_mul_f32 v237, v237, v233
 v_mul_f32 v238, v238, v233
 v_mul_f32 v239, v239, v233
 v_accvgpr_write_b32 a100, v236
 v_accvgpr_write_b32 a101, v237
 v_accvgpr_write_b32 a102, v238
 v_accvgpr_write_b32 a103, v239
 v_accvgpr_read_b32 v236, a104
 v_accvgpr_read_b32 v237, a105
 v_accvgpr_read_b32 v238, a106
 v_accvgpr_read_b32 v239, a107
 v_mul_f32 v236, v236, v233
 v_mul_f32 v237, v237, v233
 v_mul_f32 v238, v238, v233
 v_mul_f32 v239, v239, v233
 v_accvgpr_write_b32 a104, v236
 v_accvgpr_write_b32 a105, v237
 v_accvgpr_write_b32 a106, v238
 v_accvgpr_write_b32 a107, v239
 v_accvgpr_read_b32 v236, a108
 v_accvgpr_read_b32 v237, a109
 v_accvgpr_read_b32 v238, a110
 v_accvgpr_read_b32 v239, a111
 v_mul_f32 v236, v236, v233
 v_mul_f32 v237, v237, v233
 v_mul_f32 v238, v238, v233
 v_mul_f32 v239, v239, v233
 v_accvgpr_write_b32 a108, v236
 v_accvgpr_write_b32 a109, v237
 v_accvgpr_write_b32 a110, v238
 v_accvgpr_write_b32 a111, v239
 v_accvgpr_read_b32 v236, a112
 v_accvgpr_read_b32 v237, a113
 v_accvgpr_read_b32 v238, a114
 v_accvgpr_read_b32 v239, a115
 v_mul_f32 v236, v236, v233
 v_mul_f32 v237, v237, v233
 v_mul_f32 v238, v238, v233
 v_mul_f32 v239, v239, v233
 v_accvgpr_write_b32 a112, v236
 v_accvgpr_write_b32 a113, v237
 v_accvgpr_write_b32 a114, v238
 v_accvgpr_write_b32 a115, v239
 v_accvgpr_read_b32 v236, a116
 v_accvgpr_read_b32 v237, a117
 v_accvgpr_read_b32 v238, a118
 v_accvgpr_read_b32 v239, a119
 v_mul_f32 v236, v236, v233
 v_mul_f32 v237, v237, v233
 v_mul_f32 v238, v238, v233
 v_mul_f32 v239, v239, v233
 v_accvgpr_write_b32 a116, v236
 v_accvgpr_write_b32 a117, v237
 v_accvgpr_write_b32 a118, v238
 v_accvgpr_write_b32 a119, v239
 v_accvgpr_read_b32 v236, a120
 v_accvgpr_read_b32 v237, a121
 v_accvgpr_read_b32 v238, a122
 v_accvgpr_read_b32 v239, a123
 v_mul_f32 v236, v236, v233
 v_mul_f32 v237, v237, v233
 v_mul_f32 v238, v238, v233
 v_mul_f32 v239, v239, v233
 v_accvgpr_write_b32 a120, v236
 v_accvgpr_write_b32 a121, v237
 v_accvgpr_write_b32 a122, v238
 v_accvgpr_write_b32 a123, v239
 v_accvgpr_read_b32 v236, a124
 v_accvgpr_read_b32 v237, a125
 v_accvgpr_read_b32 v238, a126
 v_accvgpr_read_b32 v239, a127
 v_mul_f32 v236, v236, v233
 v_mul_f32 v237, v237, v233
 v_mul_f32 v238, v238, v233
 v_mul_f32 v239, v239, v233
 v_accvgpr_write_b32 a124, v236
 v_accvgpr_write_b32 a125, v237
 v_accvgpr_write_b32 a126, v238
 v_accvgpr_write_b32 a127, v239
 v_exp_f32 v216, v128
 v_exp_f32 v217, v129
 s_nop 0
 v_add_f32 v227, v216, v217
 v_cvt_pk_bf16_f32 v200, v216, v217
 v_exp_f32 v218, v130
 v_exp_f32 v219, v131
 v_add_f32 v227, v227, v218
 v_add_f32 v227, v227, v219
 v_cvt_pk_bf16_f32 v201, v218, v219
 v_exp_f32 v220, v132
 v_exp_f32 v221, v133
 v_add_f32 v227, v227, v220
 v_add_f32 v227, v227, v221
 v_cvt_pk_bf16_f32 v202, v220, v221
 v_exp_f32 v222, v134
 v_exp_f32 v223, v135
 v_add_f32 v227, v227, v222
 v_add_f32 v227, v227, v223
 v_cvt_pk_bf16_f32 v203, v222, v223
 v_exp_f32 v216, v136
 v_exp_f32 v217, v137
 v_add_f32 v227, v227, v216
 v_add_f32 v227, v227, v217
 v_cvt_pk_bf16_f32 v204, v216, v217
 v_exp_f32 v218, v138
 v_exp_f32 v219, v139
 v_add_f32 v227, v227, v218
 v_add_f32 v227, v227, v219
 v_cvt_pk_bf16_f32 v205, v218, v219
 v_exp_f32 v220, v140
 v_exp_f32 v221, v141
 v_add_f32 v227, v227, v220
 v_add_f32 v227, v227, v221
 v_cvt_pk_bf16_f32 v206, v220, v221
 v_exp_f32 v222, v142
 v_exp_f32 v223, v143
 v_add_f32 v227, v227, v222
 v_add_f32 v227, v227, v223
 v_cvt_pk_bf16_f32 v207, v222, v223
 s_nop 3
 s_branch K2_back14
K2_rare16:
 s_nop 15
 s_nop 15
 v_max3_f32 v232, v80, v81, v82
 v_max3_f32 v232, v232, v83, v84
 v_max3_f32 v232, v232, v85, v86
 v_max3_f32 v232, v232, v87, v88
 v_max3_f32 v232, v232, v89, v90
 v_max3_f32 v232, v232, v91, v92
 v_max3_f32 v232, v232, v93, v94
 v_max_f32 v232, v232, v95
 v_mov_b32 v233, v232
 s_nop 1
 v_permlane32_swap_b32 v232, v233
 v_max_f32 v232, v232, v233
 v_max_f32 v232, 0, v232
 v_sub_f32 v80, v80, v232
 v_sub_f32 v81, v81, v232
 v_sub_f32 v82, v82, v232
 v_sub_f32 v83, v83, v232
 v_sub_f32 v84, v84, v232
 v_sub_f32 v85, v85, v232
 v_sub_f32 v86, v86, v232
 v_sub_f32 v87, v87, v232
 v_sub_f32 v88, v88, v232
 v_sub_f32 v89, v89, v232
 v_sub_f32 v90, v90, v232
 v_sub_f32 v91, v91, v232
 v_sub_f32 v92, v92, v232
 v_sub_f32 v93, v93, v232
 v_sub_f32 v94, v94, v232
 v_sub_f32 v95, v95, v232
 v_sub_f32 v112, v112, v232
 v_sub_f32 v113, v113, v232
 v_sub_f32 v114, v114, v232
 v_sub_f32 v115, v115, v232
 v_sub_f32 v116, v116, v232
 v_sub_f32 v117, v117, v232
 v_sub_f32 v118, v118, v232
 v_sub_f32 v119, v119, v232
 v_sub_f32 v120, v120, v232
 v_sub_f32 v121, v121, v232
 v_sub_f32 v122, v122, v232
 v_sub_f32 v123, v123, v232
 v_sub_f32 v124, v124, v232
 v_sub_f32 v125, v125, v232
 v_sub_f32 v126, v126, v232
 v_sub_f32 v127, v127, v232
 v_sub_f32 v144, v144, v232
 v_sub_f32 v145, v145, v232
 v_sub_f32 v146, v146, v232
 v_sub_f32 v147, v147, v232
 v_sub_f32 v148, v148, v232
 v_sub_f32 v149, v149, v232
 v_sub_f32 v150, v150, v232
 v_sub_f32 v151, v151, v232
 v_sub_f32 v152, v152, v232
 v_sub_f32 v153, v153, v232
 v_sub_f32 v154, v154, v232
 v_sub_f32 v155, v155, v232
 v_sub_f32 v156, v156, v232
 v_sub_f32 v157, v157, v232
 v_sub_f32 v158, v158, v232
 v_sub_f32 v159, v159, v232
 v_exp_f32 v233, -v232
 s_nop 0
 v_mul_f32 v228, v228, v233
 v_accvgpr_read_b32 v236, a0
 v_accvgpr_read_b32 v237, a1
 v_accvgpr_read_b32 v238, a2
 v_accvgpr_read_b32 v239, a3
 v_mul_f32 v236, v236, v233
 v_mul_f32 v237, v237, v233
 v_mul_f32 v238, v238, v233
 v_mul_f32 v239, v239, v233
 v_accvgpr_write_b32 a0, v236
 v_accvgpr_write_b32 a1, v237
 v_accvgpr_write_b32 a2, v238
 v_accvgpr_write_b32 a3, v239
 v_accvgpr_read_b32 v236, a4
 v_accvgpr_read_b32 v237, a5
 v_accvgpr_read_b32 v238, a6
 v_accvgpr_read_b32 v239, a7
 v_mul_f32 v236, v236, v233
 v_mul_f32 v237, v237, v233
 v_mul_f32 v238, v238, v233
 v_mul_f32 v239, v239, v233
 v_accvgpr_write_b32 a4, v236
 v_accvgpr_write_b32 a5, v237
 v_accvgpr_write_b32 a6, v238
 v_accvgpr_write_b32 a7, v239
 v_accvgpr_read_b32 v236, a8
 v_accvgpr_read_b32 v237, a9
 v_accvgpr_read_b32 v238, a10
 v_accvgpr_read_b32 v239, a11
 v_mul_f32 v236, v236, v233
 v_mul_f32 v237, v237, v233
 v_mul_f32 v238, v238, v233
 v_mul_f32 v239, v239, v233
 v_accvgpr_write_b32 a8, v236
 v_accvgpr_write_b32 a9, v237
 v_accvgpr_write_b32 a10, v238
 v_accvgpr_write_b32 a11, v239
 v_accvgpr_read_b32 v236, a12
 v_accvgpr_read_b32 v237, a13
 v_accvgpr_read_b32 v238, a14
 v_accvgpr_read_b32 v239, a15
 v_mul_f32 v236, v236, v233
 v_mul_f32 v237, v237, v233
 v_mul_f32 v238, v238, v233
 v_mul_f32 v239, v239, v233
 v_accvgpr_write_b32 a12, v236
 v_accvgpr_write_b32 a13, v237
 v_accvgpr_write_b32 a14, v238
 v_accvgpr_write_b32 a15, v239
 v_accvgpr_read_b32 v236, a16
 v_accvgpr_read_b32 v237, a17
 v_accvgpr_read_b32 v238, a18
 v_accvgpr_read_b32 v239, a19
 v_mul_f32 v236, v236, v233
 v_mul_f32 v237, v237, v233
 v_mul_f32 v238, v238, v233
 v_mul_f32 v239, v239, v233
 v_accvgpr_write_b32 a16, v236
 v_accvgpr_write_b32 a17, v237
 v_accvgpr_write_b32 a18, v238
 v_accvgpr_write_b32 a19, v239
 v_accvgpr_read_b32 v236, a20
 v_accvgpr_read_b32 v237, a21
 v_accvgpr_read_b32 v238, a22
 v_accvgpr_read_b32 v239, a23
 v_mul_f32 v236, v236, v233
 v_mul_f32 v237, v237, v233
 v_mul_f32 v238, v238, v233
 v_mul_f32 v239, v239, v233
 v_accvgpr_write_b32 a20, v236
 v_accvgpr_write_b32 a21, v237
 v_accvgpr_write_b32 a22, v238
 v_accvgpr_write_b32 a23, v239
 v_accvgpr_read_b32 v236, a24
 v_accvgpr_read_b32 v237, a25
 v_accvgpr_read_b32 v238, a26
 v_accvgpr_read_b32 v239, a27
 v_mul_f32 v236, v236, v233
 v_mul_f32 v237, v237, v233
 v_mul_f32 v238, v238, v233
 v_mul_f32 v239, v239, v233
 v_accvgpr_write_b32 a24, v236
 v_accvgpr_write_b32 a25, v237
 v_accvgpr_write_b32 a26, v238
 v_accvgpr_write_b32 a27, v239
 v_accvgpr_read_b32 v236, a28
 v_accvgpr_read_b32 v237, a29
 v_accvgpr_read_b32 v238, a30
 v_accvgpr_read_b32 v239, a31
 v_mul_f32 v236, v236, v233
 v_mul_f32 v237, v237, v233
 v_mul_f32 v238, v238, v233
 v_mul_f32 v239, v239, v233
 v_accvgpr_write_b32 a28, v236
 v_accvgpr_write_b32 a29, v237
 v_accvgpr_write_b32 a30, v238
 v_accvgpr_write_b32 a31, v239
 v_accvgpr_read_b32 v236, a32
 v_accvgpr_read_b32 v237, a33
 v_accvgpr_read_b32 v238, a34
 v_accvgpr_read_b32 v239, a35
 v_mul_f32 v236, v236, v233
 v_mul_f32 v237, v237, v233
 v_mul_f32 v238, v238, v233
 v_mul_f32 v239, v239, v233
 v_accvgpr_write_b32 a32, v236
 v_accvgpr_write_b32 a33, v237
 v_accvgpr_write_b32 a34, v238
 v_accvgpr_write_b32 a35, v239
 v_accvgpr_read_b32 v236, a36
 v_accvgpr_read_b32 v237, a37
 v_accvgpr_read_b32 v238, a38
 v_accvgpr_read_b32 v239, a39
 v_mul_f32 v236, v236, v233
 v_mul_f32 v237, v237, v233
 v_mul_f32 v238, v238, v233
 v_mul_f32 v239, v239, v233
 v_accvgpr_write_b32 a36, v236
 v_accvgpr_write_b32 a37, v237
 v_accvgpr_write_b32 a38, v238
 v_accvgpr_write_b32 a39, v239
 v_accvgpr_read_b32 v236, a40
 v_accvgpr_read_b32 v237, a41
 v_accvgpr_read_b32 v238, a42
 v_accvgpr_read_b32 v239, a43
 v_mul_f32 v236, v236, v233
 v_mul_f32 v237, v237, v233
 v_mul_f32 v238, v238, v233
 v_mul_f32 v239, v239, v233
 v_accvgpr_write_b32 a40, v236
 v_accvgpr_write_b32 a41, v237
 v_accvgpr_write_b32 a42, v238
 v_accvgpr_write_b32 a43, v239
 v_accvgpr_read_b32 v236, a44
 v_accvgpr_read_b32 v237, a45
 v_accvgpr_read_b32 v238, a46
 v_accvgpr_read_b32 v239, a47
 v_mul_f32 v236, v236, v233
 v_mul_f32 v237, v237, v233
 v_mul_f32 v238, v238, v233
 v_mul_f32 v239, v239, v233
 v_accvgpr_write_b32 a44, v236
 v_accvgpr_write_b32 a45, v237
 v_accvgpr_write_b32 a46, v238
 v_accvgpr_write_b32 a47, v239
 v_accvgpr_read_b32 v236, a48
 v_accvgpr_read_b32 v237, a49
 v_accvgpr_read_b32 v238, a50
 v_accvgpr_read_b32 v239, a51
 v_mul_f32 v236, v236, v233
 v_mul_f32 v237, v237, v233
 v_mul_f32 v238, v238, v233
 v_mul_f32 v239, v239, v233
 v_accvgpr_write_b32 a48, v236
 v_accvgpr_write_b32 a49, v237
 v_accvgpr_write_b32 a50, v238
 v_accvgpr_write_b32 a51, v239
 v_accvgpr_read_b32 v236, a52
 v_accvgpr_read_b32 v237, a53
 v_accvgpr_read_b32 v238, a54
 v_accvgpr_read_b32 v239, a55
 v_mul_f32 v236, v236, v233
 v_mul_f32 v237, v237, v233
 v_mul_f32 v238, v238, v233
 v_mul_f32 v239, v239, v233
 v_accvgpr_write_b32 a52, v236
 v_accvgpr_write_b32 a53, v237
 v_accvgpr_write_b32 a54, v238
 v_accvgpr_write_b32 a55, v239
 v_accvgpr_read_b32 v236, a56
 v_accvgpr_read_b32 v237, a57
 v_accvgpr_read_b32 v238, a58
 v_accvgpr_read_b32 v239, a59
 v_mul_f32 v236, v236, v233
 v_mul_f32 v237, v237, v233
 v_mul_f32 v238, v238, v233
 v_mul_f32 v239, v239, v233
 v_accvgpr_write_b32 a56, v236
 v_accvgpr_write_b32 a57, v237
 v_accvgpr_write_b32 a58, v238
 v_accvgpr_write_b32 a59, v239
 v_accvgpr_read_b32 v236, a60
 v_accvgpr_read_b32 v237, a61
 v_accvgpr_read_b32 v238, a62
 v_accvgpr_read_b32 v239, a63
 v_mul_f32 v236, v236, v233
 v_mul_f32 v237, v237, v233
 v_mul_f32 v238, v238, v233
 v_mul_f32 v239, v239, v233
 v_accvgpr_write_b32 a60, v236
 v_accvgpr_write_b32 a61, v237
 v_accvgpr_write_b32 a62, v238
 v_accvgpr_write_b32 a63, v239
 v_exp_f32 v208, v80
 v_exp_f32 v209, v81
 s_nop 0
 v_add_f32 v226, v208, v209
 v_cvt_pk_bf16_f32 v192, v208, v209
 v_exp_f32 v210, v82
 v_exp_f32 v211, v83
 v_add_f32 v226, v226, v210
 v_add_f32 v226, v226, v211
 v_cvt_pk_bf16_f32 v193, v210, v211
 v_exp_f32 v212, v84
 v_exp_f32 v213, v85
 v_add_f32 v226, v226, v212
 v_add_f32 v226, v226, v213
 v_cvt_pk_bf16_f32 v194, v212, v213
 v_exp_f32 v214, v86
 v_exp_f32 v215, v87
 v_add_f32 v226, v226, v214
 v_add_f32 v226, v226, v215
 v_cvt_pk_bf16_f32 v195, v214, v215
 v_exp_f32 v208, v88
 v_exp_f32 v209, v89
 v_exp_f32 v210, v90
 v_add_f32 v226, v226, v208
 v_add_f32 v226, v226, v209
 v_cvt_pk_bf16_f32 v196, v208, v209
 v_exp_f32 v211, v91
 v_add_f32 v226, v226, v210
 v_exp_f32 v212, v92
 v_add_f32 v226, v226, v211
 v_cvt_pk_bf16_f32 v197, v210, v211
 v_exp_f32 v213, v93
 v_add_f32 v226, v226, v212
 v_exp_f32 v214, v94
 v_add_f32 v226, v226, v213
 v_cvt_pk_bf16_f32 v198, v212, v213
 v_exp_f32 v215, v95
 v_add_f32 v226, v226, v214
 v_add_f32 v226, v226, v215
 v_cvt_pk_bf16_f32 v199, v214, v215
 s_nop 3
 s_branch K2_back16
K2_rare17:
 s_nop 15
 s_nop 15
 v_max3_f32 v232, v96, v97, v98
 v_max3_f32 v232, v232, v99, v100
 v_max3_f32 v232, v232, v101, v102
 v_max3_f32 v232, v232, v103, v104
 v_max3_f32 v232, v232, v105, v106
 v_max3_f32 v232, v232, v107, v108
 v_max3_f32 v232, v232, v109, v110
 v_max_f32 v232, v232, v111
 v_mov_b32 v233, v232
 s_nop 1
 v_permlane32_swap_b32 v232, v233
 v_max_f32 v232, v232, v233
 v_max_f32 v232, 0, v232
 v_sub_f32 v96, v96, v232
 v_sub_f32 v97, v97, v232
 v_sub_f32 v98, v98, v232
 v_sub_f32 v99, v99, v232
 v_sub_f32 v100, v100, v232
 v_sub_f32 v101, v101, v232
 v_sub_f32 v102, v102, v232
 v_sub_f32 v103, v103, v232
 v_sub_f32 v104, v104, v232
 v_sub_f32 v105, v105, v232
 v_sub_f32 v106, v106, v232
 v_sub_f32 v107, v107, v232
 v_sub_f32 v108, v108, v232
 v_sub_f32 v109, v109, v232
 v_sub_f32 v110, v110, v232
 v_sub_f32 v111, v111, v232
 v_sub_f32 v128, v128, v232
 v_sub_f32 v129, v129, v232
 v_sub_f32 v130, v130, v232
 v_sub_f32 v131, v131, v232
 v_sub_f32 v132, v132, v232
 v_sub_f32 v133, v133, v232
 v_sub_f32 v134, v134, v232
 v_sub_f32 v135, v135, v232
 v_sub_f32 v136, v136, v232
 v_sub_f32 v137, v137, v232
 v_sub_f32 v138, v138, v232
 v_sub_f32 v139, v139, v232
 v_sub_f32 v140, v140, v232
 v_sub_f32 v141, v141, v232
 v_sub_f32 v142, v142, v232
 v_sub_f32 v143, v143, v232
 v_sub_f32 v160, v160, v232
 v_sub_f32 v161, v161, v232
 v_sub_f32 v162, v162, v232
 v_sub_f32 v163, v163, v232
 v_sub_f32 v164, v164, v232
 v_sub_f32 v165, v165, v232
 v_sub_f32 v166, v166, v232
 v_sub_f32 v167, v167, v232
 v_sub_f32 v168, v168, v232
 v_sub_f32 v169, v169, v232
 v_sub_f32 v170, v170, v232
 v_sub_f32 v171, v171, v232
 v_sub_f32 v172, v172, v232
 v_sub_f32 v173, v173, v232
 v_sub_f32 v174, v174, v232
 v_sub_f32 v175, v175, v232
 v_sub_f32 v176, v176, v232
 v_sub_f32 v177, v177, v232
 v_sub_f32 v178, v178, v232
 v_sub_f32 v179, v179, v232
 v_sub_f32 v180, v180, v232
 v_sub_f32 v181, v181, v232
 v_sub_f32 v182, v182, v232
 v_sub_f32 v183, v183, v232
 v_sub_f32 v184, v184, v232
 v_sub_f32 v185, v185, v232
 v_sub_f32 v186, v186, v232
 v_sub_f32 v187, v187, v232
 v_sub_f32 v188, v188, v232
 v_sub_f32 v189, v189, v232
 v_sub_f32 v190, v190, v232
 v_sub_f32 v191, v191, v232
 v_exp_f32 v233, -v232
 s_nop 0
 v_mul_f32 v229, v229, v233
 v_accvgpr_read_b32 v236, a64
 v_accvgpr_read_b32 v237, a65
 v_accvgpr_read_b32 v238, a66
 v_accvgpr_read_b32 v239, a67
 v_mul_f32 v236, v236, v233
 v_mul_f32 v237, v237, v233
 v_mul_f32 v238, v238, v233
 v_mul_f32 v239, v239, v233
 v_accvgpr_write_b32 a64, v236
 v_accvgpr_write_b32 a65, v237
 v_accvgpr_write_b32 a66, v238
 v_accvgpr_write_b32 a67, v239
 v_accvgpr_read_b32 v236, a68
 v_accvgpr_read_b32 v237, a69
 v_accvgpr_read_b32 v238, a70
 v_accvgpr_read_b32 v239, a71
 v_mul_f32 v236, v236, v233
 v_mul_f32 v237, v237, v233
 v_mul_f32 v238, v238, v233
 v_mul_f32 v239, v239, v233
 v_accvgpr_write_b32 a68, v236
 v_accvgpr_write_b32 a69, v237
 v_accvgpr_write_b32 a70, v238
 v_accvgpr_write_b32 a71, v239
 v_accvgpr_read_b32 v236, a72
 v_accvgpr_read_b32 v237, a73
 v_accvgpr_read_b32 v238, a74
 v_accvgpr_read_b32 v239, a75
 v_mul_f32 v236, v236, v233
 v_mul_f32 v237, v237, v233
 v_mul_f32 v238, v238, v233
 v_mul_f32 v239, v239, v233
 v_accvgpr_write_b32 a72, v236
 v_accvgpr_write_b32 a73, v237
 v_accvgpr_write_b32 a74, v238
 v_accvgpr_write_b32 a75, v239
 v_accvgpr_read_b32 v236, a76
 v_accvgpr_read_b32 v237, a77
 v_accvgpr_read_b32 v238, a78
 v_accvgpr_read_b32 v239, a79
 v_mul_f32 v236, v236, v233
 v_mul_f32 v237, v237, v233
 v_mul_f32 v238, v238, v233
 v_mul_f32 v239, v239, v233
 v_accvgpr_write_b32 a76, v236
 v_accvgpr_write_b32 a77, v237
 v_accvgpr_write_b32 a78, v238
 v_accvgpr_write_b32 a79, v239
 v_accvgpr_read_b32 v236, a80
 v_accvgpr_read_b32 v237, a81
 v_accvgpr_read_b32 v238, a82
 v_accvgpr_read_b32 v239, a83
 v_mul_f32 v236, v236, v233
 v_mul_f32 v237, v237, v233
 v_mul_f32 v238, v238, v233
 v_mul_f32 v239, v239, v233
 v_accvgpr_write_b32 a80, v236
 v_accvgpr_write_b32 a81, v237
 v_accvgpr_write_b32 a82, v238
 v_accvgpr_write_b32 a83, v239
 v_accvgpr_read_b32 v236, a84
 v_accvgpr_read_b32 v237, a85
 v_accvgpr_read_b32 v238, a86
 v_accvgpr_read_b32 v239, a87
 v_mul_f32 v236, v236, v233
 v_mul_f32 v237, v237, v233
 v_mul_f32 v238, v238, v233
 v_mul_f32 v239, v239, v233
 v_accvgpr_write_b32 a84, v236
 v_accvgpr_write_b32 a85, v237
 v_accvgpr_write_b32 a86, v238
 v_accvgpr_write_b32 a87, v239
 v_accvgpr_read_b32 v236, a88
 v_accvgpr_read_b32 v237, a89
 v_accvgpr_read_b32 v238, a90
 v_accvgpr_read_b32 v239, a91
 v_mul_f32 v236, v236, v233
 v_mul_f32 v237, v237, v233
 v_mul_f32 v238, v238, v233
 v_mul_f32 v239, v239, v233
 v_accvgpr_write_b32 a88, v236
 v_accvgpr_write_b32 a89, v237
 v_accvgpr_write_b32 a90, v238
 v_accvgpr_write_b32 a91, v239
 v_accvgpr_read_b32 v236, a92
 v_accvgpr_read_b32 v237, a93
 v_accvgpr_read_b32 v238, a94
 v_accvgpr_read_b32 v239, a95
 v_mul_f32 v236, v236, v233
 v_mul_f32 v237, v237, v233
 v_mul_f32 v238, v238, v233
 v_mul_f32 v239, v239, v233
 v_accvgpr_write_b32 a92, v236
 v_accvgpr_write_b32 a93, v237
 v_accvgpr_write_b32 a94, v238
 v_accvgpr_write_b32 a95, v239
 v_accvgpr_read_b32 v236, a96
 v_accvgpr_read_b32 v237, a97
 v_accvgpr_read_b32 v238, a98
 v_accvgpr_read_b32 v239, a99
 v_mul_f32 v236, v236, v233
 v_mul_f32 v237, v237, v233
 v_mul_f32 v238, v238, v233
 v_mul_f32 v239, v239, v233
 v_accvgpr_write_b32 a96, v236
 v_accvgpr_write_b32 a97, v237
 v_accvgpr_write_b32 a98, v238
 v_accvgpr_write_b32 a99, v239
 v_accvgpr_read_b32 v236, a100
 v_accvgpr_read_b32 v237, a101
 v_accvgpr_read_b32 v238, a102
 v_accvgpr_read_b32 v239, a103
 v_mul_f32 v236, v236, v233
 v_mul_f32 v237, v237, v233
 v_mul_f32 v238, v238, v233
 v_mul_f32 v239, v239, v233
 v_accvgpr_write_b32 a100, v236
 v_accvgpr_write_b32 a101, v237
 v_accvgpr_write_b32 a102, v238
 v_accvgpr_write_b32 a103, v239
 v_accvgpr_read_b32 v236, a104
 v_accvgpr_read_b32 v237, a105
 v_accvgpr_read_b32 v238, a106
 v_accvgpr_read_b32 v239, a107
 v_mul_f32 v236, v236, v233
 v_mul_f32 v237, v237, v233
 v_mul_f32 v238, v238, v233
 v_mul_f32 v239, v239, v233
 v_accvgpr_write_b32 a104, v236
 v_accvgpr_write_b32 a105, v237
 v_accvgpr_write_b32 a106, v238
 v_accvgpr_write_b32 a107, v239
 v_accvgpr_read_b32 v236, a108
 v_accvgpr_read_b32 v237, a109
 v_accvgpr_read_b32 v238, a110
 v_accvgpr_read_b32 v239, a111
 v_mul_f32 v236, v236, v233
 v_mul_f32 v237, v237, v233
 v_mul_f32 v238, v238, v233
 v_mul_f32 v239, v239, v233
 v_accvgpr_write_b32 a108, v236
 v_accvgpr_write_b32 a109, v237
 v_accvgpr_write_b32 a110, v238
 v_accvgpr_write_b32 a111, v239
 v_accvgpr_read_b32 v236, a112
 v_accvgpr_read_b32 v237, a113
 v_accvgpr_read_b32 v238, a114
 v_accvgpr_read_b32 v239, a115
 v_mul_f32 v236, v236, v233
 v_mul_f32 v237, v237, v233
 v_mul_f32 v238, v238, v233
 v_mul_f32 v239, v239, v233
 v_accvgpr_write_b32 a112, v236
 v_accvgpr_write_b32 a113, v237
 v_accvgpr_write_b32 a114, v238
 v_accvgpr_write_b32 a115, v239
 v_accvgpr_read_b32 v236, a116
 v_accvgpr_read_b32 v237, a117
 v_accvgpr_read_b32 v238, a118
 v_accvgpr_read_b32 v239, a119
 v_mul_f32 v236, v236, v233
 v_mul_f32 v237, v237, v233
 v_mul_f32 v238, v238, v233
 v_mul_f32 v239, v239, v233
 v_accvgpr_write_b32 a116, v236
 v_accvgpr_write_b32 a117, v237
 v_accvgpr_write_b32 a118, v238
 v_accvgpr_write_b32 a119, v239
 v_accvgpr_read_b32 v236, a120
 v_accvgpr_read_b32 v237, a121
 v_accvgpr_read_b32 v238, a122
 v_accvgpr_read_b32 v239, a123
 v_mul_f32 v236, v236, v233
 v_mul_f32 v237, v237, v233
 v_mul_f32 v238, v238, v233
 v_mul_f32 v239, v239, v233
 v_accvgpr_write_b32 a120, v236
 v_accvgpr_write_b32 a121, v237
 v_accvgpr_write_b32 a122, v238
 v_accvgpr_write_b32 a123, v239
 v_accvgpr_read_b32 v236, a124
 v_accvgpr_read_b32 v237, a125
 v_accvgpr_read_b32 v238, a126
 v_accvgpr_read_b32 v239, a127
 v_mul_f32 v236, v236, v233
 v_mul_f32 v237, v237, v233
 v_mul_f32 v238, v238, v233
 v_mul_f32 v239, v239, v233
 v_accvgpr_write_b32 a124, v236
 v_accvgpr_write_b32 a125, v237
 v_accvgpr_write_b32 a126, v238
 v_accvgpr_write_b32 a127, v239
 v_exp_f32 v216, v96
 v_exp_f32 v217, v97
 s_nop 0
 v_add_f32 v227, v216, v217
 v_cvt_pk_bf16_f32 v200, v216, v217
 v_exp_f32 v218, v98
 v_exp_f32 v219, v99
 v_add_f32 v227, v227, v218
 v_add_f32 v227, v227, v219
 v_cvt_pk_bf16_f32 v201, v218, v219
 v_exp_f32 v220, v100
 v_exp_f32 v221, v101
 v_add_f32 v227, v227, v220
 v_add_f32 v227, v227, v221
 v_cvt_pk_bf16_f32 v202, v220, v221
 v_exp_f32 v222, v102
 v_exp_f32 v223, v103
 v_add_f32 v227, v227, v222
 v_add_f32 v227, v227, v223
 v_cvt_pk_bf16_f32 v203, v222, v223
 v_exp_f32 v216, v104
 v_exp_f32 v217, v105
 v_add_f32 v227, v227, v216
 v_add_f32 v227, v227, v217
 v_cvt_pk_bf16_f32 v204, v216, v217
 v_exp_f32 v218, v106
 v_exp_f32 v219, v107
 v_add_f32 v227, v227, v218
 v_add_f32 v227, v227, v219
 v_cvt_pk_bf16_f32 v205, v218, v219
 v_exp_f32 v220, v108
 v_exp_f32 v221, v109
 v_add_f32 v227, v227, v220
 v_add_f32 v227, v227, v221
 v_cvt_pk_bf16_f32 v206, v220, v221
 v_exp_f32 v222, v110
 v_exp_f32 v223, v111
 v_add_f32 v227, v227, v222
 v_add_f32 v227, v227, v223
 v_cvt_pk_bf16_f32 v207, v222, v223
 s_nop 3
 s_branch K2_back17
K2_rare19:
 s_nop 15
 s_nop 15
 v_max3_f32 v232, v112, v113, v114
 v_max3_f32 v232, v232, v115, v116
 v_max3_f32 v232, v232, v117, v118
 v_max3_f32 v232, v232, v119, v120
 v_max3_f32 v232, v232, v121, v122
 v_max3_f32 v232, v232, v123, v124
 v_max3_f32 v232, v232, v125, v126
 v_max_f32 v232, v232, v127
 v_mov_b32 v233, v232
 s_nop 1
 v_permlane32_swap_b32 v232, v233
 v_max_f32 v232, v232, v233
 v_max_f32 v232, 0, v232
 v_sub_f32 v112, v112, v232
 v_sub_f32 v113, v113, v232
 v_sub_f32 v114, v114, v232
 v_sub_f32 v115, v115, v232
 v_sub_f32 v116, v116, v232
 v_sub_f32 v117, v117, v232
 v_sub_f32 v118, v118, v232
 v_sub_f32 v119, v119, v232
 v_sub_f32 v120, v120, v232
 v_sub_f32 v121, v121, v232
 v_sub_f32 v122, v122, v232
 v_sub_f32 v123, v123, v232
 v_sub_f32 v124, v124, v232
 v_sub_f32 v125, v125, v232
 v_sub_f32 v126, v126, v232
 v_sub_f32 v127, v127, v232
 v_sub_f32 v144, v144, v232
 v_sub_f32 v145, v145, v232
 v_sub_f32 v146, v146, v232
 v_sub_f32 v147, v147, v232
 v_sub_f32 v148, v148, v232
 v_sub_f32 v149, v149, v232
 v_sub_f32 v150, v150, v232
 v_sub_f32 v151, v151, v232
 v_sub_f32 v152, v152, v232
 v_sub_f32 v153, v153, v232
 v_sub_f32 v154, v154, v232
 v_sub_f32 v155, v155, v232
 v_sub_f32 v156, v156, v232
 v_sub_f32 v157, v157, v232
 v_sub_f32 v158, v158, v232
 v_sub_f32 v159, v159, v232
 v_exp_f32 v233, -v232
 s_nop 0
 v_mul_f32 v228, v228, v233
 v_accvgpr_read_b32 v236, a0
 v_accvgpr_read_b32 v237, a1
 v_accvgpr_read_b32 v238, a2
 v_accvgpr_read_b32 v239, a3
 v_mul_f32 v236, v236, v233
 v_mul_f32 v237, v237, v233
 v_mul_f32 v238, v238, v233
 v_mul_f32 v239, v239, v233
 v_accvgpr_write_b32 a0, v236
 v_accvgpr_write_b32 a1, v237
 v_accvgpr_write_b32 a2, v238
 v_accvgpr_write_b32 a3, v239
 v_accvgpr_read_b32 v236, a4
 v_accvgpr_read_b32 v237, a5
 v_accvgpr_read_b32 v238, a6
 v_accvgpr_read_b32 v239, a7
 v_mul_f32 v236, v236, v233
 v_mul_f32 v237, v237, v233
 v_mul_f32 v238, v238, v233
 v_mul_f32 v239, v239, v233
 v_accvgpr_write_b32 a4, v236
 v_accvgpr_write_b32 a5, v237
 v_accvgpr_write_b32 a6, v238
 v_accvgpr_write_b32 a7, v239
 v_accvgpr_read_b32 v236, a8
 v_accvgpr_read_b32 v237, a9
 v_accvgpr_read_b32 v238, a10
 v_accvgpr_read_b32 v239, a11
 v_mul_f32 v236, v236, v233
 v_mul_f32 v237, v237, v233
 v_mul_f32 v238, v238, v233
 v_mul_f32 v239, v239, v233
 v_accvgpr_write_b32 a8, v236
 v_accvgpr_write_b32 a9, v237
 v_accvgpr_write_b32 a10, v238
 v_accvgpr_write_b32 a11, v239
 v_accvgpr_read_b32 v236, a12
 v_accvgpr_read_b32 v237, a13
 v_accvgpr_read_b32 v238, a14
 v_accvgpr_read_b32 v239, a15
 v_mul_f32 v236, v236, v233
 v_mul_f32 v237, v237, v233
 v_mul_f32 v238, v238, v233
 v_mul_f32 v239, v239, v233
 v_accvgpr_write_b32 a12, v236
 v_accvgpr_write_b32 a13, v237
 v_accvgpr_write_b32 a14, v238
 v_accvgpr_write_b32 a15, v239
 v_accvgpr_read_b32 v236, a16
 v_accvgpr_read_b32 v237, a17
 v_accvgpr_read_b32 v238, a18
 v_accvgpr_read_b32 v239, a19
 v_mul_f32 v236, v236, v233
 v_mul_f32 v237, v237, v233
 v_mul_f32 v238, v238, v233
 v_mul_f32 v239, v239, v233
 v_accvgpr_write_b32 a16, v236
 v_accvgpr_write_b32 a17, v237
 v_accvgpr_write_b32 a18, v238
 v_accvgpr_write_b32 a19, v239
 v_accvgpr_read_b32 v236, a20
 v_accvgpr_read_b32 v237, a21
 v_accvgpr_read_b32 v238, a22
 v_accvgpr_read_b32 v239, a23
 v_mul_f32 v236, v236, v233
 v_mul_f32 v237, v237, v233
 v_mul_f32 v238, v238, v233
 v_mul_f32 v239, v239, v233
 v_accvgpr_write_b32 a20, v236
 v_accvgpr_write_b32 a21, v237
 v_accvgpr_write_b32 a22, v238
 v_accvgpr_write_b32 a23, v239
 v_accvgpr_read_b32 v236, a24
 v_accvgpr_read_b32 v237, a25
 v_accvgpr_read_b32 v238, a26
 v_accvgpr_read_b32 v239, a27
 v_mul_f32 v236, v236, v233
 v_mul_f32 v237, v237, v233
 v_mul_f32 v238, v238, v233
 v_mul_f32 v239, v239, v233
 v_accvgpr_write_b32 a24, v236
 v_accvgpr_write_b32 a25, v237
 v_accvgpr_write_b32 a26, v238
 v_accvgpr_write_b32 a27, v239
 v_accvgpr_read_b32 v236, a28
 v_accvgpr_read_b32 v237, a29
 v_accvgpr_read_b32 v238, a30
 v_accvgpr_read_b32 v239, a31
 v_mul_f32 v236, v236, v233
 v_mul_f32 v237, v237, v233
 v_mul_f32 v238, v238, v233
 v_mul_f32 v239, v239, v233
 v_accvgpr_write_b32 a28, v236
 v_accvgpr_write_b32 a29, v237
 v_accvgpr_write_b32 a30, v238
 v_accvgpr_write_b32 a31, v239
 v_accvgpr_read_b32 v236, a32
 v_accvgpr_read_b32 v237, a33
 v_accvgpr_read_b32 v238, a34
 v_accvgpr_read_b32 v239, a35
 v_mul_f32 v236, v236, v233
 v_mul_f32 v237, v237, v233
 v_mul_f32 v238, v238, v233
 v_mul_f32 v239, v239, v233
 v_accvgpr_write_b32 a32, v236
 v_accvgpr_write_b32 a33, v237
 v_accvgpr_write_b32 a34, v238
 v_accvgpr_write_b32 a35, v239
 v_accvgpr_read_b32 v236, a36
 v_accvgpr_read_b32 v237, a37
 v_accvgpr_read_b32 v238, a38
 v_accvgpr_read_b32 v239, a39
 v_mul_f32 v236, v236, v233
 v_mul_f32 v237, v237, v233
 v_mul_f32 v238, v238, v233
 v_mul_f32 v239, v239, v233
 v_accvgpr_write_b32 a36, v236
 v_accvgpr_write_b32 a37, v237
 v_accvgpr_write_b32 a38, v238
 v_accvgpr_write_b32 a39, v239
 v_accvgpr_read_b32 v236, a40
 v_accvgpr_read_b32 v237, a41
 v_accvgpr_read_b32 v238, a42
 v_accvgpr_read_b32 v239, a43
 v_mul_f32 v236, v236, v233
 v_mul_f32 v237, v237, v233
 v_mul_f32 v238, v238, v233
 v_mul_f32 v239, v239, v233
 v_accvgpr_write_b32 a40, v236
 v_accvgpr_write_b32 a41, v237
 v_accvgpr_write_b32 a42, v238
 v_accvgpr_write_b32 a43, v239
 v_accvgpr_read_b32 v236, a44
 v_accvgpr_read_b32 v237, a45
 v_accvgpr_read_b32 v238, a46
 v_accvgpr_read_b32 v239, a47
 v_mul_f32 v236, v236, v233
 v_mul_f32 v237, v237, v233
 v_mul_f32 v238, v238, v233
 v_mul_f32 v239, v239, v233
 v_accvgpr_write_b32 a44, v236
 v_accvgpr_write_b32 a45, v237
 v_accvgpr_write_b32 a46, v238
 v_accvgpr_write_b32 a47, v239
 v_accvgpr_read_b32 v236, a48
 v_accvgpr_read_b32 v237, a49
 v_accvgpr_read_b32 v238, a50
 v_accvgpr_read_b32 v239, a51
 v_mul_f32 v236, v236, v233
 v_mul_f32 v237, v237, v233
 v_mul_f32 v238, v238, v233
 v_mul_f32 v239, v239, v233
 v_accvgpr_write_b32 a48, v236
 v_accvgpr_write_b32 a49, v237
 v_accvgpr_write_b32 a50, v238
 v_accvgpr_write_b32 a51, v239
 v_accvgpr_read_b32 v236, a52
 v_accvgpr_read_b32 v237, a53
 v_accvgpr_read_b32 v238, a54
 v_accvgpr_read_b32 v239, a55
 v_mul_f32 v236, v236, v233
 v_mul_f32 v237, v237, v233
 v_mul_f32 v238, v238, v233
 v_mul_f32 v239, v239, v233
 v_accvgpr_write_b32 a52, v236
 v_accvgpr_write_b32 a53, v237
 v_accvgpr_write_b32 a54, v238
 v_accvgpr_write_b32 a55, v239
 v_accvgpr_read_b32 v236, a56
 v_accvgpr_read_b32 v237, a57
 v_accvgpr_read_b32 v238, a58
 v_accvgpr_read_b32 v239, a59
 v_mul_f32 v236, v236, v233
 v_mul_f32 v237, v237, v233
 v_mul_f32 v238, v238, v233
 v_mul_f32 v239, v239, v233
 v_accvgpr_write_b32 a56, v236
 v_accvgpr_write_b32 a57, v237
 v_accvgpr_write_b32 a58, v238
 v_accvgpr_write_b32 a59, v239
 v_accvgpr_read_b32 v236, a60
 v_accvgpr_read_b32 v237, a61
 v_accvgpr_read_b32 v238, a62
 v_accvgpr_read_b32 v239, a63
 v_mul_f32 v236, v236, v233
 v_mul_f32 v237, v237, v233
 v_mul_f32 v238, v238, v233
 v_mul_f32 v239, v239, v233
 v_accvgpr_write_b32 a60, v236
 v_accvgpr_write_b32 a61, v237
 v_accvgpr_write_b32 a62, v238
 v_accvgpr_write_b32 a63, v239
 v_exp_f32 v208, v112
 v_exp_f32 v209, v113
 s_nop 0
 v_add_f32 v226, v208, v209
 v_cvt_pk_bf16_f32 v192, v208, v209
 v_exp_f32 v210, v114
 v_exp_f32 v211, v115
 v_add_f32 v226, v226, v210
 v_add_f32 v226, v226, v211
 v_cvt_pk_bf16_f32 v193, v210, v211
 v_exp_f32 v212, v116
 v_exp_f32 v213, v117
 v_add_f32 v226, v226, v212
 v_add_f32 v226, v226, v213
 v_cvt_pk_bf16_f32 v194, v212, v213
 v_exp_f32 v214, v118
 v_exp_f32 v215, v119
 v_add_f32 v226, v226, v214
 v_add_f32 v226, v226, v215
 v_cvt_pk_bf16_f32 v195, v214, v215
 v_exp_f32 v208, v120
 v_exp_f32 v209, v121
 v_add_f32 v226, v226, v208
 v_exp_f32 v210, v122
 v_exp_f32 v211, v123
 v_add_f32 v226, v226, v209
 v_cvt_pk_bf16_f32 v196, v208, v209
 v_exp_f32 v212, v124
 v_exp_f32 v213, v125
 v_exp_f32 v214, v126
 v_add_f32 v226, v226, v210
 v_exp_f32 v215, v127
 v_add_f32 v226, v226, v211
 v_cvt_pk_bf16_f32 v197, v210, v211
 v_add_f32 v226, v226, v212
 v_add_f32 v226, v226, v213
 v_cvt_pk_bf16_f32 v198, v212, v213
 v_add_f32 v226, v226, v214
 v_add_f32 v226, v226, v215
 v_cvt_pk_bf16_f32 v199, v214, v215
 s_nop 3
 s_branch K2_back19
K2_rare20:
 s_nop 15
 s_nop 15
 v_max3_f32 v232, v128, v129, v130
 v_max3_f32 v232, v232, v131, v132
 v_max3_f32 v232, v232, v133, v134
 v_max3_f32 v232, v232, v135, v136
 v_max3_f32 v232, v232, v137, v138
 v_max3_f32 v232, v232, v139, v140
 v_max3_f32 v232, v232, v141, v142
 v_max_f32 v232, v232, v143
 v_mov_b32 v233, v232
 s_nop 1
 v_permlane32_swap_b32 v232, v233
 v_max_f32 v232, v232, v233
 v_max_f32 v232, 0, v232
 v_sub_f32 v128, v128, v232
 v_sub_f32 v129, v129, v232
 v_sub_f32 v130, v130, v232
 v_sub_f32 v131, v131, v232
 v_sub_f32 v132, v132, v232
 v_sub_f32 v133, v133, v232
 v_sub_f32 v134, v134, v232
 v_sub_f32 v135, v135, v232
 v_sub_f32 v136, v136, v232
 v_sub_f32 v137, v137, v232
 v_sub_f32 v138, v138, v232
 v_sub_f32 v139, v139, v232
 v_sub_f32 v140, v140, v232
 v_sub_f32 v141, v141, v232
 v_sub_f32 v142, v142, v232
 v_sub_f32 v143, v143, v232
 v_sub_f32 v80, v80, v232
 v_sub_f32 v81, v81, v232
 v_sub_f32 v82, v82, v232
 v_sub_f32 v83, v83, v232
 v_sub_f32 v84, v84, v232
 v_sub_f32 v85, v85, v232
 v_sub_f32 v86, v86, v232
 v_sub_f32 v87, v87, v232
 v_sub_f32 v88, v88, v232
 v_sub_f32 v89, v89, v232
 v_sub_f32 v90, v90, v232
 v_sub_f32 v91, v91, v232
 v_sub_f32 v92, v92, v232
 v_sub_f32 v93, v93, v232
 v_sub_f32 v94, v94, v232
 v_sub_f32 v95, v95, v232
 v_sub_f32 v96, v96, v232
 v_sub_f32 v97, v97, v232
 v_sub_f32 v98, v98, v232
 v_sub_f32 v99, v99, v232
 v_sub_f32 v100, v100, v232
 v_sub_f32 v101, v101, v232
 v_sub_f32 v102, v102, v232
 v_sub_f32 v103, v103, v232
 v_sub_f32 v104, v104, v232
 v_sub_f32 v105, v105, v232
 v_sub_f32 v106, v106, v232
 v_sub_f32 v107, v107, v232
 v_sub_f32 v108, v108, v232
 v_sub_f32 v109, v109, v232
 v_sub_f32 v110, v110, v232
 v_sub_f32 v111, v111, v232
 v_sub_f32 v160, v160, v232
 v_sub_f32 v161, v161, v232
 v_sub_f32 v162, v162, v232
 v_sub_f32 v163, v163, v232
 v_sub_f32 v164, v164, v232
 v_sub_f32 v165, v165, v232
 v_sub_f32 v166, v166, v232
 v_sub_f32 v167, v167, v232
 v_sub_f32 v168, v168, v232
 v_sub_f32 v169, v169, v232
 v_sub_f32 v170, v170, v232
 v_sub_f32 v171, v171, v232
 v_sub_f32 v172, v172, v232
 v_sub_f32 v173, v173, v232
 v_sub_f32 v174, v174, v232
 v_sub_f32 v175, v175, v232
 v_sub_f32 v176, v176, v232
 v_sub_f32 v177, v177, v232
 v_sub_f32 v178, v178, v232
 v_sub_f32 v179, v179, v232
 v_sub_f32 v180, v180, v232
 v_sub_f32 v181, v181, v232
 v_sub_f32 v182, v182, v232
 v_sub_f32 v183, v183, v232
 v_sub_f32 v184, v184, v232
 v_sub_f32 v185, v185, v232
 v_sub_f32 v186, v186, v232
 v_sub_f32 v187, v187, v232
 v_sub_f32 v188, v188, v232
 v_sub_f32 v189, v189, v232
 v_sub_f32 v190, v190, v232
 v_sub_f32 v191, v191, v232
 v_exp_f32 v233, -v232
 s_nop 0
 v_mul_f32 v229, v229, v233
 v_accvgpr_read_b32 v236, a64
 v_accvgpr_read_b32 v237, a65
 v_accvgpr_read_b32 v238, a66
 v_accvgpr_read_b32 v239, a67
 v_mul_f32 v236, v236, v233
 v_mul_f32 v237, v237, v233
 v_mul_f32 v238, v238, v233
 v_mul_f32 v239, v239, v233
 v_accvgpr_write_b32 a64, v236
 v_accvgpr_write_b32 a65, v237
 v_accvgpr_write_b32 a66, v238
 v_accvgpr_write_b32 a67, v239
 v_accvgpr_read_b32 v236, a68
 v_accvgpr_read_b32 v237, a69
 v_accvgpr_read_b32 v238, a70
 v_accvgpr_read_b32 v239, a71
 v_mul_f32 v236, v236, v233
 v_mul_f32 v237, v237, v233
 v_mul_f32 v238, v238, v233
 v_mul_f32 v239, v239, v233
 v_accvgpr_write_b32 a68, v236
 v_accvgpr_write_b32 a69, v237
 v_accvgpr_write_b32 a70, v238
 v_accvgpr_write_b32 a71, v239
 v_accvgpr_read_b32 v236, a72
 v_accvgpr_read_b32 v237, a73
 v_accvgpr_read_b32 v238, a74
 v_accvgpr_read_b32 v239, a75
 v_mul_f32 v236, v236, v233
 v_mul_f32 v237, v237, v233
 v_mul_f32 v238, v238, v233
 v_mul_f32 v239, v239, v233
 v_accvgpr_write_b32 a72, v236
 v_accvgpr_write_b32 a73, v237
 v_accvgpr_write_b32 a74, v238
 v_accvgpr_write_b32 a75, v239
 v_accvgpr_read_b32 v236, a76
 v_accvgpr_read_b32 v237, a77
 v_accvgpr_read_b32 v238, a78
 v_accvgpr_read_b32 v239, a79
 v_mul_f32 v236, v236, v233
 v_mul_f32 v237, v237, v233
 v_mul_f32 v238, v238, v233
 v_mul_f32 v239, v239, v233
 v_accvgpr_write_b32 a76, v236
 v_accvgpr_write_b32 a77, v237
 v_accvgpr_write_b32 a78, v238
 v_accvgpr_write_b32 a79, v239
 v_accvgpr_read_b32 v236, a80
 v_accvgpr_read_b32 v237, a81
 v_accvgpr_read_b32 v238, a82
 v_accvgpr_read_b32 v239, a83
 v_mul_f32 v236, v236, v233
 v_mul_f32 v237, v237, v233
 v_mul_f32 v238, v238, v233
 v_mul_f32 v239, v239, v233
 v_accvgpr_write_b32 a80, v236
 v_accvgpr_write_b32 a81, v237
 v_accvgpr_write_b32 a82, v238
 v_accvgpr_write_b32 a83, v239
 v_accvgpr_read_b32 v236, a84
 v_accvgpr_read_b32 v237, a85
 v_accvgpr_read_b32 v238, a86
 v_accvgpr_read_b32 v239, a87
 v_mul_f32 v236, v236, v233
 v_mul_f32 v237, v237, v233
 v_mul_f32 v238, v238, v233
 v_mul_f32 v239, v239, v233
 v_accvgpr_write_b32 a84, v236
 v_accvgpr_write_b32 a85, v237
 v_accvgpr_write_b32 a86, v238
 v_accvgpr_write_b32 a87, v239
 v_accvgpr_read_b32 v236, a88
 v_accvgpr_read_b32 v237, a89
 v_accvgpr_read_b32 v238, a90
 v_accvgpr_read_b32 v239, a91
 v_mul_f32 v236, v236, v233
 v_mul_f32 v237, v237, v233
 v_mul_f32 v238, v238, v233
 v_mul_f32 v239, v239, v233
 v_accvgpr_write_b32 a88, v236
 v_accvgpr_write_b32 a89, v237
 v_accvgpr_write_b32 a90, v238
 v_accvgpr_write_b32 a91, v239
 v_accvgpr_read_b32 v236, a92
 v_accvgpr_read_b32 v237, a93
 v_accvgpr_read_b32 v238, a94
 v_accvgpr_read_b32 v239, a95
 v_mul_f32 v236, v236, v233
 v_mul_f32 v237, v237, v233
 v_mul_f32 v238, v238, v233
 v_mul_f32 v239, v239, v233
 v_accvgpr_write_b32 a92, v236
 v_accvgpr_write_b32 a93, v237
 v_accvgpr_write_b32 a94, v238
 v_accvgpr_write_b32 a95, v239
 v_accvgpr_read_b32 v236, a96
 v_accvgpr_read_b32 v237, a97
 v_accvgpr_read_b32 v238, a98
 v_accvgpr_read_b32 v239, a99
 v_mul_f32 v236, v236, v233
 v_mul_f32 v237, v237, v233
 v_mul_f32 v238, v238, v233
 v_mul_f32 v239, v239, v233
 v_accvgpr_write_b32 a96, v236
 v_accvgpr_write_b32 a97, v237
 v_accvgpr_write_b32 a98, v238
 v_accvgpr_write_b32 a99, v239
 v_accvgpr_read_b32 v236, a100
 v_accvgpr_read_b32 v237, a101
 v_accvgpr_read_b32 v238, a102
 v_accvgpr_read_b32 v239, a103
 v_mul_f32 v236, v236, v233
 v_mul_f32 v237, v237, v233
 v_mul_f32 v238, v238, v233
 v_mul_f32 v239, v239, v233
 v_accvgpr_write_b32 a100, v236
 v_accvgpr_write_b32 a101, v237
 v_accvgpr_write_b32 a102, v238
 v_accvgpr_write_b32 a103, v239
 v_accvgpr_read_b32 v236, a104
 v_accvgpr_read_b32 v237, a105
 v_accvgpr_read_b32 v238, a106
 v_accvgpr_read_b32 v239, a107
 v_mul_f32 v236, v236, v233
 v_mul_f32 v237, v237, v233
 v_mul_f32 v238, v238, v233
 v_mul_f32 v239, v239, v233
 v_accvgpr_write_b32 a104, v236
 v_accvgpr_write_b32 a105, v237
 v_accvgpr_write_b32 a106, v238
 v_accvgpr_write_b32 a107, v239
 v_accvgpr_read_b32 v236, a108
 v_accvgpr_read_b32 v237, a109
 v_accvgpr_read_b32 v238, a110
 v_accvgpr_read_b32 v239, a111
 v_mul_f32 v236, v236, v233
 v_mul_f32 v237, v237, v233
 v_mul_f32 v238, v238, v233
 v_mul_f32 v239, v239, v233
 v_accvgpr_write_b32 a108, v236
 v_accvgpr_write_b32 a109, v237
 v_accvgpr_write_b32 a110, v238
 v_accvgpr_write_b32 a111, v239
 v_accvgpr_read_b32 v236, a112
 v_accvgpr_read_b32 v237, a113
 v_accvgpr_read_b32 v238, a114
 v_accvgpr_read_b32 v239, a115
 v_mul_f32 v236, v236, v233
 v_mul_f32 v237, v237, v233
 v_mul_f32 v238, v238, v233
 v_mul_f32 v239, v239, v233
 v_accvgpr_write_b32 a112, v236
 v_accvgpr_write_b32 a113, v237
 v_accvgpr_write_b32 a114, v238
 v_accvgpr_write_b32 a115, v239
 v_accvgpr_read_b32 v236, a116
 v_accvgpr_read_b32 v237, a117
 v_accvgpr_read_b32 v238, a118
 v_accvgpr_read_b32 v239, a119
 v_mul_f32 v236, v236, v233
 v_mul_f32 v237, v237, v233
 v_mul_f32 v238, v238, v233
 v_mul_f32 v239, v239, v233
 v_accvgpr_write_b32 a116, v236
 v_accvgpr_write_b32 a117, v237
 v_accvgpr_write_b32 a118, v238
 v_accvgpr_write_b32 a119, v239
 v_accvgpr_read_b32 v236, a120
 v_accvgpr_read_b32 v237, a121
 v_accvgpr_read_b32 v238, a122
 v_accvgpr_read_b32 v239, a123
 v_mul_f32 v236, v236, v233
 v_mul_f32 v237, v237, v233
 v_mul_f32 v238, v238, v233
 v_mul_f32 v239, v239, v233
 v_accvgpr_write_b32 a120, v236
 v_accvgpr_write_b32 a121, v237
 v_accvgpr_write_b32 a122, v238
 v_accvgpr_write_b32 a123, v239
 v_accvgpr_read_b32 v236, a124
 v_accvgpr_read_b32 v237, a125
 v_accvgpr_read_b32 v238, a126
 v_accvgpr_read_b32 v239, a127
 v_mul_f32 v236, v236, v233
 v_mul_f32 v237, v237, v233
 v_mul_f32 v238, v238, v233
 v_mul_f32 v239, v239, v233
 v_accvgpr_write_b32 a124, v236
 v_accvgpr_write_b32 a125, v237
 v_accvgpr_write_b32 a126, v238
 v_accvgpr_write_b32 a127, v239
 v_exp_f32 v216, v128
 v_exp_f32 v217, v129
 v_exp_f32 v218, v130
 v_exp_f32 v219, v131
 v_exp_f32 v220, v132
 v_exp_f32 v221, v133
 v_add_f32 v227, v216, v217
 v_cvt_pk_bf16_f32 v200, v216, v217
 v_exp_f32 v222, v134
 v_exp_f32 v223, v135
 v_add_f32 v227, v227, v218
 v_add_f32 v227, v227, v219
 v_cvt_pk_bf16_f32 v201, v218, v219
 v_exp_f32 v216, v136
 v_exp_f32 v217, v137
 v_add_f32 v227, v227, v220
 v_add_f32 v227, v227, v221
 v_cvt_pk_bf16_f32 v202, v220, v221
 v_exp_f32 v218, v138
 v_add_f32 v227, v227, v222
 v_exp_f32 v219, v139
 v_add_f32 v227, v227, v223
 v_cvt_pk_bf16_f32 v203, v222, v223
 v_exp_f32 v220, v140
 v_add_f32 v227, v227, v216
 v_exp_f32 v221, v141
 v_add_f32 v227, v227, v217
 v_cvt_pk_bf16_f32 v204, v216, v217
 v_exp_f32 v222, v142
 v_exp_f32 v223, v143
 v_add_f32 v227, v227, v218
 v_add_f32 v227, v227, v219
 v_cvt_pk_bf16_f32 v205, v218, v219
 v_add_f32 v227, v227, v220
 v_add_f32 v227, v227, v221
 v_cvt_pk_bf16_f32 v206, v220, v221
 v_add_f32 v227, v227, v222
 v_add_f32 v227, v227, v223
 v_cvt_pk_bf16_f32 v207, v222, v223
 v_exp_f32 v208, v80
 s_nop 3
 s_branch K2_back20
K2_rare22:
 s_nop 15
 s_nop 15
 v_max3_f32 v232, v80, v81, v82
 v_max3_f32 v232, v232, v83, v84
 v_max3_f32 v232, v232, v85, v86
 v_max3_f32 v232, v232, v87, v88
 v_max3_f32 v232, v232, v89, v90
 v_max3_f32 v232, v232, v91, v92
 v_max3_f32 v232, v232, v93, v94
 v_max_f32 v232, v232, v95
 v_mov_b32 v233, v232
 s_nop 1
 v_permlane32_swap_b32 v232, v233
 v_max_f32 v232, v232, v233
 v_max_f32 v232, 0, v232
 v_sub_f32 v80, v80, v232
 v_sub_f32 v81, v81, v232
 v_sub_f32 v82, v82, v232
 v_sub_f32 v83, v83, v232
 v_sub_f32 v84, v84, v232
 v_sub_f32 v85, v85, v232
 v_sub_f32 v86, v86, v232
 v_sub_f32 v87, v87, v232
 v_sub_f32 v88, v88, v232
 v_sub_f32 v89, v89, v232
 v_sub_f32 v90, v90, v232
 v_sub_f32 v91, v91, v232
 v_sub_f32 v92, v92, v232
 v_sub_f32 v93, v93, v232
 v_sub_f32 v94, v94, v232
 v_sub_f32 v95, v95, v232
 v_sub_f32 v96, v96, v232
 v_sub_f32 v97, v97, v232
 v_sub_f32 v98, v98, v232
 v_sub_f32 v99, v99, v232
 v_sub_f32 v100, v100, v232
 v_sub_f32 v101, v101, v232
 v_sub_f32 v102, v102, v232
 v_sub_f32 v103, v103, v232
 v_sub_f32 v104, v104, v232
 v_sub_f32 v105, v105, v232
 v_sub_f32 v106, v106, v232
 v_sub_f32 v107, v107, v232
 v_sub_f32 v108, v108, v232
 v_sub_f32 v109, v109, v232
 v_sub_f32 v110, v110, v232
 v_sub_f32 v111, v111, v232
 v_sub_f32 v112, v112, v232
 v_sub_f32 v113, v113, v232
 v_sub_f32 v114, v114, v232
 v_sub_f32 v115, v115, v232
 v_sub_f32 v116, v116, v232
 v_sub_f32 v117, v117, v232
 v_sub_f32 v118, v118, v232
 v_sub_f32 v119, v119, v232
 v_sub_f32 v120, v120, v232
 v_sub_f32 v121, v121, v232
 v_sub_f32 v122, v122, v232
 v_sub_f32 v123, v123, v232
 v_sub_f32 v124, v124, v232
 v_sub_f32 v125, v125, v232
 v_sub_f32 v126, v126, v232
 v_sub_f32 v127, v127, v232
 v_sub_f32 v128, v128, v232
 v_sub_f32 v129, v129, v232
 v_sub_f32 v130, v130, v232
 v_sub_f32 v131, v131, v232
 v_sub_f32 v132, v132, v232
 v_sub_f32 v133, v133, v232
 v_sub_f32 v134, v134, v232
 v_sub_f32 v135, v135, v232
 v_sub_f32 v136, v136, v232
 v_sub_f32 v137, v137, v232
 v_sub_f32 v138, v138, v232
 v_sub_f32 v139, v139, v232
 v_sub_f32 v140, v140, v232
 v_sub_f32 v141, v141, v232
 v_sub_f32 v142, v142, v232
 v_sub_f32 v143, v143, v232
 v_sub_f32 v160, v160, v232
 v_sub_f32 v161, v161, v232
 v_sub_f32 v162, v162, v232
 v_sub_f32 v163, v163, v232
 v_sub_f32 v164, v164, v232
 v_sub_f32 v165, v165, v232
 v_sub_f32 v166, v166, v232
 v_sub_f32 v167, v167, v232
 v_sub_f32 v168, v168, v232
 v_sub_f32 v169, v169, v232
 v_sub_f32 v170, v170, v232
 v_sub_f32 v171, v171, v232
 v_sub_f32 v172, v172, v232
 v_sub_f32 v173, v173, v232
 v_sub_f32 v174, v174, v232
 v_sub_f32 v175, v175, v232
 v_sub_f32 v176, v176, v232
 v_sub_f32 v177, v177, v232
 v_sub_f32 v178, v178, v232
 v_sub_f32 v179, v179, v232
 v_sub_f32 v180, v180, v232
 v_sub_f32 v181, v181, v232
 v_sub_f32 v182, v182, v232
 v_sub_f32 v183, v183, v232
 v_sub_f32 v184, v184, v232
 v_sub_f32 v185, v185, v232
 v_sub_f32 v186, v186, v232
 v_sub_f32 v187, v187, v232
 v_sub_f32 v188, v188, v232
 v_sub_f32 v189, v189, v232
 v_sub_f32 v190, v190, v232
 v_sub_f32 v191, v191, v232
 v_exp_f32 v233, -v232
 s_nop 0
 v_mul_f32 v229, v229, v233
 v_accvgpr_read_b32 v236, a64
 v_accvgpr_read_b32 v237, a65
 v_accvgpr_read_b32 v238, a66
 v_accvgpr_read_b32 v239, a67
 v_mul_f32 v236, v236, v233
 v_mul_f32 v237, v237, v233
 v_mul_f32 v238, v238, v233
 v_mul_f32 v239, v239, v233
 v_accvgpr_write_b32 a64, v236
 v_accvgpr_write_b32 a65, v237
 v_accvgpr_write_b32 a66, v238
 v_accvgpr_write_b32 a67, v239
 v_accvgpr_read_b32 v236, a68
 v_accvgpr_read_b32 v237, a69
 v_accvgpr_read_b32 v238, a70
 v_accvgpr_read_b32 v239, a71
 v_mul_f32 v236, v236, v233
 v_mul_f32 v237, v237, v233
 v_mul_f32 v238, v238, v233
 v_mul_f32 v239, v239, v233
 v_accvgpr_write_b32 a68, v236
 v_accvgpr_write_b32 a69, v237
 v_accvgpr_write_b32 a70, v238
 v_accvgpr_write_b32 a71, v239
 v_accvgpr_read_b32 v236, a72
 v_accvgpr_read_b32 v237, a73
 v_accvgpr_read_b32 v238, a74
 v_accvgpr_read_b32 v239, a75
 v_mul_f32 v236, v236, v233
 v_mul_f32 v237, v237, v233
 v_mul_f32 v238, v238, v233
 v_mul_f32 v239, v239, v233
 v_accvgpr_write_b32 a72, v236
 v_accvgpr_write_b32 a73, v237
 v_accvgpr_write_b32 a74, v238
 v_accvgpr_write_b32 a75, v239
 v_accvgpr_read_b32 v236, a76
 v_accvgpr_read_b32 v237, a77
 v_accvgpr_read_b32 v238, a78
 v_accvgpr_read_b32 v239, a79
 v_mul_f32 v236, v236, v233
 v_mul_f32 v237, v237, v233
 v_mul_f32 v238, v238, v233
 v_mul_f32 v239, v239, v233
 v_accvgpr_write_b32 a76, v236
 v_accvgpr_write_b32 a77, v237
 v_accvgpr_write_b32 a78, v238
 v_accvgpr_write_b32 a79, v239
 v_accvgpr_read_b32 v236, a80
 v_accvgpr_read_b32 v237, a81
 v_accvgpr_read_b32 v238, a82
 v_accvgpr_read_b32 v239, a83
 v_mul_f32 v236, v236, v233
 v_mul_f32 v237, v237, v233
 v_mul_f32 v238, v238, v233
 v_mul_f32 v239, v239, v233
 v_accvgpr_write_b32 a80, v236
 v_accvgpr_write_b32 a81, v237
 v_accvgpr_write_b32 a82, v238
 v_accvgpr_write_b32 a83, v239
 v_accvgpr_read_b32 v236, a84
 v_accvgpr_read_b32 v237, a85
 v_accvgpr_read_b32 v238, a86
 v_accvgpr_read_b32 v239, a87
 v_mul_f32 v236, v236, v233
 v_mul_f32 v237, v237, v233
 v_mul_f32 v238, v238, v233
 v_mul_f32 v239, v239, v233
 v_accvgpr_write_b32 a84, v236
 v_accvgpr_write_b32 a85, v237
 v_accvgpr_write_b32 a86, v238
 v_accvgpr_write_b32 a87, v239
 v_accvgpr_read_b32 v236, a88
 v_accvgpr_read_b32 v237, a89
 v_accvgpr_read_b32 v238, a90
 v_accvgpr_read_b32 v239, a91
 v_mul_f32 v236, v236, v233
 v_mul_f32 v237, v237, v233
 v_mul_f32 v238, v238, v233
 v_mul_f32 v239, v239, v233
 v_accvgpr_write_b32 a88, v236
 v_accvgpr_write_b32 a89, v237
 v_accvgpr_write_b32 a90, v238
 v_accvgpr_write_b32 a91, v239
 v_accvgpr_read_b32 v236, a92
 v_accvgpr_read_b32 v237, a93
 v_accvgpr_read_b32 v238, a94
 v_accvgpr_read_b32 v239, a95
 v_mul_f32 v236, v236, v233
 v_mul_f32 v237, v237, v233
 v_mul_f32 v238, v238, v233
 v_mul_f32 v239, v239, v233
 v_accvgpr_write_b32 a92, v236
 v_accvgpr_write_b32 a93, v237
 v_accvgpr_write_b32 a94, v238
 v_accvgpr_write_b32 a95, v239
 v_accvgpr_read_b32 v236, a96
 v_accvgpr_read_b32 v237, a97
 v_accvgpr_read_b32 v238, a98
 v_accvgpr_read_b32 v239, a99
 v_mul_f32 v236, v236, v233
 v_mul_f32 v237, v237, v233
 v_mul_f32 v238, v238, v233
 v_mul_f32 v239, v239, v233
 v_accvgpr_write_b32 a96, v236
 v_accvgpr_write_b32 a97, v237
 v_accvgpr_write_b32 a98, v238
 v_accvgpr_write_b32 a99, v239
 v_accvgpr_read_b32 v236, a100
 v_accvgpr_read_b32 v237, a101
 v_accvgpr_read_b32 v238, a102
 v_accvgpr_read_b32 v239, a103
 v_mul_f32 v236, v236, v233
 v_mul_f32 v237, v237, v233
 v_mul_f32 v238, v238, v233
 v_mul_f32 v239, v239, v233
 v_accvgpr_write_b32 a100, v236
 v_accvgpr_write_b32 a101, v237
 v_accvgpr_write_b32 a102, v238
 v_accvgpr_write_b32 a103, v239
 v_accvgpr_read_b32 v236, a104
 v_accvgpr_read_b32 v237, a105
 v_accvgpr_read_b32 v238, a106
 v_accvgpr_read_b32 v239, a107
 v_mul_f32 v236, v236, v233
 v_mul_f32 v237, v237, v233
 v_mul_f32 v238, v238, v233
 v_mul_f32 v239, v239, v233
 v_accvgpr_write_b32 a104, v236
 v_accvgpr_write_b32 a105, v237
 v_accvgpr_write_b32 a106, v238
 v_accvgpr_write_b32 a107, v239
 v_accvgpr_read_b32 v236, a108
 v_accvgpr_read_b32 v237, a109
 v_accvgpr_read_b32 v238, a110
 v_accvgpr_read_b32 v239, a111
 v_mul_f32 v236, v236, v233
 v_mul_f32 v237, v237, v233
 v_mul_f32 v238, v238, v233
 v_mul_f32 v239, v239, v233
 v_accvgpr_write_b32 a108, v236
 v_accvgpr_write_b32 a109, v237
 v_accvgpr_write_b32 a110, v238
 v_accvgpr_write_b32 a111, v239
 v_accvgpr_read_b32 v236, a112
 v_accvgpr_read_b32 v237, a113
 v_accvgpr_read_b32 v238, a114
 v_accvgpr_read_b32 v239, a115
 v_mul_f32 v236, v236, v233
 v_mul_f32 v237, v237, v233
 v_mul_f32 v238, v238, v233
 v_mul_f32 v239, v239, v233
 v_accvgpr_write_b32 a112, v236
 v_accvgpr_write_b32 a113, v237
 v_accvgpr_write_b32 a114, v238
 v_accvgpr_write_b32 a115, v239
 v_accvgpr_read_b32 v236, a116
 v_accvgpr_read_b32 v237, a117
 v_accvgpr_read_b32 v238, a118
 v_accvgpr_read_b32 v239, a119
 v_mul_f32 v236, v236, v233
 v_mul_f32 v237, v237, v233
 v_mul_f32 v238, v238, v233
 v_mul_f32 v239, v239, v233
 v_accvgpr_write_b32 a116, v236
 v_accvgpr_write_b32 a117, v237
 v_accvgpr_write_b32 a118, v238
 v_accvgpr_write_b32 a119, v239
 v_accvgpr_read_b32 v236, a120
 v_accvgpr_read_b32 v237, a121
 v_accvgpr_read_b32 v238, a122
 v_accvgpr_read_b32 v239, a123
 v_mul_f32 v236, v236, v233
 v_mul_f32 v237, v237, v233
 v_mul_f32 v238, v238, v233
 v_mul_f32 v239, v239, v233
 v_accvgpr_write_b32 a120, v236
 v_accvgpr_write_b32 a121, v237
 v_accvgpr_write_b32 a122, v238
 v_accvgpr_write_b32 a123, v239
 v_accvgpr_read_b32 v236, a124
 v_accvgpr_read_b32 v237, a125
 v_accvgpr_read_b32 v238, a126
 v_accvgpr_read_b32 v239, a127
 v_mul_f32 v236, v236, v233
 v_mul_f32 v237, v237, v233
 v_mul_f32 v238, v238, v233
 v_mul_f32 v239, v239, v233
 v_accvgpr_write_b32 a124, v236
 v_accvgpr_write_b32 a125, v237
 v_accvgpr_write_b32 a126, v238
 v_accvgpr_write_b32 a127, v239
 v_exp_f32 v208, v80
 v_exp_f32 v209, v81
 s_nop 0
 v_add_f32 v226, v208, v209
 v_cvt_pk_bf16_f32 v192, v208, v209
 v_exp_f32 v210, v82
 v_exp_f32 v211, v83
 v_add_f32 v226, v226, v210
 v_add_f32 v226, v226, v211
 v_cvt_pk_bf16_f32 v193, v210, v211
 v_exp_f32 v212, v84
 v_exp_f32 v213, v85
 v_add_f32 v226, v226, v212
 v_add_f32 v226, v226, v213
 v_cvt_pk_bf16_f32 v194, v212, v213
 v_exp_f32 v214, v86
 v_exp_f32 v215, v87
 v_add_f32 v226, v226, v214
 v_add_f32 v226, v226, v215
 v_cvt_pk_bf16_f32 v195, v214, v215
 v_exp_f32 v208, v88
 v_exp_f32 v209, v89
 v_add_f32 v226, v226, v208
 v_add_f32 v226, v226, v209
 v_exp_f32 v210, v90
 v_cvt_pk_bf16_f32 v196, v208, v209
 v_exp_f32 v211, v91
 v_add_f32 v226, v226, v210
 v_exp_f32 v212, v92
 v_add_f32 v226, v226, v211
 v_cvt_pk_bf16_f32 v197, v210, v211
 v_exp_f32 v213, v93
 v_add_f32 v226, v226, v212
 v_exp_f32 v214, v94
 v_add_f32 v226, v226, v213
 v_exp_f32 v215, v95
 v_cvt_pk_bf16_f32 v198, v212, v213
 v_add_f32 v226, v226, v214
 v_add_f32 v226, v226, v215
 v_cvt_pk_bf16_f32 v199, v214, v215
 v_exp_f32 v216, v96
 s_nop 3
 s_branch K2_back22
K2_rare23:
 s_nop 15
 s_nop 15
 v_max3_f32 v232, v96, v97, v98
 v_max3_f32 v232, v232, v99, v100
 v_max3_f32 v232, v232, v101, v102
 v_max3_f32 v232, v232, v103, v104
 v_max3_f32 v232, v232, v105, v106
 v_max3_f32 v232, v232, v107, v108
 v_max3_f32 v232, v232, v109, v110
 v_max_f32 v232, v232, v111
 v_mov_b32 v233, v232
 s_nop 1
 v_permlane32_swap_b32 v232, v233
 v_max_f32 v232, v232, v233
 v_max_f32 v232, 0, v232
 v_sub_f32 v96, v96, v232
 v_sub_f32 v97, v97, v232
 v_sub_f32 v98, v98, v232
 v_sub_f32 v99, v99, v232
 v_sub_f32 v100, v100, v232
 v_sub_f32 v101, v101, v232
 v_sub_f32 v102, v102, v232
 v_sub_f32 v103, v103, v232
 v_sub_f32 v104, v104, v232
 v_sub_f32 v105, v105, v232
 v_sub_f32 v106, v106, v232
 v_sub_f32 v107, v107, v232
 v_sub_f32 v108, v108, v232
 v_sub_f32 v109, v109, v232
 v_sub_f32 v110, v110, v232
 v_sub_f32 v111, v111, v232
 v_sub_f32 v80, v80, v232
 v_sub_f32 v81, v81, v232
 v_sub_f32 v82, v82, v232
 v_sub_f32 v83, v83, v232
 v_sub_f32 v84, v84, v232
 v_sub_f32 v85, v85, v232
 v_sub_f32 v86, v86, v232
 v_sub_f32 v87, v87, v232
 v_sub_f32 v88, v88, v232
 v_sub_f32 v89, v89, v232
 v_sub_f32 v90, v90, v232
 v_sub_f32 v91, v91, v232
 v_sub_f32 v92, v92, v232
 v_sub_f32 v93, v93, v232
 v_sub_f32 v94, v94, v232
 v_sub_f32 v95, v95, v232
 v_sub_f32 v112, v112, v232
 v_sub_f32 v113, v113, v232
 v_sub_f32 v114, v114, v232
 v_sub_f32 v115, v115, v232
 v_sub_f32 v116, v116, v232
 v_sub_f32 v117, v117, v232
 v_sub_f32 v118, v118, v232
 v_sub_f32 v119, v119, v232
 v_sub_f32 v120, v120, v232
 v_sub_f32 v121, v121, v232
 v_sub_f32 v122, v122, v232
 v_sub_f32 v123, v123, v232
 v_sub_f32 v124, v124, v232
 v_sub_f32 v125, v125, v232
 v_sub_f32 v126, v126, v232
 v_sub_f32 v127, v127, v232
 v_sub_f32 v128, v128, v232
 v_sub_f32 v129, v129, v232
 v_sub_f32 v130, v130, v232
 v_sub_f32 v131, v131, v232
 v_sub_f32 v132, v132, v232
 v_sub_f32 v133, v133, v232
 v_sub_f32 v134, v134, v232
 v_sub_f32 v135, v135, v232
 v_sub_f32 v136, v136, v232
 v_sub_f32 v137, v137, v232
 v_sub_f32 v138, v138, v232
 v_sub_f32 v139, v139, v232
 v_sub_f32 v140, v140, v232
 v_sub_f32 v141, v141, v232
 v_sub_f32 v142, v142, v232
 v_sub_f32 v143, v143, v232
 v_sub_f32 v160, v160, v232
 v_sub_f32 v161, v161, v232
 v_sub_f32 v162, v162, v232
 v_sub_f32 v163, v163, v232
 v_sub_f32 v164, v164, v232
 v_sub_f32 v165, v165, v232
 v_sub_f32 v166, v166, v232
 v_sub_f32 v167, v167, v232
 v_sub_f32 v168, v168, v232
 v_sub_f32 v169, v169, v232
 v_sub_f32 v170, v170, v232
 v_sub_f32 v171, v171, v232
 v_sub_f32 v172, v172, v232
 v_sub_f32 v173, v173, v232
 v_sub_f32 v174, v174, v232
 v_sub_f32 v175, v175, v232
 v_sub_f32 v176, v176, v232
 v_sub_f32 v177, v177, v232
 v_sub_f32 v178, v178, v232
 v_sub_f32 v179, v179, v232
 v_sub_f32 v180, v180, v232
 v_sub_f32 v181, v181, v232
 v_sub_f32 v182, v182, v232
 v_sub_f32 v183, v183, v232
 v_sub_f32 v184, v184, v232
 v_sub_f32 v185, v185, v232
 v_sub_f32 v186, v186, v232
 v_sub_f32 v187, v187, v232
 v_sub_f32 v188, v188, v232
 v_sub_f32 v189, v189, v232
 v_sub_f32 v190, v190, v232
 v_sub_f32 v191, v191, v232
 v_exp_f32 v233, -v232
 s_nop 0
 v_mul_f32 v229, v229, v233
 v_accvgpr_read_b32 v236, a64
 v_accvgpr_read_b32 v237, a65
 v_accvgpr_read_b32 v238, a66
 v_accvgpr_read_b32 v239, a67
 v_mul_f32 v236, v236, v233
 v_mul_f32 v237, v237, v233
 v_mul_f32 v238, v238, v233
 v_mul_f32 v239, v239, v233
 v_accvgpr_write_b32 a64, v236
 v_accvgpr_write_b32 a65, v237
 v_accvgpr_write_b32 a66, v238
 v_accvgpr_write_b32 a67, v239
 v_accvgpr_read_b32 v236, a68
 v_accvgpr_read_b32 v237, a69
 v_accvgpr_read_b32 v238, a70
 v_accvgpr_read_b32 v239, a71
 v_mul_f32 v236, v236, v233
 v_mul_f32 v237, v237, v233
 v_mul_f32 v238, v238, v233
 v_mul_f32 v239, v239, v233
 v_accvgpr_write_b32 a68, v236
 v_accvgpr_write_b32 a69, v237
 v_accvgpr_write_b32 a70, v238
 v_accvgpr_write_b32 a71, v239
 v_accvgpr_read_b32 v236, a72
 v_accvgpr_read_b32 v237, a73
 v_accvgpr_read_b32 v238, a74
 v_accvgpr_read_b32 v239, a75
 v_mul_f32 v236, v236, v233
 v_mul_f32 v237, v237, v233
 v_mul_f32 v238, v238, v233
 v_mul_f32 v239, v239, v233
 v_accvgpr_write_b32 a72, v236
 v_accvgpr_write_b32 a73, v237
 v_accvgpr_write_b32 a74, v238
 v_accvgpr_write_b32 a75, v239
 v_accvgpr_read_b32 v236, a76
 v_accvgpr_read_b32 v237, a77
 v_accvgpr_read_b32 v238, a78
 v_accvgpr_read_b32 v239, a79
 v_mul_f32 v236, v236, v233
 v_mul_f32 v237, v237, v233
 v_mul_f32 v238, v238, v233
 v_mul_f32 v239, v239, v233
 v_accvgpr_write_b32 a76, v236
 v_accvgpr_write_b32 a77, v237
 v_accvgpr_write_b32 a78, v238
 v_accvgpr_write_b32 a79, v239
 v_accvgpr_read_b32 v236, a80
 v_accvgpr_read_b32 v237, a81
 v_accvgpr_read_b32 v238, a82
 v_accvgpr_read_b32 v239, a83
 v_mul_f32 v236, v236, v233
 v_mul_f32 v237, v237, v233
 v_mul_f32 v238, v238, v233
 v_mul_f32 v239, v239, v233
 v_accvgpr_write_b32 a80, v236
 v_accvgpr_write_b32 a81, v237
 v_accvgpr_write_b32 a82, v238
 v_accvgpr_write_b32 a83, v239
 v_accvgpr_read_b32 v236, a84
 v_accvgpr_read_b32 v237, a85
 v_accvgpr_read_b32 v238, a86
 v_accvgpr_read_b32 v239, a87
 v_mul_f32 v236, v236, v233
 v_mul_f32 v237, v237, v233
 v_mul_f32 v238, v238, v233
 v_mul_f32 v239, v239, v233
 v_accvgpr_write_b32 a84, v236
 v_accvgpr_write_b32 a85, v237
 v_accvgpr_write_b32 a86, v238
 v_accvgpr_write_b32 a87, v239
 v_accvgpr_read_b32 v236, a88
 v_accvgpr_read_b32 v237, a89
 v_accvgpr_read_b32 v238, a90
 v_accvgpr_read_b32 v239, a91
 v_mul_f32 v236, v236, v233
 v_mul_f32 v237, v237, v233
 v_mul_f32 v238, v238, v233
 v_mul_f32 v239, v239, v233
 v_accvgpr_write_b32 a88, v236
 v_accvgpr_write_b32 a89, v237
 v_accvgpr_write_b32 a90, v238
 v_accvgpr_write_b32 a91, v239
 v_accvgpr_read_b32 v236, a92
 v_accvgpr_read_b32 v237, a93
 v_accvgpr_read_b32 v238, a94
 v_accvgpr_read_b32 v239, a95
 v_mul_f32 v236, v236, v233
 v_mul_f32 v237, v237, v233
 v_mul_f32 v238, v238, v233
 v_mul_f32 v239, v239, v233
 v_accvgpr_write_b32 a92, v236
 v_accvgpr_write_b32 a93, v237
 v_accvgpr_write_b32 a94, v238
 v_accvgpr_write_b32 a95, v239
 v_accvgpr_read_b32 v236, a96
 v_accvgpr_read_b32 v237, a97
 v_accvgpr_read_b32 v238, a98
 v_accvgpr_read_b32 v239, a99
 v_mul_f32 v236, v236, v233
 v_mul_f32 v237, v237, v233
 v_mul_f32 v238, v238, v233
 v_mul_f32 v239, v239, v233
 v_accvgpr_write_b32 a96, v236
 v_accvgpr_write_b32 a97, v237
 v_accvgpr_write_b32 a98, v238
 v_accvgpr_write_b32 a99, v239
 v_accvgpr_read_b32 v236, a100
 v_accvgpr_read_b32 v237, a101
 v_accvgpr_read_b32 v238, a102
 v_accvgpr_read_b32 v239, a103
 v_mul_f32 v236, v236, v233
 v_mul_f32 v237, v237, v233
 v_mul_f32 v238, v238, v233
 v_mul_f32 v239, v239, v233
 v_accvgpr_write_b32 a100, v236
 v_accvgpr_write_b32 a101, v237
 v_accvgpr_write_b32 a102, v238
 v_accvgpr_write_b32 a103, v239
 v_accvgpr_read_b32 v236, a104
 v_accvgpr_read_b32 v237, a105
 v_accvgpr_read_b32 v238, a106
 v_accvgpr_read_b32 v239, a107
 v_mul_f32 v236, v236, v233
 v_mul_f32 v237, v237, v233
 v_mul_f32 v238, v238, v233
 v_mul_f32 v239, v239, v233
 v_accvgpr_write_b32 a104, v236
 v_accvgpr_write_b32 a105, v237
 v_accvgpr_write_b32 a106, v238
 v_accvgpr_write_b32 a107, v239
 v_accvgpr_read_b32 v236, a108
 v_accvgpr_read_b32 v237, a109
 v_accvgpr_read_b32 v238, a110
 v_accvgpr_read_b32 v239, a111
 v_mul_f32 v236, v236, v233
 v_mul_f32 v237, v237, v233
 v_mul_f32 v238, v238, v233
 v_mul_f32 v239, v239, v233
 v_accvgpr_write_b32 a108, v236
 v_accvgpr_write_b32 a109, v237
 v_accvgpr_write_b32 a110, v238
 v_accvgpr_write_b32 a111, v239
 v_accvgpr_read_b32 v236, a112
 v_accvgpr_read_b32 v237, a113
 v_accvgpr_read_b32 v238, a114
 v_accvgpr_read_b32 v239, a115
 v_mul_f32 v236, v236, v233
 v_mul_f32 v237, v237, v233
 v_mul_f32 v238, v238, v233
 v_mul_f32 v239, v239, v233
 v_accvgpr_write_b32 a112, v236
 v_accvgpr_write_b32 a113, v237
 v_accvgpr_write_b32 a114, v238
 v_accvgpr_write_b32 a115, v239
 v_accvgpr_read_b32 v236, a116
 v_accvgpr_read_b32 v237, a117
 v_accvgpr_read_b32 v238, a118
 v_accvgpr_read_b32 v239, a119
 v_mul_f32 v236, v236, v233
 v_mul_f32 v237, v237, v233
 v_mul_f32 v238, v238, v233
 v_mul_f32 v239, v239, v233
 v_accvgpr_write_b32 a116, v236
 v_accvgpr_write_b32 a117, v237
 v_accvgpr_write_b32 a118, v238
 v_accvgpr_write_b32 a119, v239
 v_accvgpr_read_b32 v236, a120
 v_accvgpr_read_b32 v237, a121
 v_accvgpr_read_b32 v238, a122
 v_accvgpr_read_b32 v239, a123
 v_mul_f32 v236, v236, v233
 v_mul_f32 v237, v237, v233
 v_mul_f32 v238, v238, v233
 v_mul_f32 v239, v239, v233
 v_accvgpr_write_b32 a120, v236
 v_accvgpr_write_b32 a121, v237
 v_accvgpr_write_b32 a122, v238
 v_accvgpr_write_b32 a123, v239
 v_accvgpr_read_b32 v236, a124
 v_accvgpr_read_b32 v237, a125
 v_accvgpr_read_b32 v238, a126
 v_accvgpr_read_b32 v239, a127
 v_mul_f32 v236, v236, v233
 v_mul_f32 v237, v237, v233
 v_mul_f32 v238, v238, v233
 v_mul_f32 v239, v239, v233
 v_accvgpr_write_b32 a124, v236
 v_accvgpr_write_b32 a125, v237
 v_accvgpr_write_b32 a126, v238
 v_accvgpr_write_b32 a127, v239
 v_exp_f32 v216, v96
 v_exp_f32 v217, v97
 v_exp_f32 v218, v98
 v_exp_f32 v219, v99
 v_add_f32 v227, v216, v217
 v_cvt_pk_bf16_f32 v200, v216, v217
 v_exp_f32 v220, v100
 v_exp_f32 v221, v101
 v_add_f32 v227, v227, v218
 v_add_f32 v227, v227, v219
 v_cvt_pk_bf16_f32 v201, v218, v219
 v_exp_f32 v222, v102
 v_add_f32 v227, v227, v220
 v_add_f32 v227, v227, v221
 v_cvt_pk_bf16_f32 v202, v220, v221
 v_exp_f32 v223, v103
 v_add_f32 v227, v227, v222
 v_exp_f32 v216, v104
 v_add_f32 v227, v227, v223
 v_cvt_pk_bf16_f32 v203, v222, v223
 v_exp_f32 v217, v105
 v_add_f32 v227, v227, v216
 v_add_f32 v227, v227, v217
 v_cvt_pk_bf16_f32 v204, v216, v217
 v_exp_f32 v218, v106
 v_exp_f32 v219, v107
 v_add_f32 v227, v227, v218
 v_add_f32 v227, v227, v219
 v_cvt_pk_bf16_f32 v205, v218, v219
 v_exp_f32 v220, v108
 v_exp_f32 v221, v109
 v_add_f32 v227, v227, v220
 v_add_f32 v227, v227, v221
 v_cvt_pk_bf16_f32 v206, v220, v221
 v_exp_f32 v222, v110
 v_exp_f32 v223, v111
 v_add_f32 v227, v227, v222
 v_add_f32 v227, v227, v223
 v_cvt_pk_bf16_f32 v207, v222, v223
 v_exp_f32 v208, v112
 s_nop 3
 s_branch K2_back23
K2_rare25:
 s_nop 15
 s_nop 15
 v_max3_f32 v232, v112, v113, v114
 v_max3_f32 v232, v232, v115, v116
 v_max3_f32 v232, v232, v117, v118
 v_max3_f32 v232, v232, v119, v120
 v_max3_f32 v232, v232, v121, v122
 v_max3_f32 v232, v232, v123, v124
 v_max3_f32 v232, v232, v125, v126
 v_max_f32 v232, v232, v127
 v_mov_b32 v233, v232
 s_nop 1
 v_permlane32_swap_b32 v232, v233
 v_max_f32 v232, v232, v233
 v_max_f32 v232, 0, v232
 v_sub_f32 v112, v112, v232
 v_sub_f32 v113, v113, v232
 v_sub_f32 v114, v114, v232
 v_sub_f32 v115, v115, v232
 v_sub_f32 v116, v116, v232
 v_sub_f32 v117, v117, v232
 v_sub_f32 v118, v118, v232
 v_sub_f32 v119, v119, v232
 v_sub_f32 v120, v120, v232
 v_sub_f32 v121, v121, v232
 v_sub_f32 v122, v122, v232
 v_sub_f32 v123, v123, v232
 v_sub_f32 v124, v124, v232
 v_sub_f32 v125, v125, v232
 v_sub_f32 v126, v126, v232
 v_sub_f32 v127, v127, v232
 v_sub_f32 v128, v128, v232
 v_sub_f32 v129, v129, v232
 v_sub_f32 v130, v130, v232
 v_sub_f32 v131, v131, v232
 v_sub_f32 v132, v132, v232
 v_sub_f32 v133, v133, v232
 v_sub_f32 v134, v134, v232
 v_sub_f32 v135, v135, v232
 v_sub_f32 v136, v136, v232
 v_sub_f32 v137, v137, v232
 v_sub_f32 v138, v138, v232
 v_sub_f32 v139, v139, v232
 v_sub_f32 v140, v140, v232
 v_sub_f32 v141, v141, v232
 v_sub_f32 v142, v142, v232
 v_sub_f32 v143, v143, v232
 v_sub_f32 v80, v80, v232
 v_sub_f32 v81, v81, v232
 v_sub_f32 v82, v82, v232
 v_sub_f32 v83, v83, v232
 v_sub_f32 v84, v84, v232
 v_sub_f32 v85, v85, v232
 v_sub_f32 v86, v86, v232
 v_sub_f32 v87, v87, v232
 v_sub_f32 v88, v88, v232
 v_sub_f32 v89, v89, v232
 v_sub_f32 v90, v90, v232
 v_sub_f32 v91, v91, v232
 v_sub_f32 v92, v92, v232
 v_sub_f32 v93, v93, v232
 v_sub_f32 v94, v94, v232
 v_sub_f32 v95, v95, v232
 v_sub_f32 v96, v96, v232
 v_sub_f32 v97, v97, v232
 v_sub_f32 v98, v98, v232
 v_sub_f32 v99, v99, v232
 v_sub_f32 v100, v100, v232
 v_sub_f32 v101, v101, v232
 v_sub_f32 v102, v102, v232
 v_sub_f32 v103, v103, v232
 v_sub_f32 v104, v104, v232
 v_sub_f32 v105, v105, v232
 v_sub_f32 v106, v106, v232
 v_sub_f32 v107, v107, v232
 v_sub_f32 v108, v108, v232
 v_sub_f32 v109, v109, v232
 v_sub_f32 v110, v110, v232
 v_sub_f32 v111, v111, v232
 v_sub_f32 v160, v160, v232
 v_sub_f32 v161, v161, v232
 v_sub_f32 v162, v162, v232
 v_sub_f32 v163, v163, v232
 v_sub_f32 v164, v164, v232
 v_sub_f32 v165, v165, v232
 v_sub_f32 v166, v166, v232
 v_sub_f32 v167, v167, v232
 v_sub_f32 v168, v168, v232
 v_sub_f32 v169, v169, v232
 v_sub_f32 v170, v170, v232
 v_sub_f32 v171, v171, v232
 v_sub_f32 v172, v172, v232
 v_sub_f32 v173, v173, v232
 v_sub_f32 v174, v174, v232
 v_sub_f32 v175, v175, v232
 v_sub_f32 v176, v176, v232
 v_sub_f32 v177, v177, v232
 v_sub_f32 v178, v178, v232
 v_sub_f32 v179, v179, v232
 v_sub_f32 v180, v180, v232
 v_sub_f32 v181, v181, v232
 v_sub_f32 v182, v182, v232
 v_sub_f32 v183, v183, v232
 v_sub_f32 v184, v184, v232
 v_sub_f32 v185, v185, v232
 v_sub_f32 v186, v186, v232
 v_sub_f32 v187, v187, v232
 v_sub_f32 v188, v188, v232
 v_sub_f32 v189, v189, v232
 v_sub_f32 v190, v190, v232
 v_sub_f32 v191, v191, v232
 v_exp_f32 v233, -v232
 s_nop 0
 v_mul_f32 v229, v229, v233
 v_accvgpr_read_b32 v236, a64
 v_accvgpr_read_b32 v237, a65
 v_accvgpr_read_b32 v238, a66
 v_accvgpr_read_b32 v239, a67
 v_mul_f32 v236, v236, v233
 v_mul_f32 v237, v237, v233
 v_mul_f32 v238, v238, v233
 v_mul_f32 v239, v239, v233
 v_accvgpr_write_b32 a64, v236
 v_accvgpr_write_b32 a65, v237
 v_accvgpr_write_b32 a66, v238
 v_accvgpr_write_b32 a67, v239
 v_accvgpr_read_b32 v236, a68
 v_accvgpr_read_b32 v237, a69
 v_accvgpr_read_b32 v238, a70
 v_accvgpr_read_b32 v239, a71
 v_mul_f32 v236, v236, v233
 v_mul_f32 v237, v237, v233
 v_mul_f32 v238, v238, v233
 v_mul_f32 v239, v239, v233
 v_accvgpr_write_b32 a68, v236
 v_accvgpr_write_b32 a69, v237
 v_accvgpr_write_b32 a70, v238
 v_accvgpr_write_b32 a71, v239
 v_accvgpr_read_b32 v236, a72
 v_accvgpr_read_b32 v237, a73
 v_accvgpr_read_b32 v238, a74
 v_accvgpr_read_b32 v239, a75
 v_mul_f32 v236, v236, v233
 v_mul_f32 v237, v237, v233
 v_mul_f32 v238, v238, v233
 v_mul_f32 v239, v239, v233
 v_accvgpr_write_b32 a72, v236
 v_accvgpr_write_b32 a73, v237
 v_accvgpr_write_b32 a74, v238
 v_accvgpr_write_b32 a75, v239
 v_accvgpr_read_b32 v236, a76
 v_accvgpr_read_b32 v237, a77
 v_accvgpr_read_b32 v238, a78
 v_accvgpr_read_b32 v239, a79
 v_mul_f32 v236, v236, v233
 v_mul_f32 v237, v237, v233
 v_mul_f32 v238, v238, v233
 v_mul_f32 v239, v239, v233
 v_accvgpr_write_b32 a76, v236
 v_accvgpr_write_b32 a77, v237
 v_accvgpr_write_b32 a78, v238
 v_accvgpr_write_b32 a79, v239
 v_accvgpr_read_b32 v236, a80
 v_accvgpr_read_b32 v237, a81
 v_accvgpr_read_b32 v238, a82
 v_accvgpr_read_b32 v239, a83
 v_mul_f32 v236, v236, v233
 v_mul_f32 v237, v237, v233
 v_mul_f32 v238, v238, v233
 v_mul_f32 v239, v239, v233
 v_accvgpr_write_b32 a80, v236
 v_accvgpr_write_b32 a81, v237
 v_accvgpr_write_b32 a82, v238
 v_accvgpr_write_b32 a83, v239
 v_accvgpr_read_b32 v236, a84
 v_accvgpr_read_b32 v237, a85
 v_accvgpr_read_b32 v238, a86
 v_accvgpr_read_b32 v239, a87
 v_mul_f32 v236, v236, v233
 v_mul_f32 v237, v237, v233
 v_mul_f32 v238, v238, v233
 v_mul_f32 v239, v239, v233
 v_accvgpr_write_b32 a84, v236
 v_accvgpr_write_b32 a85, v237
 v_accvgpr_write_b32 a86, v238
 v_accvgpr_write_b32 a87, v239
 v_accvgpr_read_b32 v236, a88
 v_accvgpr_read_b32 v237, a89
 v_accvgpr_read_b32 v238, a90
 v_accvgpr_read_b32 v239, a91
 v_mul_f32 v236, v236, v233
 v_mul_f32 v237, v237, v233
 v_mul_f32 v238, v238, v233
 v_mul_f32 v239, v239, v233
 v_accvgpr_write_b32 a88, v236
 v_accvgpr_write_b32 a89, v237
 v_accvgpr_write_b32 a90, v238
 v_accvgpr_write_b32 a91, v239
 v_accvgpr_read_b32 v236, a92
 v_accvgpr_read_b32 v237, a93
 v_accvgpr_read_b32 v238, a94
 v_accvgpr_read_b32 v239, a95
 v_mul_f32 v236, v236, v233
 v_mul_f32 v237, v237, v233
 v_mul_f32 v238, v238, v233
 v_mul_f32 v239, v239, v233
 v_accvgpr_write_b32 a92, v236
 v_accvgpr_write_b32 a93, v237
 v_accvgpr_write_b32 a94, v238
 v_accvgpr_write_b32 a95, v239
 v_accvgpr_read_b32 v236, a96
 v_accvgpr_read_b32 v237, a97
 v_accvgpr_read_b32 v238, a98
 v_accvgpr_read_b32 v239, a99
 v_mul_f32 v236, v236, v233
 v_mul_f32 v237, v237, v233
 v_mul_f32 v238, v238, v233
 v_mul_f32 v239, v239, v233
 v_accvgpr_write_b32 a96, v236
 v_accvgpr_write_b32 a97, v237
 v_accvgpr_write_b32 a98, v238
 v_accvgpr_write_b32 a99, v239
 v_accvgpr_read_b32 v236, a100
 v_accvgpr_read_b32 v237, a101
 v_accvgpr_read_b32 v238, a102
 v_accvgpr_read_b32 v239, a103
 v_mul_f32 v236, v236, v233
 v_mul_f32 v237, v237, v233
 v_mul_f32 v238, v238, v233
 v_mul_f32 v239, v239, v233
 v_accvgpr_write_b32 a100, v236
 v_accvgpr_write_b32 a101, v237
 v_accvgpr_write_b32 a102, v238
 v_accvgpr_write_b32 a103, v239
 v_accvgpr_read_b32 v236, a104
 v_accvgpr_read_b32 v237, a105
 v_accvgpr_read_b32 v238, a106
 v_accvgpr_read_b32 v239, a107
 v_mul_f32 v236, v236, v233
 v_mul_f32 v237, v237, v233
 v_mul_f32 v238, v238, v233
 v_mul_f32 v239, v239, v233
 v_accvgpr_write_b32 a104, v236
 v_accvgpr_write_b32 a105, v237
 v_accvgpr_write_b32 a106, v238
 v_accvgpr_write_b32 a107, v239
 v_accvgpr_read_b32 v236, a108
 v_accvgpr_read_b32 v237, a109
 v_accvgpr_read_b32 v238, a110
 v_accvgpr_read_b32 v239, a111
 v_mul_f32 v236, v236, v233
 v_mul_f32 v237, v237, v233
 v_mul_f32 v238, v238, v233
 v_mul_f32 v239, v239, v233
 v_accvgpr_write_b32 a108, v236
 v_accvgpr_write_b32 a109, v237
 v_accvgpr_write_b32 a110, v238
 v_accvgpr_write_b32 a111, v239
 v_accvgpr_read_b32 v236, a112
 v_accvgpr_read_b32 v237, a113
 v_accvgpr_read_b32 v238, a114
 v_accvgpr_read_b32 v239, a115
 v_mul_f32 v236, v236, v233
 v_mul_f32 v237, v237, v233
 v_mul_f32 v238, v238, v233
 v_mul_f32 v239, v239, v233
 v_accvgpr_write_b32 a112, v236
 v_accvgpr_write_b32 a113, v237
 v_accvgpr_write_b32 a114, v238
 v_accvgpr_write_b32 a115, v239
 v_accvgpr_read_b32 v236, a116
 v_accvgpr_read_b32 v237, a117
 v_accvgpr_read_b32 v238, a118
 v_accvgpr_read_b32 v239, a119
 v_mul_f32 v236, v236, v233
 v_mul_f32 v237, v237, v233
 v_mul_f32 v238, v238, v233
 v_mul_f32 v239, v239, v233
 v_accvgpr_write_b32 a116, v236
 v_accvgpr_write_b32 a117, v237
 v_accvgpr_write_b32 a118, v238
 v_accvgpr_write_b32 a119, v239
 v_accvgpr_read_b32 v236, a120
 v_accvgpr_read_b32 v237, a121
 v_accvgpr_read_b32 v238, a122
 v_accvgpr_read_b32 v239, a123
 v_mul_f32 v236, v236, v233
 v_mul_f32 v237, v237, v233
 v_mul_f32 v238, v238, v233
 v_mul_f32 v239, v239, v233
 v_accvgpr_write_b32 a120, v236
 v_accvgpr_write_b32 a121, v237
 v_accvgpr_write_b32 a122, v238
 v_accvgpr_write_b32 a123, v239
 v_accvgpr_read_b32 v236, a124
 v_accvgpr_read_b32 v237, a125
 v_accvgpr_read_b32 v238, a126
 v_accvgpr_read_b32 v239, a127
 v_mul_f32 v236, v236, v233
 v_mul_f32 v237, v237, v233
 v_mul_f32 v238, v238, v233
 v_mul_f32 v239, v239, v233
 v_accvgpr_write_b32 a124, v236
 v_accvgpr_write_b32 a125, v237
 v_accvgpr_write_b32 a126, v238
 v_accvgpr_write_b32 a127, v239
 v_exp_f32 v208, v112
 v_exp_f32 v209, v113
 s_nop 0
 v_add_f32 v226, v208, v209
 v_cvt_pk_bf16_f32 v192, v208, v209
 v_exp_f32 v210, v114
 v_exp_f32 v211, v115
 v_add_f32 v226, v226, v210
 v_add_f32 v226, v226, v211
 v_cvt_pk_bf16_f32 v193, v210, v211
 v_exp_f32 v212, v116
 v_exp_f32 v213, v117
 v_add_f32 v226, v226, v212
 v_add_f32 v226, v226, v213
 v_cvt_pk_bf16_f32 v194, v212, v213
 v_exp_f32 v214, v118
 v_exp_f32 v215, v119
 v_add_f32 v226, v226, v214
 v_add_f32 v226, v226, v215
 v_cvt_pk_bf16_f32 v195, v214, v215
 v_exp_f32 v208, v120
 v_exp_f32 v209, v121
 v_add_f32 v226, v226, v208
 v_add_f32 v226, v226, v209
 v_exp_f32 v210, v122
 v_cvt_pk_bf16_f32 v196, v208, v209
 v_exp_f32 v211, v123
 v_add_f32 v226, v226, v210
 v_exp_f32 v212, v124
 v_add_f32 v226, v226, v211
 v_cvt_pk_bf16_f32 v197, v210, v211
 v_exp_f32 v213, v125
 v_add_f32 v226, v226, v212
 v_exp_f32 v214, v126
 v_add_f32 v226, v226, v213
 v_exp_f32 v215, v127
 v_cvt_pk_bf16_f32 v198, v212, v213
 v_add_f32 v226, v226, v214
 v_add_f32 v226, v226, v215
 v_cvt_pk_bf16_f32 v199, v214, v215
 v_exp_f32 v216, v128
 s_nop 3
 s_branch K2_back25
K2_rare26:
 s_nop 15
 s_nop 15
 v_max3_f32 v232, v128, v129, v130
 v_max3_f32 v232, v232, v131, v132
 v_max3_f32 v232, v232, v133, v134
 v_max3_f32 v232, v232, v135, v136
 v_max3_f32 v232, v232, v137, v138
 v_max3_f32 v232, v232, v139, v140
 v_max3_f32 v232, v232, v141, v142
 v_max_f32 v232, v232, v143
 v_mov_b32 v233, v232
 s_nop 1
 v_permlane32_swap_b32 v232, v233
 v_max_f32 v232, v232, v233
 v_max_f32 v232, 0, v232
 v_sub_f32 v128, v128, v232
 v_sub_f32 v129, v129, v232
 v_sub_f32 v130, v130, v232
 v_sub_f32 v131, v131, v232
 v_sub_f32 v132, v132, v232
 v_sub_f32 v133, v133, v232
 v_sub_f32 v134, v134, v232
 v_sub_f32 v135, v135, v232
 v_sub_f32 v136, v136, v232
 v_sub_f32 v137, v137, v232
 v_sub_f32 v138, v138, v232
 v_sub_f32 v139, v139, v232
 v_sub_f32 v140, v140, v232
 v_sub_f32 v141, v141, v232
 v_sub_f32 v142, v142, v232
 v_sub_f32 v143, v143, v232
 v_sub_f32 v112, v112, v232
 v_sub_f32 v113, v113, v232
 v_sub_f32 v114, v114, v232
 v_sub_f32 v115, v115, v232
 v_sub_f32 v116, v116, v232
 v_sub_f32 v117, v117, v232
 v_sub_f32 v118, v118, v232
 v_sub_f32 v119, v119, v232
 v_sub_f32 v120, v120, v232
 v_sub_f32 v121, v121, v232
 v_sub_f32 v122, v122, v232
 v_sub_f32 v123, v123, v232
 v_sub_f32 v124, v124, v232
 v_sub_f32 v125, v125, v232
 v_sub_f32 v126, v126, v232
 v_sub_f32 v127, v127, v232
 v_sub_f32 v80, v80, v232
 v_sub_f32 v81, v81, v232
 v_sub_f32 v82, v82, v232
 v_sub_f32 v83, v83, v232
 v_sub_f32 v84, v84, v232
 v_sub_f32 v85, v85, v232
 v_sub_f32 v86, v86, v232
 v_sub_f32 v87, v87, v232
 v_sub_f32 v88, v88, v232
 v_sub_f32 v89, v89, v232
 v_sub_f32 v90, v90, v232
 v_sub_f32 v91, v91, v232
 v_sub_f32 v92, v92, v232
 v_sub_f32 v93, v93, v232
 v_sub_f32 v94, v94, v232
 v_sub_f32 v95, v95, v232
 v_sub_f32 v96, v96, v232
 v_sub_f32 v97, v97, v232
 v_sub_f32 v98, v98, v232
 v_sub_f32 v99, v99, v232
 v_sub_f32 v100, v100, v232
 v_sub_f32 v101, v101, v232
 v_sub_f32 v102, v102, v232
 v_sub_f32 v103, v103, v232
 v_sub_f32 v104, v104, v232
 v_sub_f32 v105, v105, v232
 v_sub_f32 v106, v106, v232
 v_sub_f32 v107, v107, v232
 v_sub_f32 v108, v108, v232
 v_sub_f32 v109, v109, v232
 v_sub_f32 v110, v110, v232
 v_sub_f32 v111, v111, v232
 v_sub_f32 v160, v160, v232
 v_sub_f32 v161, v161, v232
 v_sub_f32 v162, v162, v232
 v_sub_f32 v163, v163, v232
 v_sub_f32 v164, v164, v232
 v_sub_f32 v165, v165, v232
 v_sub_f32 v166, v166, v232
 v_sub_f32 v167, v167, v232
 v_sub_f32 v168, v168, v232
 v_sub_f32 v169, v169, v232
 v_sub_f32 v170, v170, v232
 v_sub_f32 v171, v171, v232
 v_sub_f32 v172, v172, v232
 v_sub_f32 v173, v173, v232
 v_sub_f32 v174, v174, v232
 v_sub_f32 v175, v175, v232
 v_sub_f32 v176, v176, v232
 v_sub_f32 v177, v177, v232
 v_sub_f32 v178, v178, v232
 v_sub_f32 v179, v179, v232
 v_sub_f32 v180, v180, v232
 v_sub_f32 v181, v181, v232
 v_sub_f32 v182, v182, v232
 v_sub_f32 v183, v183, v232
 v_sub_f32 v184, v184, v232
 v_sub_f32 v185, v185, v232
 v_sub_f32 v186, v186, v232
 v_sub_f32 v187, v187, v232
 v_sub_f32 v188, v188, v232
 v_sub_f32 v189, v189, v232
 v_sub_f32 v190, v190, v232
 v_sub_f32 v191, v191, v232
 v_exp_f32 v233, -v232
 s_nop 0
 v_mul_f32 v229, v229, v233
 v_accvgpr_read_b32 v236, a64
 v_accvgpr_read_b32 v237, a65
 v_accvgpr_read_b32 v238, a66
 v_accvgpr_read_b32 v239, a67
 v_mul_f32 v236, v236, v233
 v_mul_f32 v237, v237, v233
 v_mul_f32 v238, v238, v233
 v_mul_f32 v239, v239, v233
 v_accvgpr_write_b32 a64, v236
 v_accvgpr_write_b32 a65, v237
 v_accvgpr_write_b32 a66, v238
 v_accvgpr_write_b32 a67, v239
 v_accvgpr_read_b32 v236, a68
 v_accvgpr_read_b32 v237, a69
 v_accvgpr_read_b32 v238, a70
 v_accvgpr_read_b32 v239, a71
 v_mul_f32 v236, v236, v233
 v_mul_f32 v237, v237, v233
 v_mul_f32 v238, v238, v233
 v_mul_f32 v239, v239, v233
 v_accvgpr_write_b32 a68, v236
 v_accvgpr_write_b32 a69, v237
 v_accvgpr_write_b32 a70, v238
 v_accvgpr_write_b32 a71, v239
 v_accvgpr_read_b32 v236, a72
 v_accvgpr_read_b32 v237, a73
 v_accvgpr_read_b32 v238, a74
 v_accvgpr_read_b32 v239, a75
 v_mul_f32 v236, v236, v233
 v_mul_f32 v237, v237, v233
 v_mul_f32 v238, v238, v233
 v_mul_f32 v239, v239, v233
 v_accvgpr_write_b32 a72, v236
 v_accvgpr_write_b32 a73, v237
 v_accvgpr_write_b32 a74, v238
 v_accvgpr_write_b32 a75, v239
 v_accvgpr_read_b32 v236, a76
 v_accvgpr_read_b32 v237, a77
 v_accvgpr_read_b32 v238, a78
 v_accvgpr_read_b32 v239, a79
 v_mul_f32 v236, v236, v233
 v_mul_f32 v237, v237, v233
 v_mul_f32 v238, v238, v233
 v_mul_f32 v239, v239, v233
 v_accvgpr_write_b32 a76, v236
 v_accvgpr_write_b32 a77, v237
 v_accvgpr_write_b32 a78, v238
 v_accvgpr_write_b32 a79, v239
 v_accvgpr_read_b32 v236, a80
 v_accvgpr_read_b32 v237, a81
 v_accvgpr_read_b32 v238, a82
 v_accvgpr_read_b32 v239, a83
 v_mul_f32 v236, v236, v233
 v_mul_f32 v237, v237, v233
 v_mul_f32 v238, v238, v233
 v_mul_f32 v239, v239, v233
 v_accvgpr_write_b32 a80, v236
 v_accvgpr_write_b32 a81, v237
 v_accvgpr_write_b32 a82, v238
 v_accvgpr_write_b32 a83, v239
 v_accvgpr_read_b32 v236, a84
 v_accvgpr_read_b32 v237, a85
 v_accvgpr_read_b32 v238, a86
 v_accvgpr_read_b32 v239, a87
 v_mul_f32 v236, v236, v233
 v_mul_f32 v237, v237, v233
 v_mul_f32 v238, v238, v233
 v_mul_f32 v239, v239, v233
 v_accvgpr_write_b32 a84, v236
 v_accvgpr_write_b32 a85, v237
 v_accvgpr_write_b32 a86, v238
 v_accvgpr_write_b32 a87, v239
 v_accvgpr_read_b32 v236, a88
 v_accvgpr_read_b32 v237, a89
 v_accvgpr_read_b32 v238, a90
 v_accvgpr_read_b32 v239, a91
 v_mul_f32 v236, v236, v233
 v_mul_f32 v237, v237, v233
 v_mul_f32 v238, v238, v233
 v_mul_f32 v239, v239, v233
 v_accvgpr_write_b32 a88, v236
 v_accvgpr_write_b32 a89, v237
 v_accvgpr_write_b32 a90, v238
 v_accvgpr_write_b32 a91, v239
 v_accvgpr_read_b32 v236, a92
 v_accvgpr_read_b32 v237, a93
 v_accvgpr_read_b32 v238, a94
 v_accvgpr_read_b32 v239, a95
 v_mul_f32 v236, v236, v233
 v_mul_f32 v237, v237, v233
 v_mul_f32 v238, v238, v233
 v_mul_f32 v239, v239, v233
 v_accvgpr_write_b32 a92, v236
 v_accvgpr_write_b32 a93, v237
 v_accvgpr_write_b32 a94, v238
 v_accvgpr_write_b32 a95, v239
 v_accvgpr_read_b32 v236, a96
 v_accvgpr_read_b32 v237, a97
 v_accvgpr_read_b32 v238, a98
 v_accvgpr_read_b32 v239, a99
 v_mul_f32 v236, v236, v233
 v_mul_f32 v237, v237, v233
 v_mul_f32 v238, v238, v233
 v_mul_f32 v239, v239, v233
 v_accvgpr_write_b32 a96, v236
 v_accvgpr_write_b32 a97, v237
 v_accvgpr_write_b32 a98, v238
 v_accvgpr_write_b32 a99, v239
 v_accvgpr_read_b32 v236, a100
 v_accvgpr_read_b32 v237, a101
 v_accvgpr_read_b32 v238, a102
 v_accvgpr_read_b32 v239, a103
 v_mul_f32 v236, v236, v233
 v_mul_f32 v237, v237, v233
 v_mul_f32 v238, v238, v233
 v_mul_f32 v239, v239, v233
 v_accvgpr_write_b32 a100, v236
 v_accvgpr_write_b32 a101, v237
 v_accvgpr_write_b32 a102, v238
 v_accvgpr_write_b32 a103, v239
 v_accvgpr_read_b32 v236, a104
 v_accvgpr_read_b32 v237, a105
 v_accvgpr_read_b32 v238, a106
 v_accvgpr_read_b32 v239, a107
 v_mul_f32 v236, v236, v233
 v_mul_f32 v237, v237, v233
 v_mul_f32 v238, v238, v233
 v_mul_f32 v239, v239, v233
 v_accvgpr_write_b32 a104, v236
 v_accvgpr_write_b32 a105, v237
 v_accvgpr_write_b32 a106, v238
 v_accvgpr_write_b32 a107, v239
 v_accvgpr_read_b32 v236, a108
 v_accvgpr_read_b32 v237, a109
 v_accvgpr_read_b32 v238, a110
 v_accvgpr_read_b32 v239, a111
 v_mul_f32 v236, v236, v233
 v_mul_f32 v237, v237, v233
 v_mul_f32 v238, v238, v233
 v_mul_f32 v239, v239, v233
 v_accvgpr_write_b32 a108, v236
 v_accvgpr_write_b32 a109, v237
 v_accvgpr_write_b32 a110, v238
 v_accvgpr_write_b32 a111, v239
 v_accvgpr_read_b32 v236, a112
 v_accvgpr_read_b32 v237, a113
 v_accvgpr_read_b32 v238, a114
 v_accvgpr_read_b32 v239, a115
 v_mul_f32 v236, v236, v233
 v_mul_f32 v237, v237, v233
 v_mul_f32 v238, v238, v233
 v_mul_f32 v239, v239, v233
 v_accvgpr_write_b32 a112, v236
 v_accvgpr_write_b32 a113, v237
 v_accvgpr_write_b32 a114, v238
 v_accvgpr_write_b32 a115, v239
 v_accvgpr_read_b32 v236, a116
 v_accvgpr_read_b32 v237, a117
 v_accvgpr_read_b32 v238, a118
 v_accvgpr_read_b32 v239, a119
 v_mul_f32 v236, v236, v233
 v_mul_f32 v237, v237, v233
 v_mul_f32 v238, v238, v233
 v_mul_f32 v239, v239, v233
 v_accvgpr_write_b32 a116, v236
 v_accvgpr_write_b32 a117, v237
 v_accvgpr_write_b32 a118, v238
 v_accvgpr_write_b32 a119, v239
 v_accvgpr_read_b32 v236, a120
 v_accvgpr_read_b32 v237, a121
 v_accvgpr_read_b32 v238, a122
 v_accvgpr_read_b32 v239, a123
 v_mul_f32 v236, v236, v233
 v_mul_f32 v237, v237, v233
 v_mul_f32 v238, v238, v233
 v_mul_f32 v239, v239, v233
 v_accvgpr_write_b32 a120, v236
 v_accvgpr_write_b32 a121, v237
 v_accvgpr_write_b32 a122, v238
 v_accvgpr_write_b32 a123, v239
 v_accvgpr_read_b32 v236, a124
 v_accvgpr_read_b32 v237, a125
 v_accvgpr_read_b32 v238, a126
 v_accvgpr_read_b32 v239, a127
 v_mul_f32 v236, v236, v233
 v_mul_f32 v237, v237, v233
 v_mul_f32 v238, v238, v233
 v_mul_f32 v239, v239, v233
 v_accvgpr_write_b32 a124, v236
 v_accvgpr_write_b32 a125, v237
 v_accvgpr_write_b32 a126, v238
 v_accvgpr_write_b32 a127, v239
 v_exp_f32 v216, v128
 v_exp_f32 v217, v129
 v_exp_f32 v218, v130
 v_exp_f32 v219, v131
 v_add_f32 v227, v216, v217
 v_cvt_pk_bf16_f32 v200, v216, v217
 v_exp_f32 v220, v132
 v_exp_f32 v221, v133
 v_add_f32 v227, v227, v218
 v_add_f32 v227, v227, v219
 v_cvt_pk_bf16_f32 v201, v218, v219
 v_exp_f32 v222, v134
 v_add_f32 v227, v227, v220
 v_add_f32 v227, v227, v221
 v_cvt_pk_bf16_f32 v202, v220, v221
 v_exp_f32 v223, v135
 v_add_f32 v227, v227, v222
 v_exp_f32 v216, v136
 v_add_f32 v227, v227, v223
 v_cvt_pk_bf16_f32 v203, v222, v223
 v_exp_f32 v217, v137
 v_add_f32 v227, v227, v216
 v_add_f32 v227, v227, v217
 v_cvt_pk_bf16_f32 v204, v216, v217
 v_exp_f32 v218, v138
 v_exp_f32 v219, v139
 v_add_f32 v227, v227, v218
 v_add_f32 v227, v227, v219
 v_cvt_pk_bf16_f32 v205, v218, v219
 v_exp_f32 v220, v140
 v_exp_f32 v221, v141
 v_add_f32 v227, v227, v220
 v_add_f32 v227, v227, v221
 v_cvt_pk_bf16_f32 v206, v220, v221
 v_exp_f32 v222, v142
 v_exp_f32 v223, v143
 v_add_f32 v227, v227, v222
 v_add_f32 v227, v227, v223
 v_cvt_pk_bf16_f32 v207, v222, v223
 v_exp_f32 v208, v80
 s_nop 3
 s_branch K2_back26
K2_rare27:
 s_nop 15
 s_nop 15
 v_max3_f32 v232, v80, v81, v82
 v_max3_f32 v232, v232, v83, v84
 v_max3_f32 v232, v232, v85, v86
 v_max3_f32 v232, v232, v87, v88
 v_max3_f32 v232, v232, v89, v90
 v_max3_f32 v232, v232, v91, v92
 v_max3_f32 v232, v232, v93, v94
 v_max_f32 v232, v232, v95
 v_mov_b32 v233, v232
 s_nop 1
 v_permlane32_swap_b32 v232, v233
 v_max_f32 v232, v232, v233
 v_max_f32 v232, 0, v232
 v_sub_f32 v80, v80, v232
 v_sub_f32 v81, v81, v232
 v_sub_f32 v82, v82, v232
 v_sub_f32 v83, v83, v232
 v_sub_f32 v84, v84, v232
 v_sub_f32 v85, v85, v232
 v_sub_f32 v86, v86, v232
 v_sub_f32 v87, v87, v232
 v_sub_f32 v88, v88, v232
 v_sub_f32 v89, v89, v232
 v_sub_f32 v90, v90, v232
 v_sub_f32 v91, v91, v232
 v_sub_f32 v92, v92, v232
 v_sub_f32 v93, v93, v232
 v_sub_f32 v94, v94, v232
 v_sub_f32 v95, v95, v232
 v_sub_f32 v96, v96, v232
 v_sub_f32 v97, v97, v232
 v_sub_f32 v98, v98, v232
 v_sub_f32 v99, v99, v232
 v_sub_f32 v100, v100, v232
 v_sub_f32 v101, v101, v232
 v_sub_f32 v102, v102, v232
 v_sub_f32 v103, v103, v232
 v_sub_f32 v104, v104, v232
 v_sub_f32 v105, v105, v232
 v_sub_f32 v106, v106, v232
 v_sub_f32 v107, v107, v232
 v_sub_f32 v108, v108, v232
 v_sub_f32 v109, v109, v232
 v_sub_f32 v110, v110, v232
 v_sub_f32 v111, v111, v232
 v_sub_f32 v112, v112, v232
 v_sub_f32 v113, v113, v232
 v_sub_f32 v114, v114, v232
 v_sub_f32 v115, v115, v232
 v_sub_f32 v116, v116, v232
 v_sub_f32 v117, v117, v232
 v_sub_f32 v118, v118, v232
 v_sub_f32 v119, v119, v232
 v_sub_f32 v120, v120, v232
 v_sub_f32 v121, v121, v232
 v_sub_f32 v122, v122, v232
 v_sub_f32 v123, v123, v232
 v_sub_f32 v124, v124, v232
 v_sub_f32 v125, v125, v232
 v_sub_f32 v126, v126, v232
 v_sub_f32 v127, v127, v232
 v_sub_f32 v128, v128, v232
 v_sub_f32 v129, v129, v232
 v_sub_f32 v130, v130, v232
 v_sub_f32 v131, v131, v232
 v_sub_f32 v132, v132, v232
 v_sub_f32 v133, v133, v232
 v_sub_f32 v134, v134, v232
 v_sub_f32 v135, v135, v232
 v_sub_f32 v136, v136, v232
 v_sub_f32 v137, v137, v232
 v_sub_f32 v138, v138, v232
 v_sub_f32 v139, v139, v232
 v_sub_f32 v140, v140, v232
 v_sub_f32 v141, v141, v232
 v_sub_f32 v142, v142, v232
 v_sub_f32 v143, v143, v232
 v_sub_f32 v160, v160, v232
 v_sub_f32 v161, v161, v232
 v_sub_f32 v162, v162, v232
 v_sub_f32 v163, v163, v232
 v_sub_f32 v164, v164, v232
 v_sub_f32 v165, v165, v232
 v_sub_f32 v166, v166, v232
 v_sub_f32 v167, v167, v232
 v_sub_f32 v168, v168, v232
 v_sub_f32 v169, v169, v232
 v_sub_f32 v170, v170, v232
 v_sub_f32 v171, v171, v232
 v_sub_f32 v172, v172, v232
 v_sub_f32 v173, v173, v232
 v_sub_f32 v174, v174, v232
 v_sub_f32 v175, v175, v232
 v_sub_f32 v176, v176, v232
 v_sub_f32 v177, v177, v232
 v_sub_f32 v178, v178, v232
 v_sub_f32 v179, v179, v232
 v_sub_f32 v180, v180, v232
 v_sub_f32 v181, v181, v232
 v_sub_f32 v182, v182, v232
 v_sub_f32 v183, v183, v232
 v_sub_f32 v184, v184, v232
 v_sub_f32 v185, v185, v232
 v_sub_f32 v186, v186, v232
 v_sub_f32 v187, v187, v232
 v_sub_f32 v188, v188, v232
 v_sub_f32 v189, v189, v232
 v_sub_f32 v190, v190, v232
 v_sub_f32 v191, v191, v232
 v_exp_f32 v233, -v232
 s_nop 0
 v_mul_f32 v229, v229, v233
 v_accvgpr_read_b32 v236, a64
 v_accvgpr_read_b32 v237, a65
 v_accvgpr_read_b32 v238, a66
 v_accvgpr_read_b32 v239, a67
 v_mul_f32 v236, v236, v233
 v_mul_f32 v237, v237, v233
 v_mul_f32 v238, v238, v233
 v_mul_f32 v239, v239, v233
 v_accvgpr_write_b32 a64, v236
 v_accvgpr_write_b32 a65, v237
 v_accvgpr_write_b32 a66, v238
 v_accvgpr_write_b32 a67, v239
 v_accvgpr_read_b32 v236, a68
 v_accvgpr_read_b32 v237, a69
 v_accvgpr_read_b32 v238, a70
 v_accvgpr_read_b32 v239, a71
 v_mul_f32 v236, v236, v233
 v_mul_f32 v237, v237, v233
 v_mul_f32 v238, v238, v233
 v_mul_f32 v239, v239, v233
 v_accvgpr_write_b32 a68, v236
 v_accvgpr_write_b32 a69, v237
 v_accvgpr_write_b32 a70, v238
 v_accvgpr_write_b32 a71, v239
 v_accvgpr_read_b32 v236, a72
 v_accvgpr_read_b32 v237, a73
 v_accvgpr_read_b32 v238, a74
 v_accvgpr_read_b32 v239, a75
 v_mul_f32 v236, v236, v233
 v_mul_f32 v237, v237, v233
 v_mul_f32 v238, v238, v233
 v_mul_f32 v239, v239, v233
 v_accvgpr_write_b32 a72, v236
 v_accvgpr_write_b32 a73, v237
 v_accvgpr_write_b32 a74, v238
 v_accvgpr_write_b32 a75, v239
 v_accvgpr_read_b32 v236, a76
 v_accvgpr_read_b32 v237, a77
 v_accvgpr_read_b32 v238, a78
 v_accvgpr_read_b32 v239, a79
 v_mul_f32 v236, v236, v233
 v_mul_f32 v237, v237, v233
 v_mul_f32 v238, v238, v233
 v_mul_f32 v239, v239, v233
 v_accvgpr_write_b32 a76, v236
 v_accvgpr_write_b32 a77, v237
 v_accvgpr_write_b32 a78, v238
 v_accvgpr_write_b32 a79, v239
 v_accvgpr_read_b32 v236, a80
 v_accvgpr_read_b32 v237, a81
 v_accvgpr_read_b32 v238, a82
 v_accvgpr_read_b32 v239, a83
 v_mul_f32 v236, v236, v233
 v_mul_f32 v237, v237, v233
 v_mul_f32 v238, v238, v233
 v_mul_f32 v239, v239, v233
 v_accvgpr_write_b32 a80, v236
 v_accvgpr_write_b32 a81, v237
 v_accvgpr_write_b32 a82, v238
 v_accvgpr_write_b32 a83, v239
 v_accvgpr_read_b32 v236, a84
 v_accvgpr_read_b32 v237, a85
 v_accvgpr_read_b32 v238, a86
 v_accvgpr_read_b32 v239, a87
 v_mul_f32 v236, v236, v233
 v_mul_f32 v237, v237, v233
 v_mul_f32 v238, v238, v233
 v_mul_f32 v239, v239, v233
 v_accvgpr_write_b32 a84, v236
 v_accvgpr_write_b32 a85, v237
 v_accvgpr_write_b32 a86, v238
 v_accvgpr_write_b32 a87, v239
 v_accvgpr_read_b32 v236, a88
 v_accvgpr_read_b32 v237, a89
 v_accvgpr_read_b32 v238, a90
 v_accvgpr_read_b32 v239, a91
 v_mul_f32 v236, v236, v233
 v_mul_f32 v237, v237, v233
 v_mul_f32 v238, v238, v233
 v_mul_f32 v239, v239, v233
 v_accvgpr_write_b32 a88, v236
 v_accvgpr_write_b32 a89, v237
 v_accvgpr_write_b32 a90, v238
 v_accvgpr_write_b32 a91, v239
 v_accvgpr_read_b32 v236, a92
 v_accvgpr_read_b32 v237, a93
 v_accvgpr_read_b32 v238, a94
 v_accvgpr_read_b32 v239, a95
 v_mul_f32 v236, v236, v233
 v_mul_f32 v237, v237, v233
 v_mul_f32 v238, v238, v233
 v_mul_f32 v239, v239, v233
 v_accvgpr_write_b32 a92, v236
 v_accvgpr_write_b32 a93, v237
 v_accvgpr_write_b32 a94, v238
 v_accvgpr_write_b32 a95, v239
 v_accvgpr_read_b32 v236, a96
 v_accvgpr_read_b32 v237, a97
 v_accvgpr_read_b32 v238, a98
 v_accvgpr_read_b32 v239, a99
 v_mul_f32 v236, v236, v233
 v_mul_f32 v237, v237, v233
 v_mul_f32 v238, v238, v233
 v_mul_f32 v239, v239, v233
 v_accvgpr_write_b32 a96, v236
 v_accvgpr_write_b32 a97, v237
 v_accvgpr_write_b32 a98, v238
 v_accvgpr_write_b32 a99, v239
 v_accvgpr_read_b32 v236, a100
 v_accvgpr_read_b32 v237, a101
 v_accvgpr_read_b32 v238, a102
 v_accvgpr_read_b32 v239, a103
 v_mul_f32 v236, v236, v233
 v_mul_f32 v237, v237, v233
 v_mul_f32 v238, v238, v233
 v_mul_f32 v239, v239, v233
 v_accvgpr_write_b32 a100, v236
 v_accvgpr_write_b32 a101, v237
 v_accvgpr_write_b32 a102, v238
 v_accvgpr_write_b32 a103, v239
 v_accvgpr_read_b32 v236, a104
 v_accvgpr_read_b32 v237, a105
 v_accvgpr_read_b32 v238, a106
 v_accvgpr_read_b32 v239, a107
 v_mul_f32 v236, v236, v233
 v_mul_f32 v237, v237, v233
 v_mul_f32 v238, v238, v233
 v_mul_f32 v239, v239, v233
 v_accvgpr_write_b32 a104, v236
 v_accvgpr_write_b32 a105, v237
 v_accvgpr_write_b32 a106, v238
 v_accvgpr_write_b32 a107, v239
 v_accvgpr_read_b32 v236, a108
 v_accvgpr_read_b32 v237, a109
 v_accvgpr_read_b32 v238, a110
 v_accvgpr_read_b32 v239, a111
 v_mul_f32 v236, v236, v233
 v_mul_f32 v237, v237, v233
 v_mul_f32 v238, v238, v233
 v_mul_f32 v239, v239, v233
 v_accvgpr_write_b32 a108, v236
 v_accvgpr_write_b32 a109, v237
 v_accvgpr_write_b32 a110, v238
 v_accvgpr_write_b32 a111, v239
 v_accvgpr_read_b32 v236, a112
 v_accvgpr_read_b32 v237, a113
 v_accvgpr_read_b32 v238, a114
 v_accvgpr_read_b32 v239, a115
 v_mul_f32 v236, v236, v233
 v_mul_f32 v237, v237, v233
 v_mul_f32 v238, v238, v233
 v_mul_f32 v239, v239, v233
 v_accvgpr_write_b32 a112, v236
 v_accvgpr_write_b32 a113, v237
 v_accvgpr_write_b32 a114, v238
 v_accvgpr_write_b32 a115, v239
 v_accvgpr_read_b32 v236, a116
 v_accvgpr_read_b32 v237, a117
 v_accvgpr_read_b32 v238, a118
 v_accvgpr_read_b32 v239, a119
 v_mul_f32 v236, v236, v233
 v_mul_f32 v237, v237, v233
 v_mul_f32 v238, v238, v233
 v_mul_f32 v239, v239, v233
 v_accvgpr_write_b32 a116, v236
 v_accvgpr_write_b32 a117, v237
 v_accvgpr_write_b32 a118, v238
 v_accvgpr_write_b32 a119, v239
 v_accvgpr_read_b32 v236, a120
 v_accvgpr_read_b32 v237, a121
 v_accvgpr_read_b32 v238, a122
 v_accvgpr_read_b32 v239, a123
 v_mul_f32 v236, v236, v233
 v_mul_f32 v237, v237, v233
 v_mul_f32 v238, v238, v233
 v_mul_f32 v239, v239, v233
 v_accvgpr_write_b32 a120, v236
 v_accvgpr_write_b32 a121, v237
 v_accvgpr_write_b32 a122, v238
 v_accvgpr_write_b32 a123, v239
 v_accvgpr_read_b32 v236, a124
 v_accvgpr_read_b32 v237, a125
 v_accvgpr_read_b32 v238, a126
 v_accvgpr_read_b32 v239, a127
 v_mul_f32 v236, v236, v233
 v_mul_f32 v237, v237, v233
 v_mul_f32 v238, v238, v233
 v_mul_f32 v239, v239, v233
 v_accvgpr_write_b32 a124, v236
 v_accvgpr_write_b32 a125, v237
 v_accvgpr_write_b32 a126, v238
 v_accvgpr_write_b32 a127, v239
 v_exp_f32 v208, v80
 v_exp_f32 v209, v81
 s_nop 0
 v_add_f32 v226, v208, v209
 v_cvt_pk_bf16_f32 v192, v208, v209
 v_exp_f32 v210, v82
 v_exp_f32 v211, v83
 v_add_f32 v226, v226, v210
 v_add_f32 v226, v226, v211
 v_cvt_pk_bf16_f32 v193, v210, v211
 v_exp_f32 v212, v84
 v_exp_f32 v213, v85
 v_add_f32 v226, v226, v212
 v_add_f32 v226, v226, v213
 v_cvt_pk_bf16_f32 v194, v212, v213
 v_exp_f32 v214, v86
 v_exp_f32 v215, v87
 v_add_f32 v226, v226, v214
 v_add_f32 v226, v226, v215
 v_cvt_pk_bf16_f32 v195, v214, v215
 v_exp_f32 v208, v88
 v_exp_f32 v209, v89
 v_exp_f32 v210, v90
 v_exp_f32 v211, v91
 v_add_f32 v226, v226, v208
 v_exp_f32 v212, v92
 v_add_f32 v226, v226, v209
 v_cvt_pk_bf16_f32 v196, v208, v209
 v_exp_f32 v213, v93
 v_add_f32 v226, v226, v210
 v_exp_f32 v214, v94
 v_add_f32 v226, v226, v211
 v_cvt_pk_bf16_f32 v197, v210, v211
 v_add_f32 v226, v226, v212
 v_exp_f32 v215, v95
 v_add_f32 v226, v226, v213
 v_cvt_pk_bf16_f32 v198, v212, v213
 v_add_f32 v226, v226, v214
 v_add_f32 v226, v226, v215
 v_cvt_pk_bf16_f32 v199, v214, v215
 v_exp_f32 v216, v96
 s_nop 3
 s_branch K2_back27
K2_rare28:
 s_nop 15
 s_nop 15
 v_max3_f32 v232, v96, v97, v98
 v_max3_f32 v232, v232, v99, v100
 v_max3_f32 v232, v232, v101, v102
 v_max3_f32 v232, v232, v103, v104
 v_max3_f32 v232, v232, v105, v106
 v_max3_f32 v232, v232, v107, v108
 v_max3_f32 v232, v232, v109, v110
 v_max_f32 v232, v232, v111
 v_mov_b32 v233, v232
 s_nop 1
 v_permlane32_swap_b32 v232, v233
 v_max_f32 v232, v232, v233
 v_max_f32 v232, 0, v232
 v_sub_f32 v96, v96, v232
 v_sub_f32 v97, v97, v232
 v_sub_f32 v98, v98, v232
 v_sub_f32 v99, v99, v232
 v_sub_f32 v100, v100, v232
 v_sub_f32 v101, v101, v232
 v_sub_f32 v102, v102, v232
 v_sub_f32 v103, v103, v232
 v_sub_f32 v104, v104, v232
 v_sub_f32 v105, v105, v232
 v_sub_f32 v106, v106, v232
 v_sub_f32 v107, v107, v232
 v_sub_f32 v108, v108, v232
 v_sub_f32 v109, v109, v232
 v_sub_f32 v110, v110, v232
 v_sub_f32 v111, v111, v232
 v_sub_f32 v80, v80, v232
 v_sub_f32 v81, v81, v232
 v_sub_f32 v82, v82, v232
 v_sub_f32 v83, v83, v232
 v_sub_f32 v84, v84, v232
 v_sub_f32 v85, v85, v232
 v_sub_f32 v86, v86, v232
 v_sub_f32 v87, v87, v232
 v_sub_f32 v88, v88, v232
 v_sub_f32 v89, v89, v232
 v_sub_f32 v90, v90, v232
 v_sub_f32 v91, v91, v232
 v_sub_f32 v92, v92, v232
 v_sub_f32 v93, v93, v232
 v_sub_f32 v94, v94, v232
 v_sub_f32 v95, v95, v232
 v_sub_f32 v112, v112, v232
 v_sub_f32 v113, v113, v232
 v_sub_f32 v114, v114, v232
 v_sub_f32 v115, v115, v232
 v_sub_f32 v116, v116, v232
 v_sub_f32 v117, v117, v232
 v_sub_f32 v118, v118, v232
 v_sub_f32 v119, v119, v232
 v_sub_f32 v120, v120, v232
 v_sub_f32 v121, v121, v232
 v_sub_f32 v122, v122, v232
 v_sub_f32 v123, v123, v232
 v_sub_f32 v124, v124, v232
 v_sub_f32 v125, v125, v232
 v_sub_f32 v126, v126, v232
 v_sub_f32 v127, v127, v232
 v_sub_f32 v128, v128, v232
 v_sub_f32 v129, v129, v232
 v_sub_f32 v130, v130, v232
 v_sub_f32 v131, v131, v232
 v_sub_f32 v132, v132, v232
 v_sub_f32 v133, v133, v232
 v_sub_f32 v134, v134, v232
 v_sub_f32 v135, v135, v232
 v_sub_f32 v136, v136, v232
 v_sub_f32 v137, v137, v232
 v_sub_f32 v138, v138, v232
 v_sub_f32 v139, v139, v232
 v_sub_f32 v140, v140, v232
 v_sub_f32 v141, v141, v232
 v_sub_f32 v142, v142, v232
 v_sub_f32 v143, v143, v232
 v_sub_f32 v160, v160, v232
 v_sub_f32 v161, v161, v232
 v_sub_f32 v162, v162, v232
 v_sub_f32 v163, v163, v232
 v_sub_f32 v164, v164, v232
 v_sub_f32 v165, v165, v232
 v_sub_f32 v166, v166, v232
 v_sub_f32 v167, v167, v232
 v_sub_f32 v168, v168, v232
 v_sub_f32 v169, v169, v232
 v_sub_f32 v170, v170, v232
 v_sub_f32 v171, v171, v232
 v_sub_f32 v172, v172, v232
 v_sub_f32 v173, v173, v232
 v_sub_f32 v174, v174, v232
 v_sub_f32 v175, v175, v232
 v_sub_f32 v176, v176, v232
 v_sub_f32 v177, v177, v232
 v_sub_f32 v178, v178, v232
 v_sub_f32 v179, v179, v232
 v_sub_f32 v180, v180, v232
 v_sub_f32 v181, v181, v232
 v_sub_f32 v182, v182, v232
 v_sub_f32 v183, v183, v232
 v_sub_f32 v184, v184, v232
 v_sub_f32 v185, v185, v232
 v_sub_f32 v186, v186, v232
 v_sub_f32 v187, v187, v232
 v_sub_f32 v188, v188, v232
 v_sub_f32 v189, v189, v232
 v_sub_f32 v190, v190, v232
 v_sub_f32 v191, v191, v232
 v_exp_f32 v233, -v232
 s_nop 0
 v_mul_f32 v229, v229, v233
 v_accvgpr_read_b32 v236, a64
 v_accvgpr_read_b32 v237, a65
 v_accvgpr_read_b32 v238, a66
 v_accvgpr_read_b32 v239, a67
 v_mul_f32 v236, v236, v233
 v_mul_f32 v237, v237, v233
 v_mul_f32 v238, v238, v233
 v_mul_f32 v239, v239, v233
 v_accvgpr_write_b32 a64, v236
 v_accvgpr_write_b32 a65, v237
 v_accvgpr_write_b32 a66, v238
 v_accvgpr_write_b32 a67, v239
 v_accvgpr_read_b32 v236, a68
 v_accvgpr_read_b32 v237, a69
 v_accvgpr_read_b32 v238, a70
 v_accvgpr_read_b32 v239, a71
 v_mul_f32 v236, v236, v233
 v_mul_f32 v237, v237, v233
 v_mul_f32 v238, v238, v233
 v_mul_f32 v239, v239, v233
 v_accvgpr_write_b32 a68, v236
 v_accvgpr_write_b32 a69, v237
 v_accvgpr_write_b32 a70, v238
 v_accvgpr_write_b32 a71, v239
 v_accvgpr_read_b32 v236, a72
 v_accvgpr_read_b32 v237, a73
 v_accvgpr_read_b32 v238, a74
 v_accvgpr_read_b32 v239, a75
 v_mul_f32 v236, v236, v233
 v_mul_f32 v237, v237, v233
 v_mul_f32 v238, v238, v233
 v_mul_f32 v239, v239, v233
 v_accvgpr_write_b32 a72, v236
 v_accvgpr_write_b32 a73, v237
 v_accvgpr_write_b32 a74, v238
 v_accvgpr_write_b32 a75, v239
 v_accvgpr_read_b32 v236, a76
 v_accvgpr_read_b32 v237, a77
 v_accvgpr_read_b32 v238, a78
 v_accvgpr_read_b32 v239, a79
 v_mul_f32 v236, v236, v233
 v_mul_f32 v237, v237, v233
 v_mul_f32 v238, v238, v233
 v_mul_f32 v239, v239, v233
 v_accvgpr_write_b32 a76, v236
 v_accvgpr_write_b32 a77, v237
 v_accvgpr_write_b32 a78, v238
 v_accvgpr_write_b32 a79, v239
 v_accvgpr_read_b32 v236, a80
 v_accvgpr_read_b32 v237, a81
 v_accvgpr_read_b32 v238, a82
 v_accvgpr_read_b32 v239, a83
 v_mul_f32 v236, v236, v233
 v_mul_f32 v237, v237, v233
 v_mul_f32 v238, v238, v233
 v_mul_f32 v239, v239, v233
 v_accvgpr_write_b32 a80, v236
 v_accvgpr_write_b32 a81, v237
 v_accvgpr_write_b32 a82, v238
 v_accvgpr_write_b32 a83, v239
 v_accvgpr_read_b32 v236, a84
 v_accvgpr_read_b32 v237, a85
 v_accvgpr_read_b32 v238, a86
 v_accvgpr_read_b32 v239, a87
 v_mul_f32 v236, v236, v233
 v_mul_f32 v237, v237, v233
 v_mul_f32 v238, v238, v233
 v_mul_f32 v239, v239, v233
 v_accvgpr_write_b32 a84, v236
 v_accvgpr_write_b32 a85, v237
 v_accvgpr_write_b32 a86, v238
 v_accvgpr_write_b32 a87, v239
 v_accvgpr_read_b32 v236, a88
 v_accvgpr_read_b32 v237, a89
 v_accvgpr_read_b32 v238, a90
 v_accvgpr_read_b32 v239, a91
 v_mul_f32 v236, v236, v233
 v_mul_f32 v237, v237, v233
 v_mul_f32 v238, v238, v233
 v_mul_f32 v239, v239, v233
 v_accvgpr_write_b32 a88, v236
 v_accvgpr_write_b32 a89, v237
 v_accvgpr_write_b32 a90, v238
 v_accvgpr_write_b32 a91, v239
 v_accvgpr_read_b32 v236, a92
 v_accvgpr_read_b32 v237, a93
 v_accvgpr_read_b32 v238, a94
 v_accvgpr_read_b32 v239, a95
 v_mul_f32 v236, v236, v233
 v_mul_f32 v237, v237, v233
 v_mul_f32 v238, v238, v233
 v_mul_f32 v239, v239, v233
 v_accvgpr_write_b32 a92, v236
 v_accvgpr_write_b32 a93, v237
 v_accvgpr_write_b32 a94, v238
 v_accvgpr_write_b32 a95, v239
 v_accvgpr_read_b32 v236, a96
 v_accvgpr_read_b32 v237, a97
 v_accvgpr_read_b32 v238, a98
 v_accvgpr_read_b32 v239, a99
 v_mul_f32 v236, v236, v233
 v_mul_f32 v237, v237, v233
 v_mul_f32 v238, v238, v233
 v_mul_f32 v239, v239, v233
 v_accvgpr_write_b32 a96, v236
 v_accvgpr_write_b32 a97, v237
 v_accvgpr_write_b32 a98, v238
 v_accvgpr_write_b32 a99, v239
 v_accvgpr_read_b32 v236, a100
 v_accvgpr_read_b32 v237, a101
 v_accvgpr_read_b32 v238, a102
 v_accvgpr_read_b32 v239, a103
 v_mul_f32 v236, v236, v233
 v_mul_f32 v237, v237, v233
 v_mul_f32 v238, v238, v233
 v_mul_f32 v239, v239, v233
 v_accvgpr_write_b32 a100, v236
 v_accvgpr_write_b32 a101, v237
 v_accvgpr_write_b32 a102, v238
 v_accvgpr_write_b32 a103, v239
 v_accvgpr_read_b32 v236, a104
 v_accvgpr_read_b32 v237, a105
 v_accvgpr_read_b32 v238, a106
 v_accvgpr_read_b32 v239, a107
 v_mul_f32 v236, v236, v233
 v_mul_f32 v237, v237, v233
 v_mul_f32 v238, v238, v233
 v_mul_f32 v239, v239, v233
 v_accvgpr_write_b32 a104, v236
 v_accvgpr_write_b32 a105, v237
 v_accvgpr_write_b32 a106, v238
 v_accvgpr_write_b32 a107, v239
 v_accvgpr_read_b32 v236, a108
 v_accvgpr_read_b32 v237, a109
 v_accvgpr_read_b32 v238, a110
 v_accvgpr_read_b32 v239, a111
 v_mul_f32 v236, v236, v233
 v_mul_f32 v237, v237, v233
 v_mul_f32 v238, v238, v233
 v_mul_f32 v239, v239, v233
 v_accvgpr_write_b32 a108, v236
 v_accvgpr_write_b32 a109, v237
 v_accvgpr_write_b32 a110, v238
 v_accvgpr_write_b32 a111, v239
 v_accvgpr_read_b32 v236, a112
 v_accvgpr_read_b32 v237, a113
 v_accvgpr_read_b32 v238, a114
 v_accvgpr_read_b32 v239, a115
 v_mul_f32 v236, v236, v233
 v_mul_f32 v237, v237, v233
 v_mul_f32 v238, v238, v233
 v_mul_f32 v239, v239, v233
 v_accvgpr_write_b32 a112, v236
 v_accvgpr_write_b32 a113, v237
 v_accvgpr_write_b32 a114, v238
 v_accvgpr_write_b32 a115, v239
 v_accvgpr_read_b32 v236, a116
 v_accvgpr_read_b32 v237, a117
 v_accvgpr_read_b32 v238, a118
 v_accvgpr_read_b32 v239, a119
 v_mul_f32 v236, v236, v233
 v_mul_f32 v237, v237, v233
 v_mul_f32 v238, v238, v233
 v_mul_f32 v239, v239, v233
 v_accvgpr_write_b32 a116, v236
 v_accvgpr_write_b32 a117, v237
 v_accvgpr_write_b32 a118, v238
 v_accvgpr_write_b32 a119, v239
 v_accvgpr_read_b32 v236, a120
 v_accvgpr_read_b32 v237, a121
 v_accvgpr_read_b32 v238, a122
 v_accvgpr_read_b32 v239, a123
 v_mul_f32 v236, v236, v233
 v_mul_f32 v237, v237, v233
 v_mul_f32 v238, v238, v233
 v_mul_f32 v239, v239, v233
 v_accvgpr_write_b32 a120, v236
 v_accvgpr_write_b32 a121, v237
 v_accvgpr_write_b32 a122, v238
 v_accvgpr_write_b32 a123, v239
 v_accvgpr_read_b32 v236, a124
 v_accvgpr_read_b32 v237, a125
 v_accvgpr_read_b32 v238, a126
 v_accvgpr_read_b32 v239, a127
 v_mul_f32 v236, v236, v233
 v_mul_f32 v237, v237, v233
 v_mul_f32 v238, v238, v233
 v_mul_f32 v239, v239, v233
 v_accvgpr_write_b32 a124, v236
 v_accvgpr_write_b32 a125, v237
 v_accvgpr_write_b32 a126, v238
 v_accvgpr_write_b32 a127, v239
 v_exp_f32 v216, v96
 v_exp_f32 v217, v97
 v_exp_f32 v218, v98
 v_exp_f32 v219, v99
 v_exp_f32 v220, v100
 v_add_f32 v227, v216, v217
 v_exp_f32 v221, v101
 v_cvt_pk_bf16_f32 v200, v216, v217
 v_exp_f32 v222, v102
 v_add_f32 v227, v227, v218
 v_add_f32 v227, v227, v219
 v_cvt_pk_bf16_f32 v201, v218, v219
 v_exp_f32 v223, v103
 v_add_f32 v227, v227, v220
 v_exp_f32 v216, v104
 v_exp_f32 v217, v105
 v_add_f32 v227, v227, v221
 v_cvt_pk_bf16_f32 v202, v220, v221
 v_exp_f32 v218, v106
 v_exp_f32 v219, v107
 v_add_f32 v227, v227, v222
 v_add_f32 v227, v227, v223
 v_cvt_pk_bf16_f32 v203, v222, v223
 v_exp_f32 v220, v108
 v_add_f32 v227, v227, v216
 v_exp_f32 v221, v109
 v_add_f32 v227, v227, v217
 v_cvt_pk_bf16_f32 v204, v216, v217
 v_add_f32 v227, v227, v218
 v_exp_f32 v222, v110
 v_add_f32 v227, v227, v219
 v_cvt_pk_bf16_f32 v205, v218, v219
 v_exp_f32 v223, v111
 v_add_f32 v227, v227, v220
 v_add_f32 v227, v227, v221
 v_cvt_pk_bf16_f32 v206, v220, v221
 v_add_f32 v227, v227, v222
 v_add_f32 v227, v227, v223
 v_cvt_pk_bf16_f32 v207, v222, v223
 v_exp_f32 v208, v112
 s_nop 3
 s_branch K2_back28
K2_rare29:
 s_nop 15
 s_nop 15
 v_max3_f32 v232, v112, v113, v114
 v_max3_f32 v232, v232, v115, v116
 v_max3_f32 v232, v232, v117, v118
 v_max3_f32 v232, v232, v119, v120
 v_max3_f32 v232, v232, v121, v122
 v_max3_f32 v232, v232, v123, v124
 v_max3_f32 v232, v232, v125, v126
 v_max_f32 v232, v232, v127
 v_mov_b32 v233, v232
 s_nop 1
 v_permlane32_swap_b32 v232, v233
 v_max_f32 v232, v232, v233
 v_max_f32 v232, 0, v232
 v_sub_f32 v112, v112, v232
 v_sub_f32 v113, v113, v232
 v_sub_f32 v114, v114, v232
 v_sub_f32 v115, v115, v232
 v_sub_f32 v116, v116, v232
 v_sub_f32 v117, v117, v232
 v_sub_f32 v118, v118, v232
 v_sub_f32 v119, v119, v232
 v_sub_f32 v120, v120, v232
 v_sub_f32 v121, v121, v232
 v_sub_f32 v122, v122, v232
 v_sub_f32 v123, v123, v232
 v_sub_f32 v124, v124, v232
 v_sub_f32 v125, v125, v232
 v_sub_f32 v126, v126, v232
 v_sub_f32 v127, v127, v232
 v_sub_f32 v128, v128, v232
 v_sub_f32 v129, v129, v232
 v_sub_f32 v130, v130, v232
 v_sub_f32 v131, v131, v232
 v_sub_f32 v132, v132, v232
 v_sub_f32 v133, v133, v232
 v_sub_f32 v134, v134, v232
 v_sub_f32 v135, v135, v232
 v_sub_f32 v136, v136, v232
 v_sub_f32 v137, v137, v232
 v_sub_f32 v138, v138, v232
 v_sub_f32 v139, v139, v232
 v_sub_f32 v140, v140, v232
 v_sub_f32 v141, v141, v232
 v_sub_f32 v142, v142, v232
 v_sub_f32 v143, v143, v232
 v_exp_f32 v233, -v232
 s_nop 0
 v_mul_f32 v229, v229, v233
 v_accvgpr_read_b32 v236, a64
 v_accvgpr_read_b32 v237, a65
 v_accvgpr_read_b32 v238, a66
 v_accvgpr_read_b32 v239, a67
 v_mul_f32 v236, v236, v233
 v_mul_f32 v237, v237, v233
 v_mul_f32 v238, v238, v233
 v_mul_f32 v239, v239, v233
 v_accvgpr_write_b32 a64, v236
 v_accvgpr_write_b32 a65, v237
 v_accvgpr_write_b32 a66, v238
 v_accvgpr_write_b32 a67, v239
 v_accvgpr_read_b32 v236, a68
 v_accvgpr_read_b32 v237, a69
 v_accvgpr_read_b32 v238, a70
 v_accvgpr_read_b32 v239, a71
 v_mul_f32 v236, v236, v233
 v_mul_f32 v237, v237, v233
 v_mul_f32 v238, v238, v233
 v_mul_f32 v239, v239, v233
 v_accvgpr_write_b32 a68, v236
 v_accvgpr_write_b32 a69, v237
 v_accvgpr_write_b32 a70, v238
 v_accvgpr_write_b32 a71, v239
 v_accvgpr_read_b32 v236, a72
 v_accvgpr_read_b32 v237, a73
 v_accvgpr_read_b32 v238, a74
 v_accvgpr_read_b32 v239, a75
 v_mul_f32 v236, v236, v233
 v_mul_f32 v237, v237, v233
 v_mul_f32 v238, v238, v233
 v_mul_f32 v239, v239, v233
 v_accvgpr_write_b32 a72, v236
 v_accvgpr_write_b32 a73, v237
 v_accvgpr_write_b32 a74, v238
 v_accvgpr_write_b32 a75, v239
 v_accvgpr_read_b32 v236, a76
 v_accvgpr_read_b32 v237, a77
 v_accvgpr_read_b32 v238, a78
 v_accvgpr_read_b32 v239, a79
 v_mul_f32 v236, v236, v233
 v_mul_f32 v237, v237, v233
 v_mul_f32 v238, v238, v233
 v_mul_f32 v239, v239, v233
 v_accvgpr_write_b32 a76, v236
 v_accvgpr_write_b32 a77, v237
 v_accvgpr_write_b32 a78, v238
 v_accvgpr_write_b32 a79, v239
 v_accvgpr_read_b32 v236, a80
 v_accvgpr_read_b32 v237, a81
 v_accvgpr_read_b32 v238, a82
 v_accvgpr_read_b32 v239, a83
 v_mul_f32 v236, v236, v233
 v_mul_f32 v237, v237, v233
 v_mul_f32 v238, v238, v233
 v_mul_f32 v239, v239, v233
 v_accvgpr_write_b32 a80, v236
 v_accvgpr_write_b32 a81, v237
 v_accvgpr_write_b32 a82, v238
 v_accvgpr_write_b32 a83, v239
 v_accvgpr_read_b32 v236, a84
 v_accvgpr_read_b32 v237, a85
 v_accvgpr_read_b32 v238, a86
 v_accvgpr_read_b32 v239, a87
 v_mul_f32 v236, v236, v233
 v_mul_f32 v237, v237, v233
 v_mul_f32 v238, v238, v233
 v_mul_f32 v239, v239, v233
 v_accvgpr_write_b32 a84, v236
 v_accvgpr_write_b32 a85, v237
 v_accvgpr_write_b32 a86, v238
 v_accvgpr_write_b32 a87, v239
 v_accvgpr_read_b32 v236, a88
 v_accvgpr_read_b32 v237, a89
 v_accvgpr_read_b32 v238, a90
 v_accvgpr_read_b32 v239, a91
 v_mul_f32 v236, v236, v233
 v_mul_f32 v237, v237, v233
 v_mul_f32 v238, v238, v233
 v_mul_f32 v239, v239, v233
 v_accvgpr_write_b32 a88, v236
 v_accvgpr_write_b32 a89, v237
 v_accvgpr_write_b32 a90, v238
 v_accvgpr_write_b32 a91, v239
 v_accvgpr_read_b32 v236, a92
 v_accvgpr_read_b32 v237, a93
 v_accvgpr_read_b32 v238, a94
 v_accvgpr_read_b32 v239, a95
 v_mul_f32 v236, v236, v233
 v_mul_f32 v237, v237, v233
 v_mul_f32 v238, v238, v233
 v_mul_f32 v239, v239, v233
 v_accvgpr_write_b32 a92, v236
 v_accvgpr_write_b32 a93, v237
 v_accvgpr_write_b32 a94, v238
 v_accvgpr_write_b32 a95, v239
 v_accvgpr_read_b32 v236, a96
 v_accvgpr_read_b32 v237, a97
 v_accvgpr_read_b32 v238, a98
 v_accvgpr_read_b32 v239, a99
 v_mul_f32 v236, v236, v233
 v_mul_f32 v237, v237, v233
 v_mul_f32 v238, v238, v233
 v_mul_f32 v239, v239, v233
 v_accvgpr_write_b32 a96, v236
 v_accvgpr_write_b32 a97, v237
 v_accvgpr_write_b32 a98, v238
 v_accvgpr_write_b32 a99, v239
 v_accvgpr_read_b32 v236, a100
 v_accvgpr_read_b32 v237, a101
 v_accvgpr_read_b32 v238, a102
 v_accvgpr_read_b32 v239, a103
 v_mul_f32 v236, v236, v233
 v_mul_f32 v237, v237, v233
 v_mul_f32 v238, v238, v233
 v_mul_f32 v239, v239, v233
 v_accvgpr_write_b32 a100, v236
 v_accvgpr_write_b32 a101, v237
 v_accvgpr_write_b32 a102, v238
 v_accvgpr_write_b32 a103, v239
 v_accvgpr_read_b32 v236, a104
 v_accvgpr_read_b32 v237, a105
 v_accvgpr_read_b32 v238, a106
 v_accvgpr_read_b32 v239, a107
 v_mul_f32 v236, v236, v233
 v_mul_f32 v237, v237, v233
 v_mul_f32 v238, v238, v233
 v_mul_f32 v239, v239, v233
 v_accvgpr_write_b32 a104, v236
 v_accvgpr_write_b32 a105, v237
 v_accvgpr_write_b32 a106, v238
 v_accvgpr_write_b32 a107, v239
 v_accvgpr_read_b32 v236, a108
 v_accvgpr_read_b32 v237, a109
 v_accvgpr_read_b32 v238, a110
 v_accvgpr_read_b32 v239, a111
 v_mul_f32 v236, v236, v233
 v_mul_f32 v237, v237, v233
 v_mul_f32 v238, v238, v233
 v_mul_f32 v239, v239, v233
 v_accvgpr_write_b32 a108, v236
 v_accvgpr_write_b32 a109, v237
 v_accvgpr_write_b32 a110, v238
 v_accvgpr_write_b32 a111, v239
 v_accvgpr_read_b32 v236, a112
 v_accvgpr_read_b32 v237, a113
 v_accvgpr_read_b32 v238, a114
 v_accvgpr_read_b32 v239, a115
 v_mul_f32 v236, v236, v233
 v_mul_f32 v237, v237, v233
 v_mul_f32 v238, v238, v233
 v_mul_f32 v239, v239, v233
 v_accvgpr_write_b32 a112, v236
 v_accvgpr_write_b32 a113, v237
 v_accvgpr_write_b32 a114, v238
 v_accvgpr_write_b32 a115, v239
 v_accvgpr_read_b32 v236, a116
 v_accvgpr_read_b32 v237, a117
 v_accvgpr_read_b32 v238, a118
 v_accvgpr_read_b32 v239, a119
 v_mul_f32 v236, v236, v233
 v_mul_f32 v237, v237, v233
 v_mul_f32 v238, v238, v233
 v_mul_f32 v239, v239, v233
 v_accvgpr_write_b32 a116, v236
 v_accvgpr_write_b32 a117, v237
 v_accvgpr_write_b32 a118, v238
 v_accvgpr_write_b32 a119, v239
 v_accvgpr_read_b32 v236, a120
 v_accvgpr_read_b32 v237, a121
 v_accvgpr_read_b32 v238, a122
 v_accvgpr_read_b32 v239, a123
 v_mul_f32 v236, v236, v233
 v_mul_f32 v237, v237, v233
 v_mul_f32 v238, v238, v233
 v_mul_f32 v239, v239, v233
 v_accvgpr_write_b32 a120, v236
 v_accvgpr_write_b32 a121, v237
 v_accvgpr_write_b32 a122, v238
 v_accvgpr_write_b32 a123, v239
 v_accvgpr_read_b32 v236, a124
 v_accvgpr_read_b32 v237, a125
 v_accvgpr_read_b32 v238, a126
 v_accvgpr_read_b32 v239, a127
 v_mul_f32 v236, v236, v233
 v_mul_f32 v237, v237, v233
 v_mul_f32 v238, v238, v233
 v_mul_f32 v239, v239, v233
 v_accvgpr_write_b32 a124, v236
 v_accvgpr_write_b32 a125, v237
 v_accvgpr_write_b32 a126, v238
 v_accvgpr_write_b32 a127, v239
 v_exp_f32 v208, v112
 v_exp_f32 v209, v113
 s_nop 0
 v_add_f32 v226, v208, v209
 v_cvt_pk_bf16_f32 v192, v208, v209
 v_exp_f32 v210, v114
 v_exp_f32 v211, v115
 v_add_f32 v226, v226, v210
 v_add_f32 v226, v226, v211
 v_cvt_pk_bf16_f32 v193, v210, v211
 v_exp_f32 v212, v116
 v_exp_f32 v213, v117
 v_add_f32 v226, v226, v212
 v_add_f32 v226, v226, v213
 v_cvt_pk_bf16_f32 v194, v212, v213
 v_exp_f32 v214, v118
 v_exp_f32 v215, v119
 v_add_f32 v226, v226, v214
 v_add_f32 v226, v226, v215
 v_cvt_pk_bf16_f32 v195, v214, v215
 v_exp_f32 v208, v120
 v_exp_f32 v209, v121
 v_add_f32 v226, v226, v208
 v_add_f32 v226, v226, v209
 v_cvt_pk_bf16_f32 v196, v208, v209
 v_exp_f32 v210, v122
 v_exp_f32 v211, v123
 v_add_f32 v226, v226, v210
 v_add_f32 v226, v226, v211
 v_cvt_pk_bf16_f32 v197, v210, v211
 v_exp_f32 v212, v124
 v_exp_f32 v213, v125
 v_add_f32 v226, v226, v212
 v_add_f32 v226, v226, v213
 v_cvt_pk_bf16_f32 v198, v212, v213
 v_exp_f32 v214, v126
 v_exp_f32 v215, v127
 v_add_f32 v226, v226, v214
 v_add_f32 v226, v226, v215
 v_cvt_pk_bf16_f32 v199, v214, v215
 v_exp_f32 v216, v128
 s_nop 3
 s_branch K2_back29
K2_rare30:
 s_nop 15
 s_nop 15
 v_max3_f32 v232, v128, v129, v130
 v_max3_f32 v232, v232, v131, v132
 v_max3_f32 v232, v232, v133, v134
 v_max3_f32 v232, v232, v135, v136
 v_max3_f32 v232, v232, v137, v138
 v_max3_f32 v232, v232, v139, v140
 v_max3_f32 v232, v232, v141, v142
 v_max_f32 v232, v232, v143
 v_mov_b32 v233, v232
 s_nop 1
 v_permlane32_swap_b32 v232, v233
 v_max_f32 v232, v232, v233
 v_max_f32 v232, 0, v232
 v_sub_f32 v128, v128, v232
 v_sub_f32 v129, v129, v232
 v_sub_f32 v130, v130, v232
 v_sub_f32 v131, v131, v232
 v_sub_f32 v132, v132, v232
 v_sub_f32 v133, v133, v232
 v_sub_f32 v134, v134, v232
 v_sub_f32 v135, v135, v232
 v_sub_f32 v136, v136, v232
 v_sub_f32 v137, v137, v232
 v_sub_f32 v138, v138, v232
 v_sub_f32 v139, v139, v232
 v_sub_f32 v140, v140, v232
 v_sub_f32 v141, v141, v232
 v_sub_f32 v142, v142, v232
 v_sub_f32 v143, v143, v232
 v_sub_f32 v112, v112, v232
 v_sub_f32 v113, v113, v232
 v_sub_f32 v114, v114, v232
 v_sub_f32 v115, v115, v232
 v_sub_f32 v116, v116, v232
 v_sub_f32 v117, v117, v232
 v_sub_f32 v118, v118, v232
 v_sub_f32 v119, v119, v232
 v_sub_f32 v120, v120, v232
 v_sub_f32 v121, v121, v232
 v_sub_f32 v122, v122, v232
 v_sub_f32 v123, v123, v232
 v_sub_f32 v124, v124, v232
 v_sub_f32 v125, v125, v232
 v_sub_f32 v126, v126, v232
 v_sub_f32 v127, v127, v232
 v_exp_f32 v233, -v232
 s_nop 0
 v_mul_f32 v229, v229, v233
 v_accvgpr_read_b32 v236, a64
 v_accvgpr_read_b32 v237, a65
 v_accvgpr_read_b32 v238, a66
 v_accvgpr_read_b32 v239, a67
 v_mul_f32 v236, v236, v233
 v_mul_f32 v237, v237, v233
 v_mul_f32 v238, v238, v233
 v_mul_f32 v239, v239, v233
 v_accvgpr_write_b32 a64, v236
 v_accvgpr_write_b32 a65, v237
 v_accvgpr_write_b32 a66, v238
 v_accvgpr_write_b32 a67, v239
 v_accvgpr_read_b32 v236, a68
 v_accvgpr_read_b32 v237, a69
 v_accvgpr_read_b32 v238, a70
 v_accvgpr_read_b32 v239, a71
 v_mul_f32 v236, v236, v233
 v_mul_f32 v237, v237, v233
 v_mul_f32 v238, v238, v233
 v_mul_f32 v239, v239, v233
 v_accvgpr_write_b32 a68, v236
 v_accvgpr_write_b32 a69, v237
 v_accvgpr_write_b32 a70, v238
 v_accvgpr_write_b32 a71, v239
 v_accvgpr_read_b32 v236, a72
 v_accvgpr_read_b32 v237, a73
 v_accvgpr_read_b32 v238, a74
 v_accvgpr_read_b32 v239, a75
 v_mul_f32 v236, v236, v233
 v_mul_f32 v237, v237, v233
 v_mul_f32 v238, v238, v233
 v_mul_f32 v239, v239, v233
 v_accvgpr_write_b32 a72, v236
 v_accvgpr_write_b32 a73, v237
 v_accvgpr_write_b32 a74, v238
 v_accvgpr_write_b32 a75, v239
 v_accvgpr_read_b32 v236, a76
 v_accvgpr_read_b32 v237, a77
 v_accvgpr_read_b32 v238, a78
 v_accvgpr_read_b32 v239, a79
 v_mul_f32 v236, v236, v233
 v_mul_f32 v237, v237, v233
 v_mul_f32 v238, v238, v233
 v_mul_f32 v239, v239, v233
 v_accvgpr_write_b32 a76, v236
 v_accvgpr_write_b32 a77, v237
 v_accvgpr_write_b32 a78, v238
 v_accvgpr_write_b32 a79, v239
 v_accvgpr_read_b32 v236, a80
 v_accvgpr_read_b32 v237, a81
 v_accvgpr_read_b32 v238, a82
 v_accvgpr_read_b32 v239, a83
 v_mul_f32 v236, v236, v233
 v_mul_f32 v237, v237, v233
 v_mul_f32 v238, v238, v233
 v_mul_f32 v239, v239, v233
 v_accvgpr_write_b32 a80, v236
 v_accvgpr_write_b32 a81, v237
 v_accvgpr_write_b32 a82, v238
 v_accvgpr_write_b32 a83, v239
 v_accvgpr_read_b32 v236, a84
 v_accvgpr_read_b32 v237, a85
 v_accvgpr_read_b32 v238, a86
 v_accvgpr_read_b32 v239, a87
 v_mul_f32 v236, v236, v233
 v_mul_f32 v237, v237, v233
 v_mul_f32 v238, v238, v233
 v_mul_f32 v239, v239, v233
 v_accvgpr_write_b32 a84, v236
 v_accvgpr_write_b32 a85, v237
 v_accvgpr_write_b32 a86, v238
 v_accvgpr_write_b32 a87, v239
 v_accvgpr_read_b32 v236, a88
 v_accvgpr_read_b32 v237, a89
 v_accvgpr_read_b32 v238, a90
 v_accvgpr_read_b32 v239, a91
 v_mul_f32 v236, v236, v233
 v_mul_f32 v237, v237, v233
 v_mul_f32 v238, v238, v233
 v_mul_f32 v239, v239, v233
 v_accvgpr_write_b32 a88, v236
 v_accvgpr_write_b32 a89, v237
 v_accvgpr_write_b32 a90, v238
 v_accvgpr_write_b32 a91, v239
 v_accvgpr_read_b32 v236, a92
 v_accvgpr_read_b32 v237, a93
 v_accvgpr_read_b32 v238, a94
 v_accvgpr_read_b32 v239, a95
 v_mul_f32 v236, v236, v233
 v_mul_f32 v237, v237, v233
 v_mul_f32 v238, v238, v233
 v_mul_f32 v239, v239, v233
 v_accvgpr_write_b32 a92, v236
 v_accvgpr_write_b32 a93, v237
 v_accvgpr_write_b32 a94, v238
 v_accvgpr_write_b32 a95, v239
 v_accvgpr_read_b32 v236, a96
 v_accvgpr_read_b32 v237, a97
 v_accvgpr_read_b32 v238, a98
 v_accvgpr_read_b32 v239, a99
 v_mul_f32 v236, v236, v233
 v_mul_f32 v237, v237, v233
 v_mul_f32 v238, v238, v233
 v_mul_f32 v239, v239, v233
 v_accvgpr_write_b32 a96, v236
 v_accvgpr_write_b32 a97, v237
 v_accvgpr_write_b32 a98, v238
 v_accvgpr_write_b32 a99, v239
 v_accvgpr_read_b32 v236, a100
 v_accvgpr_read_b32 v237, a101
 v_accvgpr_read_b32 v238, a102
 v_accvgpr_read_b32 v239, a103
 v_mul_f32 v236, v236, v233
 v_mul_f32 v237, v237, v233
 v_mul_f32 v238, v238, v233
 v_mul_f32 v239, v239, v233
 v_accvgpr_write_b32 a100, v236
 v_accvgpr_write_b32 a101, v237
 v_accvgpr_write_b32 a102, v238
 v_accvgpr_write_b32 a103, v239
 v_accvgpr_read_b32 v236, a104
 v_accvgpr_read_b32 v237, a105
 v_accvgpr_read_b32 v238, a106
 v_accvgpr_read_b32 v239, a107
 v_mul_f32 v236, v236, v233
 v_mul_f32 v237, v237, v233
 v_mul_f32 v238, v238, v233
 v_mul_f32 v239, v239, v233
 v_accvgpr_write_b32 a104, v236
 v_accvgpr_write_b32 a105, v237
 v_accvgpr_write_b32 a106, v238
 v_accvgpr_write_b32 a107, v239
 v_accvgpr_read_b32 v236, a108
 v_accvgpr_read_b32 v237, a109
 v_accvgpr_read_b32 v238, a110
 v_accvgpr_read_b32 v239, a111
 v_mul_f32 v236, v236, v233
 v_mul_f32 v237, v237, v233
 v_mul_f32 v238, v238, v233
 v_mul_f32 v239, v239, v233
 v_accvgpr_write_b32 a108, v236
 v_accvgpr_write_b32 a109, v237
 v_accvgpr_write_b32 a110, v238
 v_accvgpr_write_b32 a111, v239
 v_accvgpr_read_b32 v236, a112
 v_accvgpr_read_b32 v237, a113
 v_accvgpr_read_b32 v238, a114
 v_accvgpr_read_b32 v239, a115
 v_mul_f32 v236, v236, v233
 v_mul_f32 v237, v237, v233
 v_mul_f32 v238, v238, v233
 v_mul_f32 v239, v239, v233
 v_accvgpr_write_b32 a112, v236
 v_accvgpr_write_b32 a113, v237
 v_accvgpr_write_b32 a114, v238
 v_accvgpr_write_b32 a115, v239
 v_accvgpr_read_b32 v236, a116
 v_accvgpr_read_b32 v237, a117
 v_accvgpr_read_b32 v238, a118
 v_accvgpr_read_b32 v239, a119
 v_mul_f32 v236, v236, v233
 v_mul_f32 v237, v237, v233
 v_mul_f32 v238, v238, v233
 v_mul_f32 v239, v239, v233
 v_accvgpr_write_b32 a116, v236
 v_accvgpr_write_b32 a117, v237
 v_accvgpr_write_b32 a118, v238
 v_accvgpr_write_b32 a119, v239
 v_accvgpr_read_b32 v236, a120
 v_accvgpr_read_b32 v237, a121
 v_accvgpr_read_b32 v238, a122
 v_accvgpr_read_b32 v239, a123
 v_mul_f32 v236, v236, v233
 v_mul_f32 v237, v237, v233
 v_mul_f32 v238, v238, v233
 v_mul_f32 v239, v239, v233
 v_accvgpr_write_b32 a120, v236
 v_accvgpr_write_b32 a121, v237
 v_accvgpr_write_b32 a122, v238
 v_accvgpr_write_b32 a123, v239
 v_accvgpr_read_b32 v236, a124
 v_accvgpr_read_b32 v237, a125
 v_accvgpr_read_b32 v238, a126
 v_accvgpr_read_b32 v239, a127
 v_mul_f32 v236, v236, v233
 v_mul_f32 v237, v237, v233
 v_mul_f32 v238, v238, v233
 v_mul_f32 v239, v239, v233
 v_accvgpr_write_b32 a124, v236
 v_accvgpr_write_b32 a125, v237
 v_accvgpr_write_b32 a126, v238
 v_accvgpr_write_b32 a127, v239
 v_exp_f32 v216, v128
 v_exp_f32 v217, v129
 s_nop 0
 v_add_f32 v227, v216, v217
 v_cvt_pk_bf16_f32 v200, v216, v217
 v_exp_f32 v218, v130
 v_exp_f32 v219, v131
 v_add_f32 v227, v227, v218
 v_add_f32 v227, v227, v219
 v_cvt_pk_bf16_f32 v201, v218, v219
 v_exp_f32 v220, v132
 v_exp_f32 v221, v133
 v_add_f32 v227, v227, v220
 v_add_f32 v227, v227, v221
 v_cvt_pk_bf16_f32 v202, v220, v221
 v_exp_f32 v222, v134
 v_exp_f32 v223, v135
 v_add_f32 v227, v227, v222
 v_add_f32 v227, v227, v223
 v_cvt_pk_bf16_f32 v203, v222, v223
 v_exp_f32 v216, v136
 v_exp_f32 v217, v137
 v_add_f32 v227, v227, v216
 v_add_f32 v227, v227, v217
 v_exp_f32 v218, v138
 v_cvt_pk_bf16_f32 v204, v216, v217
 v_exp_f32 v219, v139
 v_add_f32 v227, v227, v218
 v_add_f32 v227, v227, v219
 v_exp_f32 v220, v140
 v_cvt_pk_bf16_f32 v205, v218, v219
 v_exp_f32 v221, v141
 v_add_f32 v227, v227, v220
 v_add_f32 v227, v227, v221
 v_exp_f32 v222, v142
 v_cvt_pk_bf16_f32 v206, v220, v221
 v_exp_f32 v223, v143
 v_add_f32 v227, v227, v222
 v_add_f32 v227, v227, v223
 v_cvt_pk_bf16_f32 v207, v222, v223
 s_nop 3
 s_branch K2_back30
 s_endpgm

.section .rodata,"a"
.p2align 6
.amdhsa_kernel gated_mix__linear_kernel_hedgehog__compressed_kv_cla__prompt_kernel
  .amdhsa_next_free_vgpr 512
  .amdhsa_next_free_sgpr 102
  .amdhsa_accum_offset 256
  .amdhsa_group_segment_fixed_size 0
  .amdhsa_kernarg_size 112
  .amdhsa_user_sgpr_count 2
  .amdhsa_user_sgpr_kernarg_segment_ptr 1
  .amdhsa_system_sgpr_workgroup_id_x 1
  .amdhsa_float_denorm_mode_32 3
.end_amdhsa_kernel
```
